```python
import torch

def _softmax(x, axis=-1):
    return torch.softmax(x, dim=axis)
def _gelu(x):
    return torch.nn.functional.gelu(x, approximate="tanh")
def _silu(x):
    return torch.nn.functional.silu(x)
def _sigmoid(x):
    return torch.sigmoid(x)
def _layernorm(x, axis=-1, eps=1e-5):
    m = x.mean(dim=axis, keepdim=True)
    v = x.var(dim=axis, keepdim=True, unbiased=False)
    return (x - m) / torch.sqrt(v + eps)
def _scatter_add(tgt, idx, src, axis=0):
    return tgt.clone().index_add_(axis, idx, src)
def _segment_sum(src, seg, n):
    out = torch.zeros((n,) + src.shape[1:], dtype=src.dtype)
    return out.index_add_(0, seg, src)
def _pad(x, pw):
    flat = tuple(v for pair in reversed(pw) for v in pair)
    return torch.nn.functional.pad(x, flat)

kernel_name = 'concat_heads__sliding_local_dilated__spectral_fnet__prompt'

def setup_inputs():

    _w = (lambda a: (lambda t: t.to(torch.bfloat16) if t.is_floating_point() else t)(torch.as_tensor(a)))
    def _A_setup():
        B, S, D = 1, 2048, 448
        return {
            "x": _w((lambda *s: torch.randn(*s, dtype=torch.bfloat16) * 0.2)(B, S, D)),
            "wqkv": _w((lambda *s: torch.randn(*s, dtype=torch.bfloat16) * 0.8)(D, 3 * D)),
            "wo": _w((lambda *s: torch.randn(*s, dtype=torch.bfloat16) * 0.2)(D, D)),
        }
    _A_in = _A_setup()

    def _B_setup():
        B, S, D = 1, 2048, 448
        ns = torch.arange(S)[:, None] * torch.arange(S)[None, :]
        nd = torch.arange(D)[:, None] * torch.arange(D)[None, :]
        Ws_re = torch.cos(-2.0 * torch.pi * ns / S).to(float)
        Ws_im = torch.sin(-2.0 * torch.pi * ns / S).to(float)
        Wd_re = torch.cos(-2.0 * torch.pi * nd / D).to(float)
        Wd_im = torch.sin(-2.0 * torch.pi * nd / D).to(float)
        return {
            "x": _w((lambda *s: torch.randn(*s, dtype=torch.bfloat16) * 0.05)(B, S, D)),
            "dft_seq_re": _w(Ws_re),
            "dft_seq_im": _w(Ws_im),
            "dft_hid_re": _w(Wd_re),
            "dft_hid_im": _w(Wd_im),
        }
    _B_in = _B_setup()

    return {
        "A_x": _A_in["x"],
        "A_wqkv": _A_in["wqkv"],
        "A_wo": _A_in["wo"],
        "B_x": _B_in["x"],
        "B_dft_seq_re": _B_in["dft_seq_re"],
        "B_dft_seq_im": _B_in["dft_seq_im"],
        "B_dft_hid_re": _B_in["dft_hid_re"],
        "B_dft_hid_im": _B_in["dft_hid_im"],
    }

def reference(A_x, A_wqkv, A_wo, B_x, B_dft_seq_re, B_dft_seq_im, B_dft_hid_re, B_dft_hid_im):
    def _A_ref(x, wqkv, wo):
        B, S, D = x.shape
        H = 16; Dh = D // H
        W, dil = 8, 2
        qkv = (lambda x, *d: x.permute(*d))((x @ wqkv).reshape(B, S, 3, H, Dh), 2, 0, 3, 1, 4)
        q, k, v = qkv[0], qkv[1], qkv[2]
        scale = Dh ** -0.5
        pos = torch.arange(S)
        off = torch.arange(W) * dil
        idx = pos[:, None] - off[None, :]
        mask = idx >= 0
        idx_c = torch.where(mask, idx, 0).reshape(-1)
        kg = k[:, :, idx_c, :].reshape(B, H, S, W, Dh)
        vg = v[:, :, idx_c, :].reshape(B, H, S, W, Dh)
        logits = torch.einsum("bhsd,bhswd->bhsw", q, kg) * scale
        logits = torch.where(mask[None, None, :, :], logits, -1e9)
        attn = _softmax(logits, axis=-1)
        o = torch.einsum("bhsw,bhswd->bhsd", attn, vg)
        return (lambda x, *d: x.permute(*d))(o, 0, 2, 1, 3).reshape(B, S, D) @ wo

    def _B_ref(x, dft_seq_re, dft_seq_im, dft_hid_re, dft_hid_im):
        a = torch.einsum("bsd,ed->bse", x, dft_hid_re)
        b = torch.einsum("bsd,ed->bse", x, dft_hid_im)
        y = torch.einsum("ts,bse->bte", dft_seq_re, a) - torch.einsum("ts,bse->bte", dft_seq_im, b)
        return y

    a = _A_ref(A_x, A_wqkv, A_wo)
    b = _B_ref(B_x, B_dft_seq_re, B_dft_seq_im, B_dft_hid_re, B_dft_hid_im)
    return torch.concatenate([a, b], axis=-1)
```

```asm
; @launch kernel=k1_kernel grid=(256,1,1) block=(256,1,1) lds=159744
; @launch kernel=k2_kernel grid=(448,1,1) block=(256,1,1) lds=66560
.amdgcn_target "amdgcn-amd-amdhsa--gfx950"
.text
.p2align 12
.fill 832, 4, 0xbf810000
.globl k1_kernel
.p2align 8
.type k1_kernel,@function
k1_kernel:
    s_load_dwordx4 s[4:7], s[0:1], 0
    s_load_dwordx2 s[8:9], s[0:1], 24
    s_load_dwordx2 s[10:11], s[0:1], 80
    s_cmp_ge_u32 s2, 256
    s_cbranch_scc1 K1_end

    s_getpc_b64 s[40:41]
    s_mov_b32 s42, 16384
    s_mov_b32 s43, 0x00020000
    v_lshlrev_b32 v1, 7, v0
    buffer_load_dword v2, v1, s[40:43], 0 offen

    v_lshrrev_b32 v3, 6, v0
    s_nop 0
    v_readfirstlane_b32 s3, v3
    s_and_b32 s24, s2, 7
    s_lshr_b32 s25, s2, 3
    s_cmp_ge_u32 s25, 24
    s_cbranch_scc1 K1_b1

    s_lshr_b32 s30, s25, 3
    s_lshr_b32 s31, s24, 1
    s_mul_i32 s26, s31, 3
    s_add_u32 s26, s26, s30
    s_and_b32 s27, s25, 7
    s_lshl_b32 s30, s30, 1
    s_add_u32 s28, s30, s27
    s_cmp_ge_u32 s28, 7
    s_cselect_b32 s30, 7, 0
    s_sub_u32 s28, s28, s30
    s_and_b32 s31, s24, 1
    s_lshl_b32 s31, s31, 3
    s_add_u32 s27, s27, s31
    v_and_b32 v4, 63, v0
    v_lshrrev_b32 v7, 3, v4
    v_mul_u32_u24 v9, 896, v7
    v_lshrrev_b32 v7, 4, v4
    v_and_b32 v8, 7, v4
    v_xor_b32 v7, v7, v8
    v_lshl_add_u32 v9, v7, 4, v9
    v_xor_b32 v10, 64, v9
    v_lshrrev_b32 v7, 2, v4
    v_mul_u32_u24 v11, 2688, v7
    v_lshrrev_b32 v7, 5, v4
    v_lshlrev_b32 v7, 1, v7
    v_and_b32 v8, 3, v4
    v_xor_b32 v7, v7, v8
    v_lshl_add_u32 v11, v7, 4, v11
    s_mul_i32 s30, s26, 176
    s_mul_i32 s31, s3, 48
    s_add_u32 s30, s30, s31
    s_sub_u32 s30, s30, 16

    s_add_i32 s31, s30, 0
    s_max_i32 s31, s31, 0
    s_min_i32 s31, s31, 2040
    s_mul_i32 s44, s31, 896
    s_add_i32 s31, s30, 8
    s_max_i32 s31, s31, 0
    s_min_i32 s31, s31, 2040
    s_mul_i32 s45, s31, 896
    s_add_i32 s31, s30, 16
    s_max_i32 s31, s31, 0
    s_min_i32 s31, s31, 2040
    s_mul_i32 s46, s31, 896
    s_add_i32 s31, s30, 24
    s_max_i32 s31, s31, 0
    s_min_i32 s31, s31, 2040
    s_mul_i32 s47, s31, 896
    s_add_i32 s31, s30, 32
    s_max_i32 s31, s31, 0
    s_min_i32 s31, s31, 2040
    s_mul_i32 s48, s31, 896
    s_add_i32 s31, s30, 40
    s_max_i32 s31, s31, 0
    s_min_i32 s31, s31, 2040
    s_mul_i32 s49, s31, 896
    s_mul_i32 s32, s27, 56
    s_mul_i32 s30, s3, 3
    s_lshr_b32 s31, s30, 2
    s_mul_i32 s31, s31, 896
    s_add_u32 s50, s31, s32
    s_and_b32 s31, s30, 3
    s_mul_i32 s31, s31, 43008
    s_add_u32 s50, s50, s31
    s_add_u32 s30, s30, 1

    s_lshr_b32 s31, s30, 2
    s_mul_i32 s31, s31, 896
    s_add_u32 s51, s31, s32
    s_and_b32 s31, s30, 3
    s_mul_i32 s31, s31, 43008
    s_add_u32 s51, s51, s31
    s_add_u32 s30, s30, 1

    s_lshr_b32 s31, s30, 2
    s_mul_i32 s31, s31, 896
    s_add_u32 s52, s31, s32
    s_and_b32 s31, s30, 3
    s_mul_i32 s31, s31, 43008
    s_add_u32 s52, s52, s31
    s_add_u32 s30, s30, 1

    s_mul_i32 s53, s3, 18432
    s_add_u32 s53, s53, 86016
    s_mul_i32 s54, s3, 3072
    s_waitcnt lgkmcnt(0)
    s_mov_b32 s12, s4
    s_mov_b32 s13, s5
    s_mov_b32 s14, 1835008
    s_mov_b32 s15, 0x00020000
    s_mov_b32 s16, s6
    s_mov_b32 s17, s7
    s_mov_b32 s18, 1204224
    s_mov_b32 s19, 0x00020000
    s_mov_b32 s20, s10
    s_mov_b32 s21, s11
    s_mov_b32 s22, 268435456
    s_mov_b32 s23, 0x00020000
    s_lshl_b32 s30, s28, 7
    s_mul_i32 s32, s28, 172032
    s_add_u32 m0, s53, 0
    s_add_u32 s31, s30, s44
    buffer_load_dwordx4 v9, s[12:15], s31 offen lds
    s_add_u32 m0, s53, 1024
    s_add_u32 s31, s30, s45
    buffer_load_dwordx4 v10, s[12:15], s31 offen lds
    s_add_u32 m0, s53, 2048
    s_add_u32 s31, s30, s46
    buffer_load_dwordx4 v9, s[12:15], s31 offen lds
    s_add_u32 m0, s53, 3072
    s_add_u32 s31, s30, s47
    buffer_load_dwordx4 v10, s[12:15], s31 offen lds
    s_add_u32 m0, s53, 4096
    s_add_u32 s31, s30, s48
    buffer_load_dwordx4 v9, s[12:15], s31 offen lds
    s_add_u32 m0, s53, 5120
    s_add_u32 s31, s30, s49
    buffer_load_dwordx4 v10, s[12:15], s31 offen lds
    s_add_u32 m0, s54, 0
    s_add_u32 s31, s32, s50
    buffer_load_dwordx4 v11, s[16:19], s31 offen lds
    s_add_u32 m0, s54, 1024
    s_add_u32 s31, s32, s51
    buffer_load_dwordx4 v11, s[16:19], s31 offen lds
    s_add_u32 m0, s54, 2048
    s_add_u32 s31, s32, s52
    buffer_load_dwordx4 v11, s[16:19], s31 offen lds
    s_add_u32 s28, s28, 1
    s_cmp_eq_u32 s28, 7
    s_cselect_b32 s28, 0, s28
    s_lshl_b32 s30, s28, 7
    s_mul_i32 s32, s28, 172032
    s_add_u32 m0, s53, 6144
    s_add_u32 s31, s30, s44
    buffer_load_dwordx4 v9, s[12:15], s31 offen lds
    s_add_u32 m0, s53, 7168
    s_add_u32 s31, s30, s45
    buffer_load_dwordx4 v10, s[12:15], s31 offen lds
    s_add_u32 m0, s53, 8192
    s_add_u32 s31, s30, s46
    buffer_load_dwordx4 v9, s[12:15], s31 offen lds
    s_add_u32 m0, s53, 9216
    s_add_u32 s31, s30, s47
    buffer_load_dwordx4 v10, s[12:15], s31 offen lds
    s_add_u32 m0, s53, 10240
    s_add_u32 s31, s30, s48
    buffer_load_dwordx4 v9, s[12:15], s31 offen lds
    s_add_u32 m0, s53, 11264
    s_add_u32 s31, s30, s49
    buffer_load_dwordx4 v10, s[12:15], s31 offen lds
    s_add_u32 m0, s54, 12288
    s_add_u32 s31, s32, s50
    buffer_load_dwordx4 v11, s[16:19], s31 offen lds
    s_add_u32 m0, s54, 13312
    s_add_u32 s31, s32, s51
    buffer_load_dwordx4 v11, s[16:19], s31 offen lds
    s_add_u32 m0, s54, 14336
    s_add_u32 s31, s32, s52
    buffer_load_dwordx4 v11, s[16:19], s31 offen lds
    s_add_u32 s28, s28, 1
    s_cmp_eq_u32 s28, 7
    s_cselect_b32 s28, 0, s28
    v_lshrrev_b32 v5, 4, v4
    v_and_b32 v6, 15, v4
    v_lshrrev_b32 v7, 1, v6
    v_xor_b32 v7, v7, v5
    v_lshlrev_b32 v7, 4, v7
    v_lshl_add_u32 v7, v6, 7, v7
    v_add_u32 v12, s53, v7
    v_xor_b32 v13, 64, v12
    v_lshrrev_b32 v7, 2, v6
    v_lshl_add_u32 v7, v5, 3, v7
    v_lshlrev_b32 v7, 6, v7
    v_and_b32 v8, 3, v4
    v_lshl_add_u32 v7, v8, 3, v7
    v_and_b32 v8, 1, v5
    v_lshl_add_u32 v14, v8, 5, v7
    v_xor_b32 v15, 32, v14
    v_add_u32 v16, 49152, v14
    v_add_u32 v17, 49152, v15
    v_and_b32 v7, 1, v6
    v_cmp_eq_u32 s[56:57], 1, v7
    v_lshl_add_u32 v7, v5, 2, v7
    v_cmp_le_u32 s[58:59], v7, v6
    v_add_u32 v7, 2, v7
    v_cmp_le_u32 s[60:61], v7, v6
    v_mov_b32 v7, 0xffff
    v_mov_b32 v8, 0xffff0000
    v_cndmask_b32 v7, v7, v8, s[56:57]
    v_cndmask_b32 v18, v7, 0, s[58:59]
    v_cndmask_b32 v19, v7, 0, s[60:61]
    v_cndmask_b32 v20, 0, v7, s[58:59]
    v_cndmask_b32 v21, 0, v7, s[60:61]
    v_cmp_gt_u32 vcc, 3, v5
    s_nop 1
    v_cndmask_b32 v22, 0, -1, vcc
    s_add_u32 s30, s26, s3
    s_cmp_eq_u32 s30, 0
    s_cselect_b64 s[62:63], -1, 0

    s_waitcnt vmcnt(9)
    s_barrier
    ds_read_b128 v[96:99], v12 offset:0
    ds_read_b128 v[100:103], v12 offset:2048
    ds_read_b128 v[104:107], v12 offset:4096
    ds_read_b64_tr_b16 v[120:121], v14 offset:0
    ds_read_b64_tr_b16 v[122:123], v14 offset:256
    ds_read_b64_tr_b16 v[124:125], v15 offset:0
    ds_read_b64_tr_b16 v[126:127], v15 offset:256
    ds_read_b64_tr_b16 v[128:129], v14 offset:4096
    ds_read_b64_tr_b16 v[130:131], v14 offset:4352
    ds_read_b64_tr_b16 v[132:133], v15 offset:4096
    ds_read_b64_tr_b16 v[134:135], v15 offset:4352
    ds_read_b64_tr_b16 v[136:137], v14 offset:8192
    ds_read_b64_tr_b16 v[138:139], v14 offset:8448
    ds_read_b64_tr_b16 v[140:141], v15 offset:8192
    ds_read_b64_tr_b16 v[142:143], v15 offset:8448
    s_waitcnt lgkmcnt(0)
    v_mfma_f32_16x16x32_bf16 v[24:27], v[120:123], v[96:99], 0
    ds_read_b128 v[108:111], v13 offset:0
    v_mfma_f32_16x16x32_bf16 v[32:35], v[120:123], v[100:103], 0
    ds_read_b128 v[112:115], v13 offset:2048
    v_mfma_f32_16x16x32_bf16 v[40:43], v[120:123], v[104:107], 0
    ds_read_b128 v[116:119], v13 offset:4096
    ds_read_b64_tr_b16 v[144:145], v14 offset:2048
    v_mfma_f32_16x16x32_bf16 v[28:31], v[124:127], v[96:99], 0
    ds_read_b64_tr_b16 v[146:147], v14 offset:2304
    v_mfma_f32_16x16x32_bf16 v[36:39], v[124:127], v[100:103], 0
    ds_read_b64_tr_b16 v[148:149], v15 offset:2048
    ds_read_b64_tr_b16 v[150:151], v15 offset:2304
    v_mfma_f32_16x16x32_bf16 v[44:47], v[124:127], v[104:107], 0
    ds_read_b64_tr_b16 v[152:153], v14 offset:6144
    v_mfma_f32_16x16x32_bf16 v[48:51], v[128:131], v[96:99], 0
    ds_read_b64_tr_b16 v[154:155], v14 offset:6400
    ds_read_b64_tr_b16 v[156:157], v15 offset:6144
    v_mfma_f32_16x16x32_bf16 v[56:59], v[128:131], v[100:103], 0
    ds_read_b64_tr_b16 v[158:159], v15 offset:6400
    v_mfma_f32_16x16x32_bf16 v[64:67], v[128:131], v[104:107], 0
    ds_read_b64_tr_b16 v[160:161], v14 offset:10240
    ds_read_b64_tr_b16 v[162:163], v14 offset:10496
    v_mfma_f32_16x16x32_bf16 v[52:55], v[132:135], v[96:99], 0
    ds_read_b64_tr_b16 v[164:165], v15 offset:10240
    v_mfma_f32_16x16x32_bf16 v[60:63], v[132:135], v[100:103], 0
    ds_read_b64_tr_b16 v[166:167], v15 offset:10496
    v_mfma_f32_16x16x32_bf16 v[68:71], v[132:135], v[104:107], 0
    s_lshl_b32 s30, s28, 7
    s_mul_i32 s32, s28, 172032
    s_add_u32 m0, s53, 12288
    s_add_u32 s31, s30, s44
    buffer_load_dwordx4 v9, s[12:15], s31 offen lds
    v_mfma_f32_16x16x32_bf16 v[72:75], v[96:99], v[136:139], 0
    s_add_u32 m0, s53, 13312
    s_add_u32 s31, s30, s45
    buffer_load_dwordx4 v10, s[12:15], s31 offen lds
    v_mfma_f32_16x16x32_bf16 v[80:83], v[100:103], v[136:139], 0
    s_add_u32 m0, s53, 14336
    s_add_u32 s31, s30, s46
    buffer_load_dwordx4 v9, s[12:15], s31 offen lds
    s_add_u32 m0, s53, 15360
    s_add_u32 s31, s30, s47
    buffer_load_dwordx4 v10, s[12:15], s31 offen lds
    v_mfma_f32_16x16x32_bf16 v[88:91], v[104:107], v[136:139], 0
    s_add_u32 m0, s53, 16384
    s_add_u32 s31, s30, s48
    buffer_load_dwordx4 v9, s[12:15], s31 offen lds
    v_mfma_f32_16x16x32_bf16 v[76:79], v[96:99], v[140:143], 0
    s_add_u32 m0, s53, 17408
    s_add_u32 s31, s30, s49
    buffer_load_dwordx4 v10, s[12:15], s31 offen lds
    s_add_u32 m0, s54, 24576
    s_add_u32 s31, s32, s50
    buffer_load_dwordx4 v11, s[16:19], s31 offen lds
    v_mfma_f32_16x16x32_bf16 v[84:87], v[100:103], v[140:143], 0
    s_add_u32 m0, s54, 25600
    s_add_u32 s31, s32, s51
    buffer_load_dwordx4 v11, s[16:19], s31 offen lds
    v_mfma_f32_16x16x32_bf16 v[92:95], v[104:107], v[140:143], 0
    s_add_u32 m0, s54, 26624
    s_add_u32 s31, s32, s52
    buffer_load_dwordx4 v11, s[16:19], s31 offen lds
    s_add_u32 s28, s28, 1
    s_cmp_eq_u32 s28, 7
    s_cselect_b32 s28, 0, s28
    s_waitcnt lgkmcnt(0)
    s_waitcnt vmcnt(9)
    s_barrier
    v_mfma_f32_16x16x32_bf16 v[24:27], v[144:147], v[108:111], v[24:27]
    v_mfma_f32_16x16x32_bf16 v[32:35], v[144:147], v[112:115], v[32:35]
    ds_read_b128 v[96:99], v12 offset:6144
    v_mfma_f32_16x16x32_bf16 v[40:43], v[144:147], v[116:119], v[40:43]
    ds_read_b128 v[100:103], v12 offset:8192
    v_mfma_f32_16x16x32_bf16 v[28:31], v[148:151], v[108:111], v[28:31]
    ds_read_b128 v[104:107], v12 offset:10240
    v_mfma_f32_16x16x32_bf16 v[36:39], v[148:151], v[112:115], v[36:39]
    ds_read_b64_tr_b16 v[120:121], v14 offset:12288
    v_mfma_f32_16x16x32_bf16 v[44:47], v[148:151], v[116:119], v[44:47]
    ds_read_b64_tr_b16 v[122:123], v14 offset:12544
    v_mfma_f32_16x16x32_bf16 v[48:51], v[152:155], v[108:111], v[48:51]
    v_mfma_f32_16x16x32_bf16 v[56:59], v[152:155], v[112:115], v[56:59]
    ds_read_b64_tr_b16 v[124:125], v15 offset:12288
    v_mfma_f32_16x16x32_bf16 v[64:67], v[152:155], v[116:119], v[64:67]
    ds_read_b64_tr_b16 v[126:127], v15 offset:12544
    v_mfma_f32_16x16x32_bf16 v[52:55], v[156:159], v[108:111], v[52:55]
    ds_read_b64_tr_b16 v[128:129], v14 offset:16384
    v_mfma_f32_16x16x32_bf16 v[60:63], v[156:159], v[112:115], v[60:63]
    ds_read_b64_tr_b16 v[130:131], v14 offset:16640
    v_mfma_f32_16x16x32_bf16 v[68:71], v[156:159], v[116:119], v[68:71]
    ds_read_b64_tr_b16 v[132:133], v15 offset:16384
    v_mfma_f32_16x16x32_bf16 v[72:75], v[108:111], v[160:163], v[72:75]
    v_mfma_f32_16x16x32_bf16 v[80:83], v[112:115], v[160:163], v[80:83]
    ds_read_b64_tr_b16 v[134:135], v15 offset:16640
    v_mfma_f32_16x16x32_bf16 v[88:91], v[116:119], v[160:163], v[88:91]
    ds_read_b64_tr_b16 v[136:137], v14 offset:20480
    v_mfma_f32_16x16x32_bf16 v[76:79], v[108:111], v[164:167], v[76:79]
    ds_read_b64_tr_b16 v[138:139], v14 offset:20736
    v_mfma_f32_16x16x32_bf16 v[84:87], v[112:115], v[164:167], v[84:87]
    ds_read_b64_tr_b16 v[140:141], v15 offset:20480
    v_mfma_f32_16x16x32_bf16 v[92:95], v[116:119], v[164:167], v[92:95]
    ds_read_b64_tr_b16 v[142:143], v15 offset:20736
    s_waitcnt lgkmcnt(0)
    v_mfma_f32_16x16x32_bf16 v[24:27], v[120:123], v[96:99], v[24:27]
    ds_read_b128 v[108:111], v13 offset:6144
    v_mfma_f32_16x16x32_bf16 v[32:35], v[120:123], v[100:103], v[32:35]
    ds_read_b128 v[112:115], v13 offset:8192
    v_mfma_f32_16x16x32_bf16 v[40:43], v[120:123], v[104:107], v[40:43]
    ds_read_b128 v[116:119], v13 offset:10240
    ds_read_b64_tr_b16 v[144:145], v14 offset:14336
    v_mfma_f32_16x16x32_bf16 v[28:31], v[124:127], v[96:99], v[28:31]
    ds_read_b64_tr_b16 v[146:147], v14 offset:14592
    v_mfma_f32_16x16x32_bf16 v[36:39], v[124:127], v[100:103], v[36:39]
    ds_read_b64_tr_b16 v[148:149], v15 offset:14336
    ds_read_b64_tr_b16 v[150:151], v15 offset:14592
    v_mfma_f32_16x16x32_bf16 v[44:47], v[124:127], v[104:107], v[44:47]
    ds_read_b64_tr_b16 v[152:153], v14 offset:18432
    v_mfma_f32_16x16x32_bf16 v[48:51], v[128:131], v[96:99], v[48:51]
    ds_read_b64_tr_b16 v[154:155], v14 offset:18688
    ds_read_b64_tr_b16 v[156:157], v15 offset:18432
    v_mfma_f32_16x16x32_bf16 v[56:59], v[128:131], v[100:103], v[56:59]
    ds_read_b64_tr_b16 v[158:159], v15 offset:18688
    v_mfma_f32_16x16x32_bf16 v[64:67], v[128:131], v[104:107], v[64:67]
    ds_read_b64_tr_b16 v[160:161], v14 offset:22528
    ds_read_b64_tr_b16 v[162:163], v14 offset:22784
    v_mfma_f32_16x16x32_bf16 v[52:55], v[132:135], v[96:99], v[52:55]
    ds_read_b64_tr_b16 v[164:165], v15 offset:22528
    v_mfma_f32_16x16x32_bf16 v[60:63], v[132:135], v[100:103], v[60:63]
    ds_read_b64_tr_b16 v[166:167], v15 offset:22784
    v_mfma_f32_16x16x32_bf16 v[68:71], v[132:135], v[104:107], v[68:71]
    s_lshl_b32 s30, s28, 7
    s_mul_i32 s32, s28, 172032
    s_add_u32 m0, s53, 0
    s_add_u32 s31, s30, s44
    buffer_load_dwordx4 v9, s[12:15], s31 offen lds
    v_mfma_f32_16x16x32_bf16 v[72:75], v[96:99], v[136:139], v[72:75]
    s_add_u32 m0, s53, 1024
    s_add_u32 s31, s30, s45
    buffer_load_dwordx4 v10, s[12:15], s31 offen lds
    v_mfma_f32_16x16x32_bf16 v[80:83], v[100:103], v[136:139], v[80:83]
    s_add_u32 m0, s53, 2048
    s_add_u32 s31, s30, s46
    buffer_load_dwordx4 v9, s[12:15], s31 offen lds
    s_add_u32 m0, s53, 3072
    s_add_u32 s31, s30, s47
    buffer_load_dwordx4 v10, s[12:15], s31 offen lds
    v_mfma_f32_16x16x32_bf16 v[88:91], v[104:107], v[136:139], v[88:91]
    s_add_u32 m0, s53, 4096
    s_add_u32 s31, s30, s48
    buffer_load_dwordx4 v9, s[12:15], s31 offen lds
    v_mfma_f32_16x16x32_bf16 v[76:79], v[96:99], v[140:143], v[76:79]
    s_add_u32 m0, s53, 5120
    s_add_u32 s31, s30, s49
    buffer_load_dwordx4 v10, s[12:15], s31 offen lds
    s_add_u32 m0, s54, 36864
    s_add_u32 s31, s32, s50
    buffer_load_dwordx4 v11, s[16:19], s31 offen lds
    v_mfma_f32_16x16x32_bf16 v[84:87], v[100:103], v[140:143], v[84:87]
    s_add_u32 m0, s54, 37888
    s_add_u32 s31, s32, s51
    buffer_load_dwordx4 v11, s[16:19], s31 offen lds
    v_mfma_f32_16x16x32_bf16 v[92:95], v[104:107], v[140:143], v[92:95]
    s_add_u32 m0, s54, 38912
    s_add_u32 s31, s32, s52
    buffer_load_dwordx4 v11, s[16:19], s31 offen lds
    s_add_u32 s28, s28, 1
    s_cmp_eq_u32 s28, 7
    s_cselect_b32 s28, 0, s28
    s_waitcnt lgkmcnt(0)
    s_waitcnt vmcnt(9)
    s_barrier
    v_mfma_f32_16x16x32_bf16 v[24:27], v[144:147], v[108:111], v[24:27]
    v_mfma_f32_16x16x32_bf16 v[32:35], v[144:147], v[112:115], v[32:35]
    ds_read_b128 v[96:99], v12 offset:12288
    v_mfma_f32_16x16x32_bf16 v[40:43], v[144:147], v[116:119], v[40:43]
    ds_read_b128 v[100:103], v12 offset:14336
    v_mfma_f32_16x16x32_bf16 v[28:31], v[148:151], v[108:111], v[28:31]
    ds_read_b128 v[104:107], v12 offset:16384
    v_mfma_f32_16x16x32_bf16 v[36:39], v[148:151], v[112:115], v[36:39]
    ds_read_b64_tr_b16 v[120:121], v14 offset:24576
    v_mfma_f32_16x16x32_bf16 v[44:47], v[148:151], v[116:119], v[44:47]
    ds_read_b64_tr_b16 v[122:123], v14 offset:24832
    v_mfma_f32_16x16x32_bf16 v[48:51], v[152:155], v[108:111], v[48:51]
    v_mfma_f32_16x16x32_bf16 v[56:59], v[152:155], v[112:115], v[56:59]
    ds_read_b64_tr_b16 v[124:125], v15 offset:24576
    v_mfma_f32_16x16x32_bf16 v[64:67], v[152:155], v[116:119], v[64:67]
    ds_read_b64_tr_b16 v[126:127], v15 offset:24832
    v_mfma_f32_16x16x32_bf16 v[52:55], v[156:159], v[108:111], v[52:55]
    ds_read_b64_tr_b16 v[128:129], v14 offset:28672
    v_mfma_f32_16x16x32_bf16 v[60:63], v[156:159], v[112:115], v[60:63]
    ds_read_b64_tr_b16 v[130:131], v14 offset:28928
    v_mfma_f32_16x16x32_bf16 v[68:71], v[156:159], v[116:119], v[68:71]
    ds_read_b64_tr_b16 v[132:133], v15 offset:28672
    v_mfma_f32_16x16x32_bf16 v[72:75], v[108:111], v[160:163], v[72:75]
    v_mfma_f32_16x16x32_bf16 v[80:83], v[112:115], v[160:163], v[80:83]
    ds_read_b64_tr_b16 v[134:135], v15 offset:28928
    v_mfma_f32_16x16x32_bf16 v[88:91], v[116:119], v[160:163], v[88:91]
    ds_read_b64_tr_b16 v[136:137], v14 offset:32768
    v_mfma_f32_16x16x32_bf16 v[76:79], v[108:111], v[164:167], v[76:79]
    ds_read_b64_tr_b16 v[138:139], v14 offset:33024
    v_mfma_f32_16x16x32_bf16 v[84:87], v[112:115], v[164:167], v[84:87]
    ds_read_b64_tr_b16 v[140:141], v15 offset:32768
    v_mfma_f32_16x16x32_bf16 v[92:95], v[116:119], v[164:167], v[92:95]
    ds_read_b64_tr_b16 v[142:143], v15 offset:33024
    s_waitcnt lgkmcnt(0)
    v_mfma_f32_16x16x32_bf16 v[24:27], v[120:123], v[96:99], v[24:27]
    ds_read_b128 v[108:111], v13 offset:12288
    v_mfma_f32_16x16x32_bf16 v[32:35], v[120:123], v[100:103], v[32:35]
    ds_read_b128 v[112:115], v13 offset:14336
    v_mfma_f32_16x16x32_bf16 v[40:43], v[120:123], v[104:107], v[40:43]
    ds_read_b128 v[116:119], v13 offset:16384
    ds_read_b64_tr_b16 v[144:145], v14 offset:26624
    v_mfma_f32_16x16x32_bf16 v[28:31], v[124:127], v[96:99], v[28:31]
    ds_read_b64_tr_b16 v[146:147], v14 offset:26880
    v_mfma_f32_16x16x32_bf16 v[36:39], v[124:127], v[100:103], v[36:39]
    ds_read_b64_tr_b16 v[148:149], v15 offset:26624
    ds_read_b64_tr_b16 v[150:151], v15 offset:26880
    v_mfma_f32_16x16x32_bf16 v[44:47], v[124:127], v[104:107], v[44:47]
    ds_read_b64_tr_b16 v[152:153], v14 offset:30720
    v_mfma_f32_16x16x32_bf16 v[48:51], v[128:131], v[96:99], v[48:51]
    ds_read_b64_tr_b16 v[154:155], v14 offset:30976
    ds_read_b64_tr_b16 v[156:157], v15 offset:30720
    v_mfma_f32_16x16x32_bf16 v[56:59], v[128:131], v[100:103], v[56:59]
    ds_read_b64_tr_b16 v[158:159], v15 offset:30976
    v_mfma_f32_16x16x32_bf16 v[64:67], v[128:131], v[104:107], v[64:67]
    ds_read_b64_tr_b16 v[160:161], v14 offset:34816
    ds_read_b64_tr_b16 v[162:163], v14 offset:35072
    v_mfma_f32_16x16x32_bf16 v[52:55], v[132:135], v[96:99], v[52:55]
    ds_read_b64_tr_b16 v[164:165], v15 offset:34816
    v_mfma_f32_16x16x32_bf16 v[60:63], v[132:135], v[100:103], v[60:63]
    ds_read_b64_tr_b16 v[166:167], v15 offset:35072
    v_mfma_f32_16x16x32_bf16 v[68:71], v[132:135], v[104:107], v[68:71]
    s_lshl_b32 s30, s28, 7
    s_mul_i32 s32, s28, 172032
    s_add_u32 m0, s53, 6144
    s_add_u32 s31, s30, s44
    buffer_load_dwordx4 v9, s[12:15], s31 offen lds
    v_mfma_f32_16x16x32_bf16 v[72:75], v[96:99], v[136:139], v[72:75]
    s_add_u32 m0, s53, 7168
    s_add_u32 s31, s30, s45
    buffer_load_dwordx4 v10, s[12:15], s31 offen lds
    v_mfma_f32_16x16x32_bf16 v[80:83], v[100:103], v[136:139], v[80:83]
    s_add_u32 m0, s53, 8192
    s_add_u32 s31, s30, s46
    buffer_load_dwordx4 v9, s[12:15], s31 offen lds
    s_add_u32 m0, s53, 9216
    s_add_u32 s31, s30, s47
    buffer_load_dwordx4 v10, s[12:15], s31 offen lds
    v_mfma_f32_16x16x32_bf16 v[88:91], v[104:107], v[136:139], v[88:91]
    s_add_u32 m0, s53, 10240
    s_add_u32 s31, s30, s48
    buffer_load_dwordx4 v9, s[12:15], s31 offen lds
    v_mfma_f32_16x16x32_bf16 v[76:79], v[96:99], v[140:143], v[76:79]
    s_add_u32 m0, s53, 11264
    s_add_u32 s31, s30, s49
    buffer_load_dwordx4 v10, s[12:15], s31 offen lds
    s_add_u32 m0, s54, 49152
    s_add_u32 s31, s32, s50
    buffer_load_dwordx4 v11, s[16:19], s31 offen lds
    v_mfma_f32_16x16x32_bf16 v[84:87], v[100:103], v[140:143], v[84:87]
    s_add_u32 m0, s54, 50176
    s_add_u32 s31, s32, s51
    buffer_load_dwordx4 v11, s[16:19], s31 offen lds
    v_mfma_f32_16x16x32_bf16 v[92:95], v[104:107], v[140:143], v[92:95]
    s_add_u32 m0, s54, 51200
    s_add_u32 s31, s32, s52
    buffer_load_dwordx4 v11, s[16:19], s31 offen lds
    s_add_u32 s28, s28, 1
    s_cmp_eq_u32 s28, 7
    s_cselect_b32 s28, 0, s28
    s_waitcnt lgkmcnt(0)
    s_waitcnt vmcnt(9)
    s_barrier
    v_mfma_f32_16x16x32_bf16 v[24:27], v[144:147], v[108:111], v[24:27]
    v_mfma_f32_16x16x32_bf16 v[32:35], v[144:147], v[112:115], v[32:35]
    ds_read_b128 v[96:99], v12 offset:0
    v_mfma_f32_16x16x32_bf16 v[40:43], v[144:147], v[116:119], v[40:43]
    ds_read_b128 v[100:103], v12 offset:2048
    v_mfma_f32_16x16x32_bf16 v[28:31], v[148:151], v[108:111], v[28:31]
    ds_read_b128 v[104:107], v12 offset:4096
    v_mfma_f32_16x16x32_bf16 v[36:39], v[148:151], v[112:115], v[36:39]
    ds_read_b64_tr_b16 v[120:121], v14 offset:36864
    v_mfma_f32_16x16x32_bf16 v[44:47], v[148:151], v[116:119], v[44:47]
    ds_read_b64_tr_b16 v[122:123], v14 offset:37120
    v_mfma_f32_16x16x32_bf16 v[48:51], v[152:155], v[108:111], v[48:51]
    v_mfma_f32_16x16x32_bf16 v[56:59], v[152:155], v[112:115], v[56:59]
    ds_read_b64_tr_b16 v[124:125], v15 offset:36864
    v_mfma_f32_16x16x32_bf16 v[64:67], v[152:155], v[116:119], v[64:67]
    ds_read_b64_tr_b16 v[126:127], v15 offset:37120
    v_mfma_f32_16x16x32_bf16 v[52:55], v[156:159], v[108:111], v[52:55]
    ds_read_b64_tr_b16 v[128:129], v14 offset:40960
    v_mfma_f32_16x16x32_bf16 v[60:63], v[156:159], v[112:115], v[60:63]
    ds_read_b64_tr_b16 v[130:131], v14 offset:41216
    v_mfma_f32_16x16x32_bf16 v[68:71], v[156:159], v[116:119], v[68:71]
    ds_read_b64_tr_b16 v[132:133], v15 offset:40960
    v_mfma_f32_16x16x32_bf16 v[72:75], v[108:111], v[160:163], v[72:75]
    v_mfma_f32_16x16x32_bf16 v[80:83], v[112:115], v[160:163], v[80:83]
    ds_read_b64_tr_b16 v[134:135], v15 offset:41216
    v_mfma_f32_16x16x32_bf16 v[88:91], v[116:119], v[160:163], v[88:91]
    ds_read_b64_tr_b16 v[136:137], v14 offset:45056
    v_mfma_f32_16x16x32_bf16 v[76:79], v[108:111], v[164:167], v[76:79]
    ds_read_b64_tr_b16 v[138:139], v14 offset:45312
    v_mfma_f32_16x16x32_bf16 v[84:87], v[112:115], v[164:167], v[84:87]
    ds_read_b64_tr_b16 v[140:141], v15 offset:45056
    v_mfma_f32_16x16x32_bf16 v[92:95], v[116:119], v[164:167], v[92:95]
    ds_read_b64_tr_b16 v[142:143], v15 offset:45312
    s_waitcnt lgkmcnt(0)
    v_mfma_f32_16x16x32_bf16 v[24:27], v[120:123], v[96:99], v[24:27]
    ds_read_b128 v[108:111], v13 offset:0
    v_mfma_f32_16x16x32_bf16 v[32:35], v[120:123], v[100:103], v[32:35]
    ds_read_b128 v[112:115], v13 offset:2048
    v_mfma_f32_16x16x32_bf16 v[40:43], v[120:123], v[104:107], v[40:43]
    ds_read_b128 v[116:119], v13 offset:4096
    ds_read_b64_tr_b16 v[144:145], v14 offset:38912
    v_mfma_f32_16x16x32_bf16 v[28:31], v[124:127], v[96:99], v[28:31]
    ds_read_b64_tr_b16 v[146:147], v14 offset:39168
    v_mfma_f32_16x16x32_bf16 v[36:39], v[124:127], v[100:103], v[36:39]
    ds_read_b64_tr_b16 v[148:149], v15 offset:38912
    ds_read_b64_tr_b16 v[150:151], v15 offset:39168
    v_mfma_f32_16x16x32_bf16 v[44:47], v[124:127], v[104:107], v[44:47]
    ds_read_b64_tr_b16 v[152:153], v14 offset:43008
    v_mfma_f32_16x16x32_bf16 v[48:51], v[128:131], v[96:99], v[48:51]
    ds_read_b64_tr_b16 v[154:155], v14 offset:43264
    ds_read_b64_tr_b16 v[156:157], v15 offset:43008
    v_mfma_f32_16x16x32_bf16 v[56:59], v[128:131], v[100:103], v[56:59]
    ds_read_b64_tr_b16 v[158:159], v15 offset:43264
    v_mfma_f32_16x16x32_bf16 v[64:67], v[128:131], v[104:107], v[64:67]
    ds_read_b64_tr_b16 v[160:161], v14 offset:47104
    ds_read_b64_tr_b16 v[162:163], v14 offset:47360
    v_mfma_f32_16x16x32_bf16 v[52:55], v[132:135], v[96:99], v[52:55]
    ds_read_b64_tr_b16 v[164:165], v15 offset:47104
    v_mfma_f32_16x16x32_bf16 v[60:63], v[132:135], v[100:103], v[60:63]
    ds_read_b64_tr_b16 v[166:167], v15 offset:47360
    v_mfma_f32_16x16x32_bf16 v[68:71], v[132:135], v[104:107], v[68:71]
    s_lshl_b32 s30, s28, 7
    s_mul_i32 s32, s28, 172032
    s_add_u32 m0, s53, 12288
    s_add_u32 s31, s30, s44
    buffer_load_dwordx4 v9, s[12:15], s31 offen lds
    v_mfma_f32_16x16x32_bf16 v[72:75], v[96:99], v[136:139], v[72:75]
    s_add_u32 m0, s53, 13312
    s_add_u32 s31, s30, s45
    buffer_load_dwordx4 v10, s[12:15], s31 offen lds
    v_mfma_f32_16x16x32_bf16 v[80:83], v[100:103], v[136:139], v[80:83]
    s_add_u32 m0, s53, 14336
    s_add_u32 s31, s30, s46
    buffer_load_dwordx4 v9, s[12:15], s31 offen lds
    s_add_u32 m0, s53, 15360
    s_add_u32 s31, s30, s47
    buffer_load_dwordx4 v10, s[12:15], s31 offen lds
    v_mfma_f32_16x16x32_bf16 v[88:91], v[104:107], v[136:139], v[88:91]
    s_add_u32 m0, s53, 16384
    s_add_u32 s31, s30, s48
    buffer_load_dwordx4 v9, s[12:15], s31 offen lds
    v_mfma_f32_16x16x32_bf16 v[76:79], v[96:99], v[140:143], v[76:79]
    s_add_u32 m0, s53, 17408
    s_add_u32 s31, s30, s49
    buffer_load_dwordx4 v10, s[12:15], s31 offen lds
    s_add_u32 m0, s54, 61440
    s_add_u32 s31, s32, s50
    buffer_load_dwordx4 v11, s[16:19], s31 offen lds
    v_mfma_f32_16x16x32_bf16 v[84:87], v[100:103], v[140:143], v[84:87]
    s_add_u32 m0, s54, 62464
    s_add_u32 s31, s32, s51
    buffer_load_dwordx4 v11, s[16:19], s31 offen lds
    v_mfma_f32_16x16x32_bf16 v[92:95], v[104:107], v[140:143], v[92:95]
    s_add_u32 m0, s54, 63488
    s_add_u32 s31, s32, s52
    buffer_load_dwordx4 v11, s[16:19], s31 offen lds
    s_add_u32 s28, s28, 1
    s_cmp_eq_u32 s28, 7
    s_cselect_b32 s28, 0, s28
    s_waitcnt lgkmcnt(0)
    s_waitcnt vmcnt(9)
    s_barrier
    v_mfma_f32_16x16x32_bf16 v[24:27], v[144:147], v[108:111], v[24:27]
    v_mfma_f32_16x16x32_bf16 v[32:35], v[144:147], v[112:115], v[32:35]
    ds_read_b128 v[96:99], v12 offset:6144
    v_mfma_f32_16x16x32_bf16 v[40:43], v[144:147], v[116:119], v[40:43]
    ds_read_b128 v[100:103], v12 offset:8192
    v_mfma_f32_16x16x32_bf16 v[28:31], v[148:151], v[108:111], v[28:31]
    ds_read_b128 v[104:107], v12 offset:10240
    v_mfma_f32_16x16x32_bf16 v[36:39], v[148:151], v[112:115], v[36:39]
    ds_read_b64_tr_b16 v[120:121], v16 offset:0
    v_mfma_f32_16x16x32_bf16 v[44:47], v[148:151], v[116:119], v[44:47]
    ds_read_b64_tr_b16 v[122:123], v16 offset:256
    v_mfma_f32_16x16x32_bf16 v[48:51], v[152:155], v[108:111], v[48:51]
    v_mfma_f32_16x16x32_bf16 v[56:59], v[152:155], v[112:115], v[56:59]
    ds_read_b64_tr_b16 v[124:125], v17 offset:0
    v_mfma_f32_16x16x32_bf16 v[64:67], v[152:155], v[116:119], v[64:67]
    ds_read_b64_tr_b16 v[126:127], v17 offset:256
    v_mfma_f32_16x16x32_bf16 v[52:55], v[156:159], v[108:111], v[52:55]
    ds_read_b64_tr_b16 v[128:129], v16 offset:4096
    v_mfma_f32_16x16x32_bf16 v[60:63], v[156:159], v[112:115], v[60:63]
    ds_read_b64_tr_b16 v[130:131], v16 offset:4352
    v_mfma_f32_16x16x32_bf16 v[68:71], v[156:159], v[116:119], v[68:71]
    ds_read_b64_tr_b16 v[132:133], v17 offset:4096
    v_mfma_f32_16x16x32_bf16 v[72:75], v[108:111], v[160:163], v[72:75]
    v_mfma_f32_16x16x32_bf16 v[80:83], v[112:115], v[160:163], v[80:83]
    ds_read_b64_tr_b16 v[134:135], v17 offset:4352
    v_mfma_f32_16x16x32_bf16 v[88:91], v[116:119], v[160:163], v[88:91]
    ds_read_b64_tr_b16 v[136:137], v16 offset:8192
    v_mfma_f32_16x16x32_bf16 v[76:79], v[108:111], v[164:167], v[76:79]
    ds_read_b64_tr_b16 v[138:139], v16 offset:8448
    v_mfma_f32_16x16x32_bf16 v[84:87], v[112:115], v[164:167], v[84:87]
    ds_read_b64_tr_b16 v[140:141], v17 offset:8192
    v_mfma_f32_16x16x32_bf16 v[92:95], v[116:119], v[164:167], v[92:95]
    ds_read_b64_tr_b16 v[142:143], v17 offset:8448
    s_waitcnt lgkmcnt(0)
    v_mfma_f32_16x16x32_bf16 v[24:27], v[120:123], v[96:99], v[24:27]
    ds_read_b128 v[108:111], v13 offset:6144
    v_mfma_f32_16x16x32_bf16 v[32:35], v[120:123], v[100:103], v[32:35]
    ds_read_b128 v[112:115], v13 offset:8192
    v_mfma_f32_16x16x32_bf16 v[40:43], v[120:123], v[104:107], v[40:43]
    ds_read_b128 v[116:119], v13 offset:10240
    ds_read_b64_tr_b16 v[144:145], v16 offset:2048
    v_mfma_f32_16x16x32_bf16 v[28:31], v[124:127], v[96:99], v[28:31]
    ds_read_b64_tr_b16 v[146:147], v16 offset:2304
    v_mfma_f32_16x16x32_bf16 v[36:39], v[124:127], v[100:103], v[36:39]
    ds_read_b64_tr_b16 v[148:149], v17 offset:2048
    ds_read_b64_tr_b16 v[150:151], v17 offset:2304
    v_mfma_f32_16x16x32_bf16 v[44:47], v[124:127], v[104:107], v[44:47]
    ds_read_b64_tr_b16 v[152:153], v16 offset:6144
    v_mfma_f32_16x16x32_bf16 v[48:51], v[128:131], v[96:99], v[48:51]
    ds_read_b64_tr_b16 v[154:155], v16 offset:6400
    ds_read_b64_tr_b16 v[156:157], v17 offset:6144
    v_mfma_f32_16x16x32_bf16 v[56:59], v[128:131], v[100:103], v[56:59]
    ds_read_b64_tr_b16 v[158:159], v17 offset:6400
    v_mfma_f32_16x16x32_bf16 v[64:67], v[128:131], v[104:107], v[64:67]
    ds_read_b64_tr_b16 v[160:161], v16 offset:10240
    ds_read_b64_tr_b16 v[162:163], v16 offset:10496
    v_mfma_f32_16x16x32_bf16 v[52:55], v[132:135], v[96:99], v[52:55]
    ds_read_b64_tr_b16 v[164:165], v17 offset:10240
    v_mfma_f32_16x16x32_bf16 v[60:63], v[132:135], v[100:103], v[60:63]
    ds_read_b64_tr_b16 v[166:167], v17 offset:10496
    v_mfma_f32_16x16x32_bf16 v[68:71], v[132:135], v[104:107], v[68:71]
    s_lshl_b32 s30, s28, 7
    s_mul_i32 s32, s28, 172032
    s_add_u32 m0, s53, 0
    s_add_u32 s31, s30, s44
    buffer_load_dwordx4 v9, s[12:15], s31 offen lds
    v_mfma_f32_16x16x32_bf16 v[72:75], v[96:99], v[136:139], v[72:75]
    s_add_u32 m0, s53, 1024
    s_add_u32 s31, s30, s45
    buffer_load_dwordx4 v10, s[12:15], s31 offen lds
    v_mfma_f32_16x16x32_bf16 v[80:83], v[100:103], v[136:139], v[80:83]
    s_add_u32 m0, s53, 2048
    s_add_u32 s31, s30, s46
    buffer_load_dwordx4 v9, s[12:15], s31 offen lds
    s_add_u32 m0, s53, 3072
    s_add_u32 s31, s30, s47
    buffer_load_dwordx4 v10, s[12:15], s31 offen lds
    v_mfma_f32_16x16x32_bf16 v[88:91], v[104:107], v[136:139], v[88:91]
    s_add_u32 m0, s53, 4096
    s_add_u32 s31, s30, s48
    buffer_load_dwordx4 v9, s[12:15], s31 offen lds
    v_mfma_f32_16x16x32_bf16 v[76:79], v[96:99], v[140:143], v[76:79]
    s_add_u32 m0, s53, 5120
    s_add_u32 s31, s30, s49
    buffer_load_dwordx4 v10, s[12:15], s31 offen lds
    s_add_u32 m0, s54, 73728
    s_add_u32 s31, s32, s50
    buffer_load_dwordx4 v11, s[16:19], s31 offen lds
    v_mfma_f32_16x16x32_bf16 v[84:87], v[100:103], v[140:143], v[84:87]
    s_add_u32 m0, s54, 74752
    s_add_u32 s31, s32, s51
    buffer_load_dwordx4 v11, s[16:19], s31 offen lds
    v_mfma_f32_16x16x32_bf16 v[92:95], v[104:107], v[140:143], v[92:95]
    s_add_u32 m0, s54, 75776
    s_add_u32 s31, s32, s52
    buffer_load_dwordx4 v11, s[16:19], s31 offen lds
    s_add_u32 s28, s28, 1
    s_cmp_eq_u32 s28, 7
    s_cselect_b32 s28, 0, s28
    s_waitcnt lgkmcnt(0)
    s_waitcnt vmcnt(9)
    s_barrier
    v_mfma_f32_16x16x32_bf16 v[24:27], v[144:147], v[108:111], v[24:27]
    v_mfma_f32_16x16x32_bf16 v[32:35], v[144:147], v[112:115], v[32:35]
    ds_read_b128 v[96:99], v12 offset:12288
    v_mfma_f32_16x16x32_bf16 v[40:43], v[144:147], v[116:119], v[40:43]
    ds_read_b128 v[100:103], v12 offset:14336
    v_mfma_f32_16x16x32_bf16 v[28:31], v[148:151], v[108:111], v[28:31]
    ds_read_b128 v[104:107], v12 offset:16384
    v_mfma_f32_16x16x32_bf16 v[36:39], v[148:151], v[112:115], v[36:39]
    ds_read_b64_tr_b16 v[120:121], v16 offset:12288
    v_mfma_f32_16x16x32_bf16 v[44:47], v[148:151], v[116:119], v[44:47]
    ds_read_b64_tr_b16 v[122:123], v16 offset:12544
    v_mfma_f32_16x16x32_bf16 v[48:51], v[152:155], v[108:111], v[48:51]
    v_mfma_f32_16x16x32_bf16 v[56:59], v[152:155], v[112:115], v[56:59]
    ds_read_b64_tr_b16 v[124:125], v17 offset:12288
    v_mfma_f32_16x16x32_bf16 v[64:67], v[152:155], v[116:119], v[64:67]
    ds_read_b64_tr_b16 v[126:127], v17 offset:12544
    v_mfma_f32_16x16x32_bf16 v[52:55], v[156:159], v[108:111], v[52:55]
    ds_read_b64_tr_b16 v[128:129], v16 offset:16384
    v_mfma_f32_16x16x32_bf16 v[60:63], v[156:159], v[112:115], v[60:63]
    ds_read_b64_tr_b16 v[130:131], v16 offset:16640
    v_mfma_f32_16x16x32_bf16 v[68:71], v[156:159], v[116:119], v[68:71]
    ds_read_b64_tr_b16 v[132:133], v17 offset:16384
    v_mfma_f32_16x16x32_bf16 v[72:75], v[108:111], v[160:163], v[72:75]
    v_mfma_f32_16x16x32_bf16 v[80:83], v[112:115], v[160:163], v[80:83]
    ds_read_b64_tr_b16 v[134:135], v17 offset:16640
    v_mfma_f32_16x16x32_bf16 v[88:91], v[116:119], v[160:163], v[88:91]
    ds_read_b64_tr_b16 v[136:137], v16 offset:20480
    v_mfma_f32_16x16x32_bf16 v[76:79], v[108:111], v[164:167], v[76:79]
    ds_read_b64_tr_b16 v[138:139], v16 offset:20736
    v_mfma_f32_16x16x32_bf16 v[84:87], v[112:115], v[164:167], v[84:87]
    ds_read_b64_tr_b16 v[140:141], v17 offset:20480
    v_mfma_f32_16x16x32_bf16 v[92:95], v[116:119], v[164:167], v[92:95]
    ds_read_b64_tr_b16 v[142:143], v17 offset:20736
    s_waitcnt lgkmcnt(0)
    v_mfma_f32_16x16x32_bf16 v[24:27], v[120:123], v[96:99], v[24:27]
    v_mfma_f32_16x16x32_bf16 v[32:35], v[120:123], v[100:103], v[32:35]
    ds_read_b128 v[108:111], v13 offset:12288
    v_mfma_f32_16x16x32_bf16 v[40:43], v[120:123], v[104:107], v[40:43]
    ds_read_b128 v[112:115], v13 offset:14336
    v_mfma_f32_16x16x32_bf16 v[28:31], v[124:127], v[96:99], v[28:31]
    ds_read_b128 v[116:119], v13 offset:16384
    v_mfma_f32_16x16x32_bf16 v[36:39], v[124:127], v[100:103], v[36:39]
    ds_read_b64_tr_b16 v[144:145], v16 offset:14336
    v_mfma_f32_16x16x32_bf16 v[44:47], v[124:127], v[104:107], v[44:47]
    ds_read_b64_tr_b16 v[146:147], v16 offset:14592
    v_mfma_f32_16x16x32_bf16 v[48:51], v[128:131], v[96:99], v[48:51]
    v_mfma_f32_16x16x32_bf16 v[56:59], v[128:131], v[100:103], v[56:59]
    ds_read_b64_tr_b16 v[148:149], v17 offset:14336
    v_mfma_f32_16x16x32_bf16 v[64:67], v[128:131], v[104:107], v[64:67]
    ds_read_b64_tr_b16 v[150:151], v17 offset:14592
    v_mfma_f32_16x16x32_bf16 v[52:55], v[132:135], v[96:99], v[52:55]
    ds_read_b64_tr_b16 v[152:153], v16 offset:18432
    v_mfma_f32_16x16x32_bf16 v[60:63], v[132:135], v[100:103], v[60:63]
    ds_read_b64_tr_b16 v[154:155], v16 offset:18688
    v_mfma_f32_16x16x32_bf16 v[68:71], v[132:135], v[104:107], v[68:71]
    ds_read_b64_tr_b16 v[156:157], v17 offset:18432
    v_mfma_f32_16x16x32_bf16 v[72:75], v[96:99], v[136:139], v[72:75]
    v_mfma_f32_16x16x32_bf16 v[80:83], v[100:103], v[136:139], v[80:83]
    ds_read_b64_tr_b16 v[158:159], v17 offset:18688
    v_mfma_f32_16x16x32_bf16 v[88:91], v[104:107], v[136:139], v[88:91]
    ds_read_b64_tr_b16 v[160:161], v16 offset:22528
    v_mfma_f32_16x16x32_bf16 v[76:79], v[96:99], v[140:143], v[76:79]
    ds_read_b64_tr_b16 v[162:163], v16 offset:22784
    v_mfma_f32_16x16x32_bf16 v[84:87], v[100:103], v[140:143], v[84:87]
    ds_read_b64_tr_b16 v[164:165], v17 offset:22528
    v_mfma_f32_16x16x32_bf16 v[92:95], v[104:107], v[140:143], v[92:95]
    ds_read_b64_tr_b16 v[166:167], v17 offset:22784
    s_waitcnt lgkmcnt(0)
    s_waitcnt vmcnt(0)
    s_barrier
    v_mfma_f32_16x16x32_bf16 v[24:27], v[144:147], v[108:111], v[24:27]
    v_mfma_f32_16x16x32_bf16 v[32:35], v[144:147], v[112:115], v[32:35]
    ds_read_b128 v[96:99], v12 offset:0
    v_mfma_f32_16x16x32_bf16 v[40:43], v[144:147], v[116:119], v[40:43]
    ds_read_b128 v[100:103], v12 offset:2048
    v_mfma_f32_16x16x32_bf16 v[28:31], v[148:151], v[108:111], v[28:31]
    ds_read_b128 v[104:107], v12 offset:4096
    v_mfma_f32_16x16x32_bf16 v[36:39], v[148:151], v[112:115], v[36:39]
    ds_read_b64_tr_b16 v[120:121], v16 offset:24576
    v_mfma_f32_16x16x32_bf16 v[44:47], v[148:151], v[116:119], v[44:47]
    ds_read_b64_tr_b16 v[122:123], v16 offset:24832
    v_mfma_f32_16x16x32_bf16 v[48:51], v[152:155], v[108:111], v[48:51]
    v_mfma_f32_16x16x32_bf16 v[56:59], v[152:155], v[112:115], v[56:59]
    ds_read_b64_tr_b16 v[124:125], v17 offset:24576
    v_mfma_f32_16x16x32_bf16 v[64:67], v[152:155], v[116:119], v[64:67]
    ds_read_b64_tr_b16 v[126:127], v17 offset:24832
    v_mfma_f32_16x16x32_bf16 v[52:55], v[156:159], v[108:111], v[52:55]
    ds_read_b64_tr_b16 v[128:129], v16 offset:28672
    v_mfma_f32_16x16x32_bf16 v[60:63], v[156:159], v[112:115], v[60:63]
    ds_read_b64_tr_b16 v[130:131], v16 offset:28928
    v_mfma_f32_16x16x32_bf16 v[68:71], v[156:159], v[116:119], v[68:71]
    ds_read_b64_tr_b16 v[132:133], v17 offset:28672
    v_mfma_f32_16x16x32_bf16 v[72:75], v[108:111], v[160:163], v[72:75]
    v_mfma_f32_16x16x32_bf16 v[80:83], v[112:115], v[160:163], v[80:83]
    ds_read_b64_tr_b16 v[134:135], v17 offset:28928
    v_mfma_f32_16x16x32_bf16 v[88:91], v[116:119], v[160:163], v[88:91]
    ds_read_b64_tr_b16 v[136:137], v16 offset:32768
    v_mfma_f32_16x16x32_bf16 v[76:79], v[108:111], v[164:167], v[76:79]
    ds_read_b64_tr_b16 v[138:139], v16 offset:33024
    v_mfma_f32_16x16x32_bf16 v[84:87], v[112:115], v[164:167], v[84:87]
    ds_read_b64_tr_b16 v[140:141], v17 offset:32768
    v_mfma_f32_16x16x32_bf16 v[92:95], v[116:119], v[164:167], v[92:95]
    ds_read_b64_tr_b16 v[142:143], v17 offset:33024
    s_waitcnt lgkmcnt(0)
    v_mfma_f32_16x16x32_bf16 v[24:27], v[120:123], v[96:99], v[24:27]
    v_mfma_f32_16x16x32_bf16 v[32:35], v[120:123], v[100:103], v[32:35]
    ds_read_b128 v[108:111], v13 offset:0
    v_mfma_f32_16x16x32_bf16 v[40:43], v[120:123], v[104:107], v[40:43]
    ds_read_b128 v[112:115], v13 offset:2048
    v_mfma_f32_16x16x32_bf16 v[28:31], v[124:127], v[96:99], v[28:31]
    ds_read_b128 v[116:119], v13 offset:4096
    v_mfma_f32_16x16x32_bf16 v[36:39], v[124:127], v[100:103], v[36:39]
    ds_read_b64_tr_b16 v[144:145], v16 offset:26624
    v_mfma_f32_16x16x32_bf16 v[44:47], v[124:127], v[104:107], v[44:47]
    ds_read_b64_tr_b16 v[146:147], v16 offset:26880
    v_mfma_f32_16x16x32_bf16 v[48:51], v[128:131], v[96:99], v[48:51]
    v_mfma_f32_16x16x32_bf16 v[56:59], v[128:131], v[100:103], v[56:59]
    ds_read_b64_tr_b16 v[148:149], v17 offset:26624
    v_mfma_f32_16x16x32_bf16 v[64:67], v[128:131], v[104:107], v[64:67]
    ds_read_b64_tr_b16 v[150:151], v17 offset:26880
    v_mfma_f32_16x16x32_bf16 v[52:55], v[132:135], v[96:99], v[52:55]
    ds_read_b64_tr_b16 v[152:153], v16 offset:30720
    v_mfma_f32_16x16x32_bf16 v[60:63], v[132:135], v[100:103], v[60:63]
    ds_read_b64_tr_b16 v[154:155], v16 offset:30976
    v_mfma_f32_16x16x32_bf16 v[68:71], v[132:135], v[104:107], v[68:71]
    ds_read_b64_tr_b16 v[156:157], v17 offset:30720
    v_mfma_f32_16x16x32_bf16 v[72:75], v[96:99], v[136:139], v[72:75]
    v_mfma_f32_16x16x32_bf16 v[80:83], v[100:103], v[136:139], v[80:83]
    ds_read_b64_tr_b16 v[158:159], v17 offset:30976
    v_mfma_f32_16x16x32_bf16 v[88:91], v[104:107], v[136:139], v[88:91]
    ds_read_b64_tr_b16 v[160:161], v16 offset:34816
    v_mfma_f32_16x16x32_bf16 v[76:79], v[96:99], v[140:143], v[76:79]
    ds_read_b64_tr_b16 v[162:163], v16 offset:35072
    v_mfma_f32_16x16x32_bf16 v[84:87], v[100:103], v[140:143], v[84:87]
    ds_read_b64_tr_b16 v[164:165], v17 offset:34816
    v_mfma_f32_16x16x32_bf16 v[92:95], v[104:107], v[140:143], v[92:95]
    ds_read_b64_tr_b16 v[166:167], v17 offset:35072
    s_waitcnt lgkmcnt(0)
    v_mfma_f32_16x16x32_bf16 v[24:27], v[144:147], v[108:111], v[24:27]
    v_mfma_f32_16x16x32_bf16 v[32:35], v[144:147], v[112:115], v[32:35]
    v_mfma_f32_16x16x32_bf16 v[40:43], v[144:147], v[116:119], v[40:43]
    v_mfma_f32_16x16x32_bf16 v[28:31], v[148:151], v[108:111], v[28:31]
    v_mfma_f32_16x16x32_bf16 v[36:39], v[148:151], v[112:115], v[36:39]
    v_mfma_f32_16x16x32_bf16 v[44:47], v[148:151], v[116:119], v[44:47]
    v_mfma_f32_16x16x32_bf16 v[48:51], v[152:155], v[108:111], v[48:51]
    v_mfma_f32_16x16x32_bf16 v[56:59], v[152:155], v[112:115], v[56:59]
    v_mfma_f32_16x16x32_bf16 v[64:67], v[152:155], v[116:119], v[64:67]
    v_mfma_f32_16x16x32_bf16 v[52:55], v[156:159], v[108:111], v[52:55]
    v_mfma_f32_16x16x32_bf16 v[60:63], v[156:159], v[112:115], v[60:63]
    v_mfma_f32_16x16x32_bf16 v[68:71], v[156:159], v[116:119], v[68:71]
    v_mfma_f32_16x16x32_bf16 v[72:75], v[108:111], v[160:163], v[72:75]
    v_mfma_f32_16x16x32_bf16 v[80:83], v[112:115], v[160:163], v[80:83]
    v_mfma_f32_16x16x32_bf16 v[88:91], v[116:119], v[160:163], v[88:91]
    v_mfma_f32_16x16x32_bf16 v[76:79], v[108:111], v[164:167], v[76:79]
    v_mfma_f32_16x16x32_bf16 v[84:87], v[112:115], v[164:167], v[84:87]
    v_mfma_f32_16x16x32_bf16 v[92:95], v[116:119], v[164:167], v[92:95]
    v_lshlrev_b32 v188, 4, v4
    v_add_u32 v7, s53, v188
    v_cvt_pk_bf16_f32 v116, v64, v65
    v_cvt_pk_bf16_f32 v117, v66, v67
    v_cvt_pk_bf16_f32 v118, v68, v69
    v_cvt_pk_bf16_f32 v119, v70, v71
    v_cvt_pk_bf16_f32 v178, v88, v89
    v_cvt_pk_bf16_f32 v179, v90, v91
    v_cvt_pk_bf16_f32 v186, v92, v93
    v_cvt_pk_bf16_f32 v187, v94, v95
    ds_write_b128 v7, v[116:119]
    ds_write_b64 v7, v[178:179] offset:1024
    ds_write_b64 v7, v[186:187] offset:1032

    v_cvt_pk_bf16_f32 v96, v24, v25
    v_cvt_pk_bf16_f32 v97, v26, v27
    v_cvt_pk_bf16_f32 v108, v48, v49
    v_cvt_pk_bf16_f32 v109, v50, v51
    v_cvt_pk_bf16_f32 v174, v72, v73
    v_cvt_pk_bf16_f32 v175, v74, v75
    v_cvt_pk_bf16_f32 v98, v28, v29
    v_cvt_pk_bf16_f32 v99, v30, v31
    v_cvt_pk_bf16_f32 v110, v52, v53
    v_cvt_pk_bf16_f32 v111, v54, v55
    v_cvt_pk_bf16_f32 v182, v76, v77
    v_cvt_pk_bf16_f32 v183, v78, v79
    v_and_b32 v98, v22, v98
    v_and_b32 v99, v22, v99
    v_cvt_pk_bf16_f32 v100, v32, v33
    v_cvt_pk_bf16_f32 v101, v34, v35
    v_cvt_pk_bf16_f32 v112, v56, v57
    v_cvt_pk_bf16_f32 v113, v58, v59
    v_cvt_pk_bf16_f32 v176, v80, v81
    v_cvt_pk_bf16_f32 v177, v82, v83
    v_cvt_pk_bf16_f32 v102, v36, v37
    v_cvt_pk_bf16_f32 v103, v38, v39
    v_cvt_pk_bf16_f32 v114, v60, v61
    v_cvt_pk_bf16_f32 v115, v62, v63
    v_cvt_pk_bf16_f32 v184, v84, v85
    v_cvt_pk_bf16_f32 v185, v86, v87
    v_and_b32 v102, v22, v102
    v_and_b32 v103, v22, v103
    v_cvt_pk_bf16_f32 v104, v40, v41
    v_cvt_pk_bf16_f32 v105, v42, v43
    v_cvt_pk_bf16_f32 v106, v44, v45
    v_cvt_pk_bf16_f32 v107, v46, v47
    v_and_b32 v106, v22, v106
    v_and_b32 v107, v22, v107
    s_sub_u32 s30, s53, 18432
    s_max_u32 s30, s30, 86016
    v_add_u32 v7, s30, v188
    s_waitcnt lgkmcnt(0)
    s_barrier
    ds_read_b128 v[168:171], v7
    ds_read_b64 v[172:173], v7 offset:1024
    ds_read_b64 v[180:181], v7 offset:1032

    v_mfma_f32_16x16x32_bf16 v[40:43], v[112:115], v[104:107], 0
    v_mfma_f32_16x16x32_bf16 v[44:47], v[116:119], v[104:107], 0
    v_mfma_f32_16x16x32_bf16 v[32:35], v[108:111], v[100:103], 0
    v_mfma_f32_16x16x32_bf16 v[36:39], v[112:115], v[100:103], 0
    v_mfma_f32_16x16x32_bf16 v[28:31], v[108:111], v[96:99], 0
    s_waitcnt lgkmcnt(0)
    v_mfma_f32_16x16x32_bf16 v[24:27], v[168:171], v[96:99], 0
    s_mov_b32 s32, 0x3e8b97f6
    v_mov_b32 v189, 0xf149f2ca
    v_cndmask_b32 v40, v40, v41, s[56:57]
    v_cndmask_b32 v42, v42, v43, s[56:57]
    v_cndmask_b32 v44, v44, v45, s[56:57]
    v_cndmask_b32 v46, v46, v47, s[56:57]

    v_cndmask_b32 v64, v40, v44, s[58:59]
    v_cndmask_b32 v65, v42, v46, s[60:61]
    v_max_f32 v66, v64, v65

    v_cndmask_b32 v32, v32, v33, s[56:57]
    v_cndmask_b32 v34, v34, v35, s[56:57]
    v_cndmask_b32 v36, v36, v37, s[56:57]
    v_cndmask_b32 v38, v38, v39, s[56:57]

    v_cndmask_b32 v32, v32, v189, s[62:63]
    v_cndmask_b32 v34, v34, v189, s[62:63]
    v_cndmask_b32 v56, v32, v36, s[58:59]
    v_cndmask_b32 v57, v34, v38, s[60:61]
    v_max_f32 v58, v56, v57

    v_cndmask_b32 v24, v24, v25, s[56:57]
    v_cndmask_b32 v26, v26, v27, s[56:57]
    v_cndmask_b32 v28, v28, v29, s[56:57]
    v_cndmask_b32 v30, v30, v31, s[56:57]

    v_cndmask_b32 v48, v24, v28, s[58:59]
    v_cndmask_b32 v49, v26, v30, s[60:61]
    v_max_f32 v50, v48, v49

    v_mov_b32 v67, v66
    v_mov_b32 v59, v58
    v_mov_b32 v51, v50
    v_permlane16_swap_b32 v66, v67
    v_permlane16_swap_b32 v58, v59
    v_permlane16_swap_b32 v50, v51
    v_max_f32 v66, v66, v67
    v_max_f32 v58, v58, v59
    v_max_f32 v50, v50, v51
    v_mov_b32 v67, v66
    v_mov_b32 v59, v58
    v_mov_b32 v51, v50
    v_permlane32_swap_b32 v66, v67
    v_permlane32_swap_b32 v58, v59
    v_permlane32_swap_b32 v50, v51
    v_max_f32 v66, v66, v67
    v_max_f32 v58, v58, v59
    v_max_f32 v50, v50, v51
    v_sub_f32 v64, v64, v66
    v_sub_f32 v65, v65, v66
    v_mul_f32 v64, s32, v64
    v_mul_f32 v65, s32, v65
    v_exp_f32 v64, v64
    v_exp_f32 v65, v65
    v_sub_f32 v56, v56, v58
    v_sub_f32 v57, v57, v58
    v_mul_f32 v56, s32, v56
    v_mul_f32 v57, s32, v57
    v_exp_f32 v56, v56
    v_exp_f32 v57, v57
    v_sub_f32 v48, v48, v50
    v_sub_f32 v49, v49, v50
    v_mul_f32 v48, s32, v48
    v_mul_f32 v49, s32, v49
    v_exp_f32 v48, v48
    v_exp_f32 v49, v49
    v_add_f32 v66, v64, v65
    v_add_f32 v58, v56, v57
    v_add_f32 v50, v48, v49
    v_mov_b32 v67, v66
    v_mov_b32 v59, v58
    v_mov_b32 v51, v50
    v_permlane16_swap_b32 v66, v67
    v_permlane16_swap_b32 v58, v59
    v_permlane16_swap_b32 v50, v51
    v_add_f32 v66, v66, v67
    v_add_f32 v58, v58, v59
    v_add_f32 v50, v50, v51
    v_mov_b32 v67, v66
    v_mov_b32 v59, v58
    v_mov_b32 v51, v50
    v_permlane32_swap_b32 v66, v67
    v_permlane32_swap_b32 v58, v59
    v_permlane32_swap_b32 v50, v51
    v_add_f32 v66, v66, v67
    v_add_f32 v58, v58, v59
    v_add_f32 v50, v50, v51
    v_rcp_f32 v66, v66
    v_rcp_f32 v58, v58
    v_rcp_f32 v50, v50
    v_mul_f32 v64, v64, v66
    v_mul_f32 v65, v65, v66
    v_cvt_pk_bf16_f32 v64, v64, v64
    v_cvt_pk_bf16_f32 v65, v65, v65
    v_and_b32 v68, v18, v64
    v_and_b32 v69, v19, v65
    v_and_b32 v70, v20, v64
    v_and_b32 v71, v21, v65

    v_mul_f32 v56, v56, v58
    v_mul_f32 v57, v57, v58
    v_cvt_pk_bf16_f32 v56, v56, v56
    v_cvt_pk_bf16_f32 v57, v57, v57
    v_and_b32 v60, v18, v56
    v_and_b32 v61, v19, v57
    v_and_b32 v62, v20, v56
    v_and_b32 v63, v21, v57

    v_mul_f32 v48, v48, v50
    v_mul_f32 v49, v49, v50
    v_cvt_pk_bf16_f32 v48, v48, v48
    v_cvt_pk_bf16_f32 v49, v49, v49
    v_and_b32 v52, v18, v48
    v_and_b32 v53, v19, v49
    v_and_b32 v54, v20, v48
    v_and_b32 v55, v21, v49

    v_mfma_f32_16x16x32_bf16 v[88:91], v[176:179], v[68:71], 0
    v_mfma_f32_16x16x32_bf16 v[92:95], v[184:187], v[68:71], 0
    v_mfma_f32_16x16x32_bf16 v[80:83], v[174:177], v[60:63], 0
    v_mfma_f32_16x16x32_bf16 v[84:87], v[182:185], v[60:63], 0
    v_mfma_f32_16x16x32_bf16 v[72:75], v[172:175], v[52:55], 0
    v_mfma_f32_16x16x32_bf16 v[76:79], v[180:183], v[52:55], 0
    s_mul_i32 s30, s26, 11
    s_mul_i32 s31, s3, 3
    s_add_u32 s30, s30, s31
    s_add_u32 s30, s30, 1
    s_lshl_b32 s30, s30, 4
    s_add_u32 s30, s30, s27
    s_lshl_b32 s30, s30, 10
    s_add_u32 s30, s30, 0

    v_cvt_pk_bf16_f32 v104, v88, v89
    v_cvt_pk_bf16_f32 v105, v90, v91
    v_cvt_pk_bf16_f32 v106, v92, v93
    v_cvt_pk_bf16_f32 v107, v94, v95
    v_and_b32 v106, v22, v106
    v_and_b32 v107, v22, v107
    buffer_store_dwordx4 v[104:107], v188, s[20:23], s30 offen
    s_nop 1
    s_sub_u32 s30, s30, 16384
    v_cvt_pk_bf16_f32 v100, v80, v81
    v_cvt_pk_bf16_f32 v101, v82, v83
    v_cvt_pk_bf16_f32 v102, v84, v85
    v_cvt_pk_bf16_f32 v103, v86, v87
    v_and_b32 v102, v22, v102
    v_and_b32 v103, v22, v103
    buffer_store_dwordx4 v[100:103], v188, s[20:23], s30 offen
    s_nop 1
    s_sub_u32 s30, s30, 16384
    v_cvt_pk_bf16_f32 v96, v72, v73
    v_cvt_pk_bf16_f32 v97, v74, v75
    v_cvt_pk_bf16_f32 v98, v76, v77
    v_cvt_pk_bf16_f32 v99, v78, v79
    v_and_b32 v98, v22, v98
    v_and_b32 v99, v22, v99
    s_cmp_eq_u32 s3, 0
    s_cbranch_scc1 K1_end
    buffer_store_dwordx4 v[96:99], v188, s[20:23], s30 offen
    s_nop 1
    s_sub_u32 s30, s30, 16384
    s_endpgm
K1_b1:
    s_lshl_b32 s30, s24, 3
    s_add_u32 s30, s30, s25
    s_sub_u32 s30, s30, 24
    s_lshr_b32 s26, s30, 1
    s_and_b32 s27, s30, 1
    s_lshl_b32 s31, s27, 3
    v_and_b32 v9, 7, v0
    v_add_u32 v9, s31, v9
    v_lshlrev_b32 v9, 4, v9

    v_lshrrev_b32 v7, 3, v0
    v_lshlrev_b32 v7, 5, v7
    v_add_u32 v7, s26, v7
    v_add_u32 v7, 0, v7
    v_sub_u32 v8, 2048, v7
    v_and_b32 v8, 2047, v8
    v_mul_u32_u24 v7, 896, v7
    v_mul_u32_u24 v8, 896, v8
    v_add_u32 v10, v7, v9
    v_sub_u32 v12, v7, v9
    v_add_u32 v12, 432, v12
    v_add_u32 v13, v8, v9
    v_sub_u32 v11, v8, v9
    v_add_u32 v11, 880, v11

    v_lshrrev_b32 v7, 3, v0
    v_lshlrev_b32 v7, 5, v7
    v_add_u32 v7, s26, v7
    v_add_u32 v7, 1024, v7
    v_sub_u32 v8, 2048, v7
    v_and_b32 v8, 2047, v8
    v_mul_u32_u24 v7, 896, v7
    v_mul_u32_u24 v8, 896, v8
    v_add_u32 v14, v7, v9
    v_sub_u32 v16, v7, v9
    v_add_u32 v16, 432, v16
    v_add_u32 v17, v8, v9
    v_sub_u32 v15, v8, v9
    v_add_u32 v15, 880, v15

    s_waitcnt lgkmcnt(0)
    s_mov_b32 s12, s8
    s_mov_b32 s13, s9
    s_mov_b32 s14, 1835008
    s_mov_b32 s15, 0x00020000
    s_mov_b32 s20, s10
    s_mov_b32 s21, s11
    s_mov_b32 s22, 268435456
    s_mov_b32 s23, 0x00020000
    buffer_load_dwordx4 v[18:21], v10, s[12:15], 0 offen
    buffer_load_dwordx4 v[26:29], v12, s[12:15], 0 offen
    buffer_load_dword v35, v12, s[12:15], 0 offen offset:16
    buffer_load_dwordx4 v[22:25], v11, s[12:15], 0 offen
    buffer_load_dword v34, v11, s[12:15], 0 offen offset:16
    buffer_load_dwordx4 v[30:33], v13, s[12:15], 0 offen offset:448

    buffer_load_dwordx4 v[36:39], v14, s[12:15], 0 offen
    buffer_load_dwordx4 v[44:47], v16, s[12:15], 0 offen
    buffer_load_dword v53, v16, s[12:15], 0 offen offset:16
    buffer_load_dwordx4 v[40:43], v15, s[12:15], 0 offen
    buffer_load_dword v52, v15, s[12:15], 0 offen offset:16
    buffer_load_dwordx4 v[48:51], v17, s[12:15], 0 offen offset:448

    v_and_b32 v4, 63, v0
    v_lshrrev_b32 v5, 4, v4
    v_and_b32 v6, 15, v4
    s_lshl_b32 s30, s3, 3
    v_lshrrev_b32 v7, 1, v6
    v_add_u32 v7, s30, v7
    v_and_b32 v8, 1, v6
    v_cvt_f32_u32 v63, v8
    v_mul_f32 v63, 0x3e800000, v63
    v_lshl_add_u32 v8, v7, 1, v8
    v_cmp_eq_u32 vcc, 1, v8
    s_nop 1
    v_cndmask_b32 v7, v7, 32, vcc
    v_cndmask_b32 v63, v63, 0, vcc
    v_cvt_f32_u32 v62, v7
    v_mul_f32 v62, 0x3c800000, v62
    v_lshlrev_b32 v7, 3, v5
    v_cvt_f32_u32 v7, v7
    v_fma_f32 v63, v62, v7, v63

    v_fmamk_f32 v64, v62, 0x0, v63
    v_fmamk_f32 v65, v62, 0x3f800000, v63
    v_fmamk_f32 v66, v62, 0x40000000, v63
    v_fmamk_f32 v67, v62, 0x40400000, v63
    v_fmamk_f32 v68, v62, 0x40800000, v63
    v_fmamk_f32 v69, v62, 0x40a00000, v63
    v_fmamk_f32 v70, v62, 0x40c00000, v63
    v_fmamk_f32 v71, v62, 0x40e00000, v63
    v_cos_f32 v64, v64
    v_cos_f32 v65, v65
    v_cos_f32 v66, v66
    v_cos_f32 v67, v67
    v_cos_f32 v68, v68
    v_cos_f32 v69, v69
    v_cos_f32 v70, v70
    v_cos_f32 v71, v71
    v_cvt_pk_bf16_f32 v54, v64, v65
    v_cvt_pk_bf16_f32 v55, v66, v67
    v_cvt_pk_bf16_f32 v56, v68, v69
    v_cvt_pk_bf16_f32 v57, v70, v71
    v_fmamk_f32 v64, v62, 0x42000000, v63
    v_fmamk_f32 v65, v62, 0x42040000, v63
    v_fmamk_f32 v66, v62, 0x42080000, v63
    v_fmamk_f32 v67, v62, 0x420c0000, v63
    v_fmamk_f32 v68, v62, 0x42100000, v63
    v_fmamk_f32 v69, v62, 0x42140000, v63
    v_fmamk_f32 v70, v62, 0x42180000, v63
    v_fmamk_f32 v71, v62, 0x421c0000, v63
    v_cos_f32 v64, v64
    v_cos_f32 v65, v65
    v_cos_f32 v66, v66
    v_cos_f32 v67, v67
    v_cos_f32 v68, v68
    v_cos_f32 v69, v69
    v_cos_f32 v70, v70
    v_cos_f32 v71, v71
    v_cvt_pk_bf16_f32 v58, v64, v65
    v_cvt_pk_bf16_f32 v59, v66, v67
    v_cvt_pk_bf16_f32 v60, v68, v69
    v_cvt_pk_bf16_f32 v61, v70, v71
    v_lshrrev_b32 v7, 3, v0
    v_and_b32 v8, 3, v7
    v_lshrrev_b32 v72, 1, v7
    v_and_b32 v72, 4, v72
    v_or_b32 v8, v8, v72
    v_and_b32 v72, 7, v0
    v_xor_b32 v8, v8, v72
    v_lshlrev_b32 v8, 5, v8
    v_lshl_add_u32 v72, v7, 8, v8
    v_lshrrev_b32 v7, 2, v6
    v_and_b32 v8, 1, v5
    v_lshl_or_b32 v8, v8, 2, v7
    v_lshl_add_u32 v7, v5, 3, v7
    v_lshlrev_b32 v7, 8, v7
    v_lshl_add_u32 v7, v8, 5, v7
    v_and_b32 v8, 3, v4
    v_lshl_add_u32 v73, v8, 3, v7
    v_cmp_eq_u32 vcc, 0, v9

    s_waitcnt vmcnt(6)
    s_nop 0
    v_cndmask_b32 v34, v34, v18, vcc
    v_lshlrev_b32 v74, 16, v18
    v_lshlrev_b32 v90, 16, v34
    v_add_f32 v74, v74, v90
    v_lshlrev_b32 v82, 16, v30
    v_lshlrev_b32 v90, 16, v35
    v_add_f32 v82, v82, v90
    v_and_b32 v75, 0xffff0000, v18
    v_and_b32 v90, 0xffff0000, v25
    v_add_f32 v75, v75, v90
    v_and_b32 v83, 0xffff0000, v30
    v_and_b32 v90, 0xffff0000, v29
    v_add_f32 v83, v83, v90
    v_lshlrev_b32 v76, 16, v19
    v_lshlrev_b32 v90, 16, v25
    v_add_f32 v76, v76, v90
    v_lshlrev_b32 v84, 16, v31
    v_lshlrev_b32 v90, 16, v29
    v_add_f32 v84, v84, v90
    v_and_b32 v77, 0xffff0000, v19
    v_and_b32 v90, 0xffff0000, v24
    v_add_f32 v77, v77, v90
    v_and_b32 v85, 0xffff0000, v31
    v_and_b32 v90, 0xffff0000, v28
    v_add_f32 v85, v85, v90
    v_lshlrev_b32 v78, 16, v20
    v_lshlrev_b32 v90, 16, v24
    v_add_f32 v78, v78, v90
    v_lshlrev_b32 v86, 16, v32
    v_lshlrev_b32 v90, 16, v28
    v_add_f32 v86, v86, v90
    v_and_b32 v79, 0xffff0000, v20
    v_and_b32 v90, 0xffff0000, v23
    v_add_f32 v79, v79, v90
    v_and_b32 v87, 0xffff0000, v32
    v_and_b32 v90, 0xffff0000, v27
    v_add_f32 v87, v87, v90
    v_lshlrev_b32 v80, 16, v21
    v_lshlrev_b32 v90, 16, v23
    v_add_f32 v80, v80, v90
    v_lshlrev_b32 v88, 16, v33
    v_lshlrev_b32 v90, 16, v27
    v_add_f32 v88, v88, v90
    v_and_b32 v81, 0xffff0000, v21
    v_and_b32 v90, 0xffff0000, v22
    v_add_f32 v81, v81, v90
    v_and_b32 v89, 0xffff0000, v33
    v_and_b32 v90, 0xffff0000, v26
    v_add_f32 v89, v89, v90
    v_add_f32 v64, v74, v82
    v_sub_f32 v74, v74, v82
    v_add_f32 v65, v75, v83
    v_sub_f32 v75, v75, v83
    v_add_f32 v66, v76, v84
    v_sub_f32 v76, v76, v84
    v_add_f32 v67, v77, v85
    v_sub_f32 v77, v77, v85
    v_add_f32 v68, v78, v86
    v_sub_f32 v78, v78, v86
    v_add_f32 v69, v79, v87
    v_sub_f32 v79, v79, v87
    v_add_f32 v70, v80, v88
    v_sub_f32 v80, v80, v88
    v_add_f32 v71, v81, v89
    v_sub_f32 v81, v81, v89
    v_cvt_pk_bf16_f32 v92, v64, v66
    v_cvt_pk_bf16_f32 v93, v68, v70
    v_cvt_pk_bf16_f32 v94, v65, v67
    v_cvt_pk_bf16_f32 v95, v69, v71
    v_cvt_pk_bf16_f32 v96, v74, v76
    v_cvt_pk_bf16_f32 v97, v78, v80
    v_cvt_pk_bf16_f32 v98, v75, v77
    v_cvt_pk_bf16_f32 v99, v79, v81
    ds_write_b128 v72, v[92:95] offset:0
    ds_write_b128 v72, v[96:99] offset:16
    s_waitcnt lgkmcnt(0)
    s_waitcnt vmcnt(0)
    v_cndmask_b32 v52, v52, v36, vcc
    v_lshlrev_b32 v74, 16, v36
    v_lshlrev_b32 v90, 16, v52
    v_add_f32 v74, v74, v90
    v_lshlrev_b32 v82, 16, v48
    v_lshlrev_b32 v90, 16, v53
    v_add_f32 v82, v82, v90
    v_and_b32 v75, 0xffff0000, v36
    v_and_b32 v90, 0xffff0000, v43
    v_add_f32 v75, v75, v90
    v_and_b32 v83, 0xffff0000, v48
    v_and_b32 v90, 0xffff0000, v47
    v_add_f32 v83, v83, v90
    v_lshlrev_b32 v76, 16, v37
    v_lshlrev_b32 v90, 16, v43
    v_add_f32 v76, v76, v90
    v_lshlrev_b32 v84, 16, v49
    v_lshlrev_b32 v90, 16, v47
    v_add_f32 v84, v84, v90
    v_and_b32 v77, 0xffff0000, v37
    v_and_b32 v90, 0xffff0000, v42
    v_add_f32 v77, v77, v90
    v_and_b32 v85, 0xffff0000, v49
    v_and_b32 v90, 0xffff0000, v46
    v_add_f32 v85, v85, v90
    v_lshlrev_b32 v78, 16, v38
    v_lshlrev_b32 v90, 16, v42
    v_add_f32 v78, v78, v90
    v_lshlrev_b32 v86, 16, v50
    v_lshlrev_b32 v90, 16, v46
    v_add_f32 v86, v86, v90
    v_and_b32 v79, 0xffff0000, v38
    v_and_b32 v90, 0xffff0000, v41
    v_add_f32 v79, v79, v90
    v_and_b32 v87, 0xffff0000, v50
    v_and_b32 v90, 0xffff0000, v45
    v_add_f32 v87, v87, v90
    v_lshlrev_b32 v80, 16, v39
    v_lshlrev_b32 v90, 16, v41
    v_add_f32 v80, v80, v90
    v_lshlrev_b32 v88, 16, v51
    v_lshlrev_b32 v90, 16, v45
    v_add_f32 v88, v88, v90
    v_and_b32 v81, 0xffff0000, v39
    v_and_b32 v90, 0xffff0000, v40
    v_add_f32 v81, v81, v90
    v_and_b32 v89, 0xffff0000, v51
    v_and_b32 v90, 0xffff0000, v44
    v_add_f32 v89, v89, v90
    v_add_f32 v64, v74, v82
    v_sub_f32 v74, v74, v82
    v_add_f32 v65, v75, v83
    v_sub_f32 v75, v75, v83
    v_add_f32 v66, v76, v84
    v_sub_f32 v76, v76, v84
    v_add_f32 v67, v77, v85
    v_sub_f32 v77, v77, v85
    v_add_f32 v68, v78, v86
    v_sub_f32 v78, v78, v86
    v_add_f32 v69, v79, v87
    v_sub_f32 v79, v79, v87
    v_add_f32 v70, v80, v88
    v_sub_f32 v80, v80, v88
    v_add_f32 v71, v81, v89
    v_sub_f32 v81, v81, v89
    v_cvt_pk_bf16_f32 v92, v64, v66
    v_cvt_pk_bf16_f32 v93, v68, v70
    v_cvt_pk_bf16_f32 v94, v65, v67
    v_cvt_pk_bf16_f32 v95, v69, v71
    v_cvt_pk_bf16_f32 v96, v74, v76
    v_cvt_pk_bf16_f32 v97, v78, v80
    v_cvt_pk_bf16_f32 v98, v75, v77
    v_cvt_pk_bf16_f32 v99, v79, v81
    ds_write_b128 v72, v[92:95] offset:8192
    ds_write_b128 v72, v[96:99] offset:8208
    s_waitcnt lgkmcnt(0)
    s_barrier
    v_xor_b32 v7, 0, v73
    ds_read_b64_tr_b16 v[100:101], v7 offset:0
    ds_read_b64_tr_b16 v[102:103], v7 offset:1024
    ds_read_b64_tr_b16 v[104:105], v7 offset:8192
    ds_read_b64_tr_b16 v[106:107], v7 offset:9216
    v_xor_b32 v7, 32, v73
    ds_read_b64_tr_b16 v[108:109], v7 offset:0
    ds_read_b64_tr_b16 v[110:111], v7 offset:1024
    ds_read_b64_tr_b16 v[112:113], v7 offset:8192
    ds_read_b64_tr_b16 v[114:115], v7 offset:9216
    v_xor_b32 v7, 64, v73
    ds_read_b64_tr_b16 v[116:117], v7 offset:0
    ds_read_b64_tr_b16 v[118:119], v7 offset:1024
    ds_read_b64_tr_b16 v[120:121], v7 offset:8192
    ds_read_b64_tr_b16 v[122:123], v7 offset:9216
    v_xor_b32 v7, 96, v73
    ds_read_b64_tr_b16 v[124:125], v7 offset:0
    ds_read_b64_tr_b16 v[126:127], v7 offset:1024
    ds_read_b64_tr_b16 v[128:129], v7 offset:8192
    ds_read_b64_tr_b16 v[130:131], v7 offset:9216
    v_xor_b32 v7, 128, v73
    ds_read_b64_tr_b16 v[132:133], v7 offset:0
    ds_read_b64_tr_b16 v[134:135], v7 offset:1024
    ds_read_b64_tr_b16 v[136:137], v7 offset:8192
    ds_read_b64_tr_b16 v[138:139], v7 offset:9216
    v_xor_b32 v7, 160, v73
    ds_read_b64_tr_b16 v[140:141], v7 offset:0
    ds_read_b64_tr_b16 v[142:143], v7 offset:1024
    ds_read_b64_tr_b16 v[144:145], v7 offset:8192
    ds_read_b64_tr_b16 v[146:147], v7 offset:9216
    v_xor_b32 v7, 192, v73
    ds_read_b64_tr_b16 v[148:149], v7 offset:0
    ds_read_b64_tr_b16 v[150:151], v7 offset:1024
    ds_read_b64_tr_b16 v[152:153], v7 offset:8192
    ds_read_b64_tr_b16 v[154:155], v7 offset:9216
    v_xor_b32 v7, 224, v73
    ds_read_b64_tr_b16 v[156:157], v7 offset:0
    ds_read_b64_tr_b16 v[158:159], v7 offset:1024
    ds_read_b64_tr_b16 v[160:161], v7 offset:8192
    ds_read_b64_tr_b16 v[162:163], v7 offset:9216
    v_lshrrev_b32 v7, 1, v6
    v_lshlrev_b32 v7, 15, v7
    v_lshl_add_u32 v7, v5, 5, v7
    v_and_b32 v8, 1, v6
    v_lshl_add_u32 v7, v8, 4, v7
    s_lshl_b32 s30, s3, 18
    s_lshl_b32 s31, s26, 10
    s_add_u32 s30, s30, s31
    s_lshl_b32 s31, s27, 9
    s_add_u32 s30, s30, s31
    s_add_u32 s30, s30, 4194304
    s_waitcnt lgkmcnt(0)

    v_mfma_f32_16x16x32_bf16 v[164:167], v[100:103], v[54:57], 0
    v_mfma_f32_16x16x32_bf16 v[168:171], v[108:111], v[54:57], 0
    v_mfma_f32_16x16x32_bf16 v[172:175], v[116:119], v[54:57], 0
    v_mfma_f32_16x16x32_bf16 v[176:179], v[124:127], v[54:57], 0
    v_mfma_f32_16x16x32_bf16 v[180:183], v[132:135], v[54:57], 0
    v_mfma_f32_16x16x32_bf16 v[184:187], v[140:143], v[54:57], 0
    v_mfma_f32_16x16x32_bf16 v[188:191], v[148:151], v[54:57], 0
    v_mfma_f32_16x16x32_bf16 v[192:195], v[156:159], v[54:57], 0
    v_mfma_f32_16x16x32_bf16 v[164:167], v[104:107], v[58:61], v[164:167]
    v_mfma_f32_16x16x32_bf16 v[168:171], v[112:115], v[58:61], v[168:171]
    v_mfma_f32_16x16x32_bf16 v[172:175], v[120:123], v[58:61], v[172:175]
    v_mfma_f32_16x16x32_bf16 v[176:179], v[128:131], v[58:61], v[176:179]
    v_mfma_f32_16x16x32_bf16 v[180:183], v[136:139], v[58:61], v[180:183]
    v_mfma_f32_16x16x32_bf16 v[184:187], v[144:147], v[58:61], v[184:187]
    v_mfma_f32_16x16x32_bf16 v[188:191], v[152:155], v[58:61], v[188:191]
    v_mfma_f32_16x16x32_bf16 v[192:195], v[160:163], v[58:61], v[192:195]
    s_nop 0
    v_cvt_pk_bf16_f32 v100, v164, v165
    v_cvt_pk_bf16_f32 v101, v166, v167
    v_cvt_pk_bf16_f32 v102, v168, v169
    v_cvt_pk_bf16_f32 v103, v170, v171
    buffer_store_dwordx4 v[100:103], v7, s[20:23], s30 offen offset:0
    v_cvt_pk_bf16_f32 v108, v172, v173
    v_cvt_pk_bf16_f32 v109, v174, v175
    v_cvt_pk_bf16_f32 v110, v176, v177
    v_cvt_pk_bf16_f32 v111, v178, v179
    buffer_store_dwordx4 v[108:111], v7, s[20:23], s30 offen offset:128
    v_cvt_pk_bf16_f32 v116, v180, v181
    v_cvt_pk_bf16_f32 v117, v182, v183
    v_cvt_pk_bf16_f32 v118, v184, v185
    v_cvt_pk_bf16_f32 v119, v186, v187
    buffer_store_dwordx4 v[116:119], v7, s[20:23], s30 offen offset:256
    v_cvt_pk_bf16_f32 v124, v188, v189
    v_cvt_pk_bf16_f32 v125, v190, v191
    v_cvt_pk_bf16_f32 v126, v192, v193
    v_cvt_pk_bf16_f32 v127, v194, v195
    buffer_store_dwordx4 v[124:127], v7, s[20:23], s30 offen offset:384
    s_endpgm
K1_end:
    s_endpgm
.globl k2_kernel
.p2align 8
.type k2_kernel,@function
k2_kernel:
    s_load_dwordx2 s[4:5], s[0:1], 16
    s_load_dwordx2 s[8:9], s[0:1], 64
    s_load_dwordx2 s[10:11], s[0:1], 80
    s_cmp_ge_u32 s2, 448
    s_cbranch_scc1 K2_end

    v_lshrrev_b32 v1, 6, v0
    s_nop 0
    v_readfirstlane_b32 s3, v1
    s_and_b32 s24, s2, 7
    s_lshr_b32 s25, s2, 3
    s_mul_i32 s28, s25, 37
    s_lshr_b32 s28, s28, 8
    s_mul_i32 s29, s28, 7
    s_sub_u32 s27, s25, s29
    s_and_b32 s29, s28, 3
    s_lshl_b32 s26, s24, 2
    s_add_u32 s26, s26, s29
    s_cmp_ge_u32 s25, 28
    s_cbranch_scc1 K2_b2

    v_and_b32 v2, 63, v0
    v_lshrrev_b32 v5, 3, v2
    v_mul_u32_u24 v7, 896, v5
    v_and_b32 v5, 6, v5
    v_and_b32 v6, 7, v2
    v_xor_b32 v5, v5, v6
    v_lshl_add_u32 v7, v5, 4, v7
    v_lshlrev_b32 v8, 4, v2
    s_lshl_b32 s30, s27, 7
    s_mul_i32 s31, s3, 7168
    s_add_u32 s30, s30, s31
    s_lshl_b32 s31, s3, 10
    s_mov_b32 m0, s31
    s_waitcnt lgkmcnt(0)

    s_mov_b32 s12, s4
    s_mov_b32 s13, s5
    s_mov_b32 s14, 401408
    s_mov_b32 s15, 0x00020000
    s_mov_b32 s16, s10
    s_mov_b32 s17, s11
    s_mov_b32 s18, 268435456
    s_mov_b32 s19, 0x00020000
    s_mov_b32 s20, s8
    s_mov_b32 s21, s9
    s_mov_b32 s22, 3670016
    s_mov_b32 s23, 0x00020000
    buffer_load_dwordx4 v7, s[12:15], s30 offen lds
    s_add_u32 s30, s30, 28672
    s_add_u32 m0, m0, 4096
    s_nop 0
    buffer_load_dwordx4 v7, s[12:15], s30 offen lds
    s_add_u32 s30, s30, 28672
    s_add_u32 m0, m0, 4096
    s_nop 0
    buffer_load_dwordx4 v7, s[12:15], s30 offen lds
    s_add_u32 s30, s30, 28672
    s_add_u32 m0, m0, 4096
    s_nop 0
    buffer_load_dwordx4 v7, s[12:15], s30 offen lds
    s_add_u32 s30, s30, 28672
    s_add_u32 m0, m0, 4096
    s_nop 0
    buffer_load_dwordx4 v7, s[12:15], s30 offen lds
    s_add_u32 s30, s30, 28672
    s_add_u32 m0, m0, 4096
    s_nop 0
    buffer_load_dwordx4 v7, s[12:15], s30 offen lds
    s_add_u32 s30, s30, 28672
    s_add_u32 m0, m0, 4096
    s_nop 0
    buffer_load_dwordx4 v7, s[12:15], s30 offen lds
    s_add_u32 s30, s30, 28672
    s_add_u32 m0, m0, 4096
    s_nop 0
    buffer_load_dwordx4 v7, s[12:15], s30 offen lds
    s_add_u32 s30, s30, 28672
    s_add_u32 m0, m0, 4096
    s_nop 0
    buffer_load_dwordx4 v7, s[12:15], s30 offen lds
    s_add_u32 s30, s30, 28672
    s_add_u32 m0, m0, 4096
    s_nop 0
    buffer_load_dwordx4 v7, s[12:15], s30 offen lds
    s_add_u32 s30, s30, 28672
    s_add_u32 m0, m0, 4096
    s_nop 0
    buffer_load_dwordx4 v7, s[12:15], s30 offen lds
    s_add_u32 s30, s30, 28672
    s_add_u32 m0, m0, 4096
    s_nop 0
    buffer_load_dwordx4 v7, s[12:15], s30 offen lds
    s_add_u32 s30, s30, 28672
    s_add_u32 m0, m0, 4096
    s_nop 0
    buffer_load_dwordx4 v7, s[12:15], s30 offen lds
    s_add_u32 s30, s30, 28672
    s_add_u32 m0, m0, 4096
    s_nop 0
    buffer_load_dwordx4 v7, s[12:15], s30 offen lds
    s_add_u32 s30, s30, 28672
    s_add_u32 m0, m0, 4096
    s_lshl_b32 s30, s26, 2
    s_add_u32 s30, s30, s3
    s_lshl_b32 s30, s30, 14
    s_add_u32 s30, s30, 0
    buffer_load_dwordx4 v[10:13], v8, s[16:19], s30 offen offset:0
    buffer_load_dwordx4 v[14:17], v8, s[16:19], s30 offen offset:1024
    buffer_load_dwordx4 v[18:21], v8, s[16:19], s30 offen offset:2048
    buffer_load_dwordx4 v[22:25], v8, s[16:19], s30 offen offset:3072
    s_add_u32 s30, s30, 4096
    buffer_load_dwordx4 v[26:29], v8, s[16:19], s30 offen offset:0
    buffer_load_dwordx4 v[30:33], v8, s[16:19], s30 offen offset:1024
    buffer_load_dwordx4 v[34:37], v8, s[16:19], s30 offen offset:2048
    buffer_load_dwordx4 v[38:41], v8, s[16:19], s30 offen offset:3072
    s_add_u32 s30, s30, 4096
    buffer_load_dwordx4 v[42:45], v8, s[16:19], s30 offen offset:0
    buffer_load_dwordx4 v[46:49], v8, s[16:19], s30 offen offset:1024
    buffer_load_dwordx4 v[50:53], v8, s[16:19], s30 offen offset:2048
    buffer_load_dwordx4 v[54:57], v8, s[16:19], s30 offen offset:3072
    s_add_u32 s30, s30, 4096
    buffer_load_dwordx4 v[58:61], v8, s[16:19], s30 offen offset:0
    buffer_load_dwordx4 v[62:65], v8, s[16:19], s30 offen offset:1024
    buffer_load_dwordx4 v[66:69], v8, s[16:19], s30 offen offset:2048
    buffer_load_dwordx4 v[70:73], v8, s[16:19], s30 offen offset:3072
    s_add_u32 s30, s30, 4096
    v_mov_b32 v74, 0
    v_mov_b32 v75, 0
    v_mov_b32 v76, 0
    v_mov_b32 v77, 0
    ds_write_b128 v8, v[74:77] offset:57344
    v_lshrrev_b32 v3, 4, v2
    v_and_b32 v4, 15, v2
    v_lshrrev_b32 v5, 2, v2
    v_lshrrev_b32 v6, 1, v5
    v_and_b32 v6, 3, v6
    v_lshlrev_b32 v6, 5, v6
    v_lshl_add_u32 v5, v5, 7, v6
    v_and_b32 v6, 3, v2
    v_lshl_add_u32 v78, v6, 3, v5
    v_xor_b32 v79, 32, v78
    v_xor_b32 v80, 64, v78
    v_xor_b32 v81, 96, v78
    s_lshl_b32 s31, s3, 11
    s_add_u32 s31, s31, 58368
    v_lshrrev_b32 v5, 1, v3
    v_and_b32 v6, 7, v4
    v_xor_b32 v5, v5, v6
    v_lshlrev_b32 v5, 4, v5
    v_lshl_add_u32 v5, v4, 7, v5
    v_and_b32 v6, 1, v3
    v_lshl_add_u32 v5, v6, 3, v5
    v_add_u32 v82, s31, v5
    v_lshrrev_b32 v5, 3, v2
    v_and_b32 v6, 7, v2
    v_mul_u32_u24 v84, 1792, v5
    v_lshl_add_u32 v84, v6, 4, v84
    v_xor_b32 v6, v6, v5
    v_lshlrev_b32 v6, 4, v6
    v_lshl_add_u32 v5, v5, 7, v6
    v_add_u32 v83, s31, v5
    s_waitcnt vmcnt(16) lgkmcnt(0)
    s_barrier

    ds_read_b64_tr_b16 v[86:87], v78 offset:0
    ds_read_b64_tr_b16 v[88:89], v78 offset:2048
    ds_read_b64_tr_b16 v[90:91], v79 offset:0
    ds_read_b64_tr_b16 v[92:93], v79 offset:2048
    ds_read_b64_tr_b16 v[94:95], v80 offset:0
    ds_read_b64_tr_b16 v[96:97], v80 offset:2048
    ds_read_b64_tr_b16 v[98:99], v81 offset:0
    ds_read_b64_tr_b16 v[100:101], v81 offset:2048
    s_waitcnt vmcnt(15) lgkmcnt(0)
    v_mfma_f32_16x16x32_bf16 v[118:121], v[86:89], v[10:13], 0
    ds_read_b64_tr_b16 v[102:103], v80 offset:3584
    ds_read_b64_tr_b16 v[104:105], v80 offset:5632
    v_mfma_f32_16x16x32_bf16 v[122:125], v[90:93], v[10:13], 0
    ds_read_b64_tr_b16 v[106:107], v81 offset:3584
    ds_read_b64_tr_b16 v[108:109], v81 offset:5632
    v_mfma_f32_16x16x32_bf16 v[126:129], v[94:97], v[10:13], 0
    ds_read_b64_tr_b16 v[110:111], v78 offset:3584
    ds_read_b64_tr_b16 v[112:113], v78 offset:5632
    v_mfma_f32_16x16x32_bf16 v[130:133], v[98:101], v[10:13], 0
    ds_read_b64_tr_b16 v[114:115], v79 offset:3584
    ds_read_b64_tr_b16 v[116:117], v79 offset:5632
    s_waitcnt vmcnt(14) lgkmcnt(0)
    v_mfma_f32_16x16x32_bf16 v[118:121], v[102:105], v[14:17], v[118:121]
    ds_read_b64_tr_b16 v[86:87], v78 offset:7168
    ds_read_b64_tr_b16 v[88:89], v78 offset:9216
    v_mfma_f32_16x16x32_bf16 v[122:125], v[106:109], v[14:17], v[122:125]
    ds_read_b64_tr_b16 v[90:91], v79 offset:7168
    ds_read_b64_tr_b16 v[92:93], v79 offset:9216
    v_mfma_f32_16x16x32_bf16 v[126:129], v[110:113], v[14:17], v[126:129]
    ds_read_b64_tr_b16 v[94:95], v80 offset:7168
    ds_read_b64_tr_b16 v[96:97], v80 offset:9216
    v_mfma_f32_16x16x32_bf16 v[130:133], v[114:117], v[14:17], v[130:133]
    ds_read_b64_tr_b16 v[98:99], v81 offset:7168
    ds_read_b64_tr_b16 v[100:101], v81 offset:9216
    s_waitcnt vmcnt(13) lgkmcnt(0)
    v_mfma_f32_16x16x32_bf16 v[118:121], v[86:89], v[18:21], v[118:121]
    ds_read_b64_tr_b16 v[102:103], v80 offset:10752
    ds_read_b64_tr_b16 v[104:105], v80 offset:12800
    v_mfma_f32_16x16x32_bf16 v[122:125], v[90:93], v[18:21], v[122:125]
    ds_read_b64_tr_b16 v[106:107], v81 offset:10752
    ds_read_b64_tr_b16 v[108:109], v81 offset:12800
    v_mfma_f32_16x16x32_bf16 v[126:129], v[94:97], v[18:21], v[126:129]
    ds_read_b64_tr_b16 v[110:111], v78 offset:10752
    ds_read_b64_tr_b16 v[112:113], v78 offset:12800
    v_mfma_f32_16x16x32_bf16 v[130:133], v[98:101], v[18:21], v[130:133]
    ds_read_b64_tr_b16 v[114:115], v79 offset:10752
    ds_read_b64_tr_b16 v[116:117], v79 offset:12800
    s_waitcnt vmcnt(12) lgkmcnt(0)
    v_mfma_f32_16x16x32_bf16 v[118:121], v[102:105], v[22:25], v[118:121]
    ds_read_b64_tr_b16 v[86:87], v78 offset:14336
    ds_read_b64_tr_b16 v[88:89], v78 offset:16384
    v_mfma_f32_16x16x32_bf16 v[122:125], v[106:109], v[22:25], v[122:125]
    ds_read_b64_tr_b16 v[90:91], v79 offset:14336
    ds_read_b64_tr_b16 v[92:93], v79 offset:16384
    v_mfma_f32_16x16x32_bf16 v[126:129], v[110:113], v[22:25], v[126:129]
    ds_read_b64_tr_b16 v[94:95], v80 offset:14336
    ds_read_b64_tr_b16 v[96:97], v80 offset:16384
    v_mfma_f32_16x16x32_bf16 v[130:133], v[114:117], v[22:25], v[130:133]
    ds_read_b64_tr_b16 v[98:99], v81 offset:14336
    ds_read_b64_tr_b16 v[100:101], v81 offset:16384
    s_waitcnt vmcnt(11) lgkmcnt(0)
    v_mfma_f32_16x16x32_bf16 v[118:121], v[86:89], v[26:29], v[118:121]
    ds_read_b64_tr_b16 v[102:103], v80 offset:17920
    ds_read_b64_tr_b16 v[104:105], v80 offset:19968
    v_mfma_f32_16x16x32_bf16 v[122:125], v[90:93], v[26:29], v[122:125]
    ds_read_b64_tr_b16 v[106:107], v81 offset:17920
    ds_read_b64_tr_b16 v[108:109], v81 offset:19968
    v_mfma_f32_16x16x32_bf16 v[126:129], v[94:97], v[26:29], v[126:129]
    ds_read_b64_tr_b16 v[110:111], v78 offset:17920
    ds_read_b64_tr_b16 v[112:113], v78 offset:19968
    v_mfma_f32_16x16x32_bf16 v[130:133], v[98:101], v[26:29], v[130:133]
    ds_read_b64_tr_b16 v[114:115], v79 offset:17920
    ds_read_b64_tr_b16 v[116:117], v79 offset:19968
    s_waitcnt vmcnt(10) lgkmcnt(0)
    v_mfma_f32_16x16x32_bf16 v[118:121], v[102:105], v[30:33], v[118:121]
    ds_read_b64_tr_b16 v[86:87], v78 offset:21504
    ds_read_b64_tr_b16 v[88:89], v78 offset:23552
    v_mfma_f32_16x16x32_bf16 v[122:125], v[106:109], v[30:33], v[122:125]
    ds_read_b64_tr_b16 v[90:91], v79 offset:21504
    ds_read_b64_tr_b16 v[92:93], v79 offset:23552
    v_mfma_f32_16x16x32_bf16 v[126:129], v[110:113], v[30:33], v[126:129]
    ds_read_b64_tr_b16 v[94:95], v80 offset:21504
    ds_read_b64_tr_b16 v[96:97], v80 offset:23552
    v_mfma_f32_16x16x32_bf16 v[130:133], v[114:117], v[30:33], v[130:133]
    ds_read_b64_tr_b16 v[98:99], v81 offset:21504
    ds_read_b64_tr_b16 v[100:101], v81 offset:23552
    s_waitcnt vmcnt(9) lgkmcnt(0)
    v_mfma_f32_16x16x32_bf16 v[118:121], v[86:89], v[34:37], v[118:121]
    ds_read_b64_tr_b16 v[102:103], v80 offset:25088
    ds_read_b64_tr_b16 v[104:105], v80 offset:27136
    v_mfma_f32_16x16x32_bf16 v[122:125], v[90:93], v[34:37], v[122:125]
    ds_read_b64_tr_b16 v[106:107], v81 offset:25088
    ds_read_b64_tr_b16 v[108:109], v81 offset:27136
    v_mfma_f32_16x16x32_bf16 v[126:129], v[94:97], v[34:37], v[126:129]
    ds_read_b64_tr_b16 v[110:111], v78 offset:25088
    ds_read_b64_tr_b16 v[112:113], v78 offset:27136
    v_mfma_f32_16x16x32_bf16 v[130:133], v[98:101], v[34:37], v[130:133]
    ds_read_b64_tr_b16 v[114:115], v79 offset:25088
    ds_read_b64_tr_b16 v[116:117], v79 offset:27136
    s_waitcnt vmcnt(8) lgkmcnt(0)
    v_mfma_f32_16x16x32_bf16 v[118:121], v[102:105], v[38:41], v[118:121]
    ds_read_b64_tr_b16 v[86:87], v78 offset:28672
    ds_read_b64_tr_b16 v[88:89], v78 offset:30720
    v_mfma_f32_16x16x32_bf16 v[122:125], v[106:109], v[38:41], v[122:125]
    ds_read_b64_tr_b16 v[90:91], v79 offset:28672
    ds_read_b64_tr_b16 v[92:93], v79 offset:30720
    v_mfma_f32_16x16x32_bf16 v[126:129], v[110:113], v[38:41], v[126:129]
    ds_read_b64_tr_b16 v[94:95], v80 offset:28672
    ds_read_b64_tr_b16 v[96:97], v80 offset:30720
    v_mfma_f32_16x16x32_bf16 v[130:133], v[114:117], v[38:41], v[130:133]
    ds_read_b64_tr_b16 v[98:99], v81 offset:28672
    ds_read_b64_tr_b16 v[100:101], v81 offset:30720
    s_waitcnt vmcnt(7) lgkmcnt(0)
    v_mfma_f32_16x16x32_bf16 v[118:121], v[86:89], v[42:45], v[118:121]
    ds_read_b64_tr_b16 v[102:103], v80 offset:32256
    ds_read_b64_tr_b16 v[104:105], v80 offset:34304
    v_mfma_f32_16x16x32_bf16 v[122:125], v[90:93], v[42:45], v[122:125]
    ds_read_b64_tr_b16 v[106:107], v81 offset:32256
    ds_read_b64_tr_b16 v[108:109], v81 offset:34304
    v_mfma_f32_16x16x32_bf16 v[126:129], v[94:97], v[42:45], v[126:129]
    ds_read_b64_tr_b16 v[110:111], v78 offset:32256
    ds_read_b64_tr_b16 v[112:113], v78 offset:34304
    v_mfma_f32_16x16x32_bf16 v[130:133], v[98:101], v[42:45], v[130:133]
    ds_read_b64_tr_b16 v[114:115], v79 offset:32256
    ds_read_b64_tr_b16 v[116:117], v79 offset:34304
    s_waitcnt vmcnt(6) lgkmcnt(0)
    v_mfma_f32_16x16x32_bf16 v[118:121], v[102:105], v[46:49], v[118:121]
    ds_read_b64_tr_b16 v[86:87], v78 offset:35840
    ds_read_b64_tr_b16 v[88:89], v78 offset:37888
    v_mfma_f32_16x16x32_bf16 v[122:125], v[106:109], v[46:49], v[122:125]
    ds_read_b64_tr_b16 v[90:91], v79 offset:35840
    ds_read_b64_tr_b16 v[92:93], v79 offset:37888
    v_mfma_f32_16x16x32_bf16 v[126:129], v[110:113], v[46:49], v[126:129]
    ds_read_b64_tr_b16 v[94:95], v80 offset:35840
    ds_read_b64_tr_b16 v[96:97], v80 offset:37888
    v_mfma_f32_16x16x32_bf16 v[130:133], v[114:117], v[46:49], v[130:133]
    ds_read_b64_tr_b16 v[98:99], v81 offset:35840
    ds_read_b64_tr_b16 v[100:101], v81 offset:37888
    s_waitcnt vmcnt(5) lgkmcnt(0)
    v_mfma_f32_16x16x32_bf16 v[118:121], v[86:89], v[50:53], v[118:121]
    ds_read_b64_tr_b16 v[102:103], v80 offset:39424
    ds_read_b64_tr_b16 v[104:105], v80 offset:41472
    v_mfma_f32_16x16x32_bf16 v[122:125], v[90:93], v[50:53], v[122:125]
    ds_read_b64_tr_b16 v[106:107], v81 offset:39424
    ds_read_b64_tr_b16 v[108:109], v81 offset:41472
    v_mfma_f32_16x16x32_bf16 v[126:129], v[94:97], v[50:53], v[126:129]
    ds_read_b64_tr_b16 v[110:111], v78 offset:39424
    ds_read_b64_tr_b16 v[112:113], v78 offset:41472
    v_mfma_f32_16x16x32_bf16 v[130:133], v[98:101], v[50:53], v[130:133]
    ds_read_b64_tr_b16 v[114:115], v79 offset:39424
    ds_read_b64_tr_b16 v[116:117], v79 offset:41472
    s_waitcnt vmcnt(4) lgkmcnt(0)
    v_mfma_f32_16x16x32_bf16 v[118:121], v[102:105], v[54:57], v[118:121]
    ds_read_b64_tr_b16 v[86:87], v78 offset:43008
    ds_read_b64_tr_b16 v[88:89], v78 offset:45056
    v_mfma_f32_16x16x32_bf16 v[122:125], v[106:109], v[54:57], v[122:125]
    ds_read_b64_tr_b16 v[90:91], v79 offset:43008
    ds_read_b64_tr_b16 v[92:93], v79 offset:45056
    v_mfma_f32_16x16x32_bf16 v[126:129], v[110:113], v[54:57], v[126:129]
    ds_read_b64_tr_b16 v[94:95], v80 offset:43008
    ds_read_b64_tr_b16 v[96:97], v80 offset:45056
    v_mfma_f32_16x16x32_bf16 v[130:133], v[114:117], v[54:57], v[130:133]
    ds_read_b64_tr_b16 v[98:99], v81 offset:43008
    ds_read_b64_tr_b16 v[100:101], v81 offset:45056
    s_waitcnt vmcnt(3) lgkmcnt(0)
    v_mfma_f32_16x16x32_bf16 v[118:121], v[86:89], v[58:61], v[118:121]
    ds_read_b64_tr_b16 v[102:103], v80 offset:46592
    ds_read_b64_tr_b16 v[104:105], v80 offset:48640
    v_mfma_f32_16x16x32_bf16 v[122:125], v[90:93], v[58:61], v[122:125]
    ds_read_b64_tr_b16 v[106:107], v81 offset:46592
    ds_read_b64_tr_b16 v[108:109], v81 offset:48640
    v_mfma_f32_16x16x32_bf16 v[126:129], v[94:97], v[58:61], v[126:129]
    ds_read_b64_tr_b16 v[110:111], v78 offset:46592
    ds_read_b64_tr_b16 v[112:113], v78 offset:48640
    v_mfma_f32_16x16x32_bf16 v[130:133], v[98:101], v[58:61], v[130:133]
    ds_read_b64_tr_b16 v[114:115], v79 offset:46592
    ds_read_b64_tr_b16 v[116:117], v79 offset:48640
    s_waitcnt vmcnt(2) lgkmcnt(0)
    v_mfma_f32_16x16x32_bf16 v[118:121], v[102:105], v[62:65], v[118:121]
    ds_read_b64_tr_b16 v[86:87], v78 offset:50176
    ds_read_b64_tr_b16 v[88:89], v78 offset:52224
    v_mfma_f32_16x16x32_bf16 v[122:125], v[106:109], v[62:65], v[122:125]
    ds_read_b64_tr_b16 v[90:91], v79 offset:50176
    ds_read_b64_tr_b16 v[92:93], v79 offset:52224
    v_mfma_f32_16x16x32_bf16 v[126:129], v[110:113], v[62:65], v[126:129]
    ds_read_b64_tr_b16 v[94:95], v80 offset:50176
    ds_read_b64_tr_b16 v[96:97], v80 offset:52224
    v_mfma_f32_16x16x32_bf16 v[130:133], v[114:117], v[62:65], v[130:133]
    ds_read_b64_tr_b16 v[98:99], v81 offset:50176
    ds_read_b64_tr_b16 v[100:101], v81 offset:52224
    s_waitcnt vmcnt(1) lgkmcnt(0)
    v_mfma_f32_16x16x32_bf16 v[118:121], v[86:89], v[66:69], v[118:121]
    ds_read_b64_tr_b16 v[102:103], v80 offset:53760
    ds_read_b64_tr_b16 v[104:105], v80 offset:55808
    v_mfma_f32_16x16x32_bf16 v[122:125], v[90:93], v[66:69], v[122:125]
    ds_read_b64_tr_b16 v[106:107], v81 offset:53760
    ds_read_b64_tr_b16 v[108:109], v81 offset:55808
    v_mfma_f32_16x16x32_bf16 v[126:129], v[94:97], v[66:69], v[126:129]
    ds_read_b64_tr_b16 v[110:111], v78 offset:53760
    ds_read_b64_tr_b16 v[112:113], v78 offset:55808
    v_mfma_f32_16x16x32_bf16 v[130:133], v[98:101], v[66:69], v[130:133]
    ds_read_b64_tr_b16 v[114:115], v79 offset:53760
    ds_read_b64_tr_b16 v[116:117], v79 offset:55808
    s_waitcnt vmcnt(0) lgkmcnt(0)
    v_mfma_f32_16x16x32_bf16 v[118:121], v[102:105], v[70:73], v[118:121]
    v_mfma_f32_16x16x32_bf16 v[122:125], v[106:109], v[70:73], v[122:125]
    v_mfma_f32_16x16x32_bf16 v[126:129], v[110:113], v[70:73], v[126:129]
    v_mfma_f32_16x16x32_bf16 v[130:133], v[114:117], v[70:73], v[130:133]
    s_nop 4
    v_cvt_pk_bf16_f32 v134, v118, v119
    v_cvt_pk_bf16_f32 v135, v120, v121
    v_xor_b32 v5, 0, v82
    ds_write_b64 v5, v[134:135]
    v_cvt_pk_bf16_f32 v136, v122, v123
    v_cvt_pk_bf16_f32 v137, v124, v125
    v_xor_b32 v5, 32, v82
    ds_write_b64 v5, v[136:137]
    v_cvt_pk_bf16_f32 v138, v126, v127
    v_cvt_pk_bf16_f32 v139, v128, v129
    v_xor_b32 v5, 64, v82
    ds_write_b64 v5, v[138:139]
    v_cvt_pk_bf16_f32 v140, v130, v131
    v_cvt_pk_bf16_f32 v141, v132, v133
    v_xor_b32 v5, 96, v82
    ds_write_b64 v5, v[140:141]
    s_lshl_b32 s30, s26, 2
    s_add_u32 s30, s30, s3
    s_mul_i32 s30, s30, 28672
    s_lshl_b32 s31, s27, 7
    s_add_u32 s30, s30, s31
    s_add_u32 s31, s30, 14336
    s_waitcnt lgkmcnt(0)
    ds_read_b128 v[118:121], v83
    ds_read_b128 v[122:125], v83 offset:1024
    s_waitcnt lgkmcnt(1)
    buffer_store_dwordx4 v[118:121], v84, s[20:23], s30 offen
    s_waitcnt lgkmcnt(0)
    buffer_store_dwordx4 v[122:125], v84, s[20:23], s31 offen
    s_endpgm

K2_b2:
    v_and_b32 v2, 63, v0
    v_lshlrev_b32 v7, 4, v2
    s_lshl_b32 s30, s26, 15
    s_lshl_b32 s31, s3, 13
    s_add_u32 s30, s30, s31
    s_add_u32 s30, s30, 4194304
    s_waitcnt lgkmcnt(0)

    s_mov_b32 s16, s10
    s_mov_b32 s17, s11
    s_mov_b32 s18, 268435456
    s_mov_b32 s19, 0x00020000
    s_mov_b32 s20, s8
    s_mov_b32 s21, s9
    s_mov_b32 s22, 3670016
    s_mov_b32 s23, 0x00020000
    buffer_load_dwordx4 v[8:11], v7, s[16:19], s30 offen offset:0
    buffer_load_dwordx4 v[12:15], v7, s[16:19], s30 offen offset:1024
    buffer_load_dwordx4 v[16:19], v7, s[16:19], s30 offen offset:2048
    buffer_load_dwordx4 v[20:23], v7, s[16:19], s30 offen offset:3072
    s_add_u32 s30, s30, 4096
    buffer_load_dwordx4 v[24:27], v7, s[16:19], s30 offen offset:0
    buffer_load_dwordx4 v[28:31], v7, s[16:19], s30 offen offset:1024
    buffer_load_dwordx4 v[32:35], v7, s[16:19], s30 offen offset:2048
    buffer_load_dwordx4 v[36:39], v7, s[16:19], s30 offen offset:3072
    s_lshr_b32 s32, s3, 1
    s_and_b32 s33, s3, 1
    v_lshrrev_b32 v3, 4, v2
    v_and_b32 v4, 15, v2
    s_cmp_eq_u32 s33, 0
    s_cselect_b32 s30, 0.5, 1.0
    s_cselect_b32 s31, 0.5, 0
    v_mov_b32 v5, s30
    v_mov_b32 v6, s31
    v_cmp_eq_u32 vcc, 0, v3
    s_nop 1
    v_cndmask_b32 v66, 1.0, v5, vcc
    v_cmp_eq_u32 vcc, 3, v3
    s_nop 1
    v_cndmask_b32 v67, 1.0, v6, vcc
    v_cndmask_b32 v68, 1.0, 0, vcc
    v_cndmask_b32 v69, -1, 0, vcc

    s_lshl_b32 s30, s27, 5
    s_add_u32 s30, s30, s32
    v_lshl_add_u32 v5, v4, 1, s30
    v_cvt_f32_u32 v64, v5
    v_mul_f32 v64, 0x3b124925, v64
    v_lshl_add_u32 v5, v3, 4, s33
    v_cvt_f32_u32 v5, v5
    v_mul_f32 v65, v64, v5

    v_fmamk_f32 v56, v64, 0x0, v65
    v_fmamk_f32 v57, v64, 0x40000000, v65
    v_fmamk_f32 v58, v64, 0x40800000, v65
    v_fmamk_f32 v59, v64, 0x40c00000, v65
    v_fmamk_f32 v60, v64, 0x41000000, v65
    v_fmamk_f32 v61, v64, 0x41200000, v65
    v_fmamk_f32 v62, v64, 0x41400000, v65
    v_fmamk_f32 v63, v64, 0x41600000, v65
    v_cos_f32 v56, v56
    v_cos_f32 v57, v57
    v_cos_f32 v58, v58
    v_cos_f32 v59, v59
    v_cos_f32 v60, v60
    v_cos_f32 v61, v61
    v_cos_f32 v62, v62
    v_cos_f32 v63, v63
    v_mul_f32 v56, v56, v66
    v_cvt_pk_bf16_f32 v40, v56, v57
    v_cvt_pk_bf16_f32 v41, v58, v59
    v_cvt_pk_bf16_f32 v42, v60, v61
    v_cvt_pk_bf16_f32 v43, v62, v63
    v_fmamk_f32 v56, v64, 0x42800000, v65
    v_fmamk_f32 v57, v64, 0x42840000, v65
    v_fmamk_f32 v58, v64, 0x42880000, v65
    v_fmamk_f32 v59, v64, 0x428c0000, v65
    v_fmamk_f32 v60, v64, 0x42900000, v65
    v_fmamk_f32 v61, v64, 0x42940000, v65
    v_fmamk_f32 v62, v64, 0x42980000, v65
    v_fmamk_f32 v63, v64, 0x429c0000, v65
    v_cos_f32 v56, v56
    v_cos_f32 v57, v57
    v_cos_f32 v58, v58
    v_cos_f32 v59, v59
    v_cos_f32 v60, v60
    v_cos_f32 v61, v61
    v_cos_f32 v62, v62
    v_cos_f32 v63, v63
    v_mul_f32 v56, v56, v67
    v_mul_f32 v57, v57, v68
    v_cvt_pk_bf16_f32 v44, v56, v57
    v_cvt_pk_bf16_f32 v45, v58, v59
    v_cvt_pk_bf16_f32 v46, v60, v61
    v_cvt_pk_bf16_f32 v47, v62, v63
    v_and_b32 v45, v69, v45
    v_and_b32 v46, v69, v46
    v_and_b32 v47, v69, v47
    s_lshl_b32 s30, s27, 5
    s_add_u32 s30, s30, 1
    s_sub_u32 s30, s30, s32
    v_lshl_add_u32 v5, v4, 1, s30
    v_cvt_f32_u32 v64, v5
    v_mul_f32 v64, 0x3b124925, v64
    v_lshl_add_u32 v5, v3, 4, s33
    v_cvt_f32_u32 v5, v5
    v_mul_f32 v65, v64, v5

    v_fmamk_f32 v56, v64, 0x0, v65
    v_fmamk_f32 v57, v64, 0x40000000, v65
    v_fmamk_f32 v58, v64, 0x40800000, v65
    v_fmamk_f32 v59, v64, 0x40c00000, v65
    v_fmamk_f32 v60, v64, 0x41000000, v65
    v_fmamk_f32 v61, v64, 0x41200000, v65
    v_fmamk_f32 v62, v64, 0x41400000, v65
    v_fmamk_f32 v63, v64, 0x41600000, v65
    v_sin_f32 v56, v56
    v_sin_f32 v57, v57
    v_sin_f32 v58, v58
    v_sin_f32 v59, v59
    v_sin_f32 v60, v60
    v_sin_f32 v61, v61
    v_sin_f32 v62, v62
    v_sin_f32 v63, v63
    v_mul_f32 v56, v56, v66
    v_cvt_pk_bf16_f32 v48, v56, v57
    v_cvt_pk_bf16_f32 v49, v58, v59
    v_cvt_pk_bf16_f32 v50, v60, v61
    v_cvt_pk_bf16_f32 v51, v62, v63
    v_fmamk_f32 v56, v64, 0x42800000, v65
    v_fmamk_f32 v57, v64, 0x42840000, v65
    v_fmamk_f32 v58, v64, 0x42880000, v65
    v_fmamk_f32 v59, v64, 0x428c0000, v65
    v_fmamk_f32 v60, v64, 0x42900000, v65
    v_fmamk_f32 v61, v64, 0x42940000, v65
    v_fmamk_f32 v62, v64, 0x42980000, v65
    v_fmamk_f32 v63, v64, 0x429c0000, v65
    v_sin_f32 v56, v56
    v_sin_f32 v57, v57
    v_sin_f32 v58, v58
    v_sin_f32 v59, v59
    v_sin_f32 v60, v60
    v_sin_f32 v61, v61
    v_sin_f32 v62, v62
    v_sin_f32 v63, v63
    v_mul_f32 v56, v56, v67
    v_mul_f32 v57, v57, v68
    v_cvt_pk_bf16_f32 v52, v56, v57
    v_cvt_pk_bf16_f32 v53, v58, v59
    v_cvt_pk_bf16_f32 v54, v60, v61
    v_cvt_pk_bf16_f32 v55, v62, v63
    v_and_b32 v53, v69, v53
    v_and_b32 v54, v69, v54
    v_and_b32 v55, v69, v55
    v_and_b32 v5, 7, v2
    v_mul_u32_u24 v5, 4112, v5
    v_lshrrev_b32 v6, 3, v2
    v_lshl_add_u32 v5, v6, 8, v5
    s_lshl_b32 s30, s32, 11
    s_lshl_b32 s31, s33, 7
    s_add_u32 s30, s30, s31
    v_add_u32 v70, s30, v5

    s_waitcnt vmcnt(7)
    ds_write_b128 v70, v[8:11] offset:0
    s_waitcnt vmcnt(6)
    ds_write_b128 v70, v[12:15] offset:16
    s_waitcnt vmcnt(5)
    ds_write_b128 v70, v[16:19] offset:32
    s_waitcnt vmcnt(4)
    ds_write_b128 v70, v[20:23] offset:48
    s_waitcnt vmcnt(3)
    ds_write_b128 v70, v[24:27] offset:64
    s_waitcnt vmcnt(2)
    ds_write_b128 v70, v[28:31] offset:80
    s_waitcnt vmcnt(1)
    ds_write_b128 v70, v[32:35] offset:96
    s_waitcnt vmcnt(0)
    ds_write_b128 v70, v[36:39] offset:112
    s_add_u32 s34, s26, 1024
    s_cmp_eq_u32 s26, 0
    s_cselect_b32 s34, 32, s34
    v_lshl_add_u32 v5, v4, 6, s26
    v_cvt_f32_u32 v64, v5
    v_mul_f32 v64, 0x3a000000, v64
    v_lshlrev_b32 v5, 2, v3
    v_cvt_f32_u32 v5, v5
    v_mul_f32 v65, v64, v5

    v_fmamk_f32 v56, v64, 0x0, v65
    v_fmamk_f32 v57, v64, 0x3f800000, v65
    v_fmamk_f32 v58, v64, 0x40000000, v65
    v_fmamk_f32 v59, v64, 0x40400000, v65
    v_fmamk_f32 v60, v64, 0x41800000, v65
    v_fmamk_f32 v61, v64, 0x41880000, v65
    v_fmamk_f32 v62, v64, 0x41900000, v65
    v_fmamk_f32 v63, v64, 0x41980000, v65
    v_sin_f32 v108, v56
    v_cos_f32 v56, v56
    v_sin_f32 v109, v57
    v_cos_f32 v57, v57
    v_sin_f32 v110, v58
    v_cos_f32 v58, v58
    v_sin_f32 v111, v59
    v_cos_f32 v59, v59
    v_sin_f32 v112, v60
    v_cos_f32 v60, v60
    v_sin_f32 v113, v61
    v_cos_f32 v61, v61
    v_sin_f32 v114, v62
    v_cos_f32 v62, v62
    v_sin_f32 v115, v63
    v_cos_f32 v63, v63
    v_cvt_pk_bf16_f32 v72, v56, v57
    v_cvt_pk_bf16_f32 v80, v108, v109
    v_mov_b32 v96, v72
    v_xor_b32 v88, 0x80008000, v80

    v_cvt_pk_bf16_f32 v73, v58, v59
    v_cvt_pk_bf16_f32 v81, v110, v111
    v_mov_b32 v97, v73
    v_xor_b32 v89, 0x80008000, v81

    v_cvt_pk_bf16_f32 v74, v60, v61
    v_cvt_pk_bf16_f32 v82, v112, v113
    v_mov_b32 v98, v74
    v_xor_b32 v90, 0x80008000, v82

    v_cvt_pk_bf16_f32 v75, v62, v63
    v_cvt_pk_bf16_f32 v83, v114, v115
    v_mov_b32 v99, v75
    v_xor_b32 v91, 0x80008000, v83

    v_lshl_add_u32 v5, v4, 6, s34
    v_cvt_f32_u32 v64, v5
    v_mul_f32 v64, 0x3a000000, v64
    v_lshlrev_b32 v5, 2, v3
    v_cvt_f32_u32 v5, v5
    v_mul_f32 v65, v64, v5

    v_fmamk_f32 v56, v64, 0x0, v65
    v_fmamk_f32 v57, v64, 0x3f800000, v65
    v_fmamk_f32 v58, v64, 0x40000000, v65
    v_fmamk_f32 v59, v64, 0x40400000, v65
    v_fmamk_f32 v60, v64, 0x41800000, v65
    v_fmamk_f32 v61, v64, 0x41880000, v65
    v_fmamk_f32 v62, v64, 0x41900000, v65
    v_fmamk_f32 v63, v64, 0x41980000, v65
    v_sin_f32 v108, v56
    v_cos_f32 v56, v56
    v_sin_f32 v109, v57
    v_cos_f32 v57, v57
    v_sin_f32 v110, v58
    v_cos_f32 v58, v58
    v_sin_f32 v111, v59
    v_cos_f32 v59, v59
    v_sin_f32 v112, v60
    v_cos_f32 v60, v60
    v_sin_f32 v113, v61
    v_cos_f32 v61, v61
    v_sin_f32 v114, v62
    v_cos_f32 v62, v62
    v_sin_f32 v115, v63
    v_cos_f32 v63, v63
    v_cvt_pk_bf16_f32 v76, v56, v57
    v_cvt_pk_bf16_f32 v84, v108, v109
    v_mov_b32 v100, v76
    v_xor_b32 v92, 0x80008000, v84

    v_cvt_pk_bf16_f32 v77, v58, v59
    v_cvt_pk_bf16_f32 v85, v110, v111
    v_mov_b32 v101, v77
    v_xor_b32 v93, 0x80008000, v85

    v_cvt_pk_bf16_f32 v78, v60, v61
    v_cvt_pk_bf16_f32 v86, v112, v113
    v_mov_b32 v102, v78
    v_xor_b32 v94, 0x80008000, v86

    v_cvt_pk_bf16_f32 v79, v62, v63
    v_cvt_pk_bf16_f32 v87, v114, v115
    v_mov_b32 v103, v79
    v_xor_b32 v95, 0x80008000, v87

    v_lshrrev_b32 v5, 1, v4
    v_and_b32 v5, 3, v5
    v_xor_b32 v5, v5, v3
    v_lshl_add_u32 v5, v4, 2, v5
    v_lshlrev_b32 v5, 4, v5
    s_lshl_b32 s30, s3, 11
    v_add_u32 v116, s30, v5
    v_xor_b32 v117, 4096, v116

    v_mov_b32 v118, v117
    v_mov_b32 v104, 0
    v_mov_b32 v105, 0
    v_mov_b32 v106, 0
    v_mov_b32 v107, 0
    s_cmp_lg_u32 s26, 0
    s_cbranch_scc1 K2_reg
    v_cmp_eq_u32 vcc, 0, v4
    v_mov_b32 v5, 0x3f80
    v_mov_b32 v6, 0x3f800000
    v_cndmask_b32 v117, v117, v116, vcc
    v_cndmask_b32 v72, v72, v5, vcc
    v_cndmask_b32 v104, 0, v6, vcc
    v_mov_b32 v80, 0
    v_mov_b32 v96, 0
    v_mov_b32 v84, v76
    v_mov_b32 v76, 0
    v_mov_b32 v100, v92
    v_mov_b32 v92, 0

    v_cndmask_b32 v73, v73, v5, vcc
    v_cndmask_b32 v105, 0, v6, vcc
    v_mov_b32 v81, 0
    v_mov_b32 v97, 0
    v_mov_b32 v85, v77
    v_mov_b32 v77, 0
    v_mov_b32 v101, v93
    v_mov_b32 v93, 0

    v_cndmask_b32 v74, v74, v5, vcc
    v_cndmask_b32 v106, 0, v6, vcc
    v_mov_b32 v82, 0
    v_mov_b32 v98, 0
    v_mov_b32 v86, v78
    v_mov_b32 v78, 0
    v_mov_b32 v102, v94
    v_mov_b32 v94, 0

    v_cndmask_b32 v75, v75, v5, vcc
    v_cndmask_b32 v107, 0, v6, vcc
    v_mov_b32 v83, 0
    v_mov_b32 v99, 0
    v_mov_b32 v87, v79
    v_mov_b32 v79, 0
    v_mov_b32 v103, v95
    v_mov_b32 v95, 0

K2_reg:
    s_mul_i32 s30, s3, 8224
    v_add_u32 v5, s30, v7
    s_waitcnt lgkmcnt(0)
    s_barrier
    ds_read_b128 v[8:11], v5 offset:0
    ds_read_b128 v[12:15], v5 offset:1024
    ds_read_b128 v[16:19], v5 offset:2048
    ds_read_b128 v[20:23], v5 offset:3072
    ds_read_b128 v[24:27], v5 offset:4112
    ds_read_b128 v[28:31], v5 offset:5136
    ds_read_b128 v[32:35], v5 offset:6160
    ds_read_b128 v[36:39], v5 offset:7184
    s_waitcnt lgkmcnt(0)
    v_mfma_f32_16x16x32_bf16 v[120:123], v[8:11], v[40:43], 0
    v_mfma_f32_16x16x32_bf16 v[136:139], v[8:11], v[48:51], 0
    v_mfma_f32_16x16x32_bf16 v[124:127], v[16:19], v[40:43], 0
    v_mfma_f32_16x16x32_bf16 v[140:143], v[16:19], v[48:51], 0
    v_mfma_f32_16x16x32_bf16 v[128:131], v[24:27], v[40:43], 0
    v_mfma_f32_16x16x32_bf16 v[144:147], v[24:27], v[48:51], 0
    v_mfma_f32_16x16x32_bf16 v[132:135], v[32:35], v[40:43], 0
    v_mfma_f32_16x16x32_bf16 v[148:151], v[32:35], v[48:51], 0
    v_mfma_f32_16x16x32_bf16 v[120:123], v[12:15], v[44:47], v[120:123]
    v_mfma_f32_16x16x32_bf16 v[136:139], v[12:15], v[52:55], v[136:139]
    v_mfma_f32_16x16x32_bf16 v[124:127], v[20:23], v[44:47], v[124:127]
    v_mfma_f32_16x16x32_bf16 v[140:143], v[20:23], v[52:55], v[140:143]
    v_mfma_f32_16x16x32_bf16 v[128:131], v[28:31], v[44:47], v[128:131]
    v_mfma_f32_16x16x32_bf16 v[144:147], v[28:31], v[52:55], v[144:147]
    v_mfma_f32_16x16x32_bf16 v[132:135], v[36:39], v[44:47], v[132:135]
    v_mfma_f32_16x16x32_bf16 v[148:151], v[36:39], v[52:55], v[148:151]
    s_nop 0
    v_cvt_pk_bf16_f32 v152, v120, v121
    v_cvt_pk_bf16_f32 v153, v122, v123
    v_cvt_pk_bf16_f32 v154, v124, v125
    v_cvt_pk_bf16_f32 v155, v126, v127
    v_cvt_pk_bf16_f32 v160, v136, v137
    v_cvt_pk_bf16_f32 v161, v138, v139
    v_cvt_pk_bf16_f32 v162, v140, v141
    v_cvt_pk_bf16_f32 v163, v142, v143
    v_cvt_pk_bf16_f32 v156, v128, v129
    v_cvt_pk_bf16_f32 v157, v130, v131
    v_cvt_pk_bf16_f32 v158, v132, v133
    v_cvt_pk_bf16_f32 v159, v134, v135
    v_cvt_pk_bf16_f32 v164, v144, v145
    v_cvt_pk_bf16_f32 v165, v146, v147
    v_cvt_pk_bf16_f32 v166, v148, v149
    v_cvt_pk_bf16_f32 v167, v150, v151
    v_mfma_f32_16x16x32_bf16 v[8:11], v[152:155], v[72:75], 0
    v_mfma_f32_16x16x32_bf16 v[16:19], v[160:163], v[88:91], 0
    v_mfma_f32_16x16x32_bf16 v[12:15], v[152:155], v[76:79], 0
    v_mfma_f32_16x16x32_bf16 v[20:23], v[160:163], v[92:95], 0
    v_mfma_f32_16x16x32_bf16 v[8:11], v[156:159], v[80:83], v[8:11]
    v_mfma_f32_16x16x32_bf16 v[16:19], v[164:167], v[96:99], v[16:19]
    v_mfma_f32_16x16x32_bf16 v[12:15], v[156:159], v[84:87], v[12:15]
    v_mfma_f32_16x16x32_bf16 v[20:23], v[164:167], v[100:103], v[20:23]
    v_mfma_f32_16x16x32_bf16 v[16:19], v[152:155], v[104:107], v[16:19]
    s_nop 3
    ds_write_b128 v116, v[8:11] offset:33024
    s_nop 0
    ds_write_b128 v116, v[12:15] offset:34048
    ds_write_b128 v118, v[20:23] offset:42240
    ds_write_b128 v117, v[16:19] offset:41216

    v_lshrrev_b32 v5, 3, v2
    v_and_b32 v5, 3, v5
    v_xor_b32 v5, v5, v2
    v_lshlrev_b32 v5, 4, v5
    s_lshl_b32 s30, s32, 10
    v_add_u32 v116, s30, v5
    s_cmp_eq_u32 s32, 0
    s_cselect_b32 s30, s26, s34
    v_lshrrev_b32 v5, 2, v2
    v_lshl_add_u32 v168, v5, 6, s30
    v_sub_u32 v169, 2048, v168
    v_mov_b32 v5, 1024
    v_cmp_eq_u32 vcc, 0, v168
    s_nop 1
    v_cndmask_b32 v169, v169, v5, vcc
    v_and_b32 v5, 3, v2
    v_lshlrev_b32 v5, 4, v5
    v_mov_b32 v6, 1792
    v_mad_u32_u24 v168, v168, v6, v5
    v_mad_u32_u24 v169, v169, v6, v5
    s_lshl_b32 s30, s27, 6
    s_mul_i32 s31, s33, 448
    s_add_u32 s30, s30, s31
    s_add_u32 s30, s30, 896
    s_cmp_eq_u32 s33, 0
    s_cselect_b32 s35, 1.0, -1.0
    s_waitcnt lgkmcnt(0)
    s_barrier

    ds_read_b128 v[120:123], v116 offset:33024
    ds_read_b128 v[124:127], v116 offset:35072
    ds_read_b128 v[128:131], v116 offset:37120
    ds_read_b128 v[132:135], v116 offset:39168
    ds_read_b128 v[136:139], v116 offset:41216
    ds_read_b128 v[140:143], v116 offset:43264
    ds_read_b128 v[144:147], v116 offset:45312
    ds_read_b128 v[148:151], v116 offset:47360
    s_waitcnt lgkmcnt(0)
    v_fma_f32 v120, v124, s35, v120
    v_fma_f32 v121, v125, s35, v121
    v_fma_f32 v122, v126, s35, v122
    v_fma_f32 v123, v127, s35, v123
    v_fma_f32 v128, v132, s35, v128
    v_fma_f32 v129, v133, s35, v129
    v_fma_f32 v130, v134, s35, v130
    v_fma_f32 v131, v135, s35, v131
    v_fma_f32 v136, v140, s35, v136
    v_fma_f32 v137, v141, s35, v137
    v_fma_f32 v138, v142, s35, v138
    v_fma_f32 v139, v143, s35, v139
    v_fma_f32 v144, v148, s35, v144
    v_fma_f32 v145, v149, s35, v145
    v_fma_f32 v146, v150, s35, v146
    v_fma_f32 v147, v151, s35, v147
    v_add_f32 v124, v120, v136
    v_sub_f32 v140, v120, v136
    v_add_f32 v125, v121, v137
    v_sub_f32 v141, v121, v137
    v_add_f32 v126, v122, v138
    v_sub_f32 v142, v122, v138
    v_add_f32 v127, v123, v139
    v_sub_f32 v143, v123, v139
    v_add_f32 v132, v128, v144
    v_sub_f32 v148, v128, v144
    v_add_f32 v133, v129, v145
    v_sub_f32 v149, v129, v145
    v_add_f32 v134, v130, v146
    v_sub_f32 v150, v130, v146
    v_add_f32 v135, v131, v147
    v_sub_f32 v151, v131, v147
    v_cvt_pk_bf16_f32 v8, v124, v132
    v_cvt_pk_bf16_f32 v9, v125, v133
    v_cvt_pk_bf16_f32 v10, v126, v134
    v_cvt_pk_bf16_f32 v11, v127, v135
    buffer_store_dwordx4 v[8:11], v168, s[20:23], s30 offen
    v_cvt_pk_bf16_f32 v12, v140, v148
    v_cvt_pk_bf16_f32 v13, v141, v149
    v_cvt_pk_bf16_f32 v14, v142, v150
    v_cvt_pk_bf16_f32 v15, v143, v151
    buffer_store_dwordx4 v[12:15], v169, s[20:23], s30 offen
    s_endpgm
K2_end:
    s_endpgm
.fill 4096, 4, 0xbf810000
.section .rodata,"a"
.p2align 6
.amdhsa_kernel k1_kernel
  .amdhsa_next_free_vgpr 200
  .amdhsa_next_free_sgpr 80
  .amdhsa_accum_offset 200
  .amdhsa_group_segment_fixed_size 0
  .amdhsa_kernarg_size 88
  .amdhsa_user_sgpr_count 2
  .amdhsa_user_sgpr_kernarg_segment_ptr 1
  .amdhsa_system_sgpr_workgroup_id_x 1
.end_amdhsa_kernel
.p2align 6
.amdhsa_kernel k2_kernel
  .amdhsa_next_free_vgpr 176
  .amdhsa_next_free_sgpr 80
  .amdhsa_accum_offset 176
  .amdhsa_group_segment_fixed_size 0
  .amdhsa_kernarg_size 88
  .amdhsa_user_sgpr_count 2
  .amdhsa_user_sgpr_kernarg_segment_ptr 1
  .amdhsa_system_sgpr_workgroup_id_x 1
.end_amdhsa_kernel
```

```asm
; @launch grid=(256,1,1) block=(512,1,1) lds=163840
.amdgcn_target "amdgcn-amd-amdhsa--gfx950"
.text
.p2align 12
.fill 832, 4, 0xbf810000
.globl concat_heads__sliding_local_dilated__spectral_fnet__prompt_kernel
.p2align 8
.type concat_heads__sliding_local_dilated__spectral_fnet__prompt_kernel,@function
concat_heads__sliding_local_dilated__spectral_fnet__prompt_kernel:
    s_load_dwordx2 s[16:17], s[0:1], 0
    s_load_dwordx2 s[20:21], s[0:1], 8
    s_load_dwordx2 s[28:29], s[0:1], 24
    s_load_dwordx2 s[36:37], s[0:1], 80
    s_load_dwordx2 s[24:25], s[0:1], 16
    s_load_dwordx2 s[32:33], s[0:1], 64
    v_lshrrev_b32 v1, 6, v0
    s_cmp_ge_u32 s2, 256
    s_cbranch_scc1 K_exit
    v_readfirstlane_b32 s3, v1
    s_and_b32 s4, s2, 7
    s_lshr_b32 s5, s2, 3
    s_mul_i32 s6, s5, 37
    s_lshr_b32 s6, s6, 8
    s_mul_i32 s40, s6, 7
    s_sub_u32 s7, s5, s40
    s_mov_b32 s18, 1835008
    s_mov_b32 s19, 0x00020000
    s_mov_b32 s22, 1204224
    s_mov_b32 s23, 0x00020000
    s_mov_b32 s26, 401408
    s_mov_b32 s27, 0x00020000
    s_mov_b32 s30, 1835008
    s_mov_b32 s31, 0x00020000
    s_mov_b32 s34, 3670016
    s_mov_b32 s35, 0x00020000
    s_mov_b32 s38, 0x10000000
    s_mov_b32 s39, 0x00020000
    s_cmp_lg_u32 s3, 7
    s_cbranch_scc1 K_nopf
    s_getpc_b64 s[44:45]
    s_mov_b32 s46, 20480
    s_mov_b32 s47, 0x00020000
    s_mul_i32 s40, s5, 640
    v_and_b32 v1, 63, v0
    v_min_u32 v1, 4, v1
    v_lshlrev_b32 v1, 7, v1
    buffer_load_dword v255, v1, s[44:47], s40 offen
        K_nopf:
    s_lshl_b32 s8, s4, 2
    s_cmp_ge_u32 s5, 28
    s_cbranch_scc1 K_spare
    s_add_u32 s8, s8, s6
    s_cmp_ge_u32 s3, 4
    s_cbranch_scc1 K_c

    s_mul_i32 s46, s4, 1
    s_mul_i32 s40, s6, 0
    s_add_u32 s46, s46, s40
    s_mul_i32 s40, s7, 1
    s_add_u32 s46, s46, s40
    s_mul_i32 s40, s46, 37
    s_lshr_b32 s40, s40, 8
    s_mul_i32 s40, s40, 7
    s_sub_u32 s46, s46, s40

    v_and_b32 v1, 63, v0
    v_lshrrev_b32 v2, 3, v1
    v_and_b32 v3, 7, v1
    v_lshrrev_b32 v4, 1, v2
    v_xor_b32 v5, v3, v4
    v_mul_u32_u24 v8, 896, v2
    v_lshl_add_u32 v6, v5, 4, v8
    v_xor_b32 v7, 64, v6
    v_add_u32 v7, 6144, v7
    s_lshl_b32 s40, s3, 5
    v_xor_b32 v8, s40, v6
    v_and_b32 v4, 2, v2
    v_xor_b32 v4, v3, v4
    v_mul_u32_u24 v5, 2688, v2
    v_lshl_add_u32 v9, v4, 4, v5
    v_xor_b32 v10, 64, v9
    v_add_u32 v10, 20480, v10
    v_add_u32 v11, 896, v9
    v_add_u32 v12, 896, v10
    v_add_u32 v13, 1792, v9
    v_add_u32 v14, 1792, v10
    s_lshl_b32 s40, s8, 6
    s_lshl_b32 s41, s3, 4
    s_add_u32 s42, s40, s41
    s_mul_i32 s47, s42, 896
    s_mul_i32 s49, s41, 2688
    s_lshl_b32 s42, s7, 7
    s_add_u32 s49, s49, s42
    s_sub_u32 s40, s40, 16
    s_max_i32 s40, s40, 0
    s_lshl_b32 s41, s3, 2
    s_add_u32 s40, s40, s41
    s_mul_i32 s48, s40, 896
    s_lshl_b32 s52, s3, 11
    s_lshl_b32 s51, s3, 9
    s_lshl_b32 s40, s8, 7
    s_waitcnt lgkmcnt(0)
    s_load_dwordx2 s[10:11], s[36:37], s40

    s_lshl_b32 s40, s46, 7
    s_add_u32 s54, s40, s47
    s_add_u32 s55, s40, s48
    s_mul_i32 s56, s46, 172032
    s_add_u32 s56, s56, s49
    s_add_u32 s46, s46, 1
    s_cmp_eq_u32 s46, 7
    s_cselect_b32 s46, 0, s46
    s_add_u32 m0, s52, 2048
    s_nop 0
    buffer_load_dwordx4 v6, s[16:19], s54 offen lds
    buffer_load_dwordx4 v7, s[16:19], s54 offen offset:1024 lds
    s_add_u32 m0, s51, 0
    s_mov_b32 exec_hi, 0
    buffer_load_dwordx4 v8, s[16:19], s55 offen lds
    s_mov_b32 exec_hi, -1
    s_add_u32 m0, s52, 71680
    s_nop 0
    buffer_load_dwordx4 v9, s[20:23], s56 offen lds
    buffer_load_dwordx4 v10, s[20:23], s56 offen offset:1024 lds
    s_add_u32 m0, s52, 79872
    s_nop 0
    buffer_load_dwordx4 v11, s[20:23], s56 offen lds
    buffer_load_dwordx4 v12, s[20:23], s56 offen offset:1024 lds
    s_add_u32 m0, s52, 88064
    s_nop 0
    buffer_load_dwordx4 v13, s[20:23], s56 offen lds
    buffer_load_dwordx4 v14, s[20:23], s56 offen offset:1024 lds
    s_lshl_b32 s40, s46, 7
    s_add_u32 s54, s40, s47
    s_add_u32 s55, s40, s48
    s_mul_i32 s56, s46, 172032
    s_add_u32 s56, s56, s49
    s_add_u32 s46, s46, 1
    s_cmp_eq_u32 s46, 7
    s_cselect_b32 s46, 0, s46
    s_add_u32 m0, s52, 12288
    s_nop 0
    buffer_load_dwordx4 v6, s[16:19], s54 offen lds
    buffer_load_dwordx4 v7, s[16:19], s54 offen offset:1024 lds
    s_add_u32 m0, s51, 10240
    s_mov_b32 exec_hi, 0
    buffer_load_dwordx4 v8, s[16:19], s55 offen lds
    s_mov_b32 exec_hi, -1
    s_add_u32 m0, s52, 96256
    s_nop 0
    buffer_load_dwordx4 v9, s[20:23], s56 offen lds
    s_lshr_b32 s57, s3, 1
    s_and_b32 s58, s3, 1
    v_lshrrev_b32 v15, 4, v1
    v_and_b32 v16, 15, v1
    v_add_u32 v17, s58, v15
    buffer_load_dwordx4 v10, s[20:23], s56 offen offset:1024 lds
    v_cmp_eq_u32 vcc, 0, v17
    s_nop 1
    v_cndmask_b32 v54, 1.0, 0.5, vcc
    v_cndmask_b32 v55, 0, 0.5, vcc
    s_lshl_b32 s62, s7, 5
    s_add_u32 s62, s62, s57
    v_lshl_add_u32 v17, v16, 1, s62
    s_add_u32 m0, s52, 104448
    s_nop 0
    buffer_load_dwordx4 v11, s[20:23], s56 offen lds
    v_cvt_f32_u32 v52, v17
    v_mul_f32 v52, 0x3b124925, v52
    v_lshl_add_u32 v17, v15, 1, s58
    v_cvt_f32_u32 v17, v17
    v_mul_f32 v53, v52, v17
    buffer_load_dwordx4 v12, s[20:23], s56 offen offset:1024 lds
    v_fmamk_f32 v36, v52, 0x0, v53
    v_fmamk_f32 v37, v52, 0x41800000, v53
    v_fmamk_f32 v38, v52, 0x42000000, v53
    v_fmamk_f32 v39, v52, 0x42400000, v53
    v_fmamk_f32 v40, v52, 0x42800000, v53
    v_fmamk_f32 v41, v52, 0x42a00000, v53
    s_add_u32 m0, s52, 112640
    s_nop 0
    buffer_load_dwordx4 v13, s[20:23], s56 offen lds
    v_fmamk_f32 v42, v52, 0x42c00000, v53
    v_fmamk_f32 v43, v52, 0x42e00000, v53
    v_cos_f32 v36, v36
    v_cos_f32 v37, v37
    v_cos_f32 v38, v38
    buffer_load_dwordx4 v14, s[20:23], s56 offen offset:1024 lds
    v_cos_f32 v39, v39
    v_cos_f32 v40, v40
    v_cos_f32 v41, v41
    v_cos_f32 v42, v42
    v_cos_f32 v43, v43
    v_mul_f32 v36, v36, v54
    s_lshl_b32 s40, s46, 7
    s_add_u32 s54, s40, s47
    s_add_u32 s55, s40, s48
    s_mul_i32 s56, s46, 172032
    s_add_u32 s56, s56, s49
    s_mov_b32 s53, s46
    s_add_u32 s46, s46, 1
    s_cmp_eq_u32 s46, 7
    s_cselect_b32 s46, 0, s46
    s_add_u32 m0, s52, 22528
    s_nop 0
    buffer_load_dwordx4 v6, s[16:19], s54 offen lds
    v_mul_f32 v43, v43, v55
    v_cvt_pk_bf16_f32 v20, v36, v37
    v_cvt_pk_bf16_f32 v21, v38, v39
    v_cvt_pk_bf16_f32 v22, v40, v41
    v_cvt_pk_bf16_f32 v23, v42, v43
    v_fmamk_f32 v36, v52, 0x41000000, v53
    s_waitcnt lgkmcnt(0)
    s_add_u32 s12, s10, 0x5a3c9671
    s_xor_b32 s13, s11, 0x2b7e1516
    s_waitcnt vmcnt(10)
    s_barrier
    buffer_load_dwordx4 v7, s[16:19], s54 offen offset:1024 lds
    v_fmamk_f32 v37, v52, 0x41c00000, v53
    v_fmamk_f32 v38, v52, 0x42200000, v53
    v_fmamk_f32 v39, v52, 0x42600000, v53
    v_fmamk_f32 v40, v52, 0x42900000, v53
    v_fmamk_f32 v41, v52, 0x42b00000, v53
    s_add_u32 m0, s51, 20480
    s_mov_b32 exec_hi, 0
    buffer_load_dwordx4 v8, s[16:19], s55 offen lds
    s_mov_b32 exec_hi, -1
    v_fmamk_f32 v42, v52, 0x42d00000, v53
    v_cos_f32 v36, v36
    v_cos_f32 v37, v37
    v_cos_f32 v38, v38
    v_cos_f32 v39, v39
    v_cos_f32 v40, v40
    s_add_u32 m0, s52, 120832
    s_nop 0
    buffer_load_dwordx4 v9, s[20:23], s56 offen lds
    v_cos_f32 v41, v41
    v_cos_f32 v42, v42
    v_mov_b32 v43, 0
    v_cvt_pk_bf16_f32 v24, v36, v37
    v_cvt_pk_bf16_f32 v25, v38, v39
    buffer_load_dwordx4 v10, s[20:23], s56 offen offset:1024 lds
    v_cvt_pk_bf16_f32 v26, v40, v41
    v_cvt_pk_bf16_f32 v27, v42, v43
    s_lshl_b32 s62, s7, 5
    s_add_u32 s62, s62, 1
    s_sub_u32 s62, s62, s57
    v_lshl_add_u32 v17, v16, 1, s62
    s_add_u32 m0, s52, 129024
    s_nop 0
    buffer_load_dwordx4 v11, s[20:23], s56 offen lds
    v_cvt_f32_u32 v52, v17
    v_mul_f32 v52, 0x3b124925, v52
    v_lshl_add_u32 v17, v15, 1, s58
    v_cvt_f32_u32 v17, v17
    v_mul_f32 v53, v52, v17
    buffer_load_dwordx4 v12, s[20:23], s56 offen offset:1024 lds
    v_fmamk_f32 v36, v52, 0x0, v53
    v_fmamk_f32 v37, v52, 0x41800000, v53
    v_fmamk_f32 v38, v52, 0x42000000, v53
    v_fmamk_f32 v39, v52, 0x42400000, v53
    v_fmamk_f32 v40, v52, 0x42800000, v53
    v_fmamk_f32 v41, v52, 0x42a00000, v53
    s_lshl_b32 s40, s46, 7
    s_add_u32 s54, s40, s47
    s_add_u32 s55, s40, s48
    s_mul_i32 s56, s46, 172032
    s_add_u32 s56, s56, s49
    s_add_u32 s46, s46, 1
    s_cmp_eq_u32 s46, 7
    s_cselect_b32 s46, 0, s46
    s_add_u32 m0, s52, 32768
    s_nop 0
    buffer_load_dwordx4 v6, s[16:19], s54 offen lds
    v_fmamk_f32 v42, v52, 0x42c00000, v53
    v_fmamk_f32 v43, v52, 0x42e00000, v53
    v_sin_f32 v36, v36
    v_sin_f32 v37, v37
    v_sin_f32 v38, v38
    v_sin_f32 v39, v39
    buffer_load_dwordx4 v7, s[16:19], s54 offen offset:1024 lds
    v_sin_f32 v40, v40
    v_sin_f32 v41, v41
    v_sin_f32 v42, v42
    v_sin_f32 v43, v43
    v_mul_f32 v36, v36, v54
    s_add_u32 m0, s51, 30720
    s_mov_b32 exec_hi, 0
    buffer_load_dwordx4 v8, s[16:19], s55 offen lds
    s_mov_b32 exec_hi, -1
    v_mul_f32 v43, v43, v55
    v_cvt_pk_bf16_f32 v28, v36, v37
    v_cvt_pk_bf16_f32 v29, v38, v39
    v_cvt_pk_bf16_f32 v30, v40, v41
    v_cvt_pk_bf16_f32 v31, v42, v43
    v_fmamk_f32 v36, v52, 0x41000000, v53
    s_waitcnt vmcnt(10)
    s_barrier
    s_add_u32 m0, s52, 137216
    s_nop 0
    buffer_load_dwordx4 v9, s[20:23], s56 offen lds
    v_fmamk_f32 v37, v52, 0x41c00000, v53
    v_fmamk_f32 v38, v52, 0x42200000, v53
    v_fmamk_f32 v39, v52, 0x42600000, v53
    v_fmamk_f32 v40, v52, 0x42900000, v53
    v_fmamk_f32 v41, v52, 0x42b00000, v53
    buffer_load_dwordx4 v10, s[20:23], s56 offen offset:1024 lds
    v_fmamk_f32 v42, v52, 0x42d00000, v53
    v_sin_f32 v36, v36
    v_sin_f32 v37, v37
    v_sin_f32 v38, v38
    v_sin_f32 v39, v39
    v_sin_f32 v40, v40
    s_add_u32 m0, s52, 145408
    s_nop 0
    buffer_load_dwordx4 v11, s[20:23], s56 offen lds
    v_sin_f32 v41, v41
    v_sin_f32 v42, v42
    v_mov_b32 v43, 0
    v_cvt_pk_bf16_f32 v32, v36, v37
    v_cvt_pk_bf16_f32 v33, v38, v39
    buffer_load_dwordx4 v12, s[20:23], s56 offen offset:1024 lds
    v_cvt_pk_bf16_f32 v34, v40, v41
    v_cvt_pk_bf16_f32 v35, v42, v43
    s_add_u32 s59, s8, 1024
    s_cmp_eq_u32 s8, 0
    s_cselect_b32 s59, 32, s59
    v_lshl_add_u32 v17, v16, 6, s8
    v_cvt_f32_u32 v52, v17
    v_mul_f32 v52, 0x3a000000, v52
    s_lshl_b32 s40, s46, 7
    s_add_u32 s54, s40, s47
    s_add_u32 s55, s40, s48
    s_mul_i32 s56, s46, 172032
    s_add_u32 s56, s56, s49
    s_add_u32 s46, s46, 1
    s_cmp_eq_u32 s46, 7
    s_cselect_b32 s46, 0, s46
    s_add_u32 m0, s52, 43008
    s_nop 0
    buffer_load_dwordx4 v6, s[16:19], s54 offen lds
    v_lshlrev_b32 v17, 2, v15
    v_cvt_f32_u32 v17, v17
    v_mul_f32 v53, v52, v17
    v_fmamk_f32 v36, v52, 0x0, v53
    v_fmamk_f32 v37, v52, 0x3f800000, v53
    v_fmamk_f32 v38, v52, 0x40000000, v53
    buffer_load_dwordx4 v7, s[16:19], s54 offen offset:1024 lds
    v_fmamk_f32 v39, v52, 0x40400000, v53
    v_fmamk_f32 v40, v52, 0x41800000, v53
    v_fmamk_f32 v41, v52, 0x41880000, v53
    v_fmamk_f32 v42, v52, 0x41900000, v53
    v_fmamk_f32 v43, v52, 0x41980000, v53
    s_add_u32 m0, s51, 40960
    s_mov_b32 exec_hi, 0
    buffer_load_dwordx4 v8, s[16:19], s55 offen lds
    s_mov_b32 exec_hi, -1
    v_sin_f32 v44, v36
    v_cos_f32 v36, v36
    v_sin_f32 v45, v37
    v_cos_f32 v37, v37
    v_sin_f32 v46, v38
    v_cos_f32 v38, v38
    s_waitcnt vmcnt(10)
    s_barrier
    s_add_u32 m0, s52, 153600
    s_nop 0
    buffer_load_dwordx4 v9, s[20:23], s56 offen lds
    v_sin_f32 v47, v39
    v_cos_f32 v39, v39
    v_sin_f32 v48, v40
    v_cos_f32 v40, v40
    v_sin_f32 v49, v41
    buffer_load_dwordx4 v10, s[20:23], s56 offen offset:1024 lds
    v_cos_f32 v41, v41
    v_sin_f32 v50, v42
    v_cos_f32 v42, v42
    v_sin_f32 v51, v43
    v_cos_f32 v43, v43
    v_cvt_pk_bf16_f32 v56, v36, v37
    s_add_u32 m0, s52, 71680
    s_nop 0
    buffer_load_dwordx4 v11, s[20:23], s56 offen lds
    v_cvt_pk_bf16_f32 v64, v44, v45
    v_mov_b32 v80, v56
    v_xor_b32 v72, 0x80008000, v64
    v_cvt_pk_bf16_f32 v57, v38, v39
    v_cvt_pk_bf16_f32 v65, v46, v47
    v_mov_b32 v81, v57
    buffer_load_dwordx4 v12, s[20:23], s56 offen offset:1024 lds
    v_xor_b32 v73, 0x80008000, v65
    v_cvt_pk_bf16_f32 v58, v40, v41
    v_cvt_pk_bf16_f32 v66, v48, v49
    v_mov_b32 v82, v58
    v_xor_b32 v74, 0x80008000, v66
    s_lshl_b32 s40, s46, 7
    s_add_u32 s54, s40, s47
    s_add_u32 s55, s40, s48
    s_mul_i32 s56, s46, 172032
    s_add_u32 s56, s56, s49
    s_add_u32 s46, s46, 1
    s_cmp_eq_u32 s46, 7
    s_cselect_b32 s46, 0, s46
    s_add_u32 m0, s52, 53248
    s_nop 0
    buffer_load_dwordx4 v6, s[16:19], s54 offen lds
    v_cvt_pk_bf16_f32 v59, v42, v43
    v_cvt_pk_bf16_f32 v67, v50, v51
    v_mov_b32 v83, v59
    v_xor_b32 v75, 0x80008000, v67
    v_lshl_add_u32 v17, v16, 6, s59
    v_cvt_f32_u32 v52, v17
    buffer_load_dwordx4 v7, s[16:19], s54 offen offset:1024 lds
    v_mul_f32 v52, 0x3a000000, v52
    v_lshlrev_b32 v17, 2, v15
    v_cvt_f32_u32 v17, v17
    v_mul_f32 v53, v52, v17
    v_fmamk_f32 v36, v52, 0x0, v53
    s_add_u32 m0, s51, 51200
    s_mov_b32 exec_hi, 0
    buffer_load_dwordx4 v8, s[16:19], s55 offen lds
    s_mov_b32 exec_hi, -1
    v_fmamk_f32 v37, v52, 0x3f800000, v53
    v_fmamk_f32 v38, v52, 0x40000000, v53
    v_fmamk_f32 v39, v52, 0x40400000, v53
    v_fmamk_f32 v40, v52, 0x41800000, v53
    v_fmamk_f32 v41, v52, 0x41880000, v53
    v_fmamk_f32 v42, v52, 0x41900000, v53
    s_waitcnt vmcnt(10)
    s_barrier
    s_add_u32 m0, s52, 79872
    s_nop 0
    buffer_load_dwordx4 v9, s[20:23], s56 offen lds
    v_fmamk_f32 v43, v52, 0x41980000, v53
    v_sin_f32 v44, v36
    v_cos_f32 v36, v36
    v_sin_f32 v45, v37
    v_cos_f32 v37, v37
    buffer_load_dwordx4 v10, s[20:23], s56 offen offset:1024 lds
    v_sin_f32 v46, v38
    v_cos_f32 v38, v38
    v_sin_f32 v47, v39
    v_cos_f32 v39, v39
    v_sin_f32 v48, v40
    v_cos_f32 v40, v40
    s_add_u32 m0, s52, 88064
    s_nop 0
    buffer_load_dwordx4 v11, s[20:23], s56 offen lds
    v_sin_f32 v49, v41
    v_cos_f32 v41, v41
    v_sin_f32 v50, v42
    v_cos_f32 v42, v42
    v_sin_f32 v51, v43
    v_cos_f32 v43, v43
    buffer_load_dwordx4 v12, s[20:23], s56 offen offset:1024 lds
    v_cvt_pk_bf16_f32 v60, v36, v37
    v_cvt_pk_bf16_f32 v68, v44, v45
    v_mov_b32 v84, v60
    v_xor_b32 v76, 0x80008000, v68
    v_cvt_pk_bf16_f32 v61, v38, v39
    s_lshl_b32 s40, s46, 7
    s_add_u32 s54, s40, s47
    s_add_u32 s55, s40, s48
    s_mul_i32 s56, s46, 172032
    s_add_u32 s56, s56, s49
    s_add_u32 s46, s46, 1
    s_cmp_eq_u32 s46, 7
    s_cselect_b32 s46, 0, s46
    s_add_u32 m0, s52, 63488
    s_nop 0
    buffer_load_dwordx4 v6, s[16:19], s54 offen lds
    v_cvt_pk_bf16_f32 v69, v46, v47
    v_mov_b32 v85, v61
    v_xor_b32 v77, 0x80008000, v69
    v_cvt_pk_bf16_f32 v62, v40, v41
    v_cvt_pk_bf16_f32 v70, v48, v49
    v_mov_b32 v86, v62
    buffer_load_dwordx4 v7, s[16:19], s54 offen offset:1024 lds
    v_xor_b32 v78, 0x80008000, v70
    v_cvt_pk_bf16_f32 v63, v42, v43
    v_cvt_pk_bf16_f32 v71, v50, v51
    v_mov_b32 v87, v63
    v_xor_b32 v79, 0x80008000, v71
    s_add_u32 m0, s51, 61440
    s_mov_b32 exec_hi, 0
    buffer_load_dwordx4 v8, s[16:19], s55 offen lds
    s_mov_b32 exec_hi, -1
    v_lshrrev_b32 v17, 1, v16
    v_xor_b32 v18, v17, v15
    v_lshlrev_b32 v18, 4, v18
    v_lshl_add_u32 v18, v16, 7, v18
    s_lshl_b32 s62, s3, 13
    v_add_u32 v100, s62, v18
    s_waitcnt vmcnt(10)
    s_barrier
    s_add_u32 m0, s52, 96256
    s_nop 0
    buffer_load_dwordx4 v9, s[20:23], s56 offen lds
    v_xor_b32 v101, 64, v100
    v_and_b32 v17, 3, v17
    v_xor_b32 v17, v17, v15
    v_lshl_add_u32 v17, v16, 2, v17
    v_lshlrev_b32 v17, 4, v17
    buffer_load_dwordx4 v10, s[20:23], s56 offen offset:1024 lds
    s_lshl_b32 s63, s3, 11
    v_add_u32 v92, s63, v17
    v_xor_b32 v93, 4096, v92
    v_mov_b32 v94, v93
    v_lshrrev_b32 v17, 4, v1
    v_xor_b32 v17, v17, v1
    s_add_u32 m0, s52, 104448
    s_nop 0
    buffer_load_dwordx4 v11, s[20:23], s56 offen lds
    v_lshlrev_b32 v98, 4, v17
    v_xor_b32 v99, 64, v98
    s_lshl_b32 s61, s8, 15
    s_add_u32 s61, s61, s62
    s_add_u32 s61, s61, 1048576
    v_lshrrev_b32 v17, 3, v1
    buffer_load_dwordx4 v12, s[20:23], s56 offen offset:1024 lds
    v_and_b32 v17, 3, v17
    v_xor_b32 v17, v17, v1
    v_lshlrev_b32 v17, 4, v17
    s_lshl_b32 s63, s57, 10
    v_add_u32 v95, s63, v17
    s_mul_i32 s56, s53, 172032
    s_add_u32 s56, s56, s49
    s_add_u32 s53, s53, 1
    s_cmp_eq_u32 s53, 7
    s_cselect_b32 s53, 0, s53
    s_add_u32 m0, s52, 112640
    s_nop 0
    buffer_load_dwordx4 v13, s[20:23], s56 offen lds
    s_cmp_eq_u32 s57, 0
    s_cselect_b32 s63, s8, s59
    v_lshrrev_b32 v17, 2, v1
    v_lshl_add_u32 v96, v17, 6, s63
    v_sub_u32 v97, 2048, v96
    v_mov_b32 v17, 1024
    v_cmp_eq_u32 vcc, 0, v96
    buffer_load_dwordx4 v14, s[20:23], s56 offen offset:1024 lds
    s_nop 0
    v_cndmask_b32 v97, v97, v17, vcc
    v_and_b32 v17, 3, v1
    v_lshlrev_b32 v17, 4, v17
    s_lshl_b32 s62, s7, 6
    s_mul_i32 s63, s58, 448
    s_mul_i32 s56, s53, 172032
    s_add_u32 s56, s56, s49
    s_add_u32 s53, s53, 1
    s_cmp_eq_u32 s53, 7
    s_cselect_b32 s53, 0, s53
    s_add_u32 m0, s52, 120832
    s_nop 0
    buffer_load_dwordx4 v13, s[20:23], s56 offen lds
    s_add_u32 s62, s62, s63
    v_add_u32 v17, s62, v17
    v_mov_b32 v18, 1792
    v_mad_u32_u24 v96, v96, v18, v17
    v_mad_u32_u24 v97, v97, v18, v17
    s_cmp_eq_u32 s58, 0
    s_cselect_b32 s60, 1.0, -1.0
    s_waitcnt vmcnt(10)
    s_barrier
    buffer_load_dwordx4 v14, s[20:23], s56 offen offset:1024 lds
    v_mov_b32 v102, 161792
    v_mov_b32 v88, 0
    v_mov_b32 v89, 0
    v_mov_b32 v90, 0
    v_mov_b32 v91, 0
    s_cmp_lg_u32 s8, 0
    s_cbranch_scc1 H_reg
    v_cmp_eq_u32 vcc, 0, v16
    v_mov_b32 v17, 0x3f80
    v_mov_b32 v18, 0x3f800000
    v_cndmask_b32 v93, v93, v92, vcc
    v_cndmask_b32 v56, v56, v17, vcc
    v_cndmask_b32 v88, 0, v18, vcc
    v_mov_b32 v64, 0
    v_mov_b32 v80, 0
    v_mov_b32 v68, v60
    v_mov_b32 v60, 0
    v_mov_b32 v84, v76
    v_mov_b32 v76, 0
    v_cndmask_b32 v57, v57, v17, vcc
    v_cndmask_b32 v89, 0, v18, vcc
    v_mov_b32 v65, 0
    v_mov_b32 v81, 0
    v_mov_b32 v69, v61
    v_mov_b32 v61, 0
    v_mov_b32 v85, v77
    v_mov_b32 v77, 0
    v_cndmask_b32 v58, v58, v17, vcc
    v_cndmask_b32 v90, 0, v18, vcc
    v_mov_b32 v66, 0
    v_mov_b32 v82, 0
    v_mov_b32 v70, v62
    v_mov_b32 v62, 0
    v_mov_b32 v86, v78
    v_mov_b32 v78, 0
    v_cndmask_b32 v59, v59, v17, vcc
    v_cndmask_b32 v91, 0, v18, vcc
    v_mov_b32 v67, 0
    v_mov_b32 v83, 0
    v_mov_b32 v71, v63
    v_mov_b32 v63, 0
    v_mov_b32 v87, v79
    v_mov_b32 v79, 0
H_reg:
    s_mul_i32 s56, s53, 172032
    s_add_u32 s56, s56, s49
    s_add_u32 s53, s53, 1
    s_cmp_eq_u32 s53, 7
    s_cselect_b32 s53, 0, s53
    s_add_u32 m0, s52, 129024
    s_nop 0
    buffer_load_dwordx4 v13, s[20:23], s56 offen lds
    buffer_load_dwordx4 v14, s[20:23], s56 offen offset:1024 lds
    s_mul_i32 s56, s53, 172032
    s_add_u32 s56, s56, s49
    s_add_u32 s53, s53, 1
    s_cmp_eq_u32 s53, 7
    s_cselect_b32 s53, 0, s53
    s_add_u32 m0, s52, 137216
    s_nop 0
    buffer_load_dwordx4 v13, s[20:23], s56 offen lds
    buffer_load_dwordx4 v14, s[20:23], s56 offen offset:1024 lds
    s_mul_i32 s56, s53, 172032
    s_add_u32 s56, s56, s49
    s_add_u32 s53, s53, 1
    s_cmp_eq_u32 s53, 7
    s_cselect_b32 s53, 0, s53
    s_add_u32 m0, s52, 145408
    s_nop 0
    buffer_load_dwordx4 v13, s[20:23], s56 offen lds
    buffer_load_dwordx4 v14, s[20:23], s56 offen offset:1024 lds
    s_waitcnt vmcnt(10)
    s_barrier
    s_waitcnt vmcnt(6)
    s_barrier
    s_waitcnt vmcnt(2)
    s_barrier
    s_waitcnt vmcnt(0)
    s_barrier
    v_and_b32 v4, 6, v2
    v_xor_b32 v4, v3, v4
    v_mul_u32_u24 v5, 896, v2
    v_lshl_add_u32 v103, v4, 4, v5
    v_add_u32 v104, 6144, v103
    v_mov_b32 v108, 0
    s_lshl_b32 s46, s6, 1
    s_mul_i32 s54, s3, 14336
    s_lshl_b32 s40, s7, 7
    s_add_u32 s54, s54, s40
    s_add_u32 s55, s52, 71680
    s_lshl_b32 s47, s8, 7
    s_add_u32 s47, s47, 8256

    s_lshl_b32 s40, s46, 13
    s_add_u32 m0, s40, s55
    s_mul_i32 s40, s46, 57344
    s_add_u32 s40, s40, s54
    buffer_load_dwordx4 v103, s[24:27], s40 offen lds
    buffer_load_dwordx4 v104, s[24:27], s40 offen offset:1024 lds

    s_add_u32 s46, s46, 1
    s_cmp_eq_u32 s46, 7
    s_cselect_b32 s46, 0, s46
    s_lshl_b32 s40, s46, 13
    s_add_u32 m0, s40, s55
    s_mul_i32 s40, s46, 57344
    s_add_u32 s40, s40, s54
    buffer_load_dwordx4 v103, s[24:27], s40 offen lds
    buffer_load_dwordx4 v104, s[24:27], s40 offen offset:1024 lds

    s_add_u32 s46, s46, 1
    s_cmp_eq_u32 s46, 7
    s_cselect_b32 s46, 0, s46
    s_lshl_b32 s40, s46, 13
    s_add_u32 m0, s40, s55
    s_mul_i32 s40, s46, 57344
    s_add_u32 s40, s40, s54
    buffer_load_dwordx4 v103, s[24:27], s40 offen lds
    buffer_load_dwordx4 v104, s[24:27], s40 offen offset:1024 lds

    s_add_u32 s46, s46, 1
    s_cmp_eq_u32 s46, 7
    s_cselect_b32 s46, 0, s46
    s_lshl_b32 s40, s46, 13
    s_add_u32 m0, s40, s55
    s_mul_i32 s40, s46, 57344
    s_add_u32 s40, s40, s54
    buffer_load_dwordx4 v103, s[24:27], s40 offen lds
    buffer_load_dwordx4 v104, s[24:27], s40 offen offset:1024 lds

    s_add_u32 s46, s46, 1
    s_cmp_eq_u32 s46, 7
    s_cselect_b32 s46, 0, s46
    s_lshl_b32 s40, s46, 13
    s_add_u32 m0, s40, s55
    s_mul_i32 s40, s46, 57344
    s_add_u32 s40, s40, s54
    buffer_load_dwordx4 v103, s[24:27], s40 offen lds
    buffer_load_dwordx4 v104, s[24:27], s40 offen offset:1024 lds

    s_add_u32 s46, s46, 1
    s_cmp_eq_u32 s46, 7
    s_cselect_b32 s46, 0, s46
    s_lshl_b32 s40, s46, 13
    s_add_u32 m0, s40, s55
    s_mul_i32 s40, s46, 57344
    s_add_u32 s40, s40, s54
    buffer_load_dwordx4 v103, s[24:27], s40 offen lds
    buffer_load_dwordx4 v104, s[24:27], s40 offen offset:1024 lds

    s_add_u32 s46, s46, 1
    s_cmp_eq_u32 s46, 7
    s_cselect_b32 s46, 0, s46
    s_lshl_b32 s40, s46, 13
    s_add_u32 m0, s40, s55
    s_mul_i32 s40, s46, 57344
    s_add_u32 s40, s40, s54
    buffer_load_dwordx4 v103, s[24:27], s40 offen lds
    buffer_load_dwordx4 v104, s[24:27], s40 offen offset:1024 lds

    buffer_load_dwordx2 v[106:107], v108, s[36:39], s47 offen sc1
    s_waitcnt vmcnt(0)
    v_cmp_ne_u64 vcc, s[12:13], v[106:107]
    s_nop 0
    s_cbranch_vccnz H_late
    s_lshl_b32 s62, s3, 13
    s_add_u32 m0, s62, 0
    s_add_u32 s63, s61, 4096
    buffer_load_dwordx4 v98, s[36:39], s61 offen offset:0 sc1 lds
    buffer_load_dwordx4 v99, s[36:39], s61 offen offset:1024 sc1 lds
    buffer_load_dwordx4 v98, s[36:39], s61 offen offset:2048 sc1 lds
    buffer_load_dwordx4 v99, s[36:39], s61 offen offset:3072 sc1 lds
    s_add_u32 m0, s62, 4096
    s_nop 0
    buffer_load_dwordx4 v98, s[36:39], s63 offen offset:0 sc1 lds
    buffer_load_dwordx4 v99, s[36:39], s63 offen offset:1024 sc1 lds
    buffer_load_dwordx4 v98, s[36:39], s63 offen offset:2048 sc1 lds
    buffer_load_dwordx4 v99, s[36:39], s63 offen offset:3072 sc1 lds
    s_barrier
    s_branch H_go
H_late:
    s_barrier
    s_mov_b32 s44, 0
        H_pl:
    buffer_load_dwordx2 v[106:107], v108, s[36:39], s47 offen sc1
    s_add_u32 s44, s44, 1
    s_cmp_gt_u32 s44, 200000
    s_cbranch_scc1 H_pd
    s_waitcnt vmcnt(0)
    v_cmp_ne_u64 vcc, s[12:13], v[106:107]
    s_nop 0
    s_cbranch_vccnz H_pl
        H_pd:

    s_lshl_b32 s62, s3, 13
    s_add_u32 m0, s62, 0
    s_add_u32 s63, s61, 4096
    buffer_load_dwordx4 v98, s[36:39], s61 offen offset:0 sc1 lds
    buffer_load_dwordx4 v99, s[36:39], s61 offen offset:1024 sc1 lds
    buffer_load_dwordx4 v98, s[36:39], s61 offen offset:2048 sc1 lds
    buffer_load_dwordx4 v99, s[36:39], s61 offen offset:3072 sc1 lds
    s_add_u32 m0, s62, 4096
    s_nop 0
    buffer_load_dwordx4 v98, s[36:39], s63 offen offset:0 sc1 lds
    buffer_load_dwordx4 v99, s[36:39], s63 offen offset:1024 sc1 lds
    buffer_load_dwordx4 v98, s[36:39], s63 offen offset:2048 sc1 lds
    buffer_load_dwordx4 v99, s[36:39], s63 offen offset:3072 sc1 lds
H_go:
    s_waitcnt vmcnt(6)
    ds_read_b128 v[110:113], v100 offset:0
    ds_read_b128 v[114:117], v101 offset:0
    s_waitcnt vmcnt(4)
    ds_read_b128 v[118:121], v100 offset:2048
    ds_read_b128 v[122:125], v101 offset:2048
    s_waitcnt vmcnt(2)
    ds_read_b128 v[126:129], v100 offset:4096
    ds_read_b128 v[130:133], v101 offset:4096
    s_waitcnt vmcnt(0)
    ds_read_b128 v[134:137], v100 offset:6144
    ds_read_b128 v[138:141], v101 offset:6144
    s_waitcnt lgkmcnt(6)
    v_mfma_f32_16x16x32_bf16 v[142:145], v[110:113], v[20:23], 0
    v_mfma_f32_16x16x32_bf16 v[158:161], v[110:113], v[28:31], 0
    v_mfma_f32_16x16x32_bf16 v[142:145], v[114:117], v[24:27], v[142:145]
    v_mfma_f32_16x16x32_bf16 v[158:161], v[114:117], v[32:35], v[158:161]
    s_waitcnt lgkmcnt(4)
    v_mfma_f32_16x16x32_bf16 v[146:149], v[118:121], v[20:23], 0
    v_mfma_f32_16x16x32_bf16 v[162:165], v[118:121], v[28:31], 0
    v_mfma_f32_16x16x32_bf16 v[146:149], v[122:125], v[24:27], v[146:149]
    v_mfma_f32_16x16x32_bf16 v[162:165], v[122:125], v[32:35], v[162:165]
    s_waitcnt lgkmcnt(2)
    v_mfma_f32_16x16x32_bf16 v[150:153], v[126:129], v[20:23], 0
    v_mfma_f32_16x16x32_bf16 v[166:169], v[126:129], v[28:31], 0
    v_mfma_f32_16x16x32_bf16 v[150:153], v[130:133], v[24:27], v[150:153]
    v_mfma_f32_16x16x32_bf16 v[166:169], v[130:133], v[32:35], v[166:169]
    s_waitcnt lgkmcnt(0)
    v_mfma_f32_16x16x32_bf16 v[154:157], v[134:137], v[20:23], 0
    v_mfma_f32_16x16x32_bf16 v[170:173], v[134:137], v[28:31], 0
    v_mfma_f32_16x16x32_bf16 v[154:157], v[138:141], v[24:27], v[154:157]
    v_mfma_f32_16x16x32_bf16 v[170:173], v[138:141], v[32:35], v[170:173]
    v_cvt_pk_bf16_f32 v174, v142, v143
    v_cvt_pk_bf16_f32 v175, v144, v145
    v_cvt_pk_bf16_f32 v176, v146, v147
    v_cvt_pk_bf16_f32 v177, v148, v149
    v_cvt_pk_bf16_f32 v182, v158, v159
    v_cvt_pk_bf16_f32 v183, v160, v161
    v_cvt_pk_bf16_f32 v184, v162, v163
    v_cvt_pk_bf16_f32 v185, v164, v165
    v_mfma_f32_16x16x32_bf16 v[110:113], v[174:177], v[56:59], 0
    s_nop 0
    v_mfma_f32_16x16x32_bf16 v[118:121], v[182:185], v[72:75], 0
    v_mfma_f32_16x16x32_bf16 v[114:117], v[174:177], v[60:63], 0
    v_mfma_f32_16x16x32_bf16 v[122:125], v[182:185], v[76:79], 0
    v_mfma_f32_16x16x32_bf16 v[118:121], v[174:177], v[88:91], v[118:121]
    v_cvt_pk_bf16_f32 v178, v150, v151
    v_cvt_pk_bf16_f32 v179, v152, v153
    v_cvt_pk_bf16_f32 v180, v154, v155
    v_cvt_pk_bf16_f32 v181, v156, v157
    v_cvt_pk_bf16_f32 v186, v166, v167
    v_cvt_pk_bf16_f32 v187, v168, v169
    v_cvt_pk_bf16_f32 v188, v170, v171
    v_cvt_pk_bf16_f32 v189, v172, v173
    v_mfma_f32_16x16x32_bf16 v[110:113], v[178:181], v[64:67], v[110:113]
    s_nop 0
    v_mfma_f32_16x16x32_bf16 v[118:121], v[186:189], v[80:83], v[118:121]
    v_mfma_f32_16x16x32_bf16 v[114:117], v[178:181], v[68:71], v[114:117]
    v_mfma_f32_16x16x32_bf16 v[122:125], v[186:189], v[84:87], v[122:125]
    v_mov_b32 v17, 1
    s_nop 2
    ds_write_b128 v92, v[110:113] offset:40960
    s_nop 0
    ds_write_b128 v93, v[118:121] offset:49152
    ds_write_b128 v92, v[114:117] offset:41984
    ds_write_b128 v94, v[122:125] offset:50176
    s_mov_b64 exec, 1
    ds_add_u32 v102, v17
    s_mov_b64 exec, -1
    s_mov_b32 s44, 0
            H_sy:
    ds_read_b32 v17, v102
    s_add_u32 s44, s44, 1
    s_cmp_gt_u32 s44, 1600000
    s_cbranch_scc1 H_sd
    s_waitcnt lgkmcnt(0)
    v_cmp_gt_u32 vcc, 4, v17
    s_nop 0
    s_cbranch_vccnz H_sy
            H_sd:

    ds_read_b128 v[142:145], v95 offset:40960
    ds_read_b128 v[146:149], v95 offset:43008
    ds_read_b128 v[150:153], v95 offset:45056
    ds_read_b128 v[154:157], v95 offset:47104
    ds_read_b128 v[158:161], v95 offset:49152
    ds_read_b128 v[162:165], v95 offset:51200
    ds_read_b128 v[166:169], v95 offset:53248
    ds_read_b128 v[170:173], v95 offset:55296
    s_waitcnt lgkmcnt(6)
    v_fma_f32 v142, v146, s60, v142
    v_fma_f32 v143, v147, s60, v143
    v_fma_f32 v144, v148, s60, v144
    v_fma_f32 v145, v149, s60, v145
    s_waitcnt lgkmcnt(4)
    v_fma_f32 v150, v154, s60, v150
    v_fma_f32 v151, v155, s60, v151
    v_fma_f32 v152, v156, s60, v152
    v_fma_f32 v153, v157, s60, v153
    s_waitcnt lgkmcnt(2)
    v_fma_f32 v158, v162, s60, v158
    v_fma_f32 v159, v163, s60, v159
    v_fma_f32 v160, v164, s60, v160
    v_fma_f32 v161, v165, s60, v161
    s_waitcnt lgkmcnt(0)
    v_fma_f32 v166, v170, s60, v166
    v_fma_f32 v167, v171, s60, v167
    v_fma_f32 v168, v172, s60, v168
    v_fma_f32 v169, v173, s60, v169
    v_add_f32 v146, v142, v158
    v_add_f32 v147, v143, v159
    v_add_f32 v148, v144, v160
    v_add_f32 v149, v145, v161
    v_add_f32 v154, v150, v166
    v_add_f32 v155, v151, v167
    v_add_f32 v156, v152, v168
    v_add_f32 v157, v153, v169
    v_cvt_pk_bf16_f32 v126, v146, v154
    v_cvt_pk_bf16_f32 v127, v147, v155
    v_cvt_pk_bf16_f32 v128, v148, v156
    v_cvt_pk_bf16_f32 v129, v149, v157
    buffer_store_dwordx4 v[126:129], v96, s[32:35], 0 offen offset:896
    v_sub_f32 v162, v142, v158
    v_sub_f32 v163, v143, v159
    v_sub_f32 v164, v144, v160
    v_sub_f32 v165, v145, v161
    v_sub_f32 v170, v150, v166
    v_sub_f32 v171, v151, v167
    v_sub_f32 v172, v152, v168
    v_sub_f32 v173, v153, v169
    v_cvt_pk_bf16_f32 v130, v162, v170
    v_cvt_pk_bf16_f32 v131, v163, v171
    v_cvt_pk_bf16_f32 v132, v164, v172
    v_cvt_pk_bf16_f32 v133, v165, v173
    buffer_store_dwordx4 v[130:133], v97, s[32:35], 0 offen offset:896
    s_add_u32 s40, s7, s3
    s_cmp_lg_u32 s40, 0
    s_cbranch_scc1 H_end
    s_add_u32 s40, s10, 16
    v_mov_b32 v4, s40
    s_lshl_b32 s40, s8, 7
    s_mov_b64 exec, 1
    buffer_store_dword v4, v108, s[36:39], s40 offen
        H_end:

    s_endpgm
K_spare:
    s_add_u32 s8, s8, s7
    v_and_b32 v6, 15, v0
    v_lshlrev_b32 v6, 4, v6
    v_lshrrev_b32 v4, 4, v0
    v_lshl_add_u32 v4, v4, 5, s8
    v_sub_u32 v5, 1024, v4
    v_mul_u32_u24 v4, 896, v4
    v_add_u32 v7, v4, v6
    v_sub_u32 v8, v4, v6
    v_add_u32 v8, 432, v8
    v_mul_u32_u24 v4, 896, v5
    v_add_u32 v12, v4, v6
    v_sub_u32 v11, v4, v6
    v_add_u32 v5, 1024, v5
    v_and_b32 v5, 2047, v5
    v_mul_u32_u24 v4, 896, v5
    v_add_u32 v10, v4, v6
    v_sub_u32 v9, v4, v6
    v_add_u32 v9, 880, v9
    v_add_u32 v11, 880, v11
    s_mov_b32 s41, 917504
    s_lshl_b32 s40, s8, 7
    s_waitcnt lgkmcnt(0)

    buffer_load_dwordx4 v[14:17], v7, s[28:31], 0 offen
    buffer_load_dwordx4 v[22:25], v8, s[28:31], 0 offen
    buffer_load_dword v31, v8, s[28:31], 0 offen offset:16
    buffer_load_dwordx4 v[18:21], v9, s[28:31], 0 offen
    buffer_load_dword v30, v9, s[28:31], 0 offen offset:16
    buffer_load_dwordx4 v[26:29], v10, s[28:31], 0 offen offset:448

    buffer_load_dwordx4 v[32:35], v7, s[28:31], s41 offen
    buffer_load_dwordx4 v[40:43], v8, s[28:31], s41 offen
    buffer_load_dword v49, v8, s[28:31], s41 offen offset:16
    buffer_load_dwordx4 v[36:39], v11, s[28:31], 0 offen
    buffer_load_dword v48, v11, s[28:31], 0 offen offset:16
    buffer_load_dwordx4 v[44:47], v12, s[28:31], 0 offen offset:448

    s_load_dwordx2 s[10:11], s[36:37], s40
    s_load_dwordx2 s[14:15], s[36:37], 4096
    s_add_u32 s49, s40, 8192

    s_and_b32 s46, s3, 3
    s_lshr_b32 s47, s3, 2
    v_and_b32 v1, 63, v0
    v_lshrrev_b32 v2, 4, v1
    v_and_b32 v3, 15, v1
    s_lshl_b32 s40, s46, 3
    v_lshrrev_b32 v4, 1, v3
    v_add_u32 v4, s40, v4
    v_and_b32 v5, 1, v3
    v_cvt_f32_u32 v59, v5
    v_mul_f32 v59, 0x3e800000, v59
    v_lshl_add_u32 v5, v4, 1, v5
    v_cmp_eq_u32 vcc, 1, v5
    s_nop 1
    v_cndmask_b32 v4, v4, 32, vcc
    v_cndmask_b32 v59, v59, 0, vcc
    v_cvt_f32_u32 v58, v4
    v_mul_f32 v58, 0x3c800000, v58
    v_lshlrev_b32 v4, 3, v2
    v_cvt_f32_u32 v4, v4
    v_fma_f32 v59, v58, v4, v59

    v_fmamk_f32 v60, v58, 0x0, v59
    v_fmamk_f32 v61, v58, 0x3f800000, v59
    v_fmamk_f32 v62, v58, 0x40000000, v59
    v_fmamk_f32 v63, v58, 0x40400000, v59
    v_fmamk_f32 v64, v58, 0x40800000, v59
    v_fmamk_f32 v65, v58, 0x40a00000, v59
    v_fmamk_f32 v66, v58, 0x40c00000, v59
    v_fmamk_f32 v67, v58, 0x40e00000, v59
    v_cos_f32 v60, v60
    v_cos_f32 v61, v61
    v_cos_f32 v62, v62
    v_cos_f32 v63, v63
    v_cos_f32 v64, v64
    v_cos_f32 v65, v65
    v_cos_f32 v66, v66
    v_cos_f32 v67, v67
    v_cvt_pk_bf16_f32 v50, v60, v61
    v_cvt_pk_bf16_f32 v51, v62, v63
    v_cvt_pk_bf16_f32 v52, v64, v65
    v_cvt_pk_bf16_f32 v53, v66, v67
    v_fmamk_f32 v60, v58, 0x42000000, v59
    v_fmamk_f32 v61, v58, 0x42040000, v59
    v_fmamk_f32 v62, v58, 0x42080000, v59
    v_fmamk_f32 v63, v58, 0x420c0000, v59
    v_fmamk_f32 v64, v58, 0x42100000, v59
    v_fmamk_f32 v65, v58, 0x42140000, v59
    v_fmamk_f32 v66, v58, 0x42180000, v59
    v_fmamk_f32 v67, v58, 0x421c0000, v59
    v_cos_f32 v60, v60
    v_cos_f32 v61, v61
    v_cos_f32 v62, v62
    v_cos_f32 v63, v63
    v_cos_f32 v64, v64
    v_cos_f32 v65, v65
    v_cos_f32 v66, v66
    v_cos_f32 v67, v67
    v_cvt_pk_bf16_f32 v54, v60, v61
    v_cvt_pk_bf16_f32 v55, v62, v63
    v_cvt_pk_bf16_f32 v56, v64, v65
    v_cvt_pk_bf16_f32 v57, v66, v67
    v_lshrrev_b32 v4, 4, v0
    v_and_b32 v5, 3, v4
    v_lshlrev_b32 v5, 6, v5
    v_lshlrev_b32 v68, 1, v6
    v_xor_b32 v68, v68, v5
    v_bfe_u32 v5, v4, 3, 1
    v_lshl_add_u32 v68, v5, 4, v68
    v_lshl_add_u32 v68, v4, 9, v68
    v_xor_b32 v69, 16, v68
    v_lshrrev_b32 v4, 2, v3
    v_lshl_add_u32 v5, v2, 3, v4
    v_lshlrev_b32 v5, 9, v5
    v_lshl_add_u32 v5, v4, 6, v5
    v_and_b32 v4, 1, v1
    v_lshl_add_u32 v5, v4, 5, v5
    v_bfe_u32 v4, v1, 1, 1
    v_lshl_add_u32 v5, v4, 3, v5
    v_and_b32 v4, 1, v2
    v_xor_b32 v4, s47, v4
    v_lshl_add_u32 v71, v4, 4, v5
    v_xor_b32 v72, 64, v71
    v_xor_b32 v73, 128, v71
    v_xor_b32 v74, 192, v71
    v_lshlrev_b32 v70, 16, v2
    v_lshrrev_b32 v4, 3, v3
    v_lshl_add_u32 v70, v4, 13, v70
    v_and_b32 v4, 7, v3
    v_lshl_add_u32 v70, v4, 4, v70
    s_waitcnt lgkmcnt(0)

    s_add_u32 s12, s10, 0x5a3c9671
    s_xor_b32 s13, s11, 0x2b7e1516
    s_add_u32 s50, s14, 0x5a3c9671
    s_xor_b32 s51, s15, 0x2b7e1516
    v_cmp_eq_u32 vcc, 0, v6
    s_waitcnt vmcnt(6)
    s_nop 0
    v_cndmask_b32 v30, v30, v14, vcc
    v_lshlrev_b32 v76, 16, v14
    v_lshlrev_b32 v92, 16, v30
    v_and_b32 v77, 0xffff0000, v14
    v_and_b32 v93, 0xffff0000, v21
    v_pk_add_f32 v[76:77], v[76:77], v[92:93]
    v_lshlrev_b32 v84, 16, v26
    v_lshlrev_b32 v92, 16, v31
    v_and_b32 v85, 0xffff0000, v26
    v_and_b32 v93, 0xffff0000, v25
    v_pk_add_f32 v[84:85], v[84:85], v[92:93]
    v_lshlrev_b32 v78, 16, v15
    v_lshlrev_b32 v92, 16, v21
    v_and_b32 v79, 0xffff0000, v15
    v_and_b32 v93, 0xffff0000, v20
    v_pk_add_f32 v[78:79], v[78:79], v[92:93]
    v_lshlrev_b32 v86, 16, v27
    v_lshlrev_b32 v92, 16, v25
    v_and_b32 v87, 0xffff0000, v27
    v_and_b32 v93, 0xffff0000, v24
    v_pk_add_f32 v[86:87], v[86:87], v[92:93]
    v_lshlrev_b32 v80, 16, v16
    v_lshlrev_b32 v92, 16, v20
    v_and_b32 v81, 0xffff0000, v16
    v_and_b32 v93, 0xffff0000, v19
    v_pk_add_f32 v[80:81], v[80:81], v[92:93]
    v_lshlrev_b32 v88, 16, v28
    v_lshlrev_b32 v92, 16, v24
    v_and_b32 v89, 0xffff0000, v28
    v_and_b32 v93, 0xffff0000, v23
    v_pk_add_f32 v[88:89], v[88:89], v[92:93]
    v_lshlrev_b32 v82, 16, v17
    v_lshlrev_b32 v92, 16, v19
    v_and_b32 v83, 0xffff0000, v17
    v_and_b32 v93, 0xffff0000, v18
    v_pk_add_f32 v[82:83], v[82:83], v[92:93]
    v_lshlrev_b32 v90, 16, v29
    v_lshlrev_b32 v92, 16, v23
    v_and_b32 v91, 0xffff0000, v29
    v_and_b32 v93, 0xffff0000, v22
    v_pk_add_f32 v[90:91], v[90:91], v[92:93]
    v_pk_add_f32 v[60:61], v[76:77], v[84:85]
    v_pk_add_f32 v[76:77], v[76:77], v[84:85] neg_lo:[0,1] neg_hi:[0,1]
    v_pk_add_f32 v[62:63], v[78:79], v[86:87]
    v_pk_add_f32 v[78:79], v[78:79], v[86:87] neg_lo:[0,1] neg_hi:[0,1]
    v_pk_add_f32 v[64:65], v[80:81], v[88:89]
    v_pk_add_f32 v[80:81], v[80:81], v[88:89] neg_lo:[0,1] neg_hi:[0,1]
    v_pk_add_f32 v[66:67], v[82:83], v[90:91]
    v_pk_add_f32 v[82:83], v[82:83], v[90:91] neg_lo:[0,1] neg_hi:[0,1]
    v_cvt_pk_bf16_f32 v94, v60, v62
    v_cvt_pk_bf16_f32 v95, v64, v66
    v_cvt_pk_bf16_f32 v96, v61, v63
    v_cvt_pk_bf16_f32 v97, v65, v67
    ds_write_b128 v68, v[94:97] offset:0
    v_cvt_pk_bf16_f32 v98, v76, v78
    v_cvt_pk_bf16_f32 v99, v80, v82
    v_cvt_pk_bf16_f32 v100, v77, v79
    v_cvt_pk_bf16_f32 v101, v81, v83
    ds_write_b128 v69, v[98:101] offset:0
    s_waitcnt vmcnt(0)
    v_cndmask_b32 v48, v48, v32, vcc
    v_lshlrev_b32 v76, 16, v32
    v_lshlrev_b32 v92, 16, v48
    v_and_b32 v77, 0xffff0000, v32
    v_and_b32 v93, 0xffff0000, v39
    v_pk_add_f32 v[76:77], v[76:77], v[92:93]
    v_lshlrev_b32 v84, 16, v44
    v_lshlrev_b32 v92, 16, v49
    v_and_b32 v85, 0xffff0000, v44
    v_and_b32 v93, 0xffff0000, v43
    v_pk_add_f32 v[84:85], v[84:85], v[92:93]
    v_lshlrev_b32 v78, 16, v33
    v_lshlrev_b32 v92, 16, v39
    v_and_b32 v79, 0xffff0000, v33
    v_and_b32 v93, 0xffff0000, v38
    v_pk_add_f32 v[78:79], v[78:79], v[92:93]
    v_lshlrev_b32 v86, 16, v45
    v_lshlrev_b32 v92, 16, v43
    v_and_b32 v87, 0xffff0000, v45
    v_and_b32 v93, 0xffff0000, v42
    v_pk_add_f32 v[86:87], v[86:87], v[92:93]
    v_lshlrev_b32 v80, 16, v34
    v_lshlrev_b32 v92, 16, v38
    v_and_b32 v81, 0xffff0000, v34
    v_and_b32 v93, 0xffff0000, v37
    v_pk_add_f32 v[80:81], v[80:81], v[92:93]
    v_lshlrev_b32 v88, 16, v46
    v_lshlrev_b32 v92, 16, v42
    v_and_b32 v89, 0xffff0000, v46
    v_and_b32 v93, 0xffff0000, v41
    v_pk_add_f32 v[88:89], v[88:89], v[92:93]
    v_lshlrev_b32 v82, 16, v35
    v_lshlrev_b32 v92, 16, v37
    v_and_b32 v83, 0xffff0000, v35
    v_and_b32 v93, 0xffff0000, v36
    v_pk_add_f32 v[82:83], v[82:83], v[92:93]
    v_lshlrev_b32 v90, 16, v47
    v_lshlrev_b32 v92, 16, v41
    v_and_b32 v91, 0xffff0000, v47
    v_and_b32 v93, 0xffff0000, v40
    v_pk_add_f32 v[90:91], v[90:91], v[92:93]
    v_pk_add_f32 v[60:61], v[76:77], v[84:85]
    v_pk_add_f32 v[76:77], v[76:77], v[84:85] neg_lo:[0,1] neg_hi:[0,1]
    v_pk_add_f32 v[62:63], v[78:79], v[86:87]
    v_pk_add_f32 v[78:79], v[78:79], v[86:87] neg_lo:[0,1] neg_hi:[0,1]
    v_pk_add_f32 v[64:65], v[80:81], v[88:89]
    v_pk_add_f32 v[80:81], v[80:81], v[88:89] neg_lo:[0,1] neg_hi:[0,1]
    v_pk_add_f32 v[66:67], v[82:83], v[90:91]
    v_pk_add_f32 v[82:83], v[82:83], v[90:91] neg_lo:[0,1] neg_hi:[0,1]
    s_waitcnt lgkmcnt(0)
    v_cvt_pk_bf16_f32 v94, v60, v62
    v_cvt_pk_bf16_f32 v95, v64, v66
    v_cvt_pk_bf16_f32 v96, v61, v63
    v_cvt_pk_bf16_f32 v97, v65, v67
    ds_write_b128 v68, v[94:97] offset:16384
    v_cvt_pk_bf16_f32 v98, v76, v78
    v_cvt_pk_bf16_f32 v99, v80, v82
    v_cvt_pk_bf16_f32 v100, v77, v79
    v_cvt_pk_bf16_f32 v101, v81, v83
    ds_write_b128 v69, v[98:101] offset:16384
    s_cmp_lg_u32 s3, 7
    s_cbranch_scc1 S_nox
    s_getreg_b32 s40, hwreg(HW_REG_XCC_ID, 0, 3)
    s_add_u32 s40, s40, s12
    v_mov_b32 v102, s40
    v_mov_b32 v103, s13
    v_mov_b32 v104, 0
    s_lshl_b32 s40, s8, 7
    s_lshl_b32 s41, 7, 3
    s_add_u32 s40, s40, s41
    s_add_u32 s40, s40, 8192
    s_mov_b64 exec, 1
    buffer_store_dwordx2 v[102:103], v104, s[36:39], s40 offen sc1
    s_mov_b64 exec, -1

S_nox:
    s_waitcnt lgkmcnt(0)
    s_barrier
    ds_read_b64_tr_b16 v[102:103], v71 offset:0
    ds_read_b64_tr_b16 v[104:105], v71 offset:2048
    ds_read_b64_tr_b16 v[106:107], v71 offset:16384
    ds_read_b64_tr_b16 v[108:109], v71 offset:18432
    ds_read_b64_tr_b16 v[110:111], v72 offset:0
    ds_read_b64_tr_b16 v[112:113], v72 offset:2048
    ds_read_b64_tr_b16 v[114:115], v72 offset:16384
    ds_read_b64_tr_b16 v[116:117], v72 offset:18432
    ds_read_b64_tr_b16 v[118:119], v73 offset:0
    ds_read_b64_tr_b16 v[120:121], v73 offset:2048
    ds_read_b64_tr_b16 v[122:123], v73 offset:16384
    ds_read_b64_tr_b16 v[124:125], v73 offset:18432
    s_lshl_b32 s40, s46, 18
    s_lshl_b32 s41, s47, 14
    s_add_u32 s40, s40, s41
    s_lshl_b32 s41, s8, 7
    s_add_u32 s40, s40, s41
    s_add_u32 s40, s40, 1048576

    s_waitcnt lgkmcnt(8)
    v_mfma_f32_16x16x32_bf16 v[166:169], v[50:53], v[102:105], 0
    v_mfma_f32_16x16x32_bf16 v[166:169], v[54:57], v[106:109], v[166:169]
    ds_read_b64_tr_b16 v[126:127], v74 offset:0
    ds_read_b64_tr_b16 v[128:129], v74 offset:2048
    ds_read_b64_tr_b16 v[130:131], v74 offset:16384
    ds_read_b64_tr_b16 v[132:133], v74 offset:18432
    s_waitcnt lgkmcnt(8)
    v_mfma_f32_16x16x32_bf16 v[170:173], v[50:53], v[110:113], 0
    v_mfma_f32_16x16x32_bf16 v[170:173], v[54:57], v[114:117], v[170:173]
    ds_read_b64_tr_b16 v[134:135], v71 offset:256
    ds_read_b64_tr_b16 v[136:137], v71 offset:2304
    ds_read_b64_tr_b16 v[138:139], v71 offset:16640
    ds_read_b64_tr_b16 v[140:141], v71 offset:18688
    s_waitcnt lgkmcnt(8)
    v_mfma_f32_16x16x32_bf16 v[174:177], v[50:53], v[118:121], 0
    v_mfma_f32_16x16x32_bf16 v[174:177], v[54:57], v[122:125], v[174:177]
    ds_read_b64_tr_b16 v[142:143], v72 offset:256
    ds_read_b64_tr_b16 v[144:145], v72 offset:2304
    ds_read_b64_tr_b16 v[146:147], v72 offset:16640
    ds_read_b64_tr_b16 v[148:149], v72 offset:18688
    s_waitcnt lgkmcnt(8)
    v_mfma_f32_16x16x32_bf16 v[178:181], v[50:53], v[126:129], 0
    v_mfma_f32_16x16x32_bf16 v[178:181], v[54:57], v[130:133], v[178:181]
    ds_read_b64_tr_b16 v[150:151], v73 offset:256
    ds_read_b64_tr_b16 v[152:153], v73 offset:2304
    ds_read_b64_tr_b16 v[154:155], v73 offset:16640
    ds_read_b64_tr_b16 v[156:157], v73 offset:18688
    s_waitcnt lgkmcnt(8)
    v_mfma_f32_16x16x32_bf16 v[182:185], v[50:53], v[134:137], 0
    v_mfma_f32_16x16x32_bf16 v[182:185], v[54:57], v[138:141], v[182:185]
    ds_read_b64_tr_b16 v[158:159], v74 offset:256
    ds_read_b64_tr_b16 v[160:161], v74 offset:2304
    ds_read_b64_tr_b16 v[162:163], v74 offset:16640
    ds_read_b64_tr_b16 v[164:165], v74 offset:18688
    s_waitcnt lgkmcnt(8)
    v_mfma_f32_16x16x32_bf16 v[186:189], v[50:53], v[142:145], 0
    v_mfma_f32_16x16x32_bf16 v[186:189], v[54:57], v[146:149], v[186:189]
    s_waitcnt lgkmcnt(4)
    v_mfma_f32_16x16x32_bf16 v[190:193], v[50:53], v[150:153], 0
    v_mfma_f32_16x16x32_bf16 v[190:193], v[54:57], v[154:157], v[190:193]
    s_waitcnt lgkmcnt(0)
    v_mfma_f32_16x16x32_bf16 v[194:197], v[50:53], v[158:161], 0
    v_mfma_f32_16x16x32_bf16 v[194:197], v[54:57], v[162:165], v[194:197]
    v_cvt_pk_bf16_f32 v102, v166, v170
    v_cvt_pk_bf16_f32 v103, v174, v178
    v_cvt_pk_bf16_f32 v104, v182, v186
    s_nop 4
    v_cvt_pk_bf16_f32 v105, v190, v194
    s_add_u32 s41, s40, 0
    buffer_store_dwordx4 v[102:105], v70, s[36:39], s41 offen sc1
    v_cvt_pk_bf16_f32 v110, v167, v171
    v_cvt_pk_bf16_f32 v111, v175, v179
    v_cvt_pk_bf16_f32 v112, v183, v187
    v_cvt_pk_bf16_f32 v113, v191, v195
    s_add_u32 s41, s40, 4096
    buffer_store_dwordx4 v[110:113], v70, s[36:39], s41 offen sc1
    v_cvt_pk_bf16_f32 v118, v168, v172
    v_cvt_pk_bf16_f32 v119, v176, v180
    v_cvt_pk_bf16_f32 v120, v184, v188
    v_cvt_pk_bf16_f32 v121, v192, v196
    s_add_u32 s41, s40, 32768
    buffer_store_dwordx4 v[118:121], v70, s[36:39], s41 offen sc1
    v_cvt_pk_bf16_f32 v126, v169, v173
    v_cvt_pk_bf16_f32 v127, v177, v181
    v_cvt_pk_bf16_f32 v128, v185, v189
    v_cvt_pk_bf16_f32 v129, v193, v197
    s_add_u32 s41, s40, 36864
    buffer_store_dwordx4 v[126:129], v70, s[36:39], s41 offen sc1
    v_mov_b32 v198, s50
    v_mov_b32 v199, s51
    v_mov_b32 v200, 0
    s_lshl_b32 s40, s8, 7
    s_add_u32 s40, s40, 32768
    s_waitcnt vmcnt(0)

    s_barrier
    s_cmp_eq_u32 s3, 1
    s_cbranch_scc1 S_poll
    s_cmp_eq_u32 s3, 2
    s_cbranch_scc1 S_wo
    s_cmp_lg_u32 s3, 0
    s_cbranch_scc1 S_end
    s_mov_b64 exec, 1
    buffer_store_dwordx2 v[198:199], v200, s[36:39], s40 offen sc1
    s_branch S_end
        S_wo:
    v_lshlrev_b32 v4, 7, v1
    s_mul_i32 s40, s8, 12544
    buffer_load_dword v5, v4, s[24:27], s40 offen
    v_min_u32 v4, 4224, v4
    s_add_u32 s40, s40, 8192
    buffer_load_dword v5, v4, s[24:27], s40 offen
    s_branch S_end
        S_poll:
    v_and_b32 v201, 7, v1
    v_lshlrev_b32 v201, 3, v201

    buffer_load_dwordx2 v[202:203], v201, s[36:39], s49 offen sc1
    s_mov_b32 s44, 0
    s_getreg_b32 s40, hwreg(HW_REG_XCC_ID, 0, 3)
        X_lS:
    s_waitcnt vmcnt(0)
    v_subrev_u32 v202, s12, v202
    v_cmp_le_u32 vcc, 8, v202
    v_cmp_ne_u32 s[42:43], s13, v203
    s_nop 0
    s_or_b64 vcc, vcc, s[42:43]
    s_cbranch_vccz X_okS
    s_add_u32 s44, s44, 1
    s_cmp_gt_u32 s44, 200000
    s_cbranch_scc1 X_okS

    buffer_load_dwordx2 v[202:203], v201, s[36:39], s49 offen sc1
    s_branch X_lS
        X_okS:
    v_cmp_ne_u32 vcc, s40, v202
    s_nop 1
    s_cmp_eq_u64 vcc, 0
    s_cselect_b32 s48, 1, 0

    v_and_b32 v4, 31, v1
    v_lshlrev_b32 v4, 7, v4
    s_mov_b32 s40, 32768
    s_mov_b32 s44, 0
        S_pl:
    buffer_load_dwordx2 v[202:203], v4, s[36:39], s40 offen sc1
    s_add_u32 s44, s44, 1
    s_cmp_gt_u32 s44, 200000
    s_cbranch_scc1 S_pd
    s_waitcnt vmcnt(0)
    v_cmp_ne_u64 vcc, s[50:51], v[202:203]
    s_nop 0
    s_cbranch_vccnz S_pl
        S_pd:

    v_lshlrev_b32 v4, 7, v1
    s_lshl_b32 s40, s8, 15
    s_add_u32 s40, s40, 1048576
    buffer_load_dword v5, v4, s[36:39], s40 offen sc1
    s_add_u32 s40, s40, 8192
    buffer_load_dword v5, v4, s[36:39], s40 offen sc1
    s_add_u32 s40, s40, 8192
    buffer_load_dword v5, v4, s[36:39], s40 offen sc1
    s_add_u32 s40, s40, 8192
    buffer_load_dword v5, v4, s[36:39], s40 offen sc1
    s_add_u32 s40, s40, 8192
    v_mov_b32 v198, s12
    v_mov_b32 v199, s13
    s_waitcnt vmcnt(0)
    s_mov_b64 exec, 1
    s_cmp_eq_u32 s48, 0
    s_cbranch_scc1 SM_sR
    buffer_store_dwordx2 v[198:199], v200, s[36:39], s49 offen offset:64
SM_jR:
    s_cmp_lg_u32 s8, 0
    s_cbranch_scc1 S_end
    s_add_u32 s40, s14, 16
    v_mov_b32 v4, s40
    s_mov_b32 s40, 4096
    buffer_store_dword v4, v200, s[36:39], s40 offen
        S_end:

    s_endpgm
K_c:
    s_setprio 1
    s_lshl_b32 s40, s8, 7
    s_waitcnt lgkmcnt(0)
    s_load_dwordx2 s[10:11], s[36:37], s40
    s_add_u32 s50, s40, 8192
    s_sub_u32 s46, s3, 4
    s_lshr_b32 s47, s46, 1
    s_and_b32 s48, s46, 1
    v_and_b32 v1, 63, v0
    v_lshrrev_b32 v2, 4, v1
    v_and_b32 v3, 15, v1
    v_lshlrev_b32 v6, 4, v1
    v_lshrrev_b32 v4, 1, v3
    v_xor_b32 v4, v4, v2
    v_lshlrev_b32 v4, 4, v4
    v_lshl_add_u32 v4, v3, 7, v4
    s_lshl_b32 s40, s47, 12
    v_add_u32 v7, s40, v4
    v_xor_b32 v8, 64, v7
    v_add_u32 v9, 40960, v7
    v_add_u32 v10, 40960, v8
    v_lshrrev_b32 v4, 2, v3
    v_lshl_add_u32 v4, v2, 3, v4
    v_lshlrev_b32 v4, 7, v4
    v_and_b32 v5, 3, v1
    v_lshl_add_u32 v4, v5, 3, v4
    v_bfe_u32 v5, v1, 3, 2
    s_lshl_b32 s40, s48, 1
    v_xor_b32 v5, s40, v5
    v_lshl_add_u32 v4, v5, 5, v4
    v_add_u32 v11, 71680, v4
    v_xor_b32 v12, 32, v11
    v_add_u32 v13, 49152, v11
    v_add_u32 v14, 49152, v12
    v_and_b32 v4, 1, v3
    v_cmp_eq_u32 s[56:57], 1, v4
    v_lshl_add_u32 v4, v2, 2, v4
    v_cmp_le_u32 s[58:59], v4, v3
    v_add_u32 v4, 2, v4
    v_cmp_le_u32 s[60:61], v4, v3
    v_mov_b32 v4, 0xffff
    v_mov_b32 v5, 0xffff0000
    v_cndmask_b32 v4, v4, v5, s[56:57]
    v_cndmask_b32 v15, v4, 0, s[58:59]
    v_cndmask_b32 v16, v4, 0, s[60:61]
    v_cndmask_b32 v17, 0, v4, s[58:59]
    v_cndmask_b32 v18, 0, v4, s[60:61]
    s_add_u32 s40, s8, s47
    s_cmp_eq_u32 s40, 0
    s_cselect_b64 s[62:63], -1, 0
    s_lshl_b32 s40, s7, 1
    s_add_u32 s40, s40, s48
    s_lshl_b32 s55, s40, 10
    s_lshl_b32 s45, s40, 3
    s_cmp_eq_u32 s40, 0
    s_cselect_b32 s53, 1, 0
    s_cmp_eq_u32 s40, 13
    s_cselect_b32 s53, 1, s53
    s_cmp_ge_u32 s40, 7
    s_cselect_b32 s41, 14, 7
    s_sub_u32 s40, s41, s40
    v_cmp_gt_u32 s[100:101], s40, v2
    v_add_u32 v4, 4, v2
    v_cmp_gt_u32 s[14:15], s40, v4
    s_cmp_eq_u32 s48, 0
    s_cselect_b64 s[42:43], -1, 0
    s_xor_b64 s[100:101], s[100:101], s[42:43]
    s_xor_b64 s[14:15], s[14:15], s[42:43]
    s_cmp_eq_u32 s7, 3
    s_cselect_b32 s40, 0, 1.0
    v_mov_b32 v24, s40
    v_mov_b32 v25, 0xf149f2ca
    v_mov_b32 v30, 0xffffff00
    s_mov_b32 s54, 0x3e8b97f6
    v_and_b32 v19, 7, v1
    v_lshlrev_b32 v19, 3, v19
    s_mul_i32 s40, s8, 28
    s_lshl_b32 s41, s7, 2
    s_add_u32 s40, s40, s41
    s_add_u32 s40, s40, s46
    s_lshl_b32 s52, s40, 10
    s_add_u32 s52, s52, 65536
    s_mul_i32 s41, s48, 6144
    s_sub_u32 s41, s41, 3072
    s_add_u32 s51, s52, s41
    s_lshl_b32 s40, s8, 2
    s_lshl_b32 s41, s47, 1
    s_add_u32 s40, s40, s41
    s_mul_i32 s41, s40, 14336
    s_add_u32 s55, s55, s41
    s_add_u32 s55, s55, 2097152
    s_lshl_b32 s40, s40, 6
    s_add_u32 s40, s40, 16384
    s_add_u32 s45, s45, s40
    v_and_b32 v4, 7, v1
    v_lshlrev_b32 v4, 7, v4
    v_bfe_u32 v5, v1, 3, 1
    v_mul_u32_u24 v5, 14336, v5
    v_add3_u32 v31, v4, v5, s55
    v_mov_b32 v4, s40
    v_cmp_le_u32 vcc, 16, v1
    s_nop 1
    v_cndmask_b32 v31, v31, v4, vcc
    s_lshl_b32 s40, s46, 10
    v_add_u32 v22, s40, v6
    v_add_u32 v22, 153600, v22
    v_xor_b32 v23, 1024, v22
    v_mov_b32 v4, 161792
    v_mov_b32 v5, 0
    ds_write_b32 v4, v5
    s_waitcnt lgkmcnt(0)

    s_add_u32 s12, s10, 0x5a3c9671
    s_xor_b32 s13, s11, 0x2b7e1516
    s_bfe_u32 s40, s12, 0x80000
    v_mov_b32 v26, s40
    s_bfe_u32 s40, s12, 0x80008
    v_mov_b32 v27, s40
    s_bfe_u32 s40, s12, 0x80010
    v_mov_b32 v28, s40
    s_bfe_u32 s40, s12, 0x80018
    v_mov_b32 v29, s40
    s_cmp_lg_u32 s46, 0
    s_cbranch_scc1 C_nox
    s_getreg_b32 s40, hwreg(HW_REG_XCC_ID, 0, 3)
    s_add_u32 s40, s40, s12
    v_mov_b32 v34, s40
    v_mov_b32 v35, s13
    v_mov_b32 v36, 0
    s_lshl_b32 s40, s8, 7
    s_lshl_b32 s41, s7, 3
    s_add_u32 s40, s40, s41
    s_add_u32 s40, s40, 8192
    s_mov_b64 exec, 1
    buffer_store_dwordx2 v[34:35], v36, s[36:39], s40 offen sc1
    s_mov_b64 exec, -1

C_nox:
    s_barrier
    ds_read_b128 v[98:101], v7 offset:0
    ds_read_b128 v[102:105], v7 offset:2048
    ds_read_b128 v[106:109], v7 offset:4096
    ds_read_b64_tr_b16 v[122:123], v11 offset:0
    ds_read_b64_tr_b16 v[124:125], v11 offset:512
    ds_read_b64_tr_b16 v[126:127], v12 offset:0
    ds_read_b64_tr_b16 v[128:129], v12 offset:512
    ds_read_b64_tr_b16 v[130:131], v11 offset:8192
    ds_read_b64_tr_b16 v[132:133], v11 offset:8704
    ds_read_b64_tr_b16 v[134:135], v12 offset:8192
    ds_read_b64_tr_b16 v[136:137], v12 offset:8704
    ds_read_b64_tr_b16 v[138:139], v11 offset:16384
    ds_read_b64_tr_b16 v[140:141], v11 offset:16896
    ds_read_b64_tr_b16 v[142:143], v12 offset:16384
    ds_read_b64_tr_b16 v[144:145], v12 offset:16896
    s_waitcnt lgkmcnt(0)
    v_mfma_f32_16x16x32_bf16 v[34:37], v[122:125], v[102:105], 0
    v_mfma_f32_16x16x32_bf16 v[42:45], v[122:125], v[106:109], 0
    ds_read_b128 v[110:113], v8 offset:0
    v_mfma_f32_16x16x32_bf16 v[38:41], v[126:129], v[102:105], 0
    ds_read_b128 v[114:117], v8 offset:2048
    v_mfma_f32_16x16x32_bf16 v[46:49], v[126:129], v[106:109], 0
    ds_read_b128 v[118:121], v8 offset:4096
    v_mfma_f32_16x16x32_bf16 v[50:53], v[130:133], v[98:101], 0
    ds_read_b64_tr_b16 v[146:147], v11 offset:4096
    v_mfma_f32_16x16x32_bf16 v[58:61], v[130:133], v[102:105], 0
    ds_read_b64_tr_b16 v[148:149], v11 offset:4608
    v_mfma_f32_16x16x32_bf16 v[66:69], v[130:133], v[106:109], 0
    ds_read_b64_tr_b16 v[150:151], v12 offset:4096
    v_mfma_f32_16x16x32_bf16 v[54:57], v[134:137], v[98:101], 0
    ds_read_b64_tr_b16 v[152:153], v12 offset:4608
    v_mfma_f32_16x16x32_bf16 v[62:65], v[134:137], v[102:105], 0
    ds_read_b64_tr_b16 v[154:155], v11 offset:12288
    v_mfma_f32_16x16x32_bf16 v[70:73], v[134:137], v[106:109], 0
    ds_read_b64_tr_b16 v[156:157], v11 offset:12800
    v_mfma_f32_16x16x32_bf16 v[74:77], v[98:101], v[138:141], 0
    ds_read_b64_tr_b16 v[158:159], v12 offset:12288
    v_mfma_f32_16x16x32_bf16 v[82:85], v[102:105], v[138:141], 0
    ds_read_b64_tr_b16 v[160:161], v12 offset:12800
    v_mfma_f32_16x16x32_bf16 v[90:93], v[106:109], v[138:141], 0
    ds_read_b64_tr_b16 v[162:163], v11 offset:20480
    v_mfma_f32_16x16x32_bf16 v[78:81], v[98:101], v[142:145], 0
    ds_read_b64_tr_b16 v[164:165], v11 offset:20992
    v_mfma_f32_16x16x32_bf16 v[86:89], v[102:105], v[142:145], 0
    ds_read_b64_tr_b16 v[166:167], v12 offset:20480
    v_mfma_f32_16x16x32_bf16 v[94:97], v[106:109], v[142:145], 0
    ds_read_b64_tr_b16 v[168:169], v12 offset:20992
    s_waitcnt lgkmcnt(0)
    s_barrier
    buffer_load_dwordx4 v[210:213], v6, s[36:39], s52 offen sc1
    v_mfma_f32_16x16x32_bf16 v[34:37], v[146:149], v[114:117], v[34:37]
    v_mfma_f32_16x16x32_bf16 v[42:45], v[146:149], v[118:121], v[42:45]
    ds_read_b128 v[98:101], v7 offset:10240
    v_mfma_f32_16x16x32_bf16 v[38:41], v[150:153], v[114:117], v[38:41]
    ds_read_b128 v[102:105], v7 offset:12288
    v_mfma_f32_16x16x32_bf16 v[46:49], v[150:153], v[118:121], v[46:49]
    ds_read_b128 v[106:109], v7 offset:14336
    v_mfma_f32_16x16x32_bf16 v[50:53], v[154:157], v[110:113], v[50:53]
    ds_read_b64_tr_b16 v[122:123], v11 offset:24576
    v_mfma_f32_16x16x32_bf16 v[58:61], v[154:157], v[114:117], v[58:61]
    ds_read_b64_tr_b16 v[124:125], v11 offset:25088
    v_mfma_f32_16x16x32_bf16 v[66:69], v[154:157], v[118:121], v[66:69]
    ds_read_b64_tr_b16 v[126:127], v12 offset:24576
    v_mfma_f32_16x16x32_bf16 v[54:57], v[158:161], v[110:113], v[54:57]
    ds_read_b64_tr_b16 v[128:129], v12 offset:25088
    v_mfma_f32_16x16x32_bf16 v[62:65], v[158:161], v[114:117], v[62:65]
    ds_read_b64_tr_b16 v[130:131], v11 offset:32768
    v_mfma_f32_16x16x32_bf16 v[70:73], v[158:161], v[118:121], v[70:73]
    ds_read_b64_tr_b16 v[132:133], v11 offset:33280
    v_mfma_f32_16x16x32_bf16 v[74:77], v[110:113], v[162:165], v[74:77]
    ds_read_b64_tr_b16 v[134:135], v12 offset:32768
    v_mfma_f32_16x16x32_bf16 v[82:85], v[114:117], v[162:165], v[82:85]
    ds_read_b64_tr_b16 v[136:137], v12 offset:33280
    v_mfma_f32_16x16x32_bf16 v[90:93], v[118:121], v[162:165], v[90:93]
    ds_read_b64_tr_b16 v[138:139], v11 offset:40960
    v_mfma_f32_16x16x32_bf16 v[78:81], v[110:113], v[166:169], v[78:81]
    ds_read_b64_tr_b16 v[140:141], v11 offset:41472
    v_mfma_f32_16x16x32_bf16 v[86:89], v[114:117], v[166:169], v[86:89]
    ds_read_b64_tr_b16 v[142:143], v12 offset:40960
    v_mfma_f32_16x16x32_bf16 v[94:97], v[118:121], v[166:169], v[94:97]
    ds_read_b64_tr_b16 v[144:145], v12 offset:41472
    s_waitcnt lgkmcnt(0)
    v_mfma_f32_16x16x32_bf16 v[34:37], v[122:125], v[102:105], v[34:37]
    v_mfma_f32_16x16x32_bf16 v[42:45], v[122:125], v[106:109], v[42:45]
    ds_read_b128 v[110:113], v8 offset:10240
    v_mfma_f32_16x16x32_bf16 v[38:41], v[126:129], v[102:105], v[38:41]
    ds_read_b128 v[114:117], v8 offset:12288
    v_mfma_f32_16x16x32_bf16 v[46:49], v[126:129], v[106:109], v[46:49]
    ds_read_b128 v[118:121], v8 offset:14336
    v_mfma_f32_16x16x32_bf16 v[50:53], v[130:133], v[98:101], v[50:53]
    ds_read_b64_tr_b16 v[146:147], v11 offset:28672
    v_mfma_f32_16x16x32_bf16 v[58:61], v[130:133], v[102:105], v[58:61]
    ds_read_b64_tr_b16 v[148:149], v11 offset:29184
    v_mfma_f32_16x16x32_bf16 v[66:69], v[130:133], v[106:109], v[66:69]
    ds_read_b64_tr_b16 v[150:151], v12 offset:28672
    v_mfma_f32_16x16x32_bf16 v[54:57], v[134:137], v[98:101], v[54:57]
    ds_read_b64_tr_b16 v[152:153], v12 offset:29184
    v_mfma_f32_16x16x32_bf16 v[62:65], v[134:137], v[102:105], v[62:65]
    ds_read_b64_tr_b16 v[154:155], v11 offset:36864
    v_mfma_f32_16x16x32_bf16 v[70:73], v[134:137], v[106:109], v[70:73]
    ds_read_b64_tr_b16 v[156:157], v11 offset:37376
    v_mfma_f32_16x16x32_bf16 v[74:77], v[98:101], v[138:141], v[74:77]
    ds_read_b64_tr_b16 v[158:159], v12 offset:36864
    v_mfma_f32_16x16x32_bf16 v[82:85], v[102:105], v[138:141], v[82:85]
    ds_read_b64_tr_b16 v[160:161], v12 offset:37376
    v_mfma_f32_16x16x32_bf16 v[90:93], v[106:109], v[138:141], v[90:93]
    ds_read_b64_tr_b16 v[162:163], v11 offset:45056
    v_mfma_f32_16x16x32_bf16 v[78:81], v[98:101], v[142:145], v[78:81]
    ds_read_b64_tr_b16 v[164:165], v11 offset:45568
    v_mfma_f32_16x16x32_bf16 v[86:89], v[102:105], v[142:145], v[86:89]
    ds_read_b64_tr_b16 v[166:167], v12 offset:45056
    v_mfma_f32_16x16x32_bf16 v[94:97], v[106:109], v[142:145], v[94:97]
    ds_read_b64_tr_b16 v[168:169], v12 offset:45568
    s_waitcnt lgkmcnt(0)
    s_barrier
    v_mfma_f32_16x16x32_bf16 v[34:37], v[146:149], v[114:117], v[34:37]
    v_mfma_f32_16x16x32_bf16 v[42:45], v[146:149], v[118:121], v[42:45]
    ds_read_b128 v[98:101], v7 offset:20480
    v_mfma_f32_16x16x32_bf16 v[38:41], v[150:153], v[114:117], v[38:41]
    ds_read_b128 v[102:105], v7 offset:22528
    v_mfma_f32_16x16x32_bf16 v[46:49], v[150:153], v[118:121], v[46:49]
    v_mfma_f32_16x16x32_bf16 v[50:53], v[154:157], v[110:113], v[50:53]
    ds_read_b128 v[106:109], v7 offset:24576
    v_mfma_f32_16x16x32_bf16 v[58:61], v[154:157], v[114:117], v[58:61]
    ds_read_b64_tr_b16 v[122:123], v13 offset:0
    v_mfma_f32_16x16x32_bf16 v[66:69], v[154:157], v[118:121], v[66:69]
    v_mfma_f32_16x16x32_bf16 v[54:57], v[158:161], v[110:113], v[54:57]
    ds_read_b64_tr_b16 v[124:125], v13 offset:512
    v_mfma_f32_16x16x32_bf16 v[62:65], v[158:161], v[114:117], v[62:65]
    ds_read_b64_tr_b16 v[126:127], v14 offset:0
    v_mfma_f32_16x16x32_bf16 v[70:73], v[158:161], v[118:121], v[70:73]
    v_mfma_f32_16x16x32_bf16 v[74:77], v[110:113], v[162:165], v[74:77]
    ds_read_b64_tr_b16 v[128:129], v14 offset:512
    v_mfma_f32_16x16x32_bf16 v[82:85], v[114:117], v[162:165], v[82:85]
    ds_read_b64_tr_b16 v[130:131], v13 offset:8192
    v_mfma_f32_16x16x32_bf16 v[90:93], v[118:121], v[162:165], v[90:93]
    v_mfma_f32_16x16x32_bf16 v[78:81], v[110:113], v[166:169], v[78:81]
    ds_read_b64_tr_b16 v[132:133], v13 offset:8704
    v_mfma_f32_16x16x32_bf16 v[86:89], v[114:117], v[166:169], v[86:89]
    ds_read_b64_tr_b16 v[134:135], v14 offset:8192
    v_mfma_f32_16x16x32_bf16 v[94:97], v[118:121], v[166:169], v[94:97]
    ds_read_b64_tr_b16 v[136:137], v14 offset:8704
    s_waitcnt lgkmcnt(0)
    v_mfma_f32_16x16x32_bf16 v[34:37], v[122:125], v[102:105], v[34:37]
    ds_read_b128 v[110:113], v8 offset:20480
    v_mfma_f32_16x16x32_bf16 v[42:45], v[122:125], v[106:109], v[42:45]
    ds_read_b128 v[114:117], v8 offset:22528
    v_mfma_f32_16x16x32_bf16 v[38:41], v[126:129], v[102:105], v[38:41]
    ds_read_b128 v[118:121], v8 offset:24576
    v_mfma_f32_16x16x32_bf16 v[46:49], v[126:129], v[106:109], v[46:49]
    ds_read_b64_tr_b16 v[146:147], v13 offset:4096
    v_mfma_f32_16x16x32_bf16 v[50:53], v[130:133], v[98:101], v[50:53]
    ds_read_b64_tr_b16 v[148:149], v13 offset:4608
    v_mfma_f32_16x16x32_bf16 v[58:61], v[130:133], v[102:105], v[58:61]
    ds_read_b64_tr_b16 v[150:151], v14 offset:4096
    v_mfma_f32_16x16x32_bf16 v[66:69], v[130:133], v[106:109], v[66:69]
    ds_read_b64_tr_b16 v[152:153], v14 offset:4608
    v_mfma_f32_16x16x32_bf16 v[54:57], v[134:137], v[98:101], v[54:57]
    ds_read_b64_tr_b16 v[154:155], v13 offset:12288
    v_mfma_f32_16x16x32_bf16 v[62:65], v[134:137], v[102:105], v[62:65]
    ds_read_b64_tr_b16 v[156:157], v13 offset:12800
    v_mfma_f32_16x16x32_bf16 v[70:73], v[134:137], v[106:109], v[70:73]
    ds_read_b64_tr_b16 v[158:159], v14 offset:12288
    ds_read_b64_tr_b16 v[160:161], v14 offset:12800
    s_waitcnt lgkmcnt(0)
    s_barrier
    v_mfma_f32_16x16x32_bf16 v[34:37], v[146:149], v[114:117], v[34:37]
    ds_read_b128 v[98:101], v7 offset:30720
    v_mfma_f32_16x16x32_bf16 v[42:45], v[146:149], v[118:121], v[42:45]
    ds_read_b128 v[102:105], v7 offset:32768
    v_mfma_f32_16x16x32_bf16 v[38:41], v[150:153], v[114:117], v[38:41]
    ds_read_b128 v[106:109], v7 offset:34816
    v_mfma_f32_16x16x32_bf16 v[46:49], v[150:153], v[118:121], v[46:49]
    ds_read_b64_tr_b16 v[122:123], v13 offset:16384
    v_mfma_f32_16x16x32_bf16 v[50:53], v[154:157], v[110:113], v[50:53]
    ds_read_b64_tr_b16 v[124:125], v13 offset:16896
    v_mfma_f32_16x16x32_bf16 v[58:61], v[154:157], v[114:117], v[58:61]
    ds_read_b64_tr_b16 v[126:127], v14 offset:16384
    v_mfma_f32_16x16x32_bf16 v[66:69], v[154:157], v[118:121], v[66:69]
    ds_read_b64_tr_b16 v[128:129], v14 offset:16896
    v_mfma_f32_16x16x32_bf16 v[54:57], v[158:161], v[110:113], v[54:57]
    ds_read_b64_tr_b16 v[130:131], v13 offset:24576
    v_mfma_f32_16x16x32_bf16 v[62:65], v[158:161], v[114:117], v[62:65]
    ds_read_b64_tr_b16 v[132:133], v13 offset:25088
    v_mfma_f32_16x16x32_bf16 v[70:73], v[158:161], v[118:121], v[70:73]
    ds_read_b64_tr_b16 v[134:135], v14 offset:24576
    ds_read_b64_tr_b16 v[136:137], v14 offset:25088
    s_waitcnt lgkmcnt(0)
    v_mfma_f32_16x16x32_bf16 v[34:37], v[122:125], v[102:105], v[34:37]
    ds_read_b128 v[110:113], v8 offset:30720
    v_mfma_f32_16x16x32_bf16 v[42:45], v[122:125], v[106:109], v[42:45]
    ds_read_b128 v[114:117], v8 offset:32768
    v_mfma_f32_16x16x32_bf16 v[38:41], v[126:129], v[102:105], v[38:41]
    ds_read_b128 v[118:121], v8 offset:34816
    v_mfma_f32_16x16x32_bf16 v[46:49], v[126:129], v[106:109], v[46:49]
    ds_read_b64_tr_b16 v[146:147], v13 offset:20480
    v_mfma_f32_16x16x32_bf16 v[50:53], v[130:133], v[98:101], v[50:53]
    ds_read_b64_tr_b16 v[148:149], v13 offset:20992
    v_mfma_f32_16x16x32_bf16 v[58:61], v[130:133], v[102:105], v[58:61]
    ds_read_b64_tr_b16 v[150:151], v14 offset:20480
    v_mfma_f32_16x16x32_bf16 v[66:69], v[130:133], v[106:109], v[66:69]
    ds_read_b64_tr_b16 v[152:153], v14 offset:20992
    v_mfma_f32_16x16x32_bf16 v[54:57], v[134:137], v[98:101], v[54:57]
    ds_read_b64_tr_b16 v[154:155], v13 offset:28672
    v_mfma_f32_16x16x32_bf16 v[62:65], v[134:137], v[102:105], v[62:65]
    ds_read_b64_tr_b16 v[156:157], v13 offset:29184
    v_mfma_f32_16x16x32_bf16 v[70:73], v[134:137], v[106:109], v[70:73]
    ds_read_b64_tr_b16 v[158:159], v14 offset:28672
    ds_read_b64_tr_b16 v[160:161], v14 offset:29184
    s_waitcnt lgkmcnt(0)
    s_barrier
    buffer_load_dwordx2 v[20:21], v19, s[36:39], s50 offen sc1
    v_mfma_f32_16x16x32_bf16 v[34:37], v[146:149], v[114:117], v[34:37]
    ds_read_b128 v[98:101], v9 offset:0
    v_mfma_f32_16x16x32_bf16 v[42:45], v[146:149], v[118:121], v[42:45]
    ds_read_b128 v[102:105], v9 offset:2048
    v_mfma_f32_16x16x32_bf16 v[38:41], v[150:153], v[114:117], v[38:41]
    ds_read_b128 v[106:109], v9 offset:4096
    v_mfma_f32_16x16x32_bf16 v[46:49], v[150:153], v[118:121], v[46:49]
    ds_read_b64_tr_b16 v[122:123], v13 offset:32768
    v_mfma_f32_16x16x32_bf16 v[50:53], v[154:157], v[110:113], v[50:53]
    ds_read_b64_tr_b16 v[124:125], v13 offset:33280
    v_mfma_f32_16x16x32_bf16 v[58:61], v[154:157], v[114:117], v[58:61]
    ds_read_b64_tr_b16 v[126:127], v14 offset:32768
    v_mfma_f32_16x16x32_bf16 v[66:69], v[154:157], v[118:121], v[66:69]
    ds_read_b64_tr_b16 v[128:129], v14 offset:33280
    v_mfma_f32_16x16x32_bf16 v[54:57], v[158:161], v[110:113], v[54:57]
    ds_read_b64_tr_b16 v[130:131], v11 offset:0
    v_mfma_f32_16x16x32_bf16 v[62:65], v[158:161], v[114:117], v[62:65]
    ds_read_b64_tr_b16 v[132:133], v11 offset:512
    v_mfma_f32_16x16x32_bf16 v[70:73], v[158:161], v[118:121], v[70:73]
    ds_read_b64_tr_b16 v[134:135], v12 offset:0
    ds_read_b64_tr_b16 v[136:137], v12 offset:512
    s_waitcnt lgkmcnt(0)
    v_mfma_f32_16x16x32_bf16 v[34:37], v[122:125], v[102:105], v[34:37]
    ds_read_b128 v[110:113], v10 offset:0
    v_mfma_f32_16x16x32_bf16 v[42:45], v[122:125], v[106:109], v[42:45]
    ds_read_b128 v[114:117], v10 offset:2048
    v_mfma_f32_16x16x32_bf16 v[38:41], v[126:129], v[102:105], v[38:41]
    ds_read_b128 v[118:121], v10 offset:4096
    v_mfma_f32_16x16x32_bf16 v[46:49], v[126:129], v[106:109], v[46:49]
    ds_read_b64_tr_b16 v[146:147], v13 offset:36864
    v_mfma_f32_16x16x32_bf16 v[50:53], v[130:133], v[98:101], v[50:53]
    ds_read_b64_tr_b16 v[148:149], v13 offset:37376
    v_mfma_f32_16x16x32_bf16 v[58:61], v[130:133], v[102:105], v[58:61]
    ds_read_b64_tr_b16 v[150:151], v14 offset:36864
    v_mfma_f32_16x16x32_bf16 v[66:69], v[130:133], v[106:109], v[66:69]
    ds_read_b64_tr_b16 v[152:153], v14 offset:37376
    v_mfma_f32_16x16x32_bf16 v[54:57], v[134:137], v[98:101], v[54:57]
    ds_read_b64_tr_b16 v[154:155], v11 offset:4096
    v_mfma_f32_16x16x32_bf16 v[62:65], v[134:137], v[102:105], v[62:65]
    ds_read_b64_tr_b16 v[156:157], v11 offset:4608
    v_mfma_f32_16x16x32_bf16 v[70:73], v[134:137], v[106:109], v[70:73]
    ds_read_b64_tr_b16 v[158:159], v12 offset:4096
    ds_read_b64_tr_b16 v[160:161], v12 offset:4608
    s_waitcnt lgkmcnt(0)
    s_barrier
    v_mfma_f32_16x16x32_bf16 v[34:37], v[146:149], v[114:117], v[34:37]
    ds_read_b128 v[98:101], v9 offset:10240
    v_mfma_f32_16x16x32_bf16 v[42:45], v[146:149], v[118:121], v[42:45]
    ds_read_b128 v[102:105], v9 offset:12288
    v_mfma_f32_16x16x32_bf16 v[38:41], v[150:153], v[114:117], v[38:41]
    ds_read_b128 v[106:109], v9 offset:14336
    v_mfma_f32_16x16x32_bf16 v[46:49], v[150:153], v[118:121], v[46:49]
    ds_read_b64_tr_b16 v[122:123], v11 offset:8192
    v_mfma_f32_16x16x32_bf16 v[50:53], v[154:157], v[110:113], v[50:53]
    ds_read_b64_tr_b16 v[124:125], v11 offset:8704
    v_mfma_f32_16x16x32_bf16 v[58:61], v[154:157], v[114:117], v[58:61]
    ds_read_b64_tr_b16 v[126:127], v12 offset:8192
    v_mfma_f32_16x16x32_bf16 v[66:69], v[154:157], v[118:121], v[66:69]
    ds_read_b64_tr_b16 v[128:129], v12 offset:8704
    v_mfma_f32_16x16x32_bf16 v[54:57], v[158:161], v[110:113], v[54:57]
    ds_read_b64_tr_b16 v[130:131], v11 offset:16384
    v_mfma_f32_16x16x32_bf16 v[62:65], v[158:161], v[114:117], v[62:65]
    ds_read_b64_tr_b16 v[132:133], v11 offset:16896
    v_mfma_f32_16x16x32_bf16 v[70:73], v[158:161], v[118:121], v[70:73]
    ds_read_b64_tr_b16 v[134:135], v12 offset:16384
    ds_read_b64_tr_b16 v[136:137], v12 offset:16896
    s_waitcnt lgkmcnt(0)
    v_mfma_f32_16x16x32_bf16 v[34:37], v[122:125], v[102:105], v[34:37]
    ds_read_b128 v[110:113], v10 offset:10240
    v_mfma_f32_16x16x32_bf16 v[42:45], v[122:125], v[106:109], v[42:45]
    ds_read_b128 v[114:117], v10 offset:12288
    v_mfma_f32_16x16x32_bf16 v[38:41], v[126:129], v[102:105], v[38:41]
    ds_read_b128 v[118:121], v10 offset:14336
    v_mfma_f32_16x16x32_bf16 v[46:49], v[126:129], v[106:109], v[46:49]
    ds_read_b64_tr_b16 v[146:147], v11 offset:12288
    v_mfma_f32_16x16x32_bf16 v[50:53], v[130:133], v[98:101], v[50:53]
    ds_read_b64_tr_b16 v[148:149], v11 offset:12800
    v_mfma_f32_16x16x32_bf16 v[58:61], v[130:133], v[102:105], v[58:61]
    ds_read_b64_tr_b16 v[150:151], v12 offset:12288
    v_mfma_f32_16x16x32_bf16 v[66:69], v[130:133], v[106:109], v[66:69]
    ds_read_b64_tr_b16 v[152:153], v12 offset:12800
    v_mfma_f32_16x16x32_bf16 v[54:57], v[134:137], v[98:101], v[54:57]
    ds_read_b64_tr_b16 v[154:155], v11 offset:20480
    v_mfma_f32_16x16x32_bf16 v[62:65], v[134:137], v[102:105], v[62:65]
    ds_read_b64_tr_b16 v[156:157], v11 offset:20992
    v_mfma_f32_16x16x32_bf16 v[70:73], v[134:137], v[106:109], v[70:73]
    ds_read_b64_tr_b16 v[158:159], v12 offset:20480
    ds_read_b64_tr_b16 v[160:161], v12 offset:20992
    s_waitcnt lgkmcnt(0)
    s_barrier
    s_mov_b32 s44, 0
    s_getreg_b32 s40, hwreg(HW_REG_XCC_ID, 0, 3)
        X_lC:
    s_waitcnt vmcnt(0)
    v_subrev_u32 v20, s12, v20
    v_cmp_le_u32 vcc, 8, v20
    v_cmp_ne_u32 s[42:43], s13, v21
    s_nop 0
    s_or_b64 vcc, vcc, s[42:43]
    s_cbranch_vccz X_okC
    s_add_u32 s44, s44, 1
    s_cmp_gt_u32 s44, 200000
    s_cbranch_scc1 X_okC

    buffer_load_dwordx2 v[20:21], v19, s[36:39], s50 offen sc1
    s_branch X_lC
        X_okC:
    v_cmp_ne_u32 vcc, s40, v20
    s_nop 1
    s_cmp_eq_u64 vcc, 0
    s_cselect_b32 s49, 1, 0

    v_mfma_f32_16x16x32_bf16 v[34:37], v[146:149], v[114:117], v[34:37]
    ds_read_b128 v[98:101], v9 offset:20480
    v_mfma_f32_16x16x32_bf16 v[42:45], v[146:149], v[118:121], v[42:45]
    ds_read_b128 v[102:105], v9 offset:22528
    v_mfma_f32_16x16x32_bf16 v[38:41], v[150:153], v[114:117], v[38:41]
    ds_read_b128 v[106:109], v9 offset:24576
    v_mfma_f32_16x16x32_bf16 v[46:49], v[150:153], v[118:121], v[46:49]
    ds_read_b64_tr_b16 v[122:123], v11 offset:24576
    v_mfma_f32_16x16x32_bf16 v[50:53], v[154:157], v[110:113], v[50:53]
    ds_read_b64_tr_b16 v[124:125], v11 offset:25088
    v_mfma_f32_16x16x32_bf16 v[58:61], v[154:157], v[114:117], v[58:61]
    ds_read_b64_tr_b16 v[126:127], v12 offset:24576
    v_mfma_f32_16x16x32_bf16 v[66:69], v[154:157], v[118:121], v[66:69]
    ds_read_b64_tr_b16 v[128:129], v12 offset:25088
    v_mfma_f32_16x16x32_bf16 v[54:57], v[158:161], v[110:113], v[54:57]
    ds_read_b64_tr_b16 v[130:131], v11 offset:32768
    v_mfma_f32_16x16x32_bf16 v[62:65], v[158:161], v[114:117], v[62:65]
    ds_read_b64_tr_b16 v[132:133], v11 offset:33280
    v_mfma_f32_16x16x32_bf16 v[70:73], v[158:161], v[118:121], v[70:73]
    ds_read_b64_tr_b16 v[134:135], v12 offset:32768
    ds_read_b64_tr_b16 v[136:137], v12 offset:33280
    s_waitcnt lgkmcnt(0)
    v_mfma_f32_16x16x32_bf16 v[34:37], v[122:125], v[102:105], v[34:37]
    ds_read_b128 v[110:113], v10 offset:20480
    v_mfma_f32_16x16x32_bf16 v[42:45], v[122:125], v[106:109], v[42:45]
    ds_read_b128 v[114:117], v10 offset:22528
    v_mfma_f32_16x16x32_bf16 v[38:41], v[126:129], v[102:105], v[38:41]
    ds_read_b128 v[118:121], v10 offset:24576
    v_mfma_f32_16x16x32_bf16 v[46:49], v[126:129], v[106:109], v[46:49]
    ds_read_b64_tr_b16 v[146:147], v11 offset:28672
    v_mfma_f32_16x16x32_bf16 v[50:53], v[130:133], v[98:101], v[50:53]
    ds_read_b64_tr_b16 v[148:149], v11 offset:29184
    v_mfma_f32_16x16x32_bf16 v[58:61], v[130:133], v[102:105], v[58:61]
    ds_read_b64_tr_b16 v[150:151], v12 offset:28672
    v_mfma_f32_16x16x32_bf16 v[66:69], v[130:133], v[106:109], v[66:69]
    ds_read_b64_tr_b16 v[152:153], v12 offset:29184
    v_mfma_f32_16x16x32_bf16 v[54:57], v[134:137], v[98:101], v[54:57]
    ds_read_b64_tr_b16 v[154:155], v11 offset:36864
    v_mfma_f32_16x16x32_bf16 v[62:65], v[134:137], v[102:105], v[62:65]
    ds_read_b64_tr_b16 v[156:157], v11 offset:37376
    v_mfma_f32_16x16x32_bf16 v[70:73], v[134:137], v[106:109], v[70:73]
    ds_read_b64_tr_b16 v[158:159], v12 offset:36864
    ds_read_b64_tr_b16 v[160:161], v12 offset:37376
    s_waitcnt lgkmcnt(0)
    v_mfma_f32_16x16x32_bf16 v[34:37], v[146:149], v[114:117], v[34:37]
    v_mfma_f32_16x16x32_bf16 v[42:45], v[146:149], v[118:121], v[42:45]
    v_mfma_f32_16x16x32_bf16 v[38:41], v[150:153], v[114:117], v[38:41]
    v_mfma_f32_16x16x32_bf16 v[46:49], v[150:153], v[118:121], v[46:49]
    v_mfma_f32_16x16x32_bf16 v[50:53], v[154:157], v[110:113], v[50:53]
    v_mfma_f32_16x16x32_bf16 v[58:61], v[154:157], v[114:117], v[58:61]
    v_mfma_f32_16x16x32_bf16 v[66:69], v[154:157], v[118:121], v[66:69]
    v_mfma_f32_16x16x32_bf16 v[54:57], v[158:161], v[110:113], v[54:57]
    v_mfma_f32_16x16x32_bf16 v[62:65], v[158:161], v[114:117], v[62:65]
    v_mfma_f32_16x16x32_bf16 v[70:73], v[158:161], v[118:121], v[70:73]
    v_cvt_pk_bf16_f32 v170, v34, v35
    v_cvt_pk_bf16_f32 v171, v36, v37
    v_cvt_pk_bf16_f32 v172, v38, v39
    v_cvt_pk_bf16_f32 v173, v40, v41
    v_cvt_pk_bf16_f32 v174, v42, v43
    v_cvt_pk_bf16_f32 v175, v44, v45
    v_cvt_pk_bf16_f32 v176, v46, v47
    v_cvt_pk_bf16_f32 v177, v48, v49
    v_cvt_pk_bf16_f32 v178, v50, v51
    v_cvt_pk_bf16_f32 v179, v52, v53
    v_cvt_pk_bf16_f32 v180, v54, v55
    v_cvt_pk_bf16_f32 v181, v56, v57
    v_cvt_pk_bf16_f32 v182, v58, v59
    v_cvt_pk_bf16_f32 v183, v60, v61
    v_cvt_pk_bf16_f32 v184, v62, v63
    v_cvt_pk_bf16_f32 v185, v64, v65
    v_cvt_pk_bf16_f32 v186, v66, v67
    v_cvt_pk_bf16_f32 v187, v68, v69
    v_cvt_pk_bf16_f32 v188, v70, v71
    v_cvt_pk_bf16_f32 v189, v72, v73
    v_cndmask_b32 v190, 0, v170, s[100:101]
    v_cndmask_b32 v170, v170, 0, s[100:101]
    v_cndmask_b32 v191, 0, v171, s[100:101]
    v_cndmask_b32 v171, v171, 0, s[100:101]
    v_cndmask_b32 v192, 0, v172, s[14:15]
    v_cndmask_b32 v172, v172, 0, s[14:15]
    v_cndmask_b32 v193, 0, v173, s[14:15]
    v_cndmask_b32 v173, v173, 0, s[14:15]
    v_cndmask_b32 v194, 0, v174, s[100:101]
    v_cndmask_b32 v174, v174, 0, s[100:101]
    v_cndmask_b32 v195, 0, v175, s[100:101]
    v_cndmask_b32 v175, v175, 0, s[100:101]
    v_cndmask_b32 v196, 0, v176, s[14:15]
    v_cndmask_b32 v176, v176, 0, s[14:15]
    v_cndmask_b32 v197, 0, v177, s[14:15]
    v_cndmask_b32 v177, v177, 0, s[14:15]
    v_mfma_f32_16x16x32_bf16 v[34:37], v[178:181], v[170:173], 0
    v_mfma_f32_16x16x32_bf16 v[38:41], v[182:185], v[170:173], 0
    v_mfma_f32_16x16x32_bf16 v[42:45], v[182:185], v[174:177], 0
    v_mfma_f32_16x16x32_bf16 v[46:49], v[186:189], v[174:177], 0
    v_mfma_f32_16x16x32_bf16 v[50:53], v[178:181], v[190:193], 0
    v_mfma_f32_16x16x32_bf16 v[54:57], v[182:185], v[190:193], 0
    v_mfma_f32_16x16x32_bf16 v[58:61], v[182:185], v[194:197], 0
    v_mfma_f32_16x16x32_bf16 v[62:65], v[186:189], v[194:197], 0
    s_nop 0
    v_cndmask_b32 v34, v34, v35, s[56:57]
    v_cndmask_b32 v36, v36, v37, s[56:57]
    v_cndmask_b32 v38, v38, v39, s[56:57]
    v_cndmask_b32 v40, v40, v41, s[56:57]

    v_cndmask_b32 v34, v34, v25, s[62:63]
    v_cndmask_b32 v36, v36, v25, s[62:63]
    v_cndmask_b32 v202, v34, v38, s[58:59]
    v_cndmask_b32 v203, v36, v40, s[60:61]
    v_cndmask_b32 v42, v42, v43, s[56:57]
    v_cndmask_b32 v44, v44, v45, s[56:57]
    v_cndmask_b32 v46, v46, v47, s[56:57]
    v_cndmask_b32 v48, v48, v49, s[56:57]

    v_cndmask_b32 v204, v42, v46, s[58:59]
    v_cndmask_b32 v205, v44, v48, s[60:61]
    v_and_or_b32 v66, v202, v30, v26
    v_and_or_b32 v67, v203, v30, v27
    v_and_or_b32 v68, v204, v30, v28
    v_and_or_b32 v69, v205, v30, v29
    s_cmp_lg_u32 s53, 0
    s_cbranch_scc1 SM_jS
    s_cmp_eq_u32 s49, 0
    s_cbranch_scc1 SM_sS
    buffer_store_dwordx4 v[66:69], v6, s[36:39], s51 offen
SM_jS:
    v_cndmask_b32 v50, v50, v51, s[56:57]
    v_cndmask_b32 v52, v52, v53, s[56:57]
    v_cndmask_b32 v54, v54, v55, s[56:57]
    v_cndmask_b32 v56, v56, v57, s[56:57]

    v_cndmask_b32 v50, v50, v25, s[62:63]
    v_cndmask_b32 v52, v52, v25, s[62:63]
    v_cndmask_b32 v198, v50, v54, s[58:59]
    v_cndmask_b32 v199, v52, v56, s[60:61]
    v_cndmask_b32 v58, v58, v59, s[56:57]
    v_cndmask_b32 v60, v60, v61, s[56:57]
    v_cndmask_b32 v62, v62, v63, s[56:57]
    v_cndmask_b32 v64, v64, v65, s[56:57]

    v_cndmask_b32 v200, v58, v62, s[58:59]
    v_cndmask_b32 v201, v60, v64, s[60:61]
    ds_write_b128 v22, v[198:201]
    s_waitcnt lgkmcnt(0)
    s_barrier
    ds_read_b128 v[206:209], v23
    ds_read_b128 v[98:101], v7 offset:20480
    ds_read_b128 v[102:105], v7 offset:22528
    ds_read_b128 v[106:109], v7 offset:24576
    ds_read_b64_tr_b16 v[138:139], v11 offset:40960
    ds_read_b64_tr_b16 v[140:141], v11 offset:41472
    ds_read_b64_tr_b16 v[142:143], v12 offset:40960
    ds_read_b64_tr_b16 v[144:145], v12 offset:41472
    s_waitcnt lgkmcnt(0)
    v_mfma_f32_16x16x32_bf16 v[74:77], v[98:101], v[138:141], v[74:77]
    ds_read_b128 v[110:113], v8 offset:20480
    ds_read_b128 v[114:117], v8 offset:22528
    v_mfma_f32_16x16x32_bf16 v[82:85], v[102:105], v[138:141], v[82:85]
    ds_read_b128 v[118:121], v8 offset:24576
    ds_read_b64_tr_b16 v[162:163], v11 offset:45056
    v_mfma_f32_16x16x32_bf16 v[90:93], v[106:109], v[138:141], v[90:93]
    ds_read_b64_tr_b16 v[164:165], v11 offset:45568
    ds_read_b64_tr_b16 v[166:167], v12 offset:45056
    v_mfma_f32_16x16x32_bf16 v[78:81], v[98:101], v[142:145], v[78:81]
    ds_read_b64_tr_b16 v[168:169], v12 offset:45568
    v_fma_f32 v198, v206, v24, v198
    v_mfma_f32_16x16x32_bf16 v[86:89], v[102:105], v[142:145], v[86:89]
    v_fma_f32 v199, v207, v24, v199
    v_fma_f32 v200, v208, v24, v200
    v_mfma_f32_16x16x32_bf16 v[94:97], v[106:109], v[142:145], v[94:97]
    v_fma_f32 v201, v209, v24, v201
    v_max_f32 v230, v198, v199
    v_max_f32 v231, v200, v201
    s_waitcnt lgkmcnt(0)
    v_mfma_f32_16x16x32_bf16 v[74:77], v[110:113], v[162:165], v[74:77]
    ds_read_b128 v[98:101], v7 offset:30720
    ds_read_b128 v[102:105], v7 offset:32768
    v_mfma_f32_16x16x32_bf16 v[82:85], v[114:117], v[162:165], v[82:85]
    ds_read_b128 v[106:109], v7 offset:34816
    ds_read_b64_tr_b16 v[138:139], v13 offset:0
    v_mfma_f32_16x16x32_bf16 v[90:93], v[118:121], v[162:165], v[90:93]
    ds_read_b64_tr_b16 v[140:141], v13 offset:512
    ds_read_b64_tr_b16 v[142:143], v14 offset:0
    v_mfma_f32_16x16x32_bf16 v[78:81], v[110:113], v[166:169], v[78:81]
    ds_read_b64_tr_b16 v[144:145], v14 offset:512
    v_mov_b32 v232, v230
    v_mfma_f32_16x16x32_bf16 v[86:89], v[114:117], v[166:169], v[86:89]
    v_mov_b32 v233, v231
    v_permlane16_swap_b32 v230, v232
    v_mfma_f32_16x16x32_bf16 v[94:97], v[118:121], v[166:169], v[94:97]
    v_permlane16_swap_b32 v231, v233
    v_max_f32 v230, v230, v232
    v_max_f32 v231, v231, v233
    s_waitcnt lgkmcnt(0)
    v_mfma_f32_16x16x32_bf16 v[74:77], v[98:101], v[138:141], v[74:77]
    ds_read_b128 v[110:113], v8 offset:30720
    ds_read_b128 v[114:117], v8 offset:32768
    v_mfma_f32_16x16x32_bf16 v[82:85], v[102:105], v[138:141], v[82:85]
    ds_read_b128 v[118:121], v8 offset:34816
    ds_read_b64_tr_b16 v[162:163], v13 offset:4096
    v_mfma_f32_16x16x32_bf16 v[90:93], v[106:109], v[138:141], v[90:93]
    ds_read_b64_tr_b16 v[164:165], v13 offset:4608
    ds_read_b64_tr_b16 v[166:167], v14 offset:4096
    v_mfma_f32_16x16x32_bf16 v[78:81], v[98:101], v[142:145], v[78:81]
    ds_read_b64_tr_b16 v[168:169], v14 offset:4608
    v_mov_b32 v232, v230
    v_mfma_f32_16x16x32_bf16 v[86:89], v[102:105], v[142:145], v[86:89]
    v_mov_b32 v233, v231
    v_permlane32_swap_b32 v230, v232
    v_mfma_f32_16x16x32_bf16 v[94:97], v[106:109], v[142:145], v[94:97]
    v_permlane32_swap_b32 v231, v233
    v_max_f32 v230, v230, v232
    v_max_f32 v231, v231, v233
    s_waitcnt lgkmcnt(0)
    s_barrier
    v_mfma_f32_16x16x32_bf16 v[74:77], v[110:113], v[162:165], v[74:77]
    ds_read_b128 v[98:101], v9 offset:0
    ds_read_b128 v[102:105], v9 offset:2048
    v_mfma_f32_16x16x32_bf16 v[82:85], v[114:117], v[162:165], v[82:85]
    ds_read_b128 v[106:109], v9 offset:4096
    ds_read_b64_tr_b16 v[138:139], v13 offset:8192
    v_mfma_f32_16x16x32_bf16 v[90:93], v[118:121], v[162:165], v[90:93]
    ds_read_b64_tr_b16 v[140:141], v13 offset:8704
    ds_read_b64_tr_b16 v[142:143], v14 offset:8192
    v_mfma_f32_16x16x32_bf16 v[78:81], v[110:113], v[166:169], v[78:81]
    ds_read_b64_tr_b16 v[144:145], v14 offset:8704
    v_mul_f32 v230, s54, v230
    v_mfma_f32_16x16x32_bf16 v[86:89], v[114:117], v[166:169], v[86:89]
    v_mul_f32 v231, s54, v231
    v_fma_f32 v198, v198, s54, -v230
    v_mfma_f32_16x16x32_bf16 v[94:97], v[118:121], v[166:169], v[94:97]
    v_fma_f32 v199, v199, s54, -v230
    v_fma_f32 v200, v200, s54, -v231
    v_fma_f32 v201, v201, s54, -v231
    s_waitcnt lgkmcnt(0)
    v_mfma_f32_16x16x32_bf16 v[74:77], v[98:101], v[138:141], v[74:77]
    ds_read_b128 v[110:113], v10 offset:0
    ds_read_b128 v[114:117], v10 offset:2048
    v_mfma_f32_16x16x32_bf16 v[82:85], v[102:105], v[138:141], v[82:85]
    ds_read_b128 v[118:121], v10 offset:4096
    ds_read_b64_tr_b16 v[162:163], v13 offset:12288
    v_mfma_f32_16x16x32_bf16 v[90:93], v[106:109], v[138:141], v[90:93]
    ds_read_b64_tr_b16 v[164:165], v13 offset:12800
    ds_read_b64_tr_b16 v[166:167], v14 offset:12288
    v_mfma_f32_16x16x32_bf16 v[78:81], v[98:101], v[142:145], v[78:81]
    ds_read_b64_tr_b16 v[168:169], v14 offset:12800
    v_exp_f32 v198, v198
    v_mfma_f32_16x16x32_bf16 v[86:89], v[102:105], v[142:145], v[86:89]
    v_exp_f32 v199, v199
    v_exp_f32 v200, v200
    v_mfma_f32_16x16x32_bf16 v[94:97], v[106:109], v[142:145], v[94:97]
    v_exp_f32 v201, v201
    v_add_f32 v230, v198, v199
    v_add_f32 v231, v200, v201
    s_waitcnt lgkmcnt(0)
    v_mfma_f32_16x16x32_bf16 v[74:77], v[110:113], v[162:165], v[74:77]
    ds_read_b128 v[98:101], v9 offset:10240
    ds_read_b128 v[102:105], v9 offset:12288
    v_mfma_f32_16x16x32_bf16 v[82:85], v[114:117], v[162:165], v[82:85]
    ds_read_b128 v[106:109], v9 offset:14336
    ds_read_b64_tr_b16 v[138:139], v13 offset:16384
    v_mfma_f32_16x16x32_bf16 v[90:93], v[118:121], v[162:165], v[90:93]
    ds_read_b64_tr_b16 v[140:141], v13 offset:16896
    ds_read_b64_tr_b16 v[142:143], v14 offset:16384
    v_mfma_f32_16x16x32_bf16 v[78:81], v[110:113], v[166:169], v[78:81]
    ds_read_b64_tr_b16 v[144:145], v14 offset:16896
    v_mov_b32 v232, v230
    v_mfma_f32_16x16x32_bf16 v[86:89], v[114:117], v[166:169], v[86:89]
    v_mov_b32 v233, v231
    v_permlane16_swap_b32 v230, v232
    v_mfma_f32_16x16x32_bf16 v[94:97], v[118:121], v[166:169], v[94:97]
    v_permlane16_swap_b32 v231, v233
    v_add_f32 v230, v230, v232
    v_add_f32 v231, v231, v233
    s_waitcnt lgkmcnt(0)
    v_mfma_f32_16x16x32_bf16 v[74:77], v[98:101], v[138:141], v[74:77]
    ds_read_b128 v[110:113], v10 offset:10240
    ds_read_b128 v[114:117], v10 offset:12288
    v_mfma_f32_16x16x32_bf16 v[82:85], v[102:105], v[138:141], v[82:85]
    ds_read_b128 v[118:121], v10 offset:14336
    ds_read_b64_tr_b16 v[162:163], v13 offset:20480
    v_mfma_f32_16x16x32_bf16 v[90:93], v[106:109], v[138:141], v[90:93]
    ds_read_b64_tr_b16 v[164:165], v13 offset:20992
    ds_read_b64_tr_b16 v[166:167], v14 offset:20480
    v_mfma_f32_16x16x32_bf16 v[78:81], v[98:101], v[142:145], v[78:81]
    ds_read_b64_tr_b16 v[168:169], v14 offset:20992
    v_mov_b32 v232, v230
    v_mfma_f32_16x16x32_bf16 v[86:89], v[102:105], v[142:145], v[86:89]
    v_mov_b32 v233, v231
    v_permlane32_swap_b32 v230, v232
    v_mfma_f32_16x16x32_bf16 v[94:97], v[106:109], v[142:145], v[94:97]
    v_permlane32_swap_b32 v231, v233
    v_add_f32 v230, v230, v232
    v_add_f32 v231, v231, v233
    s_waitcnt lgkmcnt(0)
    buffer_load_dwordx4 v[210:213], v6, s[36:39], s52 offen sc1
    buffer_load_dword v32, v31, s[36:39], 0 offen sc1
    s_barrier
    v_mfma_f32_16x16x32_bf16 v[74:77], v[110:113], v[162:165], v[74:77]
    ds_read_b128 v[98:101], v9 offset:20480
    ds_read_b128 v[102:105], v9 offset:22528
    v_mfma_f32_16x16x32_bf16 v[82:85], v[114:117], v[162:165], v[82:85]
    ds_read_b128 v[106:109], v9 offset:24576
    ds_read_b64_tr_b16 v[138:139], v13 offset:24576
    v_mfma_f32_16x16x32_bf16 v[90:93], v[118:121], v[162:165], v[90:93]
    ds_read_b64_tr_b16 v[140:141], v13 offset:25088
    ds_read_b64_tr_b16 v[142:143], v14 offset:24576
    v_mfma_f32_16x16x32_bf16 v[78:81], v[110:113], v[166:169], v[78:81]
    ds_read_b64_tr_b16 v[144:145], v14 offset:25088
    v_rcp_f32 v230, v230
    v_mfma_f32_16x16x32_bf16 v[86:89], v[114:117], v[166:169], v[86:89]
    v_rcp_f32 v231, v231
    v_mul_f32 v198, v198, v230
    v_mfma_f32_16x16x32_bf16 v[94:97], v[118:121], v[166:169], v[94:97]
    v_mul_f32 v199, v199, v230
    v_mul_f32 v200, v200, v231
    v_mul_f32 v201, v201, v231
    s_waitcnt lgkmcnt(0)
    v_mfma_f32_16x16x32_bf16 v[74:77], v[98:101], v[138:141], v[74:77]
    ds_read_b128 v[110:113], v10 offset:20480
    ds_read_b128 v[114:117], v10 offset:22528
    v_mfma_f32_16x16x32_bf16 v[82:85], v[102:105], v[138:141], v[82:85]
    ds_read_b128 v[118:121], v10 offset:24576
    ds_read_b64_tr_b16 v[162:163], v13 offset:28672
    v_mfma_f32_16x16x32_bf16 v[90:93], v[106:109], v[138:141], v[90:93]
    ds_read_b64_tr_b16 v[164:165], v13 offset:29184
    ds_read_b64_tr_b16 v[166:167], v14 offset:28672
    v_mfma_f32_16x16x32_bf16 v[78:81], v[98:101], v[142:145], v[78:81]
    ds_read_b64_tr_b16 v[168:169], v14 offset:29184
    v_cvt_pk_bf16_f32 v198, v198, v198
    v_mfma_f32_16x16x32_bf16 v[86:89], v[102:105], v[142:145], v[86:89]
    v_cvt_pk_bf16_f32 v199, v199, v199
    v_cvt_pk_bf16_f32 v200, v200, v200
    v_mfma_f32_16x16x32_bf16 v[94:97], v[106:109], v[142:145], v[94:97]
    v_cvt_pk_bf16_f32 v201, v201, v201
    v_and_b32 v214, v15, v198
    v_and_b32 v215, v16, v199
    s_waitcnt lgkmcnt(0)
    v_mfma_f32_16x16x32_bf16 v[74:77], v[110:113], v[162:165], v[74:77]
    v_and_b32 v216, v17, v198
    v_mfma_f32_16x16x32_bf16 v[82:85], v[114:117], v[162:165], v[82:85]
    v_and_b32 v217, v18, v199
    v_mfma_f32_16x16x32_bf16 v[90:93], v[118:121], v[162:165], v[90:93]
    v_and_b32 v218, v15, v200
    v_mfma_f32_16x16x32_bf16 v[78:81], v[110:113], v[166:169], v[78:81]
    v_and_b32 v219, v16, v201
    v_mfma_f32_16x16x32_bf16 v[86:89], v[114:117], v[166:169], v[86:89]
    v_and_b32 v220, v17, v200
    v_mfma_f32_16x16x32_bf16 v[94:97], v[118:121], v[166:169], v[94:97]
    v_and_b32 v221, v18, v201
    v_cvt_pk_bf16_f32 v234, v74, v75
    v_cvt_pk_bf16_f32 v235, v76, v77
    v_cvt_pk_bf16_f32 v236, v82, v83
    v_cvt_pk_bf16_f32 v237, v84, v85
    v_cvt_pk_bf16_f32 v238, v90, v91
    v_cvt_pk_bf16_f32 v239, v92, v93
    v_cvt_pk_bf16_f32 v240, v78, v79
    v_cvt_pk_bf16_f32 v241, v80, v81
    v_cvt_pk_bf16_f32 v242, v86, v87
    v_cvt_pk_bf16_f32 v243, v88, v89
    v_cvt_pk_bf16_f32 v244, v94, v95
    v_cvt_pk_bf16_f32 v245, v96, v97
    v_mfma_f32_16x16x32_bf16 v[34:37], v[234:237], v[214:217], 0
    v_mfma_f32_16x16x32_bf16 v[38:41], v[240:243], v[214:217], 0
    v_mfma_f32_16x16x32_bf16 v[42:45], v[236:239], v[218:221], 0
    v_mfma_f32_16x16x32_bf16 v[46:49], v[242:245], v[218:221], 0
    s_cmp_lg_u32 s53, 0
    s_cbranch_scc1 C_sv
    s_mov_b32 s44, 0
    s_mov_b32 s40, 0x0c0c0400
    s_mov_b32 s41, 0x05040100
    s_waitcnt vmcnt(1)
        C_sl:
    v_perm_b32 v4, v211, v210, s40
    v_perm_b32 v5, v213, v212, s40
    v_perm_b32 v4, v5, v4, s41
    v_cmp_ne_u32 vcc, s12, v4
    s_nop 0
    s_cbranch_vccz C_sk
    s_add_u32 s44, s44, 1
    s_cmp_gt_u32 s44, 200000
    s_cbranch_scc1 C_sk
    buffer_load_dwordx4 v[210:213], v6, s[36:39], s52 offen sc1
    s_waitcnt vmcnt(0)
    s_branch C_sl
        C_sk:

    v_and_b32 v210, v30, v210
    v_add_f32 v202, v202, v210
    v_and_b32 v211, v30, v211
    v_add_f32 v203, v203, v211
    v_and_b32 v212, v30, v212
    v_add_f32 v204, v204, v212
    v_and_b32 v213, v30, v213
    v_add_f32 v205, v205, v213
C_sv:
    v_max_f32 v230, v202, v203
    v_max_f32 v231, v204, v205
    v_mov_b32 v232, v230
    v_cvt_pk_bf16_f32 v190, v34, v35
    v_mov_b32 v233, v231
    v_permlane16_swap_b32 v230, v232
    s_nop 0
    v_permlane16_swap_b32 v231, v233
    v_cvt_pk_bf16_f32 v191, v36, v37
    v_max_f32 v230, v230, v232
    v_max_f32 v231, v231, v233
    v_mov_b32 v232, v230
    v_cvt_pk_bf16_f32 v192, v38, v39
    v_mov_b32 v233, v231
    v_permlane32_swap_b32 v230, v232
    s_nop 0
    v_permlane32_swap_b32 v231, v233
    v_cvt_pk_bf16_f32 v193, v40, v41
    v_max_f32 v230, v230, v232
    v_max_f32 v231, v231, v233
    v_mul_f32 v230, s54, v230
    v_cvt_pk_bf16_f32 v194, v42, v43
    v_mul_f32 v231, s54, v231
    v_fma_f32 v202, v202, s54, -v230
    v_fma_f32 v203, v203, s54, -v230
    v_cvt_pk_bf16_f32 v195, v44, v45
    v_fma_f32 v204, v204, s54, -v231
    v_fma_f32 v205, v205, s54, -v231
    v_exp_f32 v202, v202
    v_cvt_pk_bf16_f32 v196, v46, v47
    v_exp_f32 v203, v203
    v_exp_f32 v204, v204
    v_exp_f32 v205, v205
    v_cvt_pk_bf16_f32 v197, v48, v49
    v_add_f32 v230, v202, v203
    v_add_f32 v231, v204, v205
    v_mov_b32 v232, v230
    v_mov_b32 v233, v231
    s_nop 0
    v_permlane16_swap_b32 v230, v232
    v_permlane16_swap_b32 v231, v233
    v_add_f32 v230, v230, v232
    v_add_f32 v231, v231, v233
    v_mov_b32 v232, v230
    v_mov_b32 v233, v231
    s_nop 0
    v_permlane32_swap_b32 v230, v232
    v_permlane32_swap_b32 v231, v233
    v_add_f32 v230, v230, v232
    v_add_f32 v231, v231, v233
    v_rcp_f32 v230, v230
    v_rcp_f32 v231, v231
    v_mul_f32 v202, v202, v230
    v_mul_f32 v203, v203, v230
    v_mul_f32 v204, v204, v231
    v_mul_f32 v205, v205, v231
    v_cvt_pk_bf16_f32 v202, v202, v202
    v_cvt_pk_bf16_f32 v203, v203, v203
    v_cvt_pk_bf16_f32 v204, v204, v204
    v_cvt_pk_bf16_f32 v205, v205, v205
    v_and_b32 v222, v15, v202
    v_and_b32 v223, v16, v203
    v_and_b32 v224, v17, v202
    v_and_b32 v225, v18, v203
    v_and_b32 v226, v15, v204
    v_and_b32 v227, v16, v205
    v_and_b32 v228, v17, v204
    v_and_b32 v229, v18, v205
    v_mfma_f32_16x16x32_bf16 v[50:53], v[234:237], v[222:225], 0
    v_mfma_f32_16x16x32_bf16 v[54:57], v[240:243], v[222:225], 0
    v_mfma_f32_16x16x32_bf16 v[58:61], v[236:239], v[226:229], 0
    v_mfma_f32_16x16x32_bf16 v[62:65], v[242:245], v[226:229], 0
    v_mov_b32 v246, s12
    v_mov_b32 v247, s13
    v_mov_b32 v248, 0
    s_add_u32 s41, s55, 14336
    s_nop 0
    v_cvt_pk_bf16_f32 v170, v50, v51
    v_cvt_pk_bf16_f32 v171, v52, v53
    v_cvt_pk_bf16_f32 v172, v54, v55
    v_cvt_pk_bf16_f32 v173, v56, v57
    v_cndmask_b32 v170, v170, v190, s[100:101]
    v_cndmask_b32 v171, v171, v191, s[100:101]
    v_cndmask_b32 v172, v172, v192, s[14:15]
    v_cndmask_b32 v173, v173, v193, s[14:15]
    v_cvt_pk_bf16_f32 v174, v58, v59
    v_cvt_pk_bf16_f32 v175, v60, v61
    v_cvt_pk_bf16_f32 v176, v62, v63
    v_cvt_pk_bf16_f32 v177, v64, v65
    v_cndmask_b32 v174, v174, v194, s[100:101]
    v_cndmask_b32 v175, v175, v195, s[100:101]
    v_cndmask_b32 v176, v176, v196, s[14:15]
    v_cndmask_b32 v177, v177, v197, s[14:15]
    s_cmp_eq_u32 s49, 0
    s_cbranch_scc1 SM_sO
    buffer_store_dwordx4 v[170:173], v6, s[36:39], s55 offen
    buffer_store_dwordx4 v[174:177], v6, s[36:39], s41 offen
    s_waitcnt vmcnt(0)
    s_mov_b64 exec, 1
    buffer_store_dwordx2 v[246:247], v248, s[36:39], s45 offen
    s_mov_b64 exec, -1
SM_jO:
    v_min_u32 v19, 13, v1
    v_lshlrev_b32 v19, 3, v19
    s_and_b32 s45, s45, 0xffffff80
    s_mov_b32 s44, 0
    buffer_load_dwordx2 v[20:21], v19, s[36:39], s45 offen sc1
    v_lshrrev_b32 v4, 2, v1
    v_bfe_u32 v5, v1, 3, 2
    v_lshlrev_b32 v5, 5, v5
    v_lshl_add_u32 v4, v4, 7, v5
    v_and_b32 v5, 3, v1
    v_lshl_add_u32 v4, v5, 3, v4
    v_add_u32 v34, 71680, v4
    v_xor_b32 v35, 32, v34
    v_xor_b32 v36, 64, v34
    v_xor_b32 v37, 96, v34
    s_lshl_b32 s41, s46, 11
    s_add_u32 s41, s41, 57344
    v_lshrrev_b32 v4, 1, v2
    v_and_b32 v5, 7, v3
    v_xor_b32 v4, v4, v5
    v_lshlrev_b32 v4, 4, v4
    v_lshl_add_u32 v4, v3, 7, v4
    v_and_b32 v5, 1, v2
    v_lshl_add_u32 v4, v5, 3, v4
    v_add_u32 v38, s41, v4
    v_lshrrev_b32 v4, 3, v1
    v_and_b32 v5, 7, v1
    v_mul_u32_u24 v40, 1792, v4
    v_lshl_add_u32 v40, v5, 4, v40
    v_xor_b32 v5, v5, v4
    v_lshlrev_b32 v5, 4, v5
    v_lshl_add_u32 v4, v4, 7, v5
    v_add_u32 v39, s41, v4
    s_lshl_b32 s40, s8, 2
    s_add_u32 s40, s40, s46
    s_mul_i32 s55, s40, 14336
    s_add_u32 s55, s55, 2097152
    s_mul_i32 s51, s40, 28672
    s_lshl_b32 s41, s7, 7
    s_add_u32 s51, s51, s41
    s_add_u32 s52, s51, 14336
        C_ol:
    s_waitcnt vmcnt(0)
    v_cmp_ne_u64 vcc, s[12:13], v[20:21]
    s_nop 0
    s_cbranch_vccz C_ok
    s_add_u32 s44, s44, 1
    s_cmp_gt_u32 s44, 200000
    s_cbranch_scc1 C_ok
    buffer_load_dwordx2 v[20:21], v19, s[36:39], s45 offen sc1
    s_branch C_ol
        C_ok:

    buffer_load_dwordx4 v[42:45], v6, s[36:39], s55 offen offset:0 sc1
    buffer_load_dwordx4 v[46:49], v6, s[36:39], s55 offen offset:1024 sc1
    buffer_load_dwordx4 v[50:53], v6, s[36:39], s55 offen offset:2048 sc1
    buffer_load_dwordx4 v[54:57], v6, s[36:39], s55 offen offset:3072 sc1
    s_add_u32 s55, s55, 4096
    buffer_load_dwordx4 v[58:61], v6, s[36:39], s55 offen offset:0 sc1
    buffer_load_dwordx4 v[62:65], v6, s[36:39], s55 offen offset:1024 sc1
    buffer_load_dwordx4 v[66:69], v6, s[36:39], s55 offen offset:2048 sc1
    buffer_load_dwordx4 v[70:73], v6, s[36:39], s55 offen offset:3072 sc1
    s_add_u32 s55, s55, 4096
    buffer_load_dwordx4 v[74:77], v6, s[36:39], s55 offen offset:0 sc1
    buffer_load_dwordx4 v[78:81], v6, s[36:39], s55 offen offset:1024 sc1
    buffer_load_dwordx4 v[82:85], v6, s[36:39], s55 offen offset:2048 sc1
    buffer_load_dwordx4 v[86:89], v6, s[36:39], s55 offen offset:3072 sc1
    s_add_u32 s55, s55, 4096
    buffer_load_dwordx4 v[90:93], v6, s[36:39], s55 offen offset:0 sc1
    buffer_load_dwordx4 v[94:97], v6, s[36:39], s55 offen offset:1024 sc1
    s_barrier
    ds_read_b64_tr_b16 v[98:99], v34 offset:0
    ds_read_b64_tr_b16 v[100:101], v34 offset:2048
    ds_read_b64_tr_b16 v[102:103], v35 offset:0
    ds_read_b64_tr_b16 v[104:105], v35 offset:2048
    ds_read_b64_tr_b16 v[106:107], v36 offset:0
    ds_read_b64_tr_b16 v[108:109], v36 offset:2048
    ds_read_b64_tr_b16 v[110:111], v37 offset:0
    ds_read_b64_tr_b16 v[112:113], v37 offset:2048
    ds_read_b64_tr_b16 v[114:115], v34 offset:4096
    ds_read_b64_tr_b16 v[116:117], v34 offset:6144
    ds_read_b64_tr_b16 v[118:119], v35 offset:4096
    ds_read_b64_tr_b16 v[120:121], v35 offset:6144
    ds_read_b64_tr_b16 v[122:123], v36 offset:4096
    ds_read_b64_tr_b16 v[124:125], v36 offset:6144
    ds_read_b64_tr_b16 v[126:127], v37 offset:4096
    ds_read_b64_tr_b16 v[128:129], v37 offset:6144
    ds_read_b64_tr_b16 v[130:131], v34 offset:8192
    ds_read_b64_tr_b16 v[132:133], v34 offset:10240
    ds_read_b64_tr_b16 v[134:135], v35 offset:8192
    ds_read_b64_tr_b16 v[136:137], v35 offset:10240
    ds_read_b64_tr_b16 v[138:139], v36 offset:8192
    ds_read_b64_tr_b16 v[140:141], v36 offset:10240
    ds_read_b64_tr_b16 v[142:143], v37 offset:8192
    ds_read_b64_tr_b16 v[144:145], v37 offset:10240
    ds_read_b64_tr_b16 v[146:147], v34 offset:12288
    ds_read_b64_tr_b16 v[148:149], v34 offset:14336
    ds_read_b64_tr_b16 v[150:151], v35 offset:12288
    ds_read_b64_tr_b16 v[152:153], v35 offset:14336
    ds_read_b64_tr_b16 v[154:155], v36 offset:12288
    ds_read_b64_tr_b16 v[156:157], v36 offset:14336
    ds_read_b64_tr_b16 v[158:159], v37 offset:12288
    ds_read_b64_tr_b16 v[160:161], v37 offset:14336
    ds_read_b64_tr_b16 v[162:163], v34 offset:16384
    ds_read_b64_tr_b16 v[164:165], v34 offset:18432
    ds_read_b64_tr_b16 v[166:167], v35 offset:16384
    ds_read_b64_tr_b16 v[168:169], v35 offset:18432
    ds_read_b64_tr_b16 v[170:171], v36 offset:16384
    ds_read_b64_tr_b16 v[172:173], v36 offset:18432
    ds_read_b64_tr_b16 v[174:175], v37 offset:16384
    ds_read_b64_tr_b16 v[176:177], v37 offset:18432
    ds_read_b64_tr_b16 v[178:179], v34 offset:20480
    ds_read_b64_tr_b16 v[180:181], v34 offset:22528
    ds_read_b64_tr_b16 v[182:183], v35 offset:20480
    ds_read_b64_tr_b16 v[184:185], v35 offset:22528
    ds_read_b64_tr_b16 v[186:187], v36 offset:20480
    ds_read_b64_tr_b16 v[188:189], v36 offset:22528
    ds_read_b64_tr_b16 v[190:191], v37 offset:20480
    ds_read_b64_tr_b16 v[192:193], v37 offset:22528
    ds_read_b64_tr_b16 v[194:195], v34 offset:24576
    ds_read_b64_tr_b16 v[196:197], v34 offset:26624
    ds_read_b64_tr_b16 v[198:199], v35 offset:24576
    ds_read_b64_tr_b16 v[200:201], v35 offset:26624
    ds_read_b64_tr_b16 v[202:203], v36 offset:24576
    ds_read_b64_tr_b16 v[204:205], v36 offset:26624
    ds_read_b64_tr_b16 v[206:207], v37 offset:24576
    ds_read_b64_tr_b16 v[208:209], v37 offset:26624
    ds_read_b64_tr_b16 v[210:211], v34 offset:28672
    ds_read_b64_tr_b16 v[212:213], v34 offset:30720
    ds_read_b64_tr_b16 v[214:215], v35 offset:28672
    ds_read_b64_tr_b16 v[216:217], v35 offset:30720
    ds_read_b64_tr_b16 v[218:219], v36 offset:28672
    ds_read_b64_tr_b16 v[220:221], v36 offset:30720
    ds_read_b64_tr_b16 v[222:223], v37 offset:28672
    ds_read_b64_tr_b16 v[224:225], v37 offset:30720
    s_waitcnt vmcnt(13) lgkmcnt(15)
    v_mfma_f32_16x16x32_bf16 v[226:229], v[98:101], v[42:45], 0
    ds_read_b64_tr_b16 v[98:99], v34 offset:32768
    ds_read_b64_tr_b16 v[100:101], v34 offset:34816
    v_mfma_f32_16x16x32_bf16 v[230:233], v[102:105], v[42:45], 0
    ds_read_b64_tr_b16 v[102:103], v35 offset:32768
    ds_read_b64_tr_b16 v[104:105], v35 offset:34816
    v_mfma_f32_16x16x32_bf16 v[234:237], v[106:109], v[42:45], 0
    ds_read_b64_tr_b16 v[106:107], v36 offset:32768
    ds_read_b64_tr_b16 v[108:109], v36 offset:34816
    v_mfma_f32_16x16x32_bf16 v[238:241], v[110:113], v[42:45], 0
    ds_read_b64_tr_b16 v[110:111], v37 offset:32768
    ds_read_b64_tr_b16 v[112:113], v37 offset:34816
    s_waitcnt vmcnt(12) lgkmcnt(15)
    v_mfma_f32_16x16x32_bf16 v[226:229], v[114:117], v[46:49], v[226:229]
    ds_read_b64_tr_b16 v[114:115], v34 offset:36864
    ds_read_b64_tr_b16 v[116:117], v34 offset:38912
    v_mfma_f32_16x16x32_bf16 v[230:233], v[118:121], v[46:49], v[230:233]
    ds_read_b64_tr_b16 v[118:119], v35 offset:36864
    ds_read_b64_tr_b16 v[120:121], v35 offset:38912
    v_mfma_f32_16x16x32_bf16 v[234:237], v[122:125], v[46:49], v[234:237]
    ds_read_b64_tr_b16 v[122:123], v36 offset:36864
    ds_read_b64_tr_b16 v[124:125], v36 offset:38912
    v_mfma_f32_16x16x32_bf16 v[238:241], v[126:129], v[46:49], v[238:241]
    ds_read_b64_tr_b16 v[126:127], v37 offset:36864
    ds_read_b64_tr_b16 v[128:129], v37 offset:38912
    s_waitcnt vmcnt(11) lgkmcnt(15)
    v_mfma_f32_16x16x32_bf16 v[226:229], v[130:133], v[50:53], v[226:229]
    ds_read_b64_tr_b16 v[130:131], v34 offset:40960
    ds_read_b64_tr_b16 v[132:133], v34 offset:43008
    v_mfma_f32_16x16x32_bf16 v[230:233], v[134:137], v[50:53], v[230:233]
    ds_read_b64_tr_b16 v[134:135], v35 offset:40960
    ds_read_b64_tr_b16 v[136:137], v35 offset:43008
    v_mfma_f32_16x16x32_bf16 v[234:237], v[138:141], v[50:53], v[234:237]
    ds_read_b64_tr_b16 v[138:139], v36 offset:40960
    ds_read_b64_tr_b16 v[140:141], v36 offset:43008
    v_mfma_f32_16x16x32_bf16 v[238:241], v[142:145], v[50:53], v[238:241]
    ds_read_b64_tr_b16 v[142:143], v37 offset:40960
    ds_read_b64_tr_b16 v[144:145], v37 offset:43008
    s_waitcnt vmcnt(10) lgkmcnt(15)
    v_mfma_f32_16x16x32_bf16 v[226:229], v[146:149], v[54:57], v[226:229]
    ds_read_b64_tr_b16 v[146:147], v34 offset:45056
    ds_read_b64_tr_b16 v[148:149], v34 offset:47104
    v_mfma_f32_16x16x32_bf16 v[230:233], v[150:153], v[54:57], v[230:233]
    ds_read_b64_tr_b16 v[150:151], v35 offset:45056
    ds_read_b64_tr_b16 v[152:153], v35 offset:47104
    v_mfma_f32_16x16x32_bf16 v[234:237], v[154:157], v[54:57], v[234:237]
    ds_read_b64_tr_b16 v[154:155], v36 offset:45056
    ds_read_b64_tr_b16 v[156:157], v36 offset:47104
    v_mfma_f32_16x16x32_bf16 v[238:241], v[158:161], v[54:57], v[238:241]
    ds_read_b64_tr_b16 v[158:159], v37 offset:45056
    ds_read_b64_tr_b16 v[160:161], v37 offset:47104
    s_waitcnt vmcnt(9) lgkmcnt(15)
    v_mfma_f32_16x16x32_bf16 v[226:229], v[162:165], v[58:61], v[226:229]
    ds_read_b64_tr_b16 v[162:163], v34 offset:49152
    ds_read_b64_tr_b16 v[164:165], v34 offset:51200
    v_mfma_f32_16x16x32_bf16 v[230:233], v[166:169], v[58:61], v[230:233]
    ds_read_b64_tr_b16 v[166:167], v35 offset:49152
    ds_read_b64_tr_b16 v[168:169], v35 offset:51200
    v_mfma_f32_16x16x32_bf16 v[234:237], v[170:173], v[58:61], v[234:237]
    ds_read_b64_tr_b16 v[170:171], v36 offset:49152
    ds_read_b64_tr_b16 v[172:173], v36 offset:51200
    v_mfma_f32_16x16x32_bf16 v[238:241], v[174:177], v[58:61], v[238:241]
    ds_read_b64_tr_b16 v[174:175], v37 offset:49152
    ds_read_b64_tr_b16 v[176:177], v37 offset:51200
    s_waitcnt vmcnt(8) lgkmcnt(15)
    v_mfma_f32_16x16x32_bf16 v[226:229], v[178:181], v[62:65], v[226:229]
    ds_read_b64_tr_b16 v[178:179], v34 offset:53248
    ds_read_b64_tr_b16 v[180:181], v34 offset:55296
    v_mfma_f32_16x16x32_bf16 v[230:233], v[182:185], v[62:65], v[230:233]
    ds_read_b64_tr_b16 v[182:183], v35 offset:53248
    ds_read_b64_tr_b16 v[184:185], v35 offset:55296
    v_mfma_f32_16x16x32_bf16 v[234:237], v[186:189], v[62:65], v[234:237]
    ds_read_b64_tr_b16 v[186:187], v36 offset:53248
    ds_read_b64_tr_b16 v[188:189], v36 offset:55296
    v_mfma_f32_16x16x32_bf16 v[238:241], v[190:193], v[62:65], v[238:241]
    ds_read_b64_tr_b16 v[190:191], v37 offset:53248
    ds_read_b64_tr_b16 v[192:193], v37 offset:55296
    s_waitcnt vmcnt(7) lgkmcnt(15)
    v_mfma_f32_16x16x32_bf16 v[226:229], v[194:197], v[66:69], v[226:229]
    v_mfma_f32_16x16x32_bf16 v[230:233], v[198:201], v[66:69], v[230:233]
    v_mfma_f32_16x16x32_bf16 v[234:237], v[202:205], v[66:69], v[234:237]
    v_mfma_f32_16x16x32_bf16 v[238:241], v[206:209], v[66:69], v[238:241]
    s_waitcnt vmcnt(6) lgkmcnt(15)
    v_mfma_f32_16x16x32_bf16 v[226:229], v[210:213], v[70:73], v[226:229]
    v_mfma_f32_16x16x32_bf16 v[230:233], v[214:217], v[70:73], v[230:233]
    v_mfma_f32_16x16x32_bf16 v[234:237], v[218:221], v[70:73], v[234:237]
    v_mfma_f32_16x16x32_bf16 v[238:241], v[222:225], v[70:73], v[238:241]
    s_waitcnt vmcnt(5) lgkmcnt(15)
    v_mfma_f32_16x16x32_bf16 v[226:229], v[98:101], v[74:77], v[226:229]
    v_mfma_f32_16x16x32_bf16 v[230:233], v[102:105], v[74:77], v[230:233]
    v_mfma_f32_16x16x32_bf16 v[234:237], v[106:109], v[74:77], v[234:237]
    v_mfma_f32_16x16x32_bf16 v[238:241], v[110:113], v[74:77], v[238:241]
    s_waitcnt vmcnt(4) lgkmcnt(15)
    v_mfma_f32_16x16x32_bf16 v[226:229], v[114:117], v[78:81], v[226:229]
    v_mfma_f32_16x16x32_bf16 v[230:233], v[118:121], v[78:81], v[230:233]
    v_mfma_f32_16x16x32_bf16 v[234:237], v[122:125], v[78:81], v[234:237]
    v_mfma_f32_16x16x32_bf16 v[238:241], v[126:129], v[78:81], v[238:241]
    s_waitcnt vmcnt(3) lgkmcnt(15)
    v_mfma_f32_16x16x32_bf16 v[226:229], v[130:133], v[82:85], v[226:229]
    v_mfma_f32_16x16x32_bf16 v[230:233], v[134:137], v[82:85], v[230:233]
    v_mfma_f32_16x16x32_bf16 v[234:237], v[138:141], v[82:85], v[234:237]
    v_mfma_f32_16x16x32_bf16 v[238:241], v[142:145], v[82:85], v[238:241]
    s_waitcnt vmcnt(2) lgkmcnt(15)
    v_mfma_f32_16x16x32_bf16 v[226:229], v[146:149], v[86:89], v[226:229]
    v_mfma_f32_16x16x32_bf16 v[230:233], v[150:153], v[86:89], v[230:233]
    v_mfma_f32_16x16x32_bf16 v[234:237], v[154:157], v[86:89], v[234:237]
    v_mfma_f32_16x16x32_bf16 v[238:241], v[158:161], v[86:89], v[238:241]
    s_waitcnt vmcnt(1) lgkmcnt(8)
    v_mfma_f32_16x16x32_bf16 v[226:229], v[162:165], v[90:93], v[226:229]
    v_mfma_f32_16x16x32_bf16 v[230:233], v[166:169], v[90:93], v[230:233]
    v_mfma_f32_16x16x32_bf16 v[234:237], v[170:173], v[90:93], v[234:237]
    v_mfma_f32_16x16x32_bf16 v[238:241], v[174:177], v[90:93], v[238:241]
    s_waitcnt vmcnt(0) lgkmcnt(0)
    v_mfma_f32_16x16x32_bf16 v[226:229], v[178:181], v[94:97], v[226:229]
    v_mfma_f32_16x16x32_bf16 v[230:233], v[182:185], v[94:97], v[230:233]
    v_mfma_f32_16x16x32_bf16 v[234:237], v[186:189], v[94:97], v[234:237]
    v_mfma_f32_16x16x32_bf16 v[238:241], v[190:193], v[94:97], v[238:241]
    s_nop 4
    v_cvt_pk_bf16_f32 v42, v226, v227
    v_cvt_pk_bf16_f32 v43, v228, v229
    v_xor_b32 v4, 0, v38
    ds_write_b64 v4, v[42:43]
    v_cvt_pk_bf16_f32 v44, v230, v231
    v_cvt_pk_bf16_f32 v45, v232, v233
    v_xor_b32 v4, 32, v38
    ds_write_b64 v4, v[44:45]
    v_cvt_pk_bf16_f32 v46, v234, v235
    v_cvt_pk_bf16_f32 v47, v236, v237
    v_xor_b32 v4, 64, v38
    ds_write_b64 v4, v[46:47]
    v_cvt_pk_bf16_f32 v48, v238, v239
    v_cvt_pk_bf16_f32 v49, v240, v241
    v_xor_b32 v4, 96, v38
    ds_write_b64 v4, v[48:49]
    s_waitcnt lgkmcnt(0)
    ds_read_b128 v[50:53], v39
    ds_read_b128 v[54:57], v39 offset:1024
    s_waitcnt lgkmcnt(1)
    buffer_store_dwordx4 v[50:53], v40, s[32:35], s51 offen
    s_waitcnt lgkmcnt(0)
    buffer_store_dwordx4 v[54:57], v40, s[32:35], s52 offen

    s_endpgm
SM_sR:
    buffer_store_dwordx2 v[198:199], v200, s[36:39], s49 offen offset:64 sc1
    s_branch SM_jR
SM_sS:
    buffer_store_dwordx4 v[66:69], v6, s[36:39], s51 offen sc1
    s_branch SM_jS
SM_sO:
    buffer_store_dwordx4 v[170:173], v6, s[36:39], s55 offen sc1
    buffer_store_dwordx4 v[174:177], v6, s[36:39], s41 offen sc1
    s_waitcnt vmcnt(0)
    s_mov_b64 exec, 1
    buffer_store_dwordx2 v[246:247], v248, s[36:39], s45 offen sc1
    s_mov_b64 exec, -1
    s_branch SM_jO
K_exit:
    s_endpgm
.fill 5120, 4, 0xbf810000
.section .rodata,"a"
.p2align 6
.amdhsa_kernel concat_heads__sliding_local_dilated__spectral_fnet__prompt_kernel
  .amdhsa_next_free_vgpr 256
  .amdhsa_next_free_sgpr 102
  .amdhsa_accum_offset 256
  .amdhsa_group_segment_fixed_size 0
  .amdhsa_kernarg_size 88
  .amdhsa_user_sgpr_count 2
  .amdhsa_user_sgpr_kernarg_segment_ptr 1
  .amdhsa_system_sgpr_workgroup_id_x 1
.end_amdhsa_kernel
```

```asm
; @launch grid=(256,1,1) block=(512,1,1) lds=163840
.amdgcn_target "amdgcn-amd-amdhsa--gfx950"
.text
.p2align 12
.fill 832, 4, 0xbf810000
.globl concat_heads__sliding_local_dilated__spectral_fnet__prompt_kernel
.p2align 8
.type concat_heads__sliding_local_dilated__spectral_fnet__prompt_kernel,@function
concat_heads__sliding_local_dilated__spectral_fnet__prompt_kernel:
    s_load_dwordx2 s[16:17], s[0:1], 0
    s_load_dwordx2 s[20:21], s[0:1], 8
    s_load_dwordx2 s[28:29], s[0:1], 24
    s_load_dwordx2 s[36:37], s[0:1], 80
    s_load_dwordx2 s[24:25], s[0:1], 16
    s_load_dwordx2 s[32:33], s[0:1], 64
    v_lshrrev_b32 v1, 6, v0
    s_cmp_ge_u32 s2, 256
    s_cbranch_scc1 K_exit
    v_readfirstlane_b32 s3, v1
    s_and_b32 s4, s2, 7
    s_lshr_b32 s5, s2, 3
    s_cmp_lg_u32 s3, 7
    s_cbranch_scc1 K_nopf
    s_getpc_b64 s[44:45]
    s_mov_b32 s46, 20480
    s_mov_b32 s47, 0x00020000
    s_mul_i32 s40, s5, 640
    v_and_b32 v1, 63, v0
    v_min_u32 v1, 4, v1
    v_lshlrev_b32 v1, 7, v1
    buffer_load_dword v255, v1, s[44:47], s40 offen
        K_nopf:
    s_mul_i32 s6, s5, 37
    s_lshr_b32 s6, s6, 8
    s_mul_i32 s40, s6, 7
    s_sub_u32 s7, s5, s40
    s_mov_b32 s38, 0x10000000
    s_mov_b32 s39, 0x00020000
    s_lshl_b32 s8, s4, 2
    s_cmp_lt_u32 s5, 28
    s_cbranch_scc1 K_a

    s_add_u32 s8, s8, s7
    s_mov_b32 s30, 1835008
    s_mov_b32 s31, 0x00020000
    s_lshl_b32 s40, s3, 7
    s_add_u32 s40, s40, s8
    v_and_b32 v4, 32, v0
    v_add_u32 v4, s40, v4
    v_and_b32 v5, 31, v0
    v_lshlrev_b32 v5, 4, v5
    v_mov_b32 v6, 896
    v_mad_u32_u24 v7, v4, v6, v5
    v_add_u32 v5, 384, v5
    v_sub_u32 v8, 960, v4
    v_mad_u32_u24 v8, v8, v6, v5
    v_sub_u32 v9, 2048, v4
    v_and_b32 v9, 2047, v9
    v_mad_u32_u24 v9, v9, v6, v5
    s_lshl_b32 s42, s3, 13
    s_mov_b32 m0, s42
    s_mov_b32 s52, 57344
    s_mov_b32 s53, 917504
    s_mov_b32 s54, 974848
    s_lshl_b32 s40, s8, 7
    s_waitcnt lgkmcnt(0)

    buffer_load_dwordx4 v7, s[28:31], 0 offen nt lds
    s_add_u32 m0, m0, 1024
    s_nop 0
    buffer_load_dwordx4 v7, s[28:31], s52 offen nt lds
    s_add_u32 m0, m0, 1024
    s_nop 0
    buffer_load_dwordx4 v9, s[28:31], 0 offen nt lds
    s_add_u32 m0, m0, 1024
    s_nop 0
    buffer_load_dwordx4 v8, s[28:31], s53 offen nt lds
    s_add_u32 m0, m0, 1024
    s_load_dwordx2 s[10:11], s[36:37], s40
    s_load_dwordx2 s[14:15], s[36:37], 4096
    s_barrier
    buffer_load_dwordx4 v7, s[28:31], s53 offen nt lds
    s_add_u32 m0, m0, 1024
    s_nop 0
    buffer_load_dwordx4 v7, s[28:31], s54 offen nt lds
    s_add_u32 m0, m0, 1024
    s_nop 0
    buffer_load_dwordx4 v8, s[28:31], s52 offen nt lds
    s_add_u32 m0, m0, 1024
    s_nop 0
    buffer_load_dwordx4 v8, s[28:31], 0 offen nt lds
    s_branch K_spare2
K_a:
    s_add_u32 s8, s8, s6
    s_cmp_ge_u32 s3, 4
    s_cbranch_scc1 K_c
    s_setprio 2
    s_mov_b32 s44, s4
    s_add_u32 s44, s44, s7
    s_mul_i32 s40, s44, 37
    s_lshr_b32 s40, s40, 8
    s_mul_i32 s40, s40, 7
    s_sub_u32 s44, s44, s40
    s_mov_b32 s18, 1835008
    s_mov_b32 s19, 0x00020000
    s_mov_b32 s22, 1204224
    s_mov_b32 s23, 0x00020000
    v_and_b32 v1, 63, v0
    v_lshrrev_b32 v6, 3, v1
    v_and_b32 v7, 7, v1
    v_lshrrev_b32 v8, 4, v1
    v_xor_b32 v3, v7, v8
    v_mul_u32_u24 v23, 896, v6
    v_lshl_add_u32 v21, v3, 4, v23
    v_xor_b32 v22, 64, v21
    v_add_u32 v22, 6144, v22
    s_lshl_b32 s40, s3, 5
    v_xor_b32 v23, s40, v21
    v_and_b32 v2, 2, v6
    v_xor_b32 v2, v7, v2
    v_mul_u32_u24 v3, 2688, v6
    v_lshl_add_u32 v24, v2, 4, v3
    v_xor_b32 v25, 64, v24
    v_add_u32 v25, 20480, v25
    v_add_u32 v26, 896, v24
    v_add_u32 v27, 896, v25
    v_add_u32 v28, 1792, v24
    v_add_u32 v29, 1792, v25
    s_mov_b32 s45, s44
    s_lshl_b32 s40, s8, 6
    s_lshl_b32 s41, s3, 4
    s_add_u32 s42, s40, s41
    s_mul_i32 s46, s42, 896
    s_mul_i32 s48, s41, 2688
    s_lshl_b32 s42, s7, 7
    s_add_u32 s48, s48, s42
    s_sub_u32 s40, s40, 16
    s_max_i32 s40, s40, 0
    s_lshl_b32 s41, s3, 2
    s_add_u32 s40, s40, s41
    s_mul_i32 s47, s40, 896
    s_lshl_b32 s50, s3, 11
    s_lshl_b32 s49, s3, 9

    s_lshl_b32 s40, s44, 7
    s_add_u32 s51, s40, s46
    s_add_u32 s52, s40, s47
    s_mul_i32 s53, s44, 172032
    s_add_u32 s53, s53, s48
    s_add_u32 m0, s50, 2048
    s_add_u32 s44, s44, 1
    s_cmp_eq_u32 s44, 7
    s_cselect_b32 s44, 0, s44
    s_waitcnt lgkmcnt(0)
    buffer_load_dwordx4 v21, s[16:19], s51 offen lds
    buffer_load_dwordx4 v22, s[16:19], s51 offen offset:1024 lds
    s_add_u32 m0, s49, 0
    s_mov_b32 exec_hi, 0
    buffer_load_dwordx4 v23, s[16:19], s52 offen lds
    s_mov_b32 exec_hi, -1
    s_add_u32 m0, s50, 79872
    s_nop 0
    buffer_load_dwordx4 v24, s[20:23], s53 offen lds
    buffer_load_dwordx4 v25, s[20:23], s53 offen offset:1024 lds
    s_add_u32 m0, s50, 88064
    s_nop 0
    buffer_load_dwordx4 v26, s[20:23], s53 offen lds
    buffer_load_dwordx4 v27, s[20:23], s53 offen offset:1024 lds
    s_add_u32 m0, s50, 96256
    s_mul_i32 s53, s45, 172032
    s_add_u32 s53, s53, s48
    s_add_u32 s45, s45, 1
    s_cmp_eq_u32 s45, 7
    s_cselect_b32 s45, 0, s45
    buffer_load_dwordx4 v28, s[20:23], s53 offen lds
    buffer_load_dwordx4 v29, s[20:23], s53 offen offset:1024 lds
    s_lshl_b32 s40, s44, 7
    s_add_u32 s51, s40, s46
    s_add_u32 s52, s40, s47
    s_mul_i32 s53, s44, 172032
    s_add_u32 s53, s53, s48
    s_add_u32 m0, s50, 12288
    s_add_u32 s44, s44, 1
    s_cmp_eq_u32 s44, 7
    s_cselect_b32 s44, 0, s44
    buffer_load_dwordx4 v21, s[16:19], s51 offen lds
    buffer_load_dwordx4 v22, s[16:19], s51 offen offset:1024 lds
    s_lshl_b32 s56, s8, 7
    s_load_dwordx2 s[10:11], s[36:37], s56
    s_add_u32 s63, s56, 8256
    s_add_u32 s30, s56, 8192
    s_getreg_b32 s28, hwreg(HW_REG_XCC_ID, 0, 3)
    v_min_u32 v20, 6, v1
    v_lshlrev_b32 v20, 3, v20
    s_mov_b32 s26, 401408
    s_mov_b32 s27, 0x00020000
    s_mov_b32 s34, 3670016
    s_mov_b32 s35, 0x00020000
    s_lshr_b32 s58, s3, 1
    s_and_b32 s59, s3, 1
    v_and_b32 v9, 15, v1
    v_mov_b32 v4, 0
    v_mov_b32 v14, 1
    v_mov_b32 v5, 161792
    v_and_b32 v112, 6, v6
    v_xor_b32 v112, v7, v112
    v_mul_u32_u24 v113, 896, v6
    v_lshl_add_u32 v10, v112, 4, v113
    v_add_u32 v11, 6144, v10
    s_mov_b32 s54, s6
    s_mul_i32 s55, s3, 14336
    s_lshl_b32 s56, s7, 7
    s_add_u32 s55, s55, s56
    s_and_b32 s56, s3, 1
    s_lshl_b32 s57, s7, 1
    s_add_u32 s56, s56, s57
    s_lshl_b32 s15, s56, 10
    s_lshl_b32 s56, s8, 2
    s_and_b32 s57, s3, 2
    s_add_u32 s56, s56, s57
    s_mul_i32 s57, s56, 14336
    s_add_u32 s15, s15, s57
    s_add_u32 s15, s15, 2097152
    s_lshl_b32 s100, s56, 6
    s_add_u32 s100, s100, 16384
    v_lshlrev_b32 v112, 7, v7
    v_and_b32 v113, 1, v6
    v_mul_u32_u24 v113, 14336, v113
    v_add3_u32 v12, v112, v113, s15
    v_mov_b32 v112, s100
    v_cmp_le_u32 vcc, 16, v1
    s_nop 1
    v_cndmask_b32 v12, v12, v112, vcc
    v_xor_b32 v112, v8, v1
    v_lshlrev_b32 v88, 4, v112
    v_xor_b32 v89, 64, v88
    s_lshl_b32 s56, s3, 13
    s_lshl_b32 s62, s8, 15
    s_add_u32 s62, s62, s56
    s_add_u32 s62, s62, 1048576
    s_mov_b32 s14, 0
    v_add_u32 v112, s59, v8
    v_cmp_eq_u32 vcc, 0, v112
    s_nop 1
    v_cndmask_b32 v110, 1.0, 0.5, vcc
    v_cndmask_b32 v111, 0, 0.5, vcc
    s_lshl_b32 s56, s7, 5
    s_add_u32 s56, s56, s58
    v_lshl_add_u32 v112, v9, 1, s56
    v_cvt_f32_u32 v108, v112
    v_mul_f32 v108, 0x3b124925, v108
    v_lshl_add_u32 v112, v8, 1, s59
    v_cvt_f32_u32 v112, v112
    v_mul_f32 v109, v108, v112
    v_fmamk_f32 v92, v108, 0x0, v109
    v_fmamk_f32 v93, v108, 0x41800000, v109
    v_fmamk_f32 v94, v108, 0x42000000, v109
    v_fmamk_f32 v95, v108, 0x42400000, v109
    v_fmamk_f32 v96, v108, 0x42800000, v109
    v_fmamk_f32 v97, v108, 0x42a00000, v109
    v_fmamk_f32 v98, v108, 0x42c00000, v109
    v_fmamk_f32 v99, v108, 0x42e00000, v109
    v_cos_f32 v92, v92
    v_cos_f32 v93, v93
    v_cos_f32 v94, v94
    v_cos_f32 v95, v95
    v_cos_f32 v96, v96
    v_cos_f32 v97, v97
    v_cos_f32 v98, v98
    v_cos_f32 v99, v99
    v_mul_f32 v92, v92, v110
    v_mul_f32 v99, v99, v111
    v_cvt_pk_bf16_f32 v30, v92, v93
    v_cvt_pk_bf16_f32 v31, v94, v95
    v_cvt_pk_bf16_f32 v32, v96, v97
    v_cvt_pk_bf16_f32 v33, v98, v99
    v_fmamk_f32 v92, v108, 0x41000000, v109
    v_fmamk_f32 v93, v108, 0x41c00000, v109
    v_fmamk_f32 v94, v108, 0x42200000, v109
    v_fmamk_f32 v95, v108, 0x42600000, v109
    v_fmamk_f32 v96, v108, 0x42900000, v109
    v_fmamk_f32 v97, v108, 0x42b00000, v109
    v_fmamk_f32 v98, v108, 0x42d00000, v109
    v_cos_f32 v92, v92
    v_cos_f32 v93, v93
    v_cos_f32 v94, v94
    v_cos_f32 v95, v95
    v_cos_f32 v96, v96
    v_cos_f32 v97, v97
    v_cos_f32 v98, v98
    v_mov_b32 v99, 0
    v_cvt_pk_bf16_f32 v34, v92, v93
    v_cvt_pk_bf16_f32 v35, v94, v95
    v_cvt_pk_bf16_f32 v36, v96, v97
    v_cvt_pk_bf16_f32 v37, v98, v99
    s_lshl_b32 s56, s7, 5
    s_add_u32 s56, s56, 1
    s_sub_u32 s56, s56, s58
    v_lshl_add_u32 v112, v9, 1, s56
    v_cvt_f32_u32 v108, v112
    v_mul_f32 v108, 0x3b124925, v108
    v_lshl_add_u32 v112, v8, 1, s59
    v_cvt_f32_u32 v112, v112
    v_mul_f32 v109, v108, v112
    v_fmamk_f32 v92, v108, 0x0, v109
    v_fmamk_f32 v93, v108, 0x41800000, v109
    v_fmamk_f32 v94, v108, 0x42000000, v109
    v_fmamk_f32 v95, v108, 0x42400000, v109
    v_fmamk_f32 v96, v108, 0x42800000, v109
    v_fmamk_f32 v97, v108, 0x42a00000, v109
    v_fmamk_f32 v98, v108, 0x42c00000, v109
    v_fmamk_f32 v99, v108, 0x42e00000, v109
    v_sin_f32 v92, v92
    v_sin_f32 v93, v93
    v_sin_f32 v94, v94
    v_sin_f32 v95, v95
    v_sin_f32 v96, v96
    v_sin_f32 v97, v97
    v_sin_f32 v98, v98
    v_sin_f32 v99, v99
    v_mul_f32 v92, v92, v110
    v_mul_f32 v99, v99, v111
    v_cvt_pk_bf16_f32 v38, v92, v93
    v_cvt_pk_bf16_f32 v39, v94, v95
    v_cvt_pk_bf16_f32 v40, v96, v97
    v_cvt_pk_bf16_f32 v41, v98, v99
    v_fmamk_f32 v92, v108, 0x41000000, v109
    v_fmamk_f32 v93, v108, 0x41c00000, v109
    v_fmamk_f32 v94, v108, 0x42200000, v109
    v_fmamk_f32 v95, v108, 0x42600000, v109
    v_fmamk_f32 v96, v108, 0x42900000, v109
    v_fmamk_f32 v97, v108, 0x42b00000, v109
    v_fmamk_f32 v98, v108, 0x42d00000, v109
    v_sin_f32 v92, v92
    v_sin_f32 v93, v93
    v_sin_f32 v94, v94
    v_sin_f32 v95, v95
    v_sin_f32 v96, v96
    v_sin_f32 v97, v97
    v_sin_f32 v98, v98
    v_mov_b32 v99, 0
    v_cvt_pk_bf16_f32 v42, v92, v93
    v_cvt_pk_bf16_f32 v43, v94, v95
    v_cvt_pk_bf16_f32 v44, v96, v97
    v_cvt_pk_bf16_f32 v45, v98, v99
    s_add_u32 s60, s8, 1024
    s_cmp_eq_u32 s8, 0
    s_cselect_b32 s60, 32, s60
    v_lshl_add_u32 v112, v9, 6, s8
    v_cvt_f32_u32 v108, v112
    v_mul_f32 v108, 0x3a000000, v108
    v_lshlrev_b32 v112, 2, v8
    v_cvt_f32_u32 v112, v112
    v_mul_f32 v109, v108, v112
    v_fmamk_f32 v92, v108, 0x0, v109
    v_fmamk_f32 v93, v108, 0x3f800000, v109
    s_add_u32 m0, s49, 10240
    s_mov_b32 exec_hi, 0
    buffer_load_dwordx4 v23, s[16:19], s52 offen lds
    s_mov_b32 exec_hi, -1
    s_add_u32 m0, s50, 104448
    s_nop 0
    buffer_load_dwordx4 v24, s[20:23], s53 offen lds
    buffer_load_dwordx4 v25, s[20:23], s53 offen offset:1024 lds
    s_waitcnt lgkmcnt(0)
    s_add_u32 s12, s10, 0x5a3c9671
    s_xor_b32 s13, s11, 0x2b7e1516
    s_add_u32 s28, s28, s12
    s_mov_b32 s29, s13
    s_waitcnt vmcnt(5)
    s_barrier
    s_add_u32 m0, s50, 112640
    s_nop 0
    buffer_load_dwordx4 v26, s[20:23], s53 offen lds
    v_fmamk_f32 v94, v108, 0x40000000, v109
    v_fmamk_f32 v95, v108, 0x40400000, v109
    v_fmamk_f32 v96, v108, 0x41800000, v109
    buffer_load_dwordx4 v27, s[20:23], s53 offen offset:1024 lds
    v_fmamk_f32 v97, v108, 0x41880000, v109
    v_fmamk_f32 v98, v108, 0x41900000, v109
    v_fmamk_f32 v99, v108, 0x41980000, v109
    s_add_u32 m0, s50, 120832
    s_mul_i32 s53, s45, 172032
    s_add_u32 s53, s53, s48
    s_add_u32 s45, s45, 1
    s_cmp_eq_u32 s45, 7
    s_cselect_b32 s45, 0, s45
    buffer_load_dwordx4 v28, s[20:23], s53 offen lds
    v_sin_f32 v100, v92
    v_cos_f32 v92, v92
    v_sin_f32 v101, v93
    buffer_load_dwordx4 v29, s[20:23], s53 offen offset:1024 lds
    v_cos_f32 v93, v93
    v_sin_f32 v102, v94
    v_cos_f32 v94, v94
    s_lshl_b32 s40, s44, 7
    s_add_u32 s51, s40, s46
    s_add_u32 s52, s40, s47
    s_mul_i32 s53, s44, 172032
    s_add_u32 s53, s53, s48
    s_add_u32 m0, s50, 22528
    s_add_u32 s44, s44, 1
    s_cmp_eq_u32 s44, 7
    s_cselect_b32 s44, 0, s44
    buffer_load_dwordx4 v21, s[16:19], s51 offen lds
    v_sin_f32 v103, v95
    v_cos_f32 v95, v95
    v_sin_f32 v104, v96
    buffer_load_dwordx4 v22, s[16:19], s51 offen offset:1024 lds
    v_cos_f32 v96, v96
    v_sin_f32 v105, v97
    v_cos_f32 v97, v97
    s_add_u32 m0, s49, 20480
    s_mov_b32 exec_hi, 0
    buffer_load_dwordx4 v23, s[16:19], s52 offen lds
    s_mov_b32 exec_hi, -1
    v_sin_f32 v106, v98
    v_cos_f32 v98, v98
    v_sin_f32 v107, v99
    s_add_u32 m0, s50, 129024
    s_nop 0
    buffer_load_dwordx4 v24, s[20:23], s53 offen lds
    v_cos_f32 v99, v99
    v_cvt_pk_bf16_f32 v46, v92, v93
    v_cvt_pk_bf16_f32 v54, v100, v101
    buffer_load_dwordx4 v25, s[20:23], s53 offen offset:1024 lds
    v_mov_b32 v70, v46
    v_xor_b32 v62, 0x80008000, v54
    v_cvt_pk_bf16_f32 v47, v94, v95
    s_add_u32 m0, s50, 137216
    s_nop 0
    buffer_load_dwordx4 v26, s[20:23], s53 offen lds
    v_cvt_pk_bf16_f32 v55, v102, v103
    v_mov_b32 v71, v47
    v_xor_b32 v63, 0x80008000, v55
    buffer_load_dwordx4 v27, s[20:23], s53 offen offset:1024 lds
    v_cvt_pk_bf16_f32 v48, v96, v97
    v_cvt_pk_bf16_f32 v56, v104, v105
    v_mov_b32 v72, v48
    s_add_u32 m0, s50, 145408
    s_mul_i32 s53, s45, 172032
    s_add_u32 s53, s53, s48
    s_add_u32 s45, s45, 1
    s_cmp_eq_u32 s45, 7
    s_cselect_b32 s45, 0, s45
    buffer_load_dwordx4 v28, s[20:23], s53 offen lds
    v_xor_b32 v64, 0x80008000, v56
    v_cvt_pk_bf16_f32 v49, v98, v99
    v_cvt_pk_bf16_f32 v57, v106, v107
    buffer_load_dwordx4 v29, s[20:23], s53 offen offset:1024 lds
    v_mov_b32 v73, v49
    v_xor_b32 v65, 0x80008000, v57
    v_lshl_add_u32 v112, v9, 6, s60
    s_lshl_b32 s40, s44, 7
    s_add_u32 s51, s40, s46
    s_add_u32 s52, s40, s47
    s_mul_i32 s53, s44, 172032
    s_add_u32 s53, s53, s48
    s_add_u32 m0, s50, 32768
    s_add_u32 s44, s44, 1
    s_cmp_eq_u32 s44, 7
    s_cselect_b32 s44, 0, s44
    buffer_load_dwordx4 v21, s[16:19], s51 offen lds
    v_cvt_f32_u32 v108, v112
    v_mul_f32 v108, 0x3a000000, v108
    v_lshlrev_b32 v112, 2, v8
    s_waitcnt vmcnt(10)
    s_barrier
    buffer_load_dwordx4 v22, s[16:19], s51 offen offset:1024 lds
    v_cvt_f32_u32 v112, v112
    v_mul_f32 v109, v108, v112
    v_fmamk_f32 v92, v108, 0x0, v109
    s_add_u32 m0, s49, 30720
    s_mov_b32 exec_hi, 0
    buffer_load_dwordx4 v23, s[16:19], s52 offen lds
    s_mov_b32 exec_hi, -1
    v_fmamk_f32 v93, v108, 0x3f800000, v109
    v_fmamk_f32 v94, v108, 0x40000000, v109
    v_fmamk_f32 v95, v108, 0x40400000, v109
    s_add_u32 m0, s50, 153600
    s_nop 0
    buffer_load_dwordx4 v24, s[20:23], s53 offen lds
    v_fmamk_f32 v96, v108, 0x41800000, v109
    v_fmamk_f32 v97, v108, 0x41880000, v109
    v_fmamk_f32 v98, v108, 0x41900000, v109
    buffer_load_dwordx4 v25, s[20:23], s53 offen offset:1024 lds
    v_fmamk_f32 v99, v108, 0x41980000, v109
    v_sin_f32 v100, v92
    v_cos_f32 v92, v92
    s_add_u32 m0, s50, 71680
    s_nop 0
    buffer_load_dwordx4 v26, s[20:23], s53 offen lds
    v_sin_f32 v101, v93
    v_cos_f32 v93, v93
    v_sin_f32 v102, v94
    buffer_load_dwordx4 v27, s[20:23], s53 offen offset:1024 lds
    v_cos_f32 v94, v94
    v_sin_f32 v103, v95
    v_cos_f32 v95, v95
    s_add_u32 m0, s50, 79872
    s_mul_i32 s53, s45, 172032
    s_add_u32 s53, s53, s48
    s_add_u32 s45, s45, 1
    s_cmp_eq_u32 s45, 7
    s_cselect_b32 s45, 0, s45
    buffer_load_dwordx4 v28, s[20:23], s53 offen lds
    v_sin_f32 v104, v96
    v_cos_f32 v96, v96
    v_sin_f32 v105, v97
    buffer_load_dwordx4 v29, s[20:23], s53 offen offset:1024 lds
    v_cos_f32 v97, v97
    v_sin_f32 v106, v98
    v_cos_f32 v98, v98
    s_lshl_b32 s40, s44, 7
    s_add_u32 s51, s40, s46
    s_add_u32 s52, s40, s47
    s_mul_i32 s53, s44, 172032
    s_add_u32 s53, s53, s48
    s_add_u32 m0, s50, 43008
    s_add_u32 s44, s44, 1
    s_cmp_eq_u32 s44, 7
    s_cselect_b32 s44, 0, s44
    buffer_load_dwordx4 v21, s[16:19], s51 offen lds
    v_sin_f32 v107, v99
    v_cos_f32 v99, v99
    v_cvt_pk_bf16_f32 v50, v92, v93
    buffer_load_dwordx4 v22, s[16:19], s51 offen offset:1024 lds
    v_cvt_pk_bf16_f32 v58, v100, v101
    v_mov_b32 v74, v50
    v_xor_b32 v66, 0x80008000, v58
    s_add_u32 m0, s49, 40960
    s_mov_b32 exec_hi, 0
    buffer_load_dwordx4 v23, s[16:19], s52 offen lds
    s_mov_b32 exec_hi, -1
    v_cvt_pk_bf16_f32 v51, v94, v95
    v_cvt_pk_bf16_f32 v59, v102, v103
    v_mov_b32 v75, v51
    s_waitcnt vmcnt(12)
    s_barrier
    s_add_u32 m0, s50, 88064
    s_nop 0
    buffer_load_dwordx4 v24, s[20:23], s53 offen lds
    v_xor_b32 v67, 0x80008000, v59
    v_cvt_pk_bf16_f32 v52, v96, v97
    v_cvt_pk_bf16_f32 v60, v104, v105
    buffer_load_dwordx4 v25, s[20:23], s53 offen offset:1024 lds
    v_mov_b32 v76, v52
    v_xor_b32 v68, 0x80008000, v60
    v_cvt_pk_bf16_f32 v53, v98, v99
    s_add_u32 m0, s50, 96256
    s_nop 0
    buffer_load_dwordx4 v26, s[20:23], s53 offen lds
    v_cvt_pk_bf16_f32 v61, v106, v107
    v_mov_b32 v77, v53
    v_xor_b32 v69, 0x80008000, v61
    buffer_load_dwordx4 v27, s[20:23], s53 offen offset:1024 lds
    v_lshrrev_b32 v112, 1, v9
    v_xor_b32 v113, v112, v8
    v_lshlrev_b32 v113, 4, v113
    s_add_u32 m0, s50, 104448
    s_mul_i32 s53, s45, 172032
    s_add_u32 s53, s53, s48
    s_add_u32 s45, s45, 1
    s_cmp_eq_u32 s45, 7
    s_cselect_b32 s45, 0, s45
    buffer_load_dwordx4 v28, s[20:23], s53 offen lds
    v_lshl_add_u32 v113, v9, 7, v113
    s_lshl_b32 s56, s3, 13
    v_add_u32 v90, s56, v113
    buffer_load_dwordx4 v29, s[20:23], s53 offen offset:1024 lds
    v_xor_b32 v91, 64, v90
    v_and_b32 v112, 3, v112
    v_xor_b32 v112, v112, v8
    buffer_load_dwordx2 v[18:19], v20, s[36:39], s30 offen sc1
    v_lshl_add_u32 v112, v9, 2, v112
    v_lshlrev_b32 v112, 4, v112
    s_lshl_b32 s57, s3, 11
    s_lshl_b32 s40, s44, 7
    s_add_u32 s51, s40, s46
    s_add_u32 s52, s40, s47
    s_mul_i32 s53, s44, 172032
    s_add_u32 s53, s53, s48
    s_add_u32 m0, s50, 53248
    s_add_u32 s44, s44, 1
    s_cmp_eq_u32 s44, 7
    s_cselect_b32 s44, 0, s44
    buffer_load_dwordx4 v21, s[16:19], s51 offen lds
    v_add_u32 v82, s57, v112
    v_xor_b32 v83, 4096, v82
    v_mov_b32 v84, v83
    buffer_load_dwordx4 v22, s[16:19], s51 offen offset:1024 lds
    v_bfe_u32 v112, v1, 3, 2
    v_xor_b32 v112, v112, v1
    v_lshlrev_b32 v112, 4, v112
    s_waitcnt vmcnt(12)
    s_barrier
    s_add_u32 m0, s49, 51200
    s_mov_b32 exec_hi, 0
    buffer_load_dwordx4 v23, s[16:19], s52 offen lds
    s_mov_b32 exec_hi, -1
    s_lshl_b32 s57, s58, 10
    v_add_u32 v85, s57, v112
    s_cmp_eq_u32 s58, 0
    s_cselect_b32 s57, s8, s60
    s_add_u32 m0, s50, 112640
    s_nop 0
    buffer_load_dwordx4 v24, s[20:23], s53 offen lds
    v_lshrrev_b32 v112, 2, v1
    v_lshl_add_u32 v86, v112, 6, s57
    v_sub_u32 v87, 2048, v86
    buffer_load_dwordx4 v25, s[20:23], s53 offen offset:1024 lds
    v_mov_b32 v112, 1024
    v_cmp_eq_u32 vcc, 0, v86
    s_nop 1
    v_cndmask_b32 v87, v87, v112, vcc
    v_and_b32 v112, 3, v1
    s_add_u32 m0, s50, 120832
    s_nop 0
    buffer_load_dwordx4 v26, s[20:23], s53 offen lds
    v_lshlrev_b32 v112, 4, v112
    s_lshl_b32 s56, s7, 6
    s_mul_i32 s57, s59, 448
    buffer_load_dwordx4 v27, s[20:23], s53 offen offset:1024 lds
    s_add_u32 s56, s56, s57
    v_add_u32 v112, s56, v112
    v_mov_b32 v113, 1792
    s_add_u32 m0, s50, 129024
    s_mul_i32 s53, s45, 172032
    s_add_u32 s53, s53, s48
    s_add_u32 s45, s45, 1
    s_cmp_eq_u32 s45, 7
    s_cselect_b32 s45, 0, s45
    buffer_load_dwordx4 v28, s[20:23], s53 offen lds
    v_mad_u32_u24 v86, v86, v113, v112
    v_mad_u32_u24 v87, v87, v113, v112
    s_cmp_eq_u32 s59, 0
    s_cselect_b32 s61, 1.0, -1.0
    buffer_load_dwordx4 v29, s[20:23], s53 offen offset:1024 lds
    v_mov_b32 v78, 0
    v_mov_b32 v79, 0
    v_mov_b32 v80, 0
    s_lshl_b32 s40, s44, 7
    s_add_u32 s51, s40, s46
    s_add_u32 s52, s40, s47
    s_mul_i32 s53, s44, 172032
    s_add_u32 s53, s53, s48
    s_add_u32 m0, s50, 63488
    s_add_u32 s44, s44, 1
    s_cmp_eq_u32 s44, 7
    s_cselect_b32 s44, 0, s44
    buffer_load_dwordx4 v21, s[16:19], s51 offen lds
    v_mov_b32 v81, 0
    s_cmp_eq_u32 s8, 0
    s_cbranch_scc1 H_cls0
H_reg:
    s_waitcnt vmcnt(11)
    s_barrier
    buffer_load_dwordx4 v22, s[16:19], s51 offen offset:1024 lds
    s_add_u32 m0, s49, 61440
    s_mov_b32 exec_hi, 0
    buffer_load_dwordx4 v23, s[16:19], s52 offen lds
    s_mov_b32 exec_hi, -1
    s_add_u32 m0, s50, 137216
    s_nop 0
    buffer_load_dwordx4 v24, s[20:23], s53 offen lds
    buffer_load_dwordx4 v25, s[20:23], s53 offen offset:1024 lds
    s_add_u32 m0, s50, 145408
    s_nop 0
    buffer_load_dwordx4 v26, s[20:23], s53 offen lds
    buffer_load_dwordx4 v27, s[20:23], s53 offen offset:1024 lds
    s_add_u32 m0, s50, 153600
    s_mul_i32 s53, s45, 172032
    s_add_u32 s53, s53, s48
    s_add_u32 s45, s45, 1
    s_cmp_eq_u32 s45, 7
    s_cselect_b32 s45, 0, s45
    buffer_load_dwordx4 v28, s[20:23], s53 offen lds
    buffer_load_dwordx4 v29, s[20:23], s53 offen offset:1024 lds
    s_waitcnt vmcnt(9)
    s_barrier
    s_mov_b32 s101, 1

    v_cmp_ne_u64 vcc, s[28:29], v[18:19]
    s_nop 0
    s_cbranch_vccnz X_cH
        X_okH:

    v_mov_b32 v2, s101
    ds_write_b32 v5, v2 offset:4
    s_lshl_b32 s40, s54, 13
    s_add_u32 s40, s40, s50
    s_add_u32 m0, s40, 71680
    s_mul_i32 s40, s54, 57344
    s_add_u32 s40, s40, s55
    s_add_u32 s54, s54, 1
    s_cmp_eq_u32 s54, 4
    s_cselect_b32 s54, 0, s54
    buffer_load_dwordx4 v10, s[24:27], s40 offen lds
    buffer_load_dwordx4 v11, s[24:27], s40 offen offset:1024 lds
    s_lshl_b32 s40, s54, 13
    s_add_u32 s40, s40, s50
    s_add_u32 m0, s40, 71680
    s_mul_i32 s40, s54, 57344
    s_add_u32 s40, s40, s55
    s_add_u32 s54, s54, 1
    s_cmp_eq_u32 s54, 4
    s_cselect_b32 s54, 0, s54
    buffer_load_dwordx4 v10, s[24:27], s40 offen lds
    s_waitcnt lgkmcnt(0)
    s_waitcnt vmcnt(5)
    s_barrier
    s_setprio 0
    buffer_load_dwordx4 v11, s[24:27], s40 offen offset:1024 lds
    s_lshl_b32 s40, s54, 13
    s_add_u32 s40, s40, s50
    s_add_u32 m0, s40, 71680
    s_mul_i32 s40, s54, 57344
    s_add_u32 s40, s40, s55
    s_add_u32 s54, s54, 1
    s_cmp_eq_u32 s54, 4
    s_cselect_b32 s54, 0, s54
    buffer_load_dwordx4 v10, s[24:27], s40 offen lds
    buffer_load_dwordx4 v11, s[24:27], s40 offen offset:1024 lds
    buffer_load_dword v13, v12, s[36:39], 0 offen sc1
    s_lshl_b32 s40, s54, 13
    s_add_u32 s40, s40, s50
    s_add_u32 m0, s40, 71680
    s_mul_i32 s40, s54, 57344
    s_add_u32 s40, s40, s55
    s_add_u32 s54, s54, 1
    s_cmp_eq_u32 s54, 4
    s_cselect_b32 s54, 0, s54
    buffer_load_dwordx4 v10, s[24:27], s40 offen lds
    buffer_load_dwordx4 v11, s[24:27], s40 offen offset:1024 lds
    s_waitcnt vmcnt(9)
    s_mov_b64 exec, 1
    ds_add_u32 v5, v14 offset:32
    s_mov_b64 exec, -1
    s_add_u32 m0, s50, 104448
    s_add_u32 s40, s55, 229376
    buffer_load_dwordx4 v10, s[24:27], s40 offen lds
    buffer_load_dwordx4 v11, s[24:27], s40 offen offset:1024 lds
    s_add_u32 m0, s50, 112640
    s_add_u32 s40, s55, 286720
    buffer_load_dwordx4 v10, s[24:27], s40 offen lds
    buffer_load_dwordx4 v11, s[24:27], s40 offen offset:1024 lds
    s_add_u32 m0, s50, 120832
    s_add_u32 s40, s55, 344064
    buffer_load_dwordx4 v10, s[24:27], s40 offen lds
    buffer_load_dwordx4 v11, s[24:27], s40 offen offset:1024 lds
    buffer_load_dwordx2 v[16:17], v4, s[36:39], s63 offen sc1
    s_waitcnt vmcnt(0)
    s_mov_b64 exec, 1
    ds_add_u32 v5, v14 offset:12
    s_mov_b64 exec, -1

    v_cmp_ne_u64 vcc, s[12:13], v[16:17]
    s_nop 0
    s_cbranch_vccnz H_ng
    s_lshl_b32 s40, s3, 13
    s_add_u32 m0, s40, 0
    s_add_u32 s41, s62, 4096
    buffer_load_dwordx4 v88, s[36:39], s62 offen offset:0 sc1 lds
    buffer_load_dwordx4 v89, s[36:39], s62 offen offset:1024 sc1 lds
    buffer_load_dwordx4 v88, s[36:39], s62 offen offset:2048 sc1 lds
    buffer_load_dwordx4 v89, s[36:39], s62 offen offset:3072 sc1 lds
    s_add_u32 m0, s40, 4096
    s_nop 0
    buffer_load_dwordx4 v88, s[36:39], s41 offen offset:0 sc1 lds
    buffer_load_dwordx4 v89, s[36:39], s41 offen offset:1024 sc1 lds
    buffer_load_dwordx4 v88, s[36:39], s41 offen offset:2048 sc1 lds
    buffer_load_dwordx4 v89, s[36:39], s41 offen offset:3072 sc1 lds
    s_mov_b32 s14, 1
H_ng:
    s_cmp_lg_u32 s14, 0
    s_cbranch_scc1 H_go
    s_mov_b32 s9, 0
    buffer_load_dwordx2 v[16:17], v4, s[36:39], s63 offen sc1
        P_lR:
    s_waitcnt vmcnt(0)
    v_cmp_ne_u64 vcc, s[12:13], v[16:17]
    s_nop 0
    s_cbranch_vccz P_dR
    buffer_load_dwordx2 v[16:17], v4, s[36:39], s63 offen sc1
    s_add_u32 s9, s9, 1
    s_cmp_lt_u32 s9, 200000
    s_cbranch_scc1 P_lR
    s_waitcnt vmcnt(0)
        P_dR:

    s_lshl_b32 s40, s3, 13
    s_add_u32 m0, s40, 0
    s_add_u32 s41, s62, 4096
    buffer_load_dwordx4 v88, s[36:39], s62 offen offset:0 sc1 lds
    buffer_load_dwordx4 v89, s[36:39], s62 offen offset:1024 sc1 lds
    buffer_load_dwordx4 v88, s[36:39], s62 offen offset:2048 sc1 lds
    buffer_load_dwordx4 v89, s[36:39], s62 offen offset:3072 sc1 lds
    s_add_u32 m0, s40, 4096
    s_nop 0
    buffer_load_dwordx4 v88, s[36:39], s41 offen offset:0 sc1 lds
    buffer_load_dwordx4 v89, s[36:39], s41 offen offset:1024 sc1 lds
    buffer_load_dwordx4 v88, s[36:39], s41 offen offset:2048 sc1 lds
    buffer_load_dwordx4 v89, s[36:39], s41 offen offset:3072 sc1 lds
H_go:
    s_waitcnt lgkmcnt(0)
    s_waitcnt vmcnt(6)
    ds_read_b128 v[114:117], v90 offset:0
    ds_read_b128 v[118:121], v91 offset:0
    s_waitcnt vmcnt(4)
    ds_read_b128 v[122:125], v90 offset:2048
    ds_read_b128 v[126:129], v91 offset:2048
    s_waitcnt lgkmcnt(3)
    v_mfma_f32_16x16x32_bf16 v[146:149], v[114:117], v[30:33], 0
    v_mfma_f32_16x16x32_bf16 v[162:165], v[114:117], v[38:41], 0
    s_waitcnt lgkmcnt(2)
    v_mfma_f32_16x16x32_bf16 v[146:149], v[118:121], v[34:37], v[146:149]
    v_mfma_f32_16x16x32_bf16 v[162:165], v[118:121], v[42:45], v[162:165]
    s_waitcnt vmcnt(2)
    ds_read_b128 v[130:133], v90 offset:4096
    ds_read_b128 v[134:137], v91 offset:4096
    s_waitcnt lgkmcnt(3)
    v_mfma_f32_16x16x32_bf16 v[150:153], v[122:125], v[30:33], 0
    v_mfma_f32_16x16x32_bf16 v[166:169], v[122:125], v[38:41], 0
    s_waitcnt lgkmcnt(2)
    v_mfma_f32_16x16x32_bf16 v[150:153], v[126:129], v[34:37], v[150:153]
    v_mfma_f32_16x16x32_bf16 v[166:169], v[126:129], v[42:45], v[166:169]
    s_waitcnt vmcnt(0)
    ds_read_b128 v[138:141], v90 offset:6144
    ds_read_b128 v[142:145], v91 offset:6144
    v_cvt_pk_bf16_f32 v178, v146, v147
    v_cvt_pk_bf16_f32 v179, v148, v149
    v_cvt_pk_bf16_f32 v186, v162, v163
    v_cvt_pk_bf16_f32 v187, v164, v165
    s_waitcnt lgkmcnt(3)
    v_mfma_f32_16x16x32_bf16 v[154:157], v[130:133], v[30:33], 0
    v_mfma_f32_16x16x32_bf16 v[170:173], v[130:133], v[38:41], 0
    s_waitcnt lgkmcnt(2)
    v_mfma_f32_16x16x32_bf16 v[154:157], v[134:137], v[34:37], v[154:157]
    v_mfma_f32_16x16x32_bf16 v[170:173], v[134:137], v[42:45], v[170:173]
    v_cvt_pk_bf16_f32 v180, v150, v151
    v_cvt_pk_bf16_f32 v181, v152, v153
    v_cvt_pk_bf16_f32 v188, v166, v167
    v_cvt_pk_bf16_f32 v189, v168, v169
    s_waitcnt lgkmcnt(1)
    v_mfma_f32_16x16x32_bf16 v[158:161], v[138:141], v[30:33], 0
    v_mfma_f32_16x16x32_bf16 v[174:177], v[138:141], v[38:41], 0
    s_waitcnt lgkmcnt(0)
    v_mfma_f32_16x16x32_bf16 v[158:161], v[142:145], v[34:37], v[158:161]
    v_mfma_f32_16x16x32_bf16 v[174:177], v[142:145], v[42:45], v[174:177]
    v_mfma_f32_16x16x32_bf16 v[194:197], v[178:181], v[46:49], 0
    v_mfma_f32_16x16x32_bf16 v[202:205], v[186:189], v[62:65], 0
    v_cvt_pk_bf16_f32 v182, v154, v155
    v_cvt_pk_bf16_f32 v183, v156, v157
    v_cvt_pk_bf16_f32 v190, v170, v171
    v_cvt_pk_bf16_f32 v191, v172, v173
    v_mfma_f32_16x16x32_bf16 v[198:201], v[178:181], v[50:53], 0
    v_mfma_f32_16x16x32_bf16 v[206:209], v[186:189], v[66:69], 0
    v_cvt_pk_bf16_f32 v184, v158, v159
    v_cvt_pk_bf16_f32 v185, v160, v161
    v_cvt_pk_bf16_f32 v192, v174, v175
    v_cvt_pk_bf16_f32 v193, v176, v177
    v_mfma_f32_16x16x32_bf16 v[202:205], v[178:181], v[78:81], v[202:205]
    v_mfma_f32_16x16x32_bf16 v[194:197], v[182:185], v[54:57], v[194:197]
    v_mfma_f32_16x16x32_bf16 v[202:205], v[190:193], v[70:73], v[202:205]
    v_mfma_f32_16x16x32_bf16 v[198:201], v[182:185], v[58:61], v[198:201]
    v_mfma_f32_16x16x32_bf16 v[206:209], v[190:193], v[74:77], v[206:209]
    v_mov_b32 v2, 1
    s_mov_b32 s9, 0
    s_nop 2
    ds_write_b128 v82, v[194:197] offset:32768
    ds_write_b128 v83, v[202:205] offset:40960
    ds_write_b128 v82, v[198:201] offset:33792
    ds_write_b128 v84, v[206:209] offset:41984
    s_mov_b64 exec, 1
    ds_add_u32 v5, v2
    s_mov_b64 exec, -1
        H_sy:
    ds_read_b32 v2, v5
    s_add_u32 s9, s9, 1
    s_cmp_gt_u32 s9, 1600000
    s_cbranch_scc1 H_sd
    s_waitcnt lgkmcnt(0)
    v_cmp_gt_u32 vcc, 4, v2
    s_nop 0
    s_cbranch_vccnz H_sy
        H_sd:

    ds_read_b128 v[146:149], v85 offset:32768
    ds_read_b128 v[150:153], v85 offset:34816
    ds_read_b128 v[154:157], v85 offset:36864
    ds_read_b128 v[158:161], v85 offset:38912
    ds_read_b128 v[162:165], v85 offset:40960
    ds_read_b128 v[166:169], v85 offset:43008
    ds_read_b128 v[170:173], v85 offset:45056
    ds_read_b128 v[174:177], v85 offset:47104
    s_waitcnt lgkmcnt(6)
    v_fma_f32 v146, v150, s61, v146
    v_fma_f32 v147, v151, s61, v147
    v_fma_f32 v148, v152, s61, v148
    v_fma_f32 v149, v153, s61, v149
    s_waitcnt lgkmcnt(4)
    v_fma_f32 v154, v158, s61, v154
    v_fma_f32 v155, v159, s61, v155
    v_fma_f32 v156, v160, s61, v156
    v_fma_f32 v157, v161, s61, v157
    s_waitcnt lgkmcnt(2)
    v_fma_f32 v162, v166, s61, v162
    v_fma_f32 v163, v167, s61, v163
    v_fma_f32 v164, v168, s61, v164
    v_fma_f32 v165, v169, s61, v165
    s_waitcnt lgkmcnt(0)
    v_fma_f32 v170, v174, s61, v170
    v_fma_f32 v171, v175, s61, v171
    v_fma_f32 v172, v176, s61, v172
    v_fma_f32 v173, v177, s61, v173
    v_pk_add_f32 v[150:151], v[146:147], v[162:163]
    v_pk_add_f32 v[152:153], v[148:149], v[164:165]
    v_pk_add_f32 v[158:159], v[154:155], v[170:171]
    v_pk_add_f32 v[160:161], v[156:157], v[172:173]
    v_cvt_pk_bf16_f32 v114, v150, v158
    v_cvt_pk_bf16_f32 v115, v151, v159
    v_cvt_pk_bf16_f32 v116, v152, v160
    v_cvt_pk_bf16_f32 v117, v153, v161
    buffer_store_dwordx4 v[114:117], v86, s[32:35], 0 offen offset:896
    v_pk_add_f32 v[166:167], v[146:147], v[162:163] neg_lo:[0,1] neg_hi:[0,1]
    v_pk_add_f32 v[168:169], v[148:149], v[164:165] neg_lo:[0,1] neg_hi:[0,1]
    v_pk_add_f32 v[174:175], v[154:155], v[170:171] neg_lo:[0,1] neg_hi:[0,1]
    v_pk_add_f32 v[176:177], v[156:157], v[172:173] neg_lo:[0,1] neg_hi:[0,1]
    v_cvt_pk_bf16_f32 v118, v166, v174
    v_cvt_pk_bf16_f32 v119, v167, v175
    v_cvt_pk_bf16_f32 v120, v168, v176
    v_cvt_pk_bf16_f32 v121, v169, v177
    buffer_store_dwordx4 v[118:121], v87, s[32:35], 0 offen offset:896
    s_add_u32 s40, s7, s3
    s_cmp_lg_u32 s40, 0
    s_cbranch_scc1 H_end
    s_mov_b32 s9, 0
        W_lE:
    ds_read_b32 v2, v5 offset:8
    s_add_u32 s9, s9, 1
    s_cmp_gt_u32 s9, 1600000
    s_cbranch_scc1 W_dE
    s_waitcnt lgkmcnt(0)
    v_cmp_gt_u32 vcc, 1, v2
    s_nop 0
    s_cbranch_vccnz W_lE
        W_dE:

    s_add_u32 s40, s10, 16
    v_mov_b32 v2, s40
    s_lshl_b32 s40, s8, 7
    s_mov_b64 exec, 1
    buffer_store_dword v2, v4, s[36:39], s40 offen
        H_end:

    s_endpgm
        K_spare2:
    s_add_u32 s58, s40, 8192
    s_getreg_b32 s60, hwreg(HW_REG_XCC_ID, 0, 3)
    v_and_b32 v6, 15, v0
    v_lshlrev_b32 v6, 4, v6
    v_bfe_u32 v4, v0, 4, 2
    v_lshl_add_u32 v4, v4, 9, s42
    v_add_u32 v7, v4, v6
    v_sub_u32 v8, v4, v6
    v_add_u32 v8, 432, v8
    v_mov_b32 v38, 0
    s_and_b32 s55, s3, 3
    s_lshr_b32 s56, s3, 2
    v_and_b32 v1, 63, v0
    v_lshrrev_b32 v2, 4, v1
    v_and_b32 v3, 15, v1
    s_lshl_b32 s40, s55, 3
    v_lshrrev_b32 v4, 1, v3
    v_add_u32 v4, s40, v4
    v_and_b32 v5, 1, v3
    v_cvt_f32_u32 v37, v5
    v_mul_f32 v37, 0x3e800000, v37
    v_lshl_add_u32 v5, v4, 1, v5
    v_cmp_eq_u32 vcc, 1, v5
    s_nop 1
    v_cndmask_b32 v4, v4, 32, vcc
    v_cndmask_b32 v37, v37, 0, vcc
    v_cvt_f32_u32 v36, v4
    v_mul_f32 v36, 0x3c800000, v36
    v_lshlrev_b32 v4, 3, v2
    v_cvt_f32_u32 v4, v4
    v_fma_f32 v37, v36, v4, v37

    v_fmamk_f32 v40, v36, 0x0, v37
    v_fmamk_f32 v41, v36, 0x3f800000, v37
    v_fmamk_f32 v42, v36, 0x40000000, v37
    v_fmamk_f32 v43, v36, 0x40400000, v37
    v_fmamk_f32 v44, v36, 0x40800000, v37
    v_fmamk_f32 v45, v36, 0x40a00000, v37
    v_fmamk_f32 v46, v36, 0x40c00000, v37
    v_fmamk_f32 v47, v36, 0x40e00000, v37
    v_cos_f32 v40, v40
    v_cos_f32 v41, v41
    v_cos_f32 v42, v42
    v_cos_f32 v43, v43
    v_cos_f32 v44, v44
    v_cos_f32 v45, v45
    v_cos_f32 v46, v46
    v_cos_f32 v47, v47
    v_cvt_pk_bf16_f32 v28, v40, v41
    v_cvt_pk_bf16_f32 v29, v42, v43
    v_cvt_pk_bf16_f32 v30, v44, v45
    v_cvt_pk_bf16_f32 v31, v46, v47
    v_fmamk_f32 v40, v36, 0x42000000, v37
    v_fmamk_f32 v41, v36, 0x42040000, v37
    v_fmamk_f32 v42, v36, 0x42080000, v37
    v_fmamk_f32 v43, v36, 0x420c0000, v37
    v_fmamk_f32 v44, v36, 0x42100000, v37
    v_fmamk_f32 v45, v36, 0x42140000, v37
    v_fmamk_f32 v46, v36, 0x42180000, v37
    v_fmamk_f32 v47, v36, 0x421c0000, v37
    v_cos_f32 v40, v40
    v_cos_f32 v41, v41
    v_cos_f32 v42, v42
    v_cos_f32 v43, v43
    v_cos_f32 v44, v44
    v_cos_f32 v45, v45
    v_cos_f32 v46, v46
    v_cos_f32 v47, v47
    v_cvt_pk_bf16_f32 v32, v40, v41
    v_cvt_pk_bf16_f32 v33, v42, v43
    v_cvt_pk_bf16_f32 v34, v44, v45
    v_cvt_pk_bf16_f32 v35, v46, v47
    v_lshrrev_b32 v4, 4, v0
    v_and_b32 v5, 3, v4
    v_lshlrev_b32 v5, 6, v5
    v_lshlrev_b32 v48, 1, v6
    v_xor_b32 v48, v48, v5
    v_bfe_u32 v5, v4, 3, 1
    v_lshl_add_u32 v48, v5, 4, v48
    v_lshl_add_u32 v48, v4, 9, v48
    v_add_u32 v48, 65536, v48
    v_xor_b32 v49, 16, v48
    v_lshrrev_b32 v4, 2, v3
    v_lshl_add_u32 v5, v2, 3, v4
    v_lshlrev_b32 v5, 9, v5
    v_lshl_add_u32 v5, v4, 6, v5
    v_and_b32 v4, 1, v1
    v_lshl_add_u32 v5, v4, 5, v5
    v_bfe_u32 v4, v1, 1, 1
    v_lshl_add_u32 v5, v4, 3, v5
    v_and_b32 v4, 1, v2
    v_xor_b32 v4, s56, v4
    v_lshl_add_u32 v53, v4, 4, v5
    v_add_u32 v53, 65536, v53
    v_xor_b32 v54, 64, v53
    v_xor_b32 v55, 128, v53
    v_xor_b32 v56, 192, v53
    v_lshlrev_b32 v50, 16, v2
    v_lshrrev_b32 v4, 3, v3
    v_lshl_add_u32 v50, v4, 13, v50
    v_and_b32 v4, 7, v3
    v_lshl_add_u32 v50, v4, 4, v50
    s_lshl_b32 s40, s8, 1
    s_add_u32 s40, s40, s56
    s_lshl_b32 s41, s40, 7
    s_add_u32 s41, s41, 16384
    s_mul_i32 s40, s40, 28672
    s_mul_i32 s43, s55, 3584
    s_add_u32 s40, s40, s43
    s_add_u32 s40, s40, 2097152
    v_lshl_add_u32 v51, v1, 7, s40
    v_mov_b32 v4, s41
    v_cmp_le_u32 vcc, 28, v1
    s_nop 1
    v_cndmask_b32 v51, v51, v4, vcc
    s_waitcnt lgkmcnt(0)

    s_add_u32 s12, s10, 0x5a3c9671
    s_xor_b32 s13, s11, 0x2b7e1516
    s_add_u32 s60, s60, s12
    s_mov_b32 s61, s13
    s_add_u32 s50, s14, 0x5a3c9671
    s_xor_b32 s51, s15, 0x2b7e1516
    v_cmp_eq_u32 vcc, 0, v6
    s_waitcnt vmcnt(4)
    ds_read_b128 v[10:13], v7 offset:0
    ds_read_b32 v26, v8 offset:2128
    ds_read_b128 v[14:17], v8 offset:2112
    ds_read_b128 v[22:25], v7 offset:2112
    ds_read_b32 v27, v8 offset:16
    ds_read_b128 v[18:21], v8 offset:0
    s_waitcnt lgkmcnt(3)
    v_cndmask_b32 v26, v26, v10, vcc

    v_lshlrev_b32 v58, 16, v10
    v_lshlrev_b32 v74, 16, v26
    v_and_b32 v59, 0xffff0000, v10
    v_and_b32 v75, 0xffff0000, v17
    v_pk_add_f32 v[58:59], v[58:59], v[74:75]
    v_lshlrev_b32 v60, 16, v11
    v_lshlrev_b32 v74, 16, v17
    v_and_b32 v61, 0xffff0000, v11
    v_and_b32 v75, 0xffff0000, v16
    v_pk_add_f32 v[60:61], v[60:61], v[74:75]
    v_lshlrev_b32 v62, 16, v12
    v_lshlrev_b32 v74, 16, v16
    v_and_b32 v63, 0xffff0000, v12
    v_and_b32 v75, 0xffff0000, v15
    v_pk_add_f32 v[62:63], v[62:63], v[74:75]
    v_lshlrev_b32 v64, 16, v13
    v_lshlrev_b32 v74, 16, v15
    v_and_b32 v65, 0xffff0000, v13
    v_and_b32 v75, 0xffff0000, v14
    v_pk_add_f32 v[64:65], v[64:65], v[74:75]
    s_waitcnt lgkmcnt(0)
    v_lshlrev_b32 v66, 16, v22
    v_lshlrev_b32 v74, 16, v27
    v_and_b32 v67, 0xffff0000, v22
    v_and_b32 v75, 0xffff0000, v21
    v_pk_add_f32 v[66:67], v[66:67], v[74:75]
    v_lshlrev_b32 v68, 16, v23
    v_lshlrev_b32 v74, 16, v21
    v_and_b32 v69, 0xffff0000, v23
    v_and_b32 v75, 0xffff0000, v20
    v_pk_add_f32 v[68:69], v[68:69], v[74:75]
    v_lshlrev_b32 v70, 16, v24
    v_lshlrev_b32 v74, 16, v20
    v_and_b32 v71, 0xffff0000, v24
    v_and_b32 v75, 0xffff0000, v19
    v_pk_add_f32 v[70:71], v[70:71], v[74:75]
    v_lshlrev_b32 v72, 16, v25
    v_lshlrev_b32 v74, 16, v19
    v_and_b32 v73, 0xffff0000, v25
    v_and_b32 v75, 0xffff0000, v18
    v_pk_add_f32 v[72:73], v[72:73], v[74:75]
    v_pk_add_f32 v[40:41], v[58:59], v[66:67]
    v_pk_add_f32 v[42:43], v[60:61], v[68:69]
    v_pk_add_f32 v[44:45], v[62:63], v[70:71]
    v_pk_add_f32 v[46:47], v[64:65], v[72:73]
    v_cvt_pk_bf16_f32 v76, v40, v42
    v_cvt_pk_bf16_f32 v77, v44, v46
    v_cvt_pk_bf16_f32 v78, v41, v43
    v_cvt_pk_bf16_f32 v79, v45, v47
    ds_write_b128 v48, v[76:79] offset:0
    v_pk_add_f32 v[40:41], v[58:59], v[66:67] neg_lo:[0,1] neg_hi:[0,1]
    v_pk_add_f32 v[42:43], v[60:61], v[68:69] neg_lo:[0,1] neg_hi:[0,1]
    v_pk_add_f32 v[44:45], v[62:63], v[70:71] neg_lo:[0,1] neg_hi:[0,1]
    v_pk_add_f32 v[46:47], v[64:65], v[72:73] neg_lo:[0,1] neg_hi:[0,1]
    v_cvt_pk_bf16_f32 v80, v40, v42
    v_cvt_pk_bf16_f32 v81, v44, v46
    v_cvt_pk_bf16_f32 v82, v41, v43
    v_cvt_pk_bf16_f32 v83, v45, v47
    ds_write_b128 v49, v[80:83] offset:0
    s_waitcnt lgkmcnt(0)
    s_barrier
    ds_read_b64_tr_b16 v[84:85], v53 offset:0
    ds_read_b64_tr_b16 v[86:87], v53 offset:2048
    ds_read_b64_tr_b16 v[88:89], v54 offset:0
    ds_read_b64_tr_b16 v[90:91], v54 offset:2048
    ds_read_b64_tr_b16 v[92:93], v55 offset:0
    ds_read_b64_tr_b16 v[94:95], v55 offset:2048
    ds_read_b64_tr_b16 v[96:97], v56 offset:0
    ds_read_b64_tr_b16 v[98:99], v56 offset:2048
    ds_read_b64_tr_b16 v[100:101], v53 offset:256
    ds_read_b64_tr_b16 v[102:103], v53 offset:2304
    ds_read_b64_tr_b16 v[104:105], v54 offset:256
    ds_read_b64_tr_b16 v[106:107], v54 offset:2304
    s_waitcnt lgkmcnt(10)
    v_mfma_f32_16x16x32_bf16 v[116:119], v[28:31], v[84:87], 0
    ds_read_b64_tr_b16 v[108:109], v55 offset:256
    ds_read_b64_tr_b16 v[110:111], v55 offset:2304
    s_waitcnt lgkmcnt(10)
    v_mfma_f32_16x16x32_bf16 v[120:123], v[28:31], v[88:91], 0
    ds_read_b64_tr_b16 v[112:113], v56 offset:256
    ds_read_b64_tr_b16 v[114:115], v56 offset:2304
    s_waitcnt lgkmcnt(10)
    v_mfma_f32_16x16x32_bf16 v[124:127], v[28:31], v[92:95], 0
    s_waitcnt lgkmcnt(8)
    v_mfma_f32_16x16x32_bf16 v[128:131], v[28:31], v[96:99], 0
    s_waitcnt lgkmcnt(6)
    v_mfma_f32_16x16x32_bf16 v[132:135], v[28:31], v[100:103], 0
    s_waitcnt lgkmcnt(4)
    v_mfma_f32_16x16x32_bf16 v[136:139], v[28:31], v[104:107], 0
    s_waitcnt lgkmcnt(2)
    v_mfma_f32_16x16x32_bf16 v[140:143], v[28:31], v[108:111], 0
    s_waitcnt lgkmcnt(0)
    v_mfma_f32_16x16x32_bf16 v[144:147], v[28:31], v[112:115], 0
    s_waitcnt vmcnt(0)
    ds_read_b128 v[10:13], v7 offset:4096
    ds_read_b32 v26, v8 offset:6224
    ds_read_b128 v[14:17], v8 offset:6208
    ds_read_b128 v[22:25], v7 offset:6208
    ds_read_b32 v27, v8 offset:4112
    ds_read_b128 v[18:21], v8 offset:4096
    s_waitcnt lgkmcnt(3)
    v_cndmask_b32 v26, v26, v10, vcc

    v_lshlrev_b32 v58, 16, v10
    v_lshlrev_b32 v74, 16, v26
    v_and_b32 v59, 0xffff0000, v10
    v_and_b32 v75, 0xffff0000, v17
    v_pk_add_f32 v[58:59], v[58:59], v[74:75]
    v_lshlrev_b32 v60, 16, v11
    v_lshlrev_b32 v74, 16, v17
    v_and_b32 v61, 0xffff0000, v11
    v_and_b32 v75, 0xffff0000, v16
    v_pk_add_f32 v[60:61], v[60:61], v[74:75]
    v_lshlrev_b32 v62, 16, v12
    v_lshlrev_b32 v74, 16, v16
    v_and_b32 v63, 0xffff0000, v12
    v_and_b32 v75, 0xffff0000, v15
    v_pk_add_f32 v[62:63], v[62:63], v[74:75]
    v_lshlrev_b32 v64, 16, v13
    v_lshlrev_b32 v74, 16, v15
    v_and_b32 v65, 0xffff0000, v13
    v_and_b32 v75, 0xffff0000, v14
    v_pk_add_f32 v[64:65], v[64:65], v[74:75]
    s_waitcnt lgkmcnt(0)
    v_lshlrev_b32 v66, 16, v22
    v_lshlrev_b32 v74, 16, v27
    v_and_b32 v67, 0xffff0000, v22
    v_and_b32 v75, 0xffff0000, v21
    v_pk_add_f32 v[66:67], v[66:67], v[74:75]
    v_lshlrev_b32 v68, 16, v23
    v_lshlrev_b32 v74, 16, v21
    v_and_b32 v69, 0xffff0000, v23
    v_and_b32 v75, 0xffff0000, v20
    v_pk_add_f32 v[68:69], v[68:69], v[74:75]
    v_lshlrev_b32 v70, 16, v24
    v_lshlrev_b32 v74, 16, v20
    v_and_b32 v71, 0xffff0000, v24
    v_and_b32 v75, 0xffff0000, v19
    v_pk_add_f32 v[70:71], v[70:71], v[74:75]
    v_lshlrev_b32 v72, 16, v25
    v_lshlrev_b32 v74, 16, v19
    v_and_b32 v73, 0xffff0000, v25
    v_and_b32 v75, 0xffff0000, v18
    v_pk_add_f32 v[72:73], v[72:73], v[74:75]
    v_pk_add_f32 v[40:41], v[58:59], v[66:67]
    v_pk_add_f32 v[42:43], v[60:61], v[68:69]
    v_pk_add_f32 v[44:45], v[62:63], v[70:71]
    v_pk_add_f32 v[46:47], v[64:65], v[72:73]
    v_cvt_pk_bf16_f32 v76, v40, v42
    v_cvt_pk_bf16_f32 v77, v44, v46
    v_cvt_pk_bf16_f32 v78, v41, v43
    v_cvt_pk_bf16_f32 v79, v45, v47
    ds_write_b128 v48, v[76:79] offset:16384
    v_pk_add_f32 v[40:41], v[58:59], v[66:67] neg_lo:[0,1] neg_hi:[0,1]
    v_pk_add_f32 v[42:43], v[60:61], v[68:69] neg_lo:[0,1] neg_hi:[0,1]
    v_pk_add_f32 v[44:45], v[62:63], v[70:71] neg_lo:[0,1] neg_hi:[0,1]
    v_pk_add_f32 v[46:47], v[64:65], v[72:73] neg_lo:[0,1] neg_hi:[0,1]
    v_cvt_pk_bf16_f32 v80, v40, v42
    v_cvt_pk_bf16_f32 v81, v44, v46
    v_cvt_pk_bf16_f32 v82, v41, v43
    v_cvt_pk_bf16_f32 v83, v45, v47
    ds_write_b128 v49, v[80:83] offset:16384
    s_lshl_b32 s40, s55, 18
    s_lshl_b32 s41, s56, 14
    s_add_u32 s40, s40, s41
    s_lshl_b32 s41, s8, 7
    s_add_u32 s40, s40, s41
    s_add_u32 s40, s40, 1048576
    s_waitcnt lgkmcnt(0)
    s_barrier

    ds_read_b64_tr_b16 v[84:85], v53 offset:16384
    ds_read_b64_tr_b16 v[86:87], v53 offset:18432
    ds_read_b64_tr_b16 v[88:89], v54 offset:16384
    ds_read_b64_tr_b16 v[90:91], v54 offset:18432
    ds_read_b64_tr_b16 v[92:93], v55 offset:16384
    ds_read_b64_tr_b16 v[94:95], v55 offset:18432
    ds_read_b64_tr_b16 v[96:97], v56 offset:16384
    ds_read_b64_tr_b16 v[98:99], v56 offset:18432
    ds_read_b64_tr_b16 v[100:101], v53 offset:16640
    ds_read_b64_tr_b16 v[102:103], v53 offset:18688
    ds_read_b64_tr_b16 v[104:105], v54 offset:16640
    ds_read_b64_tr_b16 v[106:107], v54 offset:18688
    s_waitcnt lgkmcnt(10)
    v_mfma_f32_16x16x32_bf16 v[116:119], v[32:35], v[84:87], v[116:119]
    ds_read_b64_tr_b16 v[108:109], v55 offset:16640
    ds_read_b64_tr_b16 v[110:111], v55 offset:18688
    s_waitcnt lgkmcnt(10)
    v_mfma_f32_16x16x32_bf16 v[120:123], v[32:35], v[88:91], v[120:123]
    ds_read_b64_tr_b16 v[112:113], v56 offset:16640
    ds_read_b64_tr_b16 v[114:115], v56 offset:18688
    s_waitcnt lgkmcnt(10)
    v_mfma_f32_16x16x32_bf16 v[124:127], v[32:35], v[92:95], v[124:127]
    s_waitcnt lgkmcnt(8)
    v_mfma_f32_16x16x32_bf16 v[128:131], v[32:35], v[96:99], v[128:131]
    s_waitcnt lgkmcnt(6)
    v_mfma_f32_16x16x32_bf16 v[132:135], v[32:35], v[100:103], v[132:135]
    s_waitcnt lgkmcnt(4)
    v_mfma_f32_16x16x32_bf16 v[136:139], v[32:35], v[104:107], v[136:139]
    s_waitcnt lgkmcnt(2)
    v_mfma_f32_16x16x32_bf16 v[140:143], v[32:35], v[108:111], v[140:143]
    s_waitcnt lgkmcnt(0)
    v_mfma_f32_16x16x32_bf16 v[144:147], v[32:35], v[112:115], v[144:147]
    v_cvt_pk_bf16_f32 v84, v116, v120
    v_cvt_pk_bf16_f32 v85, v124, v128
    s_nop 1
    v_cvt_pk_bf16_f32 v86, v132, v136
    s_nop 2
    v_cvt_pk_bf16_f32 v87, v140, v144
    s_add_u32 s41, s40, 0
    buffer_store_dwordx4 v[84:87], v50, s[36:39], s41 offen sc1
    v_cvt_pk_bf16_f32 v88, v117, v121
    v_cvt_pk_bf16_f32 v89, v125, v129
    v_cvt_pk_bf16_f32 v90, v133, v137
    v_cvt_pk_bf16_f32 v91, v141, v145
    s_add_u32 s41, s40, 4096
    buffer_store_dwordx4 v[88:91], v50, s[36:39], s41 offen sc1
    v_cvt_pk_bf16_f32 v92, v118, v122
    v_cvt_pk_bf16_f32 v93, v126, v130
    v_cvt_pk_bf16_f32 v94, v134, v138
    v_cvt_pk_bf16_f32 v95, v142, v146
    s_add_u32 s41, s40, 32768
    buffer_store_dwordx4 v[92:95], v50, s[36:39], s41 offen sc1
    v_cvt_pk_bf16_f32 v96, v119, v123
    v_cvt_pk_bf16_f32 v97, v127, v131
    v_cvt_pk_bf16_f32 v98, v135, v139
    v_cvt_pk_bf16_f32 v99, v143, v147
    s_add_u32 s41, s40, 36864
    buffer_store_dwordx4 v[96:99], v50, s[36:39], s41 offen sc1
    v_mov_b32 v148, s50
    v_mov_b32 v149, s51
    s_lshl_b32 s40, s8, 7
    s_add_u32 s40, s40, 32768
    v_min_u32 v150, 6, v1
    v_lshlrev_b32 v150, 3, v150
    s_cmp_lg_u32 s3, 1
    s_cbranch_scc1 S_n1

    buffer_load_dwordx2 v[152:153], v150, s[36:39], s58 offen sc1
S_n1:
    s_waitcnt vmcnt(0)
    s_barrier
    s_cmp_eq_u32 s3, 1
    s_cbranch_scc1 S_poll
    s_cmp_lg_u32 s3, 0
    s_cbranch_scc1 S_w2
    s_mov_b64 exec, 1
    buffer_store_dwordx2 v[148:149], v38, s[36:39], s40 offen sc1
    s_branch S_end
        S_w2:
    s_cmp_lt_u32 s3, 99
    s_cbranch_scc1 S_end
    s_lshl_b32 s40, s8, 2
    s_and_b32 s41, s3, 2
    s_add_u32 s40, s40, s41
    s_lshl_b32 s40, s40, 1
    s_and_b32 s41, s3, 1
    s_add_u32 s40, s40, s41
    s_mul_i32 s40, s40, 7168
    s_add_u32 s40, s40, 2111488
    v_min_u32 v4, 55, v1
    v_lshlrev_b32 v4, 7, v4
    buffer_load_dword v52, v4, s[36:39], s40 offen sc1
    s_branch S_end
        S_poll:

    s_mov_b32 s57, 1
    s_waitcnt vmcnt(0)
    v_cmp_ne_u64 vcc, s[60:61], v[152:153]
    s_nop 0
    s_cbranch_vccnz X_cS
        X_okS:

    v_and_b32 v4, 31, v1
    v_lshlrev_b32 v4, 7, v4
    s_mov_b32 s40, 32768
    v_mov_b32 v148, s12
    v_mov_b32 v149, s13
    s_mov_b32 s9, 0
    buffer_load_dwordx2 v[152:153], v4, s[36:39], s40 offen sc1
        P_lB:
    s_waitcnt vmcnt(0)
    v_cmp_ne_u64 vcc, s[50:51], v[152:153]
    s_nop 0
    s_cbranch_vccz P_dB
    buffer_load_dwordx2 v[152:153], v4, s[36:39], s40 offen sc1
    s_add_u32 s9, s9, 1
    s_cmp_lt_u32 s9, 200000
    s_cbranch_scc1 P_lB
    s_waitcnt vmcnt(0)
        P_dB:

    v_lshlrev_b32 v4, 7, v1
    s_lshl_b32 s40, s8, 15
    s_add_u32 s40, s40, 1048576
    buffer_load_dword v5, v4, s[36:39], s40 offen sc1
    s_add_u32 s40, s40, 8192
    buffer_load_dword v5, v4, s[36:39], s40 offen sc1
    s_add_u32 s40, s40, 8192
    buffer_load_dword v5, v4, s[36:39], s40 offen sc1
    s_add_u32 s40, s40, 8192
    buffer_load_dword v5, v4, s[36:39], s40 offen sc1
    s_add_u32 s40, s40, 8192
    s_mov_b64 exec, 1
    s_cmp_eq_u32 s57, 0
    s_cbranch_scc1 SM_sR
    buffer_store_dwordx2 v[148:149], v38, s[36:39], s58 offen offset:64
SM_jR:
    s_cmp_lg_u32 s8, 0
    s_cbranch_scc1 S_end
    s_add_u32 s40, s14, 16
    v_mov_b32 v4, s40
    s_mov_b32 s40, 4096
    buffer_store_dword v4, v38, s[36:39], s40 offen
        S_end:

    s_endpgm
K_c:
    s_lshl_b32 s40, s8, 7
    s_waitcnt lgkmcnt(0)
    s_load_dwordx2 s[10:11], s[36:37], s40
    s_add_u32 s60, s40, 8192
    s_getreg_b32 s52, hwreg(HW_REG_XCC_ID, 0, 3)
    s_mov_b32 s26, 401408
    s_mov_b32 s27, 0x00020000
    s_mov_b32 s34, 3670016
    s_mov_b32 s35, 0x00020000
    s_sub_u32 s58, s3, 4
    s_lshr_b32 s100, s58, 1
    s_and_b32 s101, s58, 1
    s_lshl_b32 s23, s58, 11
    v_and_b32 v1, 63, v0
    v_lshlrev_b32 v4, 4, v1
    s_mul_i32 s15, s2, 1792
    v_min_u32 v41, 13, v1
    v_lshlrev_b32 v41, 7, v41
    v_lshrrev_b32 v24, 4, v1
    v_and_b32 v25, 15, v1
    v_lshrrev_b32 v26, 3, v1
    v_and_b32 v27, 7, v1
    v_mov_b32 v5, 161792
    v_mov_b32 v6, 0
    v_lshl_add_u32 v2, v25, 2, v5
    ds_write_b32 v2, v6
    v_lshrrev_b32 v3, 1, v25
    v_xor_b32 v3, v3, v24
    v_lshlrev_b32 v3, 4, v3
    v_lshl_add_u32 v3, v25, 7, v3
    s_lshr_b32 s16, s58, 1
    s_lshl_b32 s16, s16, 12
    v_add_u32 v28, s16, v3
    v_xor_b32 v29, 64, v28
    v_add_u32 v30, 40960, v28
    v_add_u32 v31, 40960, v29
    v_lshrrev_b32 v3, 2, v25
    v_lshl_add_u32 v3, v24, 3, v3
    v_lshlrev_b32 v3, 7, v3
    v_and_b32 v7, 3, v1
    v_lshl_add_u32 v3, v7, 3, v3
    v_bfe_u32 v7, v1, 3, 2
    s_and_b32 s16, s58, 1
    s_lshl_b32 s16, s16, 1
    v_xor_b32 v7, s16, v7
    v_lshl_add_u32 v3, v7, 5, v3
    v_add_u32 v32, 71680, v3
    v_xor_b32 v33, 32, v32
    v_add_u32 v34, 49152, v32
    v_add_u32 v35, 49152, v33
    s_and_b32 s16, s58, 1
    s_lshl_b32 s17, s7, 1
    s_add_u32 s16, s16, s17
    s_cmp_ge_u32 s16, 7
    s_cselect_b32 s17, 14, 7
    s_sub_u32 s16, s17, s16
    v_cmp_gt_u32 s[54:55], s16, v24
    v_add_u32 v2, 4, v24
    v_cmp_gt_u32 s[56:57], s16, v2
    s_bitcmp0_b32 s58, 0
    s_cselect_b64 vcc, -1, 0
    s_xor_b64 s[54:55], s[54:55], vcc
    s_xor_b64 s[56:57], s[56:57], vcc
    s_and_b32 s16, s58, 1
    s_lshl_b32 s17, s7, 1
    s_add_u32 s16, s16, s17
    s_lshl_b32 s62, s16, 10
    s_lshl_b32 s16, s8, 2
    s_and_b32 s17, s58, 2
    s_add_u32 s16, s16, s17
    s_mul_i32 s17, s16, 14336
    s_add_u32 s62, s62, s17
    s_add_u32 s62, s62, 2097152
    s_lshl_b32 s18, s16, 6
    s_add_u32 s18, s18, 16384
    s_lshl_b32 s16, s101, 11
    s_sub_u32 s16, s16, 1024
    s_add_u32 s61, s62, s16
    s_lshl_b32 s17, s7, 1
    s_add_u32 s16, s101, s17
    s_lshl_b32 s16, s16, 3
    s_add_u32 s19, s18, s16
    v_and_b32 v2, 1, v25
    v_cmp_eq_u32 s[44:45], 1, v2
    v_lshl_add_u32 v2, v24, 2, v2
    v_cmp_le_u32 s[46:47], v2, v25
    v_add_u32 v2, 2, v2
    v_cmp_le_u32 s[48:49], v2, v25
    v_mov_b32 v2, 0xffff
    v_mov_b32 v3, 0xffff0000
    v_cndmask_b32 v2, v2, v3, s[44:45]
    v_cndmask_b32 v36, v2, 0, s[46:47]
    v_cndmask_b32 v37, v2, 0, s[48:49]
    v_cndmask_b32 v38, 0, v2, s[46:47]
    v_cndmask_b32 v39, 0, v2, s[48:49]
    s_add_u32 s16, s8, s100
    s_cmp_eq_u32 s16, 0
    s_cselect_b64 s[50:51], -1, 0
    s_mul_i32 s16, s101, 6
    s_cmp_eq_u32 s16, s7
    s_cselect_b32 s63, 1, 0
    s_cmp_eq_u32 s7, 3
    s_cselect_b32 s16, 0, 1.0
    v_mov_b32 v44, s16
    v_mov_b32 v45, 0xf149f2ca
    v_mov_b32 v46, 0xffffff00
    s_mov_b32 s14, 0x3e8b97f6
    s_add_u32 s16, s23, 129024
    v_add_u32 v42, s16, v4
    s_xor_b32 s16, s23, 2048
    s_add_u32 s16, s16, 129024
    v_add_u32 v43, s16, v4
    v_lshl_add_u32 v47, s58, 2, v5
    v_xor_b32 v48, 4, v47
    s_lshl_b32 s16, s7, 7
    v_min_u32 v8, 13, v1
    v_lshlrev_b32 v8, 3, v8
    v_lshrrev_b32 v2, 2, v1
    v_bfe_u32 v3, v1, 3, 2
    v_lshlrev_b32 v3, 5, v3
    v_lshl_add_u32 v2, v2, 7, v3
    v_and_b32 v3, 3, v1
    v_lshl_add_u32 v2, v3, 3, v2
    v_add_u32 v16, 71680, v2
    v_xor_b32 v17, 32, v16
    v_xor_b32 v18, 64, v16
    v_xor_b32 v19, 96, v16
    s_add_u32 s17, s23, 129024
    v_lshrrev_b32 v2, 1, v24
    v_xor_b32 v2, v2, v27
    v_lshlrev_b32 v2, 4, v2
    v_lshl_add_u32 v2, v25, 7, v2
    v_and_b32 v3, 1, v24
    v_lshl_add_u32 v2, v3, 3, v2
    v_add_u32 v20, s17, v2
    v_xor_b32 v21, 32, v20
    v_xor_b32 v22, 64, v20
    v_xor_b32 v23, 96, v20
    v_mul_u32_u24 v10, 1792, v26
    v_lshl_add_u32 v10, v27, 4, v10
    v_xor_b32 v3, v27, v26
    v_lshlrev_b32 v3, 4, v3
    v_lshl_add_u32 v2, v26, 7, v3
    v_add_u32 v9, s17, v2
    s_lshl_b32 s17, s8, 2
    s_add_u32 s17, s17, s58
    s_mul_i32 s20, s17, 14336
    s_add_u32 s20, s20, 2097152
    s_mul_i32 s21, s17, 28672
    s_add_u32 s21, s21, s16
    s_add_u32 s22, s21, 14336
    s_waitcnt lgkmcnt(0)
    s_add_u32 s12, s10, 0x5a3c9671
    s_xor_b32 s13, s11, 0x2b7e1516
    s_add_u32 s52, s52, s12
    s_mov_b32 s53, s13
    v_mov_b32 v14, s12
    v_mov_b32 v15, s13
    s_bfe_u32 s40, s12, 0x80000
    v_mov_b32 v50, s40
    s_bfe_u32 s40, s12, 0x80008
    v_mov_b32 v51, s40
    s_bfe_u32 s40, s12, 0x80010
    v_mov_b32 v52, s40
    s_bfe_u32 s40, s12, 0x80018
    v_mov_b32 v53, s40
    s_setprio 3
    s_cmp_lg_u32 s58, 0
    s_cbranch_scc1 C_nox
    v_mov_b32 v12, s52
    v_mov_b32 v13, s53
    s_lshl_b32 s41, s7, 3
    s_add_u32 s40, s60, s41
    s_mov_b64 exec, 1
    buffer_store_dwordx2 v[12:13], v6, s[36:39], s40 offen sc1
    s_mov_b64 exec, -1

C_nox:
    s_cmp_lg_u32 s58, 0
    s_cbranch_scc1 C_nwo
    buffer_load_dword v7, v41, s[24:27], s15 offen
C_nwo:
    s_barrier
    ds_read_b128 v[130:133], v28 offset:2048
    ds_read_b64_tr_b16 v[150:151], v32 offset:8192
    ds_read_b64_tr_b16 v[152:153], v32 offset:8704
    ds_read_b128 v[134:137], v28 offset:4096
    ds_read_b64_tr_b16 v[154:155], v33 offset:8192
    ds_read_b64_tr_b16 v[156:157], v33 offset:8704
    ds_read_b128 v[126:129], v28 offset:0
    ds_read_b64_tr_b16 v[158:159], v32 offset:16384
    ds_read_b64_tr_b16 v[160:161], v32 offset:16896
    ds_read_b64_tr_b16 v[162:163], v33 offset:16384
    ds_read_b64_tr_b16 v[164:165], v33 offset:16896
    ds_read_b64_tr_b16 v[166:167], v32 offset:24576
    ds_read_b64_tr_b16 v[168:169], v32 offset:25088
    ds_read_b64_tr_b16 v[170:171], v33 offset:24576
    ds_read_b64_tr_b16 v[172:173], v33 offset:25088
    s_waitcnt lgkmcnt(12)
    v_mfma_f32_16x16x32_bf16 v[62:65], v[150:153], v[130:133], 0
    ds_read_b128 v[142:145], v29 offset:2048
    s_waitcnt lgkmcnt(12)
    v_mfma_f32_16x16x32_bf16 v[70:73], v[150:153], v[134:137], 0
    ds_read_b64_tr_b16 v[174:175], v32 offset:12288
    s_waitcnt lgkmcnt(11)
    v_mfma_f32_16x16x32_bf16 v[66:69], v[154:157], v[130:133], 0
    ds_read_b64_tr_b16 v[176:177], v32 offset:12800
    v_mfma_f32_16x16x32_bf16 v[74:77], v[154:157], v[134:137], 0
    ds_read_b128 v[146:149], v29 offset:4096
    s_waitcnt lgkmcnt(10)
    v_mfma_f32_16x16x32_bf16 v[78:81], v[158:161], v[126:129], 0
    ds_read_b64_tr_b16 v[178:179], v33 offset:12288
    v_mfma_f32_16x16x32_bf16 v[86:89], v[158:161], v[130:133], 0
    ds_read_b64_tr_b16 v[180:181], v33 offset:12800
    v_mfma_f32_16x16x32_bf16 v[94:97], v[158:161], v[134:137], 0
    ds_read_b128 v[138:141], v29 offset:0
    s_waitcnt lgkmcnt(11)
    v_mfma_f32_16x16x32_bf16 v[82:85], v[162:165], v[126:129], 0
    ds_read_b64_tr_b16 v[182:183], v32 offset:20480
    v_mfma_f32_16x16x32_bf16 v[90:93], v[162:165], v[130:133], 0
    ds_read_b64_tr_b16 v[184:185], v32 offset:20992
    v_mfma_f32_16x16x32_bf16 v[98:101], v[162:165], v[134:137], 0
    ds_read_b64_tr_b16 v[186:187], v33 offset:20480
    s_waitcnt lgkmcnt(12)
    v_mfma_f32_16x16x32_bf16 v[102:105], v[126:129], v[166:169], 0
    ds_read_b64_tr_b16 v[188:189], v33 offset:20992
    v_mfma_f32_16x16x32_bf16 v[110:113], v[130:133], v[166:169], 0
    ds_read_b64_tr_b16 v[190:191], v32 offset:28672
    v_mfma_f32_16x16x32_bf16 v[118:121], v[134:137], v[166:169], 0
    ds_read_b64_tr_b16 v[192:193], v32 offset:29184
    s_waitcnt lgkmcnt(13)
    v_mfma_f32_16x16x32_bf16 v[106:109], v[126:129], v[170:173], 0
    ds_read_b64_tr_b16 v[194:195], v33 offset:28672
    v_mfma_f32_16x16x32_bf16 v[114:117], v[130:133], v[170:173], 0
    ds_read_b64_tr_b16 v[196:197], v33 offset:29184
    v_mfma_f32_16x16x32_bf16 v[122:125], v[134:137], v[170:173], 0
    s_waitcnt lgkmcnt(12)
    v_mfma_f32_16x16x32_bf16 v[62:65], v[174:177], v[142:145], v[62:65]
    s_waitcnt lgkmcnt(11)
    v_mfma_f32_16x16x32_bf16 v[70:73], v[174:177], v[146:149], v[70:73]
    s_waitcnt lgkmcnt(9)
    v_mfma_f32_16x16x32_bf16 v[66:69], v[178:181], v[142:145], v[66:69]
    v_mfma_f32_16x16x32_bf16 v[74:77], v[178:181], v[146:149], v[74:77]
    s_waitcnt lgkmcnt(6)
    v_mfma_f32_16x16x32_bf16 v[78:81], v[182:185], v[138:141], v[78:81]
    v_mfma_f32_16x16x32_bf16 v[86:89], v[182:185], v[142:145], v[86:89]
    s_waitcnt lgkmcnt(0)
    s_barrier
    ds_read_b128 v[130:133], v28 offset:12288
    ds_read_b64_tr_b16 v[150:151], v32 offset:32768
    v_mfma_f32_16x16x32_bf16 v[94:97], v[182:185], v[146:149], v[94:97]
    ds_read_b64_tr_b16 v[152:153], v32 offset:33280
    v_mfma_f32_16x16x32_bf16 v[82:85], v[186:189], v[138:141], v[82:85]
    ds_read_b128 v[134:137], v28 offset:14336
    ds_read_b64_tr_b16 v[154:155], v33 offset:32768
    v_mfma_f32_16x16x32_bf16 v[90:93], v[186:189], v[142:145], v[90:93]
    ds_read_b64_tr_b16 v[156:157], v33 offset:33280
    v_mfma_f32_16x16x32_bf16 v[98:101], v[186:189], v[146:149], v[98:101]
    ds_read_b128 v[126:129], v28 offset:10240
    v_mfma_f32_16x16x32_bf16 v[102:105], v[138:141], v[190:193], v[102:105]
    ds_read_b64_tr_b16 v[158:159], v32 offset:40960
    ds_read_b64_tr_b16 v[160:161], v32 offset:41472
    v_mfma_f32_16x16x32_bf16 v[110:113], v[142:145], v[190:193], v[110:113]
    ds_read_b64_tr_b16 v[162:163], v33 offset:40960
    v_mfma_f32_16x16x32_bf16 v[118:121], v[146:149], v[190:193], v[118:121]
    ds_read_b64_tr_b16 v[164:165], v33 offset:41472
    v_mfma_f32_16x16x32_bf16 v[106:109], v[138:141], v[194:197], v[106:109]
    ds_read_b64_tr_b16 v[166:167], v34 offset:0
    ds_read_b64_tr_b16 v[168:169], v34 offset:512
    v_mfma_f32_16x16x32_bf16 v[114:117], v[142:145], v[194:197], v[114:117]
    ds_read_b64_tr_b16 v[170:171], v35 offset:0
    v_mfma_f32_16x16x32_bf16 v[122:125], v[146:149], v[194:197], v[122:125]
    ds_read_b64_tr_b16 v[172:173], v35 offset:512
    s_waitcnt lgkmcnt(12)
    v_mfma_f32_16x16x32_bf16 v[62:65], v[150:153], v[130:133], v[62:65]
    ds_read_b128 v[142:145], v29 offset:12288
    s_waitcnt lgkmcnt(12)
    v_mfma_f32_16x16x32_bf16 v[70:73], v[150:153], v[134:137], v[70:73]
    ds_read_b64_tr_b16 v[174:175], v32 offset:36864
    s_waitcnt lgkmcnt(11)
    v_mfma_f32_16x16x32_bf16 v[66:69], v[154:157], v[130:133], v[66:69]
    ds_read_b64_tr_b16 v[176:177], v32 offset:37376
    v_mfma_f32_16x16x32_bf16 v[74:77], v[154:157], v[134:137], v[74:77]
    ds_read_b128 v[146:149], v29 offset:14336
    s_waitcnt lgkmcnt(10)
    v_mfma_f32_16x16x32_bf16 v[78:81], v[158:161], v[126:129], v[78:81]
    ds_read_b64_tr_b16 v[178:179], v33 offset:36864
    v_mfma_f32_16x16x32_bf16 v[86:89], v[158:161], v[130:133], v[86:89]
    ds_read_b64_tr_b16 v[180:181], v33 offset:37376
    v_mfma_f32_16x16x32_bf16 v[94:97], v[158:161], v[134:137], v[94:97]
    ds_read_b128 v[138:141], v29 offset:10240
    s_waitcnt lgkmcnt(11)
    v_mfma_f32_16x16x32_bf16 v[82:85], v[162:165], v[126:129], v[82:85]
    ds_read_b64_tr_b16 v[182:183], v32 offset:45056
    v_mfma_f32_16x16x32_bf16 v[90:93], v[162:165], v[130:133], v[90:93]
    ds_read_b64_tr_b16 v[184:185], v32 offset:45568
    v_mfma_f32_16x16x32_bf16 v[98:101], v[162:165], v[134:137], v[98:101]
    ds_read_b64_tr_b16 v[186:187], v33 offset:45056
    s_waitcnt lgkmcnt(12)
    v_mfma_f32_16x16x32_bf16 v[102:105], v[126:129], v[166:169], v[102:105]
    ds_read_b64_tr_b16 v[188:189], v33 offset:45568
    v_mfma_f32_16x16x32_bf16 v[110:113], v[130:133], v[166:169], v[110:113]
    ds_read_b64_tr_b16 v[190:191], v34 offset:4096
    v_mfma_f32_16x16x32_bf16 v[118:121], v[134:137], v[166:169], v[118:121]
    ds_read_b64_tr_b16 v[192:193], v34 offset:4608
    s_waitcnt lgkmcnt(13)
    v_mfma_f32_16x16x32_bf16 v[106:109], v[126:129], v[170:173], v[106:109]
    ds_read_b64_tr_b16 v[194:195], v35 offset:4096
    v_mfma_f32_16x16x32_bf16 v[114:117], v[130:133], v[170:173], v[114:117]
    ds_read_b64_tr_b16 v[196:197], v35 offset:4608
    v_mfma_f32_16x16x32_bf16 v[122:125], v[134:137], v[170:173], v[122:125]
    s_waitcnt lgkmcnt(12)
    v_mfma_f32_16x16x32_bf16 v[62:65], v[174:177], v[142:145], v[62:65]
    s_waitcnt lgkmcnt(11)
    v_mfma_f32_16x16x32_bf16 v[70:73], v[174:177], v[146:149], v[70:73]
    s_waitcnt lgkmcnt(9)
    v_mfma_f32_16x16x32_bf16 v[66:69], v[178:181], v[142:145], v[66:69]
    v_mfma_f32_16x16x32_bf16 v[74:77], v[178:181], v[146:149], v[74:77]
    s_waitcnt lgkmcnt(6)
    v_mfma_f32_16x16x32_bf16 v[78:81], v[182:185], v[138:141], v[78:81]
    v_mfma_f32_16x16x32_bf16 v[86:89], v[182:185], v[142:145], v[86:89]
    s_waitcnt lgkmcnt(0)
    s_barrier
    ds_read_b128 v[130:133], v28 offset:22528
    ds_read_b64_tr_b16 v[150:151], v34 offset:8192
    v_mfma_f32_16x16x32_bf16 v[94:97], v[182:185], v[146:149], v[94:97]
    ds_read_b64_tr_b16 v[152:153], v34 offset:8704
    v_mfma_f32_16x16x32_bf16 v[82:85], v[186:189], v[138:141], v[82:85]
    ds_read_b128 v[134:137], v28 offset:24576
    ds_read_b64_tr_b16 v[154:155], v35 offset:8192
    v_mfma_f32_16x16x32_bf16 v[90:93], v[186:189], v[142:145], v[90:93]
    ds_read_b64_tr_b16 v[156:157], v35 offset:8704
    v_mfma_f32_16x16x32_bf16 v[98:101], v[186:189], v[146:149], v[98:101]
    ds_read_b128 v[126:129], v28 offset:20480
    v_mfma_f32_16x16x32_bf16 v[102:105], v[138:141], v[190:193], v[102:105]
    ds_read_b64_tr_b16 v[158:159], v34 offset:16384
    ds_read_b64_tr_b16 v[160:161], v34 offset:16896
    v_mfma_f32_16x16x32_bf16 v[110:113], v[142:145], v[190:193], v[110:113]
    ds_read_b64_tr_b16 v[162:163], v35 offset:16384
    v_mfma_f32_16x16x32_bf16 v[118:121], v[146:149], v[190:193], v[118:121]
    ds_read_b64_tr_b16 v[164:165], v35 offset:16896
    v_mfma_f32_16x16x32_bf16 v[106:109], v[138:141], v[194:197], v[106:109]
    ds_read_b64_tr_b16 v[166:167], v34 offset:24576
    ds_read_b64_tr_b16 v[168:169], v34 offset:25088
    v_mfma_f32_16x16x32_bf16 v[114:117], v[142:145], v[194:197], v[114:117]
    ds_read_b64_tr_b16 v[170:171], v35 offset:24576
    v_mfma_f32_16x16x32_bf16 v[122:125], v[146:149], v[194:197], v[122:125]
    ds_read_b64_tr_b16 v[172:173], v35 offset:25088
    s_waitcnt lgkmcnt(12)
    v_mfma_f32_16x16x32_bf16 v[62:65], v[150:153], v[130:133], v[62:65]
    ds_read_b128 v[142:145], v29 offset:22528
    s_waitcnt lgkmcnt(12)
    v_mfma_f32_16x16x32_bf16 v[70:73], v[150:153], v[134:137], v[70:73]
    ds_read_b64_tr_b16 v[174:175], v34 offset:12288
    s_waitcnt lgkmcnt(11)
    v_mfma_f32_16x16x32_bf16 v[66:69], v[154:157], v[130:133], v[66:69]
    ds_read_b64_tr_b16 v[176:177], v34 offset:12800
    v_mfma_f32_16x16x32_bf16 v[74:77], v[154:157], v[134:137], v[74:77]
    ds_read_b128 v[146:149], v29 offset:24576
    s_waitcnt lgkmcnt(10)
    v_mfma_f32_16x16x32_bf16 v[78:81], v[158:161], v[126:129], v[78:81]
    ds_read_b64_tr_b16 v[178:179], v35 offset:12288
    v_mfma_f32_16x16x32_bf16 v[86:89], v[158:161], v[130:133], v[86:89]
    ds_read_b64_tr_b16 v[180:181], v35 offset:12800
    v_mfma_f32_16x16x32_bf16 v[94:97], v[158:161], v[134:137], v[94:97]
    ds_read_b128 v[138:141], v29 offset:20480
    s_waitcnt lgkmcnt(11)
    v_mfma_f32_16x16x32_bf16 v[82:85], v[162:165], v[126:129], v[82:85]
    ds_read_b64_tr_b16 v[182:183], v34 offset:20480
    v_mfma_f32_16x16x32_bf16 v[90:93], v[162:165], v[130:133], v[90:93]
    ds_read_b64_tr_b16 v[184:185], v34 offset:20992
    v_mfma_f32_16x16x32_bf16 v[98:101], v[162:165], v[134:137], v[98:101]
    ds_read_b64_tr_b16 v[186:187], v35 offset:20480
    s_waitcnt lgkmcnt(12)
    v_mfma_f32_16x16x32_bf16 v[102:105], v[126:129], v[166:169], v[102:105]
    ds_read_b64_tr_b16 v[188:189], v35 offset:20992
    v_mfma_f32_16x16x32_bf16 v[110:113], v[130:133], v[166:169], v[110:113]
    ds_read_b64_tr_b16 v[190:191], v34 offset:28672
    v_mfma_f32_16x16x32_bf16 v[118:121], v[134:137], v[166:169], v[118:121]
    ds_read_b64_tr_b16 v[192:193], v34 offset:29184
    s_waitcnt lgkmcnt(13)
    v_mfma_f32_16x16x32_bf16 v[106:109], v[126:129], v[170:173], v[106:109]
    ds_read_b64_tr_b16 v[194:195], v35 offset:28672
    v_mfma_f32_16x16x32_bf16 v[114:117], v[130:133], v[170:173], v[114:117]
    ds_read_b64_tr_b16 v[196:197], v35 offset:29184
    v_mfma_f32_16x16x32_bf16 v[122:125], v[134:137], v[170:173], v[122:125]
    s_waitcnt lgkmcnt(12)
    v_mfma_f32_16x16x32_bf16 v[62:65], v[174:177], v[142:145], v[62:65]
    s_waitcnt lgkmcnt(11)
    v_mfma_f32_16x16x32_bf16 v[70:73], v[174:177], v[146:149], v[70:73]
    s_waitcnt lgkmcnt(9)
    v_mfma_f32_16x16x32_bf16 v[66:69], v[178:181], v[142:145], v[66:69]
    v_mfma_f32_16x16x32_bf16 v[74:77], v[178:181], v[146:149], v[74:77]
    s_waitcnt lgkmcnt(6)
    v_mfma_f32_16x16x32_bf16 v[78:81], v[182:185], v[138:141], v[78:81]
    v_mfma_f32_16x16x32_bf16 v[86:89], v[182:185], v[142:145], v[86:89]
    s_waitcnt lgkmcnt(0)
    s_barrier
    ds_read_b128 v[130:133], v28 offset:32768
    ds_read_b64_tr_b16 v[150:151], v34 offset:32768
    v_mfma_f32_16x16x32_bf16 v[94:97], v[182:185], v[146:149], v[94:97]
    ds_read_b64_tr_b16 v[152:153], v34 offset:33280
    v_mfma_f32_16x16x32_bf16 v[82:85], v[186:189], v[138:141], v[82:85]
    ds_read_b128 v[134:137], v28 offset:34816
    ds_read_b64_tr_b16 v[154:155], v35 offset:32768
    v_mfma_f32_16x16x32_bf16 v[90:93], v[186:189], v[142:145], v[90:93]
    ds_read_b64_tr_b16 v[156:157], v35 offset:33280
    v_mfma_f32_16x16x32_bf16 v[98:101], v[186:189], v[146:149], v[98:101]
    ds_read_b128 v[126:129], v28 offset:30720
    v_mfma_f32_16x16x32_bf16 v[102:105], v[138:141], v[190:193], v[102:105]
    ds_read_b64_tr_b16 v[158:159], v32 offset:0
    ds_read_b64_tr_b16 v[160:161], v32 offset:512
    v_mfma_f32_16x16x32_bf16 v[110:113], v[142:145], v[190:193], v[110:113]
    ds_read_b64_tr_b16 v[162:163], v33 offset:0
    v_mfma_f32_16x16x32_bf16 v[118:121], v[146:149], v[190:193], v[118:121]
    ds_read_b64_tr_b16 v[164:165], v33 offset:512
    v_mfma_f32_16x16x32_bf16 v[106:109], v[138:141], v[194:197], v[106:109]
    ds_read_b64_tr_b16 v[166:167], v32 offset:8192
    ds_read_b64_tr_b16 v[168:169], v32 offset:8704
    v_mfma_f32_16x16x32_bf16 v[114:117], v[142:145], v[194:197], v[114:117]
    ds_read_b64_tr_b16 v[170:171], v33 offset:8192
    v_mfma_f32_16x16x32_bf16 v[122:125], v[146:149], v[194:197], v[122:125]
    ds_read_b64_tr_b16 v[172:173], v33 offset:8704
    s_waitcnt lgkmcnt(12)
    v_mfma_f32_16x16x32_bf16 v[62:65], v[150:153], v[130:133], v[62:65]
    ds_read_b128 v[142:145], v29 offset:32768
    s_waitcnt lgkmcnt(12)
    v_mfma_f32_16x16x32_bf16 v[70:73], v[150:153], v[134:137], v[70:73]
    ds_read_b64_tr_b16 v[174:175], v34 offset:36864
    s_waitcnt lgkmcnt(11)
    v_mfma_f32_16x16x32_bf16 v[66:69], v[154:157], v[130:133], v[66:69]
    ds_read_b64_tr_b16 v[176:177], v34 offset:37376
    v_mfma_f32_16x16x32_bf16 v[74:77], v[154:157], v[134:137], v[74:77]
    ds_read_b128 v[146:149], v29 offset:34816
    s_waitcnt lgkmcnt(10)
    v_mfma_f32_16x16x32_bf16 v[78:81], v[158:161], v[126:129], v[78:81]
    ds_read_b64_tr_b16 v[178:179], v35 offset:36864
    v_mfma_f32_16x16x32_bf16 v[86:89], v[158:161], v[130:133], v[86:89]
    ds_read_b64_tr_b16 v[180:181], v35 offset:37376
    v_mfma_f32_16x16x32_bf16 v[94:97], v[158:161], v[134:137], v[94:97]
    ds_read_b128 v[138:141], v29 offset:30720
    s_waitcnt lgkmcnt(11)
    v_mfma_f32_16x16x32_bf16 v[82:85], v[162:165], v[126:129], v[82:85]
    ds_read_b64_tr_b16 v[182:183], v32 offset:4096
    v_mfma_f32_16x16x32_bf16 v[90:93], v[162:165], v[130:133], v[90:93]
    ds_read_b64_tr_b16 v[184:185], v32 offset:4608
    v_mfma_f32_16x16x32_bf16 v[98:101], v[162:165], v[134:137], v[98:101]
    ds_read_b64_tr_b16 v[186:187], v33 offset:4096
    s_waitcnt lgkmcnt(12)
    v_mfma_f32_16x16x32_bf16 v[102:105], v[126:129], v[166:169], v[102:105]
    ds_read_b64_tr_b16 v[188:189], v33 offset:4608
    v_mfma_f32_16x16x32_bf16 v[110:113], v[130:133], v[166:169], v[110:113]
    ds_read_b64_tr_b16 v[190:191], v32 offset:12288
    v_mfma_f32_16x16x32_bf16 v[118:121], v[134:137], v[166:169], v[118:121]
    ds_read_b64_tr_b16 v[192:193], v32 offset:12800
    s_waitcnt lgkmcnt(13)
    v_mfma_f32_16x16x32_bf16 v[106:109], v[126:129], v[170:173], v[106:109]
    ds_read_b64_tr_b16 v[194:195], v33 offset:12288
    v_mfma_f32_16x16x32_bf16 v[114:117], v[130:133], v[170:173], v[114:117]
    ds_read_b64_tr_b16 v[196:197], v33 offset:12800
    v_mfma_f32_16x16x32_bf16 v[122:125], v[134:137], v[170:173], v[122:125]
    s_waitcnt lgkmcnt(12)
    v_mfma_f32_16x16x32_bf16 v[62:65], v[174:177], v[142:145], v[62:65]
    s_waitcnt lgkmcnt(11)
    v_mfma_f32_16x16x32_bf16 v[70:73], v[174:177], v[146:149], v[70:73]
    s_waitcnt lgkmcnt(9)
    v_mfma_f32_16x16x32_bf16 v[66:69], v[178:181], v[142:145], v[66:69]
    v_mfma_f32_16x16x32_bf16 v[74:77], v[178:181], v[146:149], v[74:77]
    s_waitcnt lgkmcnt(6)
    v_mfma_f32_16x16x32_bf16 v[78:81], v[182:185], v[138:141], v[78:81]
    v_mfma_f32_16x16x32_bf16 v[86:89], v[182:185], v[142:145], v[86:89]
    s_waitcnt lgkmcnt(0)
    s_barrier
    ds_read_b128 v[130:133], v30 offset:2048
    ds_read_b64_tr_b16 v[150:151], v32 offset:16384
    v_mfma_f32_16x16x32_bf16 v[94:97], v[182:185], v[146:149], v[94:97]
    ds_read_b64_tr_b16 v[152:153], v32 offset:16896
    v_mfma_f32_16x16x32_bf16 v[82:85], v[186:189], v[138:141], v[82:85]
    ds_read_b128 v[134:137], v30 offset:4096
    ds_read_b64_tr_b16 v[154:155], v33 offset:16384
    v_mfma_f32_16x16x32_bf16 v[90:93], v[186:189], v[142:145], v[90:93]
    ds_read_b64_tr_b16 v[156:157], v33 offset:16896
    v_mfma_f32_16x16x32_bf16 v[98:101], v[186:189], v[146:149], v[98:101]
    ds_read_b128 v[126:129], v30 offset:0
    v_mfma_f32_16x16x32_bf16 v[102:105], v[138:141], v[190:193], v[102:105]
    ds_read_b64_tr_b16 v[158:159], v32 offset:24576
    ds_read_b64_tr_b16 v[160:161], v32 offset:25088
    v_mfma_f32_16x16x32_bf16 v[110:113], v[142:145], v[190:193], v[110:113]
    ds_read_b64_tr_b16 v[162:163], v33 offset:24576
    v_mfma_f32_16x16x32_bf16 v[118:121], v[146:149], v[190:193], v[118:121]
    ds_read_b64_tr_b16 v[164:165], v33 offset:25088
    v_mfma_f32_16x16x32_bf16 v[106:109], v[138:141], v[194:197], v[106:109]
    ds_read_b64_tr_b16 v[166:167], v32 offset:32768
    ds_read_b64_tr_b16 v[168:169], v32 offset:33280
    v_mfma_f32_16x16x32_bf16 v[114:117], v[142:145], v[194:197], v[114:117]
    ds_read_b64_tr_b16 v[170:171], v33 offset:32768
    v_mfma_f32_16x16x32_bf16 v[122:125], v[146:149], v[194:197], v[122:125]
    ds_read_b64_tr_b16 v[172:173], v33 offset:33280
    s_waitcnt lgkmcnt(12)
    v_mfma_f32_16x16x32_bf16 v[62:65], v[150:153], v[130:133], v[62:65]
    ds_read_b128 v[142:145], v31 offset:2048
    s_waitcnt lgkmcnt(12)
    v_mfma_f32_16x16x32_bf16 v[70:73], v[150:153], v[134:137], v[70:73]
    ds_read_b64_tr_b16 v[174:175], v32 offset:20480
    s_waitcnt lgkmcnt(11)
    v_mfma_f32_16x16x32_bf16 v[66:69], v[154:157], v[130:133], v[66:69]
    ds_read_b64_tr_b16 v[176:177], v32 offset:20992
    v_mfma_f32_16x16x32_bf16 v[74:77], v[154:157], v[134:137], v[74:77]
    ds_read_b128 v[146:149], v31 offset:4096
    s_waitcnt lgkmcnt(10)
    v_mfma_f32_16x16x32_bf16 v[78:81], v[158:161], v[126:129], v[78:81]
    ds_read_b64_tr_b16 v[178:179], v33 offset:20480
    v_mfma_f32_16x16x32_bf16 v[86:89], v[158:161], v[130:133], v[86:89]
    ds_read_b64_tr_b16 v[180:181], v33 offset:20992
    v_mfma_f32_16x16x32_bf16 v[94:97], v[158:161], v[134:137], v[94:97]
    ds_read_b128 v[138:141], v31 offset:0
    s_waitcnt lgkmcnt(11)
    v_mfma_f32_16x16x32_bf16 v[82:85], v[162:165], v[126:129], v[82:85]
    ds_read_b64_tr_b16 v[182:183], v32 offset:28672
    v_mfma_f32_16x16x32_bf16 v[90:93], v[162:165], v[130:133], v[90:93]
    ds_read_b64_tr_b16 v[184:185], v32 offset:29184
    v_mfma_f32_16x16x32_bf16 v[98:101], v[162:165], v[134:137], v[98:101]
    ds_read_b64_tr_b16 v[186:187], v33 offset:28672
    s_waitcnt lgkmcnt(12)
    v_mfma_f32_16x16x32_bf16 v[102:105], v[126:129], v[166:169], v[102:105]
    ds_read_b64_tr_b16 v[188:189], v33 offset:29184
    v_mfma_f32_16x16x32_bf16 v[110:113], v[130:133], v[166:169], v[110:113]
    ds_read_b64_tr_b16 v[190:191], v32 offset:36864
    v_mfma_f32_16x16x32_bf16 v[118:121], v[134:137], v[166:169], v[118:121]
    ds_read_b64_tr_b16 v[192:193], v32 offset:37376
    s_waitcnt lgkmcnt(13)
    v_mfma_f32_16x16x32_bf16 v[106:109], v[126:129], v[170:173], v[106:109]
    ds_read_b64_tr_b16 v[194:195], v33 offset:36864
    v_mfma_f32_16x16x32_bf16 v[114:117], v[130:133], v[170:173], v[114:117]
    ds_read_b64_tr_b16 v[196:197], v33 offset:37376
    v_mfma_f32_16x16x32_bf16 v[122:125], v[134:137], v[170:173], v[122:125]
    s_waitcnt lgkmcnt(12)
    v_mfma_f32_16x16x32_bf16 v[62:65], v[174:177], v[142:145], v[62:65]
    s_waitcnt lgkmcnt(11)
    v_mfma_f32_16x16x32_bf16 v[70:73], v[174:177], v[146:149], v[70:73]
    s_waitcnt lgkmcnt(9)
    v_mfma_f32_16x16x32_bf16 v[66:69], v[178:181], v[142:145], v[66:69]
    v_mfma_f32_16x16x32_bf16 v[74:77], v[178:181], v[146:149], v[74:77]
    s_waitcnt lgkmcnt(6)
    v_mfma_f32_16x16x32_bf16 v[78:81], v[182:185], v[138:141], v[78:81]
    v_mfma_f32_16x16x32_bf16 v[86:89], v[182:185], v[142:145], v[86:89]
    s_waitcnt lgkmcnt(0)
    s_barrier
    ds_read_b128 v[130:133], v30 offset:12288
    ds_read_b64_tr_b16 v[150:151], v32 offset:40960
    v_mfma_f32_16x16x32_bf16 v[94:97], v[182:185], v[146:149], v[94:97]
    ds_read_b64_tr_b16 v[152:153], v32 offset:41472
    v_mfma_f32_16x16x32_bf16 v[82:85], v[186:189], v[138:141], v[82:85]
    ds_read_b128 v[134:137], v30 offset:14336
    ds_read_b64_tr_b16 v[154:155], v33 offset:40960
    v_mfma_f32_16x16x32_bf16 v[90:93], v[186:189], v[142:145], v[90:93]
    ds_read_b64_tr_b16 v[156:157], v33 offset:41472
    v_mfma_f32_16x16x32_bf16 v[98:101], v[186:189], v[146:149], v[98:101]
    ds_read_b128 v[126:129], v30 offset:10240
    v_mfma_f32_16x16x32_bf16 v[102:105], v[138:141], v[190:193], v[102:105]
    ds_read_b64_tr_b16 v[158:159], v34 offset:0
    ds_read_b64_tr_b16 v[160:161], v34 offset:512
    v_mfma_f32_16x16x32_bf16 v[110:113], v[142:145], v[190:193], v[110:113]
    ds_read_b64_tr_b16 v[162:163], v35 offset:0
    v_mfma_f32_16x16x32_bf16 v[118:121], v[146:149], v[190:193], v[118:121]
    ds_read_b64_tr_b16 v[164:165], v35 offset:512
    v_mfma_f32_16x16x32_bf16 v[106:109], v[138:141], v[194:197], v[106:109]
    ds_read_b64_tr_b16 v[166:167], v34 offset:8192
    ds_read_b64_tr_b16 v[168:169], v34 offset:8704
    v_mfma_f32_16x16x32_bf16 v[114:117], v[142:145], v[194:197], v[114:117]
    ds_read_b64_tr_b16 v[170:171], v35 offset:8192
    v_mfma_f32_16x16x32_bf16 v[122:125], v[146:149], v[194:197], v[122:125]
    ds_read_b64_tr_b16 v[172:173], v35 offset:8704
    s_waitcnt lgkmcnt(12)
    v_mfma_f32_16x16x32_bf16 v[62:65], v[150:153], v[130:133], v[62:65]
    ds_read_b128 v[142:145], v31 offset:12288
    s_waitcnt lgkmcnt(12)
    v_mfma_f32_16x16x32_bf16 v[70:73], v[150:153], v[134:137], v[70:73]
    ds_read_b64_tr_b16 v[174:175], v32 offset:45056
    s_waitcnt lgkmcnt(11)
    v_mfma_f32_16x16x32_bf16 v[66:69], v[154:157], v[130:133], v[66:69]
    ds_read_b64_tr_b16 v[176:177], v32 offset:45568
    v_mfma_f32_16x16x32_bf16 v[74:77], v[154:157], v[134:137], v[74:77]
    ds_read_b128 v[146:149], v31 offset:14336
    s_waitcnt lgkmcnt(10)
    v_mfma_f32_16x16x32_bf16 v[78:81], v[158:161], v[126:129], v[78:81]
    ds_read_b64_tr_b16 v[178:179], v33 offset:45056
    v_mfma_f32_16x16x32_bf16 v[86:89], v[158:161], v[130:133], v[86:89]
    ds_read_b64_tr_b16 v[180:181], v33 offset:45568
    v_mfma_f32_16x16x32_bf16 v[94:97], v[158:161], v[134:137], v[94:97]
    ds_read_b128 v[138:141], v31 offset:10240
    s_waitcnt lgkmcnt(11)
    v_mfma_f32_16x16x32_bf16 v[82:85], v[162:165], v[126:129], v[82:85]
    ds_read_b64_tr_b16 v[182:183], v34 offset:4096
    v_mfma_f32_16x16x32_bf16 v[90:93], v[162:165], v[130:133], v[90:93]
    ds_read_b64_tr_b16 v[184:185], v34 offset:4608
    v_mfma_f32_16x16x32_bf16 v[98:101], v[162:165], v[134:137], v[98:101]
    ds_read_b64_tr_b16 v[186:187], v35 offset:4096
    s_waitcnt lgkmcnt(12)
    v_mfma_f32_16x16x32_bf16 v[102:105], v[126:129], v[166:169], v[102:105]
    ds_read_b64_tr_b16 v[188:189], v35 offset:4608
    v_mfma_f32_16x16x32_bf16 v[110:113], v[130:133], v[166:169], v[110:113]
    ds_read_b64_tr_b16 v[190:191], v34 offset:12288
    v_mfma_f32_16x16x32_bf16 v[118:121], v[134:137], v[166:169], v[118:121]
    ds_read_b64_tr_b16 v[192:193], v34 offset:12800
    s_waitcnt lgkmcnt(13)
    v_mfma_f32_16x16x32_bf16 v[106:109], v[126:129], v[170:173], v[106:109]
    ds_read_b64_tr_b16 v[194:195], v35 offset:12288
    v_mfma_f32_16x16x32_bf16 v[114:117], v[130:133], v[170:173], v[114:117]
    ds_read_b64_tr_b16 v[196:197], v35 offset:12800
    v_mfma_f32_16x16x32_bf16 v[122:125], v[134:137], v[170:173], v[122:125]
    s_waitcnt lgkmcnt(12)
    v_mfma_f32_16x16x32_bf16 v[62:65], v[174:177], v[142:145], v[62:65]
    s_waitcnt lgkmcnt(11)
    v_mfma_f32_16x16x32_bf16 v[70:73], v[174:177], v[146:149], v[70:73]
    s_waitcnt lgkmcnt(9)
    v_mfma_f32_16x16x32_bf16 v[66:69], v[178:181], v[142:145], v[66:69]
    v_mfma_f32_16x16x32_bf16 v[74:77], v[178:181], v[146:149], v[74:77]
    s_waitcnt lgkmcnt(6)
    v_mfma_f32_16x16x32_bf16 v[78:81], v[182:185], v[138:141], v[78:81]
    v_mfma_f32_16x16x32_bf16 v[86:89], v[182:185], v[142:145], v[86:89]
    v_mfma_f32_16x16x32_bf16 v[94:97], v[182:185], v[146:149], v[94:97]
    s_waitcnt lgkmcnt(4)
    v_mfma_f32_16x16x32_bf16 v[82:85], v[186:189], v[138:141], v[82:85]
    v_mfma_f32_16x16x32_bf16 v[90:93], v[186:189], v[142:145], v[90:93]
    v_mfma_f32_16x16x32_bf16 v[98:101], v[186:189], v[146:149], v[98:101]
    s_waitcnt lgkmcnt(2)
    v_mfma_f32_16x16x32_bf16 v[102:105], v[138:141], v[190:193], v[102:105]
    v_mfma_f32_16x16x32_bf16 v[110:113], v[142:145], v[190:193], v[110:113]
    v_mfma_f32_16x16x32_bf16 v[118:121], v[146:149], v[190:193], v[118:121]
    s_waitcnt lgkmcnt(0)
    v_mfma_f32_16x16x32_bf16 v[106:109], v[138:141], v[194:197], v[106:109]
    v_mfma_f32_16x16x32_bf16 v[114:117], v[142:145], v[194:197], v[114:117]
    s_barrier
    ds_read_b128 v[130:133], v30 offset:22528
    ds_read_b64_tr_b16 v[150:151], v34 offset:16384
    ds_read_b64_tr_b16 v[152:153], v34 offset:16896
    ds_read_b128 v[134:137], v30 offset:24576
    ds_read_b64_tr_b16 v[154:155], v35 offset:16384
    ds_read_b64_tr_b16 v[156:157], v35 offset:16896
    v_mfma_f32_16x16x32_bf16 v[122:125], v[146:149], v[194:197], v[122:125]
    ds_read_b128 v[126:129], v30 offset:20480
    ds_read_b64_tr_b16 v[158:159], v34 offset:24576
    ds_read_b64_tr_b16 v[160:161], v34 offset:25088
    ds_read_b64_tr_b16 v[162:163], v35 offset:24576
    ds_read_b64_tr_b16 v[164:165], v35 offset:25088
    s_waitcnt lgkmcnt(8)
    v_mfma_f32_16x16x32_bf16 v[62:65], v[150:153], v[130:133], v[62:65]
    ds_read_b128 v[142:145], v31 offset:22528
    ds_read_b64_tr_b16 v[174:175], v34 offset:20480
    s_waitcnt lgkmcnt(9)
    v_mfma_f32_16x16x32_bf16 v[70:73], v[150:153], v[134:137], v[70:73]
    ds_read_b64_tr_b16 v[176:177], v34 offset:20992
    s_waitcnt lgkmcnt(8)
    v_mfma_f32_16x16x32_bf16 v[66:69], v[154:157], v[130:133], v[66:69]
    ds_read_b128 v[146:149], v31 offset:24576
    v_mfma_f32_16x16x32_bf16 v[74:77], v[154:157], v[134:137], v[74:77]
    ds_read_b64_tr_b16 v[178:179], v35 offset:20480
    s_waitcnt lgkmcnt(7)
    v_mfma_f32_16x16x32_bf16 v[78:81], v[158:161], v[126:129], v[78:81]
    ds_read_b64_tr_b16 v[180:181], v35 offset:20992
    v_mfma_f32_16x16x32_bf16 v[86:89], v[158:161], v[130:133], v[86:89]
    ds_read_b128 v[138:141], v31 offset:20480
    ds_read_b64_tr_b16 v[182:183], v34 offset:28672
    v_mfma_f32_16x16x32_bf16 v[94:97], v[158:161], v[134:137], v[94:97]
    ds_read_b64_tr_b16 v[184:185], v34 offset:29184
    s_waitcnt lgkmcnt(9)
    v_mfma_f32_16x16x32_bf16 v[82:85], v[162:165], v[126:129], v[82:85]
    ds_read_b64_tr_b16 v[186:187], v35 offset:28672
    v_mfma_f32_16x16x32_bf16 v[90:93], v[162:165], v[130:133], v[90:93]
    ds_read_b64_tr_b16 v[188:189], v35 offset:29184
    v_mfma_f32_16x16x32_bf16 v[98:101], v[162:165], v[134:137], v[98:101]
    ds_read_b32 v40, v5 offset:4
    s_waitcnt lgkmcnt(9)
    v_mfma_f32_16x16x32_bf16 v[62:65], v[174:177], v[142:145], v[62:65]
    s_waitcnt lgkmcnt(8)
    v_mfma_f32_16x16x32_bf16 v[70:73], v[174:177], v[146:149], v[70:73]
    s_waitcnt lgkmcnt(6)
    v_mfma_f32_16x16x32_bf16 v[66:69], v[178:181], v[142:145], v[66:69]
    v_mfma_f32_16x16x32_bf16 v[74:77], v[178:181], v[146:149], v[74:77]
    s_waitcnt lgkmcnt(3)
    v_mfma_f32_16x16x32_bf16 v[78:81], v[182:185], v[138:141], v[78:81]
    s_waitcnt lgkmcnt(1)
    v_mfma_f32_16x16x32_bf16 v[82:85], v[186:189], v[138:141], v[82:85]
    s_waitcnt lgkmcnt(0)
    v_readfirstlane_b32 s59, v40
    v_mfma_f32_16x16x32_bf16 v[86:89], v[182:185], v[142:145], v[86:89]
    v_cvt_pk_bf16_f32 v150, v62, v63
    v_cvt_pk_bf16_f32 v151, v64, v65
    v_cvt_pk_bf16_f32 v152, v66, v67
    v_cvt_pk_bf16_f32 v153, v68, v69
    v_cvt_pk_bf16_f32 v154, v70, v71
    v_cvt_pk_bf16_f32 v155, v72, v73
    v_mfma_f32_16x16x32_bf16 v[90:93], v[186:189], v[142:145], v[90:93]
    v_cvt_pk_bf16_f32 v156, v74, v75
    v_cvt_pk_bf16_f32 v157, v76, v77
    v_cndmask_b32 v158, 0, v150, s[54:55]
    v_cndmask_b32 v150, v150, 0, s[54:55]
    v_cndmask_b32 v159, 0, v151, s[54:55]
    v_cndmask_b32 v151, v151, 0, s[54:55]
    v_mfma_f32_16x16x32_bf16 v[94:97], v[182:185], v[146:149], v[94:97]
    v_cndmask_b32 v160, 0, v152, s[56:57]
    v_cndmask_b32 v152, v152, 0, s[56:57]
    v_cndmask_b32 v161, 0, v153, s[56:57]
    v_cndmask_b32 v153, v153, 0, s[56:57]
    v_cndmask_b32 v162, 0, v154, s[54:55]
    v_cndmask_b32 v154, v154, 0, s[54:55]
    v_mfma_f32_16x16x32_bf16 v[98:101], v[186:189], v[146:149], v[98:101]
    v_cndmask_b32 v163, 0, v155, s[54:55]
    v_cndmask_b32 v155, v155, 0, s[54:55]
    v_cndmask_b32 v164, 0, v156, s[56:57]
    v_cndmask_b32 v156, v156, 0, s[56:57]
    v_cndmask_b32 v165, 0, v157, s[56:57]
    v_cndmask_b32 v157, v157, 0, s[56:57]
    v_cvt_pk_bf16_f32 v218, v78, v79
    v_cvt_pk_bf16_f32 v219, v80, v81
    v_cvt_pk_bf16_f32 v220, v82, v83
    v_cvt_pk_bf16_f32 v221, v84, v85
    s_nop 1
    v_mfma_f32_16x16x32_bf16 v[62:65], v[218:221], v[150:153], 0
    v_cvt_pk_bf16_f32 v222, v86, v87
    v_cvt_pk_bf16_f32 v223, v88, v89
    v_cvt_pk_bf16_f32 v224, v90, v91
    v_cvt_pk_bf16_f32 v225, v92, v93
    s_nop 1
    v_mfma_f32_16x16x32_bf16 v[70:73], v[222:225], v[154:157], 0
    v_mfma_f32_16x16x32_bf16 v[66:69], v[222:225], v[150:153], 0
    v_cvt_pk_bf16_f32 v226, v94, v95
    v_cvt_pk_bf16_f32 v227, v96, v97
    v_cvt_pk_bf16_f32 v228, v98, v99
    v_cvt_pk_bf16_f32 v229, v100, v101
    s_nop 1
    v_mfma_f32_16x16x32_bf16 v[74:77], v[226:229], v[154:157], 0
    v_mfma_f32_16x16x32_bf16 v[174:177], v[218:221], v[158:161], 0
    v_mfma_f32_16x16x32_bf16 v[178:181], v[222:225], v[158:161], 0
    v_mfma_f32_16x16x32_bf16 v[182:185], v[222:225], v[162:165], 0
    v_mfma_f32_16x16x32_bf16 v[186:189], v[226:229], v[162:165], 0
    v_cndmask_b32 v62, v62, v63, s[44:45]
    ds_read_b32 v40, v5 offset:32
    v_cndmask_b32 v64, v64, v65, s[44:45]
    ds_read_b64_tr_b16 v[166:167], v34 offset:32768
    v_cndmask_b32 v66, v66, v67, s[44:45]
    ds_read_b64_tr_b16 v[168:169], v34 offset:33280
    v_cndmask_b32 v68, v68, v69, s[44:45]
    ds_read_b64_tr_b16 v[170:171], v35 offset:32768
    v_cndmask_b32 v62, v62, v45, s[50:51]
    ds_read_b64_tr_b16 v[172:173], v35 offset:33280
    v_cndmask_b32 v64, v64, v45, s[50:51]
    ds_read_b64_tr_b16 v[190:191], v34 offset:36864
    v_cndmask_b32 v202, v62, v66, s[46:47]
    ds_read_b64_tr_b16 v[192:193], v34 offset:37376
    v_cndmask_b32 v203, v64, v68, s[48:49]
    ds_read_b64_tr_b16 v[194:195], v35 offset:36864
    v_cndmask_b32 v70, v70, v71, s[44:45]
    ds_read_b64_tr_b16 v[196:197], v35 offset:37376
    v_cndmask_b32 v72, v72, v73, s[44:45]
    v_cndmask_b32 v74, v74, v75, s[44:45]
    v_cndmask_b32 v76, v76, v77, s[44:45]
    v_cndmask_b32 v204, v70, v74, s[46:47]
    v_cndmask_b32 v205, v72, v76, s[48:49]
    v_and_or_b32 v94, v202, v46, v50
    v_and_or_b32 v95, v203, v46, v51
    v_and_or_b32 v96, v204, v46, v52
    v_and_or_b32 v97, v205, v46, v53
    s_cmp_lg_u32 s63, 0
    s_cbranch_scc1 SM_jS
    s_cmp_eq_u32 s59, 0
    s_cbranch_scc1 SM_sS
    buffer_store_dwordx4 v[94:97], v4, s[36:39], s61 offen
SM_jS:
    s_waitcnt lgkmcnt(8)
    v_cmp_gt_u32 vcc, 4, v40
    s_nop 0
    s_cbranch_vccnz C_vr
C_vd:
    s_waitcnt lgkmcnt(6)
    v_mfma_f32_16x16x32_bf16 v[102:105], v[126:129], v[166:169], v[102:105]
    v_cndmask_b32 v174, v174, v175, s[44:45]
    v_cndmask_b32 v176, v176, v177, s[44:45]
    v_mfma_f32_16x16x32_bf16 v[110:113], v[130:133], v[166:169], v[110:113]
    v_cndmask_b32 v178, v178, v179, s[44:45]
    v_cndmask_b32 v180, v180, v181, s[44:45]
    v_mfma_f32_16x16x32_bf16 v[118:121], v[134:137], v[166:169], v[118:121]
    v_cndmask_b32 v174, v174, v45, s[50:51]
    v_cndmask_b32 v176, v176, v45, s[50:51]
    s_waitcnt lgkmcnt(4)
    v_mfma_f32_16x16x32_bf16 v[106:109], v[126:129], v[170:173], v[106:109]
    v_cndmask_b32 v198, v174, v178, s[46:47]
    v_cndmask_b32 v199, v176, v180, s[48:49]
    v_mfma_f32_16x16x32_bf16 v[114:117], v[130:133], v[170:173], v[114:117]
    v_cndmask_b32 v182, v182, v183, s[44:45]
    v_cndmask_b32 v184, v184, v185, s[44:45]
    v_mfma_f32_16x16x32_bf16 v[122:125], v[134:137], v[170:173], v[122:125]
    v_cndmask_b32 v186, v186, v187, s[44:45]
    v_cndmask_b32 v188, v188, v189, s[44:45]
    s_waitcnt lgkmcnt(2)
    v_mfma_f32_16x16x32_bf16 v[102:105], v[138:141], v[190:193], v[102:105]
    v_cndmask_b32 v200, v182, v186, s[46:47]
    v_cndmask_b32 v201, v184, v188, s[48:49]
    ds_write_b128 v42, v[198:201]
    ds_write_b32 v47, v5 offset:16
    ds_read_b32 v2, v48 offset:16
    ds_read_b128 v[206:209], v43
    v_mfma_f32_16x16x32_bf16 v[110:113], v[142:145], v[190:193], v[110:113]
    v_mfma_f32_16x16x32_bf16 v[118:121], v[146:149], v[190:193], v[118:121]
    s_waitcnt lgkmcnt(4)
    v_mfma_f32_16x16x32_bf16 v[106:109], v[138:141], v[194:197], v[106:109]
    v_mfma_f32_16x16x32_bf16 v[114:117], v[142:145], v[194:197], v[114:117]
    v_mfma_f32_16x16x32_bf16 v[122:125], v[146:149], v[194:197], v[122:125]
    s_waitcnt lgkmcnt(0)
    v_cmp_eq_u32 vcc, 0, v2
    s_nop 0
    s_cbranch_vccnz C_ir
C_id:
    v_fma_f32 v198, v206, v44, v198
    v_fma_f32 v199, v207, v44, v199
    v_fma_f32 v200, v208, v44, v200
    v_fma_f32 v201, v209, v44, v201
    v_max_f32 v214, v198, v199
    v_max_f32 v215, v200, v201
    v_mov_b32 v216, v214
    v_mov_b32 v217, v215
    v_cvt_pk_bf16_f32 v218, v102, v103
    v_permlane16_swap_b32 v214, v216
    v_permlane16_swap_b32 v215, v217
    v_max_f32 v214, v214, v216
    v_max_f32 v215, v215, v217
    v_mov_b32 v216, v214
    v_mov_b32 v217, v215
    v_cvt_pk_bf16_f32 v219, v104, v105
    v_permlane32_swap_b32 v214, v216
    v_permlane32_swap_b32 v215, v217
    v_max_f32 v214, v214, v216
    v_max_f32 v215, v215, v217
    v_mul_f32 v214, s14, v214
    v_mul_f32 v215, s14, v215
    v_fma_f32 v198, v198, s14, -v214
    v_fma_f32 v199, v199, s14, -v214
    v_fma_f32 v200, v200, s14, -v215
    v_fma_f32 v201, v201, s14, -v215
    buffer_load_dwordx4 v[210:213], v4, s[36:39], s62 offen sc1
    v_exp_f32 v198, v198
    v_exp_f32 v199, v199
    v_exp_f32 v200, v200
    v_exp_f32 v201, v201
    v_add_f32 v214, v198, v199
    v_add_f32 v215, v200, v201
    v_mov_b32 v216, v214
    v_mov_b32 v217, v215
    v_cvt_pk_bf16_f32 v220, v110, v111
    v_permlane16_swap_b32 v214, v216
    v_permlane16_swap_b32 v215, v217
    v_add_f32 v214, v214, v216
    v_add_f32 v215, v215, v217
    v_mov_b32 v216, v214
    v_mov_b32 v217, v215
    v_cvt_pk_bf16_f32 v221, v112, v113
    v_permlane32_swap_b32 v214, v216
    v_permlane32_swap_b32 v215, v217
    v_add_f32 v214, v214, v216
    v_add_f32 v215, v215, v217
    v_rcp_f32 v214, v214
    v_rcp_f32 v215, v215
    v_mul_f32 v198, v198, v214
    v_mul_f32 v199, v199, v214
    v_mul_f32 v200, v200, v215
    v_mul_f32 v201, v201, v215
    v_cvt_pk_bf16_f32 v198, v198, v198
    v_cvt_pk_bf16_f32 v199, v199, v199
    v_cvt_pk_bf16_f32 v200, v200, v200
    v_cvt_pk_bf16_f32 v201, v201, v201
    v_cvt_pk_bf16_f32 v222, v118, v119
    v_cvt_pk_bf16_f32 v223, v120, v121
    v_cvt_pk_bf16_f32 v224, v106, v107
    v_cvt_pk_bf16_f32 v225, v108, v109
    v_cvt_pk_bf16_f32 v226, v114, v115
    v_cvt_pk_bf16_f32 v227, v116, v117
    v_cvt_pk_bf16_f32 v228, v122, v123
    v_cvt_pk_bf16_f32 v229, v124, v125
    v_and_b32 v78, v36, v198
    v_and_b32 v79, v37, v199
    v_and_b32 v80, v38, v198
    v_and_b32 v81, v39, v199
    v_and_b32 v82, v36, v200
    v_and_b32 v83, v37, v201
    v_and_b32 v84, v38, v200
    v_and_b32 v85, v39, v201
    v_mfma_f32_16x16x32_bf16 v[62:65], v[218:221], v[78:81], 0
    v_mfma_f32_16x16x32_bf16 v[66:69], v[224:227], v[78:81], 0
    v_mfma_f32_16x16x32_bf16 v[70:73], v[220:223], v[82:85], 0
    v_mfma_f32_16x16x32_bf16 v[74:77], v[226:229], v[82:85], 0
    s_mov_b32 s9, 0
    s_add_u32 s17, s62, 14336
    s_cmp_lg_u32 s63, 0
    s_cbranch_scc1 C_sv
    s_mov_b32 s40, 0x0c0c0400
    s_mov_b32 s41, 0x05040100
        C_sl:
    s_waitcnt vmcnt(0)
    v_perm_b32 v2, v211, v210, s40
    v_perm_b32 v3, v213, v212, s40
    v_and_b32 v210, v46, v210
    v_perm_b32 v2, v3, v2, s41
    v_and_b32 v211, v46, v211
    v_cmp_ne_u32 vcc, s12, v2
    v_and_b32 v212, v46, v212
    v_and_b32 v213, v46, v213
    s_cbranch_vccnz C_sr
        C_sk:

    v_pk_add_f32 v[202:203], v[202:203], v[210:211]
    v_pk_add_f32 v[204:205], v[204:205], v[212:213]
C_sv:
    s_nop 1
    v_max_f32 v214, v202, v203
    v_max_f32 v215, v204, v205
    v_mov_b32 v216, v214
    v_mov_b32 v217, v215
    v_cvt_pk_bf16_f32 v158, v62, v63
    v_permlane16_swap_b32 v214, v216
    v_permlane16_swap_b32 v215, v217
    v_max_f32 v214, v214, v216
    v_max_f32 v215, v215, v217
    v_mov_b32 v216, v214
    v_mov_b32 v217, v215
    v_cvt_pk_bf16_f32 v159, v64, v65
    v_permlane32_swap_b32 v214, v216
    v_permlane32_swap_b32 v215, v217
    v_max_f32 v214, v214, v216
    v_max_f32 v215, v215, v217
    v_mul_f32 v214, s14, v214
    v_mul_f32 v215, s14, v215
    v_fma_f32 v202, v202, s14, -v214
    v_fma_f32 v203, v203, s14, -v214
    v_fma_f32 v204, v204, s14, -v215
    v_fma_f32 v205, v205, s14, -v215
    v_exp_f32 v202, v202
    v_exp_f32 v203, v203
    v_exp_f32 v204, v204
    v_exp_f32 v205, v205
    v_add_f32 v214, v202, v203
    v_add_f32 v215, v204, v205
    v_mov_b32 v216, v214
    v_mov_b32 v217, v215
    v_cvt_pk_bf16_f32 v160, v66, v67
    v_permlane16_swap_b32 v214, v216
    v_permlane16_swap_b32 v215, v217
    v_add_f32 v214, v214, v216
    v_add_f32 v215, v215, v217
    v_mov_b32 v216, v214
    v_mov_b32 v217, v215
    v_cvt_pk_bf16_f32 v161, v68, v69
    v_permlane32_swap_b32 v214, v216
    v_permlane32_swap_b32 v215, v217
    v_add_f32 v214, v214, v216
    v_add_f32 v215, v215, v217
    v_rcp_f32 v214, v214
    v_rcp_f32 v215, v215
    v_mul_f32 v202, v202, v214
    v_mul_f32 v203, v203, v214
    v_mul_f32 v204, v204, v215
    v_mul_f32 v205, v205, v215
    v_cvt_pk_bf16_f32 v202, v202, v202
    v_cvt_pk_bf16_f32 v203, v203, v203
    v_cvt_pk_bf16_f32 v204, v204, v204
    v_cvt_pk_bf16_f32 v205, v205, v205
    v_and_b32 v86, v36, v202
    v_and_b32 v87, v37, v203
    v_and_b32 v88, v38, v202
    v_and_b32 v89, v39, v203
    v_and_b32 v90, v36, v204
    v_and_b32 v91, v37, v205
    v_and_b32 v92, v38, v204
    v_and_b32 v93, v39, v205
    v_mfma_f32_16x16x32_bf16 v[174:177], v[218:221], v[86:89], 0
    v_mfma_f32_16x16x32_bf16 v[178:181], v[224:227], v[86:89], 0
    v_mfma_f32_16x16x32_bf16 v[182:185], v[220:223], v[90:93], 0
    v_mfma_f32_16x16x32_bf16 v[186:189], v[226:229], v[90:93], 0
    ds_read_b32 v7, v5 offset:12
    v_cvt_pk_bf16_f32 v162, v70, v71
    v_cvt_pk_bf16_f32 v163, v72, v73
    v_cvt_pk_bf16_f32 v164, v74, v75
    v_cvt_pk_bf16_f32 v165, v76, v77
    s_cmp_eq_u32 s59, 0
    s_cbranch_scc1 SM_sO
    v_cvt_pk_bf16_f32 v54, v174, v175
    v_cvt_pk_bf16_f32 v55, v176, v177
    v_cvt_pk_bf16_f32 v56, v178, v179
    v_cvt_pk_bf16_f32 v57, v180, v181
    v_cndmask_b32 v54, v54, v158, s[54:55]
    v_cndmask_b32 v55, v55, v159, s[54:55]
    v_cndmask_b32 v56, v56, v160, s[56:57]
    v_cndmask_b32 v57, v57, v161, s[56:57]
    buffer_store_dwordx4 v[54:57], v4, s[36:39], s62 offen
    v_cvt_pk_bf16_f32 v58, v182, v183
    v_cvt_pk_bf16_f32 v59, v184, v185
    v_cvt_pk_bf16_f32 v60, v186, v187
    v_cvt_pk_bf16_f32 v61, v188, v189
    v_cndmask_b32 v58, v58, v162, s[54:55]
    v_cndmask_b32 v59, v59, v163, s[54:55]
    v_cndmask_b32 v60, v60, v164, s[56:57]
    v_cndmask_b32 v61, v61, v165, s[56:57]
    buffer_store_dwordx4 v[58:61], v4, s[36:39], s17 offen
SM_jO:
    s_waitcnt lgkmcnt(0)
    v_cmp_gt_u32 vcc, 4, v7
    s_nop 0
    s_cbranch_vccz W_dW
    s_mov_b32 s9, 0
        W_lW:
    ds_read_b32 v2, v5 offset:12
    s_add_u32 s9, s9, 1
    s_cmp_gt_u32 s9, 1600000
    s_cbranch_scc1 W_dW
    s_waitcnt lgkmcnt(0)
    v_cmp_gt_u32 vcc, 4, v2
    s_nop 0
    s_cbranch_vccnz W_lW
        W_dW:

    ds_read_b64_tr_b16 v[76:77], v16 offset:0
    ds_read_b64_tr_b16 v[78:79], v16 offset:2048
    ds_read_b64_tr_b16 v[80:81], v17 offset:0
    ds_read_b64_tr_b16 v[82:83], v17 offset:2048
    ds_read_b64_tr_b16 v[84:85], v18 offset:0
    ds_read_b64_tr_b16 v[86:87], v18 offset:2048
    ds_read_b64_tr_b16 v[88:89], v19 offset:0
    ds_read_b64_tr_b16 v[90:91], v19 offset:2048
    ds_read_b64_tr_b16 v[92:93], v16 offset:4096
    ds_read_b64_tr_b16 v[94:95], v16 offset:6144
    ds_read_b64_tr_b16 v[96:97], v17 offset:4096
    ds_read_b64_tr_b16 v[98:99], v17 offset:6144
    ds_read_b64_tr_b16 v[100:101], v18 offset:4096
    ds_read_b64_tr_b16 v[102:103], v18 offset:6144
    ds_read_b64_tr_b16 v[104:105], v19 offset:4096
    ds_read_b64_tr_b16 v[106:107], v19 offset:6144
    ds_read_b64_tr_b16 v[108:109], v16 offset:8192
    ds_read_b64_tr_b16 v[110:111], v16 offset:10240
    ds_read_b64_tr_b16 v[112:113], v17 offset:8192
    ds_read_b64_tr_b16 v[114:115], v17 offset:10240
    ds_read_b64_tr_b16 v[116:117], v18 offset:8192
    ds_read_b64_tr_b16 v[118:119], v18 offset:10240
    ds_read_b64_tr_b16 v[120:121], v19 offset:8192
    ds_read_b64_tr_b16 v[122:123], v19 offset:10240
    ds_read_b64_tr_b16 v[124:125], v16 offset:12288
    ds_read_b64_tr_b16 v[126:127], v16 offset:14336
    ds_read_b64_tr_b16 v[128:129], v17 offset:12288
    ds_read_b64_tr_b16 v[130:131], v17 offset:14336
    ds_read_b64_tr_b16 v[132:133], v18 offset:12288
    ds_read_b64_tr_b16 v[134:135], v18 offset:14336
    ds_read_b64_tr_b16 v[136:137], v19 offset:12288
    ds_read_b64_tr_b16 v[138:139], v19 offset:14336
    s_waitcnt vmcnt(0)
    s_mov_b64 exec, 1
    s_cmp_eq_u32 s59, 0
    s_cbranch_scc1 SM_sF
    buffer_store_dwordx2 v[14:15], v6, s[36:39], s19 offen
SM_jF:
    s_mov_b64 exec, -1
    ds_read_b64_tr_b16 v[140:141], v16 offset:16384
    ds_read_b64_tr_b16 v[142:143], v16 offset:18432
    ds_read_b64_tr_b16 v[144:145], v17 offset:16384
    ds_read_b64_tr_b16 v[146:147], v17 offset:18432
    ds_read_b64_tr_b16 v[148:149], v18 offset:16384
    ds_read_b64_tr_b16 v[150:151], v18 offset:18432
    ds_read_b64_tr_b16 v[152:153], v19 offset:16384
    ds_read_b64_tr_b16 v[154:155], v19 offset:18432
    ds_read_b64_tr_b16 v[156:157], v16 offset:20480
    ds_read_b64_tr_b16 v[158:159], v16 offset:22528
    ds_read_b64_tr_b16 v[160:161], v17 offset:20480
    ds_read_b64_tr_b16 v[162:163], v17 offset:22528
    ds_read_b64_tr_b16 v[164:165], v18 offset:20480
    ds_read_b64_tr_b16 v[166:167], v18 offset:22528
    ds_read_b64_tr_b16 v[168:169], v19 offset:20480
    ds_read_b64_tr_b16 v[170:171], v19 offset:22528
    ds_read_b64_tr_b16 v[172:173], v16 offset:24576
    ds_read_b64_tr_b16 v[174:175], v16 offset:26624
    ds_read_b64_tr_b16 v[176:177], v17 offset:24576
    ds_read_b64_tr_b16 v[178:179], v17 offset:26624
    ds_read_b64_tr_b16 v[180:181], v18 offset:24576
    ds_read_b64_tr_b16 v[182:183], v18 offset:26624
    ds_read_b64_tr_b16 v[184:185], v19 offset:24576
    ds_read_b64_tr_b16 v[186:187], v19 offset:26624
    buffer_load_dwordx2 v[12:13], v8, s[36:39], s18 offen sc1
    ds_read_b64_tr_b16 v[188:189], v16 offset:28672
    ds_read_b64_tr_b16 v[190:191], v16 offset:30720
    ds_read_b64_tr_b16 v[192:193], v17 offset:28672
    ds_read_b64_tr_b16 v[194:195], v17 offset:30720
    ds_read_b64_tr_b16 v[196:197], v18 offset:28672
    ds_read_b64_tr_b16 v[198:199], v18 offset:30720
    ds_read_b64_tr_b16 v[200:201], v19 offset:28672
    ds_read_b64_tr_b16 v[202:203], v19 offset:30720
    ds_read_b64_tr_b16 v[204:205], v16 offset:32768
    ds_read_b64_tr_b16 v[206:207], v16 offset:34816
    ds_read_b64_tr_b16 v[208:209], v17 offset:32768
    ds_read_b64_tr_b16 v[210:211], v17 offset:34816
    ds_read_b64_tr_b16 v[212:213], v18 offset:32768
    ds_read_b64_tr_b16 v[214:215], v18 offset:34816
    ds_read_b64_tr_b16 v[216:217], v19 offset:32768
    ds_read_b64_tr_b16 v[218:219], v19 offset:34816
    ds_read_b64_tr_b16 v[220:221], v16 offset:36864
    ds_read_b64_tr_b16 v[222:223], v16 offset:38912
    ds_read_b64_tr_b16 v[224:225], v17 offset:36864
    ds_read_b64_tr_b16 v[226:227], v17 offset:38912
    ds_read_b64_tr_b16 v[228:229], v18 offset:36864
    ds_read_b64_tr_b16 v[230:231], v18 offset:38912
    ds_read_b64_tr_b16 v[232:233], v19 offset:36864
    ds_read_b64_tr_b16 v[234:235], v19 offset:38912
    s_mov_b32 s9, 0
        P_lO:
    s_waitcnt vmcnt(0)
    v_cmp_ne_u64 vcc, s[12:13], v[12:13]
    s_nop 0
    s_cbranch_vccz P_dO
    buffer_load_dwordx2 v[12:13], v8, s[36:39], s18 offen sc1
    s_add_u32 s9, s9, 1
    s_cmp_lt_u32 s9, 200000
    s_cbranch_scc1 P_lO
    s_waitcnt vmcnt(0)
        P_dO:

    buffer_load_dwordx4 v[40:43], v4, s[36:39], s20 offen offset:0 sc1
    buffer_load_dwordx4 v[44:47], v4, s[36:39], s20 offen offset:1024 sc1
    buffer_load_dwordx4 v[48:51], v4, s[36:39], s20 offen offset:2048 sc1
    buffer_load_dwordx4 v[52:55], v4, s[36:39], s20 offen offset:3072 sc1
    s_add_u32 s20, s20, 4096
    buffer_load_dwordx4 v[56:59], v4, s[36:39], s20 offen offset:0 sc1
    buffer_load_dwordx4 v[60:63], v4, s[36:39], s20 offen offset:1024 sc1
    ds_write_b32 v5, v5 offset:8
    s_waitcnt vmcnt(5)
    s_waitcnt lgkmcnt(15)
    v_mfma_f32_16x16x32_bf16 v[24:27], v[76:79], v[40:43], 0
    buffer_load_dwordx4 v[64:67], v4, s[36:39], s20 offen offset:2048 sc1
    ds_read_b64_tr_b16 v[76:77], v16 offset:40960
    ds_read_b64_tr_b16 v[78:79], v16 offset:43008
    v_mfma_f32_16x16x32_bf16 v[28:31], v[80:83], v[40:43], 0
    ds_read_b64_tr_b16 v[80:81], v17 offset:40960
    ds_read_b64_tr_b16 v[82:83], v17 offset:43008
    v_mfma_f32_16x16x32_bf16 v[32:35], v[84:87], v[40:43], 0
    ds_read_b64_tr_b16 v[84:85], v18 offset:40960
    ds_read_b64_tr_b16 v[86:87], v18 offset:43008
    v_mfma_f32_16x16x32_bf16 v[36:39], v[88:91], v[40:43], 0
    ds_read_b64_tr_b16 v[88:89], v19 offset:40960
    ds_read_b64_tr_b16 v[90:91], v19 offset:43008
    s_waitcnt vmcnt(5)
    v_mfma_f32_16x16x32_bf16 v[24:27], v[92:95], v[44:47], v[24:27]
    buffer_load_dwordx4 v[68:71], v4, s[36:39], s20 offen offset:3072 sc1
    s_add_u32 s20, s20, 4096
    ds_read_b64_tr_b16 v[92:93], v16 offset:45056
    ds_read_b64_tr_b16 v[94:95], v16 offset:47104
    v_mfma_f32_16x16x32_bf16 v[28:31], v[96:99], v[44:47], v[28:31]
    ds_read_b64_tr_b16 v[96:97], v17 offset:45056
    ds_read_b64_tr_b16 v[98:99], v17 offset:47104
    v_mfma_f32_16x16x32_bf16 v[32:35], v[100:103], v[44:47], v[32:35]
    ds_read_b64_tr_b16 v[100:101], v18 offset:45056
    ds_read_b64_tr_b16 v[102:103], v18 offset:47104
    v_mfma_f32_16x16x32_bf16 v[36:39], v[104:107], v[44:47], v[36:39]
    ds_read_b64_tr_b16 v[104:105], v19 offset:45056
    ds_read_b64_tr_b16 v[106:107], v19 offset:47104
    s_waitcnt vmcnt(5)
    v_mfma_f32_16x16x32_bf16 v[24:27], v[108:111], v[48:51], v[24:27]
    buffer_load_dwordx4 v[72:75], v4, s[36:39], s20 offen offset:0 sc1
    ds_read_b64_tr_b16 v[108:109], v16 offset:49152
    ds_read_b64_tr_b16 v[110:111], v16 offset:51200
    v_mfma_f32_16x16x32_bf16 v[28:31], v[112:115], v[48:51], v[28:31]
    ds_read_b64_tr_b16 v[112:113], v17 offset:49152
    ds_read_b64_tr_b16 v[114:115], v17 offset:51200
    v_mfma_f32_16x16x32_bf16 v[32:35], v[116:119], v[48:51], v[32:35]
    ds_read_b64_tr_b16 v[116:117], v18 offset:49152
    ds_read_b64_tr_b16 v[118:119], v18 offset:51200
    v_mfma_f32_16x16x32_bf16 v[36:39], v[120:123], v[48:51], v[36:39]
    ds_read_b64_tr_b16 v[120:121], v19 offset:49152
    ds_read_b64_tr_b16 v[122:123], v19 offset:51200
    s_waitcnt vmcnt(5)
    v_mfma_f32_16x16x32_bf16 v[24:27], v[124:127], v[52:55], v[24:27]
    buffer_load_dwordx4 v[40:43], v4, s[36:39], s20 offen offset:1024 sc1
    ds_read_b64_tr_b16 v[124:125], v16 offset:53248
    ds_read_b64_tr_b16 v[126:127], v16 offset:55296
    v_mfma_f32_16x16x32_bf16 v[28:31], v[128:131], v[52:55], v[28:31]
    ds_read_b64_tr_b16 v[128:129], v17 offset:53248
    ds_read_b64_tr_b16 v[130:131], v17 offset:55296
    v_mfma_f32_16x16x32_bf16 v[32:35], v[132:135], v[52:55], v[32:35]
    ds_read_b64_tr_b16 v[132:133], v18 offset:53248
    ds_read_b64_tr_b16 v[134:135], v18 offset:55296
    v_mfma_f32_16x16x32_bf16 v[36:39], v[136:139], v[52:55], v[36:39]
    ds_read_b64_tr_b16 v[136:137], v19 offset:53248
    ds_read_b64_tr_b16 v[138:139], v19 offset:55296
    s_waitcnt vmcnt(5)
    v_mfma_f32_16x16x32_bf16 v[24:27], v[140:143], v[56:59], v[24:27]
    buffer_load_dwordx4 v[44:47], v4, s[36:39], s20 offen offset:2048 sc1
    v_mfma_f32_16x16x32_bf16 v[28:31], v[144:147], v[56:59], v[28:31]
    v_mfma_f32_16x16x32_bf16 v[32:35], v[148:151], v[56:59], v[32:35]
    v_mfma_f32_16x16x32_bf16 v[36:39], v[152:155], v[56:59], v[36:39]
    s_waitcnt vmcnt(5)
    v_mfma_f32_16x16x32_bf16 v[24:27], v[156:159], v[60:63], v[24:27]
    buffer_load_dwordx4 v[48:51], v4, s[36:39], s20 offen offset:3072 sc1
    s_add_u32 s20, s20, 4096
    v_mfma_f32_16x16x32_bf16 v[28:31], v[160:163], v[60:63], v[28:31]
    v_mfma_f32_16x16x32_bf16 v[32:35], v[164:167], v[60:63], v[32:35]
    v_mfma_f32_16x16x32_bf16 v[36:39], v[168:171], v[60:63], v[36:39]
    s_waitcnt vmcnt(5)
    v_mfma_f32_16x16x32_bf16 v[24:27], v[172:175], v[64:67], v[24:27]
    buffer_load_dwordx4 v[52:55], v4, s[36:39], s20 offen offset:0 sc1
    v_mfma_f32_16x16x32_bf16 v[28:31], v[176:179], v[64:67], v[28:31]
    v_mfma_f32_16x16x32_bf16 v[32:35], v[180:183], v[64:67], v[32:35]
    v_mfma_f32_16x16x32_bf16 v[36:39], v[184:187], v[64:67], v[36:39]
    s_waitcnt vmcnt(5)
    v_mfma_f32_16x16x32_bf16 v[24:27], v[188:191], v[68:71], v[24:27]
    buffer_load_dwordx4 v[56:59], v4, s[36:39], s20 offen offset:1024 sc1
    v_mfma_f32_16x16x32_bf16 v[28:31], v[192:195], v[68:71], v[28:31]
    v_mfma_f32_16x16x32_bf16 v[32:35], v[196:199], v[68:71], v[32:35]
    v_mfma_f32_16x16x32_bf16 v[36:39], v[200:203], v[68:71], v[36:39]
    s_waitcnt vmcnt(5)
    v_mfma_f32_16x16x32_bf16 v[24:27], v[204:207], v[72:75], v[24:27]
    s_waitcnt lgkmcnt(15)
    v_mfma_f32_16x16x32_bf16 v[28:31], v[208:211], v[72:75], v[28:31]
    v_mfma_f32_16x16x32_bf16 v[32:35], v[212:215], v[72:75], v[32:35]
    v_mfma_f32_16x16x32_bf16 v[36:39], v[216:219], v[72:75], v[36:39]
    s_waitcnt vmcnt(4)
    v_mfma_f32_16x16x32_bf16 v[24:27], v[220:223], v[40:43], v[24:27]
    v_mfma_f32_16x16x32_bf16 v[28:31], v[224:227], v[40:43], v[28:31]
    v_mfma_f32_16x16x32_bf16 v[32:35], v[228:231], v[40:43], v[32:35]
    v_mfma_f32_16x16x32_bf16 v[36:39], v[232:235], v[40:43], v[36:39]
    s_waitcnt vmcnt(3)
    v_mfma_f32_16x16x32_bf16 v[24:27], v[76:79], v[44:47], v[24:27]
    v_mfma_f32_16x16x32_bf16 v[28:31], v[80:83], v[44:47], v[28:31]
    v_mfma_f32_16x16x32_bf16 v[32:35], v[84:87], v[44:47], v[32:35]
    v_mfma_f32_16x16x32_bf16 v[36:39], v[88:91], v[44:47], v[36:39]
    s_waitcnt vmcnt(2)
    v_mfma_f32_16x16x32_bf16 v[24:27], v[92:95], v[48:51], v[24:27]
    v_mfma_f32_16x16x32_bf16 v[28:31], v[96:99], v[48:51], v[28:31]
    v_mfma_f32_16x16x32_bf16 v[32:35], v[100:103], v[48:51], v[32:35]
    v_mfma_f32_16x16x32_bf16 v[36:39], v[104:107], v[48:51], v[36:39]
    s_waitcnt vmcnt(1)
    s_waitcnt lgkmcnt(14)
    v_mfma_f32_16x16x32_bf16 v[24:27], v[108:111], v[52:55], v[24:27]
    s_waitcnt lgkmcnt(12)
    v_mfma_f32_16x16x32_bf16 v[28:31], v[112:115], v[52:55], v[28:31]
    s_waitcnt lgkmcnt(10)
    v_mfma_f32_16x16x32_bf16 v[32:35], v[116:119], v[52:55], v[32:35]
    s_waitcnt lgkmcnt(8)
    v_mfma_f32_16x16x32_bf16 v[36:39], v[120:123], v[52:55], v[36:39]
    s_waitcnt vmcnt(0)
    s_waitcnt lgkmcnt(6)
    v_mfma_f32_16x16x32_bf16 v[24:27], v[124:127], v[56:59], v[24:27]
    s_waitcnt lgkmcnt(4)
    v_mfma_f32_16x16x32_bf16 v[28:31], v[128:131], v[56:59], v[28:31]
    s_waitcnt lgkmcnt(2)
    v_mfma_f32_16x16x32_bf16 v[32:35], v[132:135], v[56:59], v[32:35]
    s_waitcnt lgkmcnt(0)
    v_mfma_f32_16x16x32_bf16 v[36:39], v[136:139], v[56:59], v[36:39]
    s_nop 1
    v_cvt_pk_bf16_f32 v156, v24, v25
    v_cvt_pk_bf16_f32 v157, v26, v27
    ds_write_b64 v20, v[156:157]
    v_cvt_pk_bf16_f32 v158, v28, v29
    v_cvt_pk_bf16_f32 v159, v30, v31
    ds_write_b64 v21, v[158:159]
    v_cvt_pk_bf16_f32 v160, v32, v33
    v_cvt_pk_bf16_f32 v161, v34, v35
    ds_write_b64 v22, v[160:161]
    v_cvt_pk_bf16_f32 v162, v36, v37
    v_cvt_pk_bf16_f32 v163, v38, v39
    ds_write_b64 v23, v[162:163]
    ds_read_b128 v[172:175], v9
    ds_read_b128 v[176:179], v9 offset:1024
    s_waitcnt lgkmcnt(1)
    buffer_store_dwordx4 v[172:175], v10, s[32:35], s21 offen
    s_waitcnt lgkmcnt(0)
    buffer_store_dwordx4 v[176:179], v10, s[32:35], s22 offen

    s_endpgm
H_cls0:
    v_cmp_eq_u32 vcc, 0, v9
    v_mov_b32 v112, 0x3f80
    v_mov_b32 v113, 0x3f800000
    v_cndmask_b32 v83, v83, v82, vcc
    v_cndmask_b32 v46, v46, v112, vcc
    v_cndmask_b32 v78, 0, v113, vcc
    v_mov_b32 v54, 0
    v_mov_b32 v70, 0
    v_mov_b32 v58, v50
    v_mov_b32 v50, 0
    v_mov_b32 v74, v66
    v_mov_b32 v66, 0
    v_cndmask_b32 v47, v47, v112, vcc
    v_cndmask_b32 v79, 0, v113, vcc
    v_mov_b32 v55, 0
    v_mov_b32 v71, 0
    v_mov_b32 v59, v51
    v_mov_b32 v51, 0
    v_mov_b32 v75, v67
    v_mov_b32 v67, 0
    v_cndmask_b32 v48, v48, v112, vcc
    v_cndmask_b32 v80, 0, v113, vcc
    v_mov_b32 v56, 0
    v_mov_b32 v72, 0
    v_mov_b32 v60, v52
    v_mov_b32 v52, 0
    v_mov_b32 v76, v68
    v_mov_b32 v68, 0
    v_cndmask_b32 v49, v49, v112, vcc
    v_cndmask_b32 v81, 0, v113, vcc
    v_mov_b32 v57, 0
    v_mov_b32 v73, 0
    v_mov_b32 v61, v53
    v_mov_b32 v53, 0
    v_mov_b32 v77, v69
    v_mov_b32 v69, 0
    s_branch H_reg
X_cH:
    s_mov_b32 s9, 0
        X_lH:
    v_cmp_ne_u64 vcc, s[28:29], v[18:19]
    s_nop 0
    s_cbranch_vccz X_okH
    v_subrev_u32 v18, s12, v18
    v_cmp_ne_u32 s[42:43], s13, v19
    v_cmp_le_u32 vcc, 8, v18
    s_nop 0
    s_or_b64 vcc, vcc, s[42:43]
    s_cbranch_vccz X_nH
    buffer_load_dwordx2 v[18:19], v20, s[36:39], s30 offen sc1
    s_add_u32 s9, s9, 1
    s_cmp_lt_u32 s9, 200000
    s_waitcnt vmcnt(0)
    s_cbranch_scc1 X_lH
        X_nH:
    s_mov_b32 s101, 0
    s_branch X_okH
X_cS:
    s_mov_b32 s9, 0
        X_lS:
    v_cmp_ne_u64 vcc, s[60:61], v[152:153]
    s_nop 0
    s_cbranch_vccz X_okS
    v_subrev_u32 v152, s12, v152
    v_cmp_ne_u32 s[42:43], s13, v153
    v_cmp_le_u32 vcc, 8, v152
    s_nop 0
    s_or_b64 vcc, vcc, s[42:43]
    s_cbranch_vccz X_nS
    buffer_load_dwordx2 v[152:153], v150, s[36:39], s58 offen sc1
    s_add_u32 s9, s9, 1
    s_cmp_lt_u32 s9, 200000
    s_waitcnt vmcnt(0)
    s_cbranch_scc1 X_lS
        X_nS:
    s_mov_b32 s57, 0
    s_branch X_okS
SM_sR:
    buffer_store_dwordx2 v[148:149], v38, s[36:39], s58 offen offset:64 sc1
    s_branch SM_jR
SM_sS:
    buffer_store_dwordx4 v[94:97], v4, s[36:39], s61 offen sc1
    s_branch SM_jS
C_vr:
    s_mov_b32 s9, 0
        W_lV:
    ds_read_b32 v2, v5 offset:32
    s_add_u32 s9, s9, 1
    s_cmp_gt_u32 s9, 1600000
    s_cbranch_scc1 W_dV
    s_waitcnt lgkmcnt(0)
    v_cmp_gt_u32 vcc, 4, v2
    s_nop 0
    s_cbranch_vccnz W_lV
        W_dV:

    ds_read_b64_tr_b16 v[166:167], v34 offset:32768
    ds_read_b64_tr_b16 v[168:169], v34 offset:33280
    ds_read_b64_tr_b16 v[170:171], v35 offset:32768
    ds_read_b64_tr_b16 v[172:173], v35 offset:33280
    ds_read_b64_tr_b16 v[190:191], v34 offset:36864
    ds_read_b64_tr_b16 v[192:193], v34 offset:37376
    ds_read_b64_tr_b16 v[194:195], v35 offset:36864
    ds_read_b64_tr_b16 v[196:197], v35 offset:37376
    s_waitcnt lgkmcnt(0)
    s_branch C_vd
C_ir:
    s_mov_b32 s9, 0
        C_il:
    ds_read_b32 v2, v48 offset:16
    ds_read_b128 v[206:209], v43
    s_add_u32 s9, s9, 1
    s_cmp_gt_u32 s9, 1600000
    s_waitcnt lgkmcnt(0)
    s_cbranch_scc1 C_id
    v_cmp_eq_u32 vcc, 0, v2
    s_nop 0
    s_cbranch_vccnz C_il
    s_branch C_id
C_sr:
    s_add_u32 s9, s9, 1
    s_cmp_gt_u32 s9, 200000
    s_cbranch_scc1 C_sk
    buffer_load_dwordx4 v[210:213], v4, s[36:39], s62 offen sc1
    s_branch C_sl
SM_sO:
    s_nop 7
    v_cvt_pk_bf16_f32 v54, v174, v175
    v_cvt_pk_bf16_f32 v55, v176, v177
    v_cvt_pk_bf16_f32 v56, v178, v179
    v_cvt_pk_bf16_f32 v57, v180, v181
    v_cndmask_b32 v54, v54, v158, s[54:55]
    v_cndmask_b32 v55, v55, v159, s[54:55]
    v_cndmask_b32 v56, v56, v160, s[56:57]
    v_cndmask_b32 v57, v57, v161, s[56:57]
    buffer_store_dwordx4 v[54:57], v4, s[36:39], s62 offen sc1
    v_cvt_pk_bf16_f32 v58, v182, v183
    v_cvt_pk_bf16_f32 v59, v184, v185
    v_cvt_pk_bf16_f32 v60, v186, v187
    v_cvt_pk_bf16_f32 v61, v188, v189
    v_cndmask_b32 v58, v58, v162, s[54:55]
    v_cndmask_b32 v59, v59, v163, s[54:55]
    v_cndmask_b32 v60, v60, v164, s[56:57]
    v_cndmask_b32 v61, v61, v165, s[56:57]
    buffer_store_dwordx4 v[58:61], v4, s[36:39], s17 offen sc1
    s_branch SM_jO
SM_sF:
    buffer_store_dwordx2 v[14:15], v6, s[36:39], s19 offen sc1
    s_branch SM_jF
K_exit:
    s_endpgm
.fill 5120, 4, 0xbf810000
.section .rodata,"a"
.p2align 6
.amdhsa_kernel concat_heads__sliding_local_dilated__spectral_fnet__prompt_kernel
  .amdhsa_next_free_vgpr 256
  .amdhsa_next_free_sgpr 102
  .amdhsa_accum_offset 256
  .amdhsa_group_segment_fixed_size 0
  .amdhsa_kernarg_size 88
  .amdhsa_user_sgpr_count 2
  .amdhsa_user_sgpr_kernarg_segment_ptr 1
  .amdhsa_system_sgpr_workgroup_id_x 1
.end_amdhsa_kernel
```

```asm
; @launch grid=(256,1,1) block=(512,1,1) lds=163840
.amdgcn_target "amdgcn-amd-amdhsa--gfx950"
.text
.p2align 12
.fill 832, 4, 0xbf810000
.globl concat_heads__sliding_local_dilated__spectral_fnet__prompt_kernel
.p2align 8
.type concat_heads__sliding_local_dilated__spectral_fnet__prompt_kernel,@function
concat_heads__sliding_local_dilated__spectral_fnet__prompt_kernel:
    s_load_dwordx2 s[16:17], s[0:1], 0
    s_load_dwordx2 s[20:21], s[0:1], 8
    s_load_dwordx2 s[28:29], s[0:1], 24
    s_load_dwordx2 s[36:37], s[0:1], 80
    s_load_dwordx2 s[24:25], s[0:1], 16
    s_load_dwordx2 s[32:33], s[0:1], 64
    v_lshrrev_b32 v1, 6, v0
    s_cmp_ge_u32 s2, 256
    s_cbranch_scc1 K_exit
    v_readfirstlane_b32 s3, v1
    s_and_b32 s4, s2, 7
    s_lshr_b32 s5, s2, 3
    s_cmp_lg_u32 s3, 7
    s_cbranch_scc1 K_nopf
    s_getpc_b64 s[44:45]
    s_mov_b32 s46, 28672
    s_mov_b32 s47, 0x00020000
    s_mul_i32 s40, s5, 896
    v_and_b32 v1, 63, v0
    v_min_u32 v1, 6, v1
    v_lshlrev_b32 v1, 7, v1
    buffer_load_dword v255, v1, s[44:47], s40 offen
        K_nopf:
    s_mul_i32 s6, s5, 37
    s_lshr_b32 s6, s6, 8
    s_mul_i32 s40, s6, 7
    s_sub_u32 s7, s5, s40
    s_mov_b32 s38, 0x10000000
    s_mov_b32 s39, 0x00020000
    s_lshl_b32 s8, s4, 2
    s_cmp_lt_u32 s5, 28
    s_cbranch_scc1 K_a

    s_add_u32 s8, s8, s7
    s_mov_b32 s30, 1835008
    s_mov_b32 s31, 0x00020000
    s_lshl_b32 s40, s3, 7
    s_add_u32 s40, s40, s8
    v_and_b32 v4, 32, v0
    v_add_u32 v4, s40, v4
    v_and_b32 v5, 31, v0
    v_lshlrev_b32 v5, 4, v5
    v_mov_b32 v6, 896
    v_mad_u32_u24 v7, v4, v6, v5
    v_add_u32 v5, 384, v5
    v_sub_u32 v8, 960, v4
    v_mad_u32_u24 v8, v8, v6, v5
    v_sub_u32 v9, 2048, v4
    v_and_b32 v9, 2047, v9
    v_mad_u32_u24 v9, v9, v6, v5
    s_lshl_b32 s42, s3, 13
    s_mov_b32 m0, s42
    s_mov_b32 s52, 57344
    s_mov_b32 s53, 917504
    s_mov_b32 s54, 974848
    s_waitcnt lgkmcnt(0)

    buffer_load_dwordx4 v7, s[28:31], 0 offen nt lds
    s_add_u32 m0, m0, 1024
    s_nop 0
    buffer_load_dwordx4 v7, s[28:31], s52 offen nt lds
    s_add_u32 m0, m0, 1024
    s_nop 0
    buffer_load_dwordx4 v9, s[28:31], 0 offen nt lds
    s_add_u32 m0, m0, 1024
    s_nop 0
    buffer_load_dwordx4 v8, s[28:31], s53 offen nt lds
    s_add_u32 m0, m0, 1024
    s_load_dwordx2 s[10:11], s[36:37], 4096
    s_branch K_spare2
K_a:
    s_add_u32 s8, s8, s6
    s_cmp_ge_u32 s3, 4
    s_cbranch_scc1 K_c
    s_setprio 2
    s_mov_b32 s44, s4
    s_add_u32 s44, s44, s7
    s_mul_i32 s40, s44, 37
    s_lshr_b32 s40, s40, 8
    s_mul_i32 s40, s40, 7
    s_sub_u32 s44, s44, s40
    s_mov_b32 s18, 1835008
    s_mov_b32 s19, 0x00020000
    s_mov_b32 s22, 1204224
    s_mov_b32 s23, 0x00020000
    v_and_b32 v1, 63, v0
    v_lshrrev_b32 v6, 3, v1
    v_and_b32 v7, 7, v1
    v_lshrrev_b32 v8, 4, v1
    v_xor_b32 v3, v7, v8
    v_mul_u32_u24 v23, 896, v6
    v_lshl_add_u32 v21, v3, 4, v23
    v_xor_b32 v22, 64, v21
    v_add_u32 v22, 6144, v22
    s_lshl_b32 s40, s3, 5
    v_xor_b32 v23, s40, v21
    v_and_b32 v2, 2, v6
    v_xor_b32 v2, v7, v2
    v_mul_u32_u24 v3, 2688, v6
    v_lshl_add_u32 v24, v2, 4, v3
    v_xor_b32 v25, 64, v24
    v_add_u32 v25, 20480, v25
    v_add_u32 v26, 896, v24
    v_add_u32 v27, 896, v25
    v_add_u32 v28, 1792, v24
    v_add_u32 v29, 1792, v25
    s_mov_b32 s45, s44
    s_lshl_b32 s40, s8, 6
    s_lshl_b32 s41, s3, 4
    s_add_u32 s42, s40, s41
    s_mul_i32 s46, s42, 896
    s_mul_i32 s48, s41, 2688
    s_lshl_b32 s42, s7, 7
    s_add_u32 s48, s48, s42
    s_sub_u32 s40, s40, 16
    s_max_i32 s40, s40, 0
    s_lshl_b32 s41, s3, 2
    s_add_u32 s40, s40, s41
    s_mul_i32 s47, s40, 896
    s_lshl_b32 s50, s3, 11
    s_lshl_b32 s49, s3, 9

    s_lshl_b32 s40, s44, 7
    s_add_u32 s51, s40, s46
    s_add_u32 s52, s40, s47
    s_mul_i32 s53, s44, 172032
    s_add_u32 s53, s53, s48
    s_add_u32 m0, s50, 2048
    s_add_u32 s44, s44, 1
    s_cmp_eq_u32 s44, 7
    s_cselect_b32 s44, 0, s44
    s_waitcnt lgkmcnt(0)
    buffer_load_dwordx4 v21, s[16:19], s51 offen lds
    buffer_load_dwordx4 v22, s[16:19], s51 offen offset:1024 lds
    s_add_u32 m0, s49, 0
    s_mov_b32 exec_hi, 0
    buffer_load_dwordx4 v23, s[16:19], s52 offen lds
    s_mov_b32 exec_hi, -1
    s_add_u32 m0, s50, 79872
    s_nop 0
    buffer_load_dwordx4 v24, s[20:23], s53 offen lds
    buffer_load_dwordx4 v25, s[20:23], s53 offen offset:1024 lds
    s_add_u32 m0, s50, 88064
    s_nop 0
    buffer_load_dwordx4 v26, s[20:23], s53 offen lds
    buffer_load_dwordx4 v27, s[20:23], s53 offen offset:1024 lds
    s_add_u32 m0, s50, 96256
    s_mul_i32 s53, s45, 172032
    s_add_u32 s53, s53, s48
    s_add_u32 s45, s45, 1
    s_cmp_eq_u32 s45, 7
    s_cselect_b32 s45, 0, s45
    buffer_load_dwordx4 v28, s[20:23], s53 offen lds
    buffer_load_dwordx4 v29, s[20:23], s53 offen offset:1024 lds
    s_lshl_b32 s40, s44, 7
    s_add_u32 s51, s40, s46
    s_add_u32 s52, s40, s47
    s_mul_i32 s53, s44, 172032
    s_add_u32 s53, s53, s48
    s_add_u32 m0, s50, 12288
    s_add_u32 s44, s44, 1
    s_cmp_eq_u32 s44, 7
    s_cselect_b32 s44, 0, s44
    buffer_load_dwordx4 v21, s[16:19], s51 offen lds
    buffer_load_dwordx4 v22, s[16:19], s51 offen offset:1024 lds
    s_lshl_b32 s56, s8, 7
    s_load_dwordx2 s[10:11], s[36:37], s56
    s_add_u32 s30, s56, 8192
    s_getreg_b32 s28, hwreg(HW_REG_XCC_ID, 0, 3)
    v_min_u32 v20, 6, v1
    v_lshlrev_b32 v20, 3, v20
    s_mov_b32 s26, 401408
    s_mov_b32 s27, 0x00020000
    s_mov_b32 s34, 3670016
    s_mov_b32 s35, 0x00020000
    s_lshr_b32 s58, s3, 1
    s_and_b32 s59, s3, 1
    v_and_b32 v9, 15, v1
    v_mov_b32 v4, 0
    v_mov_b32 v14, 1
    v_mov_b32 v5, 161792
    v_and_b32 v50, 6, v6
    v_xor_b32 v50, v7, v50
    v_mul_u32_u24 v51, 896, v6
    v_lshl_add_u32 v10, v50, 4, v51
    v_add_u32 v11, 6144, v10
    s_mov_b32 s54, s6
    s_mul_i32 s55, s3, 14336
    s_lshl_b32 s56, s7, 7
    s_add_u32 s55, s55, s56
    s_and_b32 s56, s3, 1
    s_lshl_b32 s57, s7, 1
    s_add_u32 s56, s56, s57
    s_lshl_b32 s15, s56, 10
    s_lshl_b32 s56, s8, 2
    s_and_b32 s57, s3, 2
    s_add_u32 s56, s56, s57
    s_mul_i32 s57, s56, 14336
    s_add_u32 s15, s15, s57
    s_add_u32 s15, s15, 2097152
    s_lshl_b32 s100, s56, 6
    s_add_u32 s100, s100, 16384
    v_lshlrev_b32 v50, 7, v7
    v_and_b32 v51, 1, v6
    v_mul_u32_u24 v51, 14336, v51
    v_add3_u32 v12, v50, v51, s15
    v_mov_b32 v50, s100
    v_cmp_le_u32 vcc, 16, v1
    s_nop 1
    v_cndmask_b32 v12, v12, v50, vcc
    v_and_b32 v50, 1, v9
    v_cmp_eq_u32 s[42:43], 1, v50
    v_lshl_add_u32 v50, v8, 2, v50
    v_cmp_le_u32 s[0:1], v50, v9
    v_add_u32 v50, 2, v50
    v_cmp_le_u32 s[12:13], v50, v9
    v_mov_b32 v50, 0xffff
    v_mov_b32 v51, 0xffff0000
    v_cndmask_b32 v50, v50, v51, s[42:43]
    v_cndmask_b32 v52, v50, 0, s[0:1]
    v_cndmask_b32 v53, v50, 0, s[12:13]
    v_cndmask_b32 v54, 0, v50, s[0:1]
    v_cndmask_b32 v55, 0, v50, s[12:13]
    v_lshlrev_b32 v50, 4, v1
    s_add_u32 s56, s50, 129024
    v_add_u32 v56, s56, v50
    s_xor_b32 s56, s50, 2048
    s_add_u32 s56, s56, 129024
    v_add_u32 v57, s56, v50
    v_add_u32 v59, s50, v50
    v_lshl_add_u32 v58, s58, 3, v5
    v_lshl_add_u32 v60, s3, 2, v5
    s_cmp_eq_u32 s7, 3
    s_cselect_b32 s56, 0, 1.0
    v_mov_b32 v61, s56
    s_mov_b32 s31, 0x3e8b97f6
K_h2:
    s_add_u32 m0, s49, 10240
    s_mov_b32 exec_hi, 0
    buffer_load_dwordx4 v23, s[16:19], s52 offen lds
    s_mov_b32 exec_hi, -1
    s_add_u32 m0, s50, 104448
    s_nop 0
    buffer_load_dwordx4 v24, s[20:23], s53 offen lds
    buffer_load_dwordx4 v25, s[20:23], s53 offen offset:1024 lds
    s_waitcnt lgkmcnt(0)
    s_add_u32 s12, s10, 0x5a3c9671
    s_xor_b32 s13, s11, 0x2b7e1516
    s_add_u32 s28, s28, s12
    s_mov_b32 s29, s13
    s_waitcnt vmcnt(5)
    s_barrier
    s_add_u32 m0, s50, 112640
    s_nop 0
    buffer_load_dwordx4 v26, s[20:23], s53 offen lds
    buffer_load_dwordx4 v27, s[20:23], s53 offen offset:1024 lds
    s_add_u32 m0, s50, 120832
    s_mul_i32 s53, s45, 172032
    s_add_u32 s53, s53, s48
    s_add_u32 s45, s45, 1
    s_cmp_eq_u32 s45, 7
    s_cselect_b32 s45, 0, s45
    buffer_load_dwordx4 v28, s[20:23], s53 offen lds
    buffer_load_dwordx4 v29, s[20:23], s53 offen offset:1024 lds
    s_lshl_b32 s40, s44, 7
    s_add_u32 s51, s40, s46
    s_add_u32 s52, s40, s47
    s_mul_i32 s53, s44, 172032
    s_add_u32 s53, s53, s48
    s_add_u32 m0, s50, 22528
    s_add_u32 s44, s44, 1
    s_cmp_eq_u32 s44, 7
    s_cselect_b32 s44, 0, s44
    buffer_load_dwordx4 v21, s[16:19], s51 offen lds
    buffer_load_dwordx4 v22, s[16:19], s51 offen offset:1024 lds
    s_add_u32 m0, s49, 20480
    s_mov_b32 exec_hi, 0
    buffer_load_dwordx4 v23, s[16:19], s52 offen lds
    s_mov_b32 exec_hi, -1
    s_add_u32 m0, s50, 129024
    s_nop 0
    buffer_load_dwordx4 v24, s[20:23], s53 offen lds
    buffer_load_dwordx4 v25, s[20:23], s53 offen offset:1024 lds
    s_add_u32 m0, s50, 137216
    s_nop 0
    buffer_load_dwordx4 v26, s[20:23], s53 offen lds
    buffer_load_dwordx4 v27, s[20:23], s53 offen offset:1024 lds
    s_add_u32 m0, s50, 145408
    s_mul_i32 s53, s45, 172032
    s_add_u32 s53, s53, s48
    s_add_u32 s45, s45, 1
    s_cmp_eq_u32 s45, 7
    s_cselect_b32 s45, 0, s45
    buffer_load_dwordx4 v28, s[20:23], s53 offen lds
    buffer_load_dwordx4 v29, s[20:23], s53 offen offset:1024 lds
    s_lshl_b32 s40, s44, 7
    s_add_u32 s51, s40, s46
    s_add_u32 s52, s40, s47
    s_mul_i32 s53, s44, 172032
    s_add_u32 s53, s53, s48
    s_add_u32 m0, s50, 32768
    s_add_u32 s44, s44, 1
    s_cmp_eq_u32 s44, 7
    s_cselect_b32 s44, 0, s44
    buffer_load_dwordx4 v21, s[16:19], s51 offen lds
    s_waitcnt vmcnt(10)
    s_barrier
    buffer_load_dwordx4 v22, s[16:19], s51 offen offset:1024 lds
    s_add_u32 m0, s49, 30720
    s_mov_b32 exec_hi, 0
    buffer_load_dwordx4 v23, s[16:19], s52 offen lds
    s_mov_b32 exec_hi, -1
    s_add_u32 m0, s50, 153600
    s_nop 0
    buffer_load_dwordx4 v24, s[20:23], s53 offen lds
    buffer_load_dwordx4 v25, s[20:23], s53 offen offset:1024 lds
    s_add_u32 m0, s50, 71680
    s_nop 0
    buffer_load_dwordx4 v26, s[20:23], s53 offen lds
    buffer_load_dwordx4 v27, s[20:23], s53 offen offset:1024 lds
    s_add_u32 m0, s50, 79872
    s_mul_i32 s53, s45, 172032
    s_add_u32 s53, s53, s48
    s_add_u32 s45, s45, 1
    s_cmp_eq_u32 s45, 7
    s_cselect_b32 s45, 0, s45
    buffer_load_dwordx4 v28, s[20:23], s53 offen lds
    buffer_load_dwordx4 v29, s[20:23], s53 offen offset:1024 lds
    s_lshl_b32 s40, s44, 7
    s_add_u32 s51, s40, s46
    s_add_u32 s52, s40, s47
    s_mul_i32 s53, s44, 172032
    s_add_u32 s53, s53, s48
    s_add_u32 m0, s50, 43008
    s_add_u32 s44, s44, 1
    s_cmp_eq_u32 s44, 7
    s_cselect_b32 s44, 0, s44
    buffer_load_dwordx4 v21, s[16:19], s51 offen lds
    buffer_load_dwordx4 v22, s[16:19], s51 offen offset:1024 lds
    s_add_u32 m0, s49, 40960
    s_mov_b32 exec_hi, 0
    buffer_load_dwordx4 v23, s[16:19], s52 offen lds
    s_mov_b32 exec_hi, -1
    s_waitcnt vmcnt(12)
    s_barrier
    s_add_u32 m0, s50, 88064
    s_nop 0
    buffer_load_dwordx4 v24, s[20:23], s53 offen lds
    buffer_load_dwordx4 v25, s[20:23], s53 offen offset:1024 lds
    s_add_u32 m0, s50, 96256
    s_nop 0
    buffer_load_dwordx4 v26, s[20:23], s53 offen lds
    buffer_load_dwordx4 v27, s[20:23], s53 offen offset:1024 lds
    s_add_u32 m0, s50, 104448
    s_mul_i32 s53, s45, 172032
    s_add_u32 s53, s53, s48
    s_add_u32 s45, s45, 1
    s_cmp_eq_u32 s45, 7
    s_cselect_b32 s45, 0, s45
    buffer_load_dwordx4 v28, s[20:23], s53 offen lds
    buffer_load_dwordx4 v29, s[20:23], s53 offen offset:1024 lds
    buffer_load_dwordx2 v[18:19], v20, s[36:39], s30 offen sc1
    s_lshl_b32 s40, s44, 7
    s_add_u32 s51, s40, s46
    s_add_u32 s52, s40, s47
    s_mul_i32 s53, s44, 172032
    s_add_u32 s53, s53, s48
    s_add_u32 m0, s50, 53248
    s_add_u32 s44, s44, 1
    s_cmp_eq_u32 s44, 7
    s_cselect_b32 s44, 0, s44
    buffer_load_dwordx4 v21, s[16:19], s51 offen lds
    buffer_load_dwordx4 v22, s[16:19], s51 offen offset:1024 lds
    s_waitcnt vmcnt(12)
    s_barrier
    s_add_u32 m0, s49, 51200
    s_mov_b32 exec_hi, 0
    buffer_load_dwordx4 v23, s[16:19], s52 offen lds
    s_mov_b32 exec_hi, -1
    s_add_u32 m0, s50, 112640
    s_nop 0
    buffer_load_dwordx4 v24, s[20:23], s53 offen lds
    buffer_load_dwordx4 v25, s[20:23], s53 offen offset:1024 lds
    s_add_u32 m0, s50, 120832
    s_nop 0
    buffer_load_dwordx4 v26, s[20:23], s53 offen lds
    buffer_load_dwordx4 v27, s[20:23], s53 offen offset:1024 lds
    s_add_u32 m0, s50, 129024
    s_mul_i32 s53, s45, 172032
    s_add_u32 s53, s53, s48
    s_add_u32 s45, s45, 1
    s_cmp_eq_u32 s45, 7
    s_cselect_b32 s45, 0, s45
    buffer_load_dwordx4 v28, s[20:23], s53 offen lds
    buffer_load_dwordx4 v29, s[20:23], s53 offen offset:1024 lds
    s_lshl_b32 s40, s44, 7
    s_add_u32 s51, s40, s46
    s_add_u32 s52, s40, s47
    s_mul_i32 s53, s44, 172032
    s_add_u32 s53, s53, s48
    s_add_u32 m0, s50, 63488
    s_add_u32 s44, s44, 1
    s_cmp_eq_u32 s44, 7
    s_cselect_b32 s44, 0, s44
    buffer_load_dwordx4 v21, s[16:19], s51 offen lds
    s_waitcnt vmcnt(11)
    s_barrier
    buffer_load_dwordx4 v22, s[16:19], s51 offen offset:1024 lds
    s_add_u32 m0, s49, 61440
    s_mov_b32 exec_hi, 0
    buffer_load_dwordx4 v23, s[16:19], s52 offen lds
    s_mov_b32 exec_hi, -1
    s_add_u32 m0, s50, 137216
    s_nop 0
    buffer_load_dwordx4 v24, s[20:23], s53 offen lds
    buffer_load_dwordx4 v25, s[20:23], s53 offen offset:1024 lds
    s_add_u32 m0, s50, 145408
    s_nop 0
    buffer_load_dwordx4 v26, s[20:23], s53 offen lds
    buffer_load_dwordx4 v27, s[20:23], s53 offen offset:1024 lds
    s_add_u32 m0, s50, 153600
    s_mul_i32 s53, s45, 172032
    s_add_u32 s53, s53, s48
    s_add_u32 s45, s45, 1
    s_cmp_eq_u32 s45, 7
    s_cselect_b32 s45, 0, s45
    buffer_load_dwordx4 v28, s[20:23], s53 offen lds
    buffer_load_dwordx4 v29, s[20:23], s53 offen offset:1024 lds
    s_waitcnt vmcnt(9)
    s_barrier
    s_mov_b32 s101, 1

    v_cmp_ne_u32 vcc, s28, v18
    v_cmp_ne_u32 s[42:43], s29, v19
    s_nop 0
    s_or_b64 vcc, vcc, s[42:43]
    s_cbranch_vccnz X_cH
        X_okH:

    v_mov_b32 v2, s101
    ds_write_b32 v5, v2 offset:4
    s_lshl_b32 s40, s54, 13
    s_add_u32 s40, s40, s50
    s_add_u32 m0, s40, 71680
    s_mul_i32 s40, s54, 57344
    s_add_u32 s40, s40, s55
    s_add_u32 s54, s54, 1
    s_cmp_eq_u32 s54, 4
    s_cselect_b32 s54, 0, s54
    buffer_load_dwordx4 v10, s[24:27], s40 offen lds
    buffer_load_dwordx4 v11, s[24:27], s40 offen offset:1024 lds
    s_lshl_b32 s40, s54, 13
    s_add_u32 s40, s40, s50
    s_add_u32 m0, s40, 71680
    s_mul_i32 s40, s54, 57344
    s_add_u32 s40, s40, s55
    s_add_u32 s54, s54, 1
    s_cmp_eq_u32 s54, 4
    s_cselect_b32 s54, 0, s54
    buffer_load_dwordx4 v10, s[24:27], s40 offen lds
    s_waitcnt lgkmcnt(0)
    s_waitcnt vmcnt(5)
    s_barrier
    s_setprio 0
    buffer_load_dwordx4 v11, s[24:27], s40 offen offset:1024 lds
    s_lshl_b32 s40, s54, 13
    s_add_u32 s40, s40, s50
    s_add_u32 m0, s40, 71680
    s_mul_i32 s40, s54, 57344
    s_add_u32 s40, s40, s55
    s_add_u32 s54, s54, 1
    s_cmp_eq_u32 s54, 4
    s_cselect_b32 s54, 0, s54
    buffer_load_dwordx4 v10, s[24:27], s40 offen lds
    buffer_load_dwordx4 v11, s[24:27], s40 offen offset:1024 lds
    buffer_load_dword v13, v12, s[36:39], 0 offen sc1
    s_lshl_b32 s40, s54, 13
    s_add_u32 s40, s40, s50
    s_add_u32 m0, s40, 71680
    s_mul_i32 s40, s54, 57344
    s_add_u32 s40, s40, s55
    s_add_u32 s54, s54, 1
    s_cmp_eq_u32 s54, 4
    s_cselect_b32 s54, 0, s54
    buffer_load_dwordx4 v10, s[24:27], s40 offen lds
    buffer_load_dwordx4 v11, s[24:27], s40 offen offset:1024 lds
    s_waitcnt vmcnt(9)
    s_mov_b64 exec, 1
    ds_add_u32 v5, v14 offset:32
    s_mov_b64 exec, -1
    s_add_u32 m0, s50, 104448
    s_add_u32 s40, s55, 229376
    buffer_load_dwordx4 v10, s[24:27], s40 offen lds
    buffer_load_dwordx4 v11, s[24:27], s40 offen offset:1024 lds
    s_add_u32 m0, s50, 112640
    s_add_u32 s40, s55, 286720
    buffer_load_dwordx4 v10, s[24:27], s40 offen lds
    buffer_load_dwordx4 v11, s[24:27], s40 offen offset:1024 lds
    s_add_u32 m0, s50, 120832
    s_add_u32 s40, s55, 344064
    buffer_load_dwordx4 v10, s[24:27], s40 offen lds
    buffer_load_dwordx4 v11, s[24:27], s40 offen offset:1024 lds
    s_mov_b32 s9, 0
    s_setprio 0
        H_il:
    ds_read_b64 v[62:63], v58 offset:16
    ds_read_b128 v[30:33], v56
    ds_read_b128 v[34:37], v57
    s_add_u32 s9, s9, 1
    s_cmp_gt_u32 s9, 1600000
    s_cbranch_scc1 H_id
    s_waitcnt lgkmcnt(2)
    v_and_b32 v62, v62, v63
    v_cmp_eq_u32 vcc, 0, v62
    s_waitcnt lgkmcnt(0)
    s_cbranch_vccnz H_il
        H_id:
    s_waitcnt lgkmcnt(0)

    v_fma_f32 v30, v34, v61, v30
    v_fma_f32 v31, v35, v61, v31
    v_fma_f32 v32, v36, v61, v32
    v_fma_f32 v33, v37, v61, v33
    v_max_f32 v62, v30, v31
    v_max_f32 v63, v32, v33
    v_mov_b32 v64, v62
    v_mov_b32 v65, v63
    s_nop 0
    v_permlane16_swap_b32 v62, v64
    v_permlane16_swap_b32 v63, v65
    v_max_f32 v62, v62, v64
    v_max_f32 v63, v63, v65
    v_mov_b32 v64, v62
    v_mov_b32 v65, v63
    s_nop 0
    v_permlane32_swap_b32 v62, v64
    v_permlane32_swap_b32 v63, v65
    v_max_f32 v62, v62, v64
    v_max_f32 v63, v63, v65
    v_mul_f32 v62, s31, v62
    v_mul_f32 v63, s31, v63
    v_fma_f32 v30, v30, s31, -v62
    v_fma_f32 v31, v31, s31, -v62
    v_fma_f32 v32, v32, s31, -v63
    v_fma_f32 v33, v33, s31, -v63
    v_exp_f32 v30, v30
    v_exp_f32 v31, v31
    v_exp_f32 v32, v32
    v_exp_f32 v33, v33
    v_add_f32 v62, v30, v31
    v_add_f32 v63, v32, v33
    v_mov_b32 v64, v62
    v_mov_b32 v65, v63
    s_nop 0
    v_permlane16_swap_b32 v62, v64
    v_permlane16_swap_b32 v63, v65
    v_add_f32 v62, v62, v64
    v_add_f32 v63, v63, v65
    v_mov_b32 v64, v62
    v_mov_b32 v65, v63
    s_nop 0
    v_permlane32_swap_b32 v62, v64
    v_permlane32_swap_b32 v63, v65
    v_add_f32 v62, v62, v64
    v_add_f32 v63, v63, v65
    v_rcp_f32 v62, v62
    v_rcp_f32 v63, v63
    v_mul_f32 v30, v30, v62
    v_mul_f32 v31, v31, v62
    v_mul_f32 v32, v32, v63
    v_mul_f32 v33, v33, v63
    v_cvt_pk_bf16_f32 v30, v30, v30
    v_cvt_pk_bf16_f32 v31, v31, v31
    v_cvt_pk_bf16_f32 v32, v32, v32
    v_cvt_pk_bf16_f32 v33, v33, v33
    v_and_b32 v38, v52, v30
    v_and_b32 v39, v53, v31
    v_and_b32 v40, v54, v30
    v_and_b32 v41, v55, v31
    ds_write_b128 v59, v[38:41] offset:49152
    v_and_b32 v42, v52, v32
    v_and_b32 v43, v53, v33
    v_and_b32 v44, v54, v32
    v_and_b32 v45, v55, v33
    ds_write_b128 v59, v[42:45] offset:50176
    ds_write_b32 v60, v5 offset:40
    s_setprio 0
    s_waitcnt vmcnt(0)
    s_mov_b64 exec, 1
    ds_add_u32 v5, v14 offset:12

    s_endpgm
K_spare2:
    buffer_load_dwordx4 v7, s[28:31], s53 offen nt lds
    s_add_u32 m0, m0, 1024
    s_mov_b32 s26, 401408
    s_mov_b32 s27, 0x00020000
    s_mov_b32 s34, 3670016
    s_mov_b32 s35, 0x00020000
    v_and_b32 v6, 15, v0
    v_lshlrev_b32 v6, 4, v6
    v_bfe_u32 v4, v0, 4, 2
    v_lshl_add_u32 v4, v4, 9, s42
    v_add_u32 v10, v4, v6
    v_sub_u32 v11, v4, v6
    v_add_u32 v11, 432, v11
    v_mov_b32 v12, 0
    s_and_b32 s55, s3, 3
    s_lshr_b32 s56, s3, 2
    v_and_b32 v1, 63, v0
    v_lshrrev_b32 v2, 4, v1
    v_and_b32 v3, 15, v1
    s_lshl_b32 s61, s55, 3
    v_lshrrev_b32 v4, 1, v3
    v_add_u32 v4, s61, v4
    v_and_b32 v5, 1, v3
    v_cvt_f32_u32 v73, v5
    v_mul_f32 v73, 0x3e800000, v73
    v_lshl_add_u32 v5, v4, 1, v5
    v_cmp_eq_u32 vcc, 1, v5
    s_nop 1
    v_cndmask_b32 v4, v4, 32, vcc
    v_cndmask_b32 v73, v73, 0, vcc
    v_cvt_f32_u32 v72, v4
    v_mul_f32 v72, 0x3c800000, v72
    v_lshlrev_b32 v4, 3, v2
    v_cvt_f32_u32 v4, v4
    v_fma_f32 v73, v72, v4, v73
    v_fmamk_f32 v78, v72, 0x0, v73
    v_fmamk_f32 v79, v72, 0x3f800000, v73
    v_fmamk_f32 v80, v72, 0x40000000, v73
    v_fmamk_f32 v81, v72, 0x40400000, v73
    v_fmamk_f32 v82, v72, 0x40800000, v73
    v_fmamk_f32 v83, v72, 0x40a00000, v73
    v_fmamk_f32 v84, v72, 0x40c00000, v73
    v_fmamk_f32 v85, v72, 0x40e00000, v73
    v_cos_f32 v78, v78
    v_cos_f32 v79, v79
    v_cos_f32 v80, v80
    v_cos_f32 v81, v81
    v_cos_f32 v82, v82
    v_cos_f32 v83, v83
    v_cos_f32 v84, v84
    v_cos_f32 v85, v85
    v_cvt_pk_bf16_f32 v20, v78, v79
    v_cvt_pk_bf16_f32 v21, v80, v81
    v_cvt_pk_bf16_f32 v22, v82, v83
    v_cvt_pk_bf16_f32 v23, v84, v85
    v_fmamk_f32 v78, v72, 0x42000000, v73
    v_fmamk_f32 v79, v72, 0x42040000, v73
    v_fmamk_f32 v80, v72, 0x42080000, v73
    v_fmamk_f32 v81, v72, 0x420c0000, v73
    v_fmamk_f32 v82, v72, 0x42100000, v73
    v_fmamk_f32 v83, v72, 0x42140000, v73
    v_fmamk_f32 v84, v72, 0x42180000, v73
    v_fmamk_f32 v85, v72, 0x421c0000, v73
    v_cos_f32 v78, v78
    v_cos_f32 v79, v79
    v_cos_f32 v80, v80
    v_cos_f32 v81, v81
    v_cos_f32 v82, v82
    v_cos_f32 v83, v83
    v_cos_f32 v84, v84
    v_cos_f32 v85, v85
    v_cvt_pk_bf16_f32 v24, v78, v79
    v_cvt_pk_bf16_f32 v25, v80, v81
    v_cvt_pk_bf16_f32 v26, v82, v83
    v_cvt_pk_bf16_f32 v27, v84, v85
    buffer_load_dwordx4 v7, s[28:31], s54 offen nt lds
    s_add_u32 m0, m0, 1024
    v_lshrrev_b32 v4, 4, v0
    v_and_b32 v5, 3, v4
    v_lshlrev_b32 v5, 6, v5
    v_lshlrev_b32 v13, 1, v6
    v_xor_b32 v13, v13, v5
    v_bfe_u32 v5, v4, 3, 1
    v_lshl_add_u32 v13, v5, 4, v13
    v_lshl_add_u32 v13, v4, 9, v13
    v_add_u32 v13, 65536, v13
    v_xor_b32 v14, 16, v13
    v_lshrrev_b32 v4, 2, v3
    v_lshl_add_u32 v5, v2, 3, v4
    v_lshlrev_b32 v5, 9, v5
    v_lshl_add_u32 v5, v4, 6, v5
    v_and_b32 v4, 1, v1
    v_lshl_add_u32 v5, v4, 5, v5
    v_bfe_u32 v4, v1, 1, 1
    v_lshl_add_u32 v5, v4, 3, v5
    v_and_b32 v4, 1, v2
    v_xor_b32 v4, s56, v4
    v_lshl_add_u32 v16, v4, 4, v5
    v_add_u32 v16, 65536, v16
    v_xor_b32 v17, 64, v16
    v_xor_b32 v18, 128, v16
    v_xor_b32 v19, 192, v16
    v_lshlrev_b32 v15, 16, v2
    v_lshrrev_b32 v4, 3, v3
    v_lshl_add_u32 v15, v4, 13, v15
    v_and_b32 v4, 7, v3
    v_lshl_add_u32 v15, v4, 4, v15
    buffer_load_dwordx4 v8, s[28:31], s52 offen nt lds
    s_add_u32 m0, m0, 1024
    s_lshl_b32 s59, s55, 18
    s_lshl_b32 s61, s56, 14
    s_add_u32 s59, s59, s61
    s_lshl_b32 s61, s8, 7
    s_add_u32 s59, s59, s61
    s_add_u32 s59, s59, 1048576
    s_mov_b32 s57, s56
    s_add_u32 s63, s8, 1024
    s_cmp_eq_u32 s8, 0
    s_cselect_b32 s63, 32, s63
    s_cmp_eq_u32 s57, 0
    s_cselect_b32 s58, s8, s63
    v_lshl_add_u32 v4, v3, 6, s58
    v_cvt_f32_u32 v72, v4
    v_mul_f32 v72, 0x3a000000, v72
    v_lshlrev_b32 v4, 3, v2
    v_cvt_f32_u32 v4, v4
    v_mul_f32 v73, v72, v4
    v_fmamk_f32 v78, v72, 0x0, v73
    v_fmamk_f32 v79, v72, 0x3f800000, v73
    v_fmamk_f32 v80, v72, 0x40000000, v73
    v_fmamk_f32 v81, v72, 0x40400000, v73
    v_fmamk_f32 v82, v72, 0x40800000, v73
    v_fmamk_f32 v83, v72, 0x40a00000, v73
    v_fmamk_f32 v84, v72, 0x40c00000, v73
    v_fmamk_f32 v85, v72, 0x40e00000, v73
    v_sin_f32 v86, v78
    v_cos_f32 v78, v78
    v_sin_f32 v87, v79
    v_cos_f32 v79, v79
    v_sin_f32 v88, v80
    v_cos_f32 v80, v80
    v_sin_f32 v89, v81
    buffer_load_dwordx4 v8, s[28:31], 0 offen nt lds
    s_add_u32 m0, m0, 1024
    v_cos_f32 v81, v81
    v_sin_f32 v90, v82
    v_cos_f32 v82, v82
    v_sin_f32 v91, v83
    v_cos_f32 v83, v83
    v_sin_f32 v92, v84
    v_cos_f32 v84, v84
    v_sin_f32 v93, v85
    v_cos_f32 v85, v85
    v_cvt_pk_bf16_f32 v28, v78, v79
    v_cvt_pk_bf16_f32 v32, v86, v87
    v_mov_b32 v40, v28
    v_xor_b32 v36, 0x80008000, v32
    v_cvt_pk_bf16_f32 v29, v80, v81
    v_cvt_pk_bf16_f32 v33, v88, v89
    v_mov_b32 v41, v29
    v_xor_b32 v37, 0x80008000, v33
    v_cvt_pk_bf16_f32 v30, v82, v83
    v_cvt_pk_bf16_f32 v34, v90, v91
    v_mov_b32 v42, v30
    v_xor_b32 v38, 0x80008000, v34
    v_cvt_pk_bf16_f32 v31, v84, v85
    v_cvt_pk_bf16_f32 v35, v92, v93
    v_mov_b32 v43, v31
    v_xor_b32 v39, 0x80008000, v35
    s_cmp_eq_u32 s8, 0
    s_cbranch_scc1 S_cls0
S_reg:
    v_lshlrev_b32 v47, 4, v1
    v_and_b32 v4, 16, v1
    v_lshlrev_b32 v4, 1, v4
    v_xor_b32 v44, v47, v4
    v_xor_b32 v45, 64, v44
    s_lshl_b32 s60, s8, 3
    s_add_u32 s60, s60, s3
    s_lshl_b32 s60, s60, 12
    s_add_u32 s60, s60, 1048576
    v_lshrrev_b32 v4, 2, v3
    v_lshl_add_u32 v4, v2, 3, v4
    v_lshlrev_b32 v4, 7, v4
    v_and_b32 v5, 3, v1
    v_lshl_add_u32 v4, v5, 3, v4
    v_bfe_u32 v5, v1, 3, 2
    v_lshl_add_u32 v4, v5, 5, v4
    s_lshl_b32 s61, s55, 13
    s_add_u32 s61, s61, 0
    v_add_u32 v46, s61, v4
    v_mov_b32 v52, 81920
    v_lshl_add_u32 v52, s56, 2, v52
    v_mov_b32 v59, 1
    s_lshl_b32 s61, s56, 11
    v_add_u32 v53, s61, v47
    s_lshl_b32 s61, s56, 4
    v_add_u32 v4, s61, v3
    v_mul_u32_u24 v4, 528, v4
    v_add_u32 v4, 98304, v4
    v_lshl_add_u32 v5, s55, 2, v2
    v_lshl_add_u32 v48, v5, 4, v4
    s_and_b32 s61, s3, 1
    s_lshl_b32 s61, s61, 3
    v_lshrrev_b32 v4, 3, v1
    v_add_u32 v4, s61, v4
    v_and_b32 v5, 7, v1
    v_lshlrev_b32 v5, 4, v5
    s_and_b32 s61, s3, 2
    s_add_u32 s61, s61, s56
    s_mul_i32 s61, s61, 8448
    s_add_u32 s61, s61, 98304
    v_mul_u32_u24 v72, 528, v4
    v_add3_u32 v49, v72, v5, s61
    v_add_u32 v73, s61, v72
    s_bitcmp1_b32 s3, 1
    s_cselect_b32 s62, -1, 1
    s_mul_i32 s62, s62, 16896
    s_waitcnt lgkmcnt(0)
    s_add_u32 s12, s10, 0x5a3c9671
    s_xor_b32 s13, s11, 0x2b7e1516
    v_cmp_eq_u32 vcc, 0, v6

    s_waitcnt vmcnt(4)
    ds_read_b128 v[94:97], v10 offset:0
    ds_read_b32 v110, v11 offset:2128
    ds_read_b128 v[98:101], v11 offset:2112
    ds_read_b128 v[106:109], v10 offset:2112
    ds_read_b32 v111, v11 offset:16
    ds_read_b128 v[102:105], v11 offset:0
    s_waitcnt lgkmcnt(3)
    v_cndmask_b32 v110, v110, v94, vcc

    v_lshlrev_b32 v112, 16, v94
    v_lshlrev_b32 v128, 16, v110
    v_and_b32 v113, 0xffff0000, v94
    v_and_b32 v129, 0xffff0000, v101
    v_pk_add_f32 v[112:113], v[112:113], v[128:129]
    v_lshlrev_b32 v114, 16, v95
    v_lshlrev_b32 v128, 16, v101
    v_and_b32 v115, 0xffff0000, v95
    v_and_b32 v129, 0xffff0000, v100
    v_pk_add_f32 v[114:115], v[114:115], v[128:129]
    v_lshlrev_b32 v116, 16, v96
    v_lshlrev_b32 v128, 16, v100
    v_and_b32 v117, 0xffff0000, v96
    v_and_b32 v129, 0xffff0000, v99
    v_pk_add_f32 v[116:117], v[116:117], v[128:129]
    v_lshlrev_b32 v118, 16, v97
    v_lshlrev_b32 v128, 16, v99
    v_and_b32 v119, 0xffff0000, v97
    v_and_b32 v129, 0xffff0000, v98
    v_pk_add_f32 v[118:119], v[118:119], v[128:129]
    s_waitcnt lgkmcnt(0)
    v_lshlrev_b32 v120, 16, v106
    v_lshlrev_b32 v128, 16, v111
    v_and_b32 v121, 0xffff0000, v106
    v_and_b32 v129, 0xffff0000, v105
    v_pk_add_f32 v[120:121], v[120:121], v[128:129]
    v_lshlrev_b32 v122, 16, v107
    v_lshlrev_b32 v128, 16, v105
    v_and_b32 v123, 0xffff0000, v107
    v_and_b32 v129, 0xffff0000, v104
    v_pk_add_f32 v[122:123], v[122:123], v[128:129]
    v_lshlrev_b32 v124, 16, v108
    v_lshlrev_b32 v128, 16, v104
    v_and_b32 v125, 0xffff0000, v108
    v_and_b32 v129, 0xffff0000, v103
    v_pk_add_f32 v[124:125], v[124:125], v[128:129]
    v_lshlrev_b32 v126, 16, v109
    v_lshlrev_b32 v128, 16, v103
    v_and_b32 v127, 0xffff0000, v109
    v_and_b32 v129, 0xffff0000, v102
    v_pk_add_f32 v[126:127], v[126:127], v[128:129]
    v_pk_add_f32 v[138:139], v[112:113], v[120:121]
    v_pk_add_f32 v[140:141], v[114:115], v[122:123]
    v_pk_add_f32 v[142:143], v[116:117], v[124:125]
    v_pk_add_f32 v[144:145], v[118:119], v[126:127]
    v_cvt_pk_bf16_f32 v130, v138, v140
    v_cvt_pk_bf16_f32 v131, v142, v144
    v_cvt_pk_bf16_f32 v132, v139, v141
    v_cvt_pk_bf16_f32 v133, v143, v145
    ds_write_b128 v13, v[130:133] offset:0
    v_pk_add_f32 v[138:139], v[112:113], v[120:121] neg_lo:[0,1] neg_hi:[0,1]
    v_pk_add_f32 v[140:141], v[114:115], v[122:123] neg_lo:[0,1] neg_hi:[0,1]
    v_pk_add_f32 v[142:143], v[116:117], v[124:125] neg_lo:[0,1] neg_hi:[0,1]
    v_pk_add_f32 v[144:145], v[118:119], v[126:127] neg_lo:[0,1] neg_hi:[0,1]
    v_cvt_pk_bf16_f32 v134, v138, v140
    v_cvt_pk_bf16_f32 v135, v142, v144
    v_cvt_pk_bf16_f32 v136, v139, v141
    v_cvt_pk_bf16_f32 v137, v143, v145
    ds_write_b128 v14, v[134:137] offset:0
    s_waitcnt lgkmcnt(0)
    s_barrier
    ds_read_b64_tr_b16 v[146:147], v16 offset:0
    ds_read_b64_tr_b16 v[148:149], v16 offset:2048
    ds_read_b64_tr_b16 v[150:151], v17 offset:0
    ds_read_b64_tr_b16 v[152:153], v17 offset:2048
    ds_read_b64_tr_b16 v[154:155], v18 offset:0
    ds_read_b64_tr_b16 v[156:157], v18 offset:2048
    ds_read_b64_tr_b16 v[158:159], v19 offset:0
    ds_read_b64_tr_b16 v[160:161], v19 offset:2048
    s_waitcnt lgkmcnt(6)
    v_mfma_f32_16x16x32_bf16 v[162:165], v[20:23], v[146:149], 0
    ds_read_b64_tr_b16 v[146:147], v16 offset:256
    ds_read_b64_tr_b16 v[148:149], v16 offset:2304
    s_waitcnt lgkmcnt(6)
    v_mfma_f32_16x16x32_bf16 v[166:169], v[20:23], v[150:153], 0
    ds_read_b64_tr_b16 v[150:151], v17 offset:256
    ds_read_b64_tr_b16 v[152:153], v17 offset:2304
    s_waitcnt lgkmcnt(6)
    v_mfma_f32_16x16x32_bf16 v[170:173], v[20:23], v[154:157], 0
    ds_read_b64_tr_b16 v[154:155], v18 offset:256
    ds_read_b64_tr_b16 v[156:157], v18 offset:2304
    s_waitcnt lgkmcnt(6)
    v_mfma_f32_16x16x32_bf16 v[174:177], v[20:23], v[158:161], 0
    ds_read_b64_tr_b16 v[158:159], v19 offset:256
    ds_read_b64_tr_b16 v[160:161], v19 offset:2304
    s_waitcnt lgkmcnt(6)
    v_mfma_f32_16x16x32_bf16 v[178:181], v[20:23], v[146:149], 0
    s_waitcnt lgkmcnt(4)
    v_mfma_f32_16x16x32_bf16 v[182:185], v[20:23], v[150:153], 0
    s_waitcnt lgkmcnt(2)
    v_mfma_f32_16x16x32_bf16 v[186:189], v[20:23], v[154:157], 0
    s_waitcnt lgkmcnt(0)
    v_mfma_f32_16x16x32_bf16 v[190:193], v[20:23], v[158:161], 0
    s_waitcnt vmcnt(0)
    ds_read_b128 v[94:97], v10 offset:4096
    ds_read_b32 v110, v11 offset:6224
    ds_read_b128 v[98:101], v11 offset:6208
    ds_read_b128 v[106:109], v10 offset:6208
    ds_read_b32 v111, v11 offset:4112
    ds_read_b128 v[102:105], v11 offset:4096
    s_waitcnt lgkmcnt(3)
    v_cndmask_b32 v110, v110, v94, vcc

    v_lshlrev_b32 v112, 16, v94
    v_lshlrev_b32 v128, 16, v110
    v_and_b32 v113, 0xffff0000, v94
    v_and_b32 v129, 0xffff0000, v101
    v_pk_add_f32 v[112:113], v[112:113], v[128:129]
    v_lshlrev_b32 v114, 16, v95
    v_lshlrev_b32 v128, 16, v101
    v_and_b32 v115, 0xffff0000, v95
    v_and_b32 v129, 0xffff0000, v100
    v_pk_add_f32 v[114:115], v[114:115], v[128:129]
    v_lshlrev_b32 v116, 16, v96
    v_lshlrev_b32 v128, 16, v100
    v_and_b32 v117, 0xffff0000, v96
    v_and_b32 v129, 0xffff0000, v99
    v_pk_add_f32 v[116:117], v[116:117], v[128:129]
    v_lshlrev_b32 v118, 16, v97
    v_lshlrev_b32 v128, 16, v99
    v_and_b32 v119, 0xffff0000, v97
    v_and_b32 v129, 0xffff0000, v98
    v_pk_add_f32 v[118:119], v[118:119], v[128:129]
    s_waitcnt lgkmcnt(0)
    v_lshlrev_b32 v120, 16, v106
    v_lshlrev_b32 v128, 16, v111
    v_and_b32 v121, 0xffff0000, v106
    v_and_b32 v129, 0xffff0000, v105
    v_pk_add_f32 v[120:121], v[120:121], v[128:129]
    v_lshlrev_b32 v122, 16, v107
    v_lshlrev_b32 v128, 16, v105
    v_and_b32 v123, 0xffff0000, v107
    v_and_b32 v129, 0xffff0000, v104
    v_pk_add_f32 v[122:123], v[122:123], v[128:129]
    v_lshlrev_b32 v124, 16, v108
    v_lshlrev_b32 v128, 16, v104
    v_and_b32 v125, 0xffff0000, v108
    v_and_b32 v129, 0xffff0000, v103
    v_pk_add_f32 v[124:125], v[124:125], v[128:129]
    v_lshlrev_b32 v126, 16, v109
    v_lshlrev_b32 v128, 16, v103
    v_and_b32 v127, 0xffff0000, v109
    v_and_b32 v129, 0xffff0000, v102
    v_pk_add_f32 v[126:127], v[126:127], v[128:129]
    v_pk_add_f32 v[138:139], v[112:113], v[120:121]
    v_pk_add_f32 v[140:141], v[114:115], v[122:123]
    v_pk_add_f32 v[142:143], v[116:117], v[124:125]
    v_pk_add_f32 v[144:145], v[118:119], v[126:127]
    v_cvt_pk_bf16_f32 v130, v138, v140
    v_cvt_pk_bf16_f32 v131, v142, v144
    v_cvt_pk_bf16_f32 v132, v139, v141
    v_cvt_pk_bf16_f32 v133, v143, v145
    ds_write_b128 v13, v[130:133] offset:16384
    v_pk_add_f32 v[138:139], v[112:113], v[120:121] neg_lo:[0,1] neg_hi:[0,1]
    v_pk_add_f32 v[140:141], v[114:115], v[122:123] neg_lo:[0,1] neg_hi:[0,1]
    v_pk_add_f32 v[142:143], v[116:117], v[124:125] neg_lo:[0,1] neg_hi:[0,1]
    v_pk_add_f32 v[144:145], v[118:119], v[126:127] neg_lo:[0,1] neg_hi:[0,1]
    v_cvt_pk_bf16_f32 v134, v138, v140
    v_cvt_pk_bf16_f32 v135, v142, v144
    v_cvt_pk_bf16_f32 v136, v139, v141
    v_cvt_pk_bf16_f32 v137, v143, v145
    ds_write_b128 v14, v[134:137] offset:16384
    s_waitcnt lgkmcnt(0)
    s_barrier
    ds_read_b64_tr_b16 v[146:147], v16 offset:16384
    ds_read_b64_tr_b16 v[148:149], v16 offset:18432
    ds_read_b64_tr_b16 v[150:151], v17 offset:16384
    ds_read_b64_tr_b16 v[152:153], v17 offset:18432
    ds_read_b64_tr_b16 v[154:155], v18 offset:16384
    ds_read_b64_tr_b16 v[156:157], v18 offset:18432
    ds_read_b64_tr_b16 v[158:159], v19 offset:16384
    ds_read_b64_tr_b16 v[160:161], v19 offset:18432
    s_waitcnt lgkmcnt(6)
    v_mfma_f32_16x16x32_bf16 v[162:165], v[24:27], v[146:149], v[162:165]
    ds_read_b64_tr_b16 v[146:147], v16 offset:16640
    ds_read_b64_tr_b16 v[148:149], v16 offset:18688
    s_waitcnt lgkmcnt(6)
    v_mfma_f32_16x16x32_bf16 v[166:169], v[24:27], v[150:153], v[166:169]
    ds_read_b64_tr_b16 v[150:151], v17 offset:16640
    ds_read_b64_tr_b16 v[152:153], v17 offset:18688
    s_waitcnt lgkmcnt(6)
    v_mfma_f32_16x16x32_bf16 v[170:173], v[24:27], v[154:157], v[170:173]
    ds_read_b64_tr_b16 v[154:155], v18 offset:16640
    ds_read_b64_tr_b16 v[156:157], v18 offset:18688
    s_waitcnt lgkmcnt(6)
    v_mfma_f32_16x16x32_bf16 v[174:177], v[24:27], v[158:161], v[174:177]
    ds_read_b64_tr_b16 v[158:159], v19 offset:16640
    ds_read_b64_tr_b16 v[160:161], v19 offset:18688
    s_waitcnt lgkmcnt(6)
    v_mfma_f32_16x16x32_bf16 v[178:181], v[24:27], v[146:149], v[178:181]
    s_waitcnt lgkmcnt(4)
    v_mfma_f32_16x16x32_bf16 v[182:185], v[24:27], v[150:153], v[182:185]
    s_waitcnt lgkmcnt(2)
    v_mfma_f32_16x16x32_bf16 v[186:189], v[24:27], v[154:157], v[186:189]
    s_waitcnt lgkmcnt(0)
    v_mfma_f32_16x16x32_bf16 v[190:193], v[24:27], v[158:161], v[190:193]
    v_cvt_pk_bf16_f32 v94, v162, v166
    v_cvt_pk_bf16_f32 v95, v170, v174
    s_nop 1
    v_cvt_pk_bf16_f32 v96, v178, v182
    s_nop 2
    v_cvt_pk_bf16_f32 v97, v186, v190
    s_add_u32 s41, s59, 0
    buffer_store_dwordx4 v[94:97], v15, s[36:39], s41 offen sc1
    v_cvt_pk_bf16_f32 v98, v163, v167
    v_cvt_pk_bf16_f32 v99, v171, v175
    v_cvt_pk_bf16_f32 v100, v179, v183
    v_cvt_pk_bf16_f32 v101, v187, v191
    s_add_u32 s41, s59, 4096
    buffer_store_dwordx4 v[98:101], v15, s[36:39], s41 offen sc1
    v_cvt_pk_bf16_f32 v102, v164, v168
    v_cvt_pk_bf16_f32 v103, v172, v176
    v_cvt_pk_bf16_f32 v104, v180, v184
    v_cvt_pk_bf16_f32 v105, v188, v192
    s_add_u32 s41, s59, 32768
    buffer_store_dwordx4 v[102:105], v15, s[36:39], s41 offen sc1
    v_cvt_pk_bf16_f32 v106, v165, v169
    v_cvt_pk_bf16_f32 v107, v173, v177
    v_cvt_pk_bf16_f32 v108, v181, v185
    v_cvt_pk_bf16_f32 v109, v189, v193
    s_add_u32 s41, s59, 36864
    buffer_store_dwordx4 v[106:109], v15, s[36:39], s41 offen sc1
    v_add_u32 v55, s62, v73
    s_cmp_eq_u32 s56, 0
    s_cselect_b32 s61, s8, s63
    v_lshl_add_u32 v50, v4, 6, s61
    v_sub_u32 v72, 2048, v50
    v_mov_b32 v4, 1024
    v_cmp_eq_u32 s[42:43], 0, v50
    s_nop 1
    v_cndmask_b32 v72, v72, v4, s[42:43]
    v_cndmask_b32 v55, v55, v73, s[42:43]
    s_bitcmp1_b32 s3, 1
    s_cselect_b64 s[42:43], -1, 0
    v_cndmask_b32 v50, v50, v72, s[42:43]
    v_mov_b32 v72, 1792
    v_mad_u32_u24 v50, v50, v72, v5
    v_sub_u32 v55, v55, v5
    v_and_b32 v4, 4, v1
    v_lshl_add_u32 v54, v4, 5, v49
    v_lshl_add_u32 v57, v4, 5, v50
    v_lshlrev_b32 v4, 4, v4
    v_sub_u32 v56, v55, v4
    v_mov_b32 v58, 0xffff
    s_lshl_b32 s61, s55, 14
    s_add_u32 s61, s61, 98304
    v_add_u32 v51, s61, v47
    v_cmp_eq_u32 s[42:43], 0, v2
    s_nop 1
    v_cndmask_b32 v74, 1.0, 0.5, s[42:43]
    v_and_b32 v4, 1, v2
    v_mov_b32 v5, 0xffff
    v_cmp_eq_u32 s[42:43], 1, v4
    s_nop 1
    v_cndmask_b32 v77, -1, v5, s[42:43]
    v_cndmask_b32 v72, 1.0, 0, s[42:43]
    v_cmp_eq_u32 s[42:43], 1, v2
    s_nop 1
    v_cndmask_b32 v73, v72, 0.5, s[42:43]
    s_cmp_eq_u32 s56, 0
    s_cselect_b64 s[42:43], -1, 0
    v_cndmask_b32 v75, v72, v73, s[42:43]
    v_cndmask_b32 v76, v73, v72, s[42:43]
    v_lshlrev_b32 v4, 6, v4
    v_and_b32 v5, 2, v2
    v_add_u32 v4, v4, v5
    v_cvt_f32_u32 v73, v4
    s_lshl_b32 s61, s55, 5
    s_add_u32 s61, s61, s56
    v_lshl_add_u32 v4, v3, 1, s61
    v_cvt_f32_u32 v72, v4
    v_mul_f32 v72, 0x3b124925, v72
    v_mul_f32 v73, v72, v73
    s_lshl_b32 s61, s56, 13
    v_add_u32 v5, s61, v51
    v_fmamk_f32 v78, v72, 0x0, v73
    v_fmamk_f32 v79, v72, 0x41800000, v73
    v_fmamk_f32 v80, v72, 0x42000000, v73
    v_fmamk_f32 v81, v72, 0x42400000, v73
    v_fmamk_f32 v82, v72, 0x40800000, v73
    v_fmamk_f32 v83, v72, 0x41a00000, v73
    v_fmamk_f32 v84, v72, 0x42100000, v73
    v_fmamk_f32 v85, v72, 0x42500000, v73
    v_sin_f32 v86, v78
    v_cos_f32 v78, v78
    v_sin_f32 v87, v79
    v_cos_f32 v79, v79
    v_sin_f32 v88, v80
    v_cos_f32 v80, v80
    v_sin_f32 v89, v81
    v_cos_f32 v81, v81
    v_sin_f32 v90, v82
    v_cos_f32 v82, v82
    v_sin_f32 v91, v83
    v_cos_f32 v83, v83
    v_sin_f32 v92, v84
    v_cos_f32 v84, v84
    v_sin_f32 v93, v85
    s_waitcnt vmcnt(0)
    s_barrier
    s_cmp_lg_u32 s3, 0
    s_cbranch_scc1 S_nf
    v_mov_b32 v68, s12
    v_mov_b32 v69, s13
    s_lshl_b32 s40, s8, 7
    s_add_u32 s40, s40, 32768
    s_mov_b64 exec, 1
    buffer_store_dwordx2 v[68:69], v12, s[36:39], s40 offen sc1
    s_mov_b64 exec, -1
    v_lshlrev_b32 v70, 2, v3
    v_add_u32 v70, 81920, v70
    ds_write_b32 v70, v12
        S_nf:

    v_cos_f32 v85, v85
    v_mul_f32 v78, v78, v74
    v_mul_f32 v81, v81, v75
    v_cvt_pk_bf16_f32 v60, v78, v79
    v_cvt_pk_bf16_f32 v61, v80, v81
    v_cvt_pk_bf16_f32 v62, v82, v83
    v_cvt_pk_bf16_f32 v63, v84, v85
    v_and_b32 v63, v77, v63
    ds_write_b128 v5, v[60:63] offset:0
    v_mul_f32 v89, v89, v76
    v_cvt_pk_bf16_f32 v64, v86, v87
    v_cvt_pk_bf16_f32 v65, v88, v89
    v_cvt_pk_bf16_f32 v66, v90, v91
    v_cvt_pk_bf16_f32 v67, v92, v93
    v_and_b32 v67, v77, v67
    ds_write_b128 v5, v[64:67] offset:4096
    v_fmamk_f32 v78, v72, 0x41000000, v73
    v_fmamk_f32 v79, v72, 0x41c00000, v73
    v_fmamk_f32 v80, v72, 0x42200000, v73
    v_fmamk_f32 v81, v72, 0x42600000, v73
    v_fmamk_f32 v82, v72, 0x41400000, v73
    v_fmamk_f32 v83, v72, 0x41e00000, v73
    v_fmamk_f32 v84, v72, 0x42300000, v73
    v_fmamk_f32 v85, v72, 0x42700000, v73
    v_sin_f32 v86, v78
    v_cos_f32 v78, v78
    v_sin_f32 v87, v79
    v_cos_f32 v79, v79
    v_sin_f32 v88, v80
    v_cos_f32 v80, v80
    v_sin_f32 v89, v81
    v_cos_f32 v81, v81
    v_sin_f32 v90, v82
    v_cos_f32 v82, v82
    v_sin_f32 v91, v83
    v_cos_f32 v83, v83
    v_sin_f32 v92, v84
    v_cos_f32 v84, v84
    v_sin_f32 v93, v85
    v_cos_f32 v85, v85
    v_cvt_pk_bf16_f32 v60, v78, v79
    v_cvt_pk_bf16_f32 v61, v80, v81
    v_cvt_pk_bf16_f32 v62, v82, v83
    v_cvt_pk_bf16_f32 v63, v84, v85
    v_and_b32 v61, v77, v61
    v_and_b32 v63, v77, v63
    ds_write_b128 v5, v[60:63] offset:1024
    v_cvt_pk_bf16_f32 v64, v86, v87
    v_cvt_pk_bf16_f32 v65, v88, v89
    v_cvt_pk_bf16_f32 v66, v90, v91
    v_cvt_pk_bf16_f32 v67, v92, v93
    v_and_b32 v65, v77, v65
    v_and_b32 v67, v77, v67
    ds_write_b128 v5, v[64:67] offset:5120
    v_fmamk_f32 v78, v72, 0x3f800000, v73
    v_fmamk_f32 v79, v72, 0x41880000, v73
    v_fmamk_f32 v80, v72, 0x42040000, v73
    v_fmamk_f32 v81, v72, 0x42440000, v73
    v_fmamk_f32 v82, v72, 0x40a00000, v73
    v_fmamk_f32 v83, v72, 0x41a80000, v73
    v_fmamk_f32 v84, v72, 0x42140000, v73
    v_fmamk_f32 v85, v72, 0x42540000, v73
    v_sin_f32 v86, v78
    v_cos_f32 v78, v78
    v_sin_f32 v87, v79
    v_cos_f32 v79, v79
    v_sin_f32 v88, v80
    v_cos_f32 v80, v80
    v_sin_f32 v89, v81
    v_cos_f32 v81, v81
    v_sin_f32 v90, v82
    v_cos_f32 v82, v82
    v_sin_f32 v91, v83
    v_cos_f32 v83, v83
    v_sin_f32 v92, v84
    v_cos_f32 v84, v84
    v_sin_f32 v93, v85
    v_cos_f32 v85, v85
    v_cvt_pk_bf16_f32 v60, v78, v79
    v_cvt_pk_bf16_f32 v61, v80, v81
    v_cvt_pk_bf16_f32 v62, v82, v83
    v_cvt_pk_bf16_f32 v63, v84, v85
    v_and_b32 v61, v77, v61
    v_and_b32 v63, v77, v63
    ds_write_b128 v5, v[60:63] offset:2048
    v_cvt_pk_bf16_f32 v64, v86, v87
    v_cvt_pk_bf16_f32 v65, v88, v89
    v_cvt_pk_bf16_f32 v66, v90, v91
    v_cvt_pk_bf16_f32 v67, v92, v93
    v_and_b32 v65, v77, v65
    v_and_b32 v67, v77, v67
    ds_write_b128 v5, v[64:67] offset:6144
    v_fmamk_f32 v78, v72, 0x41100000, v73
    v_fmamk_f32 v79, v72, 0x41c80000, v73
    v_fmamk_f32 v80, v72, 0x42240000, v73
    v_fmamk_f32 v81, v72, 0x42640000, v73
    v_fmamk_f32 v82, v72, 0x41500000, v73
    v_fmamk_f32 v83, v72, 0x41e80000, v73
    v_fmamk_f32 v84, v72, 0x42340000, v73
    v_fmamk_f32 v85, v72, 0x42740000, v73
    v_sin_f32 v86, v78
    v_cos_f32 v78, v78
    v_sin_f32 v87, v79
    v_cos_f32 v79, v79
    v_sin_f32 v88, v80
    v_cos_f32 v80, v80
    v_sin_f32 v89, v81
    v_cos_f32 v81, v81
    v_sin_f32 v90, v82
    v_cos_f32 v82, v82
    v_sin_f32 v91, v83
    v_cos_f32 v83, v83
    v_sin_f32 v92, v84
    v_cos_f32 v84, v84
    v_sin_f32 v93, v85
    v_cos_f32 v85, v85
    v_cvt_pk_bf16_f32 v60, v78, v79
    v_cvt_pk_bf16_f32 v61, v80, v81
    v_cvt_pk_bf16_f32 v62, v82, v83
    v_cvt_pk_bf16_f32 v63, v84, v85
    v_and_b32 v61, v77, v61
    v_and_b32 v63, v77, v63
    ds_write_b128 v5, v[60:63] offset:3072
    v_cvt_pk_bf16_f32 v64, v86, v87
    v_cvt_pk_bf16_f32 v65, v88, v89
    v_cvt_pk_bf16_f32 v66, v90, v91
    v_cvt_pk_bf16_f32 v67, v92, v93
    v_and_b32 v65, v77, v65
    v_and_b32 v67, v77, v67
    ds_write_b128 v5, v[64:67] offset:7168
    s_cmp_lg_u32 s3, 1
    s_cbranch_scc1 P_dB
    v_and_b32 v4, 31, v1
    v_lshlrev_b32 v4, 7, v4
    s_mov_b32 s40, 32768

    s_mov_b32 s9, 0
    buffer_load_dwordx2 v[70:71], v4, s[36:39], s40 offen sc1
        P_lB:
    s_waitcnt vmcnt(0)
    v_cmp_ne_u64 vcc, s[12:13], v[70:71]
    s_nop 0
    s_cbranch_vccz P_dB
    buffer_load_dwordx2 v[70:71], v4, s[36:39], s40 offen sc1
    s_add_u32 s9, s9, 1
    s_cmp_lt_u32 s9, 200000
    s_cbranch_scc1 P_lB
    s_waitcnt vmcnt(0)
        P_dB:

    s_lshl_b32 s40, s3, 12
    s_add_u32 m0, s40, 0
    s_waitcnt lgkmcnt(0)
    s_barrier
    buffer_load_dwordx4 v44, s[36:39], s60 offen offset:0 sc1 lds
    buffer_load_dwordx4 v45, s[36:39], s60 offen offset:1024 sc1 lds
    buffer_load_dwordx4 v44, s[36:39], s60 offen offset:2048 sc1 lds
    buffer_load_dwordx4 v45, s[36:39], s60 offen offset:3072 sc1 lds
    ds_read_b128 v[94:97], v51 offset:0
    ds_read_b128 v[98:101], v51 offset:1024
    ds_read_b128 v[102:105], v51 offset:2048
    ds_read_b128 v[106:109], v51 offset:3072
    ds_read_b128 v[110:113], v51 offset:4096
    ds_read_b128 v[114:117], v51 offset:5120
    ds_read_b128 v[118:121], v51 offset:6144
    ds_read_b128 v[122:125], v51 offset:7168
    ds_read_b128 v[126:129], v51 offset:8192
    ds_read_b128 v[130:133], v51 offset:9216
    ds_read_b128 v[134:137], v51 offset:10240
    ds_read_b128 v[138:141], v51 offset:11264
    ds_read_b128 v[142:145], v51 offset:12288
    ds_read_b128 v[146:149], v51 offset:13312
    ds_read_b128 v[150:153], v51 offset:14336
    ds_read_b128 v[154:157], v51 offset:15360
    v_xor_b32 v222, 32, v46
    v_xor_b32 v223, 64, v46
    v_xor_b32 v224, 96, v46
    s_lshl_b32 s40, s55, 13
    s_lshl_b32 s41, s57, 11
    s_add_u32 s40, s40, s41
    v_add_u32 v225, s40, v47
    s_waitcnt vmcnt(0) lgkmcnt(0)
    s_barrier

    s_cmp_lg_u32 s56, 0
    s_cbranch_scc1 S_np
    s_setprio 1
S_np:
    ds_read_b64_tr_b16 v[158:159], v46 offset:0
    ds_read_b64_tr_b16 v[160:161], v46 offset:512
    ds_read_b64_tr_b16 v[162:163], v46 offset:4096
    ds_read_b64_tr_b16 v[164:165], v46 offset:4608
    ds_read_b64_tr_b16 v[166:167], v222 offset:0
    ds_read_b64_tr_b16 v[168:169], v222 offset:512
    ds_read_b64_tr_b16 v[170:171], v222 offset:4096
    ds_read_b64_tr_b16 v[172:173], v222 offset:4608
    ds_read_b64_tr_b16 v[174:175], v223 offset:0
    ds_read_b64_tr_b16 v[176:177], v223 offset:512
    ds_read_b64_tr_b16 v[178:179], v223 offset:4096
    ds_read_b64_tr_b16 v[180:181], v223 offset:4608
    ds_read_b64_tr_b16 v[182:183], v224 offset:0
    ds_read_b64_tr_b16 v[184:185], v224 offset:512
    ds_read_b64_tr_b16 v[186:187], v224 offset:4096
    ds_read_b64_tr_b16 v[188:189], v224 offset:4608
    s_waitcnt lgkmcnt(14)
    v_mfma_f32_16x16x32_bf16 v[190:193], v[158:161], v[28:31], 0
    s_waitcnt lgkmcnt(12)
    v_mfma_f32_16x16x32_bf16 v[190:193], v[162:165], v[32:35], v[190:193]
    v_mfma_f32_16x16x32_bf16 v[206:209], v[158:161], v[36:39], 0
    v_mfma_f32_16x16x32_bf16 v[206:209], v[162:165], v[40:43], v[206:209]
    s_waitcnt lgkmcnt(10)
    v_mfma_f32_16x16x32_bf16 v[194:197], v[166:169], v[28:31], 0
    s_waitcnt lgkmcnt(8)
    v_mfma_f32_16x16x32_bf16 v[194:197], v[170:173], v[32:35], v[194:197]
    v_mfma_f32_16x16x32_bf16 v[210:213], v[166:169], v[36:39], 0
    v_mfma_f32_16x16x32_bf16 v[210:213], v[170:173], v[40:43], v[210:213]
    s_waitcnt lgkmcnt(6)
    v_mfma_f32_16x16x32_bf16 v[198:201], v[174:177], v[28:31], 0
    s_waitcnt lgkmcnt(4)
    v_mfma_f32_16x16x32_bf16 v[198:201], v[178:181], v[32:35], v[198:201]
    v_cvt_pk_bf16_f32 v226, v190, v191
    v_cvt_pk_bf16_f32 v227, v192, v193
    v_cvt_pk_bf16_f32 v228, v194, v195
    v_cvt_pk_bf16_f32 v229, v196, v197
    ds_write_b128 v225, v[226:229] offset:32768
    v_mfma_f32_16x16x32_bf16 v[214:217], v[174:177], v[36:39], 0
    v_mfma_f32_16x16x32_bf16 v[214:217], v[178:181], v[40:43], v[214:217]
    v_cvt_pk_bf16_f32 v230, v206, v207
    v_cvt_pk_bf16_f32 v231, v208, v209
    v_cvt_pk_bf16_f32 v232, v210, v211
    v_cvt_pk_bf16_f32 v233, v212, v213
    ds_write_b128 v225, v[230:233] offset:36864
    s_waitcnt lgkmcnt(4)
    v_mfma_f32_16x16x32_bf16 v[202:205], v[182:185], v[28:31], 0
    s_waitcnt lgkmcnt(2)
    v_mfma_f32_16x16x32_bf16 v[202:205], v[186:189], v[32:35], v[202:205]
    v_mfma_f32_16x16x32_bf16 v[218:221], v[182:185], v[36:39], 0
    v_mfma_f32_16x16x32_bf16 v[218:221], v[186:189], v[40:43], v[218:221]
    s_add_u32 s40, s8, s57
    s_cmp_eq_u32 s40, 0
    s_cbranch_scc1 S_x0
S_x1:
    v_cvt_pk_bf16_f32 v158, v198, v199
    v_cvt_pk_bf16_f32 v159, v200, v201
    s_nop 0
    v_cvt_pk_bf16_f32 v160, v202, v203
    v_cvt_pk_bf16_f32 v161, v204, v205
    ds_write_b128 v225, v[158:161] offset:33792
    v_cvt_pk_bf16_f32 v162, v214, v215
    v_cvt_pk_bf16_f32 v163, v216, v217
    v_cvt_pk_bf16_f32 v164, v218, v219
    v_cvt_pk_bf16_f32 v165, v220, v221
    ds_write_b128 v225, v[162:165] offset:37888
    s_mov_b64 exec, 1
    ds_add_u32 v52, v59 offset:8
    s_mov_b64 exec, -1
    s_mov_b32 s9, 0
        W_lU:
    ds_read_b32 v4, v52 offset:8
    s_add_u32 s9, s9, 1
    s_cmp_gt_u32 s9, 1600000
    s_cbranch_scc1 W_dU
    s_waitcnt lgkmcnt(0)
    v_cmp_gt_u32 vcc, 4, v4
    s_nop 0
    s_cbranch_vccnz W_lU
        W_dU:

    ds_read_b128 v[158:161], v53 offset:32768
    ds_read_b128 v[162:165], v53 offset:33792
    ds_read_b128 v[166:169], v53 offset:40960
    ds_read_b128 v[170:173], v53 offset:41984
    ds_read_b128 v[174:177], v53 offset:49152
    ds_read_b128 v[178:181], v53 offset:50176
    ds_read_b128 v[182:185], v53 offset:57344
    s_waitcnt lgkmcnt(6)
    v_mfma_f32_16x16x32_bf16 v[190:193], v[94:97], v[158:161], 0
    ds_read_b128 v[186:189], v53 offset:58368
    s_waitcnt lgkmcnt(6)
    v_mfma_f32_16x16x32_bf16 v[190:193], v[98:101], v[162:165], v[190:193]
    ds_read_b128 v[158:161], v53 offset:53248
    s_waitcnt lgkmcnt(6)
    v_mfma_f32_16x16x32_bf16 v[194:197], v[102:105], v[166:169], 0
    ds_read_b128 v[162:165], v53 offset:54272
    s_waitcnt lgkmcnt(6)
    v_mfma_f32_16x16x32_bf16 v[194:197], v[106:109], v[170:173], v[194:197]
    ds_read_b128 v[166:169], v53 offset:61440
    s_waitcnt lgkmcnt(6)
    v_mfma_f32_16x16x32_bf16 v[206:209], v[126:129], v[174:177], 0
    ds_read_b128 v[170:173], v53 offset:62464
    s_waitcnt lgkmcnt(6)
    v_mfma_f32_16x16x32_bf16 v[206:209], v[130:133], v[178:181], v[206:209]
    ds_read_b128 v[174:177], v53 offset:36864
    s_waitcnt lgkmcnt(6)
    v_mfma_f32_16x16x32_bf16 v[210:213], v[134:137], v[182:185], 0
    ds_read_b128 v[178:181], v53 offset:37888
    s_waitcnt lgkmcnt(6)
    v_mfma_f32_16x16x32_bf16 v[210:213], v[138:141], v[186:189], v[210:213]
    ds_read_b128 v[182:185], v53 offset:45056
    s_waitcnt lgkmcnt(6)
    v_mfma_f32_16x16x32_bf16 v[198:201], v[110:113], v[158:161], 0
    ds_read_b128 v[186:189], v53 offset:46080
    s_waitcnt lgkmcnt(6)
    v_mfma_f32_16x16x32_bf16 v[198:201], v[114:117], v[162:165], v[198:201]
    s_waitcnt lgkmcnt(5)
    v_mfma_f32_16x16x32_bf16 v[202:205], v[118:121], v[166:169], 0
    v_pk_add_f32 v[78:79], v[190:191], v[194:195]
    v_pk_add_f32 v[80:81], v[192:193], v[196:197]
    s_waitcnt lgkmcnt(4)
    v_mfma_f32_16x16x32_bf16 v[202:205], v[122:125], v[170:173], v[202:205]
    v_pk_add_f32 v[194:195], v[190:191], v[194:195] neg_lo:[0,1] neg_hi:[0,1]
    v_pk_add_f32 v[196:197], v[192:193], v[196:197] neg_lo:[0,1] neg_hi:[0,1]
    s_waitcnt lgkmcnt(3)
    v_mfma_f32_16x16x32_bf16 v[214:217], v[142:145], v[174:177], 0
    v_pk_add_f32 v[82:83], v[206:207], v[210:211]
    s_waitcnt lgkmcnt(2)
    v_mfma_f32_16x16x32_bf16 v[214:217], v[146:149], v[178:181], v[214:217]
    v_pk_add_f32 v[84:85], v[208:209], v[212:213]
    s_waitcnt lgkmcnt(1)
    v_mfma_f32_16x16x32_bf16 v[218:221], v[150:153], v[182:185], 0
    v_pk_add_f32 v[210:211], v[206:207], v[210:211] neg_lo:[0,1] neg_hi:[0,1]
    s_waitcnt lgkmcnt(0)
    v_mfma_f32_16x16x32_bf16 v[218:221], v[154:157], v[186:189], v[218:221]
    v_pk_add_f32 v[212:213], v[208:209], v[212:213] neg_lo:[0,1] neg_hi:[0,1]
    s_add_u32 s40, s8, s56
    s_cmp_eq_u32 s40, 0
    s_cbranch_scc1 S_y0
S_y1:
    v_pk_add_f32 v[190:191], v[198:199], v[202:203]
    v_pk_add_f32 v[192:193], v[200:201], v[204:205]
    v_pk_add_f32 v[202:203], v[198:199], v[202:203] neg_lo:[0,1] neg_hi:[0,1]
    v_pk_add_f32 v[204:205], v[200:201], v[204:205] neg_lo:[0,1] neg_hi:[0,1]
    v_pk_add_f32 v[206:207], v[214:215], v[218:219]
    v_pk_add_f32 v[208:209], v[216:217], v[220:221]
    v_pk_add_f32 v[218:219], v[214:215], v[218:219] neg_lo:[0,1] neg_hi:[0,1]
    v_pk_add_f32 v[220:221], v[216:217], v[220:221] neg_lo:[0,1] neg_hi:[0,1]
    v_pk_add_f32 v[198:199], v[78:79], v[190:191]
    v_pk_add_f32 v[200:201], v[80:81], v[192:193]
    v_pk_add_f32 v[214:215], v[82:83], v[206:207]
    v_pk_add_f32 v[216:217], v[84:85], v[208:209]
    v_cvt_pk_bf16_f32 v158, v198, v214
    v_cvt_pk_bf16_f32 v159, v199, v215
    v_cvt_pk_bf16_f32 v160, v200, v216
    v_cvt_pk_bf16_f32 v161, v201, v217
    ds_write_b128 v48, v[158:161] offset:0
    v_pk_add_f32 v[198:199], v[78:79], v[190:191] neg_lo:[0,1] neg_hi:[0,1]
    v_pk_add_f32 v[200:201], v[80:81], v[192:193] neg_lo:[0,1] neg_hi:[0,1]
    v_pk_add_f32 v[214:215], v[82:83], v[206:207] neg_lo:[0,1] neg_hi:[0,1]
    v_pk_add_f32 v[216:217], v[84:85], v[208:209] neg_lo:[0,1] neg_hi:[0,1]
    v_cvt_pk_bf16_f32 v162, v198, v214
    v_cvt_pk_bf16_f32 v163, v199, v215
    v_cvt_pk_bf16_f32 v164, v200, v216
    v_cvt_pk_bf16_f32 v165, v201, v217
    ds_write_b128 v48, v[162:165] offset:16896
    v_pk_add_f32 v[198:199], v[194:195], v[202:203]
    v_pk_add_f32 v[200:201], v[196:197], v[204:205]
    v_pk_add_f32 v[214:215], v[210:211], v[218:219]
    v_pk_add_f32 v[216:217], v[212:213], v[220:221]
    v_cvt_pk_bf16_f32 v166, v198, v214
    v_cvt_pk_bf16_f32 v167, v199, v215
    v_cvt_pk_bf16_f32 v168, v200, v216
    v_cvt_pk_bf16_f32 v169, v201, v217
    ds_write_b128 v48, v[166:169] offset:256
    v_pk_add_f32 v[198:199], v[194:195], v[202:203] neg_lo:[0,1] neg_hi:[0,1]
    v_pk_add_f32 v[200:201], v[196:197], v[204:205] neg_lo:[0,1] neg_hi:[0,1]
    v_pk_add_f32 v[214:215], v[210:211], v[218:219] neg_lo:[0,1] neg_hi:[0,1]
    v_pk_add_f32 v[216:217], v[212:213], v[220:221] neg_lo:[0,1] neg_hi:[0,1]
    v_cvt_pk_bf16_f32 v170, v198, v214
    v_cvt_pk_bf16_f32 v171, v199, v215
    v_cvt_pk_bf16_f32 v172, v200, v216
    v_cvt_pk_bf16_f32 v173, v201, v217
    ds_write_b128 v48, v[170:173] offset:17152
    s_mov_b64 exec, 1
    ds_add_u32 v52, v59
    s_mov_b64 exec, -1

    s_mov_b32 s9, 0
        W_lO:
    ds_read_b32 v4, v52 offset:0
    s_add_u32 s9, s9, 1
    s_cmp_gt_u32 s9, 1600000
    s_cbranch_scc1 W_dO
    s_waitcnt lgkmcnt(0)
    v_cmp_gt_u32 vcc, 4, v4
    s_nop 0
    s_cbranch_vccnz W_lO
        W_dO:

    v_and_b32 v4, 4, v1
    v_lshl_add_u32 v5, v4, 6, v50
    ds_read_b128 v[94:97], v49 offset:0
    ds_read_b128 v[98:101], v49 offset:128
    ds_read_b128 v[102:105], v49 offset:320
    ds_read_b128 v[106:109], v54 offset:256
    ds_read_b128 v[110:113], v55 offset:432
    ds_read_b32 v114, v55 offset:448
    ds_read_b128 v[118:121], v55 offset:112
    ds_read_b32 v122, v55 offset:128
    ds_read_b128 v[126:129], v56 offset:304
    ds_read_b32 v130, v56 offset:320
    s_waitcnt lgkmcnt(9)
    buffer_store_dwordx4 v[94:97], v50, s[32:35], 0 offen offset:896
    s_waitcnt lgkmcnt(8)
    buffer_store_dwordx4 v[98:101], v50, s[32:35], 0 offen offset:1024
    s_waitcnt lgkmcnt(7)
    buffer_store_dwordx4 v[102:105], v50, s[32:35], 0 offen offset:1408
    s_waitcnt lgkmcnt(6)
    buffer_store_dwordx4 v[106:109], v57, s[32:35], 0 offen offset:1344
    s_waitcnt lgkmcnt(4)
    v_bfi_b32 v134, v58, v114, v113
    v_bfi_b32 v135, v58, v113, v112
    v_bfi_b32 v136, v58, v112, v111
    v_bfi_b32 v137, v58, v111, v110
    buffer_store_dwordx4 v[134:137], v50, s[32:35], 0 offen offset:1152
    s_waitcnt lgkmcnt(2)
    v_bfi_b32 v138, v58, v122, v121
    v_bfi_b32 v139, v58, v121, v120
    v_bfi_b32 v140, v58, v120, v119
    v_bfi_b32 v141, v58, v119, v118
    buffer_store_dwordx4 v[138:141], v50, s[32:35], 0 offen offset:1664
    s_waitcnt lgkmcnt(0)
    v_bfi_b32 v142, v58, v130, v129
    v_bfi_b32 v143, v58, v129, v128
    v_bfi_b32 v144, v58, v128, v127
    v_bfi_b32 v145, v58, v127, v126
    buffer_store_dwordx4 v[142:145], v5, s[32:35], 0 offen offset:1280
    s_add_u32 s40, s8, s3
    s_cmp_lg_u32 s40, 0
    s_cbranch_scc1 S_end
    s_add_u32 s40, s10, 16
    v_mov_b32 v4, s40
    s_mov_b32 s40, 4096
    s_mov_b64 exec, 1
    buffer_store_dword v4, v12, s[36:39], s40 offen
        S_end:

    s_endpgm
K_c:
    s_lshl_b32 s40, s8, 7
    s_waitcnt lgkmcnt(0)
    s_load_dwordx2 s[10:11], s[36:37], s40
    s_add_u32 s14, s40, 8192
    s_getreg_b32 s52, hwreg(HW_REG_XCC_ID, 0, 3)
    s_mov_b32 s26, 401408
    s_mov_b32 s27, 0x00020000
    s_mov_b32 s34, 3670016
    s_mov_b32 s35, 0x00020000
    s_sub_u32 s62, s3, 4
    s_lshr_b32 s16, s62, 1
    s_and_b32 s17, s62, 1
    s_lshl_b32 s29, s62, 11
    v_and_b32 v1, 63, v0
    v_lshlrev_b32 v4, 4, v1
    s_mul_i32 s1, s2, 1792
    v_min_u32 v41, 13, v1
    v_lshlrev_b32 v41, 7, v41
    v_lshrrev_b32 v24, 4, v1
    v_and_b32 v25, 15, v1
    v_lshrrev_b32 v26, 3, v1
    v_and_b32 v27, 7, v1
    v_mov_b32 v5, 161792
    v_mov_b32 v6, 0
    v_lshl_add_u32 v2, v25, 2, v5
    ds_write_b32 v2, v6
    v_lshrrev_b32 v3, 1, v25
    v_xor_b32 v3, v3, v24
    v_lshlrev_b32 v3, 4, v3
    v_lshl_add_u32 v3, v25, 7, v3
    s_lshr_b32 s18, s62, 1
    s_lshl_b32 s18, s18, 12
    v_add_u32 v28, s18, v3
    v_xor_b32 v29, 64, v28
    v_add_u32 v30, 40960, v28
    v_add_u32 v31, 40960, v29
    v_lshrrev_b32 v3, 2, v25
    v_lshl_add_u32 v3, v24, 3, v3
    v_lshlrev_b32 v3, 7, v3
    v_and_b32 v7, 3, v1
    v_lshl_add_u32 v3, v7, 3, v3
    v_bfe_u32 v7, v1, 3, 2
    s_and_b32 s18, s62, 1
    s_lshl_b32 s18, s18, 1
    v_xor_b32 v7, s18, v7
    v_lshl_add_u32 v3, v7, 5, v3
    v_add_u32 v32, 71680, v3
    v_xor_b32 v33, 32, v32
    v_add_u32 v34, 49152, v32
    v_add_u32 v35, 49152, v33
    s_and_b32 s18, s62, 1
    s_lshl_b32 s19, s7, 1
    s_add_u32 s18, s18, s19
    s_cmp_ge_u32 s18, 7
    s_cselect_b32 s19, 14, 7
    s_sub_u32 s18, s19, s18
    v_cmp_gt_u32 s[54:55], s18, v24
    v_add_u32 v2, 4, v24
    v_cmp_gt_u32 s[56:57], s18, v2
    s_bitcmp0_b32 s62, 0
    s_cselect_b64 vcc, -1, 0
    s_xor_b64 s[54:55], s[54:55], vcc
    s_xor_b64 s[56:57], s[56:57], vcc
    v_lshrrev_b32 v3, 2, v25
    s_and_b32 s18, s62, 1
    s_lshl_b32 s19, s7, 1
    s_add_u32 s18, s18, s19
    s_cmp_ge_u32 s18, 7
    s_cselect_b32 s19, 14, 7
    s_sub_u32 s18, s19, s18
    v_cmp_gt_u32 s[58:59], s18, v3
    v_add_u32 v2, 4, v3
    v_cmp_gt_u32 s[60:61], s18, v2
    s_bitcmp0_b32 s62, 0
    s_cselect_b64 vcc, -1, 0
    s_xor_b64 s[58:59], s[58:59], vcc
    s_xor_b64 s[60:61], s[60:61], vcc
    s_and_b32 s18, s62, 1
    s_lshl_b32 s19, s7, 1
    s_add_u32 s18, s18, s19
    s_lshl_b32 s100, s18, 10
    s_lshl_b32 s18, s8, 2
    s_and_b32 s19, s62, 2
    s_add_u32 s18, s18, s19
    s_mul_i32 s19, s18, 14336
    s_add_u32 s100, s100, s19
    s_add_u32 s100, s100, 2097152
    s_lshl_b32 s20, s18, 6
    s_add_u32 s20, s20, 16384
    s_lshl_b32 s18, s17, 11
    s_sub_u32 s18, s18, 1024
    s_add_u32 s15, s100, s18
    s_lshl_b32 s19, s7, 1
    s_add_u32 s18, s17, s19
    s_lshl_b32 s18, s18, 3
    s_add_u32 s21, s20, s18
    v_and_b32 v2, 1, v25
    v_cmp_eq_u32 s[44:45], 1, v2
    v_lshl_add_u32 v2, v24, 2, v2
    v_cmp_le_u32 s[46:47], v2, v25
    v_add_u32 v2, 2, v2
    v_cmp_le_u32 s[48:49], v2, v25
    v_mov_b32 v2, 0xffff
    v_mov_b32 v3, 0xffff0000
    v_cndmask_b32 v2, v2, v3, s[44:45]
    v_cndmask_b32 v36, v2, 0, s[46:47]
    v_cndmask_b32 v37, v2, 0, s[48:49]
    v_cndmask_b32 v38, 0, v2, s[46:47]
    v_cndmask_b32 v39, 0, v2, s[48:49]
    s_add_u32 s18, s8, s16
    s_cmp_eq_u32 s18, 0
    s_cselect_b64 s[50:51], -1, 0
    s_mul_i32 s18, s17, 6
    s_cmp_eq_u32 s18, s7
    s_cselect_b32 s101, 1, 0
    s_cmp_eq_u32 s7, 3
    s_cselect_b32 s18, 0, 1.0
    v_mov_b32 v44, s18
    v_mov_b32 v45, 0xf149f2ca
    v_mov_b32 v46, 0xffffff00
    s_mov_b32 s0, 0x3e8b97f6
    s_add_u32 s18, s29, 129024
    v_add_u32 v42, s18, v4
    v_add_u32 v43, s29, v4
    v_lshl_add_u32 v47, s62, 2, v5
    v_lshl_add_u32 v218, s17, 10, v4
    v_add_u32 v219, 2048, v218
    v_lshl_add_u32 v220, s17, 2, v5
    v_lshl_add_u32 v221, s17, 3, v5
    s_lshl_b32 s18, s7, 7
    v_min_u32 v8, 13, v1
    v_lshlrev_b32 v8, 3, v8
    v_lshrrev_b32 v2, 2, v1
    v_bfe_u32 v3, v1, 3, 2
    v_lshlrev_b32 v3, 5, v3
    v_lshl_add_u32 v2, v2, 7, v3
    v_and_b32 v3, 3, v1
    v_lshl_add_u32 v2, v3, 3, v2
    v_add_u32 v16, 71680, v2
    v_xor_b32 v17, 32, v16
    v_xor_b32 v18, 64, v16
    v_xor_b32 v19, 96, v16
    s_add_u32 s19, s29, 129024
    v_lshrrev_b32 v2, 1, v24
    v_xor_b32 v2, v2, v27
    v_lshlrev_b32 v2, 4, v2
    v_lshl_add_u32 v2, v25, 7, v2
    v_and_b32 v3, 1, v24
    v_lshl_add_u32 v2, v3, 3, v2
    v_add_u32 v20, s19, v2
    v_xor_b32 v21, 32, v20
    v_xor_b32 v22, 64, v20
    v_xor_b32 v23, 96, v20
    v_mul_u32_u24 v10, 1792, v26
    v_lshl_add_u32 v10, v27, 4, v10
    v_xor_b32 v3, v27, v26
    v_lshlrev_b32 v3, 4, v3
    v_lshl_add_u32 v2, v26, 7, v3
    v_add_u32 v9, s19, v2
    s_lshl_b32 s19, s8, 2
    s_add_u32 s19, s19, s62
    s_mul_i32 s22, s19, 14336
    s_add_u32 s22, s22, 2097152
    s_mul_i32 s23, s19, 28672
    s_add_u32 s23, s23, s18
    s_add_u32 s28, s23, 14336
    s_waitcnt lgkmcnt(0)
    s_add_u32 s12, s10, 0x5a3c9671
    s_xor_b32 s13, s11, 0x2b7e1516
    s_add_u32 s52, s52, s12
    s_mov_b32 s53, s13
    v_mov_b32 v14, s12
    v_mov_b32 v15, s13
    s_bfe_u32 s40, s12, 0x80000
    v_mov_b32 v50, s40
    s_bfe_u32 s40, s12, 0x80008
    v_mov_b32 v51, s40
    s_bfe_u32 s40, s12, 0x80010
    v_mov_b32 v52, s40
    s_bfe_u32 s40, s12, 0x80018
    v_mov_b32 v53, s40
    s_setprio 3
    s_cmp_lg_u32 s62, 0
    s_cbranch_scc1 C_nox
    v_mov_b32 v12, s52
    v_mov_b32 v13, s53
    s_lshl_b32 s41, s7, 3
    s_add_u32 s40, s14, s41
    s_mov_b64 exec, 1
    buffer_store_dwordx2 v[12:13], v6, s[36:39], s40 offen sc1
    s_mov_b64 exec, -1

C_nox:
    s_cmp_lg_u32 s62, 0
    s_cbranch_scc1 C_nwo
    buffer_load_dword v7, v41, s[24:27], s1 offen
C_nwo:

    s_cmp_lg_u32 s16, 0
    s_cbranch_scc1 C_tp1
    s_barrier
    ds_read_b128 v[130:133], v28 offset:2048
    ds_read_b64_tr_b16 v[174:175], v32 offset:8192
    ds_read_b64_tr_b16 v[176:177], v32 offset:8704
    ds_read_b128 v[142:145], v29 offset:2048
    ds_read_b64_tr_b16 v[178:179], v32 offset:12288
    ds_read_b64_tr_b16 v[180:181], v32 offset:12800
    ds_read_b128 v[134:137], v28 offset:4096
    ds_read_b128 v[146:149], v29 offset:4096
    ds_read_b64_tr_b16 v[182:183], v33 offset:8192
    ds_read_b64_tr_b16 v[184:185], v33 offset:8704
    ds_read_b64_tr_b16 v[186:187], v33 offset:12288
    ds_read_b64_tr_b16 v[188:189], v33 offset:12800
    s_waitcnt lgkmcnt(9)
    v_mfma_f32_16x16x32_bf16 v[62:65], v[174:177], v[130:133], 0
    ds_read_b128 v[126:129], v28 offset:0
    s_waitcnt lgkmcnt(7)
    v_mfma_f32_16x16x32_bf16 v[62:65], v[178:181], v[142:145], v[62:65]
    ds_read_b64_tr_b16 v[190:191], v32 offset:16384
    ds_read_b64_tr_b16 v[192:193], v32 offset:16896
    s_waitcnt lgkmcnt(8)
    v_mfma_f32_16x16x32_bf16 v[70:73], v[174:177], v[134:137], 0
    ds_read_b128 v[138:141], v29 offset:0
    ds_read_b64_tr_b16 v[194:195], v32 offset:20480
    s_waitcnt lgkmcnt(9)
    v_mfma_f32_16x16x32_bf16 v[70:73], v[178:181], v[146:149], v[70:73]
    ds_read_b64_tr_b16 v[196:197], v32 offset:20992
    s_waitcnt lgkmcnt(8)
    v_mfma_f32_16x16x32_bf16 v[66:69], v[182:185], v[130:133], 0
    ds_read_b64_tr_b16 v[174:175], v33 offset:16384
    s_waitcnt lgkmcnt(7)
    v_mfma_f32_16x16x32_bf16 v[66:69], v[186:189], v[142:145], v[66:69]
    ds_read_b64_tr_b16 v[176:177], v33 offset:16896
    v_mfma_f32_16x16x32_bf16 v[74:77], v[182:185], v[134:137], 0
    ds_read_b64_tr_b16 v[178:179], v33 offset:20480
    v_mfma_f32_16x16x32_bf16 v[74:77], v[186:189], v[146:149], v[74:77]
    ds_read_b64_tr_b16 v[180:181], v33 offset:20992
    s_waitcnt lgkmcnt(7)
    v_mfma_f32_16x16x32_bf16 v[78:81], v[190:193], v[126:129], 0
    ds_read_b64_tr_b16 v[182:183], v32 offset:24576
    s_waitcnt lgkmcnt(5)
    v_mfma_f32_16x16x32_bf16 v[78:81], v[194:197], v[138:141], v[78:81]
    ds_read_b64_tr_b16 v[184:185], v32 offset:25088
    v_mfma_f32_16x16x32_bf16 v[86:89], v[190:193], v[130:133], 0
    ds_read_b64_tr_b16 v[186:187], v32 offset:28672
    v_mfma_f32_16x16x32_bf16 v[86:89], v[194:197], v[142:145], v[86:89]
    ds_read_b64_tr_b16 v[188:189], v32 offset:29184
    v_mfma_f32_16x16x32_bf16 v[94:97], v[190:193], v[134:137], 0
    ds_read_b64_tr_b16 v[190:191], v33 offset:24576
    v_mfma_f32_16x16x32_bf16 v[94:97], v[194:197], v[146:149], v[94:97]
    ds_read_b64_tr_b16 v[192:193], v33 offset:25088
    s_waitcnt lgkmcnt(8)
    v_mfma_f32_16x16x32_bf16 v[82:85], v[174:177], v[126:129], 0
    ds_read_b64_tr_b16 v[194:195], v33 offset:28672
    s_waitcnt lgkmcnt(7)
    v_mfma_f32_16x16x32_bf16 v[82:85], v[178:181], v[138:141], v[82:85]
    ds_read_b64_tr_b16 v[196:197], v33 offset:29184
    v_mfma_f32_16x16x32_bf16 v[90:93], v[174:177], v[130:133], 0
    v_mfma_f32_16x16x32_bf16 v[90:93], v[178:181], v[142:145], v[90:93]
    v_mfma_f32_16x16x32_bf16 v[98:101], v[174:177], v[134:137], 0
    v_mfma_f32_16x16x32_bf16 v[98:101], v[178:181], v[146:149], v[98:101]
    s_waitcnt lgkmcnt(0)
    s_barrier
    ds_read_b128 v[154:157], v28 offset:12288
    ds_read_b64_tr_b16 v[174:175], v32 offset:32768
    ds_read_b64_tr_b16 v[176:177], v32 offset:33280
    ds_read_b128 v[166:169], v29 offset:12288
    v_mfma_f32_16x16x32_bf16 v[102:105], v[126:129], v[182:185], 0
    ds_read_b64_tr_b16 v[178:179], v32 offset:36864
    v_mfma_f32_16x16x32_bf16 v[102:105], v[138:141], v[186:189], v[102:105]
    ds_read_b64_tr_b16 v[180:181], v32 offset:37376
    v_mfma_f32_16x16x32_bf16 v[110:113], v[130:133], v[182:185], 0
    ds_read_b128 v[158:161], v28 offset:14336
    v_mfma_f32_16x16x32_bf16 v[110:113], v[142:145], v[186:189], v[110:113]
    ds_read_b128 v[170:173], v29 offset:14336
    v_mfma_f32_16x16x32_bf16 v[106:109], v[126:129], v[190:193], 0
    ds_read_b64_tr_b16 v[182:183], v33 offset:32768
    v_mfma_f32_16x16x32_bf16 v[106:109], v[138:141], v[194:197], v[106:109]
    ds_read_b64_tr_b16 v[184:185], v33 offset:33280
    v_mfma_f32_16x16x32_bf16 v[114:117], v[130:133], v[190:193], 0
    ds_read_b64_tr_b16 v[186:187], v33 offset:36864
    ds_read_b64_tr_b16 v[188:189], v33 offset:37376
    v_mfma_f32_16x16x32_bf16 v[114:117], v[142:145], v[194:197], v[114:117]
    ds_read_b128 v[150:153], v28 offset:10240
    s_waitcnt lgkmcnt(10)
    v_mfma_f32_16x16x32_bf16 v[62:65], v[174:177], v[154:157], v[62:65]
    ds_read_b64_tr_b16 v[190:191], v32 offset:40960
    s_waitcnt lgkmcnt(8)
    v_mfma_f32_16x16x32_bf16 v[62:65], v[178:181], v[166:169], v[62:65]
    ds_read_b64_tr_b16 v[192:193], v32 offset:41472
    s_waitcnt lgkmcnt(8)
    v_mfma_f32_16x16x32_bf16 v[70:73], v[174:177], v[158:161], v[70:73]
    ds_read_b128 v[162:165], v29 offset:10240
    ds_read_b64_tr_b16 v[194:195], v32 offset:45056
    s_waitcnt lgkmcnt(9)
    v_mfma_f32_16x16x32_bf16 v[70:73], v[178:181], v[170:173], v[70:73]
    ds_read_b64_tr_b16 v[196:197], v32 offset:45568
    s_waitcnt lgkmcnt(8)
    v_mfma_f32_16x16x32_bf16 v[66:69], v[182:185], v[154:157], v[66:69]
    ds_read_b64_tr_b16 v[174:175], v33 offset:40960
    s_waitcnt lgkmcnt(7)
    v_mfma_f32_16x16x32_bf16 v[66:69], v[186:189], v[166:169], v[66:69]
    ds_read_b64_tr_b16 v[176:177], v33 offset:41472
    v_mfma_f32_16x16x32_bf16 v[74:77], v[182:185], v[158:161], v[74:77]
    ds_read_b64_tr_b16 v[178:179], v33 offset:45056
    v_mfma_f32_16x16x32_bf16 v[74:77], v[186:189], v[170:173], v[74:77]
    ds_read_b64_tr_b16 v[180:181], v33 offset:45568
    s_waitcnt lgkmcnt(7)
    v_mfma_f32_16x16x32_bf16 v[78:81], v[190:193], v[150:153], v[78:81]
    ds_read_b64_tr_b16 v[182:183], v34 offset:0
    s_waitcnt lgkmcnt(5)
    v_mfma_f32_16x16x32_bf16 v[78:81], v[194:197], v[162:165], v[78:81]
    ds_read_b64_tr_b16 v[184:185], v34 offset:512
    v_mfma_f32_16x16x32_bf16 v[86:89], v[190:193], v[154:157], v[86:89]
    ds_read_b64_tr_b16 v[186:187], v34 offset:4096
    v_mfma_f32_16x16x32_bf16 v[86:89], v[194:197], v[166:169], v[86:89]
    ds_read_b64_tr_b16 v[188:189], v34 offset:4608
    v_mfma_f32_16x16x32_bf16 v[94:97], v[190:193], v[158:161], v[94:97]
    ds_read_b64_tr_b16 v[190:191], v35 offset:0
    v_mfma_f32_16x16x32_bf16 v[94:97], v[194:197], v[170:173], v[94:97]
    ds_read_b64_tr_b16 v[192:193], v35 offset:512
    s_waitcnt lgkmcnt(8)
    v_mfma_f32_16x16x32_bf16 v[82:85], v[174:177], v[150:153], v[82:85]
    ds_read_b64_tr_b16 v[194:195], v35 offset:4096
    s_waitcnt lgkmcnt(7)
    v_mfma_f32_16x16x32_bf16 v[82:85], v[178:181], v[162:165], v[82:85]
    ds_read_b64_tr_b16 v[196:197], v35 offset:4608
    v_mfma_f32_16x16x32_bf16 v[90:93], v[174:177], v[154:157], v[90:93]
    v_mfma_f32_16x16x32_bf16 v[90:93], v[178:181], v[166:169], v[90:93]
    v_mfma_f32_16x16x32_bf16 v[98:101], v[174:177], v[158:161], v[98:101]
    v_mfma_f32_16x16x32_bf16 v[98:101], v[178:181], v[170:173], v[98:101]
    s_waitcnt lgkmcnt(0)
    s_barrier
    ds_read_b128 v[130:133], v28 offset:22528
    ds_read_b64_tr_b16 v[174:175], v34 offset:8192
    ds_read_b64_tr_b16 v[176:177], v34 offset:8704
    ds_read_b128 v[142:145], v29 offset:22528
    v_mfma_f32_16x16x32_bf16 v[102:105], v[150:153], v[182:185], v[102:105]
    ds_read_b64_tr_b16 v[178:179], v34 offset:12288
    v_mfma_f32_16x16x32_bf16 v[102:105], v[162:165], v[186:189], v[102:105]
    ds_read_b64_tr_b16 v[180:181], v34 offset:12800
    v_mfma_f32_16x16x32_bf16 v[110:113], v[154:157], v[182:185], v[110:113]
    ds_read_b128 v[134:137], v28 offset:24576
    v_mfma_f32_16x16x32_bf16 v[110:113], v[166:169], v[186:189], v[110:113]
    ds_read_b128 v[146:149], v29 offset:24576
    v_mfma_f32_16x16x32_bf16 v[106:109], v[150:153], v[190:193], v[106:109]
    ds_read_b64_tr_b16 v[182:183], v35 offset:8192
    v_mfma_f32_16x16x32_bf16 v[106:109], v[162:165], v[194:197], v[106:109]
    ds_read_b64_tr_b16 v[184:185], v35 offset:8704
    v_mfma_f32_16x16x32_bf16 v[114:117], v[154:157], v[190:193], v[114:117]
    ds_read_b64_tr_b16 v[186:187], v35 offset:12288
    ds_read_b64_tr_b16 v[188:189], v35 offset:12800
    v_mfma_f32_16x16x32_bf16 v[114:117], v[166:169], v[194:197], v[114:117]
    ds_read_b128 v[126:129], v28 offset:20480
    s_waitcnt lgkmcnt(10)
    v_mfma_f32_16x16x32_bf16 v[62:65], v[174:177], v[130:133], v[62:65]
    ds_read_b64_tr_b16 v[190:191], v34 offset:16384
    s_waitcnt lgkmcnt(8)
    v_mfma_f32_16x16x32_bf16 v[62:65], v[178:181], v[142:145], v[62:65]
    ds_read_b64_tr_b16 v[192:193], v34 offset:16896
    s_waitcnt lgkmcnt(8)
    v_mfma_f32_16x16x32_bf16 v[70:73], v[174:177], v[134:137], v[70:73]
    ds_read_b128 v[138:141], v29 offset:20480
    ds_read_b64_tr_b16 v[194:195], v34 offset:20480
    s_waitcnt lgkmcnt(9)
    v_mfma_f32_16x16x32_bf16 v[70:73], v[178:181], v[146:149], v[70:73]
    ds_read_b64_tr_b16 v[196:197], v34 offset:20992
    s_waitcnt lgkmcnt(8)
    v_mfma_f32_16x16x32_bf16 v[66:69], v[182:185], v[130:133], v[66:69]
    ds_read_b64_tr_b16 v[174:175], v35 offset:16384
    s_waitcnt lgkmcnt(7)
    v_mfma_f32_16x16x32_bf16 v[66:69], v[186:189], v[142:145], v[66:69]
    ds_read_b64_tr_b16 v[176:177], v35 offset:16896
    v_mfma_f32_16x16x32_bf16 v[74:77], v[182:185], v[134:137], v[74:77]
    ds_read_b64_tr_b16 v[178:179], v35 offset:20480
    v_mfma_f32_16x16x32_bf16 v[74:77], v[186:189], v[146:149], v[74:77]
    ds_read_b64_tr_b16 v[180:181], v35 offset:20992
    s_waitcnt lgkmcnt(7)
    v_mfma_f32_16x16x32_bf16 v[78:81], v[190:193], v[126:129], v[78:81]
    ds_read_b64_tr_b16 v[182:183], v34 offset:24576
    s_waitcnt lgkmcnt(5)
    v_mfma_f32_16x16x32_bf16 v[78:81], v[194:197], v[138:141], v[78:81]
    ds_read_b64_tr_b16 v[184:185], v34 offset:25088
    v_mfma_f32_16x16x32_bf16 v[86:89], v[190:193], v[130:133], v[86:89]
    ds_read_b64_tr_b16 v[186:187], v34 offset:28672
    v_mfma_f32_16x16x32_bf16 v[86:89], v[194:197], v[142:145], v[86:89]
    ds_read_b64_tr_b16 v[188:189], v34 offset:29184
    v_mfma_f32_16x16x32_bf16 v[94:97], v[190:193], v[134:137], v[94:97]
    ds_read_b64_tr_b16 v[190:191], v35 offset:24576
    v_mfma_f32_16x16x32_bf16 v[94:97], v[194:197], v[146:149], v[94:97]
    ds_read_b64_tr_b16 v[192:193], v35 offset:25088
    s_waitcnt lgkmcnt(8)
    v_mfma_f32_16x16x32_bf16 v[82:85], v[174:177], v[126:129], v[82:85]
    ds_read_b64_tr_b16 v[194:195], v35 offset:28672
    s_waitcnt lgkmcnt(7)
    v_mfma_f32_16x16x32_bf16 v[82:85], v[178:181], v[138:141], v[82:85]
    ds_read_b64_tr_b16 v[196:197], v35 offset:29184
    v_mfma_f32_16x16x32_bf16 v[90:93], v[174:177], v[130:133], v[90:93]
    v_mfma_f32_16x16x32_bf16 v[90:93], v[178:181], v[142:145], v[90:93]
    v_mfma_f32_16x16x32_bf16 v[98:101], v[174:177], v[134:137], v[98:101]
    v_mfma_f32_16x16x32_bf16 v[98:101], v[178:181], v[146:149], v[98:101]
    s_waitcnt lgkmcnt(0)
    s_barrier
    ds_read_b128 v[154:157], v28 offset:32768
    ds_read_b64_tr_b16 v[174:175], v34 offset:32768
    ds_read_b64_tr_b16 v[176:177], v34 offset:33280
    ds_read_b128 v[166:169], v29 offset:32768
    v_mfma_f32_16x16x32_bf16 v[102:105], v[126:129], v[182:185], v[102:105]
    ds_read_b64_tr_b16 v[178:179], v34 offset:36864
    v_mfma_f32_16x16x32_bf16 v[102:105], v[138:141], v[186:189], v[102:105]
    ds_read_b64_tr_b16 v[180:181], v34 offset:37376
    v_mfma_f32_16x16x32_bf16 v[110:113], v[130:133], v[182:185], v[110:113]
    ds_read_b128 v[158:161], v28 offset:34816
    v_mfma_f32_16x16x32_bf16 v[110:113], v[142:145], v[186:189], v[110:113]
    ds_read_b128 v[170:173], v29 offset:34816
    v_mfma_f32_16x16x32_bf16 v[106:109], v[126:129], v[190:193], v[106:109]
    ds_read_b64_tr_b16 v[182:183], v35 offset:32768
    v_mfma_f32_16x16x32_bf16 v[106:109], v[138:141], v[194:197], v[106:109]
    ds_read_b64_tr_b16 v[184:185], v35 offset:33280
    v_mfma_f32_16x16x32_bf16 v[114:117], v[130:133], v[190:193], v[114:117]
    ds_read_b64_tr_b16 v[186:187], v35 offset:36864
    ds_read_b64_tr_b16 v[188:189], v35 offset:37376
    v_mfma_f32_16x16x32_bf16 v[114:117], v[142:145], v[194:197], v[114:117]
    ds_read_b128 v[150:153], v28 offset:30720
    s_waitcnt lgkmcnt(10)
    v_mfma_f32_16x16x32_bf16 v[62:65], v[174:177], v[154:157], v[62:65]
    ds_read_b64_tr_b16 v[190:191], v32 offset:0
    s_waitcnt lgkmcnt(8)
    v_mfma_f32_16x16x32_bf16 v[62:65], v[178:181], v[166:169], v[62:65]
    ds_read_b64_tr_b16 v[192:193], v32 offset:512
    s_waitcnt lgkmcnt(8)
    v_mfma_f32_16x16x32_bf16 v[70:73], v[174:177], v[158:161], v[70:73]
    ds_read_b128 v[162:165], v29 offset:30720
    ds_read_b64_tr_b16 v[194:195], v32 offset:4096
    s_waitcnt lgkmcnt(9)
    v_mfma_f32_16x16x32_bf16 v[70:73], v[178:181], v[170:173], v[70:73]
    ds_read_b64_tr_b16 v[196:197], v32 offset:4608
    s_waitcnt lgkmcnt(8)
    v_mfma_f32_16x16x32_bf16 v[66:69], v[182:185], v[154:157], v[66:69]
    ds_read_b64_tr_b16 v[174:175], v33 offset:0
    s_waitcnt lgkmcnt(7)
    v_mfma_f32_16x16x32_bf16 v[66:69], v[186:189], v[166:169], v[66:69]
    ds_read_b64_tr_b16 v[176:177], v33 offset:512
    v_mfma_f32_16x16x32_bf16 v[74:77], v[182:185], v[158:161], v[74:77]
    ds_read_b64_tr_b16 v[178:179], v33 offset:4096
    v_mfma_f32_16x16x32_bf16 v[74:77], v[186:189], v[170:173], v[74:77]
    ds_read_b64_tr_b16 v[180:181], v33 offset:4608
    s_waitcnt lgkmcnt(7)
    v_mfma_f32_16x16x32_bf16 v[78:81], v[190:193], v[150:153], v[78:81]
    ds_read_b64_tr_b16 v[182:183], v32 offset:8192
    s_waitcnt lgkmcnt(5)
    v_mfma_f32_16x16x32_bf16 v[78:81], v[194:197], v[162:165], v[78:81]
    ds_read_b64_tr_b16 v[184:185], v32 offset:8704
    v_mfma_f32_16x16x32_bf16 v[86:89], v[190:193], v[154:157], v[86:89]
    ds_read_b64_tr_b16 v[186:187], v32 offset:12288
    v_mfma_f32_16x16x32_bf16 v[86:89], v[194:197], v[166:169], v[86:89]
    ds_read_b64_tr_b16 v[188:189], v32 offset:12800
    v_mfma_f32_16x16x32_bf16 v[94:97], v[190:193], v[158:161], v[94:97]
    ds_read_b64_tr_b16 v[190:191], v33 offset:8192
    v_mfma_f32_16x16x32_bf16 v[94:97], v[194:197], v[170:173], v[94:97]
    ds_read_b64_tr_b16 v[192:193], v33 offset:8704
    s_waitcnt lgkmcnt(8)
    v_mfma_f32_16x16x32_bf16 v[82:85], v[174:177], v[150:153], v[82:85]
    ds_read_b64_tr_b16 v[194:195], v33 offset:12288
    s_waitcnt lgkmcnt(7)
    v_mfma_f32_16x16x32_bf16 v[82:85], v[178:181], v[162:165], v[82:85]
    ds_read_b64_tr_b16 v[196:197], v33 offset:12800
    v_mfma_f32_16x16x32_bf16 v[90:93], v[174:177], v[154:157], v[90:93]
    v_mfma_f32_16x16x32_bf16 v[90:93], v[178:181], v[166:169], v[90:93]
    v_mfma_f32_16x16x32_bf16 v[98:101], v[174:177], v[158:161], v[98:101]
    v_mfma_f32_16x16x32_bf16 v[98:101], v[178:181], v[170:173], v[98:101]
    s_waitcnt lgkmcnt(0)
    s_barrier
    ds_read_b128 v[130:133], v30 offset:2048
    ds_read_b64_tr_b16 v[174:175], v32 offset:16384
    ds_read_b64_tr_b16 v[176:177], v32 offset:16896
    ds_read_b128 v[142:145], v31 offset:2048
    v_mfma_f32_16x16x32_bf16 v[102:105], v[150:153], v[182:185], v[102:105]
    ds_read_b64_tr_b16 v[178:179], v32 offset:20480
    v_mfma_f32_16x16x32_bf16 v[102:105], v[162:165], v[186:189], v[102:105]
    ds_read_b64_tr_b16 v[180:181], v32 offset:20992
    v_mfma_f32_16x16x32_bf16 v[110:113], v[154:157], v[182:185], v[110:113]
    ds_read_b128 v[134:137], v30 offset:4096
    v_mfma_f32_16x16x32_bf16 v[110:113], v[166:169], v[186:189], v[110:113]
    ds_read_b128 v[146:149], v31 offset:4096
    v_mfma_f32_16x16x32_bf16 v[106:109], v[150:153], v[190:193], v[106:109]
    ds_read_b64_tr_b16 v[182:183], v33 offset:16384
    v_mfma_f32_16x16x32_bf16 v[106:109], v[162:165], v[194:197], v[106:109]
    ds_read_b64_tr_b16 v[184:185], v33 offset:16896
    v_mfma_f32_16x16x32_bf16 v[114:117], v[154:157], v[190:193], v[114:117]
    ds_read_b64_tr_b16 v[186:187], v33 offset:20480
    ds_read_b64_tr_b16 v[188:189], v33 offset:20992
    v_mfma_f32_16x16x32_bf16 v[114:117], v[166:169], v[194:197], v[114:117]
    ds_read_b128 v[126:129], v30 offset:0
    s_waitcnt lgkmcnt(10)
    v_mfma_f32_16x16x32_bf16 v[62:65], v[174:177], v[130:133], v[62:65]
    ds_read_b64_tr_b16 v[190:191], v32 offset:24576
    s_waitcnt lgkmcnt(8)
    v_mfma_f32_16x16x32_bf16 v[62:65], v[178:181], v[142:145], v[62:65]
    ds_read_b64_tr_b16 v[192:193], v32 offset:25088
    s_waitcnt lgkmcnt(8)
    v_mfma_f32_16x16x32_bf16 v[70:73], v[174:177], v[134:137], v[70:73]
    ds_read_b128 v[138:141], v31 offset:0
    ds_read_b64_tr_b16 v[194:195], v32 offset:28672
    s_waitcnt lgkmcnt(9)
    v_mfma_f32_16x16x32_bf16 v[70:73], v[178:181], v[146:149], v[70:73]
    ds_read_b64_tr_b16 v[196:197], v32 offset:29184
    s_waitcnt lgkmcnt(8)
    v_mfma_f32_16x16x32_bf16 v[66:69], v[182:185], v[130:133], v[66:69]
    ds_read_b64_tr_b16 v[174:175], v33 offset:24576
    s_waitcnt lgkmcnt(7)
    v_mfma_f32_16x16x32_bf16 v[66:69], v[186:189], v[142:145], v[66:69]
    ds_read_b64_tr_b16 v[176:177], v33 offset:25088
    v_mfma_f32_16x16x32_bf16 v[74:77], v[182:185], v[134:137], v[74:77]
    ds_read_b64_tr_b16 v[178:179], v33 offset:28672
    v_mfma_f32_16x16x32_bf16 v[74:77], v[186:189], v[146:149], v[74:77]
    ds_read_b64_tr_b16 v[180:181], v33 offset:29184
    s_waitcnt lgkmcnt(7)
    v_mfma_f32_16x16x32_bf16 v[78:81], v[190:193], v[126:129], v[78:81]
    ds_read_b64_tr_b16 v[182:183], v32 offset:32768
    s_waitcnt lgkmcnt(5)
    v_mfma_f32_16x16x32_bf16 v[78:81], v[194:197], v[138:141], v[78:81]
    ds_read_b64_tr_b16 v[184:185], v32 offset:33280
    v_mfma_f32_16x16x32_bf16 v[86:89], v[190:193], v[130:133], v[86:89]
    ds_read_b64_tr_b16 v[186:187], v32 offset:36864
    v_mfma_f32_16x16x32_bf16 v[86:89], v[194:197], v[142:145], v[86:89]
    ds_read_b64_tr_b16 v[188:189], v32 offset:37376
    v_mfma_f32_16x16x32_bf16 v[94:97], v[190:193], v[134:137], v[94:97]
    ds_read_b64_tr_b16 v[190:191], v33 offset:32768
    v_mfma_f32_16x16x32_bf16 v[94:97], v[194:197], v[146:149], v[94:97]
    ds_read_b64_tr_b16 v[192:193], v33 offset:33280
    s_waitcnt lgkmcnt(8)
    v_mfma_f32_16x16x32_bf16 v[82:85], v[174:177], v[126:129], v[82:85]
    ds_read_b64_tr_b16 v[194:195], v33 offset:36864
    s_waitcnt lgkmcnt(7)
    v_mfma_f32_16x16x32_bf16 v[82:85], v[178:181], v[138:141], v[82:85]
    ds_read_b64_tr_b16 v[196:197], v33 offset:37376
    v_mfma_f32_16x16x32_bf16 v[90:93], v[174:177], v[130:133], v[90:93]
    v_mfma_f32_16x16x32_bf16 v[90:93], v[178:181], v[142:145], v[90:93]
    v_mfma_f32_16x16x32_bf16 v[98:101], v[174:177], v[134:137], v[98:101]
    v_mfma_f32_16x16x32_bf16 v[98:101], v[178:181], v[146:149], v[98:101]
    s_waitcnt lgkmcnt(0)
    s_barrier
    ds_read_b128 v[154:157], v30 offset:12288
    ds_read_b64_tr_b16 v[174:175], v32 offset:40960
    ds_read_b64_tr_b16 v[176:177], v32 offset:41472
    ds_read_b128 v[166:169], v31 offset:12288
    v_mfma_f32_16x16x32_bf16 v[102:105], v[126:129], v[182:185], v[102:105]
    ds_read_b64_tr_b16 v[178:179], v32 offset:45056
    v_mfma_f32_16x16x32_bf16 v[102:105], v[138:141], v[186:189], v[102:105]
    ds_read_b64_tr_b16 v[180:181], v32 offset:45568
    v_mfma_f32_16x16x32_bf16 v[110:113], v[130:133], v[182:185], v[110:113]
    ds_read_b128 v[158:161], v30 offset:14336
    v_mfma_f32_16x16x32_bf16 v[110:113], v[142:145], v[186:189], v[110:113]
    ds_read_b128 v[170:173], v31 offset:14336
    v_mfma_f32_16x16x32_bf16 v[106:109], v[126:129], v[190:193], v[106:109]
    ds_read_b64_tr_b16 v[182:183], v33 offset:40960
    v_mfma_f32_16x16x32_bf16 v[106:109], v[138:141], v[194:197], v[106:109]
    ds_read_b64_tr_b16 v[184:185], v33 offset:41472
    v_mfma_f32_16x16x32_bf16 v[114:117], v[130:133], v[190:193], v[114:117]
    ds_read_b64_tr_b16 v[186:187], v33 offset:45056
    ds_read_b64_tr_b16 v[188:189], v33 offset:45568
    v_mfma_f32_16x16x32_bf16 v[114:117], v[142:145], v[194:197], v[114:117]
    ds_read_b128 v[150:153], v30 offset:10240
    s_waitcnt lgkmcnt(10)
    v_mfma_f32_16x16x32_bf16 v[62:65], v[174:177], v[154:157], v[62:65]
    ds_read_b64_tr_b16 v[190:191], v34 offset:0
    s_waitcnt lgkmcnt(8)
    v_mfma_f32_16x16x32_bf16 v[62:65], v[178:181], v[166:169], v[62:65]
    ds_read_b64_tr_b16 v[192:193], v34 offset:512
    s_waitcnt lgkmcnt(8)
    v_mfma_f32_16x16x32_bf16 v[70:73], v[174:177], v[158:161], v[70:73]
    ds_read_b128 v[162:165], v31 offset:10240
    ds_read_b64_tr_b16 v[194:195], v34 offset:4096
    s_waitcnt lgkmcnt(9)
    v_mfma_f32_16x16x32_bf16 v[70:73], v[178:181], v[170:173], v[70:73]
    ds_read_b64_tr_b16 v[196:197], v34 offset:4608
    s_waitcnt lgkmcnt(8)
    v_mfma_f32_16x16x32_bf16 v[66:69], v[182:185], v[154:157], v[66:69]
    ds_read_b64_tr_b16 v[174:175], v35 offset:0
    s_waitcnt lgkmcnt(7)
    v_mfma_f32_16x16x32_bf16 v[66:69], v[186:189], v[166:169], v[66:69]
    ds_read_b64_tr_b16 v[176:177], v35 offset:512
    v_mfma_f32_16x16x32_bf16 v[74:77], v[182:185], v[158:161], v[74:77]
    ds_read_b64_tr_b16 v[178:179], v35 offset:4096
    v_mfma_f32_16x16x32_bf16 v[74:77], v[186:189], v[170:173], v[74:77]
    ds_read_b64_tr_b16 v[180:181], v35 offset:4608
    s_waitcnt lgkmcnt(7)
    v_mfma_f32_16x16x32_bf16 v[78:81], v[190:193], v[150:153], v[78:81]
    ds_read_b64_tr_b16 v[182:183], v34 offset:8192
    s_waitcnt lgkmcnt(5)
    v_mfma_f32_16x16x32_bf16 v[78:81], v[194:197], v[162:165], v[78:81]
    ds_read_b64_tr_b16 v[184:185], v34 offset:8704
    v_mfma_f32_16x16x32_bf16 v[86:89], v[190:193], v[154:157], v[86:89]
    ds_read_b64_tr_b16 v[186:187], v34 offset:12288
    v_mfma_f32_16x16x32_bf16 v[86:89], v[194:197], v[166:169], v[86:89]
    ds_read_b64_tr_b16 v[188:189], v34 offset:12800
    v_mfma_f32_16x16x32_bf16 v[94:97], v[190:193], v[158:161], v[94:97]
    ds_read_b64_tr_b16 v[190:191], v35 offset:8192
    v_mfma_f32_16x16x32_bf16 v[94:97], v[194:197], v[170:173], v[94:97]
    ds_read_b64_tr_b16 v[192:193], v35 offset:8704
    s_waitcnt lgkmcnt(8)
    v_mfma_f32_16x16x32_bf16 v[82:85], v[174:177], v[150:153], v[82:85]
    ds_read_b64_tr_b16 v[194:195], v35 offset:12288
    s_waitcnt lgkmcnt(7)
    v_mfma_f32_16x16x32_bf16 v[82:85], v[178:181], v[162:165], v[82:85]
    ds_read_b64_tr_b16 v[196:197], v35 offset:12800
    v_mfma_f32_16x16x32_bf16 v[90:93], v[174:177], v[154:157], v[90:93]
    v_mfma_f32_16x16x32_bf16 v[90:93], v[178:181], v[166:169], v[90:93]
    v_mfma_f32_16x16x32_bf16 v[98:101], v[174:177], v[158:161], v[98:101]
    v_mfma_f32_16x16x32_bf16 v[98:101], v[178:181], v[170:173], v[98:101]
    s_waitcnt lgkmcnt(6)
    v_mfma_f32_16x16x32_bf16 v[102:105], v[150:153], v[182:185], v[102:105]
    s_waitcnt lgkmcnt(4)
    v_mfma_f32_16x16x32_bf16 v[102:105], v[162:165], v[186:189], v[102:105]
    v_mfma_f32_16x16x32_bf16 v[110:113], v[154:157], v[182:185], v[110:113]
    v_mfma_f32_16x16x32_bf16 v[110:113], v[166:169], v[186:189], v[110:113]
    s_waitcnt lgkmcnt(2)
    v_mfma_f32_16x16x32_bf16 v[106:109], v[150:153], v[190:193], v[106:109]
    s_waitcnt lgkmcnt(0)
    v_mfma_f32_16x16x32_bf16 v[106:109], v[162:165], v[194:197], v[106:109]
    v_mfma_f32_16x16x32_bf16 v[114:117], v[154:157], v[190:193], v[114:117]
    s_barrier
    ds_read_b128 v[134:137], v30 offset:24576
    ds_read_b64_tr_b16 v[174:175], v34 offset:24576
    ds_read_b64_tr_b16 v[176:177], v34 offset:25088
    ds_read_b128 v[146:149], v31 offset:24576
    ds_read_b64_tr_b16 v[178:179], v34 offset:28672
    ds_read_b64_tr_b16 v[180:181], v34 offset:29184
    ds_read_b64_tr_b16 v[182:183], v35 offset:24576
    ds_read_b64_tr_b16 v[184:185], v35 offset:25088
    ds_read_b64_tr_b16 v[186:187], v35 offset:28672
    ds_read_b64_tr_b16 v[188:189], v35 offset:29184
    ds_read_b128 v[130:133], v30 offset:22528
    ds_read_b64_tr_b16 v[198:199], v34 offset:16384
    ds_read_b64_tr_b16 v[200:201], v34 offset:16896
    ds_read_b128 v[142:145], v31 offset:22528
    ds_read_b64_tr_b16 v[202:203], v34 offset:20480
    ds_read_b64_tr_b16 v[204:205], v34 offset:20992
    ds_read_b64_tr_b16 v[190:191], v35 offset:16384
    v_mfma_f32_16x16x32_bf16 v[114:117], v[166:169], v[194:197], v[114:117]
    ds_read_b64_tr_b16 v[192:193], v35 offset:16896
    s_waitcnt lgkmcnt(15)
    v_mfma_f32_16x16x32_bf16 v[94:97], v[174:177], v[134:137], v[94:97]
    ds_read_b64_tr_b16 v[194:195], v35 offset:20480
    s_waitcnt lgkmcnt(13)
    v_mfma_f32_16x16x32_bf16 v[94:97], v[178:181], v[146:149], v[94:97]
    ds_read_b64_tr_b16 v[196:197], v35 offset:20992
    s_waitcnt lgkmcnt(12)
    v_mfma_f32_16x16x32_bf16 v[98:101], v[182:185], v[134:137], v[98:101]
    ds_read_b128 v[126:129], v30 offset:20480
    s_waitcnt lgkmcnt(11)
    v_mfma_f32_16x16x32_bf16 v[98:101], v[186:189], v[146:149], v[98:101]
    ds_read_b128 v[138:141], v31 offset:20480
    s_waitcnt lgkmcnt(9)
    v_mfma_f32_16x16x32_bf16 v[62:65], v[198:201], v[130:133], v[62:65]
    ds_read_b32 v40, v5 offset:4
    s_waitcnt lgkmcnt(7)
    v_mfma_f32_16x16x32_bf16 v[62:65], v[202:205], v[142:145], v[62:65]
    v_mfma_f32_16x16x32_bf16 v[70:73], v[198:201], v[134:137], v[70:73]
    v_cvt_pk_bf16_f32 v234, v94, v95
    v_cvt_pk_bf16_f32 v235, v96, v97
    v_cvt_pk_bf16_f32 v236, v98, v99
    v_mfma_f32_16x16x32_bf16 v[70:73], v[202:205], v[146:149], v[70:73]
    v_cvt_pk_bf16_f32 v237, v100, v101
    ds_write_b128 v218, v[234:237]
    ds_write_b32 v220, v5 offset:56
    s_waitcnt lgkmcnt(7)
    v_mfma_f32_16x16x32_bf16 v[66:69], v[190:193], v[130:133], v[66:69]
    v_cvt_pk_bf16_f32 v150, v62, v63
    v_cvt_pk_bf16_f32 v151, v64, v65
    s_waitcnt lgkmcnt(5)
    v_mfma_f32_16x16x32_bf16 v[66:69], v[194:197], v[142:145], v[66:69]
    v_cndmask_b32 v158, 0, v150, s[54:55]
    v_cndmask_b32 v150, v150, 0, s[54:55]
    v_mfma_f32_16x16x32_bf16 v[74:77], v[190:193], v[134:137], v[74:77]
    v_cndmask_b32 v159, 0, v151, s[54:55]
    v_cndmask_b32 v151, v151, 0, s[54:55]
    v_mfma_f32_16x16x32_bf16 v[74:77], v[194:197], v[146:149], v[74:77]
    v_cvt_pk_bf16_f32 v154, v70, v71
    v_cvt_pk_bf16_f32 v155, v72, v73
    s_waitcnt lgkmcnt(4)
    v_mfma_f32_16x16x32_bf16 v[78:81], v[174:177], v[126:129], v[78:81]
    v_cndmask_b32 v162, 0, v154, s[54:55]
    v_cndmask_b32 v154, v154, 0, s[54:55]
    s_waitcnt lgkmcnt(3)
    v_mfma_f32_16x16x32_bf16 v[78:81], v[178:181], v[138:141], v[78:81]
    v_cndmask_b32 v163, 0, v155, s[54:55]
    v_cndmask_b32 v155, v155, 0, s[54:55]
    v_mfma_f32_16x16x32_bf16 v[82:85], v[182:185], v[126:129], v[82:85]
    v_cvt_pk_bf16_f32 v152, v66, v67
    v_cvt_pk_bf16_f32 v153, v68, v69
    v_mfma_f32_16x16x32_bf16 v[82:85], v[186:189], v[138:141], v[82:85]
    v_cndmask_b32 v160, 0, v152, s[56:57]
    v_cndmask_b32 v152, v152, 0, s[56:57]
    v_mfma_f32_16x16x32_bf16 v[86:89], v[174:177], v[130:133], v[86:89]
    v_cndmask_b32 v161, 0, v153, s[56:57]
    v_cndmask_b32 v153, v153, 0, s[56:57]
    v_mfma_f32_16x16x32_bf16 v[86:89], v[178:181], v[142:145], v[86:89]
    v_cvt_pk_bf16_f32 v156, v74, v75
    v_cvt_pk_bf16_f32 v157, v76, v77
    v_mfma_f32_16x16x32_bf16 v[90:93], v[182:185], v[130:133], v[90:93]
    v_cndmask_b32 v164, 0, v156, s[56:57]
    v_cndmask_b32 v156, v156, 0, s[56:57]
    v_mfma_f32_16x16x32_bf16 v[90:93], v[186:189], v[142:145], v[90:93]
    v_cndmask_b32 v165, 0, v157, s[56:57]
    v_cndmask_b32 v157, v157, 0, s[56:57]
    v_cvt_pk_bf16_f32 v226, v78, v79
    v_cvt_pk_bf16_f32 v227, v80, v81
    v_cvt_pk_bf16_f32 v228, v82, v83
    v_cvt_pk_bf16_f32 v229, v84, v85
    s_nop 1
    v_mfma_f32_16x16x32_bf16 v[62:65], v[226:229], v[150:153], 0
    v_mfma_f32_16x16x32_bf16 v[74:77], v[234:237], v[154:157], 0
    v_cvt_pk_bf16_f32 v230, v86, v87
    v_cvt_pk_bf16_f32 v231, v88, v89
    v_cvt_pk_bf16_f32 v232, v90, v91
    v_cvt_pk_bf16_f32 v233, v92, v93
    s_nop 1
    v_mfma_f32_16x16x32_bf16 v[66:69], v[230:233], v[150:153], 0
    v_mfma_f32_16x16x32_bf16 v[70:73], v[230:233], v[154:157], 0
    v_mfma_f32_16x16x32_bf16 v[174:177], v[226:229], v[158:161], 0
    v_mfma_f32_16x16x32_bf16 v[178:181], v[230:233], v[158:161], 0
    v_mfma_f32_16x16x32_bf16 v[182:185], v[230:233], v[162:165], 0
    v_mfma_f32_16x16x32_bf16 v[186:189], v[234:237], v[162:165], 0
    s_waitcnt lgkmcnt(2)
    v_readfirstlane_b32 s63, v40
    s_nop 0
    v_cndmask_b32 v66, v66, v67, s[44:45]
    ds_read_b32 v40, v5 offset:32
    v_cndmask_b32 v68, v68, v69, s[44:45]
    ds_read_b64_tr_b16 v[166:167], v34 offset:32768
    v_cndmask_b32 v62, v62, v63, s[44:45]
    ds_read_b64_tr_b16 v[168:169], v34 offset:33280
    v_cndmask_b32 v64, v64, v65, s[44:45]
    ds_read_b64_tr_b16 v[170:171], v35 offset:32768
    v_cndmask_b32 v62, v62, v45, s[50:51]
    ds_read_b64_tr_b16 v[172:173], v35 offset:33280
    v_cndmask_b32 v64, v64, v45, s[50:51]
    ds_read_b64_tr_b16 v[198:199], v34 offset:36864
    v_cndmask_b32 v210, v62, v66, s[46:47]
    ds_read_b64_tr_b16 v[200:201], v34 offset:37376
    v_cndmask_b32 v211, v64, v68, s[48:49]
    ds_read_b64_tr_b16 v[202:203], v35 offset:36864
    v_cndmask_b32 v74, v74, v75, s[44:45]
    ds_read_b64_tr_b16 v[204:205], v35 offset:37376
    v_cndmask_b32 v76, v76, v77, s[44:45]
    v_cndmask_b32 v70, v70, v71, s[44:45]
    v_cndmask_b32 v72, v72, v73, s[44:45]
    v_cndmask_b32 v212, v70, v74, s[46:47]
    v_cndmask_b32 v213, v72, v76, s[48:49]
    v_and_or_b32 v94, v210, v46, v50
    v_and_or_b32 v95, v211, v46, v51
    v_and_or_b32 v96, v212, v46, v52
    v_and_or_b32 v97, v213, v46, v53
    s_cmp_lg_u32 s101, 0
    s_cbranch_scc1 SM_jS0
    s_cmp_eq_u32 s63, 0
    s_cbranch_scc1 SM_sS0
    buffer_store_dwordx4 v[94:97], v4, s[36:39], s15 offen
SM_jS0:
    v_cndmask_b32 v178, v178, v179, s[44:45]
    v_cndmask_b32 v180, v180, v181, s[44:45]
    v_cndmask_b32 v174, v174, v175, s[44:45]
    v_cndmask_b32 v176, v176, v177, s[44:45]
    v_cndmask_b32 v174, v174, v45, s[50:51]
    v_cndmask_b32 v176, v176, v45, s[50:51]
    v_cndmask_b32 v206, v174, v178, s[46:47]
    v_cndmask_b32 v207, v176, v180, s[48:49]
    v_cndmask_b32 v186, v186, v187, s[44:45]
    v_cndmask_b32 v188, v188, v189, s[44:45]
    v_cndmask_b32 v182, v182, v183, s[44:45]
    v_cndmask_b32 v184, v184, v185, s[44:45]
    v_cndmask_b32 v208, v182, v186, s[46:47]
    v_cndmask_b32 v209, v184, v188, s[48:49]
    ds_write_b128 v42, v[206:209]
    ds_write_b32 v47, v5 offset:16
    s_waitcnt lgkmcnt(10)
    v_cmp_gt_u32 vcc, 4, v40
    s_nop 0
    s_cbranch_vccnz C_vr0
C_vd0:
    s_waitcnt lgkmcnt(8)
    v_mfma_f32_16x16x32_bf16 v[102:105], v[126:129], v[166:169], v[102:105]
    s_waitcnt lgkmcnt(4)
    v_mfma_f32_16x16x32_bf16 v[102:105], v[138:141], v[198:201], v[102:105]
    v_mfma_f32_16x16x32_bf16 v[106:109], v[126:129], v[170:173], v[106:109]
    s_waitcnt lgkmcnt(2)
    v_mfma_f32_16x16x32_bf16 v[106:109], v[138:141], v[202:205], v[106:109]
    v_mfma_f32_16x16x32_bf16 v[110:113], v[130:133], v[166:169], v[110:113]
    v_mfma_f32_16x16x32_bf16 v[110:113], v[142:145], v[198:201], v[110:113]
    v_mfma_f32_16x16x32_bf16 v[114:117], v[130:133], v[170:173], v[114:117]
    s_nop 1
    v_cvt_pk_bf16_f32 v226, v102, v103
    v_cvt_pk_bf16_f32 v227, v104, v105
    v_mfma_f32_16x16x32_bf16 v[114:117], v[142:145], v[202:205], v[114:117]
    v_cvt_pk_bf16_f32 v232, v106, v107
    v_cvt_pk_bf16_f32 v233, v108, v109
    v_cndmask_b32 v126, 0, v226, s[58:59]
    v_cndmask_b32 v226, v226, 0, s[58:59]
    v_cndmask_b32 v127, 0, v227, s[58:59]
    v_cndmask_b32 v227, v227, 0, s[58:59]
    v_cndmask_b32 v132, 0, v232, s[60:61]
    v_cndmask_b32 v232, v232, 0, s[60:61]
    v_cndmask_b32 v133, 0, v233, s[60:61]
    v_cndmask_b32 v233, v233, 0, s[60:61]
    buffer_load_dwordx4 v[214:217], v4, s[36:39], s100 offen sc1
    v_cvt_pk_bf16_f32 v228, v110, v111
    v_cvt_pk_bf16_f32 v229, v112, v113
    v_cvt_pk_bf16_f32 v234, v114, v115
    v_cvt_pk_bf16_f32 v235, v116, v117
    ds_read_b32 v48, v221
    ds_read_b64 v[230:231], v219
    ds_read_b64 v[236:237], v219 offset:8
    v_cndmask_b32 v128, 0, v228, s[58:59]
    v_cndmask_b32 v228, v228, 0, s[58:59]
    v_cndmask_b32 v129, 0, v229, s[58:59]
    v_cndmask_b32 v229, v229, 0, s[58:59]
    v_cndmask_b32 v134, 0, v234, s[60:61]
    v_cndmask_b32 v234, v234, 0, s[60:61]
    v_cndmask_b32 v135, 0, v235, s[60:61]
    v_cndmask_b32 v235, v235, 0, s[60:61]
    s_waitcnt lgkmcnt(0)
    v_cmp_ne_u32 vcc, 0, v48
    s_nop 0
    s_cbranch_vccnz D_dV
    s_mov_b32 s9, 0
D_lV:
    ds_read_b32 v48, v221
    ds_read_b64 v[230:231], v219
    ds_read_b64 v[236:237], v219 offset:8
    s_add_u32 s9, s9, 1
    s_cmp_gt_u32 s9, 1600000
    s_waitcnt lgkmcnt(0)
    s_cbranch_scc1 D_dV
    v_cmp_eq_u32 vcc, 0, v48
    s_nop 0
    s_cbranch_vccnz D_lV
            D_dV:

    v_cndmask_b32 v130, 0, v230, s[58:59]
    v_cndmask_b32 v230, v230, 0, s[58:59]
    v_cndmask_b32 v131, 0, v231, s[58:59]
    v_cndmask_b32 v231, v231, 0, s[58:59]
    v_cndmask_b32 v136, 0, v236, s[60:61]
    v_cndmask_b32 v236, v236, 0, s[60:61]
    v_cndmask_b32 v137, 0, v237, s[60:61]
    v_cndmask_b32 v237, v237, 0, s[60:61]
    s_branch C_join
C_tp1:
    s_barrier
    ds_read_b128 v[130:133], v28 offset:2048
    ds_read_b64_tr_b16 v[174:175], v32 offset:8192
    ds_read_b64_tr_b16 v[176:177], v32 offset:8704
    ds_read_b128 v[142:145], v29 offset:2048
    ds_read_b64_tr_b16 v[178:179], v32 offset:12288
    ds_read_b64_tr_b16 v[180:181], v32 offset:12800
    ds_read_b128 v[134:137], v28 offset:4096
    ds_read_b128 v[146:149], v29 offset:4096
    ds_read_b64_tr_b16 v[182:183], v33 offset:8192
    ds_read_b64_tr_b16 v[184:185], v33 offset:8704
    ds_read_b64_tr_b16 v[186:187], v33 offset:12288
    ds_read_b64_tr_b16 v[188:189], v33 offset:12800
    s_waitcnt lgkmcnt(9)
    v_mfma_f32_16x16x32_bf16 v[62:65], v[174:177], v[130:133], 0
    ds_read_b64_tr_b16 v[190:191], v32 offset:16384
    s_waitcnt lgkmcnt(7)
    v_mfma_f32_16x16x32_bf16 v[62:65], v[178:181], v[142:145], v[62:65]
    ds_read_b64_tr_b16 v[192:193], v32 offset:16896
    s_waitcnt lgkmcnt(7)
    v_mfma_f32_16x16x32_bf16 v[70:73], v[174:177], v[134:137], 0
    ds_read_b64_tr_b16 v[194:195], v32 offset:20480
    ds_read_b64_tr_b16 v[196:197], v32 offset:20992
    s_waitcnt lgkmcnt(8)
    v_mfma_f32_16x16x32_bf16 v[70:73], v[178:181], v[146:149], v[70:73]
    ds_read_b64_tr_b16 v[174:175], v33 offset:16384
    s_waitcnt lgkmcnt(7)
    v_mfma_f32_16x16x32_bf16 v[66:69], v[182:185], v[130:133], 0
    ds_read_b64_tr_b16 v[176:177], v33 offset:16896
    s_waitcnt lgkmcnt(6)
    v_mfma_f32_16x16x32_bf16 v[66:69], v[186:189], v[142:145], v[66:69]
    ds_read_b64_tr_b16 v[178:179], v33 offset:20480
    v_mfma_f32_16x16x32_bf16 v[74:77], v[182:185], v[134:137], 0
    ds_read_b64_tr_b16 v[180:181], v33 offset:20992
    v_mfma_f32_16x16x32_bf16 v[74:77], v[186:189], v[146:149], v[74:77]
    ds_read_b128 v[126:129], v28 offset:0
    s_waitcnt lgkmcnt(7)
    v_mfma_f32_16x16x32_bf16 v[86:89], v[190:193], v[130:133], 0
    ds_read_b64_tr_b16 v[182:183], v32 offset:24576
    s_waitcnt lgkmcnt(6)
    v_mfma_f32_16x16x32_bf16 v[86:89], v[194:197], v[142:145], v[86:89]
    ds_read_b64_tr_b16 v[184:185], v32 offset:25088
    v_mfma_f32_16x16x32_bf16 v[94:97], v[190:193], v[134:137], 0
    ds_read_b128 v[138:141], v29 offset:0
    ds_read_b64_tr_b16 v[186:187], v32 offset:28672
    v_mfma_f32_16x16x32_bf16 v[94:97], v[194:197], v[146:149], v[94:97]
    ds_read_b64_tr_b16 v[188:189], v32 offset:29184
    s_waitcnt lgkmcnt(8)
    v_mfma_f32_16x16x32_bf16 v[90:93], v[174:177], v[130:133], 0
    ds_read_b64_tr_b16 v[190:191], v33 offset:24576
    s_waitcnt lgkmcnt(7)
    v_mfma_f32_16x16x32_bf16 v[90:93], v[178:181], v[142:145], v[90:93]
    ds_read_b64_tr_b16 v[192:193], v33 offset:25088
    v_mfma_f32_16x16x32_bf16 v[98:101], v[174:177], v[134:137], 0
    ds_read_b64_tr_b16 v[194:195], v33 offset:28672
    v_mfma_f32_16x16x32_bf16 v[98:101], v[178:181], v[146:149], v[98:101]
    ds_read_b64_tr_b16 v[196:197], v33 offset:29184
    s_waitcnt lgkmcnt(7)
    v_mfma_f32_16x16x32_bf16 v[102:105], v[126:129], v[182:185], 0
    s_waitcnt lgkmcnt(4)
    v_mfma_f32_16x16x32_bf16 v[102:105], v[138:141], v[186:189], v[102:105]
    v_mfma_f32_16x16x32_bf16 v[110:113], v[130:133], v[182:185], 0
    v_mfma_f32_16x16x32_bf16 v[110:113], v[142:145], v[186:189], v[110:113]
    s_waitcnt lgkmcnt(0)
    s_barrier
    ds_read_b128 v[154:157], v28 offset:12288
    ds_read_b64_tr_b16 v[174:175], v32 offset:32768
    ds_read_b64_tr_b16 v[176:177], v32 offset:33280
    ds_read_b128 v[166:169], v29 offset:12288
    v_mfma_f32_16x16x32_bf16 v[118:121], v[134:137], v[182:185], 0
    ds_read_b64_tr_b16 v[178:179], v32 offset:36864
    v_mfma_f32_16x16x32_bf16 v[118:121], v[146:149], v[186:189], v[118:121]
    ds_read_b64_tr_b16 v[180:181], v32 offset:37376
    v_mfma_f32_16x16x32_bf16 v[106:109], v[126:129], v[190:193], 0
    ds_read_b128 v[158:161], v28 offset:14336
    v_mfma_f32_16x16x32_bf16 v[106:109], v[138:141], v[194:197], v[106:109]
    ds_read_b128 v[170:173], v29 offset:14336
    v_mfma_f32_16x16x32_bf16 v[114:117], v[130:133], v[190:193], 0
    ds_read_b64_tr_b16 v[182:183], v33 offset:32768
    v_mfma_f32_16x16x32_bf16 v[114:117], v[142:145], v[194:197], v[114:117]
    ds_read_b64_tr_b16 v[184:185], v33 offset:33280
    v_mfma_f32_16x16x32_bf16 v[122:125], v[134:137], v[190:193], 0
    ds_read_b64_tr_b16 v[186:187], v33 offset:36864
    ds_read_b64_tr_b16 v[188:189], v33 offset:37376
    v_mfma_f32_16x16x32_bf16 v[122:125], v[146:149], v[194:197], v[122:125]
    ds_read_b64_tr_b16 v[190:191], v32 offset:40960
    s_waitcnt lgkmcnt(10)
    v_mfma_f32_16x16x32_bf16 v[62:65], v[174:177], v[154:157], v[62:65]
    ds_read_b64_tr_b16 v[192:193], v32 offset:41472
    s_waitcnt lgkmcnt(8)
    v_mfma_f32_16x16x32_bf16 v[62:65], v[178:181], v[166:169], v[62:65]
    ds_read_b64_tr_b16 v[194:195], v32 offset:45056
    s_waitcnt lgkmcnt(8)
    v_mfma_f32_16x16x32_bf16 v[70:73], v[174:177], v[158:161], v[70:73]
    ds_read_b64_tr_b16 v[196:197], v32 offset:45568
    s_waitcnt lgkmcnt(8)
    v_mfma_f32_16x16x32_bf16 v[70:73], v[178:181], v[170:173], v[70:73]
    ds_read_b64_tr_b16 v[174:175], v33 offset:40960
    s_waitcnt lgkmcnt(7)
    v_mfma_f32_16x16x32_bf16 v[66:69], v[182:185], v[154:157], v[66:69]
    ds_read_b64_tr_b16 v[176:177], v33 offset:41472
    s_waitcnt lgkmcnt(6)
    v_mfma_f32_16x16x32_bf16 v[66:69], v[186:189], v[166:169], v[66:69]
    ds_read_b64_tr_b16 v[178:179], v33 offset:45056
    v_mfma_f32_16x16x32_bf16 v[74:77], v[182:185], v[158:161], v[74:77]
    ds_read_b64_tr_b16 v[180:181], v33 offset:45568
    v_mfma_f32_16x16x32_bf16 v[74:77], v[186:189], v[170:173], v[74:77]
    ds_read_b128 v[150:153], v28 offset:10240
    s_waitcnt lgkmcnt(7)
    v_mfma_f32_16x16x32_bf16 v[86:89], v[190:193], v[154:157], v[86:89]
    ds_read_b64_tr_b16 v[182:183], v34 offset:0
    s_waitcnt lgkmcnt(6)
    v_mfma_f32_16x16x32_bf16 v[86:89], v[194:197], v[166:169], v[86:89]
    ds_read_b64_tr_b16 v[184:185], v34 offset:512
    v_mfma_f32_16x16x32_bf16 v[94:97], v[190:193], v[158:161], v[94:97]
    ds_read_b128 v[162:165], v29 offset:10240
    ds_read_b64_tr_b16 v[186:187], v34 offset:4096
    v_mfma_f32_16x16x32_bf16 v[94:97], v[194:197], v[170:173], v[94:97]
    ds_read_b64_tr_b16 v[188:189], v34 offset:4608
    s_waitcnt lgkmcnt(8)
    v_mfma_f32_16x16x32_bf16 v[90:93], v[174:177], v[154:157], v[90:93]
    ds_read_b64_tr_b16 v[190:191], v35 offset:0
    s_waitcnt lgkmcnt(7)
    v_mfma_f32_16x16x32_bf16 v[90:93], v[178:181], v[166:169], v[90:93]
    ds_read_b64_tr_b16 v[192:193], v35 offset:512
    v_mfma_f32_16x16x32_bf16 v[98:101], v[174:177], v[158:161], v[98:101]
    ds_read_b64_tr_b16 v[194:195], v35 offset:4096
    v_mfma_f32_16x16x32_bf16 v[98:101], v[178:181], v[170:173], v[98:101]
    ds_read_b64_tr_b16 v[196:197], v35 offset:4608
    s_waitcnt lgkmcnt(7)
    v_mfma_f32_16x16x32_bf16 v[102:105], v[150:153], v[182:185], v[102:105]
    s_waitcnt lgkmcnt(4)
    v_mfma_f32_16x16x32_bf16 v[102:105], v[162:165], v[186:189], v[102:105]
    v_mfma_f32_16x16x32_bf16 v[110:113], v[154:157], v[182:185], v[110:113]
    v_mfma_f32_16x16x32_bf16 v[110:113], v[166:169], v[186:189], v[110:113]
    s_waitcnt lgkmcnt(0)
    s_barrier
    ds_read_b128 v[130:133], v28 offset:22528
    ds_read_b64_tr_b16 v[174:175], v34 offset:8192
    ds_read_b64_tr_b16 v[176:177], v34 offset:8704
    ds_read_b128 v[142:145], v29 offset:22528
    v_mfma_f32_16x16x32_bf16 v[118:121], v[158:161], v[182:185], v[118:121]
    ds_read_b64_tr_b16 v[178:179], v34 offset:12288
    v_mfma_f32_16x16x32_bf16 v[118:121], v[170:173], v[186:189], v[118:121]
    ds_read_b64_tr_b16 v[180:181], v34 offset:12800
    v_mfma_f32_16x16x32_bf16 v[106:109], v[150:153], v[190:193], v[106:109]
    ds_read_b128 v[134:137], v28 offset:24576
    v_mfma_f32_16x16x32_bf16 v[106:109], v[162:165], v[194:197], v[106:109]
    ds_read_b128 v[146:149], v29 offset:24576
    v_mfma_f32_16x16x32_bf16 v[114:117], v[154:157], v[190:193], v[114:117]
    ds_read_b64_tr_b16 v[182:183], v35 offset:8192
    v_mfma_f32_16x16x32_bf16 v[114:117], v[166:169], v[194:197], v[114:117]
    ds_read_b64_tr_b16 v[184:185], v35 offset:8704
    v_mfma_f32_16x16x32_bf16 v[122:125], v[158:161], v[190:193], v[122:125]
    ds_read_b64_tr_b16 v[186:187], v35 offset:12288
    ds_read_b64_tr_b16 v[188:189], v35 offset:12800
    v_mfma_f32_16x16x32_bf16 v[122:125], v[170:173], v[194:197], v[122:125]
    ds_read_b64_tr_b16 v[190:191], v34 offset:16384
    s_waitcnt lgkmcnt(10)
    v_mfma_f32_16x16x32_bf16 v[62:65], v[174:177], v[130:133], v[62:65]
    ds_read_b64_tr_b16 v[192:193], v34 offset:16896
    s_waitcnt lgkmcnt(8)
    v_mfma_f32_16x16x32_bf16 v[62:65], v[178:181], v[142:145], v[62:65]
    ds_read_b64_tr_b16 v[194:195], v34 offset:20480
    s_waitcnt lgkmcnt(8)
    v_mfma_f32_16x16x32_bf16 v[70:73], v[174:177], v[134:137], v[70:73]
    ds_read_b64_tr_b16 v[196:197], v34 offset:20992
    s_waitcnt lgkmcnt(8)
    v_mfma_f32_16x16x32_bf16 v[70:73], v[178:181], v[146:149], v[70:73]
    ds_read_b64_tr_b16 v[174:175], v35 offset:16384
    s_waitcnt lgkmcnt(7)
    v_mfma_f32_16x16x32_bf16 v[66:69], v[182:185], v[130:133], v[66:69]
    ds_read_b64_tr_b16 v[176:177], v35 offset:16896
    s_waitcnt lgkmcnt(6)
    v_mfma_f32_16x16x32_bf16 v[66:69], v[186:189], v[142:145], v[66:69]
    ds_read_b64_tr_b16 v[178:179], v35 offset:20480
    v_mfma_f32_16x16x32_bf16 v[74:77], v[182:185], v[134:137], v[74:77]
    ds_read_b64_tr_b16 v[180:181], v35 offset:20992
    v_mfma_f32_16x16x32_bf16 v[74:77], v[186:189], v[146:149], v[74:77]
    ds_read_b128 v[126:129], v28 offset:20480
    s_waitcnt lgkmcnt(7)
    v_mfma_f32_16x16x32_bf16 v[86:89], v[190:193], v[130:133], v[86:89]
    ds_read_b64_tr_b16 v[182:183], v34 offset:24576
    s_waitcnt lgkmcnt(6)
    v_mfma_f32_16x16x32_bf16 v[86:89], v[194:197], v[142:145], v[86:89]
    ds_read_b64_tr_b16 v[184:185], v34 offset:25088
    v_mfma_f32_16x16x32_bf16 v[94:97], v[190:193], v[134:137], v[94:97]
    ds_read_b128 v[138:141], v29 offset:20480
    ds_read_b64_tr_b16 v[186:187], v34 offset:28672
    v_mfma_f32_16x16x32_bf16 v[94:97], v[194:197], v[146:149], v[94:97]
    ds_read_b64_tr_b16 v[188:189], v34 offset:29184
    s_waitcnt lgkmcnt(8)
    v_mfma_f32_16x16x32_bf16 v[90:93], v[174:177], v[130:133], v[90:93]
    ds_read_b64_tr_b16 v[190:191], v35 offset:24576
    s_waitcnt lgkmcnt(7)
    v_mfma_f32_16x16x32_bf16 v[90:93], v[178:181], v[142:145], v[90:93]
    ds_read_b64_tr_b16 v[192:193], v35 offset:25088
    v_mfma_f32_16x16x32_bf16 v[98:101], v[174:177], v[134:137], v[98:101]
    ds_read_b64_tr_b16 v[194:195], v35 offset:28672
    v_mfma_f32_16x16x32_bf16 v[98:101], v[178:181], v[146:149], v[98:101]
    ds_read_b64_tr_b16 v[196:197], v35 offset:29184
    s_waitcnt lgkmcnt(7)
    v_mfma_f32_16x16x32_bf16 v[102:105], v[126:129], v[182:185], v[102:105]
    s_waitcnt lgkmcnt(4)
    v_mfma_f32_16x16x32_bf16 v[102:105], v[138:141], v[186:189], v[102:105]
    v_mfma_f32_16x16x32_bf16 v[110:113], v[130:133], v[182:185], v[110:113]
    v_mfma_f32_16x16x32_bf16 v[110:113], v[142:145], v[186:189], v[110:113]
    s_waitcnt lgkmcnt(0)
    s_barrier
    ds_read_b128 v[154:157], v28 offset:32768
    ds_read_b64_tr_b16 v[174:175], v34 offset:32768
    ds_read_b64_tr_b16 v[176:177], v34 offset:33280
    ds_read_b128 v[166:169], v29 offset:32768
    v_mfma_f32_16x16x32_bf16 v[118:121], v[134:137], v[182:185], v[118:121]
    ds_read_b64_tr_b16 v[178:179], v34 offset:36864
    v_mfma_f32_16x16x32_bf16 v[118:121], v[146:149], v[186:189], v[118:121]
    ds_read_b64_tr_b16 v[180:181], v34 offset:37376
    v_mfma_f32_16x16x32_bf16 v[106:109], v[126:129], v[190:193], v[106:109]
    ds_read_b128 v[158:161], v28 offset:34816
    v_mfma_f32_16x16x32_bf16 v[106:109], v[138:141], v[194:197], v[106:109]
    ds_read_b128 v[170:173], v29 offset:34816
    v_mfma_f32_16x16x32_bf16 v[114:117], v[130:133], v[190:193], v[114:117]
    ds_read_b64_tr_b16 v[182:183], v35 offset:32768
    v_mfma_f32_16x16x32_bf16 v[114:117], v[142:145], v[194:197], v[114:117]
    ds_read_b64_tr_b16 v[184:185], v35 offset:33280
    v_mfma_f32_16x16x32_bf16 v[122:125], v[134:137], v[190:193], v[122:125]
    ds_read_b64_tr_b16 v[186:187], v35 offset:36864
    ds_read_b64_tr_b16 v[188:189], v35 offset:37376
    v_mfma_f32_16x16x32_bf16 v[122:125], v[146:149], v[194:197], v[122:125]
    ds_read_b64_tr_b16 v[190:191], v32 offset:0
    s_waitcnt lgkmcnt(10)
    v_mfma_f32_16x16x32_bf16 v[62:65], v[174:177], v[154:157], v[62:65]
    ds_read_b64_tr_b16 v[192:193], v32 offset:512
    s_waitcnt lgkmcnt(8)
    v_mfma_f32_16x16x32_bf16 v[62:65], v[178:181], v[166:169], v[62:65]
    ds_read_b64_tr_b16 v[194:195], v32 offset:4096
    s_waitcnt lgkmcnt(8)
    v_mfma_f32_16x16x32_bf16 v[70:73], v[174:177], v[158:161], v[70:73]
    ds_read_b64_tr_b16 v[196:197], v32 offset:4608
    s_waitcnt lgkmcnt(8)
    v_mfma_f32_16x16x32_bf16 v[70:73], v[178:181], v[170:173], v[70:73]
    ds_read_b64_tr_b16 v[174:175], v33 offset:0
    s_waitcnt lgkmcnt(7)
    v_mfma_f32_16x16x32_bf16 v[66:69], v[182:185], v[154:157], v[66:69]
    ds_read_b64_tr_b16 v[176:177], v33 offset:512
    s_waitcnt lgkmcnt(6)
    v_mfma_f32_16x16x32_bf16 v[66:69], v[186:189], v[166:169], v[66:69]
    ds_read_b64_tr_b16 v[178:179], v33 offset:4096
    v_mfma_f32_16x16x32_bf16 v[74:77], v[182:185], v[158:161], v[74:77]
    ds_read_b64_tr_b16 v[180:181], v33 offset:4608
    v_mfma_f32_16x16x32_bf16 v[74:77], v[186:189], v[170:173], v[74:77]
    ds_read_b128 v[150:153], v28 offset:30720
    s_waitcnt lgkmcnt(7)
    v_mfma_f32_16x16x32_bf16 v[86:89], v[190:193], v[154:157], v[86:89]
    ds_read_b64_tr_b16 v[182:183], v32 offset:8192
    s_waitcnt lgkmcnt(6)
    v_mfma_f32_16x16x32_bf16 v[86:89], v[194:197], v[166:169], v[86:89]
    ds_read_b64_tr_b16 v[184:185], v32 offset:8704
    v_mfma_f32_16x16x32_bf16 v[94:97], v[190:193], v[158:161], v[94:97]
    ds_read_b128 v[162:165], v29 offset:30720
    ds_read_b64_tr_b16 v[186:187], v32 offset:12288
    v_mfma_f32_16x16x32_bf16 v[94:97], v[194:197], v[170:173], v[94:97]
    ds_read_b64_tr_b16 v[188:189], v32 offset:12800
    s_waitcnt lgkmcnt(8)
    v_mfma_f32_16x16x32_bf16 v[90:93], v[174:177], v[154:157], v[90:93]
    ds_read_b64_tr_b16 v[190:191], v33 offset:8192
    s_waitcnt lgkmcnt(7)
    v_mfma_f32_16x16x32_bf16 v[90:93], v[178:181], v[166:169], v[90:93]
    ds_read_b64_tr_b16 v[192:193], v33 offset:8704
    v_mfma_f32_16x16x32_bf16 v[98:101], v[174:177], v[158:161], v[98:101]
    ds_read_b64_tr_b16 v[194:195], v33 offset:12288
    v_mfma_f32_16x16x32_bf16 v[98:101], v[178:181], v[170:173], v[98:101]
    ds_read_b64_tr_b16 v[196:197], v33 offset:12800
    s_waitcnt lgkmcnt(7)
    v_mfma_f32_16x16x32_bf16 v[102:105], v[150:153], v[182:185], v[102:105]
    s_waitcnt lgkmcnt(4)
    v_mfma_f32_16x16x32_bf16 v[102:105], v[162:165], v[186:189], v[102:105]
    v_mfma_f32_16x16x32_bf16 v[110:113], v[154:157], v[182:185], v[110:113]
    v_mfma_f32_16x16x32_bf16 v[110:113], v[166:169], v[186:189], v[110:113]
    s_waitcnt lgkmcnt(0)
    s_barrier
    ds_read_b128 v[130:133], v30 offset:2048
    ds_read_b64_tr_b16 v[174:175], v32 offset:16384
    ds_read_b64_tr_b16 v[176:177], v32 offset:16896
    ds_read_b128 v[142:145], v31 offset:2048
    v_mfma_f32_16x16x32_bf16 v[118:121], v[158:161], v[182:185], v[118:121]
    ds_read_b64_tr_b16 v[178:179], v32 offset:20480
    v_mfma_f32_16x16x32_bf16 v[118:121], v[170:173], v[186:189], v[118:121]
    ds_read_b64_tr_b16 v[180:181], v32 offset:20992
    v_mfma_f32_16x16x32_bf16 v[106:109], v[150:153], v[190:193], v[106:109]
    ds_read_b128 v[134:137], v30 offset:4096
    v_mfma_f32_16x16x32_bf16 v[106:109], v[162:165], v[194:197], v[106:109]
    ds_read_b128 v[146:149], v31 offset:4096
    v_mfma_f32_16x16x32_bf16 v[114:117], v[154:157], v[190:193], v[114:117]
    ds_read_b64_tr_b16 v[182:183], v33 offset:16384
    v_mfma_f32_16x16x32_bf16 v[114:117], v[166:169], v[194:197], v[114:117]
    ds_read_b64_tr_b16 v[184:185], v33 offset:16896
    v_mfma_f32_16x16x32_bf16 v[122:125], v[158:161], v[190:193], v[122:125]
    ds_read_b64_tr_b16 v[186:187], v33 offset:20480
    ds_read_b64_tr_b16 v[188:189], v33 offset:20992
    v_mfma_f32_16x16x32_bf16 v[122:125], v[170:173], v[194:197], v[122:125]
    ds_read_b64_tr_b16 v[190:191], v32 offset:24576
    s_waitcnt lgkmcnt(10)
    v_mfma_f32_16x16x32_bf16 v[62:65], v[174:177], v[130:133], v[62:65]
    ds_read_b64_tr_b16 v[192:193], v32 offset:25088
    s_waitcnt lgkmcnt(8)
    v_mfma_f32_16x16x32_bf16 v[62:65], v[178:181], v[142:145], v[62:65]
    ds_read_b64_tr_b16 v[194:195], v32 offset:28672
    s_waitcnt lgkmcnt(8)
    v_mfma_f32_16x16x32_bf16 v[70:73], v[174:177], v[134:137], v[70:73]
    ds_read_b64_tr_b16 v[196:197], v32 offset:29184
    s_waitcnt lgkmcnt(8)
    v_mfma_f32_16x16x32_bf16 v[70:73], v[178:181], v[146:149], v[70:73]
    ds_read_b64_tr_b16 v[174:175], v33 offset:24576
    s_waitcnt lgkmcnt(7)
    v_mfma_f32_16x16x32_bf16 v[66:69], v[182:185], v[130:133], v[66:69]
    ds_read_b64_tr_b16 v[176:177], v33 offset:25088
    s_waitcnt lgkmcnt(6)
    v_mfma_f32_16x16x32_bf16 v[66:69], v[186:189], v[142:145], v[66:69]
    ds_read_b64_tr_b16 v[178:179], v33 offset:28672
    v_mfma_f32_16x16x32_bf16 v[74:77], v[182:185], v[134:137], v[74:77]
    ds_read_b64_tr_b16 v[180:181], v33 offset:29184
    v_mfma_f32_16x16x32_bf16 v[74:77], v[186:189], v[146:149], v[74:77]
    ds_read_b128 v[126:129], v30 offset:0
    s_waitcnt lgkmcnt(7)
    v_mfma_f32_16x16x32_bf16 v[86:89], v[190:193], v[130:133], v[86:89]
    ds_read_b64_tr_b16 v[182:183], v32 offset:32768
    s_waitcnt lgkmcnt(6)
    v_mfma_f32_16x16x32_bf16 v[86:89], v[194:197], v[142:145], v[86:89]
    ds_read_b64_tr_b16 v[184:185], v32 offset:33280
    v_mfma_f32_16x16x32_bf16 v[94:97], v[190:193], v[134:137], v[94:97]
    ds_read_b128 v[138:141], v31 offset:0
    ds_read_b64_tr_b16 v[186:187], v32 offset:36864
    v_mfma_f32_16x16x32_bf16 v[94:97], v[194:197], v[146:149], v[94:97]
    ds_read_b64_tr_b16 v[188:189], v32 offset:37376
    s_waitcnt lgkmcnt(8)
    v_mfma_f32_16x16x32_bf16 v[90:93], v[174:177], v[130:133], v[90:93]
    ds_read_b64_tr_b16 v[190:191], v33 offset:32768
    s_waitcnt lgkmcnt(7)
    v_mfma_f32_16x16x32_bf16 v[90:93], v[178:181], v[142:145], v[90:93]
    ds_read_b64_tr_b16 v[192:193], v33 offset:33280
    v_mfma_f32_16x16x32_bf16 v[98:101], v[174:177], v[134:137], v[98:101]
    ds_read_b64_tr_b16 v[194:195], v33 offset:36864
    v_mfma_f32_16x16x32_bf16 v[98:101], v[178:181], v[146:149], v[98:101]
    ds_read_b64_tr_b16 v[196:197], v33 offset:37376
    s_waitcnt lgkmcnt(7)
    v_mfma_f32_16x16x32_bf16 v[102:105], v[126:129], v[182:185], v[102:105]
    s_waitcnt lgkmcnt(4)
    v_mfma_f32_16x16x32_bf16 v[102:105], v[138:141], v[186:189], v[102:105]
    v_mfma_f32_16x16x32_bf16 v[110:113], v[130:133], v[182:185], v[110:113]
    v_mfma_f32_16x16x32_bf16 v[110:113], v[142:145], v[186:189], v[110:113]
    s_waitcnt lgkmcnt(0)
    s_barrier
    ds_read_b128 v[154:157], v30 offset:12288
    ds_read_b64_tr_b16 v[174:175], v32 offset:40960
    ds_read_b64_tr_b16 v[176:177], v32 offset:41472
    ds_read_b128 v[166:169], v31 offset:12288
    v_mfma_f32_16x16x32_bf16 v[118:121], v[134:137], v[182:185], v[118:121]
    ds_read_b64_tr_b16 v[178:179], v32 offset:45056
    v_mfma_f32_16x16x32_bf16 v[118:121], v[146:149], v[186:189], v[118:121]
    ds_read_b64_tr_b16 v[180:181], v32 offset:45568
    v_mfma_f32_16x16x32_bf16 v[106:109], v[126:129], v[190:193], v[106:109]
    ds_read_b128 v[158:161], v30 offset:14336
    v_mfma_f32_16x16x32_bf16 v[106:109], v[138:141], v[194:197], v[106:109]
    ds_read_b128 v[170:173], v31 offset:14336
    v_mfma_f32_16x16x32_bf16 v[114:117], v[130:133], v[190:193], v[114:117]
    ds_read_b64_tr_b16 v[182:183], v33 offset:40960
    v_mfma_f32_16x16x32_bf16 v[114:117], v[142:145], v[194:197], v[114:117]
    ds_read_b64_tr_b16 v[184:185], v33 offset:41472
    v_mfma_f32_16x16x32_bf16 v[122:125], v[134:137], v[190:193], v[122:125]
    ds_read_b64_tr_b16 v[186:187], v33 offset:45056
    ds_read_b64_tr_b16 v[188:189], v33 offset:45568
    v_mfma_f32_16x16x32_bf16 v[122:125], v[146:149], v[194:197], v[122:125]
    ds_read_b64_tr_b16 v[190:191], v34 offset:0
    s_waitcnt lgkmcnt(10)
    v_mfma_f32_16x16x32_bf16 v[62:65], v[174:177], v[154:157], v[62:65]
    ds_read_b64_tr_b16 v[192:193], v34 offset:512
    s_waitcnt lgkmcnt(8)
    v_mfma_f32_16x16x32_bf16 v[62:65], v[178:181], v[166:169], v[62:65]
    ds_read_b64_tr_b16 v[194:195], v34 offset:4096
    s_waitcnt lgkmcnt(8)
    v_mfma_f32_16x16x32_bf16 v[70:73], v[174:177], v[158:161], v[70:73]
    ds_read_b64_tr_b16 v[196:197], v34 offset:4608
    s_waitcnt lgkmcnt(8)
    v_mfma_f32_16x16x32_bf16 v[70:73], v[178:181], v[170:173], v[70:73]
    ds_read_b64_tr_b16 v[174:175], v35 offset:0
    s_waitcnt lgkmcnt(7)
    v_mfma_f32_16x16x32_bf16 v[66:69], v[182:185], v[154:157], v[66:69]
    ds_read_b64_tr_b16 v[176:177], v35 offset:512
    s_waitcnt lgkmcnt(6)
    v_mfma_f32_16x16x32_bf16 v[66:69], v[186:189], v[166:169], v[66:69]
    ds_read_b64_tr_b16 v[178:179], v35 offset:4096
    v_mfma_f32_16x16x32_bf16 v[74:77], v[182:185], v[158:161], v[74:77]
    ds_read_b64_tr_b16 v[180:181], v35 offset:4608
    v_mfma_f32_16x16x32_bf16 v[74:77], v[186:189], v[170:173], v[74:77]
    ds_read_b128 v[150:153], v30 offset:10240
    s_waitcnt lgkmcnt(7)
    v_mfma_f32_16x16x32_bf16 v[86:89], v[190:193], v[154:157], v[86:89]
    ds_read_b64_tr_b16 v[182:183], v34 offset:8192
    s_waitcnt lgkmcnt(6)
    v_mfma_f32_16x16x32_bf16 v[86:89], v[194:197], v[166:169], v[86:89]
    ds_read_b64_tr_b16 v[184:185], v34 offset:8704
    v_mfma_f32_16x16x32_bf16 v[94:97], v[190:193], v[158:161], v[94:97]
    ds_read_b128 v[162:165], v31 offset:10240
    ds_read_b64_tr_b16 v[186:187], v34 offset:12288
    v_mfma_f32_16x16x32_bf16 v[94:97], v[194:197], v[170:173], v[94:97]
    ds_read_b64_tr_b16 v[188:189], v34 offset:12800
    s_waitcnt lgkmcnt(8)
    v_mfma_f32_16x16x32_bf16 v[90:93], v[174:177], v[154:157], v[90:93]
    ds_read_b64_tr_b16 v[190:191], v35 offset:8192
    s_waitcnt lgkmcnt(7)
    v_mfma_f32_16x16x32_bf16 v[90:93], v[178:181], v[166:169], v[90:93]
    ds_read_b64_tr_b16 v[192:193], v35 offset:8704
    v_mfma_f32_16x16x32_bf16 v[98:101], v[174:177], v[158:161], v[98:101]
    ds_read_b64_tr_b16 v[194:195], v35 offset:12288
    v_mfma_f32_16x16x32_bf16 v[98:101], v[178:181], v[170:173], v[98:101]
    ds_read_b64_tr_b16 v[196:197], v35 offset:12800
    s_waitcnt lgkmcnt(7)
    v_mfma_f32_16x16x32_bf16 v[102:105], v[150:153], v[182:185], v[102:105]
    s_waitcnt lgkmcnt(4)
    v_mfma_f32_16x16x32_bf16 v[102:105], v[162:165], v[186:189], v[102:105]
    v_mfma_f32_16x16x32_bf16 v[110:113], v[154:157], v[182:185], v[110:113]
    v_mfma_f32_16x16x32_bf16 v[110:113], v[166:169], v[186:189], v[110:113]
    v_mfma_f32_16x16x32_bf16 v[118:121], v[158:161], v[182:185], v[118:121]
    v_mfma_f32_16x16x32_bf16 v[118:121], v[170:173], v[186:189], v[118:121]
    s_waitcnt lgkmcnt(2)
    v_mfma_f32_16x16x32_bf16 v[106:109], v[150:153], v[190:193], v[106:109]
    s_waitcnt lgkmcnt(0)
    v_mfma_f32_16x16x32_bf16 v[106:109], v[162:165], v[194:197], v[106:109]
    v_mfma_f32_16x16x32_bf16 v[114:117], v[154:157], v[190:193], v[114:117]
    v_mfma_f32_16x16x32_bf16 v[114:117], v[166:169], v[194:197], v[114:117]
    v_mfma_f32_16x16x32_bf16 v[122:125], v[158:161], v[190:193], v[122:125]
    s_barrier
    ds_read_b128 v[130:133], v30 offset:22528
    ds_read_b64_tr_b16 v[174:175], v34 offset:16384
    ds_read_b64_tr_b16 v[176:177], v34 offset:16896
    ds_read_b128 v[142:145], v31 offset:22528
    ds_read_b64_tr_b16 v[178:179], v34 offset:20480
    ds_read_b64_tr_b16 v[180:181], v34 offset:20992
    ds_read_b128 v[134:137], v30 offset:24576
    ds_read_b128 v[146:149], v31 offset:24576
    ds_read_b64_tr_b16 v[182:183], v35 offset:16384
    ds_read_b64_tr_b16 v[184:185], v35 offset:16896
    ds_read_b64_tr_b16 v[186:187], v35 offset:20480
    ds_read_b64_tr_b16 v[188:189], v35 offset:20992
    ds_read_b64_tr_b16 v[198:199], v34 offset:24576
    v_mfma_f32_16x16x32_bf16 v[122:125], v[170:173], v[194:197], v[122:125]
    ds_read_b64_tr_b16 v[200:201], v34 offset:25088
    s_waitcnt lgkmcnt(11)
    v_mfma_f32_16x16x32_bf16 v[62:65], v[174:177], v[130:133], v[62:65]
    ds_read_b64_tr_b16 v[202:203], v34 offset:28672
    s_waitcnt lgkmcnt(9)
    v_mfma_f32_16x16x32_bf16 v[62:65], v[178:181], v[142:145], v[62:65]
    ds_read_b64_tr_b16 v[204:205], v34 offset:29184
    s_waitcnt lgkmcnt(9)
    v_mfma_f32_16x16x32_bf16 v[70:73], v[174:177], v[134:137], v[70:73]
    ds_read_b64_tr_b16 v[190:191], v35 offset:24576
    s_waitcnt lgkmcnt(9)
    v_mfma_f32_16x16x32_bf16 v[70:73], v[178:181], v[146:149], v[70:73]
    ds_read_b64_tr_b16 v[192:193], v35 offset:25088
    s_waitcnt lgkmcnt(8)
    v_mfma_f32_16x16x32_bf16 v[66:69], v[182:185], v[130:133], v[66:69]
    ds_read_b64_tr_b16 v[194:195], v35 offset:28672
    ds_read_b64_tr_b16 v[196:197], v35 offset:29184
    v_cvt_pk_bf16_f32 v150, v62, v63
    v_cvt_pk_bf16_f32 v151, v64, v65
    s_waitcnt lgkmcnt(8)
    v_mfma_f32_16x16x32_bf16 v[66:69], v[186:189], v[142:145], v[66:69]
    ds_read_b128 v[126:129], v30 offset:20480
    v_cndmask_b32 v158, 0, v150, s[54:55]
    v_cndmask_b32 v150, v150, 0, s[54:55]
    v_mfma_f32_16x16x32_bf16 v[74:77], v[182:185], v[134:137], v[74:77]
    ds_read_b128 v[138:141], v31 offset:20480
    v_cndmask_b32 v159, 0, v151, s[54:55]
    v_cndmask_b32 v151, v151, 0, s[54:55]
    v_mfma_f32_16x16x32_bf16 v[74:77], v[186:189], v[146:149], v[74:77]
    ds_read_b32 v40, v5 offset:4
    v_cvt_pk_bf16_f32 v154, v70, v71
    v_cvt_pk_bf16_f32 v155, v72, v73
    s_waitcnt lgkmcnt(9)
    v_mfma_f32_16x16x32_bf16 v[86:89], v[198:201], v[130:133], v[86:89]
    v_cndmask_b32 v162, 0, v154, s[54:55]
    v_cndmask_b32 v154, v154, 0, s[54:55]
    s_waitcnt lgkmcnt(7)
    v_mfma_f32_16x16x32_bf16 v[86:89], v[202:205], v[142:145], v[86:89]
    v_cndmask_b32 v163, 0, v155, s[54:55]
    v_cndmask_b32 v155, v155, 0, s[54:55]
    s_waitcnt lgkmcnt(5)
    v_mfma_f32_16x16x32_bf16 v[90:93], v[190:193], v[130:133], v[90:93]
    v_cvt_pk_bf16_f32 v152, v66, v67
    v_cvt_pk_bf16_f32 v153, v68, v69
    s_waitcnt lgkmcnt(3)
    v_mfma_f32_16x16x32_bf16 v[90:93], v[194:197], v[142:145], v[90:93]
    v_cndmask_b32 v160, 0, v152, s[56:57]
    v_cndmask_b32 v152, v152, 0, s[56:57]
    v_mfma_f32_16x16x32_bf16 v[94:97], v[198:201], v[134:137], v[94:97]
    v_cndmask_b32 v161, 0, v153, s[56:57]
    v_cndmask_b32 v153, v153, 0, s[56:57]
    v_mfma_f32_16x16x32_bf16 v[94:97], v[202:205], v[146:149], v[94:97]
    v_cvt_pk_bf16_f32 v156, v74, v75
    v_cvt_pk_bf16_f32 v157, v76, v77
    v_mfma_f32_16x16x32_bf16 v[98:101], v[190:193], v[134:137], v[98:101]
    v_cndmask_b32 v164, 0, v156, s[56:57]
    v_cndmask_b32 v156, v156, 0, s[56:57]
    v_mfma_f32_16x16x32_bf16 v[98:101], v[194:197], v[146:149], v[98:101]
    v_cndmask_b32 v165, 0, v157, s[56:57]
    v_cndmask_b32 v157, v157, 0, s[56:57]
    ds_read_b32 v48, v220 offset:56
    ds_read_b128 v[226:229], v218
    v_cvt_pk_bf16_f32 v230, v86, v87
    v_cvt_pk_bf16_f32 v231, v88, v89
    v_cvt_pk_bf16_f32 v232, v90, v91
    v_cvt_pk_bf16_f32 v233, v92, v93
    s_nop 1
    v_mfma_f32_16x16x32_bf16 v[66:69], v[230:233], v[150:153], 0
    v_mfma_f32_16x16x32_bf16 v[70:73], v[230:233], v[154:157], 0
    v_cvt_pk_bf16_f32 v234, v94, v95
    v_cvt_pk_bf16_f32 v235, v96, v97
    v_cvt_pk_bf16_f32 v236, v98, v99
    v_cvt_pk_bf16_f32 v237, v100, v101
    s_nop 1
    v_mfma_f32_16x16x32_bf16 v[74:77], v[234:237], v[154:157], 0
    v_mfma_f32_16x16x32_bf16 v[178:181], v[230:233], v[158:161], 0
    v_mfma_f32_16x16x32_bf16 v[182:185], v[230:233], v[162:165], 0
    v_mfma_f32_16x16x32_bf16 v[186:189], v[234:237], v[162:165], 0
    s_waitcnt lgkmcnt(0)
    v_cmp_ne_u32 vcc, 0, v48
    s_nop 0
    s_cbranch_vccnz D_dK
    s_mov_b32 s9, 0
D_lK:
    ds_read_b32 v48, v220 offset:56
    ds_read_b128 v[226:229], v218
    s_add_u32 s9, s9, 1
    s_cmp_gt_u32 s9, 1600000
    s_waitcnt lgkmcnt(0)
    s_cbranch_scc1 D_dK
    v_cmp_eq_u32 vcc, 0, v48
    s_nop 0
    s_cbranch_vccnz D_lK
            D_dK:

    v_mfma_f32_16x16x32_bf16 v[62:65], v[226:229], v[150:153], 0
    v_mfma_f32_16x16x32_bf16 v[174:177], v[226:229], v[158:161], 0
    v_readfirstlane_b32 s63, v40
    v_cndmask_b32 v74, v74, v75, s[44:45]
    ds_read_b32 v40, v5 offset:32
    v_cndmask_b32 v76, v76, v77, s[44:45]
    ds_read_b64_tr_b16 v[166:167], v34 offset:32768
    v_cndmask_b32 v70, v70, v71, s[44:45]
    ds_read_b64_tr_b16 v[168:169], v34 offset:33280
    v_cndmask_b32 v72, v72, v73, s[44:45]
    ds_read_b64_tr_b16 v[170:171], v35 offset:32768
    v_cndmask_b32 v212, v70, v74, s[46:47]
    ds_read_b64_tr_b16 v[172:173], v35 offset:33280
    v_cndmask_b32 v213, v72, v76, s[48:49]
    ds_read_b64_tr_b16 v[198:199], v34 offset:36864
    v_cndmask_b32 v66, v66, v67, s[44:45]
    ds_read_b64_tr_b16 v[200:201], v34 offset:37376
    v_cndmask_b32 v68, v68, v69, s[44:45]
    ds_read_b64_tr_b16 v[202:203], v35 offset:36864
    v_cndmask_b32 v62, v62, v63, s[44:45]
    ds_read_b64_tr_b16 v[204:205], v35 offset:37376
    v_cndmask_b32 v64, v64, v65, s[44:45]
    v_cndmask_b32 v210, v62, v66, s[46:47]
    v_cndmask_b32 v211, v64, v68, s[48:49]
    v_and_or_b32 v94, v210, v46, v50
    v_and_or_b32 v95, v211, v46, v51
    v_and_or_b32 v96, v212, v46, v52
    v_and_or_b32 v97, v213, v46, v53
    s_cmp_lg_u32 s101, 0
    s_cbranch_scc1 SM_jS1
    s_cmp_eq_u32 s63, 0
    s_cbranch_scc1 SM_sS1
    buffer_store_dwordx4 v[94:97], v4, s[36:39], s15 offen
SM_jS1:
    v_cndmask_b32 v186, v186, v187, s[44:45]
    v_cndmask_b32 v188, v188, v189, s[44:45]
    v_cndmask_b32 v182, v182, v183, s[44:45]
    v_cndmask_b32 v184, v184, v185, s[44:45]
    v_cndmask_b32 v208, v182, v186, s[46:47]
    v_cndmask_b32 v209, v184, v188, s[48:49]
    v_cndmask_b32 v178, v178, v179, s[44:45]
    v_cndmask_b32 v180, v180, v181, s[44:45]
    v_cndmask_b32 v174, v174, v175, s[44:45]
    v_cndmask_b32 v176, v176, v177, s[44:45]
    v_cndmask_b32 v206, v174, v178, s[46:47]
    v_cndmask_b32 v207, v176, v180, s[48:49]
    ds_write_b128 v42, v[206:209]
    ds_write_b32 v47, v5 offset:16
    s_waitcnt lgkmcnt(10)
    v_cmp_gt_u32 vcc, 4, v40
    s_nop 0
    s_cbranch_vccnz C_vr1
C_vd1:
    s_waitcnt lgkmcnt(8)
    v_mfma_f32_16x16x32_bf16 v[102:105], v[126:129], v[166:169], v[102:105]
    s_waitcnt lgkmcnt(4)
    v_mfma_f32_16x16x32_bf16 v[102:105], v[138:141], v[198:201], v[102:105]
    v_mfma_f32_16x16x32_bf16 v[106:109], v[126:129], v[170:173], v[106:109]
    s_waitcnt lgkmcnt(2)
    v_mfma_f32_16x16x32_bf16 v[106:109], v[138:141], v[202:205], v[106:109]
    v_mfma_f32_16x16x32_bf16 v[110:113], v[130:133], v[166:169], v[110:113]
    v_mfma_f32_16x16x32_bf16 v[110:113], v[142:145], v[198:201], v[110:113]
    v_mfma_f32_16x16x32_bf16 v[114:117], v[130:133], v[170:173], v[114:117]
    s_nop 1
    v_cvt_pk_bf16_f32 v226, v102, v103
    v_cvt_pk_bf16_f32 v227, v104, v105
    v_mfma_f32_16x16x32_bf16 v[114:117], v[142:145], v[202:205], v[114:117]
    v_cvt_pk_bf16_f32 v232, v106, v107
    v_cvt_pk_bf16_f32 v233, v108, v109
    ds_write2_b64 v219, v[226:227], v[232:233] offset1:1
    ds_write_b32 v221, v5
    v_mfma_f32_16x16x32_bf16 v[118:121], v[134:137], v[166:169], v[118:121]
    v_mfma_f32_16x16x32_bf16 v[118:121], v[146:149], v[198:201], v[118:121]
    v_mfma_f32_16x16x32_bf16 v[122:125], v[134:137], v[170:173], v[122:125]
    v_cvt_pk_bf16_f32 v228, v110, v111
    v_cvt_pk_bf16_f32 v229, v112, v113
    v_mfma_f32_16x16x32_bf16 v[122:125], v[146:149], v[202:205], v[122:125]
    v_cvt_pk_bf16_f32 v234, v114, v115
    v_cvt_pk_bf16_f32 v235, v116, v117
    v_cndmask_b32 v126, 0, v226, s[58:59]
    v_cndmask_b32 v226, v226, 0, s[58:59]
    v_cndmask_b32 v127, 0, v227, s[58:59]
    v_cndmask_b32 v227, v227, 0, s[58:59]
    v_cndmask_b32 v132, 0, v232, s[60:61]
    v_cndmask_b32 v232, v232, 0, s[60:61]
    v_cndmask_b32 v133, 0, v233, s[60:61]
    v_cndmask_b32 v233, v233, 0, s[60:61]
    buffer_load_dwordx4 v[214:217], v4, s[36:39], s100 offen sc1
    v_cvt_pk_bf16_f32 v230, v118, v119
    v_cvt_pk_bf16_f32 v231, v120, v121
    v_cvt_pk_bf16_f32 v236, v122, v123
    v_cvt_pk_bf16_f32 v237, v124, v125
    v_cndmask_b32 v128, 0, v228, s[58:59]
    v_cndmask_b32 v228, v228, 0, s[58:59]
    v_cndmask_b32 v129, 0, v229, s[58:59]
    v_cndmask_b32 v229, v229, 0, s[58:59]
    v_cndmask_b32 v134, 0, v234, s[60:61]
    v_cndmask_b32 v234, v234, 0, s[60:61]
    v_cndmask_b32 v135, 0, v235, s[60:61]
    v_cndmask_b32 v235, v235, 0, s[60:61]
    v_cndmask_b32 v130, 0, v230, s[58:59]
    v_cndmask_b32 v230, v230, 0, s[58:59]
    v_cndmask_b32 v131, 0, v231, s[58:59]
    v_cndmask_b32 v231, v231, 0, s[58:59]
    v_cndmask_b32 v136, 0, v236, s[60:61]
    v_cndmask_b32 v236, v236, 0, s[60:61]
    v_cndmask_b32 v137, 0, v237, s[60:61]
    v_cndmask_b32 v237, v237, 0, s[60:61]
    s_waitcnt lgkmcnt(0)
C_join:
    s_mov_b32 s9, 0
    s_add_u32 s19, s100, 14336
    s_cmp_lg_u32 s101, 0
    s_cbranch_scc1 C_sv
    s_mov_b32 s40, 0x0c0c0400
    s_mov_b32 s41, 0x05040100
        C_sl:
    s_waitcnt vmcnt(0)
    v_perm_b32 v2, v215, v214, s40
    v_perm_b32 v3, v217, v216, s40
    v_and_b32 v214, v46, v214
    v_perm_b32 v2, v3, v2, s41
    v_and_b32 v215, v46, v215
    v_cmp_ne_u32 vcc, s12, v2
    v_and_b32 v216, v46, v216
    v_and_b32 v217, v46, v217
    s_cbranch_vccnz C_sr
        C_sk:

    v_pk_add_f32 v[210:211], v[210:211], v[214:215]
    v_pk_add_f32 v[212:213], v[212:213], v[216:217]
C_sv:
    v_max_f32 v222, v210, v211
    v_max_f32 v223, v212, v213
    v_mov_b32 v224, v222
    v_mov_b32 v225, v223
    s_nop 0
    v_permlane16_swap_b32 v222, v224
    v_permlane16_swap_b32 v223, v225
    v_max_f32 v222, v222, v224
    v_max_f32 v223, v223, v225
    v_mov_b32 v224, v222
    v_mov_b32 v225, v223
    s_nop 0
    v_permlane32_swap_b32 v222, v224
    v_permlane32_swap_b32 v223, v225
    v_max_f32 v222, v222, v224
    v_max_f32 v223, v223, v225
    v_mul_f32 v222, s0, v222
    v_mul_f32 v223, s0, v223
    v_fma_f32 v210, v210, s0, -v222
    v_fma_f32 v211, v211, s0, -v222
    v_fma_f32 v212, v212, s0, -v223
    v_fma_f32 v213, v213, s0, -v223
    v_exp_f32 v210, v210
    v_exp_f32 v211, v211
    v_exp_f32 v212, v212
    v_exp_f32 v213, v213
    v_add_f32 v222, v210, v211
    v_add_f32 v223, v212, v213
    v_mov_b32 v224, v222
    v_mov_b32 v225, v223
    ds_read_b32 v48, v47 offset:40
    ds_read_b128 v[78:81], v43 offset:49152
    ds_read_b128 v[82:85], v43 offset:50176
    ds_read_b32 v7, v5 offset:12
    v_permlane16_swap_b32 v222, v224
    v_permlane16_swap_b32 v223, v225
    v_add_f32 v222, v222, v224
    v_add_f32 v223, v223, v225
    v_mov_b32 v224, v222
    v_mov_b32 v225, v223
    s_nop 0
    v_permlane32_swap_b32 v222, v224
    v_permlane32_swap_b32 v223, v225
    v_add_f32 v222, v222, v224
    v_add_f32 v223, v223, v225
    v_rcp_f32 v222, v222
    v_rcp_f32 v223, v223
    s_waitcnt lgkmcnt(0)
    v_cmp_eq_u32 vcc, 0, v48
    v_mul_f32 v210, v210, v222
    v_mul_f32 v211, v211, v222
    v_mul_f32 v212, v212, v223
    v_mul_f32 v213, v213, v223
    v_cvt_pk_bf16_f32 v210, v210, v210
    v_cvt_pk_bf16_f32 v211, v211, v211
    v_cvt_pk_bf16_f32 v212, v212, v212
    v_cvt_pk_bf16_f32 v213, v213, v213
    s_cbranch_vccnz C_pr
C_pd:
    v_mfma_f32_16x16x32_bf16 v[62:65], v[126:129], v[78:81], 0
    v_and_b32 v86, v36, v210
    v_and_b32 v87, v37, v211
    v_mfma_f32_16x16x32_bf16 v[66:69], v[132:135], v[78:81], 0
    v_and_b32 v88, v38, v210
    v_and_b32 v89, v39, v211
    v_mfma_f32_16x16x32_bf16 v[70:73], v[128:131], v[82:85], 0
    v_and_b32 v90, v36, v212
    v_and_b32 v91, v37, v213
    v_mfma_f32_16x16x32_bf16 v[74:77], v[134:137], v[82:85], 0
    v_and_b32 v92, v38, v212
    v_and_b32 v93, v39, v213
    v_mfma_f32_16x16x32_bf16 v[62:65], v[226:229], v[86:89], v[62:65]
    v_mfma_f32_16x16x32_bf16 v[66:69], v[232:235], v[86:89], v[66:69]
    v_mfma_f32_16x16x32_bf16 v[70:73], v[228:231], v[90:93], v[70:73]
    v_mfma_f32_16x16x32_bf16 v[74:77], v[234:237], v[90:93], v[74:77]
    s_cmp_eq_u32 s63, 0
    s_cbranch_scc1 SM_sO
    s_nop 2
    v_cvt_pk_bf16_f32 v54, v62, v63
    v_cvt_pk_bf16_f32 v55, v64, v65
    v_cvt_pk_bf16_f32 v56, v66, v67
    v_cvt_pk_bf16_f32 v57, v68, v69
    buffer_store_dwordx4 v[54:57], v4, s[36:39], s100 offen
    v_cvt_pk_bf16_f32 v58, v70, v71
    v_cvt_pk_bf16_f32 v59, v72, v73
    v_cvt_pk_bf16_f32 v60, v74, v75
    v_cvt_pk_bf16_f32 v61, v76, v77
    buffer_store_dwordx4 v[58:61], v4, s[36:39], s19 offen
SM_jO:
    v_cmp_gt_u32 vcc, 4, v7
    s_nop 0
    s_cbranch_vccz W_dW
    s_mov_b32 s9, 0
        W_lW:
    ds_read_b32 v2, v5 offset:12
    s_add_u32 s9, s9, 1
    s_cmp_gt_u32 s9, 1600000
    s_cbranch_scc1 W_dW
    s_waitcnt lgkmcnt(0)
    v_cmp_gt_u32 vcc, 4, v2
    s_nop 0
    s_cbranch_vccnz W_lW
        W_dW:

    ds_read_b64_tr_b16 v[76:77], v16 offset:0
    ds_read_b64_tr_b16 v[78:79], v16 offset:2048
    ds_read_b64_tr_b16 v[80:81], v17 offset:0
    ds_read_b64_tr_b16 v[82:83], v17 offset:2048
    ds_read_b64_tr_b16 v[84:85], v18 offset:0
    ds_read_b64_tr_b16 v[86:87], v18 offset:2048
    ds_read_b64_tr_b16 v[88:89], v19 offset:0
    ds_read_b64_tr_b16 v[90:91], v19 offset:2048
    ds_read_b64_tr_b16 v[92:93], v16 offset:4096
    ds_read_b64_tr_b16 v[94:95], v16 offset:6144
    ds_read_b64_tr_b16 v[96:97], v17 offset:4096
    ds_read_b64_tr_b16 v[98:99], v17 offset:6144
    ds_read_b64_tr_b16 v[100:101], v18 offset:4096
    ds_read_b64_tr_b16 v[102:103], v18 offset:6144
    ds_read_b64_tr_b16 v[104:105], v19 offset:4096
    ds_read_b64_tr_b16 v[106:107], v19 offset:6144
    ds_read_b64_tr_b16 v[108:109], v16 offset:8192
    ds_read_b64_tr_b16 v[110:111], v16 offset:10240
    ds_read_b64_tr_b16 v[112:113], v17 offset:8192
    ds_read_b64_tr_b16 v[114:115], v17 offset:10240
    ds_read_b64_tr_b16 v[116:117], v18 offset:8192
    ds_read_b64_tr_b16 v[118:119], v18 offset:10240
    ds_read_b64_tr_b16 v[120:121], v19 offset:8192
    ds_read_b64_tr_b16 v[122:123], v19 offset:10240
    ds_read_b64_tr_b16 v[124:125], v16 offset:12288
    ds_read_b64_tr_b16 v[126:127], v16 offset:14336
    ds_read_b64_tr_b16 v[128:129], v17 offset:12288
    ds_read_b64_tr_b16 v[130:131], v17 offset:14336
    ds_read_b64_tr_b16 v[132:133], v18 offset:12288
    ds_read_b64_tr_b16 v[134:135], v18 offset:14336
    ds_read_b64_tr_b16 v[136:137], v19 offset:12288
    ds_read_b64_tr_b16 v[138:139], v19 offset:14336
    s_waitcnt vmcnt(0)
    s_mov_b64 exec, 1
    s_cmp_eq_u32 s63, 0
    s_cbranch_scc1 SM_sF
    buffer_store_dwordx2 v[14:15], v6, s[36:39], s21 offen
SM_jF:
    s_mov_b64 exec, -1
    ds_read_b64_tr_b16 v[140:141], v16 offset:16384
    ds_read_b64_tr_b16 v[142:143], v16 offset:18432
    ds_read_b64_tr_b16 v[144:145], v17 offset:16384
    ds_read_b64_tr_b16 v[146:147], v17 offset:18432
    ds_read_b64_tr_b16 v[148:149], v18 offset:16384
    ds_read_b64_tr_b16 v[150:151], v18 offset:18432
    ds_read_b64_tr_b16 v[152:153], v19 offset:16384
    ds_read_b64_tr_b16 v[154:155], v19 offset:18432
    ds_read_b64_tr_b16 v[156:157], v16 offset:20480
    ds_read_b64_tr_b16 v[158:159], v16 offset:22528
    ds_read_b64_tr_b16 v[160:161], v17 offset:20480
    ds_read_b64_tr_b16 v[162:163], v17 offset:22528
    ds_read_b64_tr_b16 v[164:165], v18 offset:20480
    ds_read_b64_tr_b16 v[166:167], v18 offset:22528
    ds_read_b64_tr_b16 v[168:169], v19 offset:20480
    ds_read_b64_tr_b16 v[170:171], v19 offset:22528
    ds_read_b64_tr_b16 v[172:173], v16 offset:24576
    ds_read_b64_tr_b16 v[174:175], v16 offset:26624
    ds_read_b64_tr_b16 v[176:177], v17 offset:24576
    ds_read_b64_tr_b16 v[178:179], v17 offset:26624
    ds_read_b64_tr_b16 v[180:181], v18 offset:24576
    ds_read_b64_tr_b16 v[182:183], v18 offset:26624
    ds_read_b64_tr_b16 v[184:185], v19 offset:24576
    ds_read_b64_tr_b16 v[186:187], v19 offset:26624
    buffer_load_dwordx2 v[12:13], v8, s[36:39], s20 offen sc1
    ds_read_b64_tr_b16 v[188:189], v16 offset:28672
    ds_read_b64_tr_b16 v[190:191], v16 offset:30720
    ds_read_b64_tr_b16 v[192:193], v17 offset:28672
    ds_read_b64_tr_b16 v[194:195], v17 offset:30720
    ds_read_b64_tr_b16 v[196:197], v18 offset:28672
    ds_read_b64_tr_b16 v[198:199], v18 offset:30720
    ds_read_b64_tr_b16 v[200:201], v19 offset:28672
    ds_read_b64_tr_b16 v[202:203], v19 offset:30720
    ds_read_b64_tr_b16 v[204:205], v16 offset:32768
    ds_read_b64_tr_b16 v[206:207], v16 offset:34816
    ds_read_b64_tr_b16 v[208:209], v17 offset:32768
    ds_read_b64_tr_b16 v[210:211], v17 offset:34816
    ds_read_b64_tr_b16 v[212:213], v18 offset:32768
    ds_read_b64_tr_b16 v[214:215], v18 offset:34816
    ds_read_b64_tr_b16 v[216:217], v19 offset:32768
    ds_read_b64_tr_b16 v[218:219], v19 offset:34816
    ds_read_b64_tr_b16 v[220:221], v16 offset:36864
    ds_read_b64_tr_b16 v[222:223], v16 offset:38912
    ds_read_b64_tr_b16 v[224:225], v17 offset:36864
    ds_read_b64_tr_b16 v[226:227], v17 offset:38912
    ds_read_b64_tr_b16 v[228:229], v18 offset:36864
    ds_read_b64_tr_b16 v[230:231], v18 offset:38912
    ds_read_b64_tr_b16 v[232:233], v19 offset:36864
    ds_read_b64_tr_b16 v[234:235], v19 offset:38912
    s_mov_b32 s9, 0
        P_lO:
    s_waitcnt vmcnt(0)
    v_cmp_ne_u64 vcc, s[12:13], v[12:13]
    s_nop 0
    s_cbranch_vccz P_dO
    buffer_load_dwordx2 v[12:13], v8, s[36:39], s20 offen sc1
    s_add_u32 s9, s9, 1
    s_cmp_lt_u32 s9, 200000
    s_cbranch_scc1 P_lO
    s_waitcnt vmcnt(0)
        P_dO:

    buffer_load_dwordx4 v[40:43], v4, s[36:39], s22 offen offset:0 sc1
    buffer_load_dwordx4 v[44:47], v4, s[36:39], s22 offen offset:1024 sc1
    buffer_load_dwordx4 v[48:51], v4, s[36:39], s22 offen offset:2048 sc1
    buffer_load_dwordx4 v[52:55], v4, s[36:39], s22 offen offset:3072 sc1
    s_add_u32 s22, s22, 4096
    buffer_load_dwordx4 v[56:59], v4, s[36:39], s22 offen offset:0 sc1
    buffer_load_dwordx4 v[60:63], v4, s[36:39], s22 offen offset:1024 sc1
    s_waitcnt vmcnt(5)
    s_waitcnt lgkmcnt(15)
    v_mfma_f32_16x16x32_bf16 v[24:27], v[76:79], v[40:43], 0
    buffer_load_dwordx4 v[64:67], v4, s[36:39], s22 offen offset:2048 sc1
    ds_read_b64_tr_b16 v[76:77], v16 offset:40960
    ds_read_b64_tr_b16 v[78:79], v16 offset:43008
    v_mfma_f32_16x16x32_bf16 v[28:31], v[80:83], v[40:43], 0
    ds_read_b64_tr_b16 v[80:81], v17 offset:40960
    ds_read_b64_tr_b16 v[82:83], v17 offset:43008
    v_mfma_f32_16x16x32_bf16 v[32:35], v[84:87], v[40:43], 0
    ds_read_b64_tr_b16 v[84:85], v18 offset:40960
    ds_read_b64_tr_b16 v[86:87], v18 offset:43008
    v_mfma_f32_16x16x32_bf16 v[36:39], v[88:91], v[40:43], 0
    ds_read_b64_tr_b16 v[88:89], v19 offset:40960
    ds_read_b64_tr_b16 v[90:91], v19 offset:43008
    s_waitcnt vmcnt(5)
    v_mfma_f32_16x16x32_bf16 v[24:27], v[92:95], v[44:47], v[24:27]
    buffer_load_dwordx4 v[68:71], v4, s[36:39], s22 offen offset:3072 sc1
    s_add_u32 s22, s22, 4096
    ds_read_b64_tr_b16 v[92:93], v16 offset:45056
    ds_read_b64_tr_b16 v[94:95], v16 offset:47104
    v_mfma_f32_16x16x32_bf16 v[28:31], v[96:99], v[44:47], v[28:31]
    ds_read_b64_tr_b16 v[96:97], v17 offset:45056
    ds_read_b64_tr_b16 v[98:99], v17 offset:47104
    v_mfma_f32_16x16x32_bf16 v[32:35], v[100:103], v[44:47], v[32:35]
    ds_read_b64_tr_b16 v[100:101], v18 offset:45056
    ds_read_b64_tr_b16 v[102:103], v18 offset:47104
    v_mfma_f32_16x16x32_bf16 v[36:39], v[104:107], v[44:47], v[36:39]
    ds_read_b64_tr_b16 v[104:105], v19 offset:45056
    ds_read_b64_tr_b16 v[106:107], v19 offset:47104
    s_waitcnt vmcnt(5)
    v_mfma_f32_16x16x32_bf16 v[24:27], v[108:111], v[48:51], v[24:27]
    buffer_load_dwordx4 v[72:75], v4, s[36:39], s22 offen offset:0 sc1
    ds_read_b64_tr_b16 v[108:109], v16 offset:49152
    ds_read_b64_tr_b16 v[110:111], v16 offset:51200
    v_mfma_f32_16x16x32_bf16 v[28:31], v[112:115], v[48:51], v[28:31]
    ds_read_b64_tr_b16 v[112:113], v17 offset:49152
    ds_read_b64_tr_b16 v[114:115], v17 offset:51200
    v_mfma_f32_16x16x32_bf16 v[32:35], v[116:119], v[48:51], v[32:35]
    ds_read_b64_tr_b16 v[116:117], v18 offset:49152
    ds_read_b64_tr_b16 v[118:119], v18 offset:51200
    v_mfma_f32_16x16x32_bf16 v[36:39], v[120:123], v[48:51], v[36:39]
    ds_read_b64_tr_b16 v[120:121], v19 offset:49152
    ds_read_b64_tr_b16 v[122:123], v19 offset:51200
    s_waitcnt vmcnt(5)
    v_mfma_f32_16x16x32_bf16 v[24:27], v[124:127], v[52:55], v[24:27]
    buffer_load_dwordx4 v[40:43], v4, s[36:39], s22 offen offset:1024 sc1
    ds_read_b64_tr_b16 v[124:125], v16 offset:53248
    ds_read_b64_tr_b16 v[126:127], v16 offset:55296
    v_mfma_f32_16x16x32_bf16 v[28:31], v[128:131], v[52:55], v[28:31]
    ds_read_b64_tr_b16 v[128:129], v17 offset:53248
    ds_read_b64_tr_b16 v[130:131], v17 offset:55296
    v_mfma_f32_16x16x32_bf16 v[32:35], v[132:135], v[52:55], v[32:35]
    ds_read_b64_tr_b16 v[132:133], v18 offset:53248
    ds_read_b64_tr_b16 v[134:135], v18 offset:55296
    v_mfma_f32_16x16x32_bf16 v[36:39], v[136:139], v[52:55], v[36:39]
    ds_read_b64_tr_b16 v[136:137], v19 offset:53248
    ds_read_b64_tr_b16 v[138:139], v19 offset:55296
    s_waitcnt vmcnt(5)
    v_mfma_f32_16x16x32_bf16 v[24:27], v[140:143], v[56:59], v[24:27]
    buffer_load_dwordx4 v[44:47], v4, s[36:39], s22 offen offset:2048 sc1
    v_mfma_f32_16x16x32_bf16 v[28:31], v[144:147], v[56:59], v[28:31]
    v_mfma_f32_16x16x32_bf16 v[32:35], v[148:151], v[56:59], v[32:35]
    v_mfma_f32_16x16x32_bf16 v[36:39], v[152:155], v[56:59], v[36:39]
    s_waitcnt vmcnt(5)
    v_mfma_f32_16x16x32_bf16 v[24:27], v[156:159], v[60:63], v[24:27]
    buffer_load_dwordx4 v[48:51], v4, s[36:39], s22 offen offset:3072 sc1
    s_add_u32 s22, s22, 4096
    v_mfma_f32_16x16x32_bf16 v[28:31], v[160:163], v[60:63], v[28:31]
    v_mfma_f32_16x16x32_bf16 v[32:35], v[164:167], v[60:63], v[32:35]
    v_mfma_f32_16x16x32_bf16 v[36:39], v[168:171], v[60:63], v[36:39]
    s_waitcnt vmcnt(5)
    v_mfma_f32_16x16x32_bf16 v[24:27], v[172:175], v[64:67], v[24:27]
    buffer_load_dwordx4 v[52:55], v4, s[36:39], s22 offen offset:0 sc1
    v_mfma_f32_16x16x32_bf16 v[28:31], v[176:179], v[64:67], v[28:31]
    v_mfma_f32_16x16x32_bf16 v[32:35], v[180:183], v[64:67], v[32:35]
    v_mfma_f32_16x16x32_bf16 v[36:39], v[184:187], v[64:67], v[36:39]
    s_waitcnt vmcnt(5)
    v_mfma_f32_16x16x32_bf16 v[24:27], v[188:191], v[68:71], v[24:27]
    buffer_load_dwordx4 v[56:59], v4, s[36:39], s22 offen offset:1024 sc1
    v_mfma_f32_16x16x32_bf16 v[28:31], v[192:195], v[68:71], v[28:31]
    v_mfma_f32_16x16x32_bf16 v[32:35], v[196:199], v[68:71], v[32:35]
    v_mfma_f32_16x16x32_bf16 v[36:39], v[200:203], v[68:71], v[36:39]
    s_waitcnt vmcnt(5)
    s_waitcnt lgkmcnt(15)
    v_mfma_f32_16x16x32_bf16 v[24:27], v[204:207], v[72:75], v[24:27]
    v_mfma_f32_16x16x32_bf16 v[28:31], v[208:211], v[72:75], v[28:31]
    v_mfma_f32_16x16x32_bf16 v[32:35], v[212:215], v[72:75], v[32:35]
    v_mfma_f32_16x16x32_bf16 v[36:39], v[216:219], v[72:75], v[36:39]
    s_waitcnt vmcnt(4)
    v_mfma_f32_16x16x32_bf16 v[24:27], v[220:223], v[40:43], v[24:27]
    v_mfma_f32_16x16x32_bf16 v[28:31], v[224:227], v[40:43], v[28:31]
    v_mfma_f32_16x16x32_bf16 v[32:35], v[228:231], v[40:43], v[32:35]
    v_mfma_f32_16x16x32_bf16 v[36:39], v[232:235], v[40:43], v[36:39]
    s_waitcnt vmcnt(3)
    v_mfma_f32_16x16x32_bf16 v[24:27], v[76:79], v[44:47], v[24:27]
    v_mfma_f32_16x16x32_bf16 v[28:31], v[80:83], v[44:47], v[28:31]
    v_mfma_f32_16x16x32_bf16 v[32:35], v[84:87], v[44:47], v[32:35]
    v_mfma_f32_16x16x32_bf16 v[36:39], v[88:91], v[44:47], v[36:39]
    s_waitcnt vmcnt(2)
    v_mfma_f32_16x16x32_bf16 v[24:27], v[92:95], v[48:51], v[24:27]
    v_mfma_f32_16x16x32_bf16 v[28:31], v[96:99], v[48:51], v[28:31]
    v_mfma_f32_16x16x32_bf16 v[32:35], v[100:103], v[48:51], v[32:35]
    v_mfma_f32_16x16x32_bf16 v[36:39], v[104:107], v[48:51], v[36:39]
    s_waitcnt vmcnt(1)
    s_waitcnt lgkmcnt(14)
    v_mfma_f32_16x16x32_bf16 v[24:27], v[108:111], v[52:55], v[24:27]
    s_waitcnt lgkmcnt(12)
    v_mfma_f32_16x16x32_bf16 v[28:31], v[112:115], v[52:55], v[28:31]
    s_waitcnt lgkmcnt(10)
    v_mfma_f32_16x16x32_bf16 v[32:35], v[116:119], v[52:55], v[32:35]
    s_waitcnt lgkmcnt(8)
    v_mfma_f32_16x16x32_bf16 v[36:39], v[120:123], v[52:55], v[36:39]
    s_waitcnt vmcnt(0)
    s_waitcnt lgkmcnt(6)
    v_mfma_f32_16x16x32_bf16 v[24:27], v[124:127], v[56:59], v[24:27]
    s_waitcnt lgkmcnt(4)
    v_mfma_f32_16x16x32_bf16 v[28:31], v[128:131], v[56:59], v[28:31]
    s_waitcnt lgkmcnt(2)
    v_mfma_f32_16x16x32_bf16 v[32:35], v[132:135], v[56:59], v[32:35]
    s_waitcnt lgkmcnt(0)
    v_mfma_f32_16x16x32_bf16 v[36:39], v[136:139], v[56:59], v[36:39]
    s_nop 1
    v_cvt_pk_bf16_f32 v156, v24, v25
    v_cvt_pk_bf16_f32 v157, v26, v27
    ds_write_b64 v20, v[156:157]
    v_cvt_pk_bf16_f32 v158, v28, v29
    v_cvt_pk_bf16_f32 v159, v30, v31
    ds_write_b64 v21, v[158:159]
    v_cvt_pk_bf16_f32 v160, v32, v33
    v_cvt_pk_bf16_f32 v161, v34, v35
    ds_write_b64 v22, v[160:161]
    v_cvt_pk_bf16_f32 v162, v36, v37
    v_cvt_pk_bf16_f32 v163, v38, v39
    ds_write_b64 v23, v[162:163]
    ds_read_b128 v[172:175], v9
    ds_read_b128 v[176:179], v9 offset:1024
    s_waitcnt lgkmcnt(1)
    buffer_store_dwordx4 v[172:175], v10, s[32:35], s23 offen
    s_waitcnt lgkmcnt(0)
    buffer_store_dwordx4 v[176:179], v10, s[32:35], s28 offen

    s_add_u32 s40, s7, s62
    s_cmp_lg_u32 s40, 0
    s_cbranch_scc1 C_end
    s_add_u32 s40, s10, 16
    v_mov_b32 v2, s40
    s_lshl_b32 s40, s8, 7
    s_mov_b64 exec, 1
    buffer_store_dword v2, v6, s[36:39], s40 offen
        C_end:

    s_endpgm
X_cH:
    s_mov_b32 s9, 0
        X_lH:
    v_cmp_ne_u64 vcc, s[28:29], v[18:19]
    s_nop 0
    s_cbranch_vccz X_okH
    v_subrev_u32 v18, s12, v18
    v_cmp_ne_u32 s[42:43], s13, v19
    v_cmp_le_u32 vcc, 8, v18
    s_nop 0
    s_or_b64 vcc, vcc, s[42:43]
    s_cbranch_vccz X_nH
    buffer_load_dwordx2 v[18:19], v20, s[36:39], s30 offen sc1
    s_add_u32 s9, s9, 1
    s_cmp_lt_u32 s9, 200000
    s_waitcnt vmcnt(0)
    s_cbranch_scc1 X_lH
        X_nH:
    s_mov_b32 s101, 0
    s_branch X_okH
S_cls0:
    s_cmp_eq_u32 s57, 0
    s_cbranch_scc0 S_cls1
    v_cmp_eq_u32 s[42:43], 0, v3
    v_mov_b32 v4, 0x3f80
    s_nop 0
    v_cndmask_b32 v28, v28, v4, s[42:43]
    v_mov_b32 v32, 0
    v_mov_b32 v40, 0
    v_cndmask_b32 v29, v29, v4, s[42:43]
    v_mov_b32 v33, 0
    v_mov_b32 v41, 0
    v_cndmask_b32 v30, v30, v4, s[42:43]
    v_mov_b32 v34, 0
    v_mov_b32 v42, 0
    v_cndmask_b32 v31, v31, v4, s[42:43]
    v_mov_b32 v35, 0
    v_mov_b32 v43, 0
    s_branch S_reg
S_cls1:
    v_mov_b32 v32, v28
    v_mov_b32 v28, 0
    v_mov_b32 v40, v36
    v_mov_b32 v36, 0
    v_mov_b32 v33, v29
    v_mov_b32 v29, 0
    v_mov_b32 v41, v37
    v_mov_b32 v37, 0
    v_mov_b32 v34, v30
    v_mov_b32 v30, 0
    v_mov_b32 v42, v38
    v_mov_b32 v38, 0
    v_mov_b32 v35, v31
    v_mov_b32 v31, 0
    v_mov_b32 v43, v39
    v_mov_b32 v39, 0
    s_branch S_reg
S_x0:
    v_cmp_eq_u32 s[42:43], 0, v3
    v_mov_b32 v4, 0x3f800000
    s_nop 0
    v_cndmask_b32 v32, 0, v4, s[42:43]
    v_cndmask_b32 v33, 0, v4, s[42:43]
    v_cndmask_b32 v34, 0, v4, s[42:43]
    v_cndmask_b32 v35, 0, v4, s[42:43]
    s_nop 1
    v_mfma_f32_16x16x32_bf16 v[162:165], v[158:161], v[32:35], 0
    v_mfma_f32_16x16x32_bf16 v[170:173], v[166:169], v[32:35], 0
    v_mfma_f32_16x16x32_bf16 v[178:181], v[174:177], v[32:35], 0
    v_mfma_f32_16x16x32_bf16 v[186:189], v[182:185], v[32:35], 0
    s_lshl_b32 s40, s3, 11
    s_add_u32 s40, s40, 32768
    v_add_u32 v4, s40, v47
    s_nop 1
    v_cvt_pk_bf16_f32 v36, v162, v163
    v_cvt_pk_bf16_f32 v37, v164, v165
    v_cvt_pk_bf16_f32 v38, v170, v171
    v_cvt_pk_bf16_f32 v39, v172, v173
    ds_write_b128 v4, v[36:39] offset:32768
    v_cvt_pk_bf16_f32 v40, v178, v179
    v_cvt_pk_bf16_f32 v41, v180, v181
    v_cvt_pk_bf16_f32 v42, v186, v187
    v_cvt_pk_bf16_f32 v43, v188, v189
    ds_write_b128 v4, v[40:43] offset:33792
    s_branch S_x1
S_y0:
    v_add_u32 v4, 32768, v47
    ds_read_b128 v[158:161], v4 offset:32768
    ds_read_b128 v[162:165], v4 offset:33792
    ds_read_b128 v[166:169], v4 offset:34816
    ds_read_b128 v[170:173], v4 offset:35840
    ds_read_b128 v[174:177], v4 offset:36864
    ds_read_b128 v[178:181], v4 offset:37888
    ds_read_b128 v[182:185], v4 offset:38912
    ds_read_b128 v[186:189], v4 offset:39936
    s_waitcnt lgkmcnt(0)
    v_mfma_f32_16x16x32_bf16 v[198:201], v[94:97], v[158:161], v[198:201]
    v_mfma_f32_16x16x32_bf16 v[198:201], v[98:101], v[162:165], v[198:201]
    v_mfma_f32_16x16x32_bf16 v[202:205], v[102:105], v[166:169], v[202:205]
    v_mfma_f32_16x16x32_bf16 v[202:205], v[106:109], v[170:173], v[202:205]
    v_mfma_f32_16x16x32_bf16 v[214:217], v[126:129], v[174:177], v[214:217]
    v_mfma_f32_16x16x32_bf16 v[214:217], v[130:133], v[178:181], v[214:217]
    v_mfma_f32_16x16x32_bf16 v[218:221], v[134:137], v[182:185], v[218:221]
    v_mfma_f32_16x16x32_bf16 v[218:221], v[138:141], v[186:189], v[218:221]
    s_nop 7
    s_branch S_y1
SM_sS0:
    buffer_store_dwordx4 v[94:97], v4, s[36:39], s15 offen sc1
    s_branch SM_jS0
C_vr0:
    s_mov_b32 s9, 0
        W_lV0:
    ds_read_b32 v2, v5 offset:32
    s_add_u32 s9, s9, 1
    s_cmp_gt_u32 s9, 1600000
    s_cbranch_scc1 W_dV0
    s_waitcnt lgkmcnt(0)
    v_cmp_gt_u32 vcc, 4, v2
    s_nop 0
    s_cbranch_vccnz W_lV0
        W_dV0:

    ds_read_b64_tr_b16 v[166:167], v34 offset:32768
    ds_read_b64_tr_b16 v[168:169], v34 offset:33280
    ds_read_b64_tr_b16 v[170:171], v35 offset:32768
    ds_read_b64_tr_b16 v[172:173], v35 offset:33280
    ds_read_b64_tr_b16 v[198:199], v34 offset:36864
    ds_read_b64_tr_b16 v[200:201], v34 offset:37376
    ds_read_b64_tr_b16 v[202:203], v35 offset:36864
    ds_read_b64_tr_b16 v[204:205], v35 offset:37376
    s_waitcnt lgkmcnt(0)
    s_branch C_vd0
SM_sS1:
    buffer_store_dwordx4 v[94:97], v4, s[36:39], s15 offen sc1
    s_branch SM_jS1
C_vr1:
    s_mov_b32 s9, 0
        W_lV1:
    ds_read_b32 v2, v5 offset:32
    s_add_u32 s9, s9, 1
    s_cmp_gt_u32 s9, 1600000
    s_cbranch_scc1 W_dV1
    s_waitcnt lgkmcnt(0)
    v_cmp_gt_u32 vcc, 4, v2
    s_nop 0
    s_cbranch_vccnz W_lV1
        W_dV1:

    ds_read_b64_tr_b16 v[166:167], v34 offset:32768
    ds_read_b64_tr_b16 v[168:169], v34 offset:33280
    ds_read_b64_tr_b16 v[170:171], v35 offset:32768
    ds_read_b64_tr_b16 v[172:173], v35 offset:33280
    ds_read_b64_tr_b16 v[198:199], v34 offset:36864
    ds_read_b64_tr_b16 v[200:201], v34 offset:37376
    ds_read_b64_tr_b16 v[202:203], v35 offset:36864
    ds_read_b64_tr_b16 v[204:205], v35 offset:37376
    s_waitcnt lgkmcnt(0)
    s_branch C_vd1
C_sr:
    s_add_u32 s9, s9, 1
    s_cmp_gt_u32 s9, 200000
    s_cbranch_scc1 C_sk
    buffer_load_dwordx4 v[214:217], v4, s[36:39], s100 offen sc1
    s_branch C_sl
C_pr:
    s_mov_b32 s9, 0
        C_pl:
    ds_read_b32 v48, v47 offset:40
    ds_read_b128 v[78:81], v43 offset:49152
    ds_read_b128 v[82:85], v43 offset:50176
    s_add_u32 s9, s9, 1
    s_cmp_gt_u32 s9, 1600000
    s_waitcnt lgkmcnt(0)
    s_cbranch_scc1 C_pd
    v_cmp_eq_u32 vcc, 0, v48
    s_nop 0
    s_cbranch_vccnz C_pl
    s_branch C_pd
SM_sO:
    s_nop 7
    v_cvt_pk_bf16_f32 v54, v62, v63
    v_cvt_pk_bf16_f32 v55, v64, v65
    v_cvt_pk_bf16_f32 v56, v66, v67
    v_cvt_pk_bf16_f32 v57, v68, v69
    buffer_store_dwordx4 v[54:57], v4, s[36:39], s100 offen sc1
    v_cvt_pk_bf16_f32 v58, v70, v71
    v_cvt_pk_bf16_f32 v59, v72, v73
    v_cvt_pk_bf16_f32 v60, v74, v75
    v_cvt_pk_bf16_f32 v61, v76, v77
    buffer_store_dwordx4 v[58:61], v4, s[36:39], s19 offen sc1
    s_branch SM_jO
SM_sF:
    buffer_store_dwordx2 v[14:15], v6, s[36:39], s21 offen sc1
    s_branch SM_jF
K_exit:
    s_endpgm
.fill 7168, 4, 0xbf810000
.section .rodata,"a"
.p2align 6
.amdhsa_kernel concat_heads__sliding_local_dilated__spectral_fnet__prompt_kernel
  .amdhsa_next_free_vgpr 256
  .amdhsa_next_free_sgpr 102
  .amdhsa_accum_offset 256
  .amdhsa_group_segment_fixed_size 0
  .amdhsa_kernarg_size 88
  .amdhsa_user_sgpr_count 2
  .amdhsa_user_sgpr_kernarg_segment_ptr 1
  .amdhsa_system_sgpr_workgroup_id_x 1
.end_amdhsa_kernel
```

```asm
; @launch grid=(256,1,1) block=(512,1,1) lds=163840
.amdgcn_target "amdgcn-amd-amdhsa--gfx950"
.text
.p2align 12
.fill 832, 4, 0xbf810000
.globl concat_heads__sliding_local_dilated__spectral_fnet__prompt_kernel
.p2align 8
.type concat_heads__sliding_local_dilated__spectral_fnet__prompt_kernel,@function
concat_heads__sliding_local_dilated__spectral_fnet__prompt_kernel:
    s_load_dwordx2 s[16:17], s[0:1], 0
    s_load_dwordx2 s[20:21], s[0:1], 8
    s_load_dwordx2 s[28:29], s[0:1], 24
    s_load_dwordx2 s[36:37], s[0:1], 80
    s_load_dwordx2 s[24:25], s[0:1], 16
    s_load_dwordx2 s[32:33], s[0:1], 64
    v_lshrrev_b32 v1, 6, v0
    s_cmp_ge_u32 s2, 256
    s_cbranch_scc1 K_exit
    v_readfirstlane_b32 s3, v1
    s_and_b32 s4, s2, 7
    s_lshr_b32 s5, s2, 3
    s_cmp_lg_u32 s3, 7
    s_cbranch_scc1 K_nopf
    s_getpc_b64 s[44:45]
    s_mov_b32 s46, 28672
    s_mov_b32 s47, 0x00020000
    s_mul_i32 s40, s5, 896
    v_and_b32 v1, 63, v0
    v_min_u32 v1, 6, v1
    v_lshlrev_b32 v1, 7, v1
    buffer_load_dword v255, v1, s[44:47], s40 offen
        K_nopf:
    s_mul_i32 s6, s5, 37
    s_lshr_b32 s6, s6, 8
    s_mul_i32 s40, s6, 7
    s_sub_u32 s7, s5, s40
    s_mov_b32 s38, 0x10000000
    s_mov_b32 s39, 0x00020000
    s_lshl_b32 s8, s4, 2
    s_cmp_lt_u32 s5, 28
    s_cbranch_scc1 K_a

    s_add_u32 s8, s8, s7
    s_mov_b32 s30, 1835008
    s_mov_b32 s31, 0x00020000
    s_lshl_b32 s40, s3, 7
    s_add_u32 s40, s40, s8
    v_and_b32 v4, 32, v0
    v_add_u32 v4, s40, v4
    v_and_b32 v5, 31, v0
    v_lshlrev_b32 v5, 4, v5
    v_mov_b32 v6, 896
    v_mad_u32_u24 v7, v4, v6, v5
    v_add_u32 v5, 384, v5
    v_sub_u32 v8, 960, v4
    v_mad_u32_u24 v8, v8, v6, v5
    v_sub_u32 v9, 2048, v4
    v_and_b32 v9, 2047, v9
    v_mad_u32_u24 v9, v9, v6, v5
    s_lshl_b32 s42, s3, 13
    s_mov_b32 m0, s42
    s_mov_b32 s52, 57344
    s_mov_b32 s53, 917504
    s_mov_b32 s54, 974848
    s_waitcnt lgkmcnt(0)

    buffer_load_dwordx4 v7, s[28:31], 0 offen nt lds
    s_add_u32 m0, m0, 1024
    s_nop 0
    buffer_load_dwordx4 v7, s[28:31], s52 offen nt lds
    s_add_u32 m0, m0, 1024
    s_nop 0
    buffer_load_dwordx4 v9, s[28:31], 0 offen nt lds
    s_add_u32 m0, m0, 1024
    s_nop 0
    buffer_load_dwordx4 v8, s[28:31], s53 offen nt lds
    s_add_u32 m0, m0, 1024
    s_load_dwordx2 s[10:11], s[36:37], 4096
    s_branch K_spare2
K_a:
    s_add_u32 s8, s8, s6
    s_cmp_ge_u32 s3, 4
    s_cbranch_scc1 K_c
    s_setprio 2
    s_mov_b32 s44, s4
    s_add_u32 s44, s44, s7
    s_mul_i32 s40, s44, 37
    s_lshr_b32 s40, s40, 8
    s_mul_i32 s40, s40, 7
    s_sub_u32 s44, s44, s40
    s_mov_b32 s18, 1835008
    s_mov_b32 s19, 0x00020000
    s_mov_b32 s22, 1204224
    s_mov_b32 s23, 0x00020000
    v_and_b32 v1, 63, v0
    v_lshrrev_b32 v6, 3, v1
    v_and_b32 v7, 7, v1
    v_lshrrev_b32 v8, 4, v1
    v_xor_b32 v3, v7, v8
    v_mul_u32_u24 v23, 896, v6
    v_lshl_add_u32 v21, v3, 4, v23
    v_xor_b32 v22, 64, v21
    v_add_u32 v22, 6144, v22
    s_lshl_b32 s40, s3, 5
    v_xor_b32 v23, s40, v21
    v_and_b32 v2, 2, v6
    v_xor_b32 v2, v7, v2
    v_mul_u32_u24 v3, 2688, v6
    v_lshl_add_u32 v24, v2, 4, v3
    v_xor_b32 v25, 64, v24
    v_add_u32 v25, 20480, v25
    v_add_u32 v26, 896, v24
    v_add_u32 v27, 896, v25
    v_add_u32 v28, 1792, v24
    v_add_u32 v29, 1792, v25
    s_mov_b32 s45, s44
    s_lshl_b32 s40, s8, 6
    s_lshl_b32 s41, s3, 4
    s_add_u32 s42, s40, s41
    s_mul_i32 s46, s42, 896
    s_mul_i32 s48, s41, 2688
    s_lshl_b32 s42, s7, 7
    s_add_u32 s48, s48, s42
    s_sub_u32 s40, s40, 16
    s_max_i32 s40, s40, 0
    s_lshl_b32 s41, s3, 2
    s_add_u32 s40, s40, s41
    s_mul_i32 s47, s40, 896
    s_lshl_b32 s50, s3, 11
    s_lshl_b32 s49, s3, 9

    s_lshl_b32 s40, s44, 7
    s_add_u32 s51, s40, s46
    s_add_u32 s52, s40, s47
    s_mul_i32 s53, s44, 172032
    s_add_u32 s53, s53, s48
    s_add_u32 m0, s50, 2048
    s_add_u32 s44, s44, 1
    s_cmp_eq_u32 s44, 7
    s_cselect_b32 s44, 0, s44
    s_waitcnt lgkmcnt(0)
    buffer_load_dwordx4 v21, s[16:19], s51 offen lds
    buffer_load_dwordx4 v22, s[16:19], s51 offen offset:1024 lds
    s_add_u32 m0, s49, 0
    s_mov_b32 exec_hi, 0
    buffer_load_dwordx4 v23, s[16:19], s52 offen lds
    s_mov_b32 exec_hi, -1
    s_add_u32 m0, s50, 79872
    s_nop 0
    buffer_load_dwordx4 v24, s[20:23], s53 offen lds
    buffer_load_dwordx4 v25, s[20:23], s53 offen offset:1024 lds
    s_add_u32 m0, s50, 88064
    s_nop 0
    buffer_load_dwordx4 v26, s[20:23], s53 offen lds
    buffer_load_dwordx4 v27, s[20:23], s53 offen offset:1024 lds
    s_add_u32 m0, s50, 96256
    s_mul_i32 s53, s45, 172032
    s_add_u32 s53, s53, s48
    s_add_u32 s45, s45, 1
    s_cmp_eq_u32 s45, 7
    s_cselect_b32 s45, 0, s45
    buffer_load_dwordx4 v28, s[20:23], s53 offen lds
    buffer_load_dwordx4 v29, s[20:23], s53 offen offset:1024 lds
    s_lshl_b32 s40, s44, 7
    s_add_u32 s51, s40, s46
    s_add_u32 s52, s40, s47
    s_mul_i32 s53, s44, 172032
    s_add_u32 s53, s53, s48
    s_add_u32 m0, s50, 12288
    s_add_u32 s44, s44, 1
    s_cmp_eq_u32 s44, 7
    s_cselect_b32 s44, 0, s44
    buffer_load_dwordx4 v21, s[16:19], s51 offen lds
    buffer_load_dwordx4 v22, s[16:19], s51 offen offset:1024 lds
    s_lshl_b32 s56, s8, 7
    s_load_dwordx2 s[10:11], s[36:37], s56
    s_add_u32 s30, s56, 8192
    s_getreg_b32 s28, hwreg(HW_REG_XCC_ID, 0, 3)
    v_min_u32 v20, 6, v1
    v_lshlrev_b32 v20, 3, v20
    s_mov_b32 s26, 401408
    s_mov_b32 s27, 0x00020000
    s_mov_b32 s34, 3670016
    s_mov_b32 s35, 0x00020000
    s_lshr_b32 s58, s3, 1
    s_and_b32 s59, s3, 1
    v_and_b32 v9, 15, v1
    v_mov_b32 v4, 0
    v_mov_b32 v14, 1
    v_mov_b32 v5, 161792
    v_and_b32 v50, 6, v6
    v_xor_b32 v50, v7, v50
    v_mul_u32_u24 v51, 896, v6
    v_lshl_add_u32 v10, v50, 4, v51
    v_add_u32 v11, 6144, v10
    s_mov_b32 s54, s6
    s_mul_i32 s55, s3, 14336
    s_lshl_b32 s56, s7, 7
    s_add_u32 s55, s55, s56
    s_and_b32 s56, s3, 1
    s_lshl_b32 s57, s7, 1
    s_add_u32 s56, s56, s57
    s_lshl_b32 s15, s56, 10
    s_lshl_b32 s56, s8, 2
    s_and_b32 s57, s3, 2
    s_add_u32 s56, s56, s57
    s_mul_i32 s57, s56, 14336
    s_add_u32 s15, s15, s57
    s_add_u32 s15, s15, 2097152
    s_lshl_b32 s100, s56, 6
    s_add_u32 s100, s100, 16384
    v_lshlrev_b32 v50, 7, v7
    v_and_b32 v51, 1, v6
    v_mul_u32_u24 v51, 14336, v51
    v_add3_u32 v12, v50, v51, s15
    v_mov_b32 v50, s100
    v_cmp_le_u32 vcc, 16, v1
    s_nop 1
    v_cndmask_b32 v12, v12, v50, vcc
    v_and_b32 v50, 1, v9
    v_cmp_eq_u32 s[42:43], 1, v50
    v_lshl_add_u32 v50, v8, 2, v50
    v_cmp_le_u32 s[0:1], v50, v9
    v_add_u32 v50, 2, v50
    v_cmp_le_u32 s[12:13], v50, v9
    v_mov_b32 v50, 0xffff
    v_mov_b32 v51, 0xffff0000
    v_cndmask_b32 v50, v50, v51, s[42:43]
    v_cndmask_b32 v52, v50, 0, s[0:1]
    v_cndmask_b32 v53, v50, 0, s[12:13]
    v_cndmask_b32 v54, 0, v50, s[0:1]
    v_cndmask_b32 v55, 0, v50, s[12:13]
    v_lshlrev_b32 v50, 4, v1
    s_add_u32 s56, s50, 129024
    v_add_u32 v56, s56, v50
    s_xor_b32 s56, s50, 2048
    s_add_u32 s56, s56, 129024
    v_add_u32 v57, s56, v50
    v_add_u32 v59, s50, v50
    v_lshl_add_u32 v58, s58, 3, v5
    v_lshl_add_u32 v60, s3, 2, v5
    s_cmp_eq_u32 s7, 3
    s_cselect_b32 s56, 0, 1.0
    v_mov_b32 v61, s56
    s_mov_b32 s31, 0x3e8b97f6
K_h2:
    s_add_u32 m0, s49, 10240
    s_mov_b32 exec_hi, 0
    buffer_load_dwordx4 v23, s[16:19], s52 offen lds
    s_mov_b32 exec_hi, -1
    s_add_u32 m0, s50, 104448
    s_nop 0
    buffer_load_dwordx4 v24, s[20:23], s53 offen lds
    buffer_load_dwordx4 v25, s[20:23], s53 offen offset:1024 lds
    s_waitcnt lgkmcnt(0)
    s_add_u32 s12, s10, 0x5a3c9671
    s_xor_b32 s13, s11, 0x2b7e1516
    s_add_u32 s28, s28, s12
    s_mov_b32 s29, s13
    s_waitcnt vmcnt(5)
    s_barrier
    s_add_u32 m0, s50, 112640
    s_nop 0
    buffer_load_dwordx4 v26, s[20:23], s53 offen lds
    buffer_load_dwordx4 v27, s[20:23], s53 offen offset:1024 lds
    s_add_u32 m0, s50, 120832
    s_mul_i32 s53, s45, 172032
    s_add_u32 s53, s53, s48
    s_add_u32 s45, s45, 1
    s_cmp_eq_u32 s45, 7
    s_cselect_b32 s45, 0, s45
    buffer_load_dwordx4 v28, s[20:23], s53 offen lds
    buffer_load_dwordx4 v29, s[20:23], s53 offen offset:1024 lds
    s_lshl_b32 s40, s44, 7
    s_add_u32 s51, s40, s46
    s_add_u32 s52, s40, s47
    s_mul_i32 s53, s44, 172032
    s_add_u32 s53, s53, s48
    s_add_u32 m0, s50, 22528
    s_add_u32 s44, s44, 1
    s_cmp_eq_u32 s44, 7
    s_cselect_b32 s44, 0, s44
    buffer_load_dwordx4 v21, s[16:19], s51 offen lds
    buffer_load_dwordx4 v22, s[16:19], s51 offen offset:1024 lds
    s_add_u32 m0, s49, 20480
    s_mov_b32 exec_hi, 0
    buffer_load_dwordx4 v23, s[16:19], s52 offen lds
    s_mov_b32 exec_hi, -1
    s_add_u32 m0, s50, 129024
    s_nop 0
    buffer_load_dwordx4 v24, s[20:23], s53 offen lds
    buffer_load_dwordx4 v25, s[20:23], s53 offen offset:1024 lds
    s_add_u32 m0, s50, 137216
    s_nop 0
    buffer_load_dwordx4 v26, s[20:23], s53 offen lds
    buffer_load_dwordx4 v27, s[20:23], s53 offen offset:1024 lds
    s_add_u32 m0, s50, 145408
    s_mul_i32 s53, s45, 172032
    s_add_u32 s53, s53, s48
    s_add_u32 s45, s45, 1
    s_cmp_eq_u32 s45, 7
    s_cselect_b32 s45, 0, s45
    buffer_load_dwordx4 v28, s[20:23], s53 offen lds
    buffer_load_dwordx4 v29, s[20:23], s53 offen offset:1024 lds
    s_lshl_b32 s40, s44, 7
    s_add_u32 s51, s40, s46
    s_add_u32 s52, s40, s47
    s_mul_i32 s53, s44, 172032
    s_add_u32 s53, s53, s48
    s_add_u32 m0, s50, 32768
    s_add_u32 s44, s44, 1
    s_cmp_eq_u32 s44, 7
    s_cselect_b32 s44, 0, s44
    buffer_load_dwordx4 v21, s[16:19], s51 offen lds
    s_waitcnt vmcnt(10)
    s_barrier
    buffer_load_dwordx4 v22, s[16:19], s51 offen offset:1024 lds
    s_add_u32 m0, s49, 30720
    s_mov_b32 exec_hi, 0
    buffer_load_dwordx4 v23, s[16:19], s52 offen lds
    s_mov_b32 exec_hi, -1
    s_add_u32 m0, s50, 153600
    s_nop 0
    buffer_load_dwordx4 v24, s[20:23], s53 offen lds
    buffer_load_dwordx4 v25, s[20:23], s53 offen offset:1024 lds
    s_add_u32 m0, s50, 71680
    s_nop 0
    buffer_load_dwordx4 v26, s[20:23], s53 offen lds
    buffer_load_dwordx4 v27, s[20:23], s53 offen offset:1024 lds
    s_add_u32 m0, s50, 79872
    s_mul_i32 s53, s45, 172032
    s_add_u32 s53, s53, s48
    s_add_u32 s45, s45, 1
    s_cmp_eq_u32 s45, 7
    s_cselect_b32 s45, 0, s45
    buffer_load_dwordx4 v28, s[20:23], s53 offen lds
    buffer_load_dwordx4 v29, s[20:23], s53 offen offset:1024 lds
    s_lshl_b32 s40, s44, 7
    s_add_u32 s51, s40, s46
    s_add_u32 s52, s40, s47
    s_mul_i32 s53, s44, 172032
    s_add_u32 s53, s53, s48
    s_add_u32 m0, s50, 43008
    s_add_u32 s44, s44, 1
    s_cmp_eq_u32 s44, 7
    s_cselect_b32 s44, 0, s44
    buffer_load_dwordx4 v21, s[16:19], s51 offen lds
    buffer_load_dwordx4 v22, s[16:19], s51 offen offset:1024 lds
    s_add_u32 m0, s49, 40960
    s_mov_b32 exec_hi, 0
    buffer_load_dwordx4 v23, s[16:19], s52 offen lds
    s_mov_b32 exec_hi, -1
    s_waitcnt vmcnt(12)
    s_barrier
    s_add_u32 m0, s50, 88064
    s_nop 0
    buffer_load_dwordx4 v24, s[20:23], s53 offen lds
    buffer_load_dwordx4 v25, s[20:23], s53 offen offset:1024 lds
    s_add_u32 m0, s50, 96256
    s_nop 0
    buffer_load_dwordx4 v26, s[20:23], s53 offen lds
    buffer_load_dwordx4 v27, s[20:23], s53 offen offset:1024 lds
    s_add_u32 m0, s50, 104448
    s_mul_i32 s53, s45, 172032
    s_add_u32 s53, s53, s48
    s_add_u32 s45, s45, 1
    s_cmp_eq_u32 s45, 7
    s_cselect_b32 s45, 0, s45
    buffer_load_dwordx4 v28, s[20:23], s53 offen lds
    buffer_load_dwordx4 v29, s[20:23], s53 offen offset:1024 lds
    buffer_load_dwordx2 v[18:19], v20, s[36:39], s30 offen sc1
    s_lshl_b32 s40, s44, 7
    s_add_u32 s51, s40, s46
    s_add_u32 s52, s40, s47
    s_mul_i32 s53, s44, 172032
    s_add_u32 s53, s53, s48
    s_add_u32 m0, s50, 53248
    s_add_u32 s44, s44, 1
    s_cmp_eq_u32 s44, 7
    s_cselect_b32 s44, 0, s44
    buffer_load_dwordx4 v21, s[16:19], s51 offen lds
    buffer_load_dwordx4 v22, s[16:19], s51 offen offset:1024 lds
    s_waitcnt vmcnt(12)
    s_barrier
    s_add_u32 m0, s49, 51200
    s_mov_b32 exec_hi, 0
    buffer_load_dwordx4 v23, s[16:19], s52 offen lds
    s_mov_b32 exec_hi, -1
    s_add_u32 m0, s50, 112640
    s_nop 0
    buffer_load_dwordx4 v24, s[20:23], s53 offen lds
    buffer_load_dwordx4 v25, s[20:23], s53 offen offset:1024 lds
    s_add_u32 m0, s50, 120832
    s_nop 0
    buffer_load_dwordx4 v26, s[20:23], s53 offen lds
    buffer_load_dwordx4 v27, s[20:23], s53 offen offset:1024 lds
    s_add_u32 m0, s50, 129024
    s_mul_i32 s53, s45, 172032
    s_add_u32 s53, s53, s48
    s_add_u32 s45, s45, 1
    s_cmp_eq_u32 s45, 7
    s_cselect_b32 s45, 0, s45
    buffer_load_dwordx4 v28, s[20:23], s53 offen lds
    buffer_load_dwordx4 v29, s[20:23], s53 offen offset:1024 lds
    s_lshl_b32 s40, s44, 7
    s_add_u32 s51, s40, s46
    s_add_u32 s52, s40, s47
    s_mul_i32 s53, s44, 172032
    s_add_u32 s53, s53, s48
    s_add_u32 m0, s50, 63488
    s_add_u32 s44, s44, 1
    s_cmp_eq_u32 s44, 7
    s_cselect_b32 s44, 0, s44
    buffer_load_dwordx4 v21, s[16:19], s51 offen lds
    s_waitcnt vmcnt(11)
    s_barrier
    buffer_load_dwordx4 v22, s[16:19], s51 offen offset:1024 lds
    s_add_u32 m0, s49, 61440
    s_mov_b32 exec_hi, 0
    buffer_load_dwordx4 v23, s[16:19], s52 offen lds
    s_mov_b32 exec_hi, -1
    s_add_u32 m0, s50, 137216
    s_nop 0
    buffer_load_dwordx4 v24, s[20:23], s53 offen lds
    buffer_load_dwordx4 v25, s[20:23], s53 offen offset:1024 lds
    s_add_u32 m0, s50, 145408
    s_nop 0
    buffer_load_dwordx4 v26, s[20:23], s53 offen lds
    buffer_load_dwordx4 v27, s[20:23], s53 offen offset:1024 lds
    s_add_u32 m0, s50, 153600
    s_mul_i32 s53, s45, 172032
    s_add_u32 s53, s53, s48
    s_add_u32 s45, s45, 1
    s_cmp_eq_u32 s45, 7
    s_cselect_b32 s45, 0, s45
    buffer_load_dwordx4 v28, s[20:23], s53 offen lds
    buffer_load_dwordx4 v29, s[20:23], s53 offen offset:1024 lds
    s_waitcnt vmcnt(9)
    s_barrier
    s_mov_b32 s101, 1

    v_cmp_ne_u32 vcc, s28, v18
    v_cmp_ne_u32 s[42:43], s29, v19
    s_nop 0
    s_or_b64 vcc, vcc, s[42:43]
    s_cbranch_vccnz X_cH
        X_okH:

    v_mov_b32 v2, s101
    ds_write_b32 v5, v2 offset:4
    s_lshl_b32 s40, s54, 13
    s_add_u32 s40, s40, s50
    s_add_u32 m0, s40, 71680
    s_mul_i32 s40, s54, 57344
    s_add_u32 s40, s40, s55
    s_add_u32 s54, s54, 1
    s_cmp_eq_u32 s54, 4
    s_cselect_b32 s54, 0, s54
    buffer_load_dwordx4 v10, s[24:27], s40 offen lds
    buffer_load_dwordx4 v11, s[24:27], s40 offen offset:1024 lds
    s_lshl_b32 s40, s54, 13
    s_add_u32 s40, s40, s50
    s_add_u32 m0, s40, 71680
    s_mul_i32 s40, s54, 57344
    s_add_u32 s40, s40, s55
    s_add_u32 s54, s54, 1
    s_cmp_eq_u32 s54, 4
    s_cselect_b32 s54, 0, s54
    buffer_load_dwordx4 v10, s[24:27], s40 offen lds
    s_waitcnt lgkmcnt(0)
    s_waitcnt vmcnt(5)
    s_barrier
    s_setprio 0
    buffer_load_dwordx4 v11, s[24:27], s40 offen offset:1024 lds
    s_lshl_b32 s40, s54, 13
    s_add_u32 s40, s40, s50
    s_add_u32 m0, s40, 71680
    s_mul_i32 s40, s54, 57344
    s_add_u32 s40, s40, s55
    s_add_u32 s54, s54, 1
    s_cmp_eq_u32 s54, 4
    s_cselect_b32 s54, 0, s54
    buffer_load_dwordx4 v10, s[24:27], s40 offen lds
    buffer_load_dwordx4 v11, s[24:27], s40 offen offset:1024 lds
    buffer_load_dword v13, v12, s[36:39], 0 offen sc1
    s_lshl_b32 s40, s54, 13
    s_add_u32 s40, s40, s50
    s_add_u32 m0, s40, 71680
    s_mul_i32 s40, s54, 57344
    s_add_u32 s40, s40, s55
    s_add_u32 s54, s54, 1
    s_cmp_eq_u32 s54, 4
    s_cselect_b32 s54, 0, s54
    buffer_load_dwordx4 v10, s[24:27], s40 offen lds
    buffer_load_dwordx4 v11, s[24:27], s40 offen offset:1024 lds
    s_waitcnt vmcnt(9)
    s_mov_b64 exec, 1
    ds_add_u32 v5, v14 offset:32
    s_mov_b64 exec, -1
    s_mov_b32 s9, 0
    s_setprio 0
        H_il:
    ds_read_b64 v[62:63], v58 offset:16
    ds_read_b128 v[30:33], v56
    ds_read_b128 v[34:37], v57
    s_add_u32 s9, s9, 1
    s_cmp_gt_u32 s9, 1600000
    s_cbranch_scc1 H_id
    s_waitcnt lgkmcnt(2)
    v_and_b32 v62, v62, v63
    v_cmp_eq_u32 vcc, 0, v62
    s_waitcnt lgkmcnt(0)
    s_cbranch_vccnz H_il
        H_id:
    s_waitcnt lgkmcnt(0)

    v_fma_f32 v30, v34, v61, v30
    v_fma_f32 v31, v35, v61, v31
    v_fma_f32 v32, v36, v61, v32
    v_fma_f32 v33, v37, v61, v33
    v_max_f32 v62, v30, v31
    v_max_f32 v63, v32, v33
    v_mov_b32 v64, v62
    v_mov_b32 v65, v63
    s_nop 0
    v_permlane16_swap_b32 v62, v64
    v_permlane16_swap_b32 v63, v65
    v_max_f32 v62, v62, v64
    v_max_f32 v63, v63, v65
    v_mov_b32 v64, v62
    v_mov_b32 v65, v63
    s_nop 0
    v_permlane32_swap_b32 v62, v64
    v_permlane32_swap_b32 v63, v65
    v_max_f32 v62, v62, v64
    v_max_f32 v63, v63, v65
    v_mul_f32 v62, s31, v62
    v_mul_f32 v63, s31, v63
    v_fma_f32 v30, v30, s31, -v62
    v_fma_f32 v31, v31, s31, -v62
    v_fma_f32 v32, v32, s31, -v63
    v_fma_f32 v33, v33, s31, -v63
    v_exp_f32 v30, v30
    v_exp_f32 v31, v31
    v_exp_f32 v32, v32
    v_exp_f32 v33, v33
    v_add_f32 v62, v30, v31
    v_add_f32 v63, v32, v33
    v_mov_b32 v64, v62
    v_mov_b32 v65, v63
    s_nop 0
    v_permlane16_swap_b32 v62, v64
    v_permlane16_swap_b32 v63, v65
    v_add_f32 v62, v62, v64
    v_add_f32 v63, v63, v65
    v_mov_b32 v64, v62
    v_mov_b32 v65, v63
    s_nop 0
    v_permlane32_swap_b32 v62, v64
    v_permlane32_swap_b32 v63, v65
    v_add_f32 v62, v62, v64
    v_add_f32 v63, v63, v65
    v_rcp_f32 v62, v62
    v_rcp_f32 v63, v63
    v_mul_f32 v30, v30, v62
    v_mul_f32 v31, v31, v62
    v_mul_f32 v32, v32, v63
    v_mul_f32 v33, v33, v63
    v_cvt_pk_bf16_f32 v30, v30, v30
    v_cvt_pk_bf16_f32 v31, v31, v31
    v_cvt_pk_bf16_f32 v32, v32, v32
    v_cvt_pk_bf16_f32 v33, v33, v33
    v_and_b32 v38, v52, v30
    v_and_b32 v39, v53, v31
    v_and_b32 v40, v54, v30
    v_and_b32 v41, v55, v31
    ds_write_b128 v59, v[38:41] offset:49152
    v_and_b32 v42, v52, v32
    v_and_b32 v43, v53, v33
    v_and_b32 v44, v54, v32
    v_and_b32 v45, v55, v33
    ds_write_b128 v59, v[42:45] offset:50176
    ds_write_b32 v60, v5 offset:40
    s_setprio 0
    s_add_u32 m0, s50, 104448
    s_add_u32 s40, s55, 229376
    buffer_load_dwordx4 v10, s[24:27], s40 offen lds
    buffer_load_dwordx4 v11, s[24:27], s40 offen offset:1024 lds
    s_add_u32 m0, s50, 112640
    s_add_u32 s40, s55, 286720
    buffer_load_dwordx4 v10, s[24:27], s40 offen lds
    buffer_load_dwordx4 v11, s[24:27], s40 offen offset:1024 lds
    s_add_u32 m0, s50, 120832
    s_add_u32 s40, s55, 344064
    buffer_load_dwordx4 v10, s[24:27], s40 offen lds
    buffer_load_dwordx4 v11, s[24:27], s40 offen offset:1024 lds
    s_waitcnt vmcnt(0)
    s_mov_b64 exec, 1
    ds_add_u32 v5, v14 offset:12

    s_endpgm
K_spare2:
    buffer_load_dwordx4 v7, s[28:31], s53 offen nt lds
    s_add_u32 m0, m0, 1024
    s_mov_b32 s26, 401408
    s_mov_b32 s27, 0x00020000
    s_mov_b32 s34, 3670016
    s_mov_b32 s35, 0x00020000
    v_and_b32 v6, 15, v0
    v_lshlrev_b32 v6, 4, v6
    v_bfe_u32 v4, v0, 4, 2
    v_lshl_add_u32 v4, v4, 9, s42
    v_add_u32 v10, v4, v6
    v_sub_u32 v11, v4, v6
    v_add_u32 v11, 432, v11
    v_mov_b32 v12, 0
    s_and_b32 s55, s3, 3
    s_lshr_b32 s56, s3, 2
    v_and_b32 v1, 63, v0
    v_lshrrev_b32 v2, 4, v1
    v_and_b32 v3, 15, v1
    s_lshl_b32 s61, s55, 3
    v_lshrrev_b32 v4, 1, v3
    v_add_u32 v4, s61, v4
    v_and_b32 v5, 1, v3
    v_cvt_f32_u32 v79, v5
    v_mul_f32 v79, 0x3e800000, v79
    v_lshl_add_u32 v5, v4, 1, v5
    v_cmp_eq_u32 vcc, 1, v5
    s_nop 1
    v_cndmask_b32 v4, v4, 32, vcc
    v_cndmask_b32 v79, v79, 0, vcc
    v_cvt_f32_u32 v78, v4
    v_mul_f32 v78, 0x3c800000, v78
    v_lshlrev_b32 v4, 3, v2
    v_cvt_f32_u32 v4, v4
    v_fma_f32 v79, v78, v4, v79
    v_cos_f32 v100, v78
    s_nop 0
    v_add_f32 v100, v100, v100
    v_fmamk_f32 v84, v78, 0x0, v79
    v_fmamk_f32 v85, v78, 0x3f800000, v79
    v_fmamk_f32 v92, v78, 0x42000000, v79
    v_fmamk_f32 v93, v78, 0x42040000, v79
    v_cos_f32 v84, v84
    v_cos_f32 v85, v85
    v_cos_f32 v92, v92
    v_cos_f32 v93, v93
    v_fma_f32 v86, v100, v85, -v84
    v_fma_f32 v94, v100, v93, -v92
    v_fma_f32 v87, v100, v86, -v85
    v_fma_f32 v95, v100, v94, -v93
    v_fma_f32 v88, v100, v87, -v86
    v_fma_f32 v96, v100, v95, -v94
    v_fma_f32 v89, v100, v88, -v87
    v_fma_f32 v97, v100, v96, -v95
    v_fma_f32 v90, v100, v89, -v88
    v_fma_f32 v98, v100, v97, -v96
    v_fma_f32 v91, v100, v90, -v89
    v_fma_f32 v99, v100, v98, -v97
    v_cvt_pk_bf16_f32 v20, v84, v85
    v_cvt_pk_bf16_f32 v21, v86, v87
    v_cvt_pk_bf16_f32 v22, v88, v89
    v_cvt_pk_bf16_f32 v23, v90, v91
    v_cvt_pk_bf16_f32 v24, v92, v93
    v_cvt_pk_bf16_f32 v25, v94, v95
    v_cvt_pk_bf16_f32 v26, v96, v97
    v_cvt_pk_bf16_f32 v27, v98, v99
    v_lshrrev_b32 v4, 4, v0
    v_and_b32 v5, 3, v4
    v_lshlrev_b32 v5, 6, v5
    v_lshlrev_b32 v13, 1, v6
    v_xor_b32 v13, v13, v5
    v_bfe_u32 v5, v4, 3, 1
    v_lshl_add_u32 v13, v5, 4, v13
    v_lshl_add_u32 v13, v4, 9, v13
    v_add_u32 v13, 65536, v13
    v_xor_b32 v14, 16, v13
    v_lshrrev_b32 v4, 2, v3
    v_lshl_add_u32 v5, v2, 3, v4
    v_lshlrev_b32 v5, 9, v5
    v_lshl_add_u32 v5, v4, 6, v5
    v_and_b32 v4, 1, v1
    v_lshl_add_u32 v5, v4, 5, v5
    v_bfe_u32 v4, v1, 1, 1
    v_lshl_add_u32 v5, v4, 3, v5
    v_and_b32 v4, 1, v2
    v_xor_b32 v4, s56, v4
    v_lshl_add_u32 v16, v4, 4, v5
    v_add_u32 v16, 65536, v16
    v_xor_b32 v17, 64, v16
    v_xor_b32 v18, 128, v16
    v_xor_b32 v19, 192, v16
    v_lshlrev_b32 v15, 16, v2
    v_lshrrev_b32 v4, 3, v3
    v_lshl_add_u32 v15, v4, 13, v15
    v_and_b32 v4, 7, v3
    v_lshl_add_u32 v15, v4, 4, v15
    v_lshlrev_b32 v68, 16, v4
    v_mov_b32 v5, 0xffff0000
    v_add_u32 v69, s56, v3
    v_cmp_eq_u32 vcc, 0, v69
    s_nop 1
    v_cndmask_b32 v69, v5, 0, vcc
    v_add_u32 v4, 256, v11
    v_cmp_eq_u32 vcc, 15, v3
    s_nop 1
    v_cndmask_b32 v11, v11, v4, vcc
    s_lshl_b32 s59, s55, 18
    s_lshl_b32 s61, s56, 14
    s_add_u32 s59, s59, s61
    s_lshl_b32 s61, s8, 7
    buffer_load_dwordx4 v7, s[28:31], s54 offen nt lds
    s_add_u32 m0, m0, 1024
    s_add_u32 s59, s59, s61
    s_add_u32 s59, s59, 1048576
    s_mov_b32 s57, s56
    s_add_u32 s63, s8, 1024
    s_cmp_eq_u32 s8, 0
    s_cselect_b32 s63, 32, s63
    s_cmp_eq_u32 s57, 0
    s_cselect_b32 s58, s8, s63
    v_lshl_add_u32 v4, v3, 6, s58
    v_cvt_f32_u32 v78, v4
    v_mul_f32 v78, 0x3a000000, v78
    v_lshlrev_b32 v4, 3, v2
    v_cvt_f32_u32 v4, v4
    v_mul_f32 v79, v78, v4
    v_cos_f32 v100, v78
    s_nop 0
    v_add_f32 v100, v100, v100
    v_fmamk_f32 v84, v78, 0x0, v79
    v_fmamk_f32 v85, v78, 0x3f800000, v79
    v_fmamk_f32 v92, v78, 0x0, v79
    v_fmamk_f32 v93, v78, 0x3f800000, v79
    v_cos_f32 v84, v84
    v_cos_f32 v85, v85
    v_sin_f32 v92, v92
    v_sin_f32 v93, v93
    v_fma_f32 v86, v100, v85, -v84
    v_fma_f32 v94, v100, v93, -v92
    v_fma_f32 v87, v100, v86, -v85
    v_fma_f32 v95, v100, v94, -v93
    v_fma_f32 v88, v100, v87, -v86
    v_fma_f32 v96, v100, v95, -v94
    v_fma_f32 v89, v100, v88, -v87
    v_fma_f32 v97, v100, v96, -v95
    v_fma_f32 v90, v100, v89, -v88
    v_fma_f32 v98, v100, v97, -v96
    v_fma_f32 v91, v100, v90, -v89
    v_fma_f32 v99, v100, v98, -v97
    v_cvt_pk_bf16_f32 v28, v84, v85
    v_cvt_pk_bf16_f32 v32, v92, v93
    v_mov_b32 v40, v28
    v_xor_b32 v36, 0x80008000, v32
    v_cvt_pk_bf16_f32 v29, v86, v87
    v_cvt_pk_bf16_f32 v33, v94, v95
    v_mov_b32 v41, v29
    buffer_load_dwordx4 v8, s[28:31], s52 offen nt lds
    s_add_u32 m0, m0, 1024
    v_xor_b32 v37, 0x80008000, v33
    v_cvt_pk_bf16_f32 v30, v88, v89
    v_cvt_pk_bf16_f32 v34, v96, v97
    v_mov_b32 v42, v30
    v_xor_b32 v38, 0x80008000, v34
    v_cvt_pk_bf16_f32 v31, v90, v91
    v_cvt_pk_bf16_f32 v35, v98, v99
    v_mov_b32 v43, v31
    v_xor_b32 v39, 0x80008000, v35
    s_cmp_eq_u32 s8, 0
    s_cbranch_scc1 S_cls0
S_reg:
    v_lshlrev_b32 v47, 4, v1
    v_and_b32 v4, 16, v1
    v_lshlrev_b32 v4, 1, v4
    v_xor_b32 v44, v47, v4
    v_xor_b32 v45, 64, v44
    v_bfe_u32 v70, v44, 4, 3
    v_xor_b32 v71, 4, v70
    s_lshr_b32 s61, s3, 1
    v_mov_b32 v5, 0xffff0000
    v_add_u32 v4, s61, v70
    v_cmp_eq_u32 s[42:43], 0, v4
    s_nop 1
    v_cndmask_b32 v72, v5, 0, s[42:43]
    v_add_u32 v4, s61, v71
    v_cmp_eq_u32 s[42:43], 0, v4
    s_nop 1
    v_cndmask_b32 v73, v5, 0, s[42:43]
    v_lshlrev_b32 v70, 16, v70
    v_lshlrev_b32 v71, 16, v71
    s_lshl_b32 s60, s8, 3
    s_add_u32 s60, s60, s3
    s_lshl_b32 s60, s60, 12
    s_add_u32 s60, s60, 1048576
    v_lshrrev_b32 v4, 2, v3
    v_lshl_add_u32 v4, v2, 3, v4
    v_lshlrev_b32 v4, 7, v4
    v_and_b32 v5, 3, v1
    v_lshl_add_u32 v4, v5, 3, v4
    v_bfe_u32 v5, v1, 3, 2
    v_lshl_add_u32 v4, v5, 5, v4
    s_lshl_b32 s61, s55, 13
    s_add_u32 s61, s61, 0
    v_add_u32 v46, s61, v4
    v_mov_b32 v52, 81920
    buffer_load_dwordx4 v8, s[28:31], 0 offen nt lds
    s_add_u32 m0, m0, 1024
    v_lshl_add_u32 v52, s56, 2, v52
    v_mov_b32 v59, 1
    s_lshl_b32 s61, s56, 11
    v_add_u32 v53, s61, v47
    s_lshl_b32 s61, s56, 4
    v_add_u32 v4, s61, v3
    v_mul_u32_u24 v4, 528, v4
    v_add_u32 v4, 98304, v4
    v_lshl_add_u32 v5, s55, 2, v2
    v_lshl_add_u32 v48, v5, 4, v4
    s_waitcnt lgkmcnt(0)
    s_add_u32 s12, s10, 0x5a3c9671
    s_xor_b32 s13, s11, 0x2b7e1516
    s_lshl_b32 s51, s12, 12
    s_xor_b32 s51, s51, s13
    s_and_b32 s51, s51, 0xbfff0000
    v_xor_b32 v68, s51, v68

    s_waitcnt vmcnt(4)
    ds_read_b128 v[102:105], v10 offset:0
    ds_read_b128 v[106:109], v11 offset:2112
    ds_read_b128 v[114:117], v10 offset:2112
    ds_read_b128 v[110:113], v11 offset:0
    s_waitcnt lgkmcnt(2)
    v_mov_b32 v118, v102
    v_lshlrev_b32 v122, 16, v103
    v_lshlrev_b32 v136, 16, v109
    v_and_b32 v123, 0xffff0000, v103
    v_and_b32 v137, 0xffff0000, v108
    v_pk_add_f32 v[122:123], v[122:123], v[136:137]
    v_mov_b32_dpp v118, v106 row_shr:1 row_mask:0xf bank_mask:0xf
    v_lshlrev_b32 v124, 16, v104
    v_lshlrev_b32 v136, 16, v108
    v_and_b32 v125, 0xffff0000, v104
    v_and_b32 v137, 0xffff0000, v107
    v_pk_add_f32 v[124:125], v[124:125], v[136:137]
    v_lshlrev_b32 v126, 16, v105
    v_lshlrev_b32 v136, 16, v107
    v_and_b32 v127, 0xffff0000, v105
    v_and_b32 v137, 0xffff0000, v106
    v_pk_add_f32 v[126:127], v[126:127], v[136:137]
    v_lshlrev_b32 v120, 16, v102
    v_lshlrev_b32 v136, 16, v118
    v_and_b32 v121, 0xffff0000, v102
    v_and_b32 v137, 0xffff0000, v109
    v_pk_add_f32 v[120:121], v[120:121], v[136:137]
    s_waitcnt lgkmcnt(0)
    v_lshlrev_b32 v130, 16, v115
    v_lshlrev_b32 v136, 16, v113
    v_and_b32 v131, 0xffff0000, v115
    v_and_b32 v137, 0xffff0000, v112
    v_pk_add_f32 v[130:131], v[130:131], v[136:137]
    v_mov_b32_dpp v119, v110 row_ror:1 row_mask:0xf bank_mask:0xf
    v_lshlrev_b32 v132, 16, v116
    v_lshlrev_b32 v136, 16, v112
    v_and_b32 v133, 0xffff0000, v116
    v_and_b32 v137, 0xffff0000, v111
    v_pk_add_f32 v[132:133], v[132:133], v[136:137]
    v_lshlrev_b32 v134, 16, v117
    v_lshlrev_b32 v136, 16, v111
    v_and_b32 v135, 0xffff0000, v117
    v_and_b32 v137, 0xffff0000, v110
    v_pk_add_f32 v[134:135], v[134:135], v[136:137]
    v_lshlrev_b32 v128, 16, v114
    v_lshlrev_b32 v136, 16, v119
    v_and_b32 v129, 0xffff0000, v114
    v_and_b32 v137, 0xffff0000, v113
    v_pk_add_f32 v[128:129], v[128:129], v[136:137]
    v_pk_add_f32 v[146:147], v[120:121], v[128:129]
    v_pk_add_f32 v[148:149], v[122:123], v[130:131]
    v_pk_add_f32 v[150:151], v[124:125], v[132:133]
    v_pk_add_f32 v[152:153], v[126:127], v[134:135]
    v_cvt_pk_bf16_f32 v138, v146, v148
    v_cvt_pk_bf16_f32 v139, v150, v152
    v_cvt_pk_bf16_f32 v140, v147, v149
    v_cvt_pk_bf16_f32 v141, v151, v153
    ds_write_b128 v13, v[138:141] offset:0
    v_pk_add_f32 v[146:147], v[120:121], v[128:129] neg_lo:[0,1] neg_hi:[0,1]
    v_pk_add_f32 v[148:149], v[122:123], v[130:131] neg_lo:[0,1] neg_hi:[0,1]
    v_pk_add_f32 v[150:151], v[124:125], v[132:133] neg_lo:[0,1] neg_hi:[0,1]
    v_pk_add_f32 v[152:153], v[126:127], v[134:135] neg_lo:[0,1] neg_hi:[0,1]
    v_cvt_pk_bf16_f32 v142, v146, v148
    v_cvt_pk_bf16_f32 v143, v150, v152
    v_cvt_pk_bf16_f32 v144, v147, v149
    v_cvt_pk_bf16_f32 v145, v151, v153
    ds_write_b128 v14, v[142:145] offset:0
    s_waitcnt lgkmcnt(0)
    s_barrier
    ds_read_b64_tr_b16 v[154:155], v16 offset:0
    ds_read_b64_tr_b16 v[156:157], v16 offset:2048
    ds_read_b64_tr_b16 v[158:159], v17 offset:0
    ds_read_b64_tr_b16 v[160:161], v17 offset:2048
    ds_read_b64_tr_b16 v[162:163], v18 offset:0
    ds_read_b64_tr_b16 v[164:165], v18 offset:2048
    ds_read_b64_tr_b16 v[166:167], v19 offset:0
    ds_read_b64_tr_b16 v[168:169], v19 offset:2048
    s_waitcnt lgkmcnt(6)
    v_mfma_f32_16x16x32_bf16 v[170:173], v[20:23], v[154:157], 0
    ds_read_b64_tr_b16 v[154:155], v16 offset:256
    ds_read_b64_tr_b16 v[156:157], v16 offset:2304
    s_waitcnt lgkmcnt(6)
    v_mfma_f32_16x16x32_bf16 v[174:177], v[20:23], v[158:161], 0
    ds_read_b64_tr_b16 v[158:159], v17 offset:256
    ds_read_b64_tr_b16 v[160:161], v17 offset:2304
    s_waitcnt lgkmcnt(6)
    v_mfma_f32_16x16x32_bf16 v[178:181], v[20:23], v[162:165], 0
    ds_read_b64_tr_b16 v[162:163], v18 offset:256
    ds_read_b64_tr_b16 v[164:165], v18 offset:2304
    s_waitcnt lgkmcnt(6)
    v_mfma_f32_16x16x32_bf16 v[182:185], v[20:23], v[166:169], 0
    ds_read_b64_tr_b16 v[166:167], v19 offset:256
    ds_read_b64_tr_b16 v[168:169], v19 offset:2304
    s_waitcnt lgkmcnt(6)
    v_mfma_f32_16x16x32_bf16 v[186:189], v[20:23], v[154:157], 0
    s_waitcnt lgkmcnt(4)
    v_mfma_f32_16x16x32_bf16 v[190:193], v[20:23], v[158:161], 0
    s_waitcnt lgkmcnt(2)
    v_mfma_f32_16x16x32_bf16 v[194:197], v[20:23], v[162:165], 0
    s_waitcnt lgkmcnt(0)
    v_mfma_f32_16x16x32_bf16 v[198:201], v[20:23], v[166:169], 0
    s_waitcnt vmcnt(0)
    ds_read_b128 v[102:105], v10 offset:4096
    ds_read_b128 v[106:109], v11 offset:6208
    ds_read_b128 v[114:117], v10 offset:6208
    ds_read_b128 v[110:113], v11 offset:4096
    s_waitcnt lgkmcnt(2)
    v_mov_b32 v118, v102
    v_lshlrev_b32 v122, 16, v103
    v_lshlrev_b32 v136, 16, v109
    v_and_b32 v123, 0xffff0000, v103
    v_and_b32 v137, 0xffff0000, v108
    v_pk_add_f32 v[122:123], v[122:123], v[136:137]
    v_mov_b32_dpp v118, v106 row_shr:1 row_mask:0xf bank_mask:0xf
    v_lshlrev_b32 v124, 16, v104
    v_lshlrev_b32 v136, 16, v108
    v_and_b32 v125, 0xffff0000, v104
    v_and_b32 v137, 0xffff0000, v107
    v_pk_add_f32 v[124:125], v[124:125], v[136:137]
    v_lshlrev_b32 v126, 16, v105
    v_lshlrev_b32 v136, 16, v107
    v_and_b32 v127, 0xffff0000, v105
    v_and_b32 v137, 0xffff0000, v106
    v_pk_add_f32 v[126:127], v[126:127], v[136:137]
    v_lshlrev_b32 v120, 16, v102
    v_lshlrev_b32 v136, 16, v118
    v_and_b32 v121, 0xffff0000, v102
    v_and_b32 v137, 0xffff0000, v109
    v_pk_add_f32 v[120:121], v[120:121], v[136:137]
    s_waitcnt lgkmcnt(0)
    v_lshlrev_b32 v130, 16, v115
    v_lshlrev_b32 v136, 16, v113
    v_and_b32 v131, 0xffff0000, v115
    v_and_b32 v137, 0xffff0000, v112
    v_pk_add_f32 v[130:131], v[130:131], v[136:137]
    v_mov_b32_dpp v119, v110 row_ror:1 row_mask:0xf bank_mask:0xf
    v_lshlrev_b32 v132, 16, v116
    v_lshlrev_b32 v136, 16, v112
    v_and_b32 v133, 0xffff0000, v116
    v_and_b32 v137, 0xffff0000, v111
    v_pk_add_f32 v[132:133], v[132:133], v[136:137]
    v_lshlrev_b32 v134, 16, v117
    v_lshlrev_b32 v136, 16, v111
    v_and_b32 v135, 0xffff0000, v117
    v_and_b32 v137, 0xffff0000, v110
    v_pk_add_f32 v[134:135], v[134:135], v[136:137]
    v_lshlrev_b32 v128, 16, v114
    v_lshlrev_b32 v136, 16, v119
    v_and_b32 v129, 0xffff0000, v114
    v_and_b32 v137, 0xffff0000, v113
    v_pk_add_f32 v[128:129], v[128:129], v[136:137]
    v_pk_add_f32 v[146:147], v[120:121], v[128:129]
    v_pk_add_f32 v[148:149], v[122:123], v[130:131]
    v_pk_add_f32 v[150:151], v[124:125], v[132:133]
    v_pk_add_f32 v[152:153], v[126:127], v[134:135]
    v_cvt_pk_bf16_f32 v138, v146, v148
    v_cvt_pk_bf16_f32 v139, v150, v152
    v_cvt_pk_bf16_f32 v140, v147, v149
    v_cvt_pk_bf16_f32 v141, v151, v153
    ds_write_b128 v13, v[138:141] offset:16384
    v_pk_add_f32 v[146:147], v[120:121], v[128:129] neg_lo:[0,1] neg_hi:[0,1]
    v_pk_add_f32 v[148:149], v[122:123], v[130:131] neg_lo:[0,1] neg_hi:[0,1]
    v_pk_add_f32 v[150:151], v[124:125], v[132:133] neg_lo:[0,1] neg_hi:[0,1]
    v_pk_add_f32 v[152:153], v[126:127], v[134:135] neg_lo:[0,1] neg_hi:[0,1]
    v_cvt_pk_bf16_f32 v142, v146, v148
    v_cvt_pk_bf16_f32 v143, v150, v152
    v_cvt_pk_bf16_f32 v144, v147, v149
    v_cvt_pk_bf16_f32 v145, v151, v153
    ds_write_b128 v14, v[142:145] offset:16384
    s_cmp_lg_u32 s3, 0
    s_cbranch_scc1 S_nw
    s_lshl_b32 s40, s8, 7
    s_add_u32 s40, s40, 32768
    buffer_load_dword v255, v12, s[36:39], s40 offen
S_nw:
    s_waitcnt lgkmcnt(0)
    s_barrier
    ds_read_b64_tr_b16 v[154:155], v16 offset:16384
    ds_read_b64_tr_b16 v[156:157], v16 offset:18432
    ds_read_b64_tr_b16 v[158:159], v17 offset:16384
    ds_read_b64_tr_b16 v[160:161], v17 offset:18432
    ds_read_b64_tr_b16 v[162:163], v18 offset:16384
    ds_read_b64_tr_b16 v[164:165], v18 offset:18432
    ds_read_b64_tr_b16 v[166:167], v19 offset:16384
    ds_read_b64_tr_b16 v[168:169], v19 offset:18432
    s_waitcnt lgkmcnt(6)
    v_mfma_f32_16x16x32_bf16 v[170:173], v[24:27], v[154:157], v[170:173]
    ds_read_b64_tr_b16 v[154:155], v16 offset:16640
    ds_read_b64_tr_b16 v[156:157], v16 offset:18688
    s_waitcnt lgkmcnt(6)
    v_mfma_f32_16x16x32_bf16 v[174:177], v[24:27], v[158:161], v[174:177]
    ds_read_b64_tr_b16 v[158:159], v17 offset:16640
    ds_read_b64_tr_b16 v[160:161], v17 offset:18688
    s_waitcnt lgkmcnt(6)
    v_mfma_f32_16x16x32_bf16 v[178:181], v[24:27], v[162:165], v[178:181]
    ds_read_b64_tr_b16 v[162:163], v18 offset:16640
    ds_read_b64_tr_b16 v[164:165], v18 offset:18688
    s_waitcnt lgkmcnt(6)
    v_mfma_f32_16x16x32_bf16 v[182:185], v[24:27], v[166:169], v[182:185]
    ds_read_b64_tr_b16 v[166:167], v19 offset:16640
    ds_read_b64_tr_b16 v[168:169], v19 offset:18688
    s_waitcnt lgkmcnt(6)
    v_mfma_f32_16x16x32_bf16 v[186:189], v[24:27], v[154:157], v[186:189]
    s_waitcnt lgkmcnt(4)
    v_mfma_f32_16x16x32_bf16 v[190:193], v[24:27], v[158:161], v[190:193]
    s_waitcnt lgkmcnt(2)
    v_mfma_f32_16x16x32_bf16 v[194:197], v[24:27], v[162:165], v[194:197]
    s_waitcnt lgkmcnt(0)
    v_mfma_f32_16x16x32_bf16 v[198:201], v[24:27], v[166:169], v[198:201]
    v_cvt_pk_bf16_f32 v102, v170, v174
    v_cvt_pk_bf16_f32 v103, v178, v182
    s_nop 1
    v_cvt_pk_bf16_f32 v104, v186, v190
    s_nop 2
    v_cvt_pk_bf16_f32 v105, v194, v198
    v_bfi_b32 v105, v69, v68, v105
    s_add_u32 s41, s59, 0
    buffer_store_dwordx4 v[102:105], v15, s[36:39], s41 offen sc1
    v_cvt_pk_bf16_f32 v106, v171, v175
    v_cvt_pk_bf16_f32 v107, v179, v183
    v_cvt_pk_bf16_f32 v108, v187, v191
    v_cvt_pk_bf16_f32 v109, v195, v199
    v_bfi_b32 v109, v69, v68, v109
    s_add_u32 s41, s59, 4096
    buffer_store_dwordx4 v[106:109], v15, s[36:39], s41 offen sc1
    v_cvt_pk_bf16_f32 v110, v172, v176
    v_cvt_pk_bf16_f32 v111, v180, v184
    v_cvt_pk_bf16_f32 v112, v188, v192
    v_cvt_pk_bf16_f32 v113, v196, v200
    v_bfi_b32 v113, v69, v68, v113
    s_add_u32 s41, s59, 32768
    buffer_store_dwordx4 v[110:113], v15, s[36:39], s41 offen sc1
    v_cvt_pk_bf16_f32 v114, v173, v177
    v_cvt_pk_bf16_f32 v115, v181, v185
    v_cvt_pk_bf16_f32 v116, v189, v193
    v_cvt_pk_bf16_f32 v117, v197, v201
    v_bfi_b32 v117, v69, v68, v117
    s_add_u32 s41, s59, 36864
    buffer_store_dwordx4 v[114:117], v15, s[36:39], s41 offen sc1
    s_barrier
    s_cmp_lg_u32 s3, 0
    s_cbranch_scc1 S_nf
    v_mov_b32 v74, s12
    v_mov_b32 v75, s13
    s_lshl_b32 s40, s8, 7
    s_add_u32 s40, s40, 32768
    v_lshlrev_b32 v76, 3, v3
    s_mov_b64 exec, 1
    buffer_store_dwordx2 v[74:75], v76, s[36:39], s40 offen sc1
    s_mov_b64 exec, -1
    v_lshlrev_b32 v76, 2, v3
    v_add_u32 v76, 81920, v76
    ds_write_b32 v76, v12
        S_nf:

    s_and_b32 s61, s3, 1
    s_lshl_b32 s61, s61, 3
    v_lshrrev_b32 v4, 3, v1
    v_add_u32 v4, s61, v4
    v_and_b32 v5, 7, v1
    v_lshlrev_b32 v5, 4, v5
    s_and_b32 s61, s3, 2
    s_add_u32 s61, s61, s56
    s_mul_i32 s61, s61, 8448
    s_add_u32 s61, s61, 98304
    v_mul_u32_u24 v78, 528, v4
    v_add3_u32 v49, v78, v5, s61
    v_add_u32 v79, s61, v78
    s_bitcmp1_b32 s3, 1
    s_cselect_b32 s62, -1, 1
    s_mul_i32 s62, s62, 16896
    v_add_u32 v55, s62, v79
    s_cmp_eq_u32 s56, 0
    s_cselect_b32 s61, s8, s63
    v_lshl_add_u32 v50, v4, 6, s61
    v_sub_u32 v78, 2048, v50
    v_mov_b32 v4, 1024
    v_cmp_eq_u32 s[42:43], 0, v50
    s_nop 1
    v_cndmask_b32 v78, v78, v4, s[42:43]
    v_cndmask_b32 v55, v55, v79, s[42:43]
    s_bitcmp1_b32 s3, 1
    s_cselect_b64 s[42:43], -1, 0
    v_cndmask_b32 v50, v50, v78, s[42:43]
    v_mov_b32 v78, 1792
    v_mad_u32_u24 v50, v50, v78, v5
    v_sub_u32 v55, v55, v5
    v_and_b32 v4, 4, v1
    v_lshl_add_u32 v54, v4, 5, v49
    v_lshl_add_u32 v57, v4, 5, v50
    v_lshlrev_b32 v4, 4, v4
    v_sub_u32 v56, v55, v4
    v_mov_b32 v58, 0xffff
    s_lshl_b32 s61, s55, 14
    s_add_u32 s61, s61, 98304
    v_add_u32 v51, s61, v47
    v_cmp_eq_u32 s[42:43], 0, v2
    s_nop 1
    v_cndmask_b32 v80, 1.0, 0.5, s[42:43]
    v_and_b32 v4, 1, v2
    v_mov_b32 v5, 0xffff
    v_cmp_eq_u32 s[42:43], 1, v4
    s_nop 1
    v_cndmask_b32 v83, -1, v5, s[42:43]
    v_cndmask_b32 v78, 1.0, 0, s[42:43]
    v_cmp_eq_u32 s[42:43], 1, v2
    s_nop 1
    v_cndmask_b32 v79, v78, 0.5, s[42:43]
    s_cmp_eq_u32 s56, 0
    s_cselect_b64 s[42:43], -1, 0
    v_cndmask_b32 v81, v78, v79, s[42:43]
    v_cndmask_b32 v82, v79, v78, s[42:43]
    v_lshlrev_b32 v4, 6, v4
    v_and_b32 v5, 2, v2
    v_add_u32 v4, v4, v5
    v_cvt_f32_u32 v79, v4
    s_lshl_b32 s61, s55, 5
    s_add_u32 s61, s61, s56
    v_lshl_add_u32 v4, v3, 1, s61
    v_cvt_f32_u32 v78, v4
    v_mul_f32 v78, 0x3b124925, v78
    v_mul_f32 v79, v78, v79
    s_lshl_b32 s61, s56, 13
    v_add_u32 v5, s61, v51
    v_mul_f32 v100, 0x40800000, v78
    v_cos_f32 v100, v100
    s_nop 0
    v_add_f32 v100, v100, v100
    v_fmamk_f32 v84, v78, 0x0, v79
    v_fmamk_f32 v85, v78, 0x40800000, v79
    v_cos_f32 v84, v84
    v_cos_f32 v85, v85
    s_nop 0
    v_fma_f32 v86, v100, v85, -v84
    v_fma_f32 v87, v100, v86, -v85
    v_fma_f32 v88, v100, v87, -v86
    v_fma_f32 v89, v100, v88, -v87
    v_fma_f32 v90, v100, v89, -v88
    v_fma_f32 v91, v100, v90, -v89
    v_fma_f32 v92, v100, v91, -v90
    v_fma_f32 v93, v100, v92, -v91
    v_fma_f32 v94, v100, v93, -v92
    v_fma_f32 v95, v100, v94, -v93
    v_fma_f32 v96, v100, v95, -v94
    v_fma_f32 v97, v100, v96, -v95
    v_fma_f32 v98, v100, v97, -v96
    v_fma_f32 v99, v100, v98, -v97
    v_mul_f32 v84, v84, v80
    v_mul_f32 v96, v96, v81
    v_cvt_pk_bf16_f32 v60, v84, v88
    v_cvt_pk_bf16_f32 v61, v92, v96
    v_cvt_pk_bf16_f32 v62, v85, v89
    v_cvt_pk_bf16_f32 v63, v93, v97
    v_and_b32 v63, v83, v63
    ds_write_b128 v5, v[60:63] offset:0
    v_cvt_pk_bf16_f32 v64, v86, v90
    v_cvt_pk_bf16_f32 v65, v94, v98
    v_cvt_pk_bf16_f32 v66, v87, v91
    v_cvt_pk_bf16_f32 v67, v95, v99
    v_and_b32 v65, v83, v65
    v_and_b32 v67, v83, v67
    ds_write_b128 v5, v[64:67] offset:1024
    v_fmamk_f32 v84, v78, 0x0, v79
    v_fmamk_f32 v85, v78, 0x40800000, v79
    v_sin_f32 v84, v84
    v_sin_f32 v85, v85
    s_nop 0
    v_fma_f32 v86, v100, v85, -v84
    v_fma_f32 v87, v100, v86, -v85
    v_fma_f32 v88, v100, v87, -v86
    v_fma_f32 v89, v100, v88, -v87
    v_fma_f32 v90, v100, v89, -v88
    v_fma_f32 v91, v100, v90, -v89
    v_fma_f32 v92, v100, v91, -v90
    v_fma_f32 v93, v100, v92, -v91
    v_fma_f32 v94, v100, v93, -v92
    v_fma_f32 v95, v100, v94, -v93
    v_fma_f32 v96, v100, v95, -v94
    v_fma_f32 v97, v100, v96, -v95
    v_fma_f32 v98, v100, v97, -v96
    v_fma_f32 v99, v100, v98, -v97
    v_mul_f32 v96, v96, v82
    v_cvt_pk_bf16_f32 v60, v84, v88
    v_cvt_pk_bf16_f32 v61, v92, v96
    v_cvt_pk_bf16_f32 v62, v85, v89
    v_cvt_pk_bf16_f32 v63, v93, v97
    v_and_b32 v63, v83, v63
    ds_write_b128 v5, v[60:63] offset:4096
    v_cvt_pk_bf16_f32 v64, v86, v90
    v_cvt_pk_bf16_f32 v65, v94, v98
    v_cvt_pk_bf16_f32 v66, v87, v91
    v_cvt_pk_bf16_f32 v67, v95, v99
    v_and_b32 v65, v83, v65
    v_and_b32 v67, v83, v67
    ds_write_b128 v5, v[64:67] offset:5120
    v_fmamk_f32 v84, v78, 0x3f800000, v79
    v_fmamk_f32 v85, v78, 0x40a00000, v79
    v_cos_f32 v84, v84
    v_cos_f32 v85, v85
    s_nop 0
    v_fma_f32 v86, v100, v85, -v84
    v_fma_f32 v87, v100, v86, -v85
    v_fma_f32 v88, v100, v87, -v86
    v_fma_f32 v89, v100, v88, -v87
    v_fma_f32 v90, v100, v89, -v88
    v_fma_f32 v91, v100, v90, -v89
    v_fma_f32 v92, v100, v91, -v90
    v_fma_f32 v93, v100, v92, -v91
    v_fma_f32 v94, v100, v93, -v92
    v_fma_f32 v95, v100, v94, -v93
    v_fma_f32 v96, v100, v95, -v94
    v_fma_f32 v97, v100, v96, -v95
    v_fma_f32 v98, v100, v97, -v96
    v_fma_f32 v99, v100, v98, -v97
    v_cvt_pk_bf16_f32 v60, v84, v88
    v_cvt_pk_bf16_f32 v61, v92, v96
    v_cvt_pk_bf16_f32 v62, v85, v89
    v_cvt_pk_bf16_f32 v63, v93, v97
    v_and_b32 v61, v83, v61
    v_and_b32 v63, v83, v63
    ds_write_b128 v5, v[60:63] offset:2048
    v_cvt_pk_bf16_f32 v64, v86, v90
    v_cvt_pk_bf16_f32 v65, v94, v98
    v_cvt_pk_bf16_f32 v66, v87, v91
    v_cvt_pk_bf16_f32 v67, v95, v99
    v_and_b32 v65, v83, v65
    v_and_b32 v67, v83, v67
    ds_write_b128 v5, v[64:67] offset:3072
    v_fmamk_f32 v84, v78, 0x3f800000, v79
    v_fmamk_f32 v85, v78, 0x40a00000, v79
    v_sin_f32 v84, v84
    v_sin_f32 v85, v85
    s_nop 0
    v_fma_f32 v86, v100, v85, -v84
    v_fma_f32 v87, v100, v86, -v85
    v_fma_f32 v88, v100, v87, -v86
    v_fma_f32 v89, v100, v88, -v87
    v_fma_f32 v90, v100, v89, -v88
    v_fma_f32 v91, v100, v90, -v89
    v_fma_f32 v92, v100, v91, -v90
    v_fma_f32 v93, v100, v92, -v91
    v_fma_f32 v94, v100, v93, -v92
    v_fma_f32 v95, v100, v94, -v93
    v_fma_f32 v96, v100, v95, -v94
    v_fma_f32 v97, v100, v96, -v95
    v_fma_f32 v98, v100, v97, -v96
    v_fma_f32 v99, v100, v98, -v97
    v_cvt_pk_bf16_f32 v60, v84, v88
    v_cvt_pk_bf16_f32 v61, v92, v96
    v_cvt_pk_bf16_f32 v62, v85, v89
    v_cvt_pk_bf16_f32 v63, v93, v97
    v_and_b32 v61, v83, v61
    v_and_b32 v63, v83, v63
    ds_write_b128 v5, v[60:63] offset:6144
    v_cvt_pk_bf16_f32 v64, v86, v90
    v_cvt_pk_bf16_f32 v65, v94, v98
    v_cvt_pk_bf16_f32 v66, v87, v91
    v_cvt_pk_bf16_f32 v67, v95, v99
    v_and_b32 v65, v83, v65
    v_and_b32 v67, v83, v67
    ds_write_b128 v5, v[64:67] offset:7168
    s_cmp_lg_u32 s3, 1
    s_cbranch_scc1 P_dB
    v_and_b32 v4, 31, v1
    v_lshlrev_b32 v4, 7, v4
    s_mov_b32 s40, 32768

    s_mov_b32 s9, 0
    s_waitcnt vmcnt(0)
    buffer_load_dword v84, v4, s[36:39], s40 offen sc1
    v_mov_b32 v92, v93
    v_mov_b32 v92, v93
    v_mov_b32 v92, v93
    v_mov_b32 v92, v93
    v_mov_b32 v92, v93
    v_mov_b32 v92, v93
    v_mov_b32 v92, v93
    v_mov_b32 v92, v93
    v_mov_b32 v92, v93
    v_mov_b32 v92, v93
    v_mov_b32 v92, v93
    v_mov_b32 v92, v93
    v_mov_b32 v92, v93
    v_mov_b32 v92, v93
    v_mov_b32 v92, v93
    v_mov_b32 v92, v93
    v_mov_b32 v92, v93
    v_mov_b32 v92, v93
    v_mov_b32 v92, v93
    v_mov_b32 v92, v93
    v_mov_b32 v92, v93
    v_mov_b32 v92, v93
    v_mov_b32 v92, v93
    v_mov_b32 v92, v93
    v_mov_b32 v92, v93
    v_mov_b32 v92, v93
    v_mov_b32 v92, v93
    v_mov_b32 v92, v93
    v_mov_b32 v92, v93
    v_mov_b32 v92, v93
    v_mov_b32 v92, v93
    v_mov_b32 v92, v93
    v_mov_b32 v92, v93
    v_mov_b32 v92, v93
    v_mov_b32 v92, v93
    v_mov_b32 v92, v93
    v_mov_b32 v92, v93
    v_mov_b32 v92, v93
    v_mov_b32 v92, v93
    v_mov_b32 v92, v93
P_lB:
    buffer_load_dword v85, v4, s[36:39], s40 offen sc1
    s_waitcnt vmcnt(1)
    v_cmp_ne_u32 vcc, s12, v84
    s_nop 0
    s_cbranch_vccz P_dB
    buffer_load_dword v84, v4, s[36:39], s40 offen sc1
    s_waitcnt vmcnt(1)
    v_cmp_ne_u32 vcc, s12, v85
    s_nop 0
    s_cbranch_vccz P_dB
    s_add_u32 s9, s9, 1
    s_cmp_lt_u32 s9, 200000
    s_cbranch_scc1 P_lB
P_dB:
    s_lshl_b32 s40, s3, 12
    s_add_u32 m0, s40, 0
    s_waitcnt lgkmcnt(0)
    s_barrier
    buffer_load_dwordx4 v44, s[36:39], s60 offen offset:0 sc1 lds
    buffer_load_dwordx4 v45, s[36:39], s60 offen offset:1024 sc1 lds
    buffer_load_dwordx4 v44, s[36:39], s60 offen offset:2048 sc1 lds
    buffer_load_dwordx4 v45, s[36:39], s60 offen offset:3072 sc1 lds
    ds_read_b128 v[102:105], v51 offset:0
    ds_read_b128 v[106:109], v51 offset:1024
    ds_read_b128 v[110:113], v51 offset:2048
    ds_read_b128 v[114:117], v51 offset:3072
    ds_read_b128 v[118:121], v51 offset:4096
    ds_read_b128 v[122:125], v51 offset:5120
    ds_read_b128 v[126:129], v51 offset:6144
    ds_read_b128 v[130:133], v51 offset:7168
    ds_read_b128 v[134:137], v51 offset:8192
    ds_read_b128 v[138:141], v51 offset:9216
    ds_read_b128 v[142:145], v51 offset:10240
    ds_read_b128 v[146:149], v51 offset:11264
    ds_read_b128 v[150:153], v51 offset:12288
    ds_read_b128 v[154:157], v51 offset:13312
    ds_read_b128 v[158:161], v51 offset:14336
    ds_read_b128 v[162:165], v51 offset:15360
    v_xor_b32 v230, 32, v46
    v_xor_b32 v231, 64, v46
    v_xor_b32 v232, 96, v46
    s_lshl_b32 s40, s55, 13
    s_lshl_b32 s41, s57, 11
    s_add_u32 s40, s40, s41
    v_add_u32 v233, s40, v47
    s_lshl_b32 s40, s3, 12
    v_add_u32 v5, s40, v47
    v_xor_b32 v70, s51, v70
    v_xor_b32 v71, s51, v71
    s_mov_b32 s9, 0
        S_gc:

    s_waitcnt vmcnt(3)
    ds_read_b32 v84, v5 offset:12
    s_waitcnt vmcnt(2)
    ds_read_b32 v85, v5 offset:1036
    s_waitcnt vmcnt(1)
    ds_read_b32 v86, v5 offset:2060
    s_waitcnt vmcnt(0)
    ds_read_b32 v87, v5 offset:3084
    s_waitcnt lgkmcnt(1)
    v_xor_b32 v84, v70, v84
    v_xor_b32 v86, v70, v86
    v_xor_b32 v85, v71, v85
    v_or_b32 v84, v84, v86
    v_and_b32 v84, v72, v84
    v_and_or_b32 v84, v73, v85, v84
    s_waitcnt lgkmcnt(0)
    v_xor_b32 v87, v71, v87
    v_and_or_b32 v84, v73, v87, v84
    v_cmp_ne_u32 vcc, 0, v84
    s_nop 0
    s_cbranch_vccnz S_gr
        S_gk:
    s_barrier

    s_cmp_lg_u32 s56, 0
    s_cbranch_scc1 S_np
    s_setprio 1
S_np:
    ds_read_b64_tr_b16 v[166:167], v46 offset:0
    ds_read_b64_tr_b16 v[168:169], v46 offset:512
    ds_read_b64_tr_b16 v[170:171], v46 offset:4096
    ds_read_b64_tr_b16 v[172:173], v46 offset:4608
    ds_read_b64_tr_b16 v[174:175], v230 offset:0
    ds_read_b64_tr_b16 v[176:177], v230 offset:512
    ds_read_b64_tr_b16 v[178:179], v230 offset:4096
    ds_read_b64_tr_b16 v[180:181], v230 offset:4608
    ds_read_b64_tr_b16 v[182:183], v231 offset:0
    ds_read_b64_tr_b16 v[184:185], v231 offset:512
    ds_read_b64_tr_b16 v[186:187], v231 offset:4096
    ds_read_b64_tr_b16 v[188:189], v231 offset:4608
    ds_read_b64_tr_b16 v[190:191], v232 offset:0
    ds_read_b64_tr_b16 v[192:193], v232 offset:512
    ds_read_b64_tr_b16 v[194:195], v232 offset:4096
    ds_read_b64_tr_b16 v[196:197], v232 offset:4608
    s_waitcnt lgkmcnt(14)
    v_mfma_f32_16x16x32_bf16 v[198:201], v[166:169], v[28:31], 0
    s_waitcnt lgkmcnt(12)
    v_mfma_f32_16x16x32_bf16 v[198:201], v[170:173], v[32:35], v[198:201]
    v_mfma_f32_16x16x32_bf16 v[214:217], v[166:169], v[36:39], 0
    v_mfma_f32_16x16x32_bf16 v[214:217], v[170:173], v[40:43], v[214:217]
    s_waitcnt lgkmcnt(10)
    v_mfma_f32_16x16x32_bf16 v[202:205], v[174:177], v[28:31], 0
    s_waitcnt lgkmcnt(8)
    v_mfma_f32_16x16x32_bf16 v[202:205], v[178:181], v[32:35], v[202:205]
    v_mfma_f32_16x16x32_bf16 v[218:221], v[174:177], v[36:39], 0
    v_mfma_f32_16x16x32_bf16 v[218:221], v[178:181], v[40:43], v[218:221]
    s_waitcnt lgkmcnt(6)
    v_mfma_f32_16x16x32_bf16 v[206:209], v[182:185], v[28:31], 0
    s_waitcnt lgkmcnt(4)
    v_mfma_f32_16x16x32_bf16 v[206:209], v[186:189], v[32:35], v[206:209]
    v_cvt_pk_bf16_f32 v234, v198, v199
    v_cvt_pk_bf16_f32 v235, v200, v201
    v_cvt_pk_bf16_f32 v236, v202, v203
    v_cvt_pk_bf16_f32 v237, v204, v205
    ds_write_b128 v233, v[234:237] offset:32768
    v_mfma_f32_16x16x32_bf16 v[222:225], v[182:185], v[36:39], 0
    v_mfma_f32_16x16x32_bf16 v[222:225], v[186:189], v[40:43], v[222:225]
    v_cvt_pk_bf16_f32 v238, v214, v215
    v_cvt_pk_bf16_f32 v239, v216, v217
    v_cvt_pk_bf16_f32 v240, v218, v219
    v_cvt_pk_bf16_f32 v241, v220, v221
    ds_write_b128 v233, v[238:241] offset:36864
    s_waitcnt lgkmcnt(4)
    v_mfma_f32_16x16x32_bf16 v[210:213], v[190:193], v[28:31], 0
    s_waitcnt lgkmcnt(2)
    v_mfma_f32_16x16x32_bf16 v[210:213], v[194:197], v[32:35], v[210:213]
    v_mfma_f32_16x16x32_bf16 v[226:229], v[190:193], v[36:39], 0
    v_mfma_f32_16x16x32_bf16 v[226:229], v[194:197], v[40:43], v[226:229]
    s_add_u32 s40, s8, s57
    s_cmp_eq_u32 s40, 0
    s_cbranch_scc1 S_x0
S_x1:
    v_cvt_pk_bf16_f32 v166, v206, v207
    v_cvt_pk_bf16_f32 v167, v208, v209
    s_nop 0
    v_cvt_pk_bf16_f32 v168, v210, v211
    v_cvt_pk_bf16_f32 v169, v212, v213
    ds_write_b128 v233, v[166:169] offset:33792
    v_cvt_pk_bf16_f32 v170, v222, v223
    v_cvt_pk_bf16_f32 v171, v224, v225
    v_cvt_pk_bf16_f32 v172, v226, v227
    v_cvt_pk_bf16_f32 v173, v228, v229
    ds_write_b128 v233, v[170:173] offset:37888
    s_mov_b64 exec, 1
    ds_add_u32 v52, v59 offset:8
    s_mov_b64 exec, -1
    s_mov_b32 s9, 0
        W_lU:
    ds_read_b32 v4, v52 offset:8
    s_add_u32 s9, s9, 1
    s_cmp_gt_u32 s9, 1600000
    s_cbranch_scc1 W_dU
    s_waitcnt lgkmcnt(0)
    v_cmp_gt_u32 vcc, 4, v4
    s_nop 0
    s_cbranch_vccnz W_lU
        W_dU:

    ds_read_b128 v[166:169], v53 offset:32768
    ds_read_b128 v[170:173], v53 offset:33792
    ds_read_b128 v[174:177], v53 offset:40960
    ds_read_b128 v[178:181], v53 offset:41984
    ds_read_b128 v[182:185], v53 offset:49152
    ds_read_b128 v[186:189], v53 offset:50176
    ds_read_b128 v[190:193], v53 offset:57344
    s_waitcnt lgkmcnt(6)
    v_mfma_f32_16x16x32_bf16 v[198:201], v[102:105], v[166:169], 0
    ds_read_b128 v[194:197], v53 offset:58368
    s_waitcnt lgkmcnt(6)
    v_mfma_f32_16x16x32_bf16 v[198:201], v[106:109], v[170:173], v[198:201]
    ds_read_b128 v[166:169], v53 offset:53248
    s_waitcnt lgkmcnt(6)
    v_mfma_f32_16x16x32_bf16 v[202:205], v[110:113], v[174:177], 0
    ds_read_b128 v[170:173], v53 offset:54272
    s_waitcnt lgkmcnt(6)
    v_mfma_f32_16x16x32_bf16 v[202:205], v[114:117], v[178:181], v[202:205]
    ds_read_b128 v[174:177], v53 offset:61440
    s_waitcnt lgkmcnt(6)
    v_mfma_f32_16x16x32_bf16 v[214:217], v[134:137], v[182:185], 0
    ds_read_b128 v[178:181], v53 offset:62464
    s_waitcnt lgkmcnt(6)
    v_mfma_f32_16x16x32_bf16 v[214:217], v[138:141], v[186:189], v[214:217]
    ds_read_b128 v[182:185], v53 offset:36864
    s_waitcnt lgkmcnt(6)
    v_mfma_f32_16x16x32_bf16 v[218:221], v[142:145], v[190:193], 0
    ds_read_b128 v[186:189], v53 offset:37888
    s_waitcnt lgkmcnt(6)
    v_mfma_f32_16x16x32_bf16 v[218:221], v[146:149], v[194:197], v[218:221]
    ds_read_b128 v[190:193], v53 offset:45056
    s_waitcnt lgkmcnt(6)
    v_mfma_f32_16x16x32_bf16 v[206:209], v[118:121], v[166:169], 0
    ds_read_b128 v[194:197], v53 offset:46080
    s_waitcnt lgkmcnt(6)
    v_mfma_f32_16x16x32_bf16 v[206:209], v[122:125], v[170:173], v[206:209]
    s_waitcnt lgkmcnt(5)
    v_mfma_f32_16x16x32_bf16 v[210:213], v[126:129], v[174:177], 0
    v_pk_add_f32 v[84:85], v[198:199], v[202:203]
    v_pk_add_f32 v[86:87], v[200:201], v[204:205]
    s_waitcnt lgkmcnt(4)
    v_mfma_f32_16x16x32_bf16 v[210:213], v[130:133], v[178:181], v[210:213]
    v_pk_add_f32 v[202:203], v[198:199], v[202:203] neg_lo:[0,1] neg_hi:[0,1]
    v_pk_add_f32 v[204:205], v[200:201], v[204:205] neg_lo:[0,1] neg_hi:[0,1]
    s_waitcnt lgkmcnt(3)
    v_mfma_f32_16x16x32_bf16 v[222:225], v[150:153], v[182:185], 0
    v_pk_add_f32 v[88:89], v[214:215], v[218:219]
    s_waitcnt lgkmcnt(2)
    v_mfma_f32_16x16x32_bf16 v[222:225], v[154:157], v[186:189], v[222:225]
    v_pk_add_f32 v[90:91], v[216:217], v[220:221]
    s_waitcnt lgkmcnt(1)
    v_mfma_f32_16x16x32_bf16 v[226:229], v[158:161], v[190:193], 0
    v_pk_add_f32 v[218:219], v[214:215], v[218:219] neg_lo:[0,1] neg_hi:[0,1]
    s_waitcnt lgkmcnt(0)
    v_mfma_f32_16x16x32_bf16 v[226:229], v[162:165], v[194:197], v[226:229]
    v_pk_add_f32 v[220:221], v[216:217], v[220:221] neg_lo:[0,1] neg_hi:[0,1]
    s_add_u32 s40, s8, s56
    s_cmp_eq_u32 s40, 0
    s_cbranch_scc1 S_y0
S_y1:
    v_pk_add_f32 v[198:199], v[206:207], v[210:211]
    v_pk_add_f32 v[200:201], v[208:209], v[212:213]
    v_pk_add_f32 v[210:211], v[206:207], v[210:211] neg_lo:[0,1] neg_hi:[0,1]
    v_pk_add_f32 v[212:213], v[208:209], v[212:213] neg_lo:[0,1] neg_hi:[0,1]
    v_pk_add_f32 v[214:215], v[222:223], v[226:227]
    v_pk_add_f32 v[216:217], v[224:225], v[228:229]
    v_pk_add_f32 v[226:227], v[222:223], v[226:227] neg_lo:[0,1] neg_hi:[0,1]
    v_pk_add_f32 v[228:229], v[224:225], v[228:229] neg_lo:[0,1] neg_hi:[0,1]
    v_pk_add_f32 v[206:207], v[84:85], v[198:199]
    v_pk_add_f32 v[208:209], v[86:87], v[200:201]
    v_pk_add_f32 v[222:223], v[88:89], v[214:215]
    v_pk_add_f32 v[224:225], v[90:91], v[216:217]
    v_cvt_pk_bf16_f32 v166, v206, v222
    v_cvt_pk_bf16_f32 v167, v207, v223
    v_cvt_pk_bf16_f32 v168, v208, v224
    v_cvt_pk_bf16_f32 v169, v209, v225
    ds_write_b128 v48, v[166:169] offset:0
    v_pk_add_f32 v[206:207], v[84:85], v[198:199] neg_lo:[0,1] neg_hi:[0,1]
    v_pk_add_f32 v[208:209], v[86:87], v[200:201] neg_lo:[0,1] neg_hi:[0,1]
    v_pk_add_f32 v[222:223], v[88:89], v[214:215] neg_lo:[0,1] neg_hi:[0,1]
    v_pk_add_f32 v[224:225], v[90:91], v[216:217] neg_lo:[0,1] neg_hi:[0,1]
    v_cvt_pk_bf16_f32 v170, v206, v222
    v_cvt_pk_bf16_f32 v171, v207, v223
    v_cvt_pk_bf16_f32 v172, v208, v224
    v_cvt_pk_bf16_f32 v173, v209, v225
    ds_write_b128 v48, v[170:173] offset:16896
    v_pk_add_f32 v[206:207], v[202:203], v[210:211]
    v_pk_add_f32 v[208:209], v[204:205], v[212:213]
    v_pk_add_f32 v[222:223], v[218:219], v[226:227]
    v_pk_add_f32 v[224:225], v[220:221], v[228:229]
    v_cvt_pk_bf16_f32 v174, v206, v222
    v_cvt_pk_bf16_f32 v175, v207, v223
    v_cvt_pk_bf16_f32 v176, v208, v224
    v_cvt_pk_bf16_f32 v177, v209, v225
    ds_write_b128 v48, v[174:177] offset:256
    v_pk_add_f32 v[206:207], v[202:203], v[210:211] neg_lo:[0,1] neg_hi:[0,1]
    v_pk_add_f32 v[208:209], v[204:205], v[212:213] neg_lo:[0,1] neg_hi:[0,1]
    v_pk_add_f32 v[222:223], v[218:219], v[226:227] neg_lo:[0,1] neg_hi:[0,1]
    v_pk_add_f32 v[224:225], v[220:221], v[228:229] neg_lo:[0,1] neg_hi:[0,1]
    v_cvt_pk_bf16_f32 v178, v206, v222
    v_cvt_pk_bf16_f32 v179, v207, v223
    v_cvt_pk_bf16_f32 v180, v208, v224
    v_cvt_pk_bf16_f32 v181, v209, v225
    ds_write_b128 v48, v[178:181] offset:17152
    s_mov_b64 exec, 1
    ds_add_u32 v52, v59
    s_mov_b64 exec, -1

    s_mov_b32 s9, 0
        W_lO:
    ds_read_b32 v4, v52 offset:0
    s_add_u32 s9, s9, 1
    s_cmp_gt_u32 s9, 1600000
    s_cbranch_scc1 W_dO
    s_waitcnt lgkmcnt(0)
    v_cmp_gt_u32 vcc, 4, v4
    s_nop 0
    s_cbranch_vccnz W_lO
        W_dO:

    v_and_b32 v4, 4, v1
    v_lshl_add_u32 v5, v4, 6, v50
    ds_read_b128 v[102:105], v49 offset:0
    ds_read_b128 v[106:109], v49 offset:128
    ds_read_b128 v[110:113], v49 offset:320
    ds_read_b128 v[114:117], v54 offset:256
    ds_read_b128 v[118:121], v55 offset:432
    ds_read_b32 v122, v55 offset:448
    ds_read_b128 v[126:129], v55 offset:112
    ds_read_b32 v130, v55 offset:128
    ds_read_b128 v[134:137], v56 offset:304
    ds_read_b32 v138, v56 offset:320
    s_waitcnt lgkmcnt(9)
    buffer_store_dwordx4 v[102:105], v50, s[32:35], 0 offen offset:896 nt
    s_waitcnt lgkmcnt(8)
    buffer_store_dwordx4 v[106:109], v50, s[32:35], 0 offen offset:1024 nt
    s_waitcnt lgkmcnt(7)
    buffer_store_dwordx4 v[110:113], v50, s[32:35], 0 offen offset:1408 nt
    s_waitcnt lgkmcnt(6)
    buffer_store_dwordx4 v[114:117], v57, s[32:35], 0 offen offset:1344 nt
    s_waitcnt lgkmcnt(4)
    v_bfi_b32 v142, v58, v122, v121
    v_bfi_b32 v143, v58, v121, v120
    v_bfi_b32 v144, v58, v120, v119
    v_bfi_b32 v145, v58, v119, v118
    buffer_store_dwordx4 v[142:145], v50, s[32:35], 0 offen offset:1152 nt
    s_waitcnt lgkmcnt(2)
    v_bfi_b32 v146, v58, v130, v129
    v_bfi_b32 v147, v58, v129, v128
    v_bfi_b32 v148, v58, v128, v127
    v_bfi_b32 v149, v58, v127, v126
    buffer_store_dwordx4 v[146:149], v50, s[32:35], 0 offen offset:1664 nt
    s_waitcnt lgkmcnt(0)
    v_bfi_b32 v150, v58, v138, v137
    v_bfi_b32 v151, v58, v137, v136
    v_bfi_b32 v152, v58, v136, v135
    v_bfi_b32 v153, v58, v135, v134
    buffer_store_dwordx4 v[150:153], v5, s[32:35], 0 offen offset:1280 nt
    s_add_u32 s40, s8, s3
    s_cmp_lg_u32 s40, 0
    s_cbranch_scc1 S_end
    s_add_u32 s40, s10, 16
    v_mov_b32 v4, s40
    s_mov_b32 s40, 4096
    s_mov_b64 exec, 1
    buffer_store_dword v4, v12, s[36:39], s40 offen
        S_end:

    s_endpgm
K_c:
    s_lshl_b32 s40, s8, 7
    s_waitcnt lgkmcnt(0)
    s_load_dwordx2 s[10:11], s[36:37], s40
    s_add_u32 s14, s40, 8192
    s_getreg_b32 s52, hwreg(HW_REG_XCC_ID, 0, 3)
    s_mov_b32 s26, 401408
    s_mov_b32 s27, 0x00020000
    s_mov_b32 s34, 3670016
    s_mov_b32 s35, 0x00020000
    s_sub_u32 s62, s3, 4
    s_lshr_b32 s16, s62, 1
    s_and_b32 s17, s62, 1
    s_lshl_b32 s29, s62, 11
    v_and_b32 v1, 63, v0
    v_lshlrev_b32 v4, 4, v1
    s_mul_i32 s1, s2, 1792
    v_min_u32 v41, 13, v1
    v_lshlrev_b32 v41, 7, v41
    v_lshrrev_b32 v24, 4, v1
    v_and_b32 v25, 15, v1
    v_lshrrev_b32 v26, 3, v1
    v_and_b32 v27, 7, v1
    v_mov_b32 v5, 161792
    v_mov_b32 v6, 0
    v_lshl_add_u32 v2, v25, 2, v5
    ds_write_b32 v2, v6
    v_lshrrev_b32 v3, 1, v25
    v_xor_b32 v3, v3, v24
    v_lshlrev_b32 v3, 4, v3
    v_lshl_add_u32 v3, v25, 7, v3
    s_lshr_b32 s18, s62, 1
    s_lshl_b32 s18, s18, 12
    v_add_u32 v28, s18, v3
    v_xor_b32 v29, 64, v28
    v_add_u32 v30, 40960, v28
    v_add_u32 v31, 40960, v29
    v_lshrrev_b32 v3, 2, v25
    v_lshl_add_u32 v3, v24, 3, v3
    v_lshlrev_b32 v3, 7, v3
    v_and_b32 v7, 3, v1
    v_lshl_add_u32 v3, v7, 3, v3
    v_bfe_u32 v7, v1, 3, 2
    s_and_b32 s18, s62, 1
    s_lshl_b32 s18, s18, 1
    v_xor_b32 v7, s18, v7
    v_lshl_add_u32 v3, v7, 5, v3
    v_add_u32 v32, 71680, v3
    v_xor_b32 v33, 32, v32
    v_add_u32 v34, 49152, v32
    v_add_u32 v35, 49152, v33
    s_and_b32 s18, s62, 1
    s_lshl_b32 s19, s7, 1
    s_add_u32 s18, s18, s19
    s_cmp_ge_u32 s18, 7
    s_cselect_b32 s19, 14, 7
    s_sub_u32 s18, s19, s18
    v_cmp_gt_u32 s[54:55], s18, v24
    v_add_u32 v2, 4, v24
    v_cmp_gt_u32 s[56:57], s18, v2
    s_bitcmp0_b32 s62, 0
    s_cselect_b64 vcc, -1, 0
    s_xor_b64 s[54:55], s[54:55], vcc
    s_xor_b64 s[56:57], s[56:57], vcc
    v_lshrrev_b32 v3, 2, v25
    s_and_b32 s18, s62, 1
    s_lshl_b32 s19, s7, 1
    s_add_u32 s18, s18, s19
    s_cmp_ge_u32 s18, 7
    s_cselect_b32 s19, 14, 7
    s_sub_u32 s18, s19, s18
    v_cmp_gt_u32 s[58:59], s18, v3
    v_add_u32 v2, 4, v3
    v_cmp_gt_u32 s[60:61], s18, v2
    s_bitcmp0_b32 s62, 0
    s_cselect_b64 vcc, -1, 0
    s_xor_b64 s[58:59], s[58:59], vcc
    s_xor_b64 s[60:61], s[60:61], vcc
    s_and_b32 s18, s62, 1
    s_lshl_b32 s19, s7, 1
    s_add_u32 s18, s18, s19
    s_lshl_b32 s100, s18, 10
    s_lshl_b32 s18, s8, 2
    s_and_b32 s19, s62, 2
    s_add_u32 s18, s18, s19
    s_mul_i32 s19, s18, 14336
    s_add_u32 s100, s100, s19
    s_add_u32 s100, s100, 2097152
    s_lshl_b32 s20, s18, 6
    s_add_u32 s20, s20, 16384
    s_lshl_b32 s18, s17, 11
    s_sub_u32 s18, s18, 1024
    s_add_u32 s15, s100, s18
    s_lshl_b32 s19, s7, 1
    s_add_u32 s18, s17, s19
    s_lshl_b32 s18, s18, 3
    s_add_u32 s21, s20, s18
    v_and_b32 v2, 1, v25
    v_cmp_eq_u32 s[44:45], 1, v2
    v_lshl_add_u32 v2, v24, 2, v2
    v_cmp_le_u32 s[46:47], v2, v25
    v_add_u32 v2, 2, v2
    v_cmp_le_u32 s[48:49], v2, v25
    v_mov_b32 v2, 0xffff
    v_mov_b32 v3, 0xffff0000
    v_cndmask_b32 v2, v2, v3, s[44:45]
    v_cndmask_b32 v36, v2, 0, s[46:47]
    v_cndmask_b32 v37, v2, 0, s[48:49]
    v_cndmask_b32 v38, 0, v2, s[46:47]
    v_cndmask_b32 v39, 0, v2, s[48:49]
    s_add_u32 s18, s8, s16
    s_cmp_eq_u32 s18, 0
    s_cselect_b64 s[50:51], -1, 0
    s_mul_i32 s18, s17, 6
    s_cmp_eq_u32 s18, s7
    s_cselect_b32 s101, 1, 0
    s_cmp_eq_u32 s7, 3
    s_cselect_b32 s18, 0, 1.0
    v_mov_b32 v44, s18
    v_mov_b32 v45, 0xf149f2ca
    v_mov_b32 v46, 0xffffff00
    s_mov_b32 s0, 0x3e8b97f6
    s_add_u32 s18, s29, 129024
    v_add_u32 v42, s18, v4
    v_add_u32 v43, s29, v4
    v_lshl_add_u32 v47, s62, 2, v5
    v_lshl_add_u32 v218, s17, 10, v4
    v_add_u32 v219, 2048, v218
    v_lshl_add_u32 v220, s17, 2, v5
    v_lshl_add_u32 v221, s17, 3, v5
    s_lshl_b32 s18, s7, 7
    v_min_u32 v8, 13, v1
    v_lshlrev_b32 v8, 3, v8
    v_lshrrev_b32 v2, 2, v1
    v_bfe_u32 v3, v1, 3, 2
    v_lshlrev_b32 v3, 5, v3
    v_lshl_add_u32 v2, v2, 7, v3
    v_and_b32 v3, 3, v1
    v_lshl_add_u32 v2, v3, 3, v2
    v_add_u32 v16, 71680, v2
    v_xor_b32 v17, 32, v16
    v_xor_b32 v18, 64, v16
    v_xor_b32 v19, 96, v16
    s_add_u32 s19, s29, 129024
    v_lshrrev_b32 v2, 1, v24
    v_xor_b32 v2, v2, v27
    v_lshlrev_b32 v2, 4, v2
    v_lshl_add_u32 v2, v25, 7, v2
    v_and_b32 v3, 1, v24
    v_lshl_add_u32 v2, v3, 3, v2
    v_add_u32 v20, s19, v2
    v_xor_b32 v21, 32, v20
    v_xor_b32 v22, 64, v20
    v_xor_b32 v23, 96, v20
    v_mul_u32_u24 v10, 1792, v26
    v_lshl_add_u32 v10, v27, 4, v10
    v_xor_b32 v3, v27, v26
    v_lshlrev_b32 v3, 4, v3
    v_lshl_add_u32 v2, v26, 7, v3
    v_add_u32 v9, s19, v2
    s_lshl_b32 s19, s8, 2
    s_add_u32 s19, s19, s62
    s_mul_i32 s22, s19, 14336
    s_add_u32 s22, s22, 2097152
    s_mul_i32 s23, s19, 28672
    s_add_u32 s23, s23, s18
    s_add_u32 s28, s23, 14336
    s_waitcnt lgkmcnt(0)
    s_add_u32 s12, s10, 0x5a3c9671
    s_xor_b32 s13, s11, 0x2b7e1516
    s_add_u32 s52, s52, s12
    s_mov_b32 s53, s13
    v_mov_b32 v14, s12
    v_mov_b32 v15, s13
    s_bfe_u32 s40, s12, 0x80000
    v_mov_b32 v50, s40
    s_bfe_u32 s40, s12, 0x80008
    v_mov_b32 v51, s40
    s_bfe_u32 s40, s12, 0x80010
    v_mov_b32 v52, s40
    s_bfe_u32 s40, s12, 0x80018
    v_mov_b32 v53, s40
    s_setprio 3
    s_cmp_lg_u32 s62, 0
    s_cbranch_scc1 C_nox
    v_mov_b32 v12, s52
    v_mov_b32 v13, s53
    s_lshl_b32 s41, s7, 3
    s_add_u32 s40, s14, s41
    s_mov_b64 exec, 1
    buffer_store_dwordx2 v[12:13], v6, s[36:39], s40 offen sc1
    s_mov_b64 exec, -1

C_nox:
    s_cmp_lg_u32 s62, 0
    s_cbranch_scc1 C_nwo
    buffer_load_dword v7, v41, s[24:27], s1 offen
C_nwo:

    s_cmp_lg_u32 s16, 0
    s_cbranch_scc1 C_tp1
    s_barrier
    ds_read_b128 v[130:133], v28 offset:2048
    ds_read_b64_tr_b16 v[174:175], v32 offset:8192
    ds_read_b64_tr_b16 v[176:177], v32 offset:8704
    ds_read_b128 v[142:145], v29 offset:2048
    ds_read_b64_tr_b16 v[178:179], v32 offset:12288
    ds_read_b64_tr_b16 v[180:181], v32 offset:12800
    ds_read_b128 v[134:137], v28 offset:4096
    ds_read_b128 v[146:149], v29 offset:4096
    ds_read_b64_tr_b16 v[182:183], v33 offset:8192
    ds_read_b64_tr_b16 v[184:185], v33 offset:8704
    ds_read_b64_tr_b16 v[186:187], v33 offset:12288
    ds_read_b64_tr_b16 v[188:189], v33 offset:12800
    s_waitcnt lgkmcnt(9)
    v_mfma_f32_16x16x32_bf16 v[62:65], v[174:177], v[130:133], 0
    ds_read_b128 v[126:129], v28 offset:0
    s_waitcnt lgkmcnt(7)
    v_mfma_f32_16x16x32_bf16 v[62:65], v[178:181], v[142:145], v[62:65]
    ds_read_b64_tr_b16 v[190:191], v32 offset:16384
    ds_read_b64_tr_b16 v[192:193], v32 offset:16896
    s_waitcnt lgkmcnt(8)
    v_mfma_f32_16x16x32_bf16 v[70:73], v[174:177], v[134:137], 0
    ds_read_b128 v[138:141], v29 offset:0
    ds_read_b64_tr_b16 v[194:195], v32 offset:20480
    s_waitcnt lgkmcnt(9)
    v_mfma_f32_16x16x32_bf16 v[70:73], v[178:181], v[146:149], v[70:73]
    ds_read_b64_tr_b16 v[196:197], v32 offset:20992
    s_waitcnt lgkmcnt(8)
    v_mfma_f32_16x16x32_bf16 v[66:69], v[182:185], v[130:133], 0
    ds_read_b64_tr_b16 v[174:175], v33 offset:16384
    s_waitcnt lgkmcnt(7)
    v_mfma_f32_16x16x32_bf16 v[66:69], v[186:189], v[142:145], v[66:69]
    ds_read_b64_tr_b16 v[176:177], v33 offset:16896
    v_mfma_f32_16x16x32_bf16 v[74:77], v[182:185], v[134:137], 0
    ds_read_b64_tr_b16 v[178:179], v33 offset:20480
    v_mfma_f32_16x16x32_bf16 v[74:77], v[186:189], v[146:149], v[74:77]
    ds_read_b64_tr_b16 v[180:181], v33 offset:20992
    s_waitcnt lgkmcnt(7)
    v_mfma_f32_16x16x32_bf16 v[78:81], v[190:193], v[126:129], 0
    ds_read_b64_tr_b16 v[182:183], v32 offset:24576
    s_waitcnt lgkmcnt(5)
    v_mfma_f32_16x16x32_bf16 v[78:81], v[194:197], v[138:141], v[78:81]
    ds_read_b64_tr_b16 v[184:185], v32 offset:25088
    v_mfma_f32_16x16x32_bf16 v[86:89], v[190:193], v[130:133], 0
    ds_read_b64_tr_b16 v[186:187], v32 offset:28672
    v_mfma_f32_16x16x32_bf16 v[86:89], v[194:197], v[142:145], v[86:89]
    ds_read_b64_tr_b16 v[188:189], v32 offset:29184
    v_mfma_f32_16x16x32_bf16 v[94:97], v[190:193], v[134:137], 0
    ds_read_b64_tr_b16 v[190:191], v33 offset:24576
    v_mfma_f32_16x16x32_bf16 v[94:97], v[194:197], v[146:149], v[94:97]
    ds_read_b64_tr_b16 v[192:193], v33 offset:25088
    s_waitcnt lgkmcnt(8)
    v_mfma_f32_16x16x32_bf16 v[82:85], v[174:177], v[126:129], 0
    ds_read_b64_tr_b16 v[194:195], v33 offset:28672
    s_waitcnt lgkmcnt(7)
    v_mfma_f32_16x16x32_bf16 v[82:85], v[178:181], v[138:141], v[82:85]
    ds_read_b64_tr_b16 v[196:197], v33 offset:29184
    v_mfma_f32_16x16x32_bf16 v[90:93], v[174:177], v[130:133], 0
    v_mfma_f32_16x16x32_bf16 v[90:93], v[178:181], v[142:145], v[90:93]
    v_mfma_f32_16x16x32_bf16 v[98:101], v[174:177], v[134:137], 0
    v_mfma_f32_16x16x32_bf16 v[98:101], v[178:181], v[146:149], v[98:101]
    s_waitcnt lgkmcnt(0)
    s_barrier
    ds_read_b128 v[154:157], v28 offset:12288
    ds_read_b64_tr_b16 v[174:175], v32 offset:32768
    ds_read_b64_tr_b16 v[176:177], v32 offset:33280
    ds_read_b128 v[166:169], v29 offset:12288
    v_mfma_f32_16x16x32_bf16 v[102:105], v[126:129], v[182:185], 0
    ds_read_b64_tr_b16 v[178:179], v32 offset:36864
    v_mfma_f32_16x16x32_bf16 v[102:105], v[138:141], v[186:189], v[102:105]
    ds_read_b64_tr_b16 v[180:181], v32 offset:37376
    v_mfma_f32_16x16x32_bf16 v[110:113], v[130:133], v[182:185], 0
    ds_read_b128 v[158:161], v28 offset:14336
    v_mfma_f32_16x16x32_bf16 v[110:113], v[142:145], v[186:189], v[110:113]
    ds_read_b128 v[170:173], v29 offset:14336
    v_mfma_f32_16x16x32_bf16 v[106:109], v[126:129], v[190:193], 0
    ds_read_b64_tr_b16 v[182:183], v33 offset:32768
    v_mfma_f32_16x16x32_bf16 v[106:109], v[138:141], v[194:197], v[106:109]
    ds_read_b64_tr_b16 v[184:185], v33 offset:33280
    v_mfma_f32_16x16x32_bf16 v[114:117], v[130:133], v[190:193], 0
    ds_read_b64_tr_b16 v[186:187], v33 offset:36864
    ds_read_b64_tr_b16 v[188:189], v33 offset:37376
    v_mfma_f32_16x16x32_bf16 v[114:117], v[142:145], v[194:197], v[114:117]
    ds_read_b128 v[150:153], v28 offset:10240
    s_waitcnt lgkmcnt(10)
    v_mfma_f32_16x16x32_bf16 v[62:65], v[174:177], v[154:157], v[62:65]
    ds_read_b64_tr_b16 v[190:191], v32 offset:40960
    s_waitcnt lgkmcnt(8)
    v_mfma_f32_16x16x32_bf16 v[62:65], v[178:181], v[166:169], v[62:65]
    ds_read_b64_tr_b16 v[192:193], v32 offset:41472
    s_waitcnt lgkmcnt(8)
    v_mfma_f32_16x16x32_bf16 v[70:73], v[174:177], v[158:161], v[70:73]
    ds_read_b128 v[162:165], v29 offset:10240
    ds_read_b64_tr_b16 v[194:195], v32 offset:45056
    s_waitcnt lgkmcnt(9)
    v_mfma_f32_16x16x32_bf16 v[70:73], v[178:181], v[170:173], v[70:73]
    ds_read_b64_tr_b16 v[196:197], v32 offset:45568
    s_waitcnt lgkmcnt(8)
    v_mfma_f32_16x16x32_bf16 v[66:69], v[182:185], v[154:157], v[66:69]
    ds_read_b64_tr_b16 v[174:175], v33 offset:40960
    s_waitcnt lgkmcnt(7)
    v_mfma_f32_16x16x32_bf16 v[66:69], v[186:189], v[166:169], v[66:69]
    ds_read_b64_tr_b16 v[176:177], v33 offset:41472
    v_mfma_f32_16x16x32_bf16 v[74:77], v[182:185], v[158:161], v[74:77]
    ds_read_b64_tr_b16 v[178:179], v33 offset:45056
    v_mfma_f32_16x16x32_bf16 v[74:77], v[186:189], v[170:173], v[74:77]
    ds_read_b64_tr_b16 v[180:181], v33 offset:45568
    s_waitcnt lgkmcnt(7)
    v_mfma_f32_16x16x32_bf16 v[78:81], v[190:193], v[150:153], v[78:81]
    ds_read_b64_tr_b16 v[182:183], v34 offset:0
    s_waitcnt lgkmcnt(5)
    v_mfma_f32_16x16x32_bf16 v[78:81], v[194:197], v[162:165], v[78:81]
    ds_read_b64_tr_b16 v[184:185], v34 offset:512
    v_mfma_f32_16x16x32_bf16 v[86:89], v[190:193], v[154:157], v[86:89]
    ds_read_b64_tr_b16 v[186:187], v34 offset:4096
    v_mfma_f32_16x16x32_bf16 v[86:89], v[194:197], v[166:169], v[86:89]
    ds_read_b64_tr_b16 v[188:189], v34 offset:4608
    v_mfma_f32_16x16x32_bf16 v[94:97], v[190:193], v[158:161], v[94:97]
    ds_read_b64_tr_b16 v[190:191], v35 offset:0
    v_mfma_f32_16x16x32_bf16 v[94:97], v[194:197], v[170:173], v[94:97]
    ds_read_b64_tr_b16 v[192:193], v35 offset:512
    s_waitcnt lgkmcnt(8)
    v_mfma_f32_16x16x32_bf16 v[82:85], v[174:177], v[150:153], v[82:85]
    ds_read_b64_tr_b16 v[194:195], v35 offset:4096
    s_waitcnt lgkmcnt(7)
    v_mfma_f32_16x16x32_bf16 v[82:85], v[178:181], v[162:165], v[82:85]
    ds_read_b64_tr_b16 v[196:197], v35 offset:4608
    v_mfma_f32_16x16x32_bf16 v[90:93], v[174:177], v[154:157], v[90:93]
    v_mfma_f32_16x16x32_bf16 v[90:93], v[178:181], v[166:169], v[90:93]
    v_mfma_f32_16x16x32_bf16 v[98:101], v[174:177], v[158:161], v[98:101]
    v_mfma_f32_16x16x32_bf16 v[98:101], v[178:181], v[170:173], v[98:101]
    s_waitcnt lgkmcnt(0)
    s_barrier
    ds_read_b128 v[130:133], v28 offset:22528
    ds_read_b64_tr_b16 v[174:175], v34 offset:8192
    ds_read_b64_tr_b16 v[176:177], v34 offset:8704
    ds_read_b128 v[142:145], v29 offset:22528
    v_mfma_f32_16x16x32_bf16 v[102:105], v[150:153], v[182:185], v[102:105]
    ds_read_b64_tr_b16 v[178:179], v34 offset:12288
    v_mfma_f32_16x16x32_bf16 v[102:105], v[162:165], v[186:189], v[102:105]
    ds_read_b64_tr_b16 v[180:181], v34 offset:12800
    v_mfma_f32_16x16x32_bf16 v[110:113], v[154:157], v[182:185], v[110:113]
    ds_read_b128 v[134:137], v28 offset:24576
    v_mfma_f32_16x16x32_bf16 v[110:113], v[166:169], v[186:189], v[110:113]
    ds_read_b128 v[146:149], v29 offset:24576
    v_mfma_f32_16x16x32_bf16 v[106:109], v[150:153], v[190:193], v[106:109]
    ds_read_b64_tr_b16 v[182:183], v35 offset:8192
    v_mfma_f32_16x16x32_bf16 v[106:109], v[162:165], v[194:197], v[106:109]
    ds_read_b64_tr_b16 v[184:185], v35 offset:8704
    v_mfma_f32_16x16x32_bf16 v[114:117], v[154:157], v[190:193], v[114:117]
    ds_read_b64_tr_b16 v[186:187], v35 offset:12288
    ds_read_b64_tr_b16 v[188:189], v35 offset:12800
    v_mfma_f32_16x16x32_bf16 v[114:117], v[166:169], v[194:197], v[114:117]
    ds_read_b128 v[126:129], v28 offset:20480
    s_waitcnt lgkmcnt(10)
    v_mfma_f32_16x16x32_bf16 v[62:65], v[174:177], v[130:133], v[62:65]
    ds_read_b64_tr_b16 v[190:191], v34 offset:16384
    s_waitcnt lgkmcnt(8)
    v_mfma_f32_16x16x32_bf16 v[62:65], v[178:181], v[142:145], v[62:65]
    ds_read_b64_tr_b16 v[192:193], v34 offset:16896
    s_waitcnt lgkmcnt(8)
    v_mfma_f32_16x16x32_bf16 v[70:73], v[174:177], v[134:137], v[70:73]
    ds_read_b128 v[138:141], v29 offset:20480
    ds_read_b64_tr_b16 v[194:195], v34 offset:20480
    s_waitcnt lgkmcnt(9)
    v_mfma_f32_16x16x32_bf16 v[70:73], v[178:181], v[146:149], v[70:73]
    ds_read_b64_tr_b16 v[196:197], v34 offset:20992
    s_waitcnt lgkmcnt(8)
    v_mfma_f32_16x16x32_bf16 v[66:69], v[182:185], v[130:133], v[66:69]
    ds_read_b64_tr_b16 v[174:175], v35 offset:16384
    s_waitcnt lgkmcnt(7)
    v_mfma_f32_16x16x32_bf16 v[66:69], v[186:189], v[142:145], v[66:69]
    ds_read_b64_tr_b16 v[176:177], v35 offset:16896
    v_mfma_f32_16x16x32_bf16 v[74:77], v[182:185], v[134:137], v[74:77]
    ds_read_b64_tr_b16 v[178:179], v35 offset:20480
    v_mfma_f32_16x16x32_bf16 v[74:77], v[186:189], v[146:149], v[74:77]
    ds_read_b64_tr_b16 v[180:181], v35 offset:20992
    s_waitcnt lgkmcnt(7)
    v_mfma_f32_16x16x32_bf16 v[78:81], v[190:193], v[126:129], v[78:81]
    ds_read_b64_tr_b16 v[182:183], v34 offset:24576
    s_waitcnt lgkmcnt(5)
    v_mfma_f32_16x16x32_bf16 v[78:81], v[194:197], v[138:141], v[78:81]
    ds_read_b64_tr_b16 v[184:185], v34 offset:25088
    v_mfma_f32_16x16x32_bf16 v[86:89], v[190:193], v[130:133], v[86:89]
    ds_read_b64_tr_b16 v[186:187], v34 offset:28672
    v_mfma_f32_16x16x32_bf16 v[86:89], v[194:197], v[142:145], v[86:89]
    ds_read_b64_tr_b16 v[188:189], v34 offset:29184
    v_mfma_f32_16x16x32_bf16 v[94:97], v[190:193], v[134:137], v[94:97]
    ds_read_b64_tr_b16 v[190:191], v35 offset:24576
    v_mfma_f32_16x16x32_bf16 v[94:97], v[194:197], v[146:149], v[94:97]
    ds_read_b64_tr_b16 v[192:193], v35 offset:25088
    s_waitcnt lgkmcnt(8)
    v_mfma_f32_16x16x32_bf16 v[82:85], v[174:177], v[126:129], v[82:85]
    ds_read_b64_tr_b16 v[194:195], v35 offset:28672
    s_waitcnt lgkmcnt(7)
    v_mfma_f32_16x16x32_bf16 v[82:85], v[178:181], v[138:141], v[82:85]
    ds_read_b64_tr_b16 v[196:197], v35 offset:29184
    v_mfma_f32_16x16x32_bf16 v[90:93], v[174:177], v[130:133], v[90:93]
    v_mfma_f32_16x16x32_bf16 v[90:93], v[178:181], v[142:145], v[90:93]
    v_mfma_f32_16x16x32_bf16 v[98:101], v[174:177], v[134:137], v[98:101]
    v_mfma_f32_16x16x32_bf16 v[98:101], v[178:181], v[146:149], v[98:101]
    s_waitcnt lgkmcnt(0)
    s_barrier
    ds_read_b128 v[154:157], v28 offset:32768
    ds_read_b64_tr_b16 v[174:175], v34 offset:32768
    ds_read_b64_tr_b16 v[176:177], v34 offset:33280
    ds_read_b128 v[166:169], v29 offset:32768
    v_mfma_f32_16x16x32_bf16 v[102:105], v[126:129], v[182:185], v[102:105]
    ds_read_b64_tr_b16 v[178:179], v34 offset:36864
    v_mfma_f32_16x16x32_bf16 v[102:105], v[138:141], v[186:189], v[102:105]
    ds_read_b64_tr_b16 v[180:181], v34 offset:37376
    v_mfma_f32_16x16x32_bf16 v[110:113], v[130:133], v[182:185], v[110:113]
    ds_read_b128 v[158:161], v28 offset:34816
    v_mfma_f32_16x16x32_bf16 v[110:113], v[142:145], v[186:189], v[110:113]
    ds_read_b128 v[170:173], v29 offset:34816
    v_mfma_f32_16x16x32_bf16 v[106:109], v[126:129], v[190:193], v[106:109]
    ds_read_b64_tr_b16 v[182:183], v35 offset:32768
    v_mfma_f32_16x16x32_bf16 v[106:109], v[138:141], v[194:197], v[106:109]
    ds_read_b64_tr_b16 v[184:185], v35 offset:33280
    v_mfma_f32_16x16x32_bf16 v[114:117], v[130:133], v[190:193], v[114:117]
    ds_read_b64_tr_b16 v[186:187], v35 offset:36864
    ds_read_b64_tr_b16 v[188:189], v35 offset:37376
    v_mfma_f32_16x16x32_bf16 v[114:117], v[142:145], v[194:197], v[114:117]
    ds_read_b128 v[150:153], v28 offset:30720
    s_waitcnt lgkmcnt(10)
    v_mfma_f32_16x16x32_bf16 v[62:65], v[174:177], v[154:157], v[62:65]
    ds_read_b64_tr_b16 v[190:191], v32 offset:0
    s_waitcnt lgkmcnt(8)
    v_mfma_f32_16x16x32_bf16 v[62:65], v[178:181], v[166:169], v[62:65]
    ds_read_b64_tr_b16 v[192:193], v32 offset:512
    s_waitcnt lgkmcnt(8)
    v_mfma_f32_16x16x32_bf16 v[70:73], v[174:177], v[158:161], v[70:73]
    ds_read_b128 v[162:165], v29 offset:30720
    ds_read_b64_tr_b16 v[194:195], v32 offset:4096
    s_waitcnt lgkmcnt(9)
    v_mfma_f32_16x16x32_bf16 v[70:73], v[178:181], v[170:173], v[70:73]
    ds_read_b64_tr_b16 v[196:197], v32 offset:4608
    s_waitcnt lgkmcnt(8)
    v_mfma_f32_16x16x32_bf16 v[66:69], v[182:185], v[154:157], v[66:69]
    ds_read_b64_tr_b16 v[174:175], v33 offset:0
    s_waitcnt lgkmcnt(7)
    v_mfma_f32_16x16x32_bf16 v[66:69], v[186:189], v[166:169], v[66:69]
    ds_read_b64_tr_b16 v[176:177], v33 offset:512
    v_mfma_f32_16x16x32_bf16 v[74:77], v[182:185], v[158:161], v[74:77]
    ds_read_b64_tr_b16 v[178:179], v33 offset:4096
    v_mfma_f32_16x16x32_bf16 v[74:77], v[186:189], v[170:173], v[74:77]
    ds_read_b64_tr_b16 v[180:181], v33 offset:4608
    s_waitcnt lgkmcnt(7)
    v_mfma_f32_16x16x32_bf16 v[78:81], v[190:193], v[150:153], v[78:81]
    ds_read_b64_tr_b16 v[182:183], v32 offset:8192
    s_waitcnt lgkmcnt(5)
    v_mfma_f32_16x16x32_bf16 v[78:81], v[194:197], v[162:165], v[78:81]
    ds_read_b64_tr_b16 v[184:185], v32 offset:8704
    v_mfma_f32_16x16x32_bf16 v[86:89], v[190:193], v[154:157], v[86:89]
    ds_read_b64_tr_b16 v[186:187], v32 offset:12288
    v_mfma_f32_16x16x32_bf16 v[86:89], v[194:197], v[166:169], v[86:89]
    ds_read_b64_tr_b16 v[188:189], v32 offset:12800
    v_mfma_f32_16x16x32_bf16 v[94:97], v[190:193], v[158:161], v[94:97]
    ds_read_b64_tr_b16 v[190:191], v33 offset:8192
    v_mfma_f32_16x16x32_bf16 v[94:97], v[194:197], v[170:173], v[94:97]
    ds_read_b64_tr_b16 v[192:193], v33 offset:8704
    s_waitcnt lgkmcnt(8)
    v_mfma_f32_16x16x32_bf16 v[82:85], v[174:177], v[150:153], v[82:85]
    ds_read_b64_tr_b16 v[194:195], v33 offset:12288
    s_waitcnt lgkmcnt(7)
    v_mfma_f32_16x16x32_bf16 v[82:85], v[178:181], v[162:165], v[82:85]
    ds_read_b64_tr_b16 v[196:197], v33 offset:12800
    v_mfma_f32_16x16x32_bf16 v[90:93], v[174:177], v[154:157], v[90:93]
    v_mfma_f32_16x16x32_bf16 v[90:93], v[178:181], v[166:169], v[90:93]
    v_mfma_f32_16x16x32_bf16 v[98:101], v[174:177], v[158:161], v[98:101]
    v_mfma_f32_16x16x32_bf16 v[98:101], v[178:181], v[170:173], v[98:101]
    s_waitcnt lgkmcnt(0)
    s_barrier
    ds_read_b128 v[130:133], v30 offset:2048
    ds_read_b64_tr_b16 v[174:175], v32 offset:16384
    ds_read_b64_tr_b16 v[176:177], v32 offset:16896
    ds_read_b128 v[142:145], v31 offset:2048
    v_mfma_f32_16x16x32_bf16 v[102:105], v[150:153], v[182:185], v[102:105]
    ds_read_b64_tr_b16 v[178:179], v32 offset:20480
    v_mfma_f32_16x16x32_bf16 v[102:105], v[162:165], v[186:189], v[102:105]
    ds_read_b64_tr_b16 v[180:181], v32 offset:20992
    v_mfma_f32_16x16x32_bf16 v[110:113], v[154:157], v[182:185], v[110:113]
    ds_read_b128 v[134:137], v30 offset:4096
    v_mfma_f32_16x16x32_bf16 v[110:113], v[166:169], v[186:189], v[110:113]
    ds_read_b128 v[146:149], v31 offset:4096
    v_mfma_f32_16x16x32_bf16 v[106:109], v[150:153], v[190:193], v[106:109]
    ds_read_b64_tr_b16 v[182:183], v33 offset:16384
    v_mfma_f32_16x16x32_bf16 v[106:109], v[162:165], v[194:197], v[106:109]
    ds_read_b64_tr_b16 v[184:185], v33 offset:16896
    v_mfma_f32_16x16x32_bf16 v[114:117], v[154:157], v[190:193], v[114:117]
    ds_read_b64_tr_b16 v[186:187], v33 offset:20480
    ds_read_b64_tr_b16 v[188:189], v33 offset:20992
    v_mfma_f32_16x16x32_bf16 v[114:117], v[166:169], v[194:197], v[114:117]
    ds_read_b128 v[126:129], v30 offset:0
    s_waitcnt lgkmcnt(10)
    v_mfma_f32_16x16x32_bf16 v[62:65], v[174:177], v[130:133], v[62:65]
    ds_read_b64_tr_b16 v[190:191], v32 offset:24576
    s_waitcnt lgkmcnt(8)
    v_mfma_f32_16x16x32_bf16 v[62:65], v[178:181], v[142:145], v[62:65]
    ds_read_b64_tr_b16 v[192:193], v32 offset:25088
    s_waitcnt lgkmcnt(8)
    v_mfma_f32_16x16x32_bf16 v[70:73], v[174:177], v[134:137], v[70:73]
    ds_read_b128 v[138:141], v31 offset:0
    ds_read_b64_tr_b16 v[194:195], v32 offset:28672
    s_waitcnt lgkmcnt(9)
    v_mfma_f32_16x16x32_bf16 v[70:73], v[178:181], v[146:149], v[70:73]
    ds_read_b64_tr_b16 v[196:197], v32 offset:29184
    s_waitcnt lgkmcnt(8)
    v_mfma_f32_16x16x32_bf16 v[66:69], v[182:185], v[130:133], v[66:69]
    ds_read_b64_tr_b16 v[174:175], v33 offset:24576
    s_waitcnt lgkmcnt(7)
    v_mfma_f32_16x16x32_bf16 v[66:69], v[186:189], v[142:145], v[66:69]
    ds_read_b64_tr_b16 v[176:177], v33 offset:25088
    v_mfma_f32_16x16x32_bf16 v[74:77], v[182:185], v[134:137], v[74:77]
    ds_read_b64_tr_b16 v[178:179], v33 offset:28672
    v_mfma_f32_16x16x32_bf16 v[74:77], v[186:189], v[146:149], v[74:77]
    ds_read_b64_tr_b16 v[180:181], v33 offset:29184
    s_waitcnt lgkmcnt(7)
    v_mfma_f32_16x16x32_bf16 v[78:81], v[190:193], v[126:129], v[78:81]
    ds_read_b64_tr_b16 v[182:183], v32 offset:32768
    s_waitcnt lgkmcnt(5)
    v_mfma_f32_16x16x32_bf16 v[78:81], v[194:197], v[138:141], v[78:81]
    ds_read_b64_tr_b16 v[184:185], v32 offset:33280
    v_mfma_f32_16x16x32_bf16 v[86:89], v[190:193], v[130:133], v[86:89]
    ds_read_b64_tr_b16 v[186:187], v32 offset:36864
    v_mfma_f32_16x16x32_bf16 v[86:89], v[194:197], v[142:145], v[86:89]
    ds_read_b64_tr_b16 v[188:189], v32 offset:37376
    v_mfma_f32_16x16x32_bf16 v[94:97], v[190:193], v[134:137], v[94:97]
    ds_read_b64_tr_b16 v[190:191], v33 offset:32768
    v_mfma_f32_16x16x32_bf16 v[94:97], v[194:197], v[146:149], v[94:97]
    ds_read_b64_tr_b16 v[192:193], v33 offset:33280
    s_waitcnt lgkmcnt(8)
    v_mfma_f32_16x16x32_bf16 v[82:85], v[174:177], v[126:129], v[82:85]
    ds_read_b64_tr_b16 v[194:195], v33 offset:36864
    s_waitcnt lgkmcnt(7)
    v_mfma_f32_16x16x32_bf16 v[82:85], v[178:181], v[138:141], v[82:85]
    ds_read_b64_tr_b16 v[196:197], v33 offset:37376
    v_mfma_f32_16x16x32_bf16 v[90:93], v[174:177], v[130:133], v[90:93]
    v_mfma_f32_16x16x32_bf16 v[90:93], v[178:181], v[142:145], v[90:93]
    v_mfma_f32_16x16x32_bf16 v[98:101], v[174:177], v[134:137], v[98:101]
    v_mfma_f32_16x16x32_bf16 v[98:101], v[178:181], v[146:149], v[98:101]
    s_waitcnt lgkmcnt(0)
    s_barrier
    ds_read_b128 v[154:157], v30 offset:12288
    ds_read_b64_tr_b16 v[174:175], v32 offset:40960
    ds_read_b64_tr_b16 v[176:177], v32 offset:41472
    ds_read_b128 v[166:169], v31 offset:12288
    v_mfma_f32_16x16x32_bf16 v[102:105], v[126:129], v[182:185], v[102:105]
    ds_read_b64_tr_b16 v[178:179], v32 offset:45056
    v_mfma_f32_16x16x32_bf16 v[102:105], v[138:141], v[186:189], v[102:105]
    ds_read_b64_tr_b16 v[180:181], v32 offset:45568
    v_mfma_f32_16x16x32_bf16 v[110:113], v[130:133], v[182:185], v[110:113]
    ds_read_b128 v[158:161], v30 offset:14336
    v_mfma_f32_16x16x32_bf16 v[110:113], v[142:145], v[186:189], v[110:113]
    ds_read_b128 v[170:173], v31 offset:14336
    v_mfma_f32_16x16x32_bf16 v[106:109], v[126:129], v[190:193], v[106:109]
    ds_read_b64_tr_b16 v[182:183], v33 offset:40960
    v_mfma_f32_16x16x32_bf16 v[106:109], v[138:141], v[194:197], v[106:109]
    ds_read_b64_tr_b16 v[184:185], v33 offset:41472
    v_mfma_f32_16x16x32_bf16 v[114:117], v[130:133], v[190:193], v[114:117]
    ds_read_b64_tr_b16 v[186:187], v33 offset:45056
    ds_read_b64_tr_b16 v[188:189], v33 offset:45568
    v_mfma_f32_16x16x32_bf16 v[114:117], v[142:145], v[194:197], v[114:117]
    ds_read_b128 v[150:153], v30 offset:10240
    s_waitcnt lgkmcnt(10)
    v_mfma_f32_16x16x32_bf16 v[62:65], v[174:177], v[154:157], v[62:65]
    ds_read_b64_tr_b16 v[190:191], v34 offset:0
    s_waitcnt lgkmcnt(8)
    v_mfma_f32_16x16x32_bf16 v[62:65], v[178:181], v[166:169], v[62:65]
    ds_read_b64_tr_b16 v[192:193], v34 offset:512
    s_waitcnt lgkmcnt(8)
    v_mfma_f32_16x16x32_bf16 v[70:73], v[174:177], v[158:161], v[70:73]
    ds_read_b128 v[162:165], v31 offset:10240
    ds_read_b64_tr_b16 v[194:195], v34 offset:4096
    s_waitcnt lgkmcnt(9)
    v_mfma_f32_16x16x32_bf16 v[70:73], v[178:181], v[170:173], v[70:73]
    ds_read_b64_tr_b16 v[196:197], v34 offset:4608
    s_waitcnt lgkmcnt(8)
    v_mfma_f32_16x16x32_bf16 v[66:69], v[182:185], v[154:157], v[66:69]
    ds_read_b64_tr_b16 v[174:175], v35 offset:0
    s_waitcnt lgkmcnt(7)
    v_mfma_f32_16x16x32_bf16 v[66:69], v[186:189], v[166:169], v[66:69]
    ds_read_b64_tr_b16 v[176:177], v35 offset:512
    v_mfma_f32_16x16x32_bf16 v[74:77], v[182:185], v[158:161], v[74:77]
    ds_read_b64_tr_b16 v[178:179], v35 offset:4096
    v_mfma_f32_16x16x32_bf16 v[74:77], v[186:189], v[170:173], v[74:77]
    ds_read_b64_tr_b16 v[180:181], v35 offset:4608
    s_waitcnt lgkmcnt(7)
    v_mfma_f32_16x16x32_bf16 v[78:81], v[190:193], v[150:153], v[78:81]
    ds_read_b64_tr_b16 v[182:183], v34 offset:8192
    s_waitcnt lgkmcnt(5)
    v_mfma_f32_16x16x32_bf16 v[78:81], v[194:197], v[162:165], v[78:81]
    ds_read_b64_tr_b16 v[184:185], v34 offset:8704
    v_mfma_f32_16x16x32_bf16 v[86:89], v[190:193], v[154:157], v[86:89]
    ds_read_b64_tr_b16 v[186:187], v34 offset:12288
    v_mfma_f32_16x16x32_bf16 v[86:89], v[194:197], v[166:169], v[86:89]
    ds_read_b64_tr_b16 v[188:189], v34 offset:12800
    v_mfma_f32_16x16x32_bf16 v[94:97], v[190:193], v[158:161], v[94:97]
    ds_read_b64_tr_b16 v[190:191], v35 offset:8192
    v_mfma_f32_16x16x32_bf16 v[94:97], v[194:197], v[170:173], v[94:97]
    ds_read_b64_tr_b16 v[192:193], v35 offset:8704
    s_waitcnt lgkmcnt(8)
    v_mfma_f32_16x16x32_bf16 v[82:85], v[174:177], v[150:153], v[82:85]
    ds_read_b64_tr_b16 v[194:195], v35 offset:12288
    s_waitcnt lgkmcnt(7)
    v_mfma_f32_16x16x32_bf16 v[82:85], v[178:181], v[162:165], v[82:85]
    ds_read_b64_tr_b16 v[196:197], v35 offset:12800
    v_mfma_f32_16x16x32_bf16 v[90:93], v[174:177], v[154:157], v[90:93]
    v_mfma_f32_16x16x32_bf16 v[90:93], v[178:181], v[166:169], v[90:93]
    v_mfma_f32_16x16x32_bf16 v[98:101], v[174:177], v[158:161], v[98:101]
    v_mfma_f32_16x16x32_bf16 v[98:101], v[178:181], v[170:173], v[98:101]
    s_waitcnt lgkmcnt(6)
    v_mfma_f32_16x16x32_bf16 v[102:105], v[150:153], v[182:185], v[102:105]
    s_waitcnt lgkmcnt(4)
    v_mfma_f32_16x16x32_bf16 v[102:105], v[162:165], v[186:189], v[102:105]
    v_mfma_f32_16x16x32_bf16 v[110:113], v[154:157], v[182:185], v[110:113]
    v_mfma_f32_16x16x32_bf16 v[110:113], v[166:169], v[186:189], v[110:113]
    s_waitcnt lgkmcnt(2)
    v_mfma_f32_16x16x32_bf16 v[106:109], v[150:153], v[190:193], v[106:109]
    s_waitcnt lgkmcnt(0)
    v_mfma_f32_16x16x32_bf16 v[106:109], v[162:165], v[194:197], v[106:109]
    v_mfma_f32_16x16x32_bf16 v[114:117], v[154:157], v[190:193], v[114:117]
    s_barrier
    ds_read_b128 v[134:137], v30 offset:24576
    ds_read_b64_tr_b16 v[174:175], v34 offset:24576
    ds_read_b64_tr_b16 v[176:177], v34 offset:25088
    ds_read_b128 v[146:149], v31 offset:24576
    ds_read_b64_tr_b16 v[178:179], v34 offset:28672
    ds_read_b64_tr_b16 v[180:181], v34 offset:29184
    ds_read_b64_tr_b16 v[182:183], v35 offset:24576
    ds_read_b64_tr_b16 v[184:185], v35 offset:25088
    ds_read_b64_tr_b16 v[186:187], v35 offset:28672
    ds_read_b64_tr_b16 v[188:189], v35 offset:29184
    ds_read_b128 v[130:133], v30 offset:22528
    ds_read_b64_tr_b16 v[198:199], v34 offset:16384
    ds_read_b64_tr_b16 v[200:201], v34 offset:16896
    ds_read_b128 v[142:145], v31 offset:22528
    ds_read_b64_tr_b16 v[202:203], v34 offset:20480
    ds_read_b64_tr_b16 v[204:205], v34 offset:20992
    ds_read_b64_tr_b16 v[190:191], v35 offset:16384
    v_mfma_f32_16x16x32_bf16 v[114:117], v[166:169], v[194:197], v[114:117]
    ds_read_b64_tr_b16 v[192:193], v35 offset:16896
    s_waitcnt lgkmcnt(15)
    v_mfma_f32_16x16x32_bf16 v[94:97], v[174:177], v[134:137], v[94:97]
    ds_read_b64_tr_b16 v[194:195], v35 offset:20480
    s_waitcnt lgkmcnt(13)
    v_mfma_f32_16x16x32_bf16 v[94:97], v[178:181], v[146:149], v[94:97]
    ds_read_b64_tr_b16 v[196:197], v35 offset:20992
    s_waitcnt lgkmcnt(12)
    v_mfma_f32_16x16x32_bf16 v[98:101], v[182:185], v[134:137], v[98:101]
    ds_read_b128 v[126:129], v30 offset:20480
    s_waitcnt lgkmcnt(11)
    v_mfma_f32_16x16x32_bf16 v[98:101], v[186:189], v[146:149], v[98:101]
    ds_read_b128 v[138:141], v31 offset:20480
    s_waitcnt lgkmcnt(9)
    v_mfma_f32_16x16x32_bf16 v[62:65], v[198:201], v[130:133], v[62:65]
    ds_read_b32 v40, v5 offset:4
    s_waitcnt lgkmcnt(7)
    v_mfma_f32_16x16x32_bf16 v[62:65], v[202:205], v[142:145], v[62:65]
    v_mfma_f32_16x16x32_bf16 v[70:73], v[198:201], v[134:137], v[70:73]
    v_cvt_pk_bf16_f32 v234, v94, v95
    v_cvt_pk_bf16_f32 v235, v96, v97
    v_cvt_pk_bf16_f32 v236, v98, v99
    v_mfma_f32_16x16x32_bf16 v[70:73], v[202:205], v[146:149], v[70:73]
    v_cvt_pk_bf16_f32 v237, v100, v101
    ds_write_b128 v218, v[234:237]
    ds_write_b32 v220, v5 offset:56
    s_waitcnt lgkmcnt(7)
    v_mfma_f32_16x16x32_bf16 v[66:69], v[190:193], v[130:133], v[66:69]
    v_cvt_pk_bf16_f32 v150, v62, v63
    v_cvt_pk_bf16_f32 v151, v64, v65
    s_waitcnt lgkmcnt(5)
    v_mfma_f32_16x16x32_bf16 v[66:69], v[194:197], v[142:145], v[66:69]
    v_cndmask_b32 v158, 0, v150, s[54:55]
    v_cndmask_b32 v150, v150, 0, s[54:55]
    v_mfma_f32_16x16x32_bf16 v[74:77], v[190:193], v[134:137], v[74:77]
    v_cndmask_b32 v159, 0, v151, s[54:55]
    v_cndmask_b32 v151, v151, 0, s[54:55]
    v_mfma_f32_16x16x32_bf16 v[74:77], v[194:197], v[146:149], v[74:77]
    v_cvt_pk_bf16_f32 v154, v70, v71
    v_cvt_pk_bf16_f32 v155, v72, v73
    s_waitcnt lgkmcnt(4)
    v_mfma_f32_16x16x32_bf16 v[78:81], v[174:177], v[126:129], v[78:81]
    v_cndmask_b32 v162, 0, v154, s[54:55]
    v_cndmask_b32 v154, v154, 0, s[54:55]
    s_waitcnt lgkmcnt(3)
    v_mfma_f32_16x16x32_bf16 v[78:81], v[178:181], v[138:141], v[78:81]
    v_cndmask_b32 v163, 0, v155, s[54:55]
    v_cndmask_b32 v155, v155, 0, s[54:55]
    v_mfma_f32_16x16x32_bf16 v[82:85], v[182:185], v[126:129], v[82:85]
    v_cvt_pk_bf16_f32 v152, v66, v67
    v_cvt_pk_bf16_f32 v153, v68, v69
    v_mfma_f32_16x16x32_bf16 v[82:85], v[186:189], v[138:141], v[82:85]
    v_cndmask_b32 v160, 0, v152, s[56:57]
    v_cndmask_b32 v152, v152, 0, s[56:57]
    v_mfma_f32_16x16x32_bf16 v[86:89], v[174:177], v[130:133], v[86:89]
    v_cndmask_b32 v161, 0, v153, s[56:57]
    v_cndmask_b32 v153, v153, 0, s[56:57]
    v_mfma_f32_16x16x32_bf16 v[86:89], v[178:181], v[142:145], v[86:89]
    v_cvt_pk_bf16_f32 v156, v74, v75
    v_cvt_pk_bf16_f32 v157, v76, v77
    v_mfma_f32_16x16x32_bf16 v[90:93], v[182:185], v[130:133], v[90:93]
    v_cndmask_b32 v164, 0, v156, s[56:57]
    v_cndmask_b32 v156, v156, 0, s[56:57]
    v_mfma_f32_16x16x32_bf16 v[90:93], v[186:189], v[142:145], v[90:93]
    v_cndmask_b32 v165, 0, v157, s[56:57]
    v_cndmask_b32 v157, v157, 0, s[56:57]
    v_cvt_pk_bf16_f32 v226, v78, v79
    v_cvt_pk_bf16_f32 v227, v80, v81
    v_cvt_pk_bf16_f32 v228, v82, v83
    v_cvt_pk_bf16_f32 v229, v84, v85
    s_nop 1
    v_mfma_f32_16x16x32_bf16 v[62:65], v[226:229], v[150:153], 0
    v_mfma_f32_16x16x32_bf16 v[74:77], v[234:237], v[154:157], 0
    v_cvt_pk_bf16_f32 v230, v86, v87
    v_cvt_pk_bf16_f32 v231, v88, v89
    v_cvt_pk_bf16_f32 v232, v90, v91
    v_cvt_pk_bf16_f32 v233, v92, v93
    s_nop 1
    v_mfma_f32_16x16x32_bf16 v[66:69], v[230:233], v[150:153], 0
    v_mfma_f32_16x16x32_bf16 v[70:73], v[230:233], v[154:157], 0
    v_mfma_f32_16x16x32_bf16 v[174:177], v[226:229], v[158:161], 0
    v_mfma_f32_16x16x32_bf16 v[178:181], v[230:233], v[158:161], 0
    v_mfma_f32_16x16x32_bf16 v[182:185], v[230:233], v[162:165], 0
    v_mfma_f32_16x16x32_bf16 v[186:189], v[234:237], v[162:165], 0
    s_waitcnt lgkmcnt(2)
    v_readfirstlane_b32 s63, v40
    s_nop 0
    v_cndmask_b32 v66, v66, v67, s[44:45]
    ds_read_b32 v40, v5 offset:32
    v_cndmask_b32 v68, v68, v69, s[44:45]
    ds_read_b64_tr_b16 v[166:167], v34 offset:32768
    v_cndmask_b32 v62, v62, v63, s[44:45]
    ds_read_b64_tr_b16 v[168:169], v34 offset:33280
    v_cndmask_b32 v64, v64, v65, s[44:45]
    ds_read_b64_tr_b16 v[170:171], v35 offset:32768
    v_cndmask_b32 v62, v62, v45, s[50:51]
    ds_read_b64_tr_b16 v[172:173], v35 offset:33280
    v_cndmask_b32 v64, v64, v45, s[50:51]
    ds_read_b64_tr_b16 v[198:199], v34 offset:36864
    v_cndmask_b32 v210, v62, v66, s[46:47]
    ds_read_b64_tr_b16 v[200:201], v34 offset:37376
    v_cndmask_b32 v211, v64, v68, s[48:49]
    ds_read_b64_tr_b16 v[202:203], v35 offset:36864
    v_cndmask_b32 v74, v74, v75, s[44:45]
    ds_read_b64_tr_b16 v[204:205], v35 offset:37376
    v_cndmask_b32 v76, v76, v77, s[44:45]
    v_cndmask_b32 v70, v70, v71, s[44:45]
    v_cndmask_b32 v72, v72, v73, s[44:45]
    v_cndmask_b32 v212, v70, v74, s[46:47]
    v_cndmask_b32 v213, v72, v76, s[48:49]
    v_and_or_b32 v94, v210, v46, v50
    v_and_or_b32 v95, v211, v46, v51
    v_and_or_b32 v96, v212, v46, v52
    v_and_or_b32 v97, v213, v46, v53
    s_cmp_lg_u32 s101, 0
    s_cbranch_scc1 SM_jS0
    s_cmp_eq_u32 s63, 0
    s_cbranch_scc1 SM_sS0
    buffer_store_dwordx4 v[94:97], v4, s[36:39], s15 offen
SM_jS0:
    v_cndmask_b32 v178, v178, v179, s[44:45]
    v_cndmask_b32 v180, v180, v181, s[44:45]
    v_cndmask_b32 v174, v174, v175, s[44:45]
    v_cndmask_b32 v176, v176, v177, s[44:45]
    v_cndmask_b32 v174, v174, v45, s[50:51]
    v_cndmask_b32 v176, v176, v45, s[50:51]
    v_cndmask_b32 v206, v174, v178, s[46:47]
    v_cndmask_b32 v207, v176, v180, s[48:49]
    v_cndmask_b32 v186, v186, v187, s[44:45]
    v_cndmask_b32 v188, v188, v189, s[44:45]
    v_cndmask_b32 v182, v182, v183, s[44:45]
    v_cndmask_b32 v184, v184, v185, s[44:45]
    v_cndmask_b32 v208, v182, v186, s[46:47]
    v_cndmask_b32 v209, v184, v188, s[48:49]
    ds_write_b128 v42, v[206:209]
    ds_write_b32 v47, v5 offset:16
    s_waitcnt lgkmcnt(10)
    v_cmp_gt_u32 vcc, 4, v40
    s_nop 0
    s_cbranch_vccnz C_vr0
C_vd0:
    s_waitcnt lgkmcnt(8)
    v_mfma_f32_16x16x32_bf16 v[102:105], v[126:129], v[166:169], v[102:105]
    s_waitcnt lgkmcnt(4)
    v_mfma_f32_16x16x32_bf16 v[102:105], v[138:141], v[198:201], v[102:105]
    v_mfma_f32_16x16x32_bf16 v[106:109], v[126:129], v[170:173], v[106:109]
    s_waitcnt lgkmcnt(2)
    v_mfma_f32_16x16x32_bf16 v[106:109], v[138:141], v[202:205], v[106:109]
    v_mfma_f32_16x16x32_bf16 v[110:113], v[130:133], v[166:169], v[110:113]
    v_mfma_f32_16x16x32_bf16 v[110:113], v[142:145], v[198:201], v[110:113]
    v_mfma_f32_16x16x32_bf16 v[114:117], v[130:133], v[170:173], v[114:117]
    s_nop 1
    v_cvt_pk_bf16_f32 v226, v102, v103
    v_cvt_pk_bf16_f32 v227, v104, v105
    v_mfma_f32_16x16x32_bf16 v[114:117], v[142:145], v[202:205], v[114:117]
    v_cvt_pk_bf16_f32 v232, v106, v107
    v_cvt_pk_bf16_f32 v233, v108, v109
    v_cndmask_b32 v126, 0, v226, s[58:59]
    v_cndmask_b32 v226, v226, 0, s[58:59]
    v_cndmask_b32 v127, 0, v227, s[58:59]
    v_cndmask_b32 v227, v227, 0, s[58:59]
    v_cndmask_b32 v132, 0, v232, s[60:61]
    v_cndmask_b32 v232, v232, 0, s[60:61]
    v_cndmask_b32 v133, 0, v233, s[60:61]
    v_cndmask_b32 v233, v233, 0, s[60:61]
    buffer_load_dwordx4 v[214:217], v4, s[36:39], s100 offen sc1
    v_cvt_pk_bf16_f32 v228, v110, v111
    v_cvt_pk_bf16_f32 v229, v112, v113
    v_cvt_pk_bf16_f32 v234, v114, v115
    v_cvt_pk_bf16_f32 v235, v116, v117
    ds_read_b32 v48, v221
    ds_read_b64 v[230:231], v219
    ds_read_b64 v[236:237], v219 offset:8
    v_cndmask_b32 v128, 0, v228, s[58:59]
    v_cndmask_b32 v228, v228, 0, s[58:59]
    v_cndmask_b32 v129, 0, v229, s[58:59]
    v_cndmask_b32 v229, v229, 0, s[58:59]
    v_cndmask_b32 v134, 0, v234, s[60:61]
    v_cndmask_b32 v234, v234, 0, s[60:61]
    v_cndmask_b32 v135, 0, v235, s[60:61]
    v_cndmask_b32 v235, v235, 0, s[60:61]
    s_waitcnt lgkmcnt(0)
    v_cmp_ne_u32 vcc, 0, v48
    s_nop 0
    s_cbranch_vccnz D_dV
    s_mov_b32 s9, 0
D_lV:
    ds_read_b32 v48, v221
    ds_read_b64 v[230:231], v219
    ds_read_b64 v[236:237], v219 offset:8
    s_add_u32 s9, s9, 1
    s_cmp_gt_u32 s9, 1600000
    s_waitcnt lgkmcnt(0)
    s_cbranch_scc1 D_dV
    v_cmp_eq_u32 vcc, 0, v48
    s_nop 0
    s_cbranch_vccnz D_lV
            D_dV:

    v_cndmask_b32 v130, 0, v230, s[58:59]
    v_cndmask_b32 v230, v230, 0, s[58:59]
    v_cndmask_b32 v131, 0, v231, s[58:59]
    v_cndmask_b32 v231, v231, 0, s[58:59]
    v_cndmask_b32 v136, 0, v236, s[60:61]
    v_cndmask_b32 v236, v236, 0, s[60:61]
    v_cndmask_b32 v137, 0, v237, s[60:61]
    v_cndmask_b32 v237, v237, 0, s[60:61]
    s_branch C_join
C_tp1:
    s_barrier
    ds_read_b128 v[130:133], v28 offset:2048
    ds_read_b64_tr_b16 v[174:175], v32 offset:8192
    ds_read_b64_tr_b16 v[176:177], v32 offset:8704
    ds_read_b128 v[142:145], v29 offset:2048
    ds_read_b64_tr_b16 v[178:179], v32 offset:12288
    ds_read_b64_tr_b16 v[180:181], v32 offset:12800
    ds_read_b128 v[134:137], v28 offset:4096
    ds_read_b128 v[146:149], v29 offset:4096
    ds_read_b64_tr_b16 v[182:183], v33 offset:8192
    ds_read_b64_tr_b16 v[184:185], v33 offset:8704
    ds_read_b64_tr_b16 v[186:187], v33 offset:12288
    ds_read_b64_tr_b16 v[188:189], v33 offset:12800
    s_waitcnt lgkmcnt(9)
    v_mfma_f32_16x16x32_bf16 v[62:65], v[174:177], v[130:133], 0
    ds_read_b64_tr_b16 v[190:191], v32 offset:16384
    s_waitcnt lgkmcnt(7)
    v_mfma_f32_16x16x32_bf16 v[62:65], v[178:181], v[142:145], v[62:65]
    ds_read_b64_tr_b16 v[192:193], v32 offset:16896
    s_waitcnt lgkmcnt(7)
    v_mfma_f32_16x16x32_bf16 v[70:73], v[174:177], v[134:137], 0
    ds_read_b64_tr_b16 v[194:195], v32 offset:20480
    ds_read_b64_tr_b16 v[196:197], v32 offset:20992
    s_waitcnt lgkmcnt(8)
    v_mfma_f32_16x16x32_bf16 v[70:73], v[178:181], v[146:149], v[70:73]
    ds_read_b64_tr_b16 v[174:175], v33 offset:16384
    s_waitcnt lgkmcnt(7)
    v_mfma_f32_16x16x32_bf16 v[66:69], v[182:185], v[130:133], 0
    ds_read_b64_tr_b16 v[176:177], v33 offset:16896
    s_waitcnt lgkmcnt(6)
    v_mfma_f32_16x16x32_bf16 v[66:69], v[186:189], v[142:145], v[66:69]
    ds_read_b64_tr_b16 v[178:179], v33 offset:20480
    v_mfma_f32_16x16x32_bf16 v[74:77], v[182:185], v[134:137], 0
    ds_read_b64_tr_b16 v[180:181], v33 offset:20992
    v_mfma_f32_16x16x32_bf16 v[74:77], v[186:189], v[146:149], v[74:77]
    ds_read_b128 v[126:129], v28 offset:0
    s_waitcnt lgkmcnt(7)
    v_mfma_f32_16x16x32_bf16 v[86:89], v[190:193], v[130:133], 0
    ds_read_b64_tr_b16 v[182:183], v32 offset:24576
    s_waitcnt lgkmcnt(6)
    v_mfma_f32_16x16x32_bf16 v[86:89], v[194:197], v[142:145], v[86:89]
    ds_read_b64_tr_b16 v[184:185], v32 offset:25088
    v_mfma_f32_16x16x32_bf16 v[94:97], v[190:193], v[134:137], 0
    ds_read_b128 v[138:141], v29 offset:0
    ds_read_b64_tr_b16 v[186:187], v32 offset:28672
    v_mfma_f32_16x16x32_bf16 v[94:97], v[194:197], v[146:149], v[94:97]
    ds_read_b64_tr_b16 v[188:189], v32 offset:29184
    s_waitcnt lgkmcnt(8)
    v_mfma_f32_16x16x32_bf16 v[90:93], v[174:177], v[130:133], 0
    ds_read_b64_tr_b16 v[190:191], v33 offset:24576
    s_waitcnt lgkmcnt(7)
    v_mfma_f32_16x16x32_bf16 v[90:93], v[178:181], v[142:145], v[90:93]
    ds_read_b64_tr_b16 v[192:193], v33 offset:25088
    v_mfma_f32_16x16x32_bf16 v[98:101], v[174:177], v[134:137], 0
    ds_read_b64_tr_b16 v[194:195], v33 offset:28672
    v_mfma_f32_16x16x32_bf16 v[98:101], v[178:181], v[146:149], v[98:101]
    ds_read_b64_tr_b16 v[196:197], v33 offset:29184
    s_waitcnt lgkmcnt(7)
    v_mfma_f32_16x16x32_bf16 v[102:105], v[126:129], v[182:185], 0
    s_waitcnt lgkmcnt(4)
    v_mfma_f32_16x16x32_bf16 v[102:105], v[138:141], v[186:189], v[102:105]
    v_mfma_f32_16x16x32_bf16 v[110:113], v[130:133], v[182:185], 0
    v_mfma_f32_16x16x32_bf16 v[110:113], v[142:145], v[186:189], v[110:113]
    s_waitcnt lgkmcnt(0)
    s_barrier
    ds_read_b128 v[154:157], v28 offset:12288
    ds_read_b64_tr_b16 v[174:175], v32 offset:32768
    ds_read_b64_tr_b16 v[176:177], v32 offset:33280
    ds_read_b128 v[166:169], v29 offset:12288
    v_mfma_f32_16x16x32_bf16 v[118:121], v[134:137], v[182:185], 0
    ds_read_b64_tr_b16 v[178:179], v32 offset:36864
    v_mfma_f32_16x16x32_bf16 v[118:121], v[146:149], v[186:189], v[118:121]
    ds_read_b64_tr_b16 v[180:181], v32 offset:37376
    v_mfma_f32_16x16x32_bf16 v[106:109], v[126:129], v[190:193], 0
    ds_read_b128 v[158:161], v28 offset:14336
    v_mfma_f32_16x16x32_bf16 v[106:109], v[138:141], v[194:197], v[106:109]
    ds_read_b128 v[170:173], v29 offset:14336
    v_mfma_f32_16x16x32_bf16 v[114:117], v[130:133], v[190:193], 0
    ds_read_b64_tr_b16 v[182:183], v33 offset:32768
    v_mfma_f32_16x16x32_bf16 v[114:117], v[142:145], v[194:197], v[114:117]
    ds_read_b64_tr_b16 v[184:185], v33 offset:33280
    v_mfma_f32_16x16x32_bf16 v[122:125], v[134:137], v[190:193], 0
    ds_read_b64_tr_b16 v[186:187], v33 offset:36864
    ds_read_b64_tr_b16 v[188:189], v33 offset:37376
    v_mfma_f32_16x16x32_bf16 v[122:125], v[146:149], v[194:197], v[122:125]
    ds_read_b64_tr_b16 v[190:191], v32 offset:40960
    s_waitcnt lgkmcnt(10)
    v_mfma_f32_16x16x32_bf16 v[62:65], v[174:177], v[154:157], v[62:65]
    ds_read_b64_tr_b16 v[192:193], v32 offset:41472
    s_waitcnt lgkmcnt(8)
    v_mfma_f32_16x16x32_bf16 v[62:65], v[178:181], v[166:169], v[62:65]
    ds_read_b64_tr_b16 v[194:195], v32 offset:45056
    s_waitcnt lgkmcnt(8)
    v_mfma_f32_16x16x32_bf16 v[70:73], v[174:177], v[158:161], v[70:73]
    ds_read_b64_tr_b16 v[196:197], v32 offset:45568
    s_waitcnt lgkmcnt(8)
    v_mfma_f32_16x16x32_bf16 v[70:73], v[178:181], v[170:173], v[70:73]
    ds_read_b64_tr_b16 v[174:175], v33 offset:40960
    s_waitcnt lgkmcnt(7)
    v_mfma_f32_16x16x32_bf16 v[66:69], v[182:185], v[154:157], v[66:69]
    ds_read_b64_tr_b16 v[176:177], v33 offset:41472
    s_waitcnt lgkmcnt(6)
    v_mfma_f32_16x16x32_bf16 v[66:69], v[186:189], v[166:169], v[66:69]
    ds_read_b64_tr_b16 v[178:179], v33 offset:45056
    v_mfma_f32_16x16x32_bf16 v[74:77], v[182:185], v[158:161], v[74:77]
    ds_read_b64_tr_b16 v[180:181], v33 offset:45568
    v_mfma_f32_16x16x32_bf16 v[74:77], v[186:189], v[170:173], v[74:77]
    ds_read_b128 v[150:153], v28 offset:10240
    s_waitcnt lgkmcnt(7)
    v_mfma_f32_16x16x32_bf16 v[86:89], v[190:193], v[154:157], v[86:89]
    ds_read_b64_tr_b16 v[182:183], v34 offset:0
    s_waitcnt lgkmcnt(6)
    v_mfma_f32_16x16x32_bf16 v[86:89], v[194:197], v[166:169], v[86:89]
    ds_read_b64_tr_b16 v[184:185], v34 offset:512
    v_mfma_f32_16x16x32_bf16 v[94:97], v[190:193], v[158:161], v[94:97]
    ds_read_b128 v[162:165], v29 offset:10240
    ds_read_b64_tr_b16 v[186:187], v34 offset:4096
    v_mfma_f32_16x16x32_bf16 v[94:97], v[194:197], v[170:173], v[94:97]
    ds_read_b64_tr_b16 v[188:189], v34 offset:4608
    s_waitcnt lgkmcnt(8)
    v_mfma_f32_16x16x32_bf16 v[90:93], v[174:177], v[154:157], v[90:93]
    ds_read_b64_tr_b16 v[190:191], v35 offset:0
    s_waitcnt lgkmcnt(7)
    v_mfma_f32_16x16x32_bf16 v[90:93], v[178:181], v[166:169], v[90:93]
    ds_read_b64_tr_b16 v[192:193], v35 offset:512
    v_mfma_f32_16x16x32_bf16 v[98:101], v[174:177], v[158:161], v[98:101]
    ds_read_b64_tr_b16 v[194:195], v35 offset:4096
    v_mfma_f32_16x16x32_bf16 v[98:101], v[178:181], v[170:173], v[98:101]
    ds_read_b64_tr_b16 v[196:197], v35 offset:4608
    s_waitcnt lgkmcnt(7)
    v_mfma_f32_16x16x32_bf16 v[102:105], v[150:153], v[182:185], v[102:105]
    s_waitcnt lgkmcnt(4)
    v_mfma_f32_16x16x32_bf16 v[102:105], v[162:165], v[186:189], v[102:105]
    v_mfma_f32_16x16x32_bf16 v[110:113], v[154:157], v[182:185], v[110:113]
    v_mfma_f32_16x16x32_bf16 v[110:113], v[166:169], v[186:189], v[110:113]
    s_waitcnt lgkmcnt(0)
    s_barrier
    ds_read_b128 v[130:133], v28 offset:22528
    ds_read_b64_tr_b16 v[174:175], v34 offset:8192
    ds_read_b64_tr_b16 v[176:177], v34 offset:8704
    ds_read_b128 v[142:145], v29 offset:22528
    v_mfma_f32_16x16x32_bf16 v[118:121], v[158:161], v[182:185], v[118:121]
    ds_read_b64_tr_b16 v[178:179], v34 offset:12288
    v_mfma_f32_16x16x32_bf16 v[118:121], v[170:173], v[186:189], v[118:121]
    ds_read_b64_tr_b16 v[180:181], v34 offset:12800
    v_mfma_f32_16x16x32_bf16 v[106:109], v[150:153], v[190:193], v[106:109]
    ds_read_b128 v[134:137], v28 offset:24576
    v_mfma_f32_16x16x32_bf16 v[106:109], v[162:165], v[194:197], v[106:109]
    ds_read_b128 v[146:149], v29 offset:24576
    v_mfma_f32_16x16x32_bf16 v[114:117], v[154:157], v[190:193], v[114:117]
    ds_read_b64_tr_b16 v[182:183], v35 offset:8192
    v_mfma_f32_16x16x32_bf16 v[114:117], v[166:169], v[194:197], v[114:117]
    ds_read_b64_tr_b16 v[184:185], v35 offset:8704
    v_mfma_f32_16x16x32_bf16 v[122:125], v[158:161], v[190:193], v[122:125]
    ds_read_b64_tr_b16 v[186:187], v35 offset:12288
    ds_read_b64_tr_b16 v[188:189], v35 offset:12800
    v_mfma_f32_16x16x32_bf16 v[122:125], v[170:173], v[194:197], v[122:125]
    ds_read_b64_tr_b16 v[190:191], v34 offset:16384
    s_waitcnt lgkmcnt(10)
    v_mfma_f32_16x16x32_bf16 v[62:65], v[174:177], v[130:133], v[62:65]
    ds_read_b64_tr_b16 v[192:193], v34 offset:16896
    s_waitcnt lgkmcnt(8)
    v_mfma_f32_16x16x32_bf16 v[62:65], v[178:181], v[142:145], v[62:65]
    ds_read_b64_tr_b16 v[194:195], v34 offset:20480
    s_waitcnt lgkmcnt(8)
    v_mfma_f32_16x16x32_bf16 v[70:73], v[174:177], v[134:137], v[70:73]
    ds_read_b64_tr_b16 v[196:197], v34 offset:20992
    s_waitcnt lgkmcnt(8)
    v_mfma_f32_16x16x32_bf16 v[70:73], v[178:181], v[146:149], v[70:73]
    ds_read_b64_tr_b16 v[174:175], v35 offset:16384
    s_waitcnt lgkmcnt(7)
    v_mfma_f32_16x16x32_bf16 v[66:69], v[182:185], v[130:133], v[66:69]
    ds_read_b64_tr_b16 v[176:177], v35 offset:16896
    s_waitcnt lgkmcnt(6)
    v_mfma_f32_16x16x32_bf16 v[66:69], v[186:189], v[142:145], v[66:69]
    ds_read_b64_tr_b16 v[178:179], v35 offset:20480
    v_mfma_f32_16x16x32_bf16 v[74:77], v[182:185], v[134:137], v[74:77]
    ds_read_b64_tr_b16 v[180:181], v35 offset:20992
    v_mfma_f32_16x16x32_bf16 v[74:77], v[186:189], v[146:149], v[74:77]
    ds_read_b128 v[126:129], v28 offset:20480
    s_waitcnt lgkmcnt(7)
    v_mfma_f32_16x16x32_bf16 v[86:89], v[190:193], v[130:133], v[86:89]
    ds_read_b64_tr_b16 v[182:183], v34 offset:24576
    s_waitcnt lgkmcnt(6)
    v_mfma_f32_16x16x32_bf16 v[86:89], v[194:197], v[142:145], v[86:89]
    ds_read_b64_tr_b16 v[184:185], v34 offset:25088
    v_mfma_f32_16x16x32_bf16 v[94:97], v[190:193], v[134:137], v[94:97]
    ds_read_b128 v[138:141], v29 offset:20480
    ds_read_b64_tr_b16 v[186:187], v34 offset:28672
    v_mfma_f32_16x16x32_bf16 v[94:97], v[194:197], v[146:149], v[94:97]
    ds_read_b64_tr_b16 v[188:189], v34 offset:29184
    s_waitcnt lgkmcnt(8)
    v_mfma_f32_16x16x32_bf16 v[90:93], v[174:177], v[130:133], v[90:93]
    ds_read_b64_tr_b16 v[190:191], v35 offset:24576
    s_waitcnt lgkmcnt(7)
    v_mfma_f32_16x16x32_bf16 v[90:93], v[178:181], v[142:145], v[90:93]
    ds_read_b64_tr_b16 v[192:193], v35 offset:25088
    v_mfma_f32_16x16x32_bf16 v[98:101], v[174:177], v[134:137], v[98:101]
    ds_read_b64_tr_b16 v[194:195], v35 offset:28672
    v_mfma_f32_16x16x32_bf16 v[98:101], v[178:181], v[146:149], v[98:101]
    ds_read_b64_tr_b16 v[196:197], v35 offset:29184
    s_waitcnt lgkmcnt(7)
    v_mfma_f32_16x16x32_bf16 v[102:105], v[126:129], v[182:185], v[102:105]
    s_waitcnt lgkmcnt(4)
    v_mfma_f32_16x16x32_bf16 v[102:105], v[138:141], v[186:189], v[102:105]
    v_mfma_f32_16x16x32_bf16 v[110:113], v[130:133], v[182:185], v[110:113]
    v_mfma_f32_16x16x32_bf16 v[110:113], v[142:145], v[186:189], v[110:113]
    s_waitcnt lgkmcnt(0)
    s_barrier
    ds_read_b128 v[154:157], v28 offset:32768
    ds_read_b64_tr_b16 v[174:175], v34 offset:32768
    ds_read_b64_tr_b16 v[176:177], v34 offset:33280
    ds_read_b128 v[166:169], v29 offset:32768
    v_mfma_f32_16x16x32_bf16 v[118:121], v[134:137], v[182:185], v[118:121]
    ds_read_b64_tr_b16 v[178:179], v34 offset:36864
    v_mfma_f32_16x16x32_bf16 v[118:121], v[146:149], v[186:189], v[118:121]
    ds_read_b64_tr_b16 v[180:181], v34 offset:37376
    v_mfma_f32_16x16x32_bf16 v[106:109], v[126:129], v[190:193], v[106:109]
    ds_read_b128 v[158:161], v28 offset:34816
    v_mfma_f32_16x16x32_bf16 v[106:109], v[138:141], v[194:197], v[106:109]
    ds_read_b128 v[170:173], v29 offset:34816
    v_mfma_f32_16x16x32_bf16 v[114:117], v[130:133], v[190:193], v[114:117]
    ds_read_b64_tr_b16 v[182:183], v35 offset:32768
    v_mfma_f32_16x16x32_bf16 v[114:117], v[142:145], v[194:197], v[114:117]
    ds_read_b64_tr_b16 v[184:185], v35 offset:33280
    v_mfma_f32_16x16x32_bf16 v[122:125], v[134:137], v[190:193], v[122:125]
    ds_read_b64_tr_b16 v[186:187], v35 offset:36864
    ds_read_b64_tr_b16 v[188:189], v35 offset:37376
    v_mfma_f32_16x16x32_bf16 v[122:125], v[146:149], v[194:197], v[122:125]
    ds_read_b64_tr_b16 v[190:191], v32 offset:0
    s_waitcnt lgkmcnt(10)
    v_mfma_f32_16x16x32_bf16 v[62:65], v[174:177], v[154:157], v[62:65]
    ds_read_b64_tr_b16 v[192:193], v32 offset:512
    s_waitcnt lgkmcnt(8)
    v_mfma_f32_16x16x32_bf16 v[62:65], v[178:181], v[166:169], v[62:65]
    ds_read_b64_tr_b16 v[194:195], v32 offset:4096
    s_waitcnt lgkmcnt(8)
    v_mfma_f32_16x16x32_bf16 v[70:73], v[174:177], v[158:161], v[70:73]
    ds_read_b64_tr_b16 v[196:197], v32 offset:4608
    s_waitcnt lgkmcnt(8)
    v_mfma_f32_16x16x32_bf16 v[70:73], v[178:181], v[170:173], v[70:73]
    ds_read_b64_tr_b16 v[174:175], v33 offset:0
    s_waitcnt lgkmcnt(7)
    v_mfma_f32_16x16x32_bf16 v[66:69], v[182:185], v[154:157], v[66:69]
    ds_read_b64_tr_b16 v[176:177], v33 offset:512
    s_waitcnt lgkmcnt(6)
    v_mfma_f32_16x16x32_bf16 v[66:69], v[186:189], v[166:169], v[66:69]
    ds_read_b64_tr_b16 v[178:179], v33 offset:4096
    v_mfma_f32_16x16x32_bf16 v[74:77], v[182:185], v[158:161], v[74:77]
    ds_read_b64_tr_b16 v[180:181], v33 offset:4608
    v_mfma_f32_16x16x32_bf16 v[74:77], v[186:189], v[170:173], v[74:77]
    ds_read_b128 v[150:153], v28 offset:30720
    s_waitcnt lgkmcnt(7)
    v_mfma_f32_16x16x32_bf16 v[86:89], v[190:193], v[154:157], v[86:89]
    ds_read_b64_tr_b16 v[182:183], v32 offset:8192
    s_waitcnt lgkmcnt(6)
    v_mfma_f32_16x16x32_bf16 v[86:89], v[194:197], v[166:169], v[86:89]
    ds_read_b64_tr_b16 v[184:185], v32 offset:8704
    v_mfma_f32_16x16x32_bf16 v[94:97], v[190:193], v[158:161], v[94:97]
    ds_read_b128 v[162:165], v29 offset:30720
    ds_read_b64_tr_b16 v[186:187], v32 offset:12288
    v_mfma_f32_16x16x32_bf16 v[94:97], v[194:197], v[170:173], v[94:97]
    ds_read_b64_tr_b16 v[188:189], v32 offset:12800
    s_waitcnt lgkmcnt(8)
    v_mfma_f32_16x16x32_bf16 v[90:93], v[174:177], v[154:157], v[90:93]
    ds_read_b64_tr_b16 v[190:191], v33 offset:8192
    s_waitcnt lgkmcnt(7)
    v_mfma_f32_16x16x32_bf16 v[90:93], v[178:181], v[166:169], v[90:93]
    ds_read_b64_tr_b16 v[192:193], v33 offset:8704
    v_mfma_f32_16x16x32_bf16 v[98:101], v[174:177], v[158:161], v[98:101]
    ds_read_b64_tr_b16 v[194:195], v33 offset:12288
    v_mfma_f32_16x16x32_bf16 v[98:101], v[178:181], v[170:173], v[98:101]
    ds_read_b64_tr_b16 v[196:197], v33 offset:12800
    s_waitcnt lgkmcnt(7)
    v_mfma_f32_16x16x32_bf16 v[102:105], v[150:153], v[182:185], v[102:105]
    s_waitcnt lgkmcnt(4)
    v_mfma_f32_16x16x32_bf16 v[102:105], v[162:165], v[186:189], v[102:105]
    v_mfma_f32_16x16x32_bf16 v[110:113], v[154:157], v[182:185], v[110:113]
    v_mfma_f32_16x16x32_bf16 v[110:113], v[166:169], v[186:189], v[110:113]
    s_waitcnt lgkmcnt(0)
    s_barrier
    ds_read_b128 v[130:133], v30 offset:2048
    ds_read_b64_tr_b16 v[174:175], v32 offset:16384
    ds_read_b64_tr_b16 v[176:177], v32 offset:16896
    ds_read_b128 v[142:145], v31 offset:2048
    v_mfma_f32_16x16x32_bf16 v[118:121], v[158:161], v[182:185], v[118:121]
    ds_read_b64_tr_b16 v[178:179], v32 offset:20480
    v_mfma_f32_16x16x32_bf16 v[118:121], v[170:173], v[186:189], v[118:121]
    ds_read_b64_tr_b16 v[180:181], v32 offset:20992
    v_mfma_f32_16x16x32_bf16 v[106:109], v[150:153], v[190:193], v[106:109]
    ds_read_b128 v[134:137], v30 offset:4096
    v_mfma_f32_16x16x32_bf16 v[106:109], v[162:165], v[194:197], v[106:109]
    ds_read_b128 v[146:149], v31 offset:4096
    v_mfma_f32_16x16x32_bf16 v[114:117], v[154:157], v[190:193], v[114:117]
    ds_read_b64_tr_b16 v[182:183], v33 offset:16384
    v_mfma_f32_16x16x32_bf16 v[114:117], v[166:169], v[194:197], v[114:117]
    ds_read_b64_tr_b16 v[184:185], v33 offset:16896
    v_mfma_f32_16x16x32_bf16 v[122:125], v[158:161], v[190:193], v[122:125]
    ds_read_b64_tr_b16 v[186:187], v33 offset:20480
    ds_read_b64_tr_b16 v[188:189], v33 offset:20992
    v_mfma_f32_16x16x32_bf16 v[122:125], v[170:173], v[194:197], v[122:125]
    ds_read_b64_tr_b16 v[190:191], v32 offset:24576
    s_waitcnt lgkmcnt(10)
    v_mfma_f32_16x16x32_bf16 v[62:65], v[174:177], v[130:133], v[62:65]
    ds_read_b64_tr_b16 v[192:193], v32 offset:25088
    s_waitcnt lgkmcnt(8)
    v_mfma_f32_16x16x32_bf16 v[62:65], v[178:181], v[142:145], v[62:65]
    ds_read_b64_tr_b16 v[194:195], v32 offset:28672
    s_waitcnt lgkmcnt(8)
    v_mfma_f32_16x16x32_bf16 v[70:73], v[174:177], v[134:137], v[70:73]
    ds_read_b64_tr_b16 v[196:197], v32 offset:29184
    s_waitcnt lgkmcnt(8)
    v_mfma_f32_16x16x32_bf16 v[70:73], v[178:181], v[146:149], v[70:73]
    ds_read_b64_tr_b16 v[174:175], v33 offset:24576
    s_waitcnt lgkmcnt(7)
    v_mfma_f32_16x16x32_bf16 v[66:69], v[182:185], v[130:133], v[66:69]
    ds_read_b64_tr_b16 v[176:177], v33 offset:25088
    s_waitcnt lgkmcnt(6)
    v_mfma_f32_16x16x32_bf16 v[66:69], v[186:189], v[142:145], v[66:69]
    ds_read_b64_tr_b16 v[178:179], v33 offset:28672
    v_mfma_f32_16x16x32_bf16 v[74:77], v[182:185], v[134:137], v[74:77]
    ds_read_b64_tr_b16 v[180:181], v33 offset:29184
    v_mfma_f32_16x16x32_bf16 v[74:77], v[186:189], v[146:149], v[74:77]
    ds_read_b128 v[126:129], v30 offset:0
    s_waitcnt lgkmcnt(7)
    v_mfma_f32_16x16x32_bf16 v[86:89], v[190:193], v[130:133], v[86:89]
    ds_read_b64_tr_b16 v[182:183], v32 offset:32768
    s_waitcnt lgkmcnt(6)
    v_mfma_f32_16x16x32_bf16 v[86:89], v[194:197], v[142:145], v[86:89]
    ds_read_b64_tr_b16 v[184:185], v32 offset:33280
    v_mfma_f32_16x16x32_bf16 v[94:97], v[190:193], v[134:137], v[94:97]
    ds_read_b128 v[138:141], v31 offset:0
    ds_read_b64_tr_b16 v[186:187], v32 offset:36864
    v_mfma_f32_16x16x32_bf16 v[94:97], v[194:197], v[146:149], v[94:97]
    ds_read_b64_tr_b16 v[188:189], v32 offset:37376
    s_waitcnt lgkmcnt(8)
    v_mfma_f32_16x16x32_bf16 v[90:93], v[174:177], v[130:133], v[90:93]
    ds_read_b64_tr_b16 v[190:191], v33 offset:32768
    s_waitcnt lgkmcnt(7)
    v_mfma_f32_16x16x32_bf16 v[90:93], v[178:181], v[142:145], v[90:93]
    ds_read_b64_tr_b16 v[192:193], v33 offset:33280
    v_mfma_f32_16x16x32_bf16 v[98:101], v[174:177], v[134:137], v[98:101]
    ds_read_b64_tr_b16 v[194:195], v33 offset:36864
    v_mfma_f32_16x16x32_bf16 v[98:101], v[178:181], v[146:149], v[98:101]
    ds_read_b64_tr_b16 v[196:197], v33 offset:37376
    s_waitcnt lgkmcnt(7)
    v_mfma_f32_16x16x32_bf16 v[102:105], v[126:129], v[182:185], v[102:105]
    s_waitcnt lgkmcnt(4)
    v_mfma_f32_16x16x32_bf16 v[102:105], v[138:141], v[186:189], v[102:105]
    v_mfma_f32_16x16x32_bf16 v[110:113], v[130:133], v[182:185], v[110:113]
    v_mfma_f32_16x16x32_bf16 v[110:113], v[142:145], v[186:189], v[110:113]
    s_waitcnt lgkmcnt(0)
    s_barrier
    ds_read_b128 v[154:157], v30 offset:12288
    ds_read_b64_tr_b16 v[174:175], v32 offset:40960
    ds_read_b64_tr_b16 v[176:177], v32 offset:41472
    ds_read_b128 v[166:169], v31 offset:12288
    v_mfma_f32_16x16x32_bf16 v[118:121], v[134:137], v[182:185], v[118:121]
    ds_read_b64_tr_b16 v[178:179], v32 offset:45056
    v_mfma_f32_16x16x32_bf16 v[118:121], v[146:149], v[186:189], v[118:121]
    ds_read_b64_tr_b16 v[180:181], v32 offset:45568
    v_mfma_f32_16x16x32_bf16 v[106:109], v[126:129], v[190:193], v[106:109]
    ds_read_b128 v[158:161], v30 offset:14336
    v_mfma_f32_16x16x32_bf16 v[106:109], v[138:141], v[194:197], v[106:109]
    ds_read_b128 v[170:173], v31 offset:14336
    v_mfma_f32_16x16x32_bf16 v[114:117], v[130:133], v[190:193], v[114:117]
    ds_read_b64_tr_b16 v[182:183], v33 offset:40960
    v_mfma_f32_16x16x32_bf16 v[114:117], v[142:145], v[194:197], v[114:117]
    ds_read_b64_tr_b16 v[184:185], v33 offset:41472
    v_mfma_f32_16x16x32_bf16 v[122:125], v[134:137], v[190:193], v[122:125]
    ds_read_b64_tr_b16 v[186:187], v33 offset:45056
    ds_read_b64_tr_b16 v[188:189], v33 offset:45568
    v_mfma_f32_16x16x32_bf16 v[122:125], v[146:149], v[194:197], v[122:125]
    ds_read_b64_tr_b16 v[190:191], v34 offset:0
    s_waitcnt lgkmcnt(10)
    v_mfma_f32_16x16x32_bf16 v[62:65], v[174:177], v[154:157], v[62:65]
    ds_read_b64_tr_b16 v[192:193], v34 offset:512
    s_waitcnt lgkmcnt(8)
    v_mfma_f32_16x16x32_bf16 v[62:65], v[178:181], v[166:169], v[62:65]
    ds_read_b64_tr_b16 v[194:195], v34 offset:4096
    s_waitcnt lgkmcnt(8)
    v_mfma_f32_16x16x32_bf16 v[70:73], v[174:177], v[158:161], v[70:73]
    ds_read_b64_tr_b16 v[196:197], v34 offset:4608
    s_waitcnt lgkmcnt(8)
    v_mfma_f32_16x16x32_bf16 v[70:73], v[178:181], v[170:173], v[70:73]
    ds_read_b64_tr_b16 v[174:175], v35 offset:0
    s_waitcnt lgkmcnt(7)
    v_mfma_f32_16x16x32_bf16 v[66:69], v[182:185], v[154:157], v[66:69]
    ds_read_b64_tr_b16 v[176:177], v35 offset:512
    s_waitcnt lgkmcnt(6)
    v_mfma_f32_16x16x32_bf16 v[66:69], v[186:189], v[166:169], v[66:69]
    ds_read_b64_tr_b16 v[178:179], v35 offset:4096
    v_mfma_f32_16x16x32_bf16 v[74:77], v[182:185], v[158:161], v[74:77]
    ds_read_b64_tr_b16 v[180:181], v35 offset:4608
    v_mfma_f32_16x16x32_bf16 v[74:77], v[186:189], v[170:173], v[74:77]
    ds_read_b128 v[150:153], v30 offset:10240
    s_waitcnt lgkmcnt(7)
    v_mfma_f32_16x16x32_bf16 v[86:89], v[190:193], v[154:157], v[86:89]
    ds_read_b64_tr_b16 v[182:183], v34 offset:8192
    s_waitcnt lgkmcnt(6)
    v_mfma_f32_16x16x32_bf16 v[86:89], v[194:197], v[166:169], v[86:89]
    ds_read_b64_tr_b16 v[184:185], v34 offset:8704
    v_mfma_f32_16x16x32_bf16 v[94:97], v[190:193], v[158:161], v[94:97]
    ds_read_b128 v[162:165], v31 offset:10240
    ds_read_b64_tr_b16 v[186:187], v34 offset:12288
    v_mfma_f32_16x16x32_bf16 v[94:97], v[194:197], v[170:173], v[94:97]
    ds_read_b64_tr_b16 v[188:189], v34 offset:12800
    s_waitcnt lgkmcnt(8)
    v_mfma_f32_16x16x32_bf16 v[90:93], v[174:177], v[154:157], v[90:93]
    ds_read_b64_tr_b16 v[190:191], v35 offset:8192
    s_waitcnt lgkmcnt(7)
    v_mfma_f32_16x16x32_bf16 v[90:93], v[178:181], v[166:169], v[90:93]
    ds_read_b64_tr_b16 v[192:193], v35 offset:8704
    v_mfma_f32_16x16x32_bf16 v[98:101], v[174:177], v[158:161], v[98:101]
    ds_read_b64_tr_b16 v[194:195], v35 offset:12288
    v_mfma_f32_16x16x32_bf16 v[98:101], v[178:181], v[170:173], v[98:101]
    ds_read_b64_tr_b16 v[196:197], v35 offset:12800
    s_waitcnt lgkmcnt(7)
    v_mfma_f32_16x16x32_bf16 v[102:105], v[150:153], v[182:185], v[102:105]
    s_waitcnt lgkmcnt(4)
    v_mfma_f32_16x16x32_bf16 v[102:105], v[162:165], v[186:189], v[102:105]
    v_mfma_f32_16x16x32_bf16 v[110:113], v[154:157], v[182:185], v[110:113]
    v_mfma_f32_16x16x32_bf16 v[110:113], v[166:169], v[186:189], v[110:113]
    v_mfma_f32_16x16x32_bf16 v[118:121], v[158:161], v[182:185], v[118:121]
    v_mfma_f32_16x16x32_bf16 v[118:121], v[170:173], v[186:189], v[118:121]
    s_waitcnt lgkmcnt(2)
    v_mfma_f32_16x16x32_bf16 v[106:109], v[150:153], v[190:193], v[106:109]
    s_waitcnt lgkmcnt(0)
    v_mfma_f32_16x16x32_bf16 v[106:109], v[162:165], v[194:197], v[106:109]
    v_mfma_f32_16x16x32_bf16 v[114:117], v[154:157], v[190:193], v[114:117]
    v_mfma_f32_16x16x32_bf16 v[114:117], v[166:169], v[194:197], v[114:117]
    v_mfma_f32_16x16x32_bf16 v[122:125], v[158:161], v[190:193], v[122:125]
    s_barrier
    ds_read_b128 v[130:133], v30 offset:22528
    ds_read_b64_tr_b16 v[174:175], v34 offset:16384
    ds_read_b64_tr_b16 v[176:177], v34 offset:16896
    ds_read_b128 v[142:145], v31 offset:22528
    ds_read_b64_tr_b16 v[178:179], v34 offset:20480
    ds_read_b64_tr_b16 v[180:181], v34 offset:20992
    ds_read_b128 v[134:137], v30 offset:24576
    ds_read_b128 v[146:149], v31 offset:24576
    ds_read_b64_tr_b16 v[182:183], v35 offset:16384
    ds_read_b64_tr_b16 v[184:185], v35 offset:16896
    ds_read_b64_tr_b16 v[186:187], v35 offset:20480
    ds_read_b64_tr_b16 v[188:189], v35 offset:20992
    ds_read_b64_tr_b16 v[198:199], v34 offset:24576
    v_mfma_f32_16x16x32_bf16 v[122:125], v[170:173], v[194:197], v[122:125]
    ds_read_b64_tr_b16 v[200:201], v34 offset:25088
    s_waitcnt lgkmcnt(11)
    v_mfma_f32_16x16x32_bf16 v[62:65], v[174:177], v[130:133], v[62:65]
    ds_read_b64_tr_b16 v[202:203], v34 offset:28672
    s_waitcnt lgkmcnt(9)
    v_mfma_f32_16x16x32_bf16 v[62:65], v[178:181], v[142:145], v[62:65]
    ds_read_b64_tr_b16 v[204:205], v34 offset:29184
    s_waitcnt lgkmcnt(9)
    v_mfma_f32_16x16x32_bf16 v[70:73], v[174:177], v[134:137], v[70:73]
    ds_read_b64_tr_b16 v[190:191], v35 offset:24576
    s_waitcnt lgkmcnt(9)
    v_mfma_f32_16x16x32_bf16 v[70:73], v[178:181], v[146:149], v[70:73]
    ds_read_b64_tr_b16 v[192:193], v35 offset:25088
    s_waitcnt lgkmcnt(8)
    v_mfma_f32_16x16x32_bf16 v[66:69], v[182:185], v[130:133], v[66:69]
    ds_read_b64_tr_b16 v[194:195], v35 offset:28672
    ds_read_b64_tr_b16 v[196:197], v35 offset:29184
    v_cvt_pk_bf16_f32 v150, v62, v63
    v_cvt_pk_bf16_f32 v151, v64, v65
    s_waitcnt lgkmcnt(8)
    v_mfma_f32_16x16x32_bf16 v[66:69], v[186:189], v[142:145], v[66:69]
    ds_read_b128 v[126:129], v30 offset:20480
    v_cndmask_b32 v158, 0, v150, s[54:55]
    v_cndmask_b32 v150, v150, 0, s[54:55]
    v_mfma_f32_16x16x32_bf16 v[74:77], v[182:185], v[134:137], v[74:77]
    ds_read_b128 v[138:141], v31 offset:20480
    v_cndmask_b32 v159, 0, v151, s[54:55]
    v_cndmask_b32 v151, v151, 0, s[54:55]
    v_mfma_f32_16x16x32_bf16 v[74:77], v[186:189], v[146:149], v[74:77]
    ds_read_b32 v40, v5 offset:4
    v_cvt_pk_bf16_f32 v154, v70, v71
    v_cvt_pk_bf16_f32 v155, v72, v73
    s_waitcnt lgkmcnt(9)
    v_mfma_f32_16x16x32_bf16 v[86:89], v[198:201], v[130:133], v[86:89]
    v_cndmask_b32 v162, 0, v154, s[54:55]
    v_cndmask_b32 v154, v154, 0, s[54:55]
    s_waitcnt lgkmcnt(7)
    v_mfma_f32_16x16x32_bf16 v[86:89], v[202:205], v[142:145], v[86:89]
    v_cndmask_b32 v163, 0, v155, s[54:55]
    v_cndmask_b32 v155, v155, 0, s[54:55]
    s_waitcnt lgkmcnt(5)
    v_mfma_f32_16x16x32_bf16 v[90:93], v[190:193], v[130:133], v[90:93]
    v_cvt_pk_bf16_f32 v152, v66, v67
    v_cvt_pk_bf16_f32 v153, v68, v69
    s_waitcnt lgkmcnt(3)
    v_mfma_f32_16x16x32_bf16 v[90:93], v[194:197], v[142:145], v[90:93]
    v_cndmask_b32 v160, 0, v152, s[56:57]
    v_cndmask_b32 v152, v152, 0, s[56:57]
    v_mfma_f32_16x16x32_bf16 v[94:97], v[198:201], v[134:137], v[94:97]
    v_cndmask_b32 v161, 0, v153, s[56:57]
    v_cndmask_b32 v153, v153, 0, s[56:57]
    v_mfma_f32_16x16x32_bf16 v[94:97], v[202:205], v[146:149], v[94:97]
    v_cvt_pk_bf16_f32 v156, v74, v75
    v_cvt_pk_bf16_f32 v157, v76, v77
    v_mfma_f32_16x16x32_bf16 v[98:101], v[190:193], v[134:137], v[98:101]
    v_cndmask_b32 v164, 0, v156, s[56:57]
    v_cndmask_b32 v156, v156, 0, s[56:57]
    v_mfma_f32_16x16x32_bf16 v[98:101], v[194:197], v[146:149], v[98:101]
    v_cndmask_b32 v165, 0, v157, s[56:57]
    v_cndmask_b32 v157, v157, 0, s[56:57]
    ds_read_b32 v48, v220 offset:56
    ds_read_b128 v[226:229], v218
    v_cvt_pk_bf16_f32 v230, v86, v87
    v_cvt_pk_bf16_f32 v231, v88, v89
    v_cvt_pk_bf16_f32 v232, v90, v91
    v_cvt_pk_bf16_f32 v233, v92, v93
    s_nop 1
    v_mfma_f32_16x16x32_bf16 v[66:69], v[230:233], v[150:153], 0
    v_mfma_f32_16x16x32_bf16 v[70:73], v[230:233], v[154:157], 0
    v_cvt_pk_bf16_f32 v234, v94, v95
    v_cvt_pk_bf16_f32 v235, v96, v97
    v_cvt_pk_bf16_f32 v236, v98, v99
    v_cvt_pk_bf16_f32 v237, v100, v101
    s_nop 1
    v_mfma_f32_16x16x32_bf16 v[74:77], v[234:237], v[154:157], 0
    v_mfma_f32_16x16x32_bf16 v[178:181], v[230:233], v[158:161], 0
    v_mfma_f32_16x16x32_bf16 v[182:185], v[230:233], v[162:165], 0
    v_mfma_f32_16x16x32_bf16 v[186:189], v[234:237], v[162:165], 0
    s_waitcnt lgkmcnt(0)
    v_cmp_ne_u32 vcc, 0, v48
    s_nop 0
    s_cbranch_vccnz D_dK
    s_mov_b32 s9, 0
D_lK:
    ds_read_b32 v48, v220 offset:56
    ds_read_b128 v[226:229], v218
    s_add_u32 s9, s9, 1
    s_cmp_gt_u32 s9, 1600000
    s_waitcnt lgkmcnt(0)
    s_cbranch_scc1 D_dK
    v_cmp_eq_u32 vcc, 0, v48
    s_nop 0
    s_cbranch_vccnz D_lK
            D_dK:

    v_mfma_f32_16x16x32_bf16 v[62:65], v[226:229], v[150:153], 0
    v_mfma_f32_16x16x32_bf16 v[174:177], v[226:229], v[158:161], 0
    v_readfirstlane_b32 s63, v40
    v_cndmask_b32 v74, v74, v75, s[44:45]
    ds_read_b32 v40, v5 offset:32
    v_cndmask_b32 v76, v76, v77, s[44:45]
    ds_read_b64_tr_b16 v[166:167], v34 offset:32768
    v_cndmask_b32 v70, v70, v71, s[44:45]
    ds_read_b64_tr_b16 v[168:169], v34 offset:33280
    v_cndmask_b32 v72, v72, v73, s[44:45]
    ds_read_b64_tr_b16 v[170:171], v35 offset:32768
    v_cndmask_b32 v212, v70, v74, s[46:47]
    ds_read_b64_tr_b16 v[172:173], v35 offset:33280
    v_cndmask_b32 v213, v72, v76, s[48:49]
    ds_read_b64_tr_b16 v[198:199], v34 offset:36864
    v_cndmask_b32 v66, v66, v67, s[44:45]
    ds_read_b64_tr_b16 v[200:201], v34 offset:37376
    v_cndmask_b32 v68, v68, v69, s[44:45]
    ds_read_b64_tr_b16 v[202:203], v35 offset:36864
    v_cndmask_b32 v62, v62, v63, s[44:45]
    ds_read_b64_tr_b16 v[204:205], v35 offset:37376
    v_cndmask_b32 v64, v64, v65, s[44:45]
    v_cndmask_b32 v210, v62, v66, s[46:47]
    v_cndmask_b32 v211, v64, v68, s[48:49]
    v_and_or_b32 v94, v210, v46, v50
    v_and_or_b32 v95, v211, v46, v51
    v_and_or_b32 v96, v212, v46, v52
    v_and_or_b32 v97, v213, v46, v53
    s_cmp_lg_u32 s101, 0
    s_cbranch_scc1 SM_jS1
    s_cmp_eq_u32 s63, 0
    s_cbranch_scc1 SM_sS1
    buffer_store_dwordx4 v[94:97], v4, s[36:39], s15 offen
SM_jS1:
    v_cndmask_b32 v186, v186, v187, s[44:45]
    v_cndmask_b32 v188, v188, v189, s[44:45]
    v_cndmask_b32 v182, v182, v183, s[44:45]
    v_cndmask_b32 v184, v184, v185, s[44:45]
    v_cndmask_b32 v208, v182, v186, s[46:47]
    v_cndmask_b32 v209, v184, v188, s[48:49]
    v_cndmask_b32 v178, v178, v179, s[44:45]
    v_cndmask_b32 v180, v180, v181, s[44:45]
    v_cndmask_b32 v174, v174, v175, s[44:45]
    v_cndmask_b32 v176, v176, v177, s[44:45]
    v_cndmask_b32 v206, v174, v178, s[46:47]
    v_cndmask_b32 v207, v176, v180, s[48:49]
    ds_write_b128 v42, v[206:209]
    ds_write_b32 v47, v5 offset:16
    s_waitcnt lgkmcnt(10)
    v_cmp_gt_u32 vcc, 4, v40
    s_nop 0
    s_cbranch_vccnz C_vr1
C_vd1:
    s_waitcnt lgkmcnt(8)
    v_mfma_f32_16x16x32_bf16 v[102:105], v[126:129], v[166:169], v[102:105]
    s_waitcnt lgkmcnt(4)
    v_mfma_f32_16x16x32_bf16 v[102:105], v[138:141], v[198:201], v[102:105]
    v_mfma_f32_16x16x32_bf16 v[106:109], v[126:129], v[170:173], v[106:109]
    s_waitcnt lgkmcnt(2)
    v_mfma_f32_16x16x32_bf16 v[106:109], v[138:141], v[202:205], v[106:109]
    v_mfma_f32_16x16x32_bf16 v[110:113], v[130:133], v[166:169], v[110:113]
    v_mfma_f32_16x16x32_bf16 v[110:113], v[142:145], v[198:201], v[110:113]
    v_mfma_f32_16x16x32_bf16 v[114:117], v[130:133], v[170:173], v[114:117]
    s_nop 1
    v_cvt_pk_bf16_f32 v226, v102, v103
    v_cvt_pk_bf16_f32 v227, v104, v105
    v_mfma_f32_16x16x32_bf16 v[114:117], v[142:145], v[202:205], v[114:117]
    v_cvt_pk_bf16_f32 v232, v106, v107
    v_cvt_pk_bf16_f32 v233, v108, v109
    ds_write2_b64 v219, v[226:227], v[232:233] offset1:1
    ds_write_b32 v221, v5
    v_mfma_f32_16x16x32_bf16 v[118:121], v[134:137], v[166:169], v[118:121]
    v_mfma_f32_16x16x32_bf16 v[118:121], v[146:149], v[198:201], v[118:121]
    v_mfma_f32_16x16x32_bf16 v[122:125], v[134:137], v[170:173], v[122:125]
    v_cvt_pk_bf16_f32 v228, v110, v111
    v_cvt_pk_bf16_f32 v229, v112, v113
    v_mfma_f32_16x16x32_bf16 v[122:125], v[146:149], v[202:205], v[122:125]
    v_cvt_pk_bf16_f32 v234, v114, v115
    v_cvt_pk_bf16_f32 v235, v116, v117
    v_cndmask_b32 v126, 0, v226, s[58:59]
    v_cndmask_b32 v226, v226, 0, s[58:59]
    v_cndmask_b32 v127, 0, v227, s[58:59]
    v_cndmask_b32 v227, v227, 0, s[58:59]
    v_cndmask_b32 v132, 0, v232, s[60:61]
    v_cndmask_b32 v232, v232, 0, s[60:61]
    v_cndmask_b32 v133, 0, v233, s[60:61]
    v_cndmask_b32 v233, v233, 0, s[60:61]
    buffer_load_dwordx4 v[214:217], v4, s[36:39], s100 offen sc1
    v_cvt_pk_bf16_f32 v230, v118, v119
    v_cvt_pk_bf16_f32 v231, v120, v121
    v_cvt_pk_bf16_f32 v236, v122, v123
    v_cvt_pk_bf16_f32 v237, v124, v125
    v_cndmask_b32 v128, 0, v228, s[58:59]
    v_cndmask_b32 v228, v228, 0, s[58:59]
    v_cndmask_b32 v129, 0, v229, s[58:59]
    v_cndmask_b32 v229, v229, 0, s[58:59]
    v_cndmask_b32 v134, 0, v234, s[60:61]
    v_cndmask_b32 v234, v234, 0, s[60:61]
    v_cndmask_b32 v135, 0, v235, s[60:61]
    v_cndmask_b32 v235, v235, 0, s[60:61]
    v_cndmask_b32 v130, 0, v230, s[58:59]
    v_cndmask_b32 v230, v230, 0, s[58:59]
    v_cndmask_b32 v131, 0, v231, s[58:59]
    v_cndmask_b32 v231, v231, 0, s[58:59]
    v_cndmask_b32 v136, 0, v236, s[60:61]
    v_cndmask_b32 v236, v236, 0, s[60:61]
    v_cndmask_b32 v137, 0, v237, s[60:61]
    v_cndmask_b32 v237, v237, 0, s[60:61]
    s_waitcnt lgkmcnt(0)
C_join:
    s_mov_b32 s9, 0
    s_add_u32 s19, s100, 14336
    s_cmp_lg_u32 s101, 0
    s_cbranch_scc1 C_sv
    s_mov_b32 s40, 0x0c0c0400
    s_mov_b32 s41, 0x05040100
        C_sl:
    s_waitcnt vmcnt(0)
    v_perm_b32 v2, v215, v214, s40
    v_perm_b32 v3, v217, v216, s40
    v_and_b32 v214, v46, v214
    v_perm_b32 v2, v3, v2, s41
    v_and_b32 v215, v46, v215
    v_cmp_ne_u32 vcc, s12, v2
    v_and_b32 v216, v46, v216
    v_and_b32 v217, v46, v217
    s_cbranch_vccnz C_sr
        C_sk:

    v_pk_add_f32 v[210:211], v[210:211], v[214:215]
    v_pk_add_f32 v[212:213], v[212:213], v[216:217]
C_sv:
    v_max_f32 v222, v210, v211
    v_max_f32 v223, v212, v213
    v_mov_b32 v224, v222
    v_mov_b32 v225, v223
    s_nop 0
    v_permlane16_swap_b32 v222, v224
    v_permlane16_swap_b32 v223, v225
    v_max_f32 v222, v222, v224
    v_max_f32 v223, v223, v225
    v_mov_b32 v224, v222
    v_mov_b32 v225, v223
    s_nop 0
    v_permlane32_swap_b32 v222, v224
    v_permlane32_swap_b32 v223, v225
    v_max_f32 v222, v222, v224
    v_max_f32 v223, v223, v225
    v_mul_f32 v222, s0, v222
    v_mul_f32 v223, s0, v223
    v_fma_f32 v210, v210, s0, -v222
    v_fma_f32 v211, v211, s0, -v222
    v_fma_f32 v212, v212, s0, -v223
    v_fma_f32 v213, v213, s0, -v223
    v_exp_f32 v210, v210
    v_exp_f32 v211, v211
    v_exp_f32 v212, v212
    v_exp_f32 v213, v213
    v_add_f32 v222, v210, v211
    v_add_f32 v223, v212, v213
    v_mov_b32 v224, v222
    v_mov_b32 v225, v223
    ds_read_b32 v48, v47 offset:40
    ds_read_b128 v[78:81], v43 offset:49152
    ds_read_b128 v[82:85], v43 offset:50176
    ds_read_b32 v7, v5 offset:12
    v_permlane16_swap_b32 v222, v224
    v_permlane16_swap_b32 v223, v225
    v_add_f32 v222, v222, v224
    v_add_f32 v223, v223, v225
    v_mov_b32 v224, v222
    v_mov_b32 v225, v223
    s_nop 0
    v_permlane32_swap_b32 v222, v224
    v_permlane32_swap_b32 v223, v225
    v_add_f32 v222, v222, v224
    v_add_f32 v223, v223, v225
    v_rcp_f32 v222, v222
    v_rcp_f32 v223, v223
    s_waitcnt lgkmcnt(0)
    v_cmp_eq_u32 vcc, 0, v48
    v_mul_f32 v210, v210, v222
    v_mul_f32 v211, v211, v222
    v_mul_f32 v212, v212, v223
    v_mul_f32 v213, v213, v223
    v_cvt_pk_bf16_f32 v210, v210, v210
    v_cvt_pk_bf16_f32 v211, v211, v211
    v_cvt_pk_bf16_f32 v212, v212, v212
    v_cvt_pk_bf16_f32 v213, v213, v213
    s_cbranch_vccnz C_pr
C_pd:
    v_mfma_f32_16x16x32_bf16 v[62:65], v[126:129], v[78:81], 0
    v_and_b32 v86, v36, v210
    v_and_b32 v87, v37, v211
    v_mfma_f32_16x16x32_bf16 v[66:69], v[132:135], v[78:81], 0
    v_and_b32 v88, v38, v210
    v_and_b32 v89, v39, v211
    v_mfma_f32_16x16x32_bf16 v[70:73], v[128:131], v[82:85], 0
    v_and_b32 v90, v36, v212
    v_and_b32 v91, v37, v213
    v_mfma_f32_16x16x32_bf16 v[74:77], v[134:137], v[82:85], 0
    v_and_b32 v92, v38, v212
    v_and_b32 v93, v39, v213
    v_mfma_f32_16x16x32_bf16 v[62:65], v[226:229], v[86:89], v[62:65]
    v_mfma_f32_16x16x32_bf16 v[66:69], v[232:235], v[86:89], v[66:69]
    v_mfma_f32_16x16x32_bf16 v[70:73], v[228:231], v[90:93], v[70:73]
    v_mfma_f32_16x16x32_bf16 v[74:77], v[234:237], v[90:93], v[74:77]
    s_cmp_eq_u32 s63, 0
    s_cbranch_scc1 SM_sO
    s_nop 2
    v_cvt_pk_bf16_f32 v54, v62, v63
    v_cvt_pk_bf16_f32 v55, v64, v65
    v_cvt_pk_bf16_f32 v56, v66, v67
    v_cvt_pk_bf16_f32 v57, v68, v69
    buffer_store_dwordx4 v[54:57], v4, s[36:39], s100 offen nt
    v_cvt_pk_bf16_f32 v58, v70, v71
    v_cvt_pk_bf16_f32 v59, v72, v73
    v_cvt_pk_bf16_f32 v60, v74, v75
    v_cvt_pk_bf16_f32 v61, v76, v77
    buffer_store_dwordx4 v[58:61], v4, s[36:39], s19 offen nt
SM_jO:
    v_cmp_gt_u32 vcc, 4, v7
    s_nop 0
    s_cbranch_vccz W_dW
    s_mov_b32 s9, 0
        W_lW:
    ds_read_b32 v2, v5 offset:12
    s_add_u32 s9, s9, 1
    s_cmp_gt_u32 s9, 1600000
    s_cbranch_scc1 W_dW
    s_waitcnt lgkmcnt(0)
    v_cmp_gt_u32 vcc, 4, v2
    s_nop 0
    s_cbranch_vccnz W_lW
        W_dW:

    ds_read_b64_tr_b16 v[76:77], v16 offset:0
    ds_read_b64_tr_b16 v[78:79], v16 offset:2048
    ds_read_b64_tr_b16 v[80:81], v17 offset:0
    ds_read_b64_tr_b16 v[82:83], v17 offset:2048
    ds_read_b64_tr_b16 v[84:85], v18 offset:0
    ds_read_b64_tr_b16 v[86:87], v18 offset:2048
    ds_read_b64_tr_b16 v[88:89], v19 offset:0
    ds_read_b64_tr_b16 v[90:91], v19 offset:2048
    ds_read_b64_tr_b16 v[92:93], v16 offset:4096
    ds_read_b64_tr_b16 v[94:95], v16 offset:6144
    ds_read_b64_tr_b16 v[96:97], v17 offset:4096
    ds_read_b64_tr_b16 v[98:99], v17 offset:6144
    ds_read_b64_tr_b16 v[100:101], v18 offset:4096
    ds_read_b64_tr_b16 v[102:103], v18 offset:6144
    ds_read_b64_tr_b16 v[104:105], v19 offset:4096
    ds_read_b64_tr_b16 v[106:107], v19 offset:6144
    ds_read_b64_tr_b16 v[108:109], v16 offset:8192
    ds_read_b64_tr_b16 v[110:111], v16 offset:10240
    ds_read_b64_tr_b16 v[112:113], v17 offset:8192
    ds_read_b64_tr_b16 v[114:115], v17 offset:10240
    ds_read_b64_tr_b16 v[116:117], v18 offset:8192
    ds_read_b64_tr_b16 v[118:119], v18 offset:10240
    ds_read_b64_tr_b16 v[120:121], v19 offset:8192
    ds_read_b64_tr_b16 v[122:123], v19 offset:10240
    ds_read_b64_tr_b16 v[124:125], v16 offset:12288
    ds_read_b64_tr_b16 v[126:127], v16 offset:14336
    ds_read_b64_tr_b16 v[128:129], v17 offset:12288
    ds_read_b64_tr_b16 v[130:131], v17 offset:14336
    ds_read_b64_tr_b16 v[132:133], v18 offset:12288
    ds_read_b64_tr_b16 v[134:135], v18 offset:14336
    ds_read_b64_tr_b16 v[136:137], v19 offset:12288
    ds_read_b64_tr_b16 v[138:139], v19 offset:14336
    s_waitcnt vmcnt(0)
    s_mov_b64 exec, 1
    s_cmp_eq_u32 s63, 0
    s_cbranch_scc1 SM_sF
    buffer_store_dwordx2 v[14:15], v6, s[36:39], s21 offen
SM_jF:
    s_mov_b64 exec, -1
    ds_read_b64_tr_b16 v[140:141], v16 offset:16384
    ds_read_b64_tr_b16 v[142:143], v16 offset:18432
    ds_read_b64_tr_b16 v[144:145], v17 offset:16384
    ds_read_b64_tr_b16 v[146:147], v17 offset:18432
    ds_read_b64_tr_b16 v[148:149], v18 offset:16384
    ds_read_b64_tr_b16 v[150:151], v18 offset:18432
    ds_read_b64_tr_b16 v[152:153], v19 offset:16384
    ds_read_b64_tr_b16 v[154:155], v19 offset:18432
    ds_read_b64_tr_b16 v[156:157], v16 offset:20480
    ds_read_b64_tr_b16 v[158:159], v16 offset:22528
    ds_read_b64_tr_b16 v[160:161], v17 offset:20480
    ds_read_b64_tr_b16 v[162:163], v17 offset:22528
    ds_read_b64_tr_b16 v[164:165], v18 offset:20480
    ds_read_b64_tr_b16 v[166:167], v18 offset:22528
    ds_read_b64_tr_b16 v[168:169], v19 offset:20480
    ds_read_b64_tr_b16 v[170:171], v19 offset:22528
    ds_read_b64_tr_b16 v[172:173], v16 offset:24576
    ds_read_b64_tr_b16 v[174:175], v16 offset:26624
    ds_read_b64_tr_b16 v[176:177], v17 offset:24576
    ds_read_b64_tr_b16 v[178:179], v17 offset:26624
    ds_read_b64_tr_b16 v[180:181], v18 offset:24576
    ds_read_b64_tr_b16 v[182:183], v18 offset:26624
    ds_read_b64_tr_b16 v[184:185], v19 offset:24576
    ds_read_b64_tr_b16 v[186:187], v19 offset:26624
    buffer_load_dwordx2 v[12:13], v8, s[36:39], s20 offen sc1
    ds_read_b64_tr_b16 v[188:189], v16 offset:28672
    ds_read_b64_tr_b16 v[190:191], v16 offset:30720
    ds_read_b64_tr_b16 v[192:193], v17 offset:28672
    ds_read_b64_tr_b16 v[194:195], v17 offset:30720
    ds_read_b64_tr_b16 v[196:197], v18 offset:28672
    ds_read_b64_tr_b16 v[198:199], v18 offset:30720
    ds_read_b64_tr_b16 v[200:201], v19 offset:28672
    ds_read_b64_tr_b16 v[202:203], v19 offset:30720
    ds_read_b64_tr_b16 v[204:205], v16 offset:32768
    ds_read_b64_tr_b16 v[206:207], v16 offset:34816
    ds_read_b64_tr_b16 v[208:209], v17 offset:32768
    ds_read_b64_tr_b16 v[210:211], v17 offset:34816
    ds_read_b64_tr_b16 v[212:213], v18 offset:32768
    ds_read_b64_tr_b16 v[214:215], v18 offset:34816
    ds_read_b64_tr_b16 v[216:217], v19 offset:32768
    ds_read_b64_tr_b16 v[218:219], v19 offset:34816
    ds_read_b64_tr_b16 v[220:221], v16 offset:36864
    ds_read_b64_tr_b16 v[222:223], v16 offset:38912
    ds_read_b64_tr_b16 v[224:225], v17 offset:36864
    ds_read_b64_tr_b16 v[226:227], v17 offset:38912
    ds_read_b64_tr_b16 v[228:229], v18 offset:36864
    ds_read_b64_tr_b16 v[230:231], v18 offset:38912
    ds_read_b64_tr_b16 v[232:233], v19 offset:36864
    ds_read_b64_tr_b16 v[234:235], v19 offset:38912
    s_mov_b32 s9, 0
        P_lO:
    s_waitcnt vmcnt(0)
    v_cmp_ne_u64 vcc, s[12:13], v[12:13]
    s_nop 0
    s_cbranch_vccz P_dO
    buffer_load_dwordx2 v[12:13], v8, s[36:39], s20 offen sc1
    s_add_u32 s9, s9, 1
    s_cmp_lt_u32 s9, 200000
    s_cbranch_scc1 P_lO
    s_waitcnt vmcnt(0)
        P_dO:

    buffer_load_dwordx4 v[40:43], v4, s[36:39], s22 offen offset:0 sc1
    buffer_load_dwordx4 v[44:47], v4, s[36:39], s22 offen offset:1024 sc1
    buffer_load_dwordx4 v[48:51], v4, s[36:39], s22 offen offset:2048 sc1
    buffer_load_dwordx4 v[52:55], v4, s[36:39], s22 offen offset:3072 sc1
    s_add_u32 s22, s22, 4096
    buffer_load_dwordx4 v[56:59], v4, s[36:39], s22 offen offset:0 sc1
    buffer_load_dwordx4 v[60:63], v4, s[36:39], s22 offen offset:1024 sc1
    s_waitcnt vmcnt(5)
    s_waitcnt lgkmcnt(15)
    v_mfma_f32_16x16x32_bf16 v[24:27], v[76:79], v[40:43], 0
    buffer_load_dwordx4 v[64:67], v4, s[36:39], s22 offen offset:2048 sc1
    ds_read_b64_tr_b16 v[76:77], v16 offset:40960
    ds_read_b64_tr_b16 v[78:79], v16 offset:43008
    v_mfma_f32_16x16x32_bf16 v[28:31], v[80:83], v[40:43], 0
    ds_read_b64_tr_b16 v[80:81], v17 offset:40960
    ds_read_b64_tr_b16 v[82:83], v17 offset:43008
    v_mfma_f32_16x16x32_bf16 v[32:35], v[84:87], v[40:43], 0
    ds_read_b64_tr_b16 v[84:85], v18 offset:40960
    ds_read_b64_tr_b16 v[86:87], v18 offset:43008
    v_mfma_f32_16x16x32_bf16 v[36:39], v[88:91], v[40:43], 0
    ds_read_b64_tr_b16 v[88:89], v19 offset:40960
    ds_read_b64_tr_b16 v[90:91], v19 offset:43008
    s_waitcnt vmcnt(5)
    v_mfma_f32_16x16x32_bf16 v[24:27], v[92:95], v[44:47], v[24:27]
    buffer_load_dwordx4 v[68:71], v4, s[36:39], s22 offen offset:3072 sc1
    s_add_u32 s22, s22, 4096
    ds_read_b64_tr_b16 v[92:93], v16 offset:45056
    ds_read_b64_tr_b16 v[94:95], v16 offset:47104
    v_mfma_f32_16x16x32_bf16 v[28:31], v[96:99], v[44:47], v[28:31]
    ds_read_b64_tr_b16 v[96:97], v17 offset:45056
    ds_read_b64_tr_b16 v[98:99], v17 offset:47104
    v_mfma_f32_16x16x32_bf16 v[32:35], v[100:103], v[44:47], v[32:35]
    ds_read_b64_tr_b16 v[100:101], v18 offset:45056
    ds_read_b64_tr_b16 v[102:103], v18 offset:47104
    v_mfma_f32_16x16x32_bf16 v[36:39], v[104:107], v[44:47], v[36:39]
    ds_read_b64_tr_b16 v[104:105], v19 offset:45056
    ds_read_b64_tr_b16 v[106:107], v19 offset:47104
    s_waitcnt vmcnt(5)
    v_mfma_f32_16x16x32_bf16 v[24:27], v[108:111], v[48:51], v[24:27]
    buffer_load_dwordx4 v[72:75], v4, s[36:39], s22 offen offset:0 sc1
    ds_read_b64_tr_b16 v[108:109], v16 offset:49152
    ds_read_b64_tr_b16 v[110:111], v16 offset:51200
    v_mfma_f32_16x16x32_bf16 v[28:31], v[112:115], v[48:51], v[28:31]
    ds_read_b64_tr_b16 v[112:113], v17 offset:49152
    ds_read_b64_tr_b16 v[114:115], v17 offset:51200
    v_mfma_f32_16x16x32_bf16 v[32:35], v[116:119], v[48:51], v[32:35]
    ds_read_b64_tr_b16 v[116:117], v18 offset:49152
    ds_read_b64_tr_b16 v[118:119], v18 offset:51200
    v_mfma_f32_16x16x32_bf16 v[36:39], v[120:123], v[48:51], v[36:39]
    ds_read_b64_tr_b16 v[120:121], v19 offset:49152
    ds_read_b64_tr_b16 v[122:123], v19 offset:51200
    s_waitcnt vmcnt(5)
    v_mfma_f32_16x16x32_bf16 v[24:27], v[124:127], v[52:55], v[24:27]
    buffer_load_dwordx4 v[40:43], v4, s[36:39], s22 offen offset:1024 sc1
    ds_read_b64_tr_b16 v[124:125], v16 offset:53248
    ds_read_b64_tr_b16 v[126:127], v16 offset:55296
    v_mfma_f32_16x16x32_bf16 v[28:31], v[128:131], v[52:55], v[28:31]
    ds_read_b64_tr_b16 v[128:129], v17 offset:53248
    ds_read_b64_tr_b16 v[130:131], v17 offset:55296
    v_mfma_f32_16x16x32_bf16 v[32:35], v[132:135], v[52:55], v[32:35]
    ds_read_b64_tr_b16 v[132:133], v18 offset:53248
    ds_read_b64_tr_b16 v[134:135], v18 offset:55296
    v_mfma_f32_16x16x32_bf16 v[36:39], v[136:139], v[52:55], v[36:39]
    ds_read_b64_tr_b16 v[136:137], v19 offset:53248
    ds_read_b64_tr_b16 v[138:139], v19 offset:55296
    s_waitcnt vmcnt(5)
    v_mfma_f32_16x16x32_bf16 v[24:27], v[140:143], v[56:59], v[24:27]
    buffer_load_dwordx4 v[44:47], v4, s[36:39], s22 offen offset:2048 sc1
    v_mfma_f32_16x16x32_bf16 v[28:31], v[144:147], v[56:59], v[28:31]
    v_mfma_f32_16x16x32_bf16 v[32:35], v[148:151], v[56:59], v[32:35]
    v_mfma_f32_16x16x32_bf16 v[36:39], v[152:155], v[56:59], v[36:39]
    s_waitcnt vmcnt(5)
    v_mfma_f32_16x16x32_bf16 v[24:27], v[156:159], v[60:63], v[24:27]
    buffer_load_dwordx4 v[48:51], v4, s[36:39], s22 offen offset:3072 sc1
    s_add_u32 s22, s22, 4096
    v_mfma_f32_16x16x32_bf16 v[28:31], v[160:163], v[60:63], v[28:31]
    v_mfma_f32_16x16x32_bf16 v[32:35], v[164:167], v[60:63], v[32:35]
    v_mfma_f32_16x16x32_bf16 v[36:39], v[168:171], v[60:63], v[36:39]
    s_waitcnt vmcnt(5)
    v_mfma_f32_16x16x32_bf16 v[24:27], v[172:175], v[64:67], v[24:27]
    buffer_load_dwordx4 v[52:55], v4, s[36:39], s22 offen offset:0 sc1
    v_mfma_f32_16x16x32_bf16 v[28:31], v[176:179], v[64:67], v[28:31]
    v_mfma_f32_16x16x32_bf16 v[32:35], v[180:183], v[64:67], v[32:35]
    v_mfma_f32_16x16x32_bf16 v[36:39], v[184:187], v[64:67], v[36:39]
    s_waitcnt vmcnt(5)
    v_mfma_f32_16x16x32_bf16 v[24:27], v[188:191], v[68:71], v[24:27]
    buffer_load_dwordx4 v[56:59], v4, s[36:39], s22 offen offset:1024 sc1
    v_mfma_f32_16x16x32_bf16 v[28:31], v[192:195], v[68:71], v[28:31]
    v_mfma_f32_16x16x32_bf16 v[32:35], v[196:199], v[68:71], v[32:35]
    v_mfma_f32_16x16x32_bf16 v[36:39], v[200:203], v[68:71], v[36:39]
    s_waitcnt vmcnt(5)
    s_waitcnt lgkmcnt(15)
    v_mfma_f32_16x16x32_bf16 v[24:27], v[204:207], v[72:75], v[24:27]
    v_mfma_f32_16x16x32_bf16 v[28:31], v[208:211], v[72:75], v[28:31]
    v_mfma_f32_16x16x32_bf16 v[32:35], v[212:215], v[72:75], v[32:35]
    v_mfma_f32_16x16x32_bf16 v[36:39], v[216:219], v[72:75], v[36:39]
    s_waitcnt vmcnt(4)
    v_mfma_f32_16x16x32_bf16 v[24:27], v[220:223], v[40:43], v[24:27]
    v_mfma_f32_16x16x32_bf16 v[28:31], v[224:227], v[40:43], v[28:31]
    v_mfma_f32_16x16x32_bf16 v[32:35], v[228:231], v[40:43], v[32:35]
    v_mfma_f32_16x16x32_bf16 v[36:39], v[232:235], v[40:43], v[36:39]
    s_waitcnt vmcnt(3)
    v_mfma_f32_16x16x32_bf16 v[24:27], v[76:79], v[44:47], v[24:27]
    v_mfma_f32_16x16x32_bf16 v[28:31], v[80:83], v[44:47], v[28:31]
    v_mfma_f32_16x16x32_bf16 v[32:35], v[84:87], v[44:47], v[32:35]
    v_mfma_f32_16x16x32_bf16 v[36:39], v[88:91], v[44:47], v[36:39]
    s_waitcnt vmcnt(2)
    v_mfma_f32_16x16x32_bf16 v[24:27], v[92:95], v[48:51], v[24:27]
    v_mfma_f32_16x16x32_bf16 v[28:31], v[96:99], v[48:51], v[28:31]
    v_mfma_f32_16x16x32_bf16 v[32:35], v[100:103], v[48:51], v[32:35]
    v_mfma_f32_16x16x32_bf16 v[36:39], v[104:107], v[48:51], v[36:39]
    s_waitcnt vmcnt(1)
    s_waitcnt lgkmcnt(14)
    v_mfma_f32_16x16x32_bf16 v[24:27], v[108:111], v[52:55], v[24:27]
    s_waitcnt lgkmcnt(12)
    v_mfma_f32_16x16x32_bf16 v[28:31], v[112:115], v[52:55], v[28:31]
    s_waitcnt lgkmcnt(10)
    v_mfma_f32_16x16x32_bf16 v[32:35], v[116:119], v[52:55], v[32:35]
    s_waitcnt lgkmcnt(8)
    v_mfma_f32_16x16x32_bf16 v[36:39], v[120:123], v[52:55], v[36:39]
    s_waitcnt vmcnt(0)
    s_waitcnt lgkmcnt(6)
    v_mfma_f32_16x16x32_bf16 v[24:27], v[124:127], v[56:59], v[24:27]
    s_waitcnt lgkmcnt(4)
    v_mfma_f32_16x16x32_bf16 v[28:31], v[128:131], v[56:59], v[28:31]
    s_waitcnt lgkmcnt(2)
    v_mfma_f32_16x16x32_bf16 v[32:35], v[132:135], v[56:59], v[32:35]
    s_waitcnt lgkmcnt(0)
    v_mfma_f32_16x16x32_bf16 v[36:39], v[136:139], v[56:59], v[36:39]
    s_nop 1
    v_cvt_pk_bf16_f32 v156, v24, v25
    v_cvt_pk_bf16_f32 v157, v26, v27
    ds_write_b64 v20, v[156:157]
    v_cvt_pk_bf16_f32 v158, v28, v29
    v_cvt_pk_bf16_f32 v159, v30, v31
    ds_write_b64 v21, v[158:159]
    v_cvt_pk_bf16_f32 v160, v32, v33
    v_cvt_pk_bf16_f32 v161, v34, v35
    ds_write_b64 v22, v[160:161]
    v_cvt_pk_bf16_f32 v162, v36, v37
    v_cvt_pk_bf16_f32 v163, v38, v39
    ds_write_b64 v23, v[162:163]
    ds_read_b128 v[172:175], v9
    ds_read_b128 v[176:179], v9 offset:1024
    s_waitcnt lgkmcnt(1)
    buffer_store_dwordx4 v[172:175], v10, s[32:35], s23 offen nt
    s_waitcnt lgkmcnt(0)
    buffer_store_dwordx4 v[176:179], v10, s[32:35], s28 offen nt

    s_add_u32 s40, s7, s62
    s_cmp_lg_u32 s40, 0
    s_cbranch_scc1 C_end
    s_add_u32 s40, s10, 16
    v_mov_b32 v2, s40
    s_lshl_b32 s40, s8, 7
    s_mov_b64 exec, 1
    buffer_store_dword v2, v6, s[36:39], s40 offen
        C_end:

    s_endpgm
X_cH:
    s_mov_b32 s9, 0
        X_lH:
    v_cmp_ne_u64 vcc, s[28:29], v[18:19]
    s_nop 0
    s_cbranch_vccz X_okH
    v_subrev_u32 v18, s12, v18
    v_cmp_ne_u32 s[42:43], s13, v19
    v_cmp_le_u32 vcc, 8, v18
    s_nop 0
    s_or_b64 vcc, vcc, s[42:43]
    s_cbranch_vccz X_nH
    buffer_load_dwordx2 v[18:19], v20, s[36:39], s30 offen sc1
    s_add_u32 s9, s9, 1
    s_cmp_lt_u32 s9, 200000
    s_waitcnt vmcnt(0)
    s_cbranch_scc1 X_lH
        X_nH:
    s_mov_b32 s101, 0
    s_branch X_okH
S_cls0:
    s_cmp_eq_u32 s57, 0
    s_cbranch_scc0 S_cls1
    v_cmp_eq_u32 s[42:43], 0, v3
    v_mov_b32 v4, 0x3f80
    s_nop 0
    v_cndmask_b32 v28, v28, v4, s[42:43]
    v_mov_b32 v32, 0
    v_mov_b32 v40, 0
    v_cndmask_b32 v29, v29, v4, s[42:43]
    v_mov_b32 v33, 0
    v_mov_b32 v41, 0
    v_cndmask_b32 v30, v30, v4, s[42:43]
    v_mov_b32 v34, 0
    v_mov_b32 v42, 0
    v_cndmask_b32 v31, v31, v4, s[42:43]
    v_mov_b32 v35, 0
    v_mov_b32 v43, 0
    s_branch S_reg
S_cls1:
    v_mov_b32 v32, v28
    v_mov_b32 v28, 0
    v_mov_b32 v40, v36
    v_mov_b32 v36, 0
    v_mov_b32 v33, v29
    v_mov_b32 v29, 0
    v_mov_b32 v41, v37
    v_mov_b32 v37, 0
    v_mov_b32 v34, v30
    v_mov_b32 v30, 0
    v_mov_b32 v42, v38
    v_mov_b32 v38, 0
    v_mov_b32 v35, v31
    v_mov_b32 v31, 0
    v_mov_b32 v43, v39
    v_mov_b32 v39, 0
    s_branch S_reg
S_gr:
    s_add_u32 s9, s9, 1
    s_cmp_gt_u32 s9, 200000
    s_cbranch_scc1 S_gk
    buffer_load_dwordx4 v44, s[36:39], s60 offen offset:0 sc1 lds
    buffer_load_dwordx4 v45, s[36:39], s60 offen offset:1024 sc1 lds
    buffer_load_dwordx4 v44, s[36:39], s60 offen offset:2048 sc1 lds
    buffer_load_dwordx4 v45, s[36:39], s60 offen offset:3072 sc1 lds
    s_branch S_gc
S_x0:
    v_cmp_eq_u32 s[42:43], 0, v3
    v_mov_b32 v4, 0x3f800000
    s_nop 0
    v_cndmask_b32 v32, 0, v4, s[42:43]
    v_cndmask_b32 v33, 0, v4, s[42:43]
    v_cndmask_b32 v34, 0, v4, s[42:43]
    v_cndmask_b32 v35, 0, v4, s[42:43]
    s_nop 1
    v_mfma_f32_16x16x32_bf16 v[170:173], v[166:169], v[32:35], 0
    v_mfma_f32_16x16x32_bf16 v[178:181], v[174:177], v[32:35], 0
    v_mfma_f32_16x16x32_bf16 v[186:189], v[182:185], v[32:35], 0
    v_mfma_f32_16x16x32_bf16 v[194:197], v[190:193], v[32:35], 0
    s_lshl_b32 s40, s3, 11
    s_add_u32 s40, s40, 32768
    v_add_u32 v4, s40, v47
    s_nop 1
    v_cvt_pk_bf16_f32 v36, v170, v171
    v_cvt_pk_bf16_f32 v37, v172, v173
    v_cvt_pk_bf16_f32 v38, v178, v179
    v_cvt_pk_bf16_f32 v39, v180, v181
    ds_write_b128 v4, v[36:39] offset:32768
    v_cvt_pk_bf16_f32 v40, v186, v187
    v_cvt_pk_bf16_f32 v41, v188, v189
    v_cvt_pk_bf16_f32 v42, v194, v195
    v_cvt_pk_bf16_f32 v43, v196, v197
    ds_write_b128 v4, v[40:43] offset:33792
    s_branch S_x1
S_y0:
    v_add_u32 v4, 32768, v47
    ds_read_b128 v[166:169], v4 offset:32768
    ds_read_b128 v[170:173], v4 offset:33792
    ds_read_b128 v[174:177], v4 offset:34816
    ds_read_b128 v[178:181], v4 offset:35840
    ds_read_b128 v[182:185], v4 offset:36864
    ds_read_b128 v[186:189], v4 offset:37888
    ds_read_b128 v[190:193], v4 offset:38912
    ds_read_b128 v[194:197], v4 offset:39936
    s_waitcnt lgkmcnt(0)
    v_mfma_f32_16x16x32_bf16 v[206:209], v[102:105], v[166:169], v[206:209]
    v_mfma_f32_16x16x32_bf16 v[206:209], v[106:109], v[170:173], v[206:209]
    v_mfma_f32_16x16x32_bf16 v[210:213], v[110:113], v[174:177], v[210:213]
    v_mfma_f32_16x16x32_bf16 v[210:213], v[114:117], v[178:181], v[210:213]
    v_mfma_f32_16x16x32_bf16 v[222:225], v[134:137], v[182:185], v[222:225]
    v_mfma_f32_16x16x32_bf16 v[222:225], v[138:141], v[186:189], v[222:225]
    v_mfma_f32_16x16x32_bf16 v[226:229], v[142:145], v[190:193], v[226:229]
    v_mfma_f32_16x16x32_bf16 v[226:229], v[146:149], v[194:197], v[226:229]
    s_nop 7
    s_branch S_y1
SM_sS0:
    buffer_store_dwordx4 v[94:97], v4, s[36:39], s15 offen sc1
    s_branch SM_jS0
C_vr0:
    s_mov_b32 s9, 0
        W_lV0:
    ds_read_b32 v2, v5 offset:32
    s_add_u32 s9, s9, 1
    s_cmp_gt_u32 s9, 1600000
    s_cbranch_scc1 W_dV0
    s_waitcnt lgkmcnt(0)
    v_cmp_gt_u32 vcc, 4, v2
    s_nop 0
    s_cbranch_vccnz W_lV0
        W_dV0:

    ds_read_b64_tr_b16 v[166:167], v34 offset:32768
    ds_read_b64_tr_b16 v[168:169], v34 offset:33280
    ds_read_b64_tr_b16 v[170:171], v35 offset:32768
    ds_read_b64_tr_b16 v[172:173], v35 offset:33280
    ds_read_b64_tr_b16 v[198:199], v34 offset:36864
    ds_read_b64_tr_b16 v[200:201], v34 offset:37376
    ds_read_b64_tr_b16 v[202:203], v35 offset:36864
    ds_read_b64_tr_b16 v[204:205], v35 offset:37376
    s_waitcnt lgkmcnt(0)
    s_branch C_vd0
SM_sS1:
    buffer_store_dwordx4 v[94:97], v4, s[36:39], s15 offen sc1
    s_branch SM_jS1
C_vr1:
    s_mov_b32 s9, 0
        W_lV1:
    ds_read_b32 v2, v5 offset:32
    s_add_u32 s9, s9, 1
    s_cmp_gt_u32 s9, 1600000
    s_cbranch_scc1 W_dV1
    s_waitcnt lgkmcnt(0)
    v_cmp_gt_u32 vcc, 4, v2
    s_nop 0
    s_cbranch_vccnz W_lV1
        W_dV1:

    ds_read_b64_tr_b16 v[166:167], v34 offset:32768
    ds_read_b64_tr_b16 v[168:169], v34 offset:33280
    ds_read_b64_tr_b16 v[170:171], v35 offset:32768
    ds_read_b64_tr_b16 v[172:173], v35 offset:33280
    ds_read_b64_tr_b16 v[198:199], v34 offset:36864
    ds_read_b64_tr_b16 v[200:201], v34 offset:37376
    ds_read_b64_tr_b16 v[202:203], v35 offset:36864
    ds_read_b64_tr_b16 v[204:205], v35 offset:37376
    s_waitcnt lgkmcnt(0)
    s_branch C_vd1
C_sr:
    s_add_u32 s9, s9, 1
    s_cmp_gt_u32 s9, 200000
    s_cbranch_scc1 C_sk
    buffer_load_dwordx4 v[214:217], v4, s[36:39], s100 offen sc1
    s_branch C_sl
C_pr:
    s_mov_b32 s9, 0
        C_pl:
    ds_read_b32 v48, v47 offset:40
    ds_read_b128 v[78:81], v43 offset:49152
    ds_read_b128 v[82:85], v43 offset:50176
    s_add_u32 s9, s9, 1
    s_cmp_gt_u32 s9, 1600000
    s_waitcnt lgkmcnt(0)
    s_cbranch_scc1 C_pd
    v_cmp_eq_u32 vcc, 0, v48
    s_nop 0
    s_cbranch_vccnz C_pl
    s_branch C_pd
SM_sO:
    s_nop 7
    v_cvt_pk_bf16_f32 v54, v62, v63
    v_cvt_pk_bf16_f32 v55, v64, v65
    v_cvt_pk_bf16_f32 v56, v66, v67
    v_cvt_pk_bf16_f32 v57, v68, v69
    buffer_store_dwordx4 v[54:57], v4, s[36:39], s100 offen sc1
    v_cvt_pk_bf16_f32 v58, v70, v71
    v_cvt_pk_bf16_f32 v59, v72, v73
    v_cvt_pk_bf16_f32 v60, v74, v75
    v_cvt_pk_bf16_f32 v61, v76, v77
    buffer_store_dwordx4 v[58:61], v4, s[36:39], s19 offen sc1
    s_branch SM_jO
SM_sF:
    buffer_store_dwordx2 v[14:15], v6, s[36:39], s21 offen sc1
    s_branch SM_jF
K_exit:
    s_endpgm
.fill 7168, 4, 0xbf810000
.section .rodata,"a"
.p2align 6
.amdhsa_kernel concat_heads__sliding_local_dilated__spectral_fnet__prompt_kernel
  .amdhsa_next_free_vgpr 256
  .amdhsa_next_free_sgpr 102
  .amdhsa_accum_offset 256
  .amdhsa_group_segment_fixed_size 0
  .amdhsa_kernarg_size 88
  .amdhsa_user_sgpr_count 2
  .amdhsa_user_sgpr_kernarg_segment_ptr 1
  .amdhsa_system_sgpr_workgroup_id_x 1
.end_amdhsa_kernel
```

```asm
; @launch grid=(256,1,1) block=(512,1,1) lds=163840
.amdgcn_target "amdgcn-amd-amdhsa--gfx950"
.text
.p2align 12
.fill 832, 4, 0xbf810000
.globl concat_heads__sliding_local_dilated__spectral_fnet__prompt_kernel
.p2align 8
.type concat_heads__sliding_local_dilated__spectral_fnet__prompt_kernel,@function
concat_heads__sliding_local_dilated__spectral_fnet__prompt_kernel:
    s_load_dwordx2 s[16:17], s[0:1], 0
    s_load_dwordx2 s[20:21], s[0:1], 8
    s_load_dwordx2 s[28:29], s[0:1], 24
    s_load_dwordx2 s[36:37], s[0:1], 80
    s_load_dwordx2 s[24:25], s[0:1], 16
    s_load_dwordx2 s[32:33], s[0:1], 64
    v_lshrrev_b32 v1, 6, v0
    s_cmp_ge_u32 s2, 256
    s_cbranch_scc1 K_exit
    v_readfirstlane_b32 s3, v1
    s_and_b32 s4, s2, 7
    s_lshr_b32 s5, s2, 3
    s_sub_u32 s5, s5, 4
    s_and_b32 s5, s5, 31
    s_cmp_lg_u32 s3, 7
    s_cbranch_scc1 K_nopf
    s_getpc_b64 s[44:45]
    s_mov_b32 s46, 28672
    s_mov_b32 s47, 0x00020000
    s_mul_i32 s40, s5, 896
    v_and_b32 v1, 63, v0
    v_min_u32 v1, 6, v1
    v_lshlrev_b32 v1, 7, v1
    buffer_load_dword v255, v1, s[44:47], s40 offen
        K_nopf:
    s_mul_i32 s6, s5, 37
    s_lshr_b32 s6, s6, 8
    s_mul_i32 s40, s6, 7
    s_sub_u32 s7, s5, s40
    s_mov_b32 s38, 0x10000000
    s_mov_b32 s39, 0x00020000
    s_lshl_b32 s8, s4, 2
    s_cmp_lt_u32 s5, 28
    s_cbranch_scc1 K_a

    s_add_u32 s8, s8, s7
    s_mov_b32 s30, 1835008
    s_mov_b32 s31, 0x00020000
    s_lshl_b32 s40, s3, 7
    s_add_u32 s40, s40, s8
    v_and_b32 v4, 32, v0
    v_add_u32 v4, s40, v4
    v_and_b32 v5, 31, v0
    v_lshlrev_b32 v5, 4, v5
    v_mov_b32 v6, 896
    v_mad_u32_u24 v7, v4, v6, v5
    v_add_u32 v5, 384, v5
    v_sub_u32 v8, 960, v4
    v_mad_u32_u24 v8, v8, v6, v5
    v_sub_u32 v9, 2048, v4
    v_and_b32 v9, 2047, v9
    v_mad_u32_u24 v9, v9, v6, v5
    s_lshl_b32 s42, s3, 13
    s_mov_b32 m0, s42
    s_mov_b32 s52, 57344
    s_mov_b32 s53, 917504
    s_mov_b32 s54, 974848
    s_waitcnt lgkmcnt(0)

    buffer_load_dwordx4 v7, s[28:31], 0 offen nt lds
    s_add_u32 m0, m0, 1024
    s_nop 0
    buffer_load_dwordx4 v7, s[28:31], s52 offen nt lds
    s_add_u32 m0, m0, 1024
    s_nop 0
    buffer_load_dwordx4 v9, s[28:31], 0 offen nt lds
    s_add_u32 m0, m0, 1024
    s_nop 0
    buffer_load_dwordx4 v8, s[28:31], s53 offen nt lds
    s_add_u32 m0, m0, 1024
    s_load_dwordx2 s[10:11], s[36:37], 4096
    s_branch K_spare2
K_a:
    s_add_u32 s8, s8, s6
    s_cmp_ge_u32 s3, 4
    s_cbranch_scc1 K_c
    s_setprio 2
    s_mov_b32 s44, s4
    s_add_u32 s44, s44, s7
    s_mul_i32 s40, s44, 65
    s_lshr_b32 s40, s40, 8
    s_mul_i32 s40, s40, 4
    s_sub_u32 s44, s44, s40
    s_lshl_b32 s44, s44, 2
    s_lshr_b32 s44, 0x6420, s44
    s_and_b32 s44, s44, 7
    s_mov_b32 s18, 1835008
    s_mov_b32 s19, 0x00020000
    s_mov_b32 s22, 1204224
    s_mov_b32 s23, 0x00020000
    v_and_b32 v1, 63, v0
    v_lshrrev_b32 v6, 3, v1
    v_and_b32 v7, 7, v1
    v_lshrrev_b32 v8, 4, v1
    v_xor_b32 v3, v7, v8
    v_mul_u32_u24 v23, 896, v6
    v_lshl_add_u32 v21, v3, 4, v23
    v_xor_b32 v22, 64, v21
    v_add_u32 v22, 6144, v22
    s_lshl_b32 s40, s3, 5
    v_xor_b32 v23, s40, v21
    v_and_b32 v2, 2, v6
    v_xor_b32 v2, v7, v2
    v_mul_u32_u24 v3, 2688, v6
    v_lshl_add_u32 v24, v2, 4, v3
    v_xor_b32 v25, 64, v24
    v_add_u32 v25, 20480, v25
    v_add_u32 v26, 896, v24
    v_add_u32 v27, 896, v25
    v_add_u32 v28, 1792, v24
    v_add_u32 v29, 1792, v25
    s_mov_b32 s45, s44
    s_lshl_b32 s40, s8, 6
    s_lshl_b32 s41, s3, 4
    s_add_u32 s42, s40, s41
    s_mul_i32 s46, s42, 896
    s_mul_i32 s48, s41, 2688
    s_lshl_b32 s42, s7, 7
    s_add_u32 s48, s48, s42
    s_sub_u32 s40, s40, 16
    s_max_i32 s40, s40, 0
    s_lshl_b32 s41, s3, 2
    s_add_u32 s40, s40, s41
    s_mul_i32 s47, s40, 896
    s_lshl_b32 s50, s3, 11
    s_lshl_b32 s49, s3, 9

    s_lshl_b32 s40, s44, 7
    s_add_u32 s51, s40, s46
    s_add_u32 s52, s40, s47
    s_mul_i32 s53, s44, 172032
    s_add_u32 s53, s53, s48
    s_add_u32 m0, s50, 2048
    s_add_u32 s44, s44, 1
    s_cmp_eq_u32 s44, 7
    s_cselect_b32 s44, 0, s44
    s_waitcnt lgkmcnt(0)
    buffer_load_dwordx4 v21, s[16:19], s51 offen lds
    buffer_load_dwordx4 v22, s[16:19], s51 offen offset:1024 lds
    s_add_u32 m0, s49, 0
    s_mov_b32 exec_hi, 0
    buffer_load_dwordx4 v23, s[16:19], s52 offen lds
    s_mov_b32 exec_hi, -1
    s_add_u32 m0, s50, 79872
    s_nop 0
    buffer_load_dwordx4 v24, s[20:23], s53 offen lds
    buffer_load_dwordx4 v25, s[20:23], s53 offen offset:1024 lds
    s_add_u32 m0, s50, 88064
    s_nop 0
    buffer_load_dwordx4 v26, s[20:23], s53 offen lds
    buffer_load_dwordx4 v27, s[20:23], s53 offen offset:1024 lds
    s_add_u32 m0, s50, 96256
    s_mul_i32 s53, s45, 172032
    s_add_u32 s53, s53, s48
    s_add_u32 s45, s45, 1
    s_cmp_eq_u32 s45, 7
    s_cselect_b32 s45, 0, s45
    buffer_load_dwordx4 v28, s[20:23], s53 offen lds
    buffer_load_dwordx4 v29, s[20:23], s53 offen offset:1024 lds
    s_lshl_b32 s40, s44, 7
    s_add_u32 s51, s40, s46
    s_add_u32 s52, s40, s47
    s_mul_i32 s53, s44, 172032
    s_add_u32 s53, s53, s48
    s_add_u32 m0, s50, 12288
    s_add_u32 s44, s44, 1
    s_cmp_eq_u32 s44, 7
    s_cselect_b32 s44, 0, s44
    buffer_load_dwordx4 v21, s[16:19], s51 offen lds
    buffer_load_dwordx4 v22, s[16:19], s51 offen offset:1024 lds
    s_lshl_b32 s56, s8, 7
    s_load_dwordx2 s[10:11], s[36:37], s56
    s_lshl_b32 s30, s8, 10
    s_add_u32 s30, s30, 65536
    s_getreg_b32 s28, hwreg(HW_REG_XCC_ID, 0, 3)
    v_min_u32 v20, 6, v1
    v_lshlrev_b32 v20, 3, v20
    s_mov_b32 s26, 401408
    s_mov_b32 s27, 0x00020000
    s_mov_b32 s34, 3670016
    s_mov_b32 s35, 0x00020000
    s_lshr_b32 s58, s3, 1
    s_and_b32 s59, s3, 1
    v_and_b32 v9, 15, v1
    v_mov_b32 v4, 0
    v_mov_b32 v14, 1
    v_mov_b32 v5, 161792
    v_and_b32 v50, 6, v6
    v_xor_b32 v50, v7, v50
    v_mul_u32_u24 v51, 896, v6
    v_lshl_add_u32 v10, v50, 4, v51
    v_add_u32 v11, 6144, v10
    s_mov_b32 s54, s6
    s_mul_i32 s55, s3, 14336
    s_lshl_b32 s56, s7, 7
    s_add_u32 s55, s55, s56
    s_and_b32 s56, s3, 1
    s_lshl_b32 s57, s7, 1
    s_add_u32 s56, s56, s57
    s_lshl_b32 s15, s56, 10
    s_lshl_b32 s56, s8, 2
    s_and_b32 s57, s3, 2
    s_add_u32 s56, s56, s57
    s_mul_i32 s57, s56, 14336
    s_add_u32 s15, s15, s57
    s_add_u32 s15, s15, 2097152
    s_lshl_b32 s100, s56, 6
    s_add_u32 s100, s100, 16384
    v_lshlrev_b32 v50, 7, v7
    v_and_b32 v51, 1, v6
    v_mul_u32_u24 v51, 14336, v51
    v_add3_u32 v12, v50, v51, s15
    v_mov_b32 v50, s100
    v_cmp_le_u32 vcc, 16, v1
    s_nop 1
    v_cndmask_b32 v12, v12, v50, vcc
    v_and_b32 v50, 1, v9
    v_cmp_eq_u32 s[42:43], 1, v50
    v_lshl_add_u32 v50, v8, 2, v50
    v_cmp_le_u32 s[0:1], v50, v9
    v_add_u32 v50, 2, v50
    v_cmp_le_u32 s[12:13], v50, v9
    v_mov_b32 v50, 0xffff
    v_mov_b32 v51, 0xffff0000
    v_cndmask_b32 v50, v50, v51, s[42:43]
    v_cndmask_b32 v52, v50, 0, s[0:1]
    v_cndmask_b32 v53, v50, 0, s[12:13]
    v_cndmask_b32 v54, 0, v50, s[0:1]
    v_cndmask_b32 v55, 0, v50, s[12:13]
    v_lshlrev_b32 v50, 4, v1
    s_add_u32 s56, s50, 4096
    v_add_u32 v56, s56, v50
    s_xor_b32 s56, s50, 2048
    s_add_u32 s56, s56, 4096
    v_add_u32 v57, s56, v50
    v_add_u32 v59, s50, v50
    v_lshl_add_u32 v58, s58, 3, v5
    v_lshl_add_u32 v60, s3, 2, v5
    s_cmp_eq_u32 s7, 3
    s_cselect_b32 s56, 0, 1.0
    v_mov_b32 v61, s56
    s_mov_b32 s31, 0x3e8b97f6
K_h2:
    s_add_u32 m0, s49, 10240
    s_mov_b32 exec_hi, 0
    buffer_load_dwordx4 v23, s[16:19], s52 offen lds
    s_mov_b32 exec_hi, -1
    s_add_u32 m0, s50, 104448
    s_nop 0
    buffer_load_dwordx4 v24, s[20:23], s53 offen lds
    buffer_load_dwordx4 v25, s[20:23], s53 offen offset:1024 lds
    s_add_u32 m0, s50, 112640
    s_nop 0
    buffer_load_dwordx4 v26, s[20:23], s53 offen lds
    buffer_load_dwordx4 v27, s[20:23], s53 offen offset:1024 lds
    s_add_u32 m0, s50, 120832
    s_mul_i32 s53, s45, 172032
    s_add_u32 s53, s53, s48
    s_add_u32 s45, s45, 1
    s_cmp_eq_u32 s45, 7
    s_cselect_b32 s45, 0, s45
    buffer_load_dwordx4 v28, s[20:23], s53 offen lds
    buffer_load_dwordx4 v29, s[20:23], s53 offen offset:1024 lds
    s_lshl_b32 s40, s44, 7
    s_add_u32 s51, s40, s46
    s_add_u32 s52, s40, s47
    s_mul_i32 s53, s44, 172032
    s_add_u32 s53, s53, s48
    s_add_u32 m0, s50, 22528
    s_add_u32 s44, s44, 1
    s_cmp_eq_u32 s44, 7
    s_cselect_b32 s44, 0, s44
    buffer_load_dwordx4 v21, s[16:19], s51 offen lds
    s_waitcnt lgkmcnt(0)
    s_add_u32 s12, s10, 0x5a3c9671
    s_xor_b32 s13, s11, 0x2b7e1516
    s_add_u32 s28, s28, s12
    s_mov_b32 s29, s13
    s_waitcnt vmcnt(10)
    s_barrier
    buffer_load_dwordx4 v22, s[16:19], s51 offen offset:1024 lds
    s_add_u32 m0, s49, 20480
    s_mov_b32 exec_hi, 0
    buffer_load_dwordx4 v23, s[16:19], s52 offen lds
    s_mov_b32 exec_hi, -1
    s_add_u32 m0, s50, 129024
    s_nop 0
    buffer_load_dwordx4 v24, s[20:23], s53 offen lds
    buffer_load_dwordx4 v25, s[20:23], s53 offen offset:1024 lds
    s_add_u32 m0, s50, 137216
    s_nop 0
    buffer_load_dwordx4 v26, s[20:23], s53 offen lds
    buffer_load_dwordx4 v27, s[20:23], s53 offen offset:1024 lds
    s_add_u32 m0, s50, 145408
    s_mul_i32 s53, s45, 172032
    s_add_u32 s53, s53, s48
    s_add_u32 s45, s45, 1
    s_cmp_eq_u32 s45, 7
    s_cselect_b32 s45, 0, s45
    buffer_load_dwordx4 v28, s[20:23], s53 offen lds
    buffer_load_dwordx4 v29, s[20:23], s53 offen offset:1024 lds
    s_lshl_b32 s40, s44, 7
    s_add_u32 s51, s40, s46
    s_add_u32 s52, s40, s47
    s_mul_i32 s53, s44, 172032
    s_add_u32 s53, s53, s48
    s_add_u32 m0, s50, 32768
    s_add_u32 s44, s44, 1
    s_cmp_eq_u32 s44, 7
    s_cselect_b32 s44, 0, s44
    buffer_load_dwordx4 v21, s[16:19], s51 offen lds
    buffer_load_dwordx4 v22, s[16:19], s51 offen offset:1024 lds
    s_add_u32 m0, s49, 30720
    s_mov_b32 exec_hi, 0
    buffer_load_dwordx4 v23, s[16:19], s52 offen lds
    s_mov_b32 exec_hi, -1
    s_waitcnt vmcnt(12)
    s_barrier
    s_add_u32 m0, s50, 153600
    s_nop 0
    buffer_load_dwordx4 v24, s[20:23], s53 offen lds
    buffer_load_dwordx4 v25, s[20:23], s53 offen offset:1024 lds
    s_add_u32 m0, s50, 71680
    s_nop 0
    buffer_load_dwordx4 v26, s[20:23], s53 offen lds
    buffer_load_dwordx4 v27, s[20:23], s53 offen offset:1024 lds
    s_add_u32 m0, s50, 79872
    s_mul_i32 s53, s45, 172032
    s_add_u32 s53, s53, s48
    s_add_u32 s45, s45, 1
    s_cmp_eq_u32 s45, 7
    s_cselect_b32 s45, 0, s45
    buffer_load_dwordx4 v28, s[20:23], s53 offen lds
    buffer_load_dwordx4 v29, s[20:23], s53 offen offset:1024 lds
    s_lshl_b32 s40, s44, 7
    s_add_u32 s51, s40, s46
    s_add_u32 s52, s40, s47
    s_mul_i32 s53, s44, 172032
    s_add_u32 s53, s53, s48
    s_add_u32 m0, s50, 43008
    s_add_u32 s44, s44, 1
    s_cmp_eq_u32 s44, 7
    s_cselect_b32 s44, 0, s44
    buffer_load_dwordx4 v21, s[16:19], s51 offen lds
    buffer_load_dwordx4 v22, s[16:19], s51 offen offset:1024 lds
    s_add_u32 m0, s49, 40960
    s_mov_b32 exec_hi, 0
    buffer_load_dwordx4 v23, s[16:19], s52 offen lds
    s_mov_b32 exec_hi, -1
    s_waitcnt vmcnt(12)
    s_barrier
    s_add_u32 m0, s50, 88064
    s_nop 0
    buffer_load_dwordx4 v24, s[20:23], s53 offen lds
    buffer_load_dwordx4 v25, s[20:23], s53 offen offset:1024 lds
    s_add_u32 m0, s50, 96256
    s_nop 0
    buffer_load_dwordx4 v26, s[20:23], s53 offen lds
    buffer_load_dwordx4 v27, s[20:23], s53 offen offset:1024 lds
    s_add_u32 m0, s50, 104448
    s_mul_i32 s53, s45, 172032
    s_add_u32 s53, s53, s48
    s_add_u32 s45, s45, 1
    s_cmp_eq_u32 s45, 7
    s_cselect_b32 s45, 0, s45
    buffer_load_dwordx4 v28, s[20:23], s53 offen lds
    buffer_load_dwordx4 v29, s[20:23], s53 offen offset:1024 lds
    s_lshl_b32 s40, s44, 7
    s_add_u32 s51, s40, s46
    s_add_u32 s52, s40, s47
    s_mul_i32 s53, s44, 172032
    s_add_u32 s53, s53, s48
    s_add_u32 m0, s50, 53248
    s_add_u32 s44, s44, 1
    s_cmp_eq_u32 s44, 7
    s_cselect_b32 s44, 0, s44
    buffer_load_dwordx4 v21, s[16:19], s51 offen lds
    buffer_load_dwordx4 v22, s[16:19], s51 offen offset:1024 lds
    s_add_u32 m0, s49, 51200
    s_mov_b32 exec_hi, 0
    buffer_load_dwordx4 v23, s[16:19], s52 offen lds
    s_mov_b32 exec_hi, -1
    s_waitcnt vmcnt(12)
    s_barrier
    s_add_u32 m0, s50, 112640
    s_nop 0
    buffer_load_dwordx4 v24, s[20:23], s53 offen lds
    buffer_load_dwordx4 v25, s[20:23], s53 offen offset:1024 lds
    s_add_u32 m0, s50, 120832
    s_nop 0
    buffer_load_dwordx4 v26, s[20:23], s53 offen lds
    buffer_load_dwordx4 v27, s[20:23], s53 offen offset:1024 lds
    buffer_load_dwordx2 v[18:19], v20, s[36:39], s30 offen sc1
    s_lshl_b32 s40, s44, 7
    s_add_u32 s51, s40, s46
    s_add_u32 s52, s40, s47
    s_mul_i32 s53, s44, 172032
    s_add_u32 s53, s53, s48
    s_add_u32 m0, s50, 63488
    s_add_u32 s44, s44, 1
    s_cmp_eq_u32 s44, 7
    s_cselect_b32 s44, 0, s44
    buffer_load_dwordx4 v21, s[16:19], s51 offen lds
    buffer_load_dwordx4 v22, s[16:19], s51 offen offset:1024 lds
    s_add_u32 m0, s49, 61440
    s_mov_b32 exec_hi, 0
    buffer_load_dwordx4 v23, s[16:19], s52 offen lds
    s_mov_b32 exec_hi, -1
    s_add_u32 m0, s50, 129024
    s_nop 0
    buffer_load_dwordx4 v24, s[20:23], s53 offen lds
    s_waitcnt vmcnt(12)
    s_barrier
    buffer_load_dwordx4 v25, s[20:23], s53 offen offset:1024 lds
    s_add_u32 m0, s50, 137216
    s_nop 0
    buffer_load_dwordx4 v26, s[20:23], s53 offen lds
    buffer_load_dwordx4 v27, s[20:23], s53 offen offset:1024 lds
    s_add_u32 m0, s50, 145408
    s_mul_i32 s53, s45, 172032
    s_add_u32 s53, s53, s48
    s_add_u32 s45, s45, 1
    s_cmp_eq_u32 s45, 7
    s_cselect_b32 s45, 0, s45
    buffer_load_dwordx4 v28, s[20:23], s53 offen lds
    buffer_load_dwordx4 v29, s[20:23], s53 offen offset:1024 lds
    s_add_u32 m0, s50, 153600
    s_mul_i32 s53, s45, 172032
    s_add_u32 s53, s53, s48
    s_add_u32 s45, s45, 1
    s_cmp_eq_u32 s45, 7
    s_cselect_b32 s45, 0, s45
    buffer_load_dwordx4 v28, s[20:23], s53 offen lds
    s_waitcnt vmcnt(11)
    s_barrier
    buffer_load_dwordx4 v29, s[20:23], s53 offen offset:1024 lds
    s_lshl_b32 s40, s54, 13
    s_add_u32 s40, s40, s50
    s_add_u32 m0, s40, 71680
    s_mul_i32 s40, s54, 57344
    s_add_u32 s40, s40, s55
    s_add_u32 s54, s54, 1
    s_cmp_eq_u32 s54, 5
    s_cselect_b32 s54, 0, s54
    buffer_load_dwordx4 v10, s[24:27], s40 offen lds
    buffer_load_dwordx4 v11, s[24:27], s40 offen offset:1024 lds
    s_lshl_b32 s40, s54, 13
    s_add_u32 s40, s40, s50
    s_add_u32 m0, s40, 71680
    s_mul_i32 s40, s54, 57344
    s_add_u32 s40, s40, s55
    s_add_u32 s54, s54, 1
    s_cmp_eq_u32 s54, 5
    s_cselect_b32 s54, 0, s54
    buffer_load_dwordx4 v10, s[24:27], s40 offen lds
    buffer_load_dwordx4 v11, s[24:27], s40 offen offset:1024 lds
    s_waitcnt lgkmcnt(0)
    s_waitcnt vmcnt(8)
    s_barrier
    s_mov_b32 s101, 1

    v_cmp_ne_u32 vcc, s28, v18
    v_cmp_ne_u32 s[42:43], s29, v19
    s_nop 0
    s_or_b64 vcc, vcc, s[42:43]
    s_cbranch_vccnz X_cH
        X_okH:

    v_add_u32 v2, s101, v14
    ds_write_b32 v5, v2 offset:4
    s_setprio 0
    s_lshl_b32 s40, s54, 13
    s_add_u32 s40, s40, s50
    s_add_u32 m0, s40, 71680
    s_mul_i32 s40, s54, 57344
    s_add_u32 s40, s40, s55
    s_add_u32 s54, s54, 1
    s_cmp_eq_u32 s54, 5
    s_cselect_b32 s54, 0, s54
    buffer_load_dwordx4 v10, s[24:27], s40 offen lds
    buffer_load_dwordx4 v11, s[24:27], s40 offen offset:1024 lds
    buffer_load_dword v13, v12, s[36:39], 0 offen sc1
    s_lshl_b32 s40, s54, 13
    s_add_u32 s40, s40, s50
    s_add_u32 m0, s40, 71680
    s_mul_i32 s40, s54, 57344
    s_add_u32 s40, s40, s55
    s_add_u32 s54, s54, 1
    s_cmp_eq_u32 s54, 5
    s_cselect_b32 s54, 0, s54
    buffer_load_dwordx4 v10, s[24:27], s40 offen lds
    buffer_load_dwordx4 v11, s[24:27], s40 offen offset:1024 lds
    s_lshl_b32 s40, s54, 13
    s_add_u32 s40, s40, s50
    s_add_u32 m0, s40, 71680
    s_mul_i32 s40, s54, 57344
    s_add_u32 s40, s40, s55
    s_add_u32 s54, s54, 1
    s_cmp_eq_u32 s54, 5
    s_cselect_b32 s54, 0, s54
    buffer_load_dwordx4 v10, s[24:27], s40 offen lds
    buffer_load_dwordx4 v11, s[24:27], s40 offen offset:1024 lds
    s_waitcnt vmcnt(11)
    s_mov_b64 exec, 1
    ds_add_u32 v5, v14 offset:32
    s_mov_b64 exec, -1
    s_mov_b32 s9, 0
    s_setprio 0
        H_il:
    ds_read_b64 v[62:63], v58 offset:16
    ds_read_b128 v[30:33], v56
    ds_read_b128 v[34:37], v57
    s_add_u32 s9, s9, 1
    s_cmp_gt_u32 s9, 1600000
    s_cbranch_scc1 H_id
    s_waitcnt lgkmcnt(2)
    v_and_b32 v62, v62, v63
    v_cmp_eq_u32 vcc, 0, v62
    s_waitcnt lgkmcnt(0)
    s_cbranch_vccnz H_il
        H_id:
    s_waitcnt lgkmcnt(0)

    v_fma_f32 v30, v34, v61, v30
    v_fma_f32 v31, v35, v61, v31
    v_fma_f32 v32, v36, v61, v32
    v_fma_f32 v33, v37, v61, v33
    v_max_f32 v62, v30, v31
    v_max_f32 v63, v32, v33
    v_mov_b32 v64, v62
    v_mov_b32 v65, v63
    s_nop 0
    v_permlane16_swap_b32 v62, v64
    v_permlane16_swap_b32 v63, v65
    v_max_f32 v62, v62, v64
    v_max_f32 v63, v63, v65
    v_mov_b32 v64, v62
    v_mov_b32 v65, v63
    s_nop 0
    v_permlane32_swap_b32 v62, v64
    v_permlane32_swap_b32 v63, v65
    v_max_f32 v62, v62, v64
    v_max_f32 v63, v63, v65
    v_mul_f32 v62, s31, v62
    v_mul_f32 v63, s31, v63
    v_fma_f32 v30, v30, s31, -v62
    v_fma_f32 v31, v31, s31, -v62
    v_fma_f32 v32, v32, s31, -v63
    v_fma_f32 v33, v33, s31, -v63
    v_exp_f32 v30, v30
    v_exp_f32 v31, v31
    v_exp_f32 v32, v32
    v_exp_f32 v33, v33
    v_add_f32 v62, v30, v31
    v_add_f32 v63, v32, v33
    v_mov_b32 v64, v62
    v_mov_b32 v65, v63
    s_nop 0
    v_permlane16_swap_b32 v62, v64
    v_permlane16_swap_b32 v63, v65
    v_add_f32 v62, v62, v64
    v_add_f32 v63, v63, v65
    v_mov_b32 v64, v62
    v_mov_b32 v65, v63
    s_nop 0
    v_permlane32_swap_b32 v62, v64
    v_permlane32_swap_b32 v63, v65
    v_add_f32 v62, v62, v64
    v_add_f32 v63, v63, v65
    v_rcp_f32 v62, v62
    v_rcp_f32 v63, v63
    v_mul_f32 v30, v30, v62
    v_mul_f32 v31, v31, v62
    v_mul_f32 v32, v32, v63
    v_mul_f32 v33, v33, v63
    v_cvt_pk_bf16_f32 v30, v30, v30
    v_cvt_pk_bf16_f32 v31, v31, v31
    v_cvt_pk_bf16_f32 v32, v32, v32
    v_cvt_pk_bf16_f32 v33, v33, v33
    v_and_b32 v38, v52, v30
    v_and_b32 v39, v53, v31
    v_and_b32 v40, v54, v30
    v_and_b32 v41, v55, v31
    ds_write_b128 v59, v[38:41] offset:12288
    v_and_b32 v42, v52, v32
    v_and_b32 v43, v53, v33
    v_and_b32 v44, v54, v32
    v_and_b32 v45, v55, v33
    ds_write_b128 v59, v[42:45] offset:13312
    ds_write_b32 v60, v5 offset:40
    s_setprio 0
    s_waitcnt vmcnt(0)
    s_mov_b64 exec, 1
    ds_add_u32 v5, v14 offset:12
    s_mov_b64 exec, -1
    s_mov_b32 s9, 0
        W_lR:
    ds_read_b32 v2, v5 offset:80
    s_add_u32 s9, s9, 1
    s_cmp_gt_u32 s9, 1600000
    s_cbranch_scc1 W_dR
    s_waitcnt lgkmcnt(0)
    v_cmp_gt_u32 vcc, 4, v2
    s_nop 0
    s_cbranch_vccnz W_lR
        W_dR:

    s_add_u32 m0, s50, 112640
    s_add_u32 s40, s55, 286720
    buffer_load_dwordx4 v10, s[24:27], s40 offen lds
    buffer_load_dwordx4 v11, s[24:27], s40 offen offset:1024 lds
    s_add_u32 m0, s50, 120832
    s_add_u32 s40, s55, 344064
    buffer_load_dwordx4 v10, s[24:27], s40 offen lds
    buffer_load_dwordx4 v11, s[24:27], s40 offen offset:1024 lds
    s_waitcnt vmcnt(0)
    s_mov_b64 exec, 1
    ds_add_u32 v5, v14 offset:36
    s_endpgm
K_spare2:
    buffer_load_dwordx4 v7, s[28:31], s53 offen nt lds
    s_add_u32 m0, m0, 1024
    s_mov_b32 s26, 401408
    s_mov_b32 s27, 0x00020000
    s_mov_b32 s34, 3670016
    s_mov_b32 s35, 0x00020000
    v_and_b32 v6, 15, v0
    v_lshlrev_b32 v6, 4, v6
    v_bfe_u32 v4, v0, 4, 2
    v_lshl_add_u32 v4, v4, 9, s42
    v_add_u32 v10, v4, v6
    v_sub_u32 v11, v4, v6
    v_add_u32 v11, 432, v11
    v_mov_b32 v12, 0
    s_and_b32 s55, s3, 3
    s_lshr_b32 s56, s3, 2
    v_and_b32 v1, 63, v0
    v_lshrrev_b32 v2, 4, v1
    v_and_b32 v3, 15, v1
    s_lshl_b32 s61, s55, 3
    v_lshrrev_b32 v4, 1, v3
    v_add_u32 v4, s61, v4
    v_and_b32 v5, 1, v3
    v_cvt_f32_u32 v79, v5
    v_mul_f32 v79, 0x3e800000, v79
    v_lshl_add_u32 v5, v4, 1, v5
    v_cmp_eq_u32 vcc, 1, v5
    s_nop 1
    v_cndmask_b32 v4, v4, 32, vcc
    v_cndmask_b32 v79, v79, 0, vcc
    v_cvt_f32_u32 v78, v4
    v_mul_f32 v78, 0x3c800000, v78
    v_lshlrev_b32 v4, 3, v2
    v_cvt_f32_u32 v4, v4
    v_fma_f32 v79, v78, v4, v79
    v_cos_f32 v100, v78
    s_nop 0
    v_add_f32 v100, v100, v100
    v_fmamk_f32 v84, v78, 0x0, v79
    v_fmamk_f32 v85, v78, 0x3f800000, v79
    v_fmamk_f32 v92, v78, 0x42000000, v79
    v_fmamk_f32 v93, v78, 0x42040000, v79
    v_cos_f32 v84, v84
    v_cos_f32 v85, v85
    v_cos_f32 v92, v92
    v_cos_f32 v93, v93
    v_fma_f32 v86, v100, v85, -v84
    v_fma_f32 v94, v100, v93, -v92
    v_fma_f32 v87, v100, v86, -v85
    v_fma_f32 v95, v100, v94, -v93
    v_fma_f32 v88, v100, v87, -v86
    v_fma_f32 v96, v100, v95, -v94
    v_fma_f32 v89, v100, v88, -v87
    v_fma_f32 v97, v100, v96, -v95
    v_fma_f32 v90, v100, v89, -v88
    v_fma_f32 v98, v100, v97, -v96
    v_fma_f32 v91, v100, v90, -v89
    v_fma_f32 v99, v100, v98, -v97
    v_cvt_pk_bf16_f32 v20, v84, v85
    v_cvt_pk_bf16_f32 v21, v86, v87
    v_cvt_pk_bf16_f32 v22, v88, v89
    v_cvt_pk_bf16_f32 v23, v90, v91
    v_cvt_pk_bf16_f32 v24, v92, v93
    v_cvt_pk_bf16_f32 v25, v94, v95
    v_cvt_pk_bf16_f32 v26, v96, v97
    v_cvt_pk_bf16_f32 v27, v98, v99
    v_lshrrev_b32 v4, 4, v0
    v_and_b32 v5, 3, v4
    v_lshlrev_b32 v5, 6, v5
    v_lshlrev_b32 v13, 1, v6
    v_xor_b32 v13, v13, v5
    v_bfe_u32 v5, v4, 3, 1
    v_lshl_add_u32 v13, v5, 4, v13
    v_lshl_add_u32 v13, v4, 9, v13
    v_add_u32 v13, 65536, v13
    v_xor_b32 v14, 16, v13
    v_lshrrev_b32 v4, 2, v3
    v_lshl_add_u32 v5, v2, 3, v4
    v_lshlrev_b32 v5, 9, v5
    v_lshl_add_u32 v5, v4, 6, v5
    v_and_b32 v4, 1, v1
    v_lshl_add_u32 v5, v4, 5, v5
    v_bfe_u32 v4, v1, 1, 1
    v_lshl_add_u32 v5, v4, 3, v5
    v_and_b32 v4, 1, v2
    v_xor_b32 v4, s56, v4
    v_lshl_add_u32 v16, v4, 4, v5
    v_add_u32 v16, 65536, v16
    v_xor_b32 v17, 64, v16
    v_xor_b32 v18, 128, v16
    v_xor_b32 v19, 192, v16
    v_lshlrev_b32 v15, 16, v2
    v_lshrrev_b32 v4, 3, v3
    v_lshl_add_u32 v15, v4, 13, v15
    v_and_b32 v4, 7, v3
    v_lshl_add_u32 v15, v4, 4, v15
    v_lshlrev_b32 v68, 16, v4
    v_mov_b32 v5, 0xffff0000
    v_add_u32 v69, s56, v3
    v_cmp_eq_u32 vcc, 0, v69
    s_nop 1
    v_cndmask_b32 v69, v5, 0, vcc
    v_add_u32 v4, 256, v11
    v_cmp_eq_u32 vcc, 15, v3
    s_nop 1
    v_cndmask_b32 v11, v11, v4, vcc
    s_lshl_b32 s50, s8, 3
    s_add_u32 s50, s50, s3
    s_mul_i32 s50, s50, 1568
    s_and_b32 s50, s50, 0xffffff80
    buffer_load_dwordx4 v7, s[28:31], s54 offen nt lds
    s_add_u32 m0, m0, 1024
    v_min_u32 v77, 12, v1
    v_lshlrev_b32 v77, 7, v77
    s_lshl_b32 s59, s55, 18
    s_lshl_b32 s61, s56, 14
    s_add_u32 s59, s59, s61
    s_lshl_b32 s61, s8, 7
    s_add_u32 s59, s59, s61
    s_add_u32 s59, s59, 1048576
    s_mov_b32 s57, s56
    s_add_u32 s63, s8, 1024
    s_cmp_eq_u32 s8, 0
    s_cselect_b32 s63, 32, s63
    s_cmp_eq_u32 s57, 0
    s_cselect_b32 s58, s8, s63
    v_lshl_add_u32 v4, v3, 6, s58
    v_cvt_f32_u32 v78, v4
    v_mul_f32 v78, 0x3a000000, v78
    v_lshlrev_b32 v4, 3, v2
    v_cvt_f32_u32 v4, v4
    v_mul_f32 v79, v78, v4
    v_cos_f32 v100, v78
    s_nop 0
    v_add_f32 v100, v100, v100
    v_fmamk_f32 v84, v78, 0x0, v79
    v_fmamk_f32 v85, v78, 0x3f800000, v79
    v_fmamk_f32 v92, v78, 0x0, v79
    v_fmamk_f32 v93, v78, 0x3f800000, v79
    v_cos_f32 v84, v84
    v_cos_f32 v85, v85
    v_sin_f32 v92, v92
    v_sin_f32 v93, v93
    v_fma_f32 v86, v100, v85, -v84
    v_fma_f32 v94, v100, v93, -v92
    v_fma_f32 v87, v100, v86, -v85
    v_fma_f32 v95, v100, v94, -v93
    v_fma_f32 v88, v100, v87, -v86
    v_fma_f32 v96, v100, v95, -v94
    v_fma_f32 v89, v100, v88, -v87
    v_fma_f32 v97, v100, v96, -v95
    v_fma_f32 v90, v100, v89, -v88
    v_fma_f32 v98, v100, v97, -v96
    v_fma_f32 v91, v100, v90, -v89
    v_fma_f32 v99, v100, v98, -v97
    v_cvt_pk_bf16_f32 v28, v84, v85
    buffer_load_dwordx4 v8, s[28:31], s52 offen nt lds
    s_add_u32 m0, m0, 1024
    v_cvt_pk_bf16_f32 v32, v92, v93
    v_mov_b32 v40, v28
    v_xor_b32 v36, 0x80008000, v32
    v_cvt_pk_bf16_f32 v29, v86, v87
    v_cvt_pk_bf16_f32 v33, v94, v95
    v_mov_b32 v41, v29
    v_xor_b32 v37, 0x80008000, v33
    v_cvt_pk_bf16_f32 v30, v88, v89
    v_cvt_pk_bf16_f32 v34, v96, v97
    v_mov_b32 v42, v30
    v_xor_b32 v38, 0x80008000, v34
    v_cvt_pk_bf16_f32 v31, v90, v91
    v_cvt_pk_bf16_f32 v35, v98, v99
    v_mov_b32 v43, v31
    v_xor_b32 v39, 0x80008000, v35
    s_cmp_eq_u32 s8, 0
    s_cbranch_scc1 S_cls0
S_reg:
    v_lshlrev_b32 v47, 4, v1
    v_and_b32 v4, 16, v1
    v_lshlrev_b32 v4, 1, v4
    v_xor_b32 v44, v47, v4
    v_xor_b32 v45, 64, v44
    v_bfe_u32 v70, v44, 4, 3
    v_xor_b32 v71, 4, v70
    s_lshr_b32 s61, s3, 1
    v_mov_b32 v5, 0xffff0000
    v_add_u32 v4, s61, v70
    v_cmp_eq_u32 s[42:43], 0, v4
    s_nop 1
    v_cndmask_b32 v72, v5, 0, s[42:43]
    v_add_u32 v4, s61, v71
    v_cmp_eq_u32 s[42:43], 0, v4
    s_nop 1
    v_cndmask_b32 v73, v5, 0, s[42:43]
    v_lshlrev_b32 v70, 16, v70
    v_lshlrev_b32 v71, 16, v71
    s_lshl_b32 s60, s8, 3
    s_add_u32 s60, s60, s3
    s_lshl_b32 s60, s60, 12
    s_add_u32 s60, s60, 1048576
    v_lshrrev_b32 v4, 2, v3
    v_lshl_add_u32 v4, v2, 3, v4
    v_lshlrev_b32 v4, 7, v4
    v_and_b32 v5, 3, v1
    v_lshl_add_u32 v4, v5, 3, v4
    buffer_load_dwordx4 v8, s[28:31], 0 offen nt lds
    s_add_u32 m0, m0, 1024
    v_bfe_u32 v5, v1, 3, 2
    v_lshl_add_u32 v4, v5, 5, v4
    s_lshl_b32 s61, s55, 13
    s_add_u32 s61, s61, 0
    v_add_u32 v46, s61, v4
    v_mov_b32 v52, 81920
    v_lshl_add_u32 v52, s56, 2, v52
    v_mov_b32 v59, 1
    s_lshl_b32 s61, s56, 11
    v_add_u32 v53, s61, v47
    s_waitcnt lgkmcnt(0)
    s_add_u32 s12, s10, 0x5a3c9671
    s_xor_b32 s13, s11, 0x2b7e1516
    s_lshl_b32 s51, s12, 12
    s_xor_b32 s51, s51, s13
    s_and_b32 s51, s51, 0xbfff0000
    v_xor_b32 v68, s51, v68

    s_waitcnt vmcnt(4)
    ds_read_b128 v[102:105], v10 offset:0
    ds_read_b128 v[106:109], v11 offset:2112
    ds_read_b128 v[114:117], v10 offset:2112
    ds_read_b128 v[110:113], v11 offset:0
    s_waitcnt lgkmcnt(2)
    v_mov_b32 v118, v102
    v_lshlrev_b32 v122, 16, v103
    v_lshlrev_b32 v136, 16, v109
    v_and_b32 v123, 0xffff0000, v103
    v_and_b32 v137, 0xffff0000, v108
    v_pk_add_f32 v[122:123], v[122:123], v[136:137]
    v_mov_b32_dpp v118, v106 row_shr:1 row_mask:0xf bank_mask:0xf
    v_lshlrev_b32 v124, 16, v104
    v_lshlrev_b32 v136, 16, v108
    v_and_b32 v125, 0xffff0000, v104
    v_and_b32 v137, 0xffff0000, v107
    v_pk_add_f32 v[124:125], v[124:125], v[136:137]
    v_lshlrev_b32 v126, 16, v105
    v_lshlrev_b32 v136, 16, v107
    v_and_b32 v127, 0xffff0000, v105
    v_and_b32 v137, 0xffff0000, v106
    v_pk_add_f32 v[126:127], v[126:127], v[136:137]
    v_lshlrev_b32 v120, 16, v102
    v_lshlrev_b32 v136, 16, v118
    v_and_b32 v121, 0xffff0000, v102
    v_and_b32 v137, 0xffff0000, v109
    v_pk_add_f32 v[120:121], v[120:121], v[136:137]
    s_waitcnt lgkmcnt(0)
    v_lshlrev_b32 v130, 16, v115
    v_lshlrev_b32 v136, 16, v113
    v_and_b32 v131, 0xffff0000, v115
    v_and_b32 v137, 0xffff0000, v112
    v_pk_add_f32 v[130:131], v[130:131], v[136:137]
    v_mov_b32_dpp v119, v110 row_ror:1 row_mask:0xf bank_mask:0xf
    v_lshlrev_b32 v132, 16, v116
    v_lshlrev_b32 v136, 16, v112
    v_and_b32 v133, 0xffff0000, v116
    v_and_b32 v137, 0xffff0000, v111
    v_pk_add_f32 v[132:133], v[132:133], v[136:137]
    v_lshlrev_b32 v134, 16, v117
    v_lshlrev_b32 v136, 16, v111
    v_and_b32 v135, 0xffff0000, v117
    v_and_b32 v137, 0xffff0000, v110
    v_pk_add_f32 v[134:135], v[134:135], v[136:137]
    v_lshlrev_b32 v128, 16, v114
    v_lshlrev_b32 v136, 16, v119
    v_and_b32 v129, 0xffff0000, v114
    v_and_b32 v137, 0xffff0000, v113
    v_pk_add_f32 v[128:129], v[128:129], v[136:137]
    v_pk_add_f32 v[146:147], v[120:121], v[128:129]
    v_pk_add_f32 v[148:149], v[122:123], v[130:131]
    v_pk_add_f32 v[150:151], v[124:125], v[132:133]
    v_pk_add_f32 v[152:153], v[126:127], v[134:135]
    v_cvt_pk_bf16_f32 v138, v146, v148
    v_cvt_pk_bf16_f32 v139, v150, v152
    v_cvt_pk_bf16_f32 v140, v147, v149
    v_cvt_pk_bf16_f32 v141, v151, v153
    ds_write_b128 v13, v[138:141] offset:0
    v_pk_add_f32 v[146:147], v[120:121], v[128:129] neg_lo:[0,1] neg_hi:[0,1]
    v_pk_add_f32 v[148:149], v[122:123], v[130:131] neg_lo:[0,1] neg_hi:[0,1]
    v_pk_add_f32 v[150:151], v[124:125], v[132:133] neg_lo:[0,1] neg_hi:[0,1]
    v_pk_add_f32 v[152:153], v[126:127], v[134:135] neg_lo:[0,1] neg_hi:[0,1]
    v_cvt_pk_bf16_f32 v142, v146, v148
    v_cvt_pk_bf16_f32 v143, v150, v152
    v_cvt_pk_bf16_f32 v144, v147, v149
    v_cvt_pk_bf16_f32 v145, v151, v153
    ds_write_b128 v14, v[142:145] offset:0
    s_waitcnt lgkmcnt(0)
    s_barrier
    ds_read_b64_tr_b16 v[154:155], v16 offset:0
    ds_read_b64_tr_b16 v[156:157], v16 offset:2048
    ds_read_b64_tr_b16 v[158:159], v17 offset:0
    ds_read_b64_tr_b16 v[160:161], v17 offset:2048
    ds_read_b64_tr_b16 v[162:163], v18 offset:0
    ds_read_b64_tr_b16 v[164:165], v18 offset:2048
    ds_read_b64_tr_b16 v[166:167], v19 offset:0
    ds_read_b64_tr_b16 v[168:169], v19 offset:2048
    s_waitcnt lgkmcnt(6)
    v_mfma_f32_16x16x32_bf16 v[170:173], v[20:23], v[154:157], 0
    ds_read_b64_tr_b16 v[154:155], v16 offset:256
    ds_read_b64_tr_b16 v[156:157], v16 offset:2304
    s_waitcnt lgkmcnt(6)
    v_mfma_f32_16x16x32_bf16 v[174:177], v[20:23], v[158:161], 0
    ds_read_b64_tr_b16 v[158:159], v17 offset:256
    ds_read_b64_tr_b16 v[160:161], v17 offset:2304
    s_waitcnt lgkmcnt(6)
    v_mfma_f32_16x16x32_bf16 v[178:181], v[20:23], v[162:165], 0
    ds_read_b64_tr_b16 v[162:163], v18 offset:256
    ds_read_b64_tr_b16 v[164:165], v18 offset:2304
    s_waitcnt lgkmcnt(6)
    v_mfma_f32_16x16x32_bf16 v[182:185], v[20:23], v[166:169], 0
    ds_read_b64_tr_b16 v[166:167], v19 offset:256
    ds_read_b64_tr_b16 v[168:169], v19 offset:2304
    s_waitcnt lgkmcnt(6)
    v_mfma_f32_16x16x32_bf16 v[186:189], v[20:23], v[154:157], 0
    s_waitcnt lgkmcnt(4)
    v_mfma_f32_16x16x32_bf16 v[190:193], v[20:23], v[158:161], 0
    s_waitcnt lgkmcnt(2)
    v_mfma_f32_16x16x32_bf16 v[194:197], v[20:23], v[162:165], 0
    s_waitcnt lgkmcnt(0)
    v_mfma_f32_16x16x32_bf16 v[198:201], v[20:23], v[166:169], 0
    s_waitcnt vmcnt(0)
    buffer_load_dword v255, v77, s[24:27], s50 offen
    ds_read_b128 v[102:105], v10 offset:4096
    ds_read_b128 v[106:109], v11 offset:6208
    ds_read_b128 v[114:117], v10 offset:6208
    ds_read_b128 v[110:113], v11 offset:4096
    s_waitcnt lgkmcnt(2)
    v_mov_b32 v118, v102
    v_lshlrev_b32 v122, 16, v103
    v_lshlrev_b32 v136, 16, v109
    v_and_b32 v123, 0xffff0000, v103
    v_and_b32 v137, 0xffff0000, v108
    v_pk_add_f32 v[122:123], v[122:123], v[136:137]
    v_mov_b32_dpp v118, v106 row_shr:1 row_mask:0xf bank_mask:0xf
    v_lshlrev_b32 v124, 16, v104
    v_lshlrev_b32 v136, 16, v108
    v_and_b32 v125, 0xffff0000, v104
    v_and_b32 v137, 0xffff0000, v107
    v_pk_add_f32 v[124:125], v[124:125], v[136:137]
    v_lshlrev_b32 v126, 16, v105
    v_lshlrev_b32 v136, 16, v107
    v_and_b32 v127, 0xffff0000, v105
    v_and_b32 v137, 0xffff0000, v106
    v_pk_add_f32 v[126:127], v[126:127], v[136:137]
    v_lshlrev_b32 v120, 16, v102
    v_lshlrev_b32 v136, 16, v118
    v_and_b32 v121, 0xffff0000, v102
    v_and_b32 v137, 0xffff0000, v109
    v_pk_add_f32 v[120:121], v[120:121], v[136:137]
    s_waitcnt lgkmcnt(0)
    v_lshlrev_b32 v130, 16, v115
    v_lshlrev_b32 v136, 16, v113
    v_and_b32 v131, 0xffff0000, v115
    v_and_b32 v137, 0xffff0000, v112
    v_pk_add_f32 v[130:131], v[130:131], v[136:137]
    v_mov_b32_dpp v119, v110 row_ror:1 row_mask:0xf bank_mask:0xf
    v_lshlrev_b32 v132, 16, v116
    v_lshlrev_b32 v136, 16, v112
    v_and_b32 v133, 0xffff0000, v116
    v_and_b32 v137, 0xffff0000, v111
    v_pk_add_f32 v[132:133], v[132:133], v[136:137]
    v_lshlrev_b32 v134, 16, v117
    v_lshlrev_b32 v136, 16, v111
    v_and_b32 v135, 0xffff0000, v117
    v_and_b32 v137, 0xffff0000, v110
    v_pk_add_f32 v[134:135], v[134:135], v[136:137]
    v_lshlrev_b32 v128, 16, v114
    v_lshlrev_b32 v136, 16, v119
    v_and_b32 v129, 0xffff0000, v114
    v_and_b32 v137, 0xffff0000, v113
    v_pk_add_f32 v[128:129], v[128:129], v[136:137]
    v_pk_add_f32 v[146:147], v[120:121], v[128:129]
    v_pk_add_f32 v[148:149], v[122:123], v[130:131]
    v_pk_add_f32 v[150:151], v[124:125], v[132:133]
    v_pk_add_f32 v[152:153], v[126:127], v[134:135]
    v_cvt_pk_bf16_f32 v138, v146, v148
    v_cvt_pk_bf16_f32 v139, v150, v152
    v_cvt_pk_bf16_f32 v140, v147, v149
    v_cvt_pk_bf16_f32 v141, v151, v153
    ds_write_b128 v13, v[138:141] offset:16384
    v_pk_add_f32 v[146:147], v[120:121], v[128:129] neg_lo:[0,1] neg_hi:[0,1]
    v_pk_add_f32 v[148:149], v[122:123], v[130:131] neg_lo:[0,1] neg_hi:[0,1]
    v_pk_add_f32 v[150:151], v[124:125], v[132:133] neg_lo:[0,1] neg_hi:[0,1]
    v_pk_add_f32 v[152:153], v[126:127], v[134:135] neg_lo:[0,1] neg_hi:[0,1]
    v_cvt_pk_bf16_f32 v142, v146, v148
    v_cvt_pk_bf16_f32 v143, v150, v152
    v_cvt_pk_bf16_f32 v144, v147, v149
    v_cvt_pk_bf16_f32 v145, v151, v153
    ds_write_b128 v14, v[142:145] offset:16384
    s_cmp_lg_u32 s3, 0
    s_cbranch_scc1 S_nw
    s_lshl_b32 s40, s8, 7
    s_add_u32 s40, s40, 32768
    buffer_load_dword v255, v12, s[36:39], s40 offen
S_nw:
    s_waitcnt lgkmcnt(0)
    s_barrier
    ds_read_b64_tr_b16 v[154:155], v16 offset:16384
    ds_read_b64_tr_b16 v[156:157], v16 offset:18432
    ds_read_b64_tr_b16 v[158:159], v17 offset:16384
    ds_read_b64_tr_b16 v[160:161], v17 offset:18432
    ds_read_b64_tr_b16 v[162:163], v18 offset:16384
    ds_read_b64_tr_b16 v[164:165], v18 offset:18432
    ds_read_b64_tr_b16 v[166:167], v19 offset:16384
    ds_read_b64_tr_b16 v[168:169], v19 offset:18432
    s_waitcnt lgkmcnt(6)
    v_mfma_f32_16x16x32_bf16 v[170:173], v[24:27], v[154:157], v[170:173]
    ds_read_b64_tr_b16 v[154:155], v16 offset:16640
    ds_read_b64_tr_b16 v[156:157], v16 offset:18688
    s_waitcnt lgkmcnt(6)
    v_mfma_f32_16x16x32_bf16 v[174:177], v[24:27], v[158:161], v[174:177]
    ds_read_b64_tr_b16 v[158:159], v17 offset:16640
    ds_read_b64_tr_b16 v[160:161], v17 offset:18688
    s_waitcnt lgkmcnt(6)
    v_mfma_f32_16x16x32_bf16 v[178:181], v[24:27], v[162:165], v[178:181]
    ds_read_b64_tr_b16 v[162:163], v18 offset:16640
    ds_read_b64_tr_b16 v[164:165], v18 offset:18688
    s_waitcnt lgkmcnt(6)
    v_mfma_f32_16x16x32_bf16 v[182:185], v[24:27], v[166:169], v[182:185]
    ds_read_b64_tr_b16 v[166:167], v19 offset:16640
    ds_read_b64_tr_b16 v[168:169], v19 offset:18688
    s_waitcnt lgkmcnt(6)
    v_mfma_f32_16x16x32_bf16 v[186:189], v[24:27], v[154:157], v[186:189]
    s_waitcnt lgkmcnt(4)
    v_mfma_f32_16x16x32_bf16 v[190:193], v[24:27], v[158:161], v[190:193]
    s_waitcnt lgkmcnt(2)
    v_mfma_f32_16x16x32_bf16 v[194:197], v[24:27], v[162:165], v[194:197]
    s_waitcnt lgkmcnt(0)
    v_mfma_f32_16x16x32_bf16 v[198:201], v[24:27], v[166:169], v[198:201]
    v_cvt_pk_bf16_f32 v102, v170, v174
    v_cvt_pk_bf16_f32 v103, v178, v182
    s_nop 1
    v_cvt_pk_bf16_f32 v104, v186, v190
    s_nop 2
    v_cvt_pk_bf16_f32 v105, v194, v198
    v_bfi_b32 v105, v69, v68, v105
    s_add_u32 s41, s59, 0
    buffer_store_dwordx4 v[102:105], v15, s[36:39], s41 offen sc1
    v_cvt_pk_bf16_f32 v106, v171, v175
    v_cvt_pk_bf16_f32 v107, v179, v183
    v_cvt_pk_bf16_f32 v108, v187, v191
    v_cvt_pk_bf16_f32 v109, v195, v199
    v_bfi_b32 v109, v69, v68, v109
    s_add_u32 s41, s59, 4096
    buffer_store_dwordx4 v[106:109], v15, s[36:39], s41 offen sc1
    v_cvt_pk_bf16_f32 v110, v172, v176
    v_cvt_pk_bf16_f32 v111, v180, v184
    v_cvt_pk_bf16_f32 v112, v188, v192
    v_cvt_pk_bf16_f32 v113, v196, v200
    v_bfi_b32 v113, v69, v68, v113
    s_add_u32 s41, s59, 32768
    buffer_store_dwordx4 v[110:113], v15, s[36:39], s41 offen sc1
    v_cvt_pk_bf16_f32 v114, v173, v177
    v_cvt_pk_bf16_f32 v115, v181, v185
    v_cvt_pk_bf16_f32 v116, v189, v193
    v_cvt_pk_bf16_f32 v117, v197, v201
    v_bfi_b32 v117, v69, v68, v117
    s_add_u32 s41, s59, 36864
    buffer_store_dwordx4 v[114:117], v15, s[36:39], s41 offen sc1
    s_barrier
    s_cmp_lg_u32 s3, 0
    s_cbranch_scc1 S_nf
    v_mov_b32 v74, s12
    v_mov_b32 v75, s13
    s_lshl_b32 s40, s8, 7
    s_add_u32 s40, s40, 32768
    v_lshlrev_b32 v76, 3, v3
    s_mov_b64 exec, 1
    buffer_store_dwordx2 v[74:75], v76, s[36:39], s40 offen sc1
    s_mov_b64 exec, -1
    v_lshlrev_b32 v76, 2, v3
    v_add_u32 v76, 81920, v76
    ds_write_b32 v76, v12
        S_nf:

    s_lshl_b32 s40, s7, 3
    s_add_u32 s40, s40, s3
    s_mul_i32 s40, s40, 3584
    s_add_u32 s40, s40, 286720
    v_min_u32 v77, 27, v1
    v_lshlrev_b32 v77, 7, v77
    buffer_load_dword v255, v77, s[24:27], s40 offen

    s_lshl_b32 s61, s56, 4
    v_add_u32 v4, s61, v3
    v_mul_u32_u24 v4, 528, v4
    v_add_u32 v4, 98304, v4
    v_lshl_add_u32 v5, s55, 2, v2
    v_lshl_add_u32 v48, v5, 4, v4
    s_and_b32 s61, s3, 1
    s_lshl_b32 s61, s61, 3
    v_lshrrev_b32 v4, 3, v1
    v_add_u32 v4, s61, v4
    v_and_b32 v5, 7, v1
    v_lshlrev_b32 v5, 4, v5
    s_and_b32 s61, s3, 2
    s_add_u32 s61, s61, s56
    s_mul_i32 s61, s61, 8448
    s_add_u32 s61, s61, 98304
    v_mul_u32_u24 v78, 528, v4
    v_add3_u32 v49, v78, v5, s61
    v_add_u32 v79, s61, v78
    s_bitcmp1_b32 s3, 1
    s_cselect_b32 s62, -1, 1
    s_mul_i32 s62, s62, 16896
    v_add_u32 v55, s62, v79
    s_cmp_eq_u32 s56, 0
    s_cselect_b32 s61, s8, s63
    v_lshl_add_u32 v50, v4, 6, s61
    v_sub_u32 v78, 2048, v50
    v_mov_b32 v4, 1024
    v_cmp_eq_u32 s[42:43], 0, v50
    s_nop 1
    v_cndmask_b32 v78, v78, v4, s[42:43]
    v_cndmask_b32 v55, v55, v79, s[42:43]
    s_bitcmp1_b32 s3, 1
    s_cselect_b64 s[42:43], -1, 0
    v_cndmask_b32 v50, v50, v78, s[42:43]
    v_mov_b32 v78, 1792
    v_mad_u32_u24 v50, v50, v78, v5
    v_sub_u32 v55, v55, v5
    v_and_b32 v4, 4, v1
    v_lshl_add_u32 v54, v4, 5, v49
    v_lshl_add_u32 v57, v4, 5, v50
    v_lshlrev_b32 v4, 4, v4
    v_sub_u32 v56, v55, v4
    v_mov_b32 v58, 0xffff
    s_lshl_b32 s61, s55, 14
    s_add_u32 s61, s61, 98304
    v_add_u32 v51, s61, v47
    v_cmp_eq_u32 s[42:43], 0, v2
    s_nop 1
    v_cndmask_b32 v80, 1.0, 0.5, s[42:43]
    v_and_b32 v4, 1, v2
    v_mov_b32 v5, 0xffff
    v_cmp_eq_u32 s[42:43], 1, v4
    s_nop 1
    v_cndmask_b32 v83, -1, v5, s[42:43]
    v_cndmask_b32 v78, 1.0, 0, s[42:43]
    v_cmp_eq_u32 s[42:43], 1, v2
    s_nop 1
    v_cndmask_b32 v79, v78, 0.5, s[42:43]
    s_cmp_eq_u32 s56, 0
    s_cselect_b64 s[42:43], -1, 0
    v_cndmask_b32 v81, v78, v79, s[42:43]
    v_cndmask_b32 v82, v79, v78, s[42:43]
    v_lshlrev_b32 v4, 6, v4
    v_and_b32 v5, 2, v2
    v_add_u32 v4, v4, v5
    v_cvt_f32_u32 v79, v4
    s_lshl_b32 s61, s55, 5
    s_add_u32 s61, s61, s56
    v_lshl_add_u32 v4, v3, 1, s61
    v_cvt_f32_u32 v78, v4
    v_mul_f32 v78, 0x3b124925, v78
    v_mul_f32 v79, v78, v79
    s_lshl_b32 s61, s56, 13
    v_add_u32 v5, s61, v51
    v_mul_f32 v100, 0x40800000, v78
    v_cos_f32 v100, v100
    s_nop 0
    v_add_f32 v100, v100, v100
    v_fmamk_f32 v84, v78, 0x0, v79
    v_fmamk_f32 v85, v78, 0x40800000, v79
    v_cos_f32 v84, v84
    v_cos_f32 v85, v85
    s_nop 0
    v_fma_f32 v86, v100, v85, -v84
    v_fma_f32 v87, v100, v86, -v85
    v_fma_f32 v88, v100, v87, -v86
    v_fma_f32 v89, v100, v88, -v87
    v_fma_f32 v90, v100, v89, -v88
    v_fma_f32 v91, v100, v90, -v89
    v_fma_f32 v92, v100, v91, -v90
    v_fma_f32 v93, v100, v92, -v91
    v_fma_f32 v94, v100, v93, -v92
    v_fma_f32 v95, v100, v94, -v93
    v_fma_f32 v96, v100, v95, -v94
    v_fma_f32 v97, v100, v96, -v95
    v_fma_f32 v98, v100, v97, -v96
    v_fma_f32 v99, v100, v98, -v97
    v_mul_f32 v84, v84, v80
    v_mul_f32 v96, v96, v81
    v_cvt_pk_bf16_f32 v60, v84, v88
    v_cvt_pk_bf16_f32 v61, v92, v96
    v_cvt_pk_bf16_f32 v62, v85, v89
    v_cvt_pk_bf16_f32 v63, v93, v97
    v_and_b32 v63, v83, v63
    ds_write_b128 v5, v[60:63] offset:0
    v_cvt_pk_bf16_f32 v64, v86, v90
    v_cvt_pk_bf16_f32 v65, v94, v98
    v_cvt_pk_bf16_f32 v66, v87, v91
    v_cvt_pk_bf16_f32 v67, v95, v99
    v_and_b32 v65, v83, v65
    v_and_b32 v67, v83, v67
    ds_write_b128 v5, v[64:67] offset:1024
    v_fmamk_f32 v84, v78, 0x0, v79
    v_fmamk_f32 v85, v78, 0x40800000, v79
    v_sin_f32 v84, v84
    v_sin_f32 v85, v85
    s_nop 0
    v_fma_f32 v86, v100, v85, -v84
    v_fma_f32 v87, v100, v86, -v85
    v_fma_f32 v88, v100, v87, -v86
    v_fma_f32 v89, v100, v88, -v87
    v_fma_f32 v90, v100, v89, -v88
    v_fma_f32 v91, v100, v90, -v89
    v_fma_f32 v92, v100, v91, -v90
    v_fma_f32 v93, v100, v92, -v91
    v_fma_f32 v94, v100, v93, -v92
    v_fma_f32 v95, v100, v94, -v93
    v_fma_f32 v96, v100, v95, -v94
    v_fma_f32 v97, v100, v96, -v95
    v_fma_f32 v98, v100, v97, -v96
    v_fma_f32 v99, v100, v98, -v97
    v_mul_f32 v96, v96, v82
    v_cvt_pk_bf16_f32 v60, v84, v88
    v_cvt_pk_bf16_f32 v61, v92, v96
    v_cvt_pk_bf16_f32 v62, v85, v89
    v_cvt_pk_bf16_f32 v63, v93, v97
    v_and_b32 v63, v83, v63
    ds_write_b128 v5, v[60:63] offset:4096
    v_cvt_pk_bf16_f32 v64, v86, v90
    v_cvt_pk_bf16_f32 v65, v94, v98
    v_cvt_pk_bf16_f32 v66, v87, v91
    v_cvt_pk_bf16_f32 v67, v95, v99
    v_and_b32 v65, v83, v65
    v_and_b32 v67, v83, v67
    ds_write_b128 v5, v[64:67] offset:5120
    v_fmamk_f32 v84, v78, 0x3f800000, v79
    v_fmamk_f32 v85, v78, 0x40a00000, v79
    v_cos_f32 v84, v84
    v_cos_f32 v85, v85
    s_nop 0
    v_fma_f32 v86, v100, v85, -v84
    v_fma_f32 v87, v100, v86, -v85
    v_fma_f32 v88, v100, v87, -v86
    v_fma_f32 v89, v100, v88, -v87
    v_fma_f32 v90, v100, v89, -v88
    v_fma_f32 v91, v100, v90, -v89
    v_fma_f32 v92, v100, v91, -v90
    v_fma_f32 v93, v100, v92, -v91
    v_fma_f32 v94, v100, v93, -v92
    v_fma_f32 v95, v100, v94, -v93
    v_fma_f32 v96, v100, v95, -v94
    v_fma_f32 v97, v100, v96, -v95
    v_fma_f32 v98, v100, v97, -v96
    v_fma_f32 v99, v100, v98, -v97
    v_cvt_pk_bf16_f32 v60, v84, v88
    v_cvt_pk_bf16_f32 v61, v92, v96
    v_cvt_pk_bf16_f32 v62, v85, v89
    v_cvt_pk_bf16_f32 v63, v93, v97
    v_and_b32 v61, v83, v61
    v_and_b32 v63, v83, v63
    ds_write_b128 v5, v[60:63] offset:2048
    v_cvt_pk_bf16_f32 v64, v86, v90
    v_cvt_pk_bf16_f32 v65, v94, v98
    v_cvt_pk_bf16_f32 v66, v87, v91
    v_cvt_pk_bf16_f32 v67, v95, v99
    v_and_b32 v65, v83, v65
    v_and_b32 v67, v83, v67
    ds_write_b128 v5, v[64:67] offset:3072
    v_fmamk_f32 v84, v78, 0x3f800000, v79
    v_fmamk_f32 v85, v78, 0x40a00000, v79
    v_sin_f32 v84, v84
    v_sin_f32 v85, v85
    s_nop 0
    v_fma_f32 v86, v100, v85, -v84
    v_fma_f32 v87, v100, v86, -v85
    v_fma_f32 v88, v100, v87, -v86
    v_fma_f32 v89, v100, v88, -v87
    v_fma_f32 v90, v100, v89, -v88
    v_fma_f32 v91, v100, v90, -v89
    v_fma_f32 v92, v100, v91, -v90
    v_fma_f32 v93, v100, v92, -v91
    v_fma_f32 v94, v100, v93, -v92
    v_fma_f32 v95, v100, v94, -v93
    v_fma_f32 v96, v100, v95, -v94
    v_fma_f32 v97, v100, v96, -v95
    v_fma_f32 v98, v100, v97, -v96
    v_fma_f32 v99, v100, v98, -v97
    v_cvt_pk_bf16_f32 v60, v84, v88
    v_cvt_pk_bf16_f32 v61, v92, v96
    v_cvt_pk_bf16_f32 v62, v85, v89
    v_cvt_pk_bf16_f32 v63, v93, v97
    v_and_b32 v61, v83, v61
    v_and_b32 v63, v83, v63
    ds_write_b128 v5, v[60:63] offset:6144
    v_cvt_pk_bf16_f32 v64, v86, v90
    v_cvt_pk_bf16_f32 v65, v94, v98
    v_cvt_pk_bf16_f32 v66, v87, v91
    v_cvt_pk_bf16_f32 v67, v95, v99
    v_and_b32 v65, v83, v65
    v_and_b32 v67, v83, v67
    ds_write_b128 v5, v[64:67] offset:7168
    s_cmp_lg_u32 s3, 1
    s_cbranch_scc1 P_dB
    v_and_b32 v4, 31, v1
    v_lshlrev_b32 v4, 7, v4
    s_mov_b32 s40, 32768

    s_mov_b32 s9, 0
    s_waitcnt vmcnt(0)
    buffer_load_dword v84, v4, s[36:39], s40 offen sc1
    v_mov_b32 v92, v93
    v_mov_b32 v92, v93
    v_mov_b32 v92, v93
    v_mov_b32 v92, v93
    v_mov_b32 v92, v93
    v_mov_b32 v92, v93
    v_mov_b32 v92, v93
    v_mov_b32 v92, v93
    v_mov_b32 v92, v93
    v_mov_b32 v92, v93
    v_mov_b32 v92, v93
    v_mov_b32 v92, v93
    v_mov_b32 v92, v93
    v_mov_b32 v92, v93
    v_mov_b32 v92, v93
    v_mov_b32 v92, v93
    v_mov_b32 v92, v93
    v_mov_b32 v92, v93
    v_mov_b32 v92, v93
    v_mov_b32 v92, v93
    v_mov_b32 v92, v93
    v_mov_b32 v92, v93
    v_mov_b32 v92, v93
    v_mov_b32 v92, v93
    v_mov_b32 v92, v93
    v_mov_b32 v92, v93
    v_mov_b32 v92, v93
    v_mov_b32 v92, v93
    v_mov_b32 v92, v93
    v_mov_b32 v92, v93
    v_mov_b32 v92, v93
    v_mov_b32 v92, v93
    v_mov_b32 v92, v93
    v_mov_b32 v92, v93
    v_mov_b32 v92, v93
    v_mov_b32 v92, v93
    v_mov_b32 v92, v93
    v_mov_b32 v92, v93
    v_mov_b32 v92, v93
    v_mov_b32 v92, v93
P_lB:
    buffer_load_dword v85, v4, s[36:39], s40 offen sc1
    s_waitcnt vmcnt(1)
    v_cmp_ne_u32 vcc, s12, v84
    s_nop 0
    s_cbranch_vccz P_dB
    buffer_load_dword v84, v4, s[36:39], s40 offen sc1
    s_waitcnt vmcnt(1)
    v_cmp_ne_u32 vcc, s12, v85
    s_nop 0
    s_cbranch_vccz P_dB
    s_add_u32 s9, s9, 1
    s_cmp_lt_u32 s9, 200000
    s_cbranch_scc1 P_lB
P_dB:
    s_lshl_b32 s40, s3, 12
    s_add_u32 m0, s40, 0
    s_waitcnt lgkmcnt(0)
    s_barrier
    buffer_load_dwordx4 v44, s[36:39], s60 offen offset:0 sc1 lds
    buffer_load_dwordx4 v45, s[36:39], s60 offen offset:1024 sc1 lds
    buffer_load_dwordx4 v44, s[36:39], s60 offen offset:2048 sc1 lds
    buffer_load_dwordx4 v45, s[36:39], s60 offen offset:3072 sc1 lds
    ds_read_b128 v[102:105], v51 offset:0
    ds_read_b128 v[106:109], v51 offset:1024
    ds_read_b128 v[110:113], v51 offset:2048
    ds_read_b128 v[114:117], v51 offset:3072
    ds_read_b128 v[118:121], v51 offset:4096
    ds_read_b128 v[122:125], v51 offset:5120
    ds_read_b128 v[126:129], v51 offset:6144
    ds_read_b128 v[130:133], v51 offset:7168
    ds_read_b128 v[134:137], v51 offset:8192
    ds_read_b128 v[138:141], v51 offset:9216
    ds_read_b128 v[142:145], v51 offset:10240
    ds_read_b128 v[146:149], v51 offset:11264
    ds_read_b128 v[150:153], v51 offset:12288
    ds_read_b128 v[154:157], v51 offset:13312
    ds_read_b128 v[158:161], v51 offset:14336
    ds_read_b128 v[162:165], v51 offset:15360
    v_xor_b32 v230, 32, v46
    v_xor_b32 v231, 64, v46
    v_xor_b32 v232, 96, v46
    s_lshl_b32 s40, s55, 13
    s_lshl_b32 s41, s57, 11
    s_add_u32 s40, s40, s41
    v_add_u32 v233, s40, v47
    s_lshl_b32 s40, s3, 12
    v_add_u32 v5, s40, v47
    v_xor_b32 v70, s51, v70
    v_xor_b32 v71, s51, v71
    s_mov_b32 s9, 0
        S_gc:

    s_waitcnt vmcnt(3)
    ds_read_b32 v84, v5 offset:12
    s_waitcnt vmcnt(2)
    ds_read_b32 v85, v5 offset:1036
    s_waitcnt vmcnt(1)
    ds_read_b32 v86, v5 offset:2060
    s_waitcnt vmcnt(0)
    ds_read_b32 v87, v5 offset:3084
    s_waitcnt lgkmcnt(1)
    v_xor_b32 v84, v70, v84
    v_xor_b32 v86, v70, v86
    v_xor_b32 v85, v71, v85
    v_or_b32 v84, v84, v86
    v_and_b32 v84, v72, v84
    v_and_or_b32 v84, v73, v85, v84
    s_waitcnt lgkmcnt(0)
    v_xor_b32 v87, v71, v87
    v_and_or_b32 v84, v73, v87, v84
    v_cmp_ne_u32 vcc, 0, v84
    s_nop 0
    s_cbranch_vccnz S_gr
        S_gk:
    s_barrier

    s_cmp_lg_u32 s56, 0
    s_cbranch_scc1 S_np
    s_setprio 1
S_np:
    ds_read_b64_tr_b16 v[166:167], v46 offset:0
    ds_read_b64_tr_b16 v[168:169], v46 offset:512
    ds_read_b64_tr_b16 v[170:171], v46 offset:4096
    ds_read_b64_tr_b16 v[172:173], v46 offset:4608
    ds_read_b64_tr_b16 v[174:175], v230 offset:0
    ds_read_b64_tr_b16 v[176:177], v230 offset:512
    ds_read_b64_tr_b16 v[178:179], v230 offset:4096
    ds_read_b64_tr_b16 v[180:181], v230 offset:4608
    ds_read_b64_tr_b16 v[182:183], v231 offset:0
    ds_read_b64_tr_b16 v[184:185], v231 offset:512
    ds_read_b64_tr_b16 v[186:187], v231 offset:4096
    ds_read_b64_tr_b16 v[188:189], v231 offset:4608
    ds_read_b64_tr_b16 v[190:191], v232 offset:0
    ds_read_b64_tr_b16 v[192:193], v232 offset:512
    ds_read_b64_tr_b16 v[194:195], v232 offset:4096
    ds_read_b64_tr_b16 v[196:197], v232 offset:4608
    s_waitcnt lgkmcnt(14)
    v_mfma_f32_16x16x32_bf16 v[198:201], v[166:169], v[28:31], 0
    s_waitcnt lgkmcnt(12)
    v_mfma_f32_16x16x32_bf16 v[198:201], v[170:173], v[32:35], v[198:201]
    v_mfma_f32_16x16x32_bf16 v[214:217], v[166:169], v[36:39], 0
    v_mfma_f32_16x16x32_bf16 v[214:217], v[170:173], v[40:43], v[214:217]
    s_waitcnt lgkmcnt(10)
    v_mfma_f32_16x16x32_bf16 v[202:205], v[174:177], v[28:31], 0
    s_waitcnt lgkmcnt(8)
    v_mfma_f32_16x16x32_bf16 v[202:205], v[178:181], v[32:35], v[202:205]
    v_mfma_f32_16x16x32_bf16 v[218:221], v[174:177], v[36:39], 0
    v_mfma_f32_16x16x32_bf16 v[218:221], v[178:181], v[40:43], v[218:221]
    s_waitcnt lgkmcnt(6)
    v_mfma_f32_16x16x32_bf16 v[206:209], v[182:185], v[28:31], 0
    s_waitcnt lgkmcnt(4)
    v_mfma_f32_16x16x32_bf16 v[206:209], v[186:189], v[32:35], v[206:209]
    v_cvt_pk_bf16_f32 v234, v198, v199
    v_cvt_pk_bf16_f32 v235, v200, v201
    v_cvt_pk_bf16_f32 v236, v202, v203
    v_cvt_pk_bf16_f32 v237, v204, v205
    ds_write_b128 v233, v[234:237] offset:32768
    v_mfma_f32_16x16x32_bf16 v[222:225], v[182:185], v[36:39], 0
    v_mfma_f32_16x16x32_bf16 v[222:225], v[186:189], v[40:43], v[222:225]
    v_cvt_pk_bf16_f32 v238, v214, v215
    v_cvt_pk_bf16_f32 v239, v216, v217
    v_cvt_pk_bf16_f32 v240, v218, v219
    v_cvt_pk_bf16_f32 v241, v220, v221
    ds_write_b128 v233, v[238:241] offset:36864
    s_waitcnt lgkmcnt(4)
    v_mfma_f32_16x16x32_bf16 v[210:213], v[190:193], v[28:31], 0
    s_waitcnt lgkmcnt(2)
    v_mfma_f32_16x16x32_bf16 v[210:213], v[194:197], v[32:35], v[210:213]
    v_mfma_f32_16x16x32_bf16 v[226:229], v[190:193], v[36:39], 0
    v_mfma_f32_16x16x32_bf16 v[226:229], v[194:197], v[40:43], v[226:229]
    s_add_u32 s40, s8, s57
    s_cmp_eq_u32 s40, 0
    s_cbranch_scc1 S_x0
S_x1:
    v_cvt_pk_bf16_f32 v166, v206, v207
    v_cvt_pk_bf16_f32 v167, v208, v209
    s_nop 0
    v_cvt_pk_bf16_f32 v168, v210, v211
    v_cvt_pk_bf16_f32 v169, v212, v213
    ds_write_b128 v233, v[166:169] offset:33792
    v_cvt_pk_bf16_f32 v170, v222, v223
    v_cvt_pk_bf16_f32 v171, v224, v225
    v_cvt_pk_bf16_f32 v172, v226, v227
    v_cvt_pk_bf16_f32 v173, v228, v229
    ds_write_b128 v233, v[170:173] offset:37888
    s_mov_b64 exec, 1
    ds_add_u32 v52, v59 offset:8
    s_mov_b64 exec, -1
    s_mov_b32 s9, 0
        W_lU:
    ds_read_b32 v4, v52 offset:8
    s_add_u32 s9, s9, 1
    s_cmp_gt_u32 s9, 1600000
    s_cbranch_scc1 W_dU
    s_waitcnt lgkmcnt(0)
    v_cmp_gt_u32 vcc, 4, v4
    s_nop 0
    s_cbranch_vccnz W_lU
        W_dU:

    ds_read_b128 v[166:169], v53 offset:32768
    ds_read_b128 v[170:173], v53 offset:33792
    ds_read_b128 v[174:177], v53 offset:40960
    ds_read_b128 v[178:181], v53 offset:41984
    ds_read_b128 v[182:185], v53 offset:49152
    ds_read_b128 v[186:189], v53 offset:50176
    ds_read_b128 v[190:193], v53 offset:57344
    s_waitcnt lgkmcnt(6)
    v_mfma_f32_16x16x32_bf16 v[198:201], v[102:105], v[166:169], 0
    ds_read_b128 v[194:197], v53 offset:58368
    s_waitcnt lgkmcnt(6)
    v_mfma_f32_16x16x32_bf16 v[198:201], v[106:109], v[170:173], v[198:201]
    ds_read_b128 v[166:169], v53 offset:53248
    s_waitcnt lgkmcnt(6)
    v_mfma_f32_16x16x32_bf16 v[202:205], v[110:113], v[174:177], 0
    ds_read_b128 v[170:173], v53 offset:54272
    s_waitcnt lgkmcnt(6)
    v_mfma_f32_16x16x32_bf16 v[202:205], v[114:117], v[178:181], v[202:205]
    ds_read_b128 v[174:177], v53 offset:61440
    s_waitcnt lgkmcnt(6)
    v_mfma_f32_16x16x32_bf16 v[214:217], v[134:137], v[182:185], 0
    ds_read_b128 v[178:181], v53 offset:62464
    s_waitcnt lgkmcnt(6)
    v_mfma_f32_16x16x32_bf16 v[214:217], v[138:141], v[186:189], v[214:217]
    ds_read_b128 v[182:185], v53 offset:36864
    s_waitcnt lgkmcnt(6)
    v_mfma_f32_16x16x32_bf16 v[218:221], v[142:145], v[190:193], 0
    ds_read_b128 v[186:189], v53 offset:37888
    s_waitcnt lgkmcnt(6)
    v_mfma_f32_16x16x32_bf16 v[218:221], v[146:149], v[194:197], v[218:221]
    ds_read_b128 v[190:193], v53 offset:45056
    s_waitcnt lgkmcnt(6)
    v_mfma_f32_16x16x32_bf16 v[206:209], v[118:121], v[166:169], 0
    ds_read_b128 v[194:197], v53 offset:46080
    s_waitcnt lgkmcnt(6)
    v_mfma_f32_16x16x32_bf16 v[206:209], v[122:125], v[170:173], v[206:209]
    s_waitcnt lgkmcnt(5)
    v_mfma_f32_16x16x32_bf16 v[210:213], v[126:129], v[174:177], 0
    v_pk_add_f32 v[84:85], v[198:199], v[202:203]
    v_pk_add_f32 v[86:87], v[200:201], v[204:205]
    s_waitcnt lgkmcnt(4)
    v_mfma_f32_16x16x32_bf16 v[210:213], v[130:133], v[178:181], v[210:213]
    v_pk_add_f32 v[202:203], v[198:199], v[202:203] neg_lo:[0,1] neg_hi:[0,1]
    v_pk_add_f32 v[204:205], v[200:201], v[204:205] neg_lo:[0,1] neg_hi:[0,1]
    s_waitcnt lgkmcnt(3)
    v_mfma_f32_16x16x32_bf16 v[222:225], v[150:153], v[182:185], 0
    v_pk_add_f32 v[88:89], v[214:215], v[218:219]
    s_waitcnt lgkmcnt(2)
    v_mfma_f32_16x16x32_bf16 v[222:225], v[154:157], v[186:189], v[222:225]
    v_pk_add_f32 v[90:91], v[216:217], v[220:221]
    s_waitcnt lgkmcnt(1)
    v_mfma_f32_16x16x32_bf16 v[226:229], v[158:161], v[190:193], 0
    v_pk_add_f32 v[218:219], v[214:215], v[218:219] neg_lo:[0,1] neg_hi:[0,1]
    s_waitcnt lgkmcnt(0)
    v_mfma_f32_16x16x32_bf16 v[226:229], v[162:165], v[194:197], v[226:229]
    v_pk_add_f32 v[220:221], v[216:217], v[220:221] neg_lo:[0,1] neg_hi:[0,1]
    s_add_u32 s40, s8, s56
    s_cmp_eq_u32 s40, 0
    s_cbranch_scc1 S_y0
S_y1:
    v_pk_add_f32 v[198:199], v[206:207], v[210:211]
    v_pk_add_f32 v[200:201], v[208:209], v[212:213]
    v_pk_add_f32 v[210:211], v[206:207], v[210:211] neg_lo:[0,1] neg_hi:[0,1]
    v_pk_add_f32 v[212:213], v[208:209], v[212:213] neg_lo:[0,1] neg_hi:[0,1]
    v_pk_add_f32 v[214:215], v[222:223], v[226:227]
    v_pk_add_f32 v[216:217], v[224:225], v[228:229]
    v_pk_add_f32 v[226:227], v[222:223], v[226:227] neg_lo:[0,1] neg_hi:[0,1]
    v_pk_add_f32 v[228:229], v[224:225], v[228:229] neg_lo:[0,1] neg_hi:[0,1]
    v_pk_add_f32 v[206:207], v[84:85], v[198:199]
    v_pk_add_f32 v[208:209], v[86:87], v[200:201]
    v_pk_add_f32 v[222:223], v[88:89], v[214:215]
    v_pk_add_f32 v[224:225], v[90:91], v[216:217]
    v_cvt_pk_bf16_f32 v166, v206, v222
    v_cvt_pk_bf16_f32 v167, v207, v223
    v_cvt_pk_bf16_f32 v168, v208, v224
    v_cvt_pk_bf16_f32 v169, v209, v225
    ds_write_b128 v48, v[166:169] offset:0
    v_pk_add_f32 v[206:207], v[84:85], v[198:199] neg_lo:[0,1] neg_hi:[0,1]
    v_pk_add_f32 v[208:209], v[86:87], v[200:201] neg_lo:[0,1] neg_hi:[0,1]
    v_pk_add_f32 v[222:223], v[88:89], v[214:215] neg_lo:[0,1] neg_hi:[0,1]
    v_pk_add_f32 v[224:225], v[90:91], v[216:217] neg_lo:[0,1] neg_hi:[0,1]
    v_cvt_pk_bf16_f32 v170, v206, v222
    v_cvt_pk_bf16_f32 v171, v207, v223
    v_cvt_pk_bf16_f32 v172, v208, v224
    v_cvt_pk_bf16_f32 v173, v209, v225
    ds_write_b128 v48, v[170:173] offset:16896
    v_pk_add_f32 v[206:207], v[202:203], v[210:211]
    v_pk_add_f32 v[208:209], v[204:205], v[212:213]
    v_pk_add_f32 v[222:223], v[218:219], v[226:227]
    v_pk_add_f32 v[224:225], v[220:221], v[228:229]
    v_cvt_pk_bf16_f32 v174, v206, v222
    v_cvt_pk_bf16_f32 v175, v207, v223
    v_cvt_pk_bf16_f32 v176, v208, v224
    v_cvt_pk_bf16_f32 v177, v209, v225
    ds_write_b128 v48, v[174:177] offset:256
    v_pk_add_f32 v[206:207], v[202:203], v[210:211] neg_lo:[0,1] neg_hi:[0,1]
    v_pk_add_f32 v[208:209], v[204:205], v[212:213] neg_lo:[0,1] neg_hi:[0,1]
    v_pk_add_f32 v[222:223], v[218:219], v[226:227] neg_lo:[0,1] neg_hi:[0,1]
    v_pk_add_f32 v[224:225], v[220:221], v[228:229] neg_lo:[0,1] neg_hi:[0,1]
    v_cvt_pk_bf16_f32 v178, v206, v222
    v_cvt_pk_bf16_f32 v179, v207, v223
    v_cvt_pk_bf16_f32 v180, v208, v224
    v_cvt_pk_bf16_f32 v181, v209, v225
    ds_write_b128 v48, v[178:181] offset:17152
    s_mov_b64 exec, 1
    ds_add_u32 v52, v59
    s_mov_b64 exec, -1

    s_mov_b32 s9, 0
        W_lO:
    ds_read_b32 v4, v52 offset:0
    s_add_u32 s9, s9, 1
    s_cmp_gt_u32 s9, 1600000
    s_cbranch_scc1 W_dO
    s_waitcnt lgkmcnt(0)
    v_cmp_gt_u32 vcc, 4, v4
    s_nop 0
    s_cbranch_vccnz W_lO
        W_dO:

    v_and_b32 v4, 4, v1
    v_lshl_add_u32 v5, v4, 6, v50
    ds_read_b128 v[102:105], v49 offset:0
    ds_read_b128 v[106:109], v49 offset:128
    ds_read_b128 v[110:113], v49 offset:320
    ds_read_b128 v[114:117], v54 offset:256
    ds_read_b128 v[118:121], v55 offset:432
    ds_read_b32 v122, v55 offset:448
    ds_read_b128 v[126:129], v55 offset:112
    ds_read_b32 v130, v55 offset:128
    ds_read_b128 v[134:137], v56 offset:304
    ds_read_b32 v138, v56 offset:320
    s_waitcnt lgkmcnt(9)
    buffer_store_dwordx4 v[102:105], v50, s[32:35], 0 offen offset:896 nt
    s_waitcnt lgkmcnt(8)
    buffer_store_dwordx4 v[106:109], v50, s[32:35], 0 offen offset:1024 nt
    s_waitcnt lgkmcnt(7)
    buffer_store_dwordx4 v[110:113], v50, s[32:35], 0 offen offset:1408 nt
    s_waitcnt lgkmcnt(6)
    buffer_store_dwordx4 v[114:117], v57, s[32:35], 0 offen offset:1344 nt
    s_waitcnt lgkmcnt(4)
    v_bfi_b32 v142, v58, v122, v121
    v_bfi_b32 v143, v58, v121, v120
    v_bfi_b32 v144, v58, v120, v119
    v_bfi_b32 v145, v58, v119, v118
    buffer_store_dwordx4 v[142:145], v50, s[32:35], 0 offen offset:1152 nt
    s_waitcnt lgkmcnt(2)
    v_bfi_b32 v146, v58, v130, v129
    v_bfi_b32 v147, v58, v129, v128
    v_bfi_b32 v148, v58, v128, v127
    v_bfi_b32 v149, v58, v127, v126
    buffer_store_dwordx4 v[146:149], v50, s[32:35], 0 offen offset:1664 nt
    s_waitcnt lgkmcnt(0)
    v_bfi_b32 v150, v58, v138, v137
    v_bfi_b32 v151, v58, v137, v136
    v_bfi_b32 v152, v58, v136, v135
    v_bfi_b32 v153, v58, v135, v134
    buffer_store_dwordx4 v[150:153], v5, s[32:35], 0 offen offset:1280 nt
    s_add_u32 s40, s8, s3
    s_cmp_lg_u32 s40, 0
    s_cbranch_scc1 S_end
    s_add_u32 s40, s10, 16
    v_mov_b32 v4, s40
    s_mov_b32 s40, 4096
    s_mov_b64 exec, 1
    buffer_store_dword v4, v12, s[36:39], s40 offen
        S_end:

    s_endpgm
K_c:
    s_lshl_b32 s40, s8, 7
    s_waitcnt lgkmcnt(0)
    s_load_dwordx2 s[10:11], s[36:37], s40
    s_lshl_b32 s14, s8, 10
    s_add_u32 s14, s14, 65536
    s_getreg_b32 s52, hwreg(HW_REG_XCC_ID, 0, 3)
    s_mov_b32 s26, 401408
    s_mov_b32 s27, 0x00020000
    s_mov_b32 s34, 3670016
    s_mov_b32 s35, 0x00020000
    s_sub_u32 s62, s3, 4
    s_lshr_b32 s16, s62, 1
    s_and_b32 s17, s62, 1
    s_lshl_b32 s29, s62, 11
    v_and_b32 v1, 63, v0
    v_lshlrev_b32 v4, 4, v1
    s_lshl_b32 s1, s5, 3
    s_add_u32 s1, s1, s4
    s_mul_i32 s1, s1, 1792
    v_min_u32 v41, 13, v1
    v_lshlrev_b32 v41, 7, v41
    v_lshrrev_b32 v24, 4, v1
    v_and_b32 v25, 15, v1
    v_lshrrev_b32 v26, 3, v1
    v_and_b32 v27, 7, v1
    v_mov_b32 v5, 161792
    v_mov_b32 v6, 0
    v_lshl_add_u32 v2, v1, 2, v5
    ds_write_b32 v2, v6
    v_lshrrev_b32 v3, 1, v25
    v_xor_b32 v3, v3, v24
    v_lshlrev_b32 v3, 4, v3
    v_lshl_add_u32 v3, v25, 7, v3
    s_lshr_b32 s18, s62, 1
    s_lshl_b32 s18, s18, 12
    v_add_u32 v28, s18, v3
    v_xor_b32 v29, 64, v28
    v_add_u32 v30, 40960, v28
    v_add_u32 v31, 40960, v29
    v_lshrrev_b32 v3, 2, v25
    v_lshl_add_u32 v3, v24, 3, v3
    v_lshlrev_b32 v3, 7, v3
    v_and_b32 v7, 3, v1
    v_lshl_add_u32 v3, v7, 3, v3
    v_bfe_u32 v7, v1, 3, 2
    s_and_b32 s18, s62, 1
    s_lshl_b32 s18, s18, 1
    v_xor_b32 v7, s18, v7
    v_lshl_add_u32 v3, v7, 5, v3
    v_add_u32 v32, 71680, v3
    v_xor_b32 v33, 32, v32
    v_add_u32 v34, 49152, v32
    v_add_u32 v35, 49152, v33
    s_and_b32 s18, s62, 1
    s_lshl_b32 s19, s7, 1
    s_add_u32 s18, s18, s19
    s_cmp_ge_u32 s18, 7
    s_cselect_b32 s19, 14, 7
    s_sub_u32 s18, s19, s18
    v_cmp_gt_u32 s[54:55], s18, v24
    v_add_u32 v2, 4, v24
    v_cmp_gt_u32 s[56:57], s18, v2
    s_bitcmp0_b32 s62, 0
    s_cselect_b64 vcc, -1, 0
    s_xor_b64 s[54:55], s[54:55], vcc
    s_xor_b64 s[56:57], s[56:57], vcc
    v_lshrrev_b32 v3, 2, v25
    s_and_b32 s18, s62, 1
    s_lshl_b32 s19, s7, 1
    s_add_u32 s18, s18, s19
    s_cmp_ge_u32 s18, 7
    s_cselect_b32 s19, 14, 7
    s_sub_u32 s18, s19, s18
    v_cmp_gt_u32 s[58:59], s18, v3
    v_add_u32 v2, 4, v3
    v_cmp_gt_u32 s[60:61], s18, v2
    s_bitcmp0_b32 s62, 0
    s_cselect_b64 vcc, -1, 0
    s_xor_b64 s[58:59], s[58:59], vcc
    s_xor_b64 s[60:61], s[60:61], vcc
    s_and_b32 s18, s62, 1
    s_lshl_b32 s19, s7, 1
    s_add_u32 s18, s18, s19
    s_lshl_b32 s100, s18, 10
    s_lshl_b32 s18, s8, 2
    s_and_b32 s19, s62, 2
    s_add_u32 s18, s18, s19
    s_mul_i32 s19, s18, 14336
    s_add_u32 s100, s100, s19
    s_add_u32 s100, s100, 2097152
    s_lshl_b32 s20, s18, 6
    s_add_u32 s20, s20, 16384
    s_lshl_b32 s18, s17, 11
    s_sub_u32 s18, s18, 1024
    s_add_u32 s15, s100, s18
    s_lshl_b32 s19, s7, 1
    s_add_u32 s18, s17, s19
    s_lshl_b32 s18, s18, 3
    s_add_u32 s21, s20, s18
    v_and_b32 v2, 1, v25
    v_cmp_eq_u32 s[44:45], 1, v2
    v_lshl_add_u32 v2, v24, 2, v2
    v_cmp_le_u32 s[46:47], v2, v25
    v_add_u32 v2, 2, v2
    v_cmp_le_u32 s[48:49], v2, v25
    v_mov_b32 v2, 0xffff
    v_mov_b32 v3, 0xffff0000
    v_cndmask_b32 v2, v2, v3, s[44:45]
    v_cndmask_b32 v36, v2, 0, s[46:47]
    v_cndmask_b32 v37, v2, 0, s[48:49]
    v_cndmask_b32 v38, 0, v2, s[46:47]
    v_cndmask_b32 v39, 0, v2, s[48:49]
    s_add_u32 s18, s8, s16
    s_cmp_eq_u32 s18, 0
    s_cselect_b64 s[50:51], -1, 0
    s_mul_i32 s18, s17, 6
    s_cmp_eq_u32 s18, s7
    s_cselect_b32 s101, 1, 0
    v_mov_b32 v44, 1
    v_mov_b32 v45, 0xf149f2ca
    v_mov_b32 v46, 0xffffff00
    s_mov_b32 s0, 0x3e8b97f6
    s_add_u32 s18, s29, 4096
    v_add_u32 v42, s18, v4
    v_add_u32 v43, s29, v4
    v_lshl_add_u32 v47, s62, 2, v5
    v_lshl_add_u32 v218, s17, 10, v4
    v_add_u32 v219, 2048, v218
    v_lshl_add_u32 v220, s17, 2, v5
    v_lshl_add_u32 v221, s17, 3, v5
    s_lshl_b32 s18, s7, 7
    v_min_u32 v8, 13, v1
    v_lshlrev_b32 v8, 3, v8
    v_lshrrev_b32 v2, 2, v1
    v_bfe_u32 v3, v1, 3, 2
    v_lshlrev_b32 v3, 5, v3
    v_lshl_add_u32 v2, v2, 7, v3
    v_and_b32 v3, 3, v1
    v_lshl_add_u32 v2, v3, 3, v2
    v_add_u32 v16, 71680, v2
    v_xor_b32 v17, 32, v16
    v_xor_b32 v18, 64, v16
    v_xor_b32 v19, 96, v16
    s_add_u32 s19, s29, 4096
    v_lshrrev_b32 v2, 1, v24
    v_xor_b32 v2, v2, v27
    v_lshlrev_b32 v2, 4, v2
    v_lshl_add_u32 v2, v25, 7, v2
    v_and_b32 v3, 1, v24
    v_lshl_add_u32 v2, v3, 3, v2
    v_add_u32 v20, s19, v2
    v_xor_b32 v21, 32, v20
    v_xor_b32 v22, 64, v20
    v_xor_b32 v23, 96, v20
    v_mul_u32_u24 v10, 1792, v26
    v_lshl_add_u32 v10, v27, 4, v10
    v_xor_b32 v3, v27, v26
    v_lshlrev_b32 v3, 4, v3
    v_lshl_add_u32 v2, v26, 7, v3
    v_add_u32 v9, s19, v2
    s_lshl_b32 s19, s8, 2
    s_add_u32 s19, s19, s62
    s_mul_i32 s22, s19, 14336
    s_add_u32 s22, s22, 2097152
    s_mul_i32 s23, s19, 28672
    s_add_u32 s23, s23, s18
    s_add_u32 s28, s23, 14336
    s_waitcnt lgkmcnt(0)
    s_add_u32 s12, s10, 0x5a3c9671
    s_xor_b32 s13, s11, 0x2b7e1516
    s_add_u32 s52, s52, s12
    s_mov_b32 s53, s13
    v_mov_b32 v14, s12
    v_mov_b32 v15, s13
    s_bfe_u32 s40, s12, 0x80000
    v_mov_b32 v50, s40
    s_bfe_u32 s40, s12, 0x80008
    v_mov_b32 v51, s40
    s_bfe_u32 s40, s12, 0x80010
    v_mov_b32 v52, s40
    s_bfe_u32 s40, s12, 0x80018
    v_mov_b32 v53, s40
    s_setprio 3
    s_cmp_lg_u32 s62, 0
    s_cbranch_scc1 C_nox
    v_mov_b32 v12, s52
    v_mov_b32 v13, s53
    s_lshl_b32 s41, s7, 3
    s_add_u32 s40, s14, s41
    s_mov_b64 exec, 1
    buffer_store_dwordx2 v[12:13], v6, s[36:39], s40 offen sc1
    s_mov_b64 exec, -1

C_nox:

    s_cmp_lg_u32 s16, 0
    s_cbranch_scc1 C_tp1
    s_barrier
    ds_read_b128 v[130:133], v28 offset:2048
    ds_read_b64_tr_b16 v[174:175], v32 offset:8192
    ds_read_b64_tr_b16 v[176:177], v32 offset:8704
    ds_read_b128 v[142:145], v29 offset:2048
    ds_read_b64_tr_b16 v[178:179], v32 offset:12288
    ds_read_b64_tr_b16 v[180:181], v32 offset:12800
    ds_read_b128 v[134:137], v28 offset:4096
    ds_read_b128 v[146:149], v29 offset:4096
    ds_read_b64_tr_b16 v[182:183], v33 offset:8192
    ds_read_b64_tr_b16 v[184:185], v33 offset:8704
    ds_read_b64_tr_b16 v[186:187], v33 offset:12288
    ds_read_b64_tr_b16 v[188:189], v33 offset:12800
    s_waitcnt lgkmcnt(9)
    v_mfma_f32_16x16x32_bf16 v[62:65], v[174:177], v[130:133], 0
    ds_read_b128 v[126:129], v28 offset:0
    s_waitcnt lgkmcnt(7)
    v_mfma_f32_16x16x32_bf16 v[62:65], v[178:181], v[142:145], v[62:65]
    ds_read_b64_tr_b16 v[190:191], v32 offset:16384
    ds_read_b64_tr_b16 v[192:193], v32 offset:16896
    s_waitcnt lgkmcnt(8)
    v_mfma_f32_16x16x32_bf16 v[70:73], v[174:177], v[134:137], 0
    ds_read_b128 v[138:141], v29 offset:0
    ds_read_b64_tr_b16 v[194:195], v32 offset:20480
    s_waitcnt lgkmcnt(9)
    v_mfma_f32_16x16x32_bf16 v[70:73], v[178:181], v[146:149], v[70:73]
    ds_read_b64_tr_b16 v[196:197], v32 offset:20992
    s_waitcnt lgkmcnt(8)
    v_mfma_f32_16x16x32_bf16 v[66:69], v[182:185], v[130:133], 0
    ds_read_b64_tr_b16 v[174:175], v33 offset:16384
    s_waitcnt lgkmcnt(7)
    v_mfma_f32_16x16x32_bf16 v[66:69], v[186:189], v[142:145], v[66:69]
    ds_read_b64_tr_b16 v[176:177], v33 offset:16896
    v_mfma_f32_16x16x32_bf16 v[74:77], v[182:185], v[134:137], 0
    ds_read_b64_tr_b16 v[178:179], v33 offset:20480
    v_mfma_f32_16x16x32_bf16 v[74:77], v[186:189], v[146:149], v[74:77]
    ds_read_b64_tr_b16 v[180:181], v33 offset:20992
    s_waitcnt lgkmcnt(7)
    v_mfma_f32_16x16x32_bf16 v[78:81], v[190:193], v[126:129], 0
    ds_read_b64_tr_b16 v[182:183], v32 offset:24576
    s_waitcnt lgkmcnt(5)
    v_mfma_f32_16x16x32_bf16 v[78:81], v[194:197], v[138:141], v[78:81]
    ds_read_b64_tr_b16 v[184:185], v32 offset:25088
    v_mfma_f32_16x16x32_bf16 v[86:89], v[190:193], v[130:133], 0
    ds_read_b64_tr_b16 v[186:187], v32 offset:28672
    v_mfma_f32_16x16x32_bf16 v[86:89], v[194:197], v[142:145], v[86:89]
    ds_read_b64_tr_b16 v[188:189], v32 offset:29184
    v_mfma_f32_16x16x32_bf16 v[94:97], v[190:193], v[134:137], 0
    ds_read_b64_tr_b16 v[190:191], v33 offset:24576
    v_mfma_f32_16x16x32_bf16 v[94:97], v[194:197], v[146:149], v[94:97]
    ds_read_b64_tr_b16 v[192:193], v33 offset:25088
    s_waitcnt lgkmcnt(8)
    v_mfma_f32_16x16x32_bf16 v[82:85], v[174:177], v[126:129], 0
    ds_read_b64_tr_b16 v[194:195], v33 offset:28672
    s_waitcnt lgkmcnt(7)
    v_mfma_f32_16x16x32_bf16 v[82:85], v[178:181], v[138:141], v[82:85]
    ds_read_b64_tr_b16 v[196:197], v33 offset:29184
    v_mfma_f32_16x16x32_bf16 v[90:93], v[174:177], v[130:133], 0
    v_mfma_f32_16x16x32_bf16 v[90:93], v[178:181], v[142:145], v[90:93]
    v_mfma_f32_16x16x32_bf16 v[98:101], v[174:177], v[134:137], 0
    v_mfma_f32_16x16x32_bf16 v[98:101], v[178:181], v[146:149], v[98:101]
    s_waitcnt lgkmcnt(6)
    v_mfma_f32_16x16x32_bf16 v[102:105], v[126:129], v[182:185], 0
    s_waitcnt lgkmcnt(4)
    v_mfma_f32_16x16x32_bf16 v[102:105], v[138:141], v[186:189], v[102:105]
    v_mfma_f32_16x16x32_bf16 v[110:113], v[130:133], v[182:185], 0
    v_mfma_f32_16x16x32_bf16 v[110:113], v[142:145], v[186:189], v[110:113]
    s_waitcnt lgkmcnt(2)
    v_mfma_f32_16x16x32_bf16 v[106:109], v[126:129], v[190:193], 0
    s_waitcnt lgkmcnt(0)
    s_barrier
    ds_read_b128 v[154:157], v28 offset:12288
    ds_read_b64_tr_b16 v[174:175], v32 offset:32768
    ds_read_b64_tr_b16 v[176:177], v32 offset:33280
    ds_read_b128 v[166:169], v29 offset:12288
    ds_read_b64_tr_b16 v[178:179], v32 offset:36864
    ds_read_b64_tr_b16 v[180:181], v32 offset:37376
    ds_read_b128 v[158:161], v28 offset:14336
    ds_read_b128 v[170:173], v29 offset:14336
    ds_read_b64_tr_b16 v[182:183], v33 offset:32768
    ds_read_b64_tr_b16 v[184:185], v33 offset:33280
    ds_read_b64_tr_b16 v[186:187], v33 offset:36864
    ds_read_b64_tr_b16 v[188:189], v33 offset:37376
    ds_read_b128 v[150:153], v28 offset:10240
    v_mfma_f32_16x16x32_bf16 v[106:109], v[138:141], v[194:197], v[106:109]
    v_mfma_f32_16x16x32_bf16 v[114:117], v[130:133], v[190:193], 0
    ds_read_b64_tr_b16 v[190:191], v32 offset:40960
    v_mfma_f32_16x16x32_bf16 v[114:117], v[142:145], v[194:197], v[114:117]
    ds_read_b64_tr_b16 v[192:193], v32 offset:41472
    s_waitcnt lgkmcnt(12)
    v_mfma_f32_16x16x32_bf16 v[62:65], v[174:177], v[154:157], v[62:65]
    ds_read_b128 v[162:165], v29 offset:10240
    s_waitcnt lgkmcnt(10)
    v_mfma_f32_16x16x32_bf16 v[62:65], v[178:181], v[166:169], v[62:65]
    ds_read_b64_tr_b16 v[194:195], v32 offset:45056
    s_waitcnt lgkmcnt(10)
    v_mfma_f32_16x16x32_bf16 v[70:73], v[174:177], v[158:161], v[70:73]
    ds_read_b64_tr_b16 v[196:197], v32 offset:45568
    s_waitcnt lgkmcnt(10)
    v_mfma_f32_16x16x32_bf16 v[70:73], v[178:181], v[170:173], v[70:73]
    ds_read_b64_tr_b16 v[174:175], v33 offset:40960
    s_waitcnt lgkmcnt(9)
    v_mfma_f32_16x16x32_bf16 v[66:69], v[182:185], v[154:157], v[66:69]
    ds_read_b64_tr_b16 v[176:177], v33 offset:41472
    s_waitcnt lgkmcnt(8)
    v_mfma_f32_16x16x32_bf16 v[66:69], v[186:189], v[166:169], v[66:69]
    ds_read_b64_tr_b16 v[178:179], v33 offset:45056
    v_mfma_f32_16x16x32_bf16 v[74:77], v[182:185], v[158:161], v[74:77]
    ds_read_b64_tr_b16 v[180:181], v33 offset:45568
    v_mfma_f32_16x16x32_bf16 v[74:77], v[186:189], v[170:173], v[74:77]
    ds_read_b64_tr_b16 v[182:183], v34 offset:0
    s_waitcnt lgkmcnt(8)
    v_mfma_f32_16x16x32_bf16 v[78:81], v[190:193], v[150:153], v[78:81]
    ds_read_b64_tr_b16 v[184:185], v34 offset:512
    s_waitcnt lgkmcnt(6)
    v_mfma_f32_16x16x32_bf16 v[78:81], v[194:197], v[162:165], v[78:81]
    ds_read_b64_tr_b16 v[186:187], v34 offset:4096
    v_mfma_f32_16x16x32_bf16 v[86:89], v[190:193], v[154:157], v[86:89]
    ds_read_b64_tr_b16 v[188:189], v34 offset:4608
    v_mfma_f32_16x16x32_bf16 v[86:89], v[194:197], v[166:169], v[86:89]
    v_mfma_f32_16x16x32_bf16 v[94:97], v[190:193], v[158:161], v[94:97]
    ds_read_b64_tr_b16 v[190:191], v35 offset:0
    v_mfma_f32_16x16x32_bf16 v[94:97], v[194:197], v[170:173], v[94:97]
    ds_read_b64_tr_b16 v[192:193], v35 offset:512
    s_waitcnt lgkmcnt(8)
    v_mfma_f32_16x16x32_bf16 v[82:85], v[174:177], v[150:153], v[82:85]
    ds_read_b64_tr_b16 v[194:195], v35 offset:4096
    s_waitcnt lgkmcnt(7)
    v_mfma_f32_16x16x32_bf16 v[82:85], v[178:181], v[162:165], v[82:85]
    ds_read_b64_tr_b16 v[196:197], v35 offset:4608
    v_mfma_f32_16x16x32_bf16 v[90:93], v[174:177], v[154:157], v[90:93]
    v_mfma_f32_16x16x32_bf16 v[90:93], v[178:181], v[166:169], v[90:93]
    v_mfma_f32_16x16x32_bf16 v[98:101], v[174:177], v[158:161], v[98:101]
    v_mfma_f32_16x16x32_bf16 v[98:101], v[178:181], v[170:173], v[98:101]
    s_waitcnt lgkmcnt(6)
    v_mfma_f32_16x16x32_bf16 v[102:105], v[150:153], v[182:185], v[102:105]
    s_waitcnt lgkmcnt(4)
    v_mfma_f32_16x16x32_bf16 v[102:105], v[162:165], v[186:189], v[102:105]
    v_mfma_f32_16x16x32_bf16 v[110:113], v[154:157], v[182:185], v[110:113]
    v_mfma_f32_16x16x32_bf16 v[110:113], v[166:169], v[186:189], v[110:113]
    s_waitcnt lgkmcnt(2)
    v_mfma_f32_16x16x32_bf16 v[106:109], v[150:153], v[190:193], v[106:109]
    s_waitcnt lgkmcnt(0)
    s_barrier
    ds_read_b128 v[130:133], v28 offset:22528
    ds_read_b64_tr_b16 v[174:175], v34 offset:8192
    ds_read_b64_tr_b16 v[176:177], v34 offset:8704
    ds_read_b128 v[142:145], v29 offset:22528
    ds_read_b64_tr_b16 v[178:179], v34 offset:12288
    ds_read_b64_tr_b16 v[180:181], v34 offset:12800
    ds_read_b128 v[134:137], v28 offset:24576
    ds_read_b128 v[146:149], v29 offset:24576
    ds_read_b64_tr_b16 v[182:183], v35 offset:8192
    ds_read_b64_tr_b16 v[184:185], v35 offset:8704
    ds_read_b64_tr_b16 v[186:187], v35 offset:12288
    ds_read_b64_tr_b16 v[188:189], v35 offset:12800
    ds_read_b128 v[126:129], v28 offset:20480
    v_mfma_f32_16x16x32_bf16 v[106:109], v[162:165], v[194:197], v[106:109]
    v_mfma_f32_16x16x32_bf16 v[114:117], v[154:157], v[190:193], v[114:117]
    ds_read_b64_tr_b16 v[190:191], v34 offset:16384
    v_mfma_f32_16x16x32_bf16 v[114:117], v[166:169], v[194:197], v[114:117]
    ds_read_b64_tr_b16 v[192:193], v34 offset:16896
    s_waitcnt lgkmcnt(12)
    v_mfma_f32_16x16x32_bf16 v[62:65], v[174:177], v[130:133], v[62:65]
    ds_read_b128 v[138:141], v29 offset:20480
    s_waitcnt lgkmcnt(10)
    v_mfma_f32_16x16x32_bf16 v[62:65], v[178:181], v[142:145], v[62:65]
    ds_read_b64_tr_b16 v[194:195], v34 offset:20480
    s_waitcnt lgkmcnt(10)
    v_mfma_f32_16x16x32_bf16 v[70:73], v[174:177], v[134:137], v[70:73]
    ds_read_b64_tr_b16 v[196:197], v34 offset:20992
    s_waitcnt lgkmcnt(10)
    v_mfma_f32_16x16x32_bf16 v[70:73], v[178:181], v[146:149], v[70:73]
    ds_read_b64_tr_b16 v[174:175], v35 offset:16384
    s_waitcnt lgkmcnt(9)
    v_mfma_f32_16x16x32_bf16 v[66:69], v[182:185], v[130:133], v[66:69]
    ds_read_b64_tr_b16 v[176:177], v35 offset:16896
    s_waitcnt lgkmcnt(8)
    v_mfma_f32_16x16x32_bf16 v[66:69], v[186:189], v[142:145], v[66:69]
    ds_read_b64_tr_b16 v[178:179], v35 offset:20480
    v_mfma_f32_16x16x32_bf16 v[74:77], v[182:185], v[134:137], v[74:77]
    ds_read_b64_tr_b16 v[180:181], v35 offset:20992
    v_mfma_f32_16x16x32_bf16 v[74:77], v[186:189], v[146:149], v[74:77]
    ds_read_b64_tr_b16 v[182:183], v34 offset:24576
    s_waitcnt lgkmcnt(8)
    v_mfma_f32_16x16x32_bf16 v[78:81], v[190:193], v[126:129], v[78:81]
    ds_read_b64_tr_b16 v[184:185], v34 offset:25088
    s_waitcnt lgkmcnt(6)
    v_mfma_f32_16x16x32_bf16 v[78:81], v[194:197], v[138:141], v[78:81]
    ds_read_b64_tr_b16 v[186:187], v34 offset:28672
    v_mfma_f32_16x16x32_bf16 v[86:89], v[190:193], v[130:133], v[86:89]
    ds_read_b64_tr_b16 v[188:189], v34 offset:29184
    v_mfma_f32_16x16x32_bf16 v[86:89], v[194:197], v[142:145], v[86:89]
    v_mfma_f32_16x16x32_bf16 v[94:97], v[190:193], v[134:137], v[94:97]
    ds_read_b64_tr_b16 v[190:191], v35 offset:24576
    v_mfma_f32_16x16x32_bf16 v[94:97], v[194:197], v[146:149], v[94:97]
    ds_read_b64_tr_b16 v[192:193], v35 offset:25088
    s_waitcnt lgkmcnt(8)
    v_mfma_f32_16x16x32_bf16 v[82:85], v[174:177], v[126:129], v[82:85]
    ds_read_b64_tr_b16 v[194:195], v35 offset:28672
    s_waitcnt lgkmcnt(7)
    v_mfma_f32_16x16x32_bf16 v[82:85], v[178:181], v[138:141], v[82:85]
    ds_read_b64_tr_b16 v[196:197], v35 offset:29184
    v_mfma_f32_16x16x32_bf16 v[90:93], v[174:177], v[130:133], v[90:93]
    v_mfma_f32_16x16x32_bf16 v[90:93], v[178:181], v[142:145], v[90:93]
    v_mfma_f32_16x16x32_bf16 v[98:101], v[174:177], v[134:137], v[98:101]
    v_mfma_f32_16x16x32_bf16 v[98:101], v[178:181], v[146:149], v[98:101]
    s_waitcnt lgkmcnt(6)
    v_mfma_f32_16x16x32_bf16 v[102:105], v[126:129], v[182:185], v[102:105]
    s_waitcnt lgkmcnt(4)
    v_mfma_f32_16x16x32_bf16 v[102:105], v[138:141], v[186:189], v[102:105]
    v_mfma_f32_16x16x32_bf16 v[110:113], v[130:133], v[182:185], v[110:113]
    v_mfma_f32_16x16x32_bf16 v[110:113], v[142:145], v[186:189], v[110:113]
    s_waitcnt lgkmcnt(2)
    v_mfma_f32_16x16x32_bf16 v[106:109], v[126:129], v[190:193], v[106:109]
    s_waitcnt lgkmcnt(0)
    s_barrier
    ds_read_b128 v[154:157], v28 offset:32768
    ds_read_b64_tr_b16 v[174:175], v34 offset:32768
    ds_read_b64_tr_b16 v[176:177], v34 offset:33280
    ds_read_b128 v[166:169], v29 offset:32768
    ds_read_b64_tr_b16 v[178:179], v34 offset:36864
    ds_read_b64_tr_b16 v[180:181], v34 offset:37376
    ds_read_b128 v[158:161], v28 offset:34816
    ds_read_b128 v[170:173], v29 offset:34816
    ds_read_b64_tr_b16 v[182:183], v35 offset:32768
    ds_read_b64_tr_b16 v[184:185], v35 offset:33280
    ds_read_b64_tr_b16 v[186:187], v35 offset:36864
    ds_read_b64_tr_b16 v[188:189], v35 offset:37376
    ds_read_b128 v[150:153], v28 offset:30720
    v_mfma_f32_16x16x32_bf16 v[106:109], v[138:141], v[194:197], v[106:109]
    v_mfma_f32_16x16x32_bf16 v[114:117], v[130:133], v[190:193], v[114:117]
    ds_read_b64_tr_b16 v[190:191], v32 offset:0
    v_mfma_f32_16x16x32_bf16 v[114:117], v[142:145], v[194:197], v[114:117]
    ds_read_b64_tr_b16 v[192:193], v32 offset:512
    s_waitcnt lgkmcnt(12)
    v_mfma_f32_16x16x32_bf16 v[62:65], v[174:177], v[154:157], v[62:65]
    ds_read_b128 v[162:165], v29 offset:30720
    s_waitcnt lgkmcnt(10)
    v_mfma_f32_16x16x32_bf16 v[62:65], v[178:181], v[166:169], v[62:65]
    ds_read_b64_tr_b16 v[194:195], v32 offset:4096
    s_waitcnt lgkmcnt(10)
    v_mfma_f32_16x16x32_bf16 v[70:73], v[174:177], v[158:161], v[70:73]
    ds_read_b64_tr_b16 v[196:197], v32 offset:4608
    s_waitcnt lgkmcnt(10)
    v_mfma_f32_16x16x32_bf16 v[70:73], v[178:181], v[170:173], v[70:73]
    ds_read_b64_tr_b16 v[174:175], v33 offset:0
    s_waitcnt lgkmcnt(9)
    v_mfma_f32_16x16x32_bf16 v[66:69], v[182:185], v[154:157], v[66:69]
    ds_read_b64_tr_b16 v[176:177], v33 offset:512
    s_waitcnt lgkmcnt(8)
    v_mfma_f32_16x16x32_bf16 v[66:69], v[186:189], v[166:169], v[66:69]
    ds_read_b64_tr_b16 v[178:179], v33 offset:4096
    v_mfma_f32_16x16x32_bf16 v[74:77], v[182:185], v[158:161], v[74:77]
    ds_read_b64_tr_b16 v[180:181], v33 offset:4608
    v_mfma_f32_16x16x32_bf16 v[74:77], v[186:189], v[170:173], v[74:77]
    ds_read_b64_tr_b16 v[182:183], v32 offset:8192
    s_waitcnt lgkmcnt(8)
    v_mfma_f32_16x16x32_bf16 v[78:81], v[190:193], v[150:153], v[78:81]
    ds_read_b64_tr_b16 v[184:185], v32 offset:8704
    s_waitcnt lgkmcnt(6)
    v_mfma_f32_16x16x32_bf16 v[78:81], v[194:197], v[162:165], v[78:81]
    ds_read_b64_tr_b16 v[186:187], v32 offset:12288
    v_mfma_f32_16x16x32_bf16 v[86:89], v[190:193], v[154:157], v[86:89]
    ds_read_b64_tr_b16 v[188:189], v32 offset:12800
    v_mfma_f32_16x16x32_bf16 v[86:89], v[194:197], v[166:169], v[86:89]
    v_mfma_f32_16x16x32_bf16 v[94:97], v[190:193], v[158:161], v[94:97]
    ds_read_b64_tr_b16 v[190:191], v33 offset:8192
    v_mfma_f32_16x16x32_bf16 v[94:97], v[194:197], v[170:173], v[94:97]
    ds_read_b64_tr_b16 v[192:193], v33 offset:8704
    s_waitcnt lgkmcnt(8)
    v_mfma_f32_16x16x32_bf16 v[82:85], v[174:177], v[150:153], v[82:85]
    ds_read_b64_tr_b16 v[194:195], v33 offset:12288
    s_waitcnt lgkmcnt(7)
    v_mfma_f32_16x16x32_bf16 v[82:85], v[178:181], v[162:165], v[82:85]
    ds_read_b64_tr_b16 v[196:197], v33 offset:12800
    v_mfma_f32_16x16x32_bf16 v[90:93], v[174:177], v[154:157], v[90:93]
    v_mfma_f32_16x16x32_bf16 v[90:93], v[178:181], v[166:169], v[90:93]
    v_mfma_f32_16x16x32_bf16 v[98:101], v[174:177], v[158:161], v[98:101]
    v_mfma_f32_16x16x32_bf16 v[98:101], v[178:181], v[170:173], v[98:101]
    s_waitcnt lgkmcnt(6)
    v_mfma_f32_16x16x32_bf16 v[102:105], v[150:153], v[182:185], v[102:105]
    s_waitcnt lgkmcnt(4)
    v_mfma_f32_16x16x32_bf16 v[102:105], v[162:165], v[186:189], v[102:105]
    v_mfma_f32_16x16x32_bf16 v[110:113], v[154:157], v[182:185], v[110:113]
    v_mfma_f32_16x16x32_bf16 v[110:113], v[166:169], v[186:189], v[110:113]
    s_waitcnt lgkmcnt(2)
    v_mfma_f32_16x16x32_bf16 v[106:109], v[150:153], v[190:193], v[106:109]
    s_waitcnt lgkmcnt(0)
    s_barrier
    ds_read_b128 v[130:133], v30 offset:2048
    ds_read_b64_tr_b16 v[174:175], v32 offset:16384
    ds_read_b64_tr_b16 v[176:177], v32 offset:16896
    ds_read_b128 v[142:145], v31 offset:2048
    ds_read_b64_tr_b16 v[178:179], v32 offset:20480
    ds_read_b64_tr_b16 v[180:181], v32 offset:20992
    ds_read_b128 v[134:137], v30 offset:4096
    ds_read_b128 v[146:149], v31 offset:4096
    ds_read_b64_tr_b16 v[182:183], v33 offset:16384
    ds_read_b64_tr_b16 v[184:185], v33 offset:16896
    ds_read_b64_tr_b16 v[186:187], v33 offset:20480
    ds_read_b64_tr_b16 v[188:189], v33 offset:20992
    ds_read_b128 v[126:129], v30 offset:0
    v_mfma_f32_16x16x32_bf16 v[106:109], v[162:165], v[194:197], v[106:109]
    v_mfma_f32_16x16x32_bf16 v[114:117], v[154:157], v[190:193], v[114:117]
    ds_read_b64_tr_b16 v[190:191], v32 offset:24576
    v_mfma_f32_16x16x32_bf16 v[114:117], v[166:169], v[194:197], v[114:117]
    ds_read_b64_tr_b16 v[192:193], v32 offset:25088
    s_waitcnt lgkmcnt(12)
    v_mfma_f32_16x16x32_bf16 v[62:65], v[174:177], v[130:133], v[62:65]
    ds_read_b128 v[138:141], v31 offset:0
    s_waitcnt lgkmcnt(10)
    v_mfma_f32_16x16x32_bf16 v[62:65], v[178:181], v[142:145], v[62:65]
    ds_read_b64_tr_b16 v[194:195], v32 offset:28672
    s_waitcnt lgkmcnt(10)
    v_mfma_f32_16x16x32_bf16 v[70:73], v[174:177], v[134:137], v[70:73]
    ds_read_b64_tr_b16 v[196:197], v32 offset:29184
    s_waitcnt lgkmcnt(10)
    v_mfma_f32_16x16x32_bf16 v[70:73], v[178:181], v[146:149], v[70:73]
    ds_read_b64_tr_b16 v[174:175], v33 offset:24576
    s_waitcnt lgkmcnt(9)
    v_mfma_f32_16x16x32_bf16 v[66:69], v[182:185], v[130:133], v[66:69]
    ds_read_b64_tr_b16 v[176:177], v33 offset:25088
    s_waitcnt lgkmcnt(8)
    v_mfma_f32_16x16x32_bf16 v[66:69], v[186:189], v[142:145], v[66:69]
    ds_read_b64_tr_b16 v[178:179], v33 offset:28672
    v_mfma_f32_16x16x32_bf16 v[74:77], v[182:185], v[134:137], v[74:77]
    ds_read_b64_tr_b16 v[180:181], v33 offset:29184
    v_mfma_f32_16x16x32_bf16 v[74:77], v[186:189], v[146:149], v[74:77]
    ds_read_b64_tr_b16 v[182:183], v32 offset:32768
    s_waitcnt lgkmcnt(8)
    v_mfma_f32_16x16x32_bf16 v[78:81], v[190:193], v[126:129], v[78:81]
    ds_read_b64_tr_b16 v[184:185], v32 offset:33280
    s_waitcnt lgkmcnt(6)
    v_mfma_f32_16x16x32_bf16 v[78:81], v[194:197], v[138:141], v[78:81]
    ds_read_b64_tr_b16 v[186:187], v32 offset:36864
    v_mfma_f32_16x16x32_bf16 v[86:89], v[190:193], v[130:133], v[86:89]
    ds_read_b64_tr_b16 v[188:189], v32 offset:37376
    v_mfma_f32_16x16x32_bf16 v[86:89], v[194:197], v[142:145], v[86:89]
    v_mfma_f32_16x16x32_bf16 v[94:97], v[190:193], v[134:137], v[94:97]
    ds_read_b64_tr_b16 v[190:191], v33 offset:32768
    v_mfma_f32_16x16x32_bf16 v[94:97], v[194:197], v[146:149], v[94:97]
    ds_read_b64_tr_b16 v[192:193], v33 offset:33280
    s_waitcnt lgkmcnt(8)
    v_mfma_f32_16x16x32_bf16 v[82:85], v[174:177], v[126:129], v[82:85]
    ds_read_b64_tr_b16 v[194:195], v33 offset:36864
    s_waitcnt lgkmcnt(7)
    v_mfma_f32_16x16x32_bf16 v[82:85], v[178:181], v[138:141], v[82:85]
    ds_read_b64_tr_b16 v[196:197], v33 offset:37376
    v_mfma_f32_16x16x32_bf16 v[90:93], v[174:177], v[130:133], v[90:93]
    v_mfma_f32_16x16x32_bf16 v[90:93], v[178:181], v[142:145], v[90:93]
    v_mfma_f32_16x16x32_bf16 v[98:101], v[174:177], v[134:137], v[98:101]
    v_mfma_f32_16x16x32_bf16 v[98:101], v[178:181], v[146:149], v[98:101]
    s_waitcnt lgkmcnt(6)
    v_mfma_f32_16x16x32_bf16 v[102:105], v[126:129], v[182:185], v[102:105]
    s_waitcnt lgkmcnt(4)
    v_mfma_f32_16x16x32_bf16 v[102:105], v[138:141], v[186:189], v[102:105]
    v_mfma_f32_16x16x32_bf16 v[110:113], v[130:133], v[182:185], v[110:113]
    v_mfma_f32_16x16x32_bf16 v[110:113], v[142:145], v[186:189], v[110:113]
    s_waitcnt lgkmcnt(2)
    v_mfma_f32_16x16x32_bf16 v[106:109], v[126:129], v[190:193], v[106:109]
    s_waitcnt lgkmcnt(0)
    s_barrier
    ds_read_b128 v[154:157], v30 offset:12288
    ds_read_b64_tr_b16 v[174:175], v32 offset:40960
    ds_read_b64_tr_b16 v[176:177], v32 offset:41472
    ds_read_b128 v[166:169], v31 offset:12288
    ds_read_b64_tr_b16 v[178:179], v32 offset:45056
    ds_read_b64_tr_b16 v[180:181], v32 offset:45568
    ds_read_b128 v[158:161], v30 offset:14336
    ds_read_b128 v[170:173], v31 offset:14336
    ds_read_b64_tr_b16 v[182:183], v33 offset:40960
    ds_read_b64_tr_b16 v[184:185], v33 offset:41472
    ds_read_b64_tr_b16 v[186:187], v33 offset:45056
    ds_read_b64_tr_b16 v[188:189], v33 offset:45568
    ds_read_b128 v[150:153], v30 offset:10240
    v_mfma_f32_16x16x32_bf16 v[106:109], v[138:141], v[194:197], v[106:109]
    ds_read_b64_tr_b16 v[198:199], v34 offset:0
    v_mfma_f32_16x16x32_bf16 v[114:117], v[130:133], v[190:193], v[114:117]
    ds_read_b64_tr_b16 v[200:201], v34 offset:512
    v_mfma_f32_16x16x32_bf16 v[114:117], v[142:145], v[194:197], v[114:117]
    ds_read_b128 v[162:165], v31 offset:10240
    s_waitcnt lgkmcnt(13)
    v_mfma_f32_16x16x32_bf16 v[62:65], v[174:177], v[154:157], v[62:65]
    ds_read_b64_tr_b16 v[202:203], v34 offset:4096
    s_waitcnt lgkmcnt(11)
    v_mfma_f32_16x16x32_bf16 v[62:65], v[178:181], v[166:169], v[62:65]
    ds_read_b64_tr_b16 v[204:205], v34 offset:4608
    s_waitcnt lgkmcnt(11)
    v_mfma_f32_16x16x32_bf16 v[70:73], v[174:177], v[158:161], v[70:73]
    ds_read_b64_tr_b16 v[190:191], v35 offset:0
    s_waitcnt lgkmcnt(11)
    v_mfma_f32_16x16x32_bf16 v[70:73], v[178:181], v[170:173], v[70:73]
    ds_read_b64_tr_b16 v[192:193], v35 offset:512
    s_waitcnt lgkmcnt(10)
    v_mfma_f32_16x16x32_bf16 v[66:69], v[182:185], v[154:157], v[66:69]
    ds_read_b64_tr_b16 v[194:195], v35 offset:4096
    s_waitcnt lgkmcnt(9)
    v_mfma_f32_16x16x32_bf16 v[66:69], v[186:189], v[166:169], v[66:69]
    ds_read_b64_tr_b16 v[196:197], v35 offset:4608
    v_mfma_f32_16x16x32_bf16 v[74:77], v[182:185], v[158:161], v[74:77]
    v_mfma_f32_16x16x32_bf16 v[74:77], v[186:189], v[170:173], v[74:77]
    s_waitcnt lgkmcnt(7)
    v_mfma_f32_16x16x32_bf16 v[78:81], v[198:201], v[150:153], v[78:81]
    s_waitcnt lgkmcnt(4)
    v_mfma_f32_16x16x32_bf16 v[78:81], v[202:205], v[162:165], v[78:81]
    v_mfma_f32_16x16x32_bf16 v[86:89], v[198:201], v[154:157], v[86:89]
    v_mfma_f32_16x16x32_bf16 v[86:89], v[202:205], v[166:169], v[86:89]
    v_mfma_f32_16x16x32_bf16 v[94:97], v[198:201], v[158:161], v[94:97]
    v_mfma_f32_16x16x32_bf16 v[94:97], v[202:205], v[170:173], v[94:97]
    s_waitcnt lgkmcnt(2)
    v_mfma_f32_16x16x32_bf16 v[82:85], v[190:193], v[150:153], v[82:85]
    s_waitcnt lgkmcnt(0)
    v_mfma_f32_16x16x32_bf16 v[82:85], v[194:197], v[162:165], v[82:85]
    v_mfma_f32_16x16x32_bf16 v[90:93], v[190:193], v[154:157], v[90:93]
    v_mfma_f32_16x16x32_bf16 v[90:93], v[194:197], v[166:169], v[90:93]
    v_mfma_f32_16x16x32_bf16 v[98:101], v[190:193], v[158:161], v[98:101]
    s_barrier
    ds_read_b128 v[134:137], v30 offset:24576
    ds_read_b64_tr_b16 v[174:175], v34 offset:16384
    ds_read_b64_tr_b16 v[176:177], v34 offset:16896
    ds_read_b128 v[146:149], v31 offset:24576
    ds_read_b64_tr_b16 v[178:179], v34 offset:20480
    ds_read_b64_tr_b16 v[180:181], v34 offset:20992
    ds_read_b64_tr_b16 v[182:183], v35 offset:16384
    ds_read_b64_tr_b16 v[184:185], v35 offset:16896
    ds_read_b64_tr_b16 v[186:187], v35 offset:20480
    ds_read_b64_tr_b16 v[188:189], v35 offset:20992
    ds_read_b128 v[130:133], v30 offset:22528
    ds_read_b64_tr_b16 v[198:199], v34 offset:8192
    ds_read_b64_tr_b16 v[200:201], v34 offset:8704
    ds_read_b128 v[142:145], v31 offset:22528
    ds_read_b64_tr_b16 v[202:203], v34 offset:12288
    ds_read_b64_tr_b16 v[204:205], v34 offset:12800
    ds_read_b64_tr_b16 v[190:191], v35 offset:8192
    v_mfma_f32_16x16x32_bf16 v[98:101], v[194:197], v[170:173], v[98:101]
    ds_read_b64_tr_b16 v[192:193], v35 offset:8704
    s_waitcnt lgkmcnt(15)
    v_mfma_f32_16x16x32_bf16 v[94:97], v[174:177], v[134:137], v[94:97]
    ds_read_b64_tr_b16 v[194:195], v35 offset:12288
    s_waitcnt lgkmcnt(13)
    v_mfma_f32_16x16x32_bf16 v[94:97], v[178:181], v[146:149], v[94:97]
    ds_read_b64_tr_b16 v[196:197], v35 offset:12800
    s_waitcnt lgkmcnt(12)
    v_mfma_f32_16x16x32_bf16 v[98:101], v[182:185], v[134:137], v[98:101]
    ds_read_b128 v[126:129], v30 offset:20480
    s_waitcnt lgkmcnt(11)
    v_mfma_f32_16x16x32_bf16 v[98:101], v[186:189], v[146:149], v[98:101]
    ds_read_b128 v[138:141], v31 offset:20480
    s_waitcnt lgkmcnt(9)
    v_mfma_f32_16x16x32_bf16 v[62:65], v[198:201], v[130:133], v[62:65]
    s_waitcnt lgkmcnt(6)
    v_mfma_f32_16x16x32_bf16 v[62:65], v[202:205], v[142:145], v[62:65]
    v_mfma_f32_16x16x32_bf16 v[70:73], v[198:201], v[134:137], v[70:73]
    v_cvt_pk_bf16_f32 v234, v94, v95
    v_cvt_pk_bf16_f32 v235, v96, v97
    v_cvt_pk_bf16_f32 v236, v98, v99
    v_mfma_f32_16x16x32_bf16 v[70:73], v[202:205], v[146:149], v[70:73]
    v_cvt_pk_bf16_f32 v237, v100, v101
    ds_write_b128 v218, v[234:237]
    ds_write_b32 v220, v5 offset:56
    s_waitcnt lgkmcnt(6)
    v_mfma_f32_16x16x32_bf16 v[66:69], v[190:193], v[130:133], v[66:69]
    v_cvt_pk_bf16_f32 v150, v62, v63
    v_cvt_pk_bf16_f32 v151, v64, v65
    s_waitcnt lgkmcnt(4)
    v_mfma_f32_16x16x32_bf16 v[66:69], v[194:197], v[142:145], v[66:69]
    v_cndmask_b32 v158, 0, v150, s[54:55]
    v_cndmask_b32 v150, v150, 0, s[54:55]
    v_mfma_f32_16x16x32_bf16 v[74:77], v[190:193], v[134:137], v[74:77]
    v_cndmask_b32 v159, 0, v151, s[54:55]
    v_cndmask_b32 v151, v151, 0, s[54:55]
    v_mfma_f32_16x16x32_bf16 v[74:77], v[194:197], v[146:149], v[74:77]
    v_cvt_pk_bf16_f32 v154, v70, v71
    v_cvt_pk_bf16_f32 v155, v72, v73
    s_waitcnt lgkmcnt(3)
    v_mfma_f32_16x16x32_bf16 v[78:81], v[174:177], v[126:129], v[78:81]
    v_cndmask_b32 v162, 0, v154, s[54:55]
    v_cndmask_b32 v154, v154, 0, s[54:55]
    s_waitcnt lgkmcnt(2)
    v_mfma_f32_16x16x32_bf16 v[78:81], v[178:181], v[138:141], v[78:81]
    v_cndmask_b32 v163, 0, v155, s[54:55]
    v_cndmask_b32 v155, v155, 0, s[54:55]
    v_mfma_f32_16x16x32_bf16 v[82:85], v[182:185], v[126:129], v[82:85]
    v_cvt_pk_bf16_f32 v152, v66, v67
    v_cvt_pk_bf16_f32 v153, v68, v69
    v_mfma_f32_16x16x32_bf16 v[82:85], v[186:189], v[138:141], v[82:85]
    v_cndmask_b32 v160, 0, v152, s[56:57]
    v_cndmask_b32 v152, v152, 0, s[56:57]
    v_mfma_f32_16x16x32_bf16 v[86:89], v[174:177], v[130:133], v[86:89]
    v_cndmask_b32 v161, 0, v153, s[56:57]
    v_cndmask_b32 v153, v153, 0, s[56:57]
    v_mfma_f32_16x16x32_bf16 v[86:89], v[178:181], v[142:145], v[86:89]
    v_cvt_pk_bf16_f32 v156, v74, v75
    v_cvt_pk_bf16_f32 v157, v76, v77
    v_mfma_f32_16x16x32_bf16 v[90:93], v[182:185], v[130:133], v[90:93]
    v_cndmask_b32 v164, 0, v156, s[56:57]
    v_cndmask_b32 v156, v156, 0, s[56:57]
    v_mfma_f32_16x16x32_bf16 v[90:93], v[186:189], v[142:145], v[90:93]
    ds_read_b32 v40, v5 offset:4
    v_cndmask_b32 v165, 0, v157, s[56:57]
    v_cndmask_b32 v157, v157, 0, s[56:57]
    v_cvt_pk_bf16_f32 v226, v78, v79
    v_cvt_pk_bf16_f32 v227, v80, v81
    v_cvt_pk_bf16_f32 v228, v82, v83
    v_cvt_pk_bf16_f32 v229, v84, v85
    s_nop 1
    v_mfma_f32_16x16x32_bf16 v[62:65], v[226:229], v[150:153], 0
    v_mfma_f32_16x16x32_bf16 v[74:77], v[234:237], v[154:157], 0
    v_cvt_pk_bf16_f32 v230, v86, v87
    v_cvt_pk_bf16_f32 v231, v88, v89
    v_cvt_pk_bf16_f32 v232, v90, v91
    v_cvt_pk_bf16_f32 v233, v92, v93
    s_nop 1
    v_mfma_f32_16x16x32_bf16 v[66:69], v[230:233], v[150:153], 0
    v_mfma_f32_16x16x32_bf16 v[70:73], v[230:233], v[154:157], 0
    v_mfma_f32_16x16x32_bf16 v[174:177], v[226:229], v[158:161], 0
    v_mfma_f32_16x16x32_bf16 v[178:181], v[230:233], v[158:161], 0
    v_mfma_f32_16x16x32_bf16 v[182:185], v[230:233], v[162:165], 0
    v_mfma_f32_16x16x32_bf16 v[186:189], v[234:237], v[162:165], 0
    s_waitcnt lgkmcnt(0)
    v_readfirstlane_b32 s63, v40
    s_nop 0
    v_cndmask_b32 v66, v66, v67, s[44:45]
    ds_read_b32 v40, v5 offset:32
    v_cndmask_b32 v68, v68, v69, s[44:45]
    ds_read_b64_tr_b16 v[166:167], v34 offset:32768
    v_cndmask_b32 v62, v62, v63, s[44:45]
    ds_read_b64_tr_b16 v[168:169], v34 offset:33280
    v_cndmask_b32 v64, v64, v65, s[44:45]
    ds_read_b64_tr_b16 v[170:171], v35 offset:32768
    v_cndmask_b32 v62, v62, v45, s[50:51]
    ds_read_b64_tr_b16 v[172:173], v35 offset:33280
    v_cndmask_b32 v64, v64, v45, s[50:51]
    ds_read_b64_tr_b16 v[198:199], v34 offset:36864
    v_cndmask_b32 v210, v62, v66, s[46:47]
    ds_read_b64_tr_b16 v[200:201], v34 offset:37376
    v_cndmask_b32 v211, v64, v68, s[48:49]
    ds_read_b64_tr_b16 v[202:203], v35 offset:36864
    v_cndmask_b32 v74, v74, v75, s[44:45]
    ds_read_b64_tr_b16 v[204:205], v35 offset:37376
    v_cndmask_b32 v76, v76, v77, s[44:45]
    v_cndmask_b32 v70, v70, v71, s[44:45]
    v_cndmask_b32 v72, v72, v73, s[44:45]
    v_cndmask_b32 v212, v70, v74, s[46:47]
    v_cndmask_b32 v213, v72, v76, s[48:49]
    v_and_or_b32 v94, v210, v46, v50
    v_and_or_b32 v95, v211, v46, v51
    v_and_or_b32 v96, v212, v46, v52
    v_and_or_b32 v97, v213, v46, v53
    s_sub_u32 s63, s63, 1
    s_cbranch_scc1 C_mr0
C_md0:
    s_cmp_lg_u32 s101, 0
    s_cbranch_scc1 SM_jS0
    s_cmp_eq_u32 s63, 0
    s_cbranch_scc1 SM_sS0
    buffer_store_dwordx4 v[94:97], v4, s[36:39], s15 offen
SM_jS0:
    v_cndmask_b32 v178, v178, v179, s[44:45]
    v_cndmask_b32 v180, v180, v181, s[44:45]
    v_cndmask_b32 v174, v174, v175, s[44:45]
    v_cndmask_b32 v176, v176, v177, s[44:45]
    v_cndmask_b32 v174, v174, v45, s[50:51]
    v_cndmask_b32 v176, v176, v45, s[50:51]
    v_cndmask_b32 v206, v174, v178, s[46:47]
    v_cndmask_b32 v207, v176, v180, s[48:49]
    v_cndmask_b32 v186, v186, v187, s[44:45]
    v_cndmask_b32 v188, v188, v189, s[44:45]
    v_cndmask_b32 v182, v182, v183, s[44:45]
    v_cndmask_b32 v184, v184, v185, s[44:45]
    v_cndmask_b32 v208, v182, v186, s[46:47]
    v_cndmask_b32 v209, v184, v188, s[48:49]
    ds_write_b128 v42, v[206:209]
    ds_write_b32 v47, v5 offset:16
    s_waitcnt lgkmcnt(10)
    v_cmp_gt_u32 vcc, 4, v40
    s_nop 0
    s_cbranch_vccnz C_vr0
C_vd0:
    s_waitcnt lgkmcnt(8)
    v_mfma_f32_16x16x32_bf16 v[102:105], v[126:129], v[166:169], v[102:105]
    ds_read_b128 v[150:153], v30 offset:10240
    ds_read_b64_tr_b16 v[182:183], v34 offset:24576
    s_waitcnt lgkmcnt(6)
    v_mfma_f32_16x16x32_bf16 v[102:105], v[138:141], v[198:201], v[102:105]
    ds_read_b64_tr_b16 v[184:185], v34 offset:25088
    ds_read_b128 v[162:165], v31 offset:10240
    v_mfma_f32_16x16x32_bf16 v[110:113], v[130:133], v[166:169], v[110:113]
    ds_read_b64_tr_b16 v[190:191], v34 offset:28672
    ds_read_b64_tr_b16 v[192:193], v34 offset:29184
    v_mfma_f32_16x16x32_bf16 v[110:113], v[142:145], v[198:201], v[110:113]
    ds_read_b64_tr_b16 v[186:187], v35 offset:24576
    ds_read_b64_tr_b16 v[188:189], v35 offset:25088
    v_mfma_f32_16x16x32_bf16 v[106:109], v[126:129], v[170:173], v[106:109]
    ds_read_b64_tr_b16 v[194:195], v35 offset:28672
    ds_read_b64_tr_b16 v[196:197], v35 offset:29184
    s_waitcnt lgkmcnt(12)
    v_mfma_f32_16x16x32_bf16 v[106:109], v[138:141], v[202:205], v[106:109]
    ds_read_b128 v[154:157], v30 offset:12288
    ds_read_b128 v[174:177], v31 offset:12288
    v_mfma_f32_16x16x32_bf16 v[114:117], v[130:133], v[170:173], v[114:117]
    v_mfma_f32_16x16x32_bf16 v[114:117], v[142:145], v[202:205], v[114:117]
    s_waitcnt lgkmcnt(9)
    v_mfma_f32_16x16x32_bf16 v[102:105], v[150:153], v[182:185], v[102:105]
    s_waitcnt lgkmcnt(6)
    v_mfma_f32_16x16x32_bf16 v[102:105], v[162:165], v[190:193], v[102:105]
    s_waitcnt lgkmcnt(4)
    v_mfma_f32_16x16x32_bf16 v[106:109], v[150:153], v[186:189], v[106:109]
    s_waitcnt lgkmcnt(2)
    v_mfma_f32_16x16x32_bf16 v[106:109], v[162:165], v[194:197], v[106:109]
    s_waitcnt lgkmcnt(1)
    v_mfma_f32_16x16x32_bf16 v[110:113], v[154:157], v[182:185], v[110:113]
    s_nop 1
    v_cvt_pk_bf16_f32 v226, v102, v103
    v_cvt_pk_bf16_f32 v227, v104, v105
    s_waitcnt lgkmcnt(0)
    v_mfma_f32_16x16x32_bf16 v[110:113], v[174:177], v[190:193], v[110:113]
    v_mfma_f32_16x16x32_bf16 v[114:117], v[154:157], v[186:189], v[114:117]
    v_cvt_pk_bf16_f32 v232, v106, v107
    v_cvt_pk_bf16_f32 v233, v108, v109
    v_mfma_f32_16x16x32_bf16 v[114:117], v[174:177], v[194:197], v[114:117]
    ds_read_b32 v48, v221 offset:68
    ds_read_b64 v[230:231], v219 offset:0
    ds_read_b64 v[236:237], v219 offset:8
    v_cndmask_b32 v126, 0, v226, s[58:59]
    v_cndmask_b32 v226, v226, 0, s[58:59]
    v_cndmask_b32 v127, 0, v227, s[58:59]
    v_cndmask_b32 v227, v227, 0, s[58:59]
    buffer_load_dwordx4 v[214:217], v4, s[36:39], s100 offen sc1
    v_cvt_pk_bf16_f32 v228, v110, v111
    v_cvt_pk_bf16_f32 v229, v112, v113
    v_cvt_pk_bf16_f32 v234, v114, v115
    v_cvt_pk_bf16_f32 v235, v116, v117
    v_cndmask_b32 v132, 0, v232, s[60:61]
    v_cndmask_b32 v232, v232, 0, s[60:61]
    v_cndmask_b32 v133, 0, v233, s[60:61]
    v_cndmask_b32 v233, v233, 0, s[60:61]
    v_cndmask_b32 v128, 0, v228, s[58:59]
    v_cndmask_b32 v228, v228, 0, s[58:59]
    v_cndmask_b32 v129, 0, v229, s[58:59]
    v_cndmask_b32 v229, v229, 0, s[58:59]
    v_cndmask_b32 v134, 0, v234, s[60:61]
    v_cndmask_b32 v234, v234, 0, s[60:61]
    v_cndmask_b32 v135, 0, v235, s[60:61]
    v_cndmask_b32 v235, v235, 0, s[60:61]
    s_waitcnt lgkmcnt(0)
    v_cmp_ne_u32 vcc, 0, v48
    s_nop 0
    s_cbranch_vccnz D_dV0
    s_mov_b32 s9, 0
D_lV0:
    ds_read_b32 v48, v221 offset:68
    ds_read_b64 v[230:231], v219 offset:0
    ds_read_b64 v[236:237], v219 offset:8
    s_add_u32 s9, s9, 1
    s_cmp_gt_u32 s9, 1600000
    s_waitcnt lgkmcnt(0)
    s_cbranch_scc1 D_dV0
    v_cmp_eq_u32 vcc, 0, v48
    s_nop 0
    s_cbranch_vccnz D_lV0
            D_dV0:

    v_cndmask_b32 v130, 0, v230, s[58:59]
    v_cndmask_b32 v230, v230, 0, s[58:59]
    v_cndmask_b32 v131, 0, v231, s[58:59]
    v_cndmask_b32 v231, v231, 0, s[58:59]
    v_cndmask_b32 v136, 0, v236, s[60:61]
    v_cndmask_b32 v236, v236, 0, s[60:61]
    v_cndmask_b32 v137, 0, v237, s[60:61]
    v_cndmask_b32 v237, v237, 0, s[60:61]
    s_branch C_join
C_tp1:
    s_barrier
    ds_read_b128 v[130:133], v28 offset:2048
    ds_read_b64_tr_b16 v[174:175], v32 offset:8192
    ds_read_b64_tr_b16 v[176:177], v32 offset:8704
    ds_read_b128 v[142:145], v29 offset:2048
    ds_read_b64_tr_b16 v[178:179], v32 offset:12288
    ds_read_b64_tr_b16 v[180:181], v32 offset:12800
    ds_read_b128 v[134:137], v28 offset:4096
    ds_read_b128 v[146:149], v29 offset:4096
    ds_read_b64_tr_b16 v[182:183], v33 offset:8192
    ds_read_b64_tr_b16 v[184:185], v33 offset:8704
    ds_read_b64_tr_b16 v[186:187], v33 offset:12288
    ds_read_b64_tr_b16 v[188:189], v33 offset:12800
    s_waitcnt lgkmcnt(9)
    v_mfma_f32_16x16x32_bf16 v[62:65], v[174:177], v[130:133], 0
    ds_read_b64_tr_b16 v[190:191], v32 offset:16384
    s_waitcnt lgkmcnt(7)
    v_mfma_f32_16x16x32_bf16 v[62:65], v[178:181], v[142:145], v[62:65]
    ds_read_b64_tr_b16 v[192:193], v32 offset:16896
    s_waitcnt lgkmcnt(7)
    v_mfma_f32_16x16x32_bf16 v[70:73], v[174:177], v[134:137], 0
    ds_read_b64_tr_b16 v[194:195], v32 offset:20480
    ds_read_b64_tr_b16 v[196:197], v32 offset:20992
    s_waitcnt lgkmcnt(8)
    v_mfma_f32_16x16x32_bf16 v[70:73], v[178:181], v[146:149], v[70:73]
    ds_read_b64_tr_b16 v[174:175], v33 offset:16384
    s_waitcnt lgkmcnt(7)
    v_mfma_f32_16x16x32_bf16 v[66:69], v[182:185], v[130:133], 0
    ds_read_b64_tr_b16 v[176:177], v33 offset:16896
    s_waitcnt lgkmcnt(6)
    v_mfma_f32_16x16x32_bf16 v[66:69], v[186:189], v[142:145], v[66:69]
    ds_read_b64_tr_b16 v[178:179], v33 offset:20480
    v_mfma_f32_16x16x32_bf16 v[74:77], v[182:185], v[134:137], 0
    ds_read_b64_tr_b16 v[180:181], v33 offset:20992
    v_mfma_f32_16x16x32_bf16 v[74:77], v[186:189], v[146:149], v[74:77]
    ds_read_b128 v[126:129], v28 offset:0
    s_waitcnt lgkmcnt(7)
    v_mfma_f32_16x16x32_bf16 v[86:89], v[190:193], v[130:133], 0
    ds_read_b64_tr_b16 v[182:183], v32 offset:24576
    s_waitcnt lgkmcnt(6)
    v_mfma_f32_16x16x32_bf16 v[86:89], v[194:197], v[142:145], v[86:89]
    ds_read_b64_tr_b16 v[184:185], v32 offset:25088
    v_mfma_f32_16x16x32_bf16 v[94:97], v[190:193], v[134:137], 0
    ds_read_b128 v[138:141], v29 offset:0
    ds_read_b64_tr_b16 v[186:187], v32 offset:28672
    v_mfma_f32_16x16x32_bf16 v[94:97], v[194:197], v[146:149], v[94:97]
    ds_read_b64_tr_b16 v[188:189], v32 offset:29184
    s_waitcnt lgkmcnt(8)
    v_mfma_f32_16x16x32_bf16 v[90:93], v[174:177], v[130:133], 0
    ds_read_b64_tr_b16 v[190:191], v33 offset:24576
    s_waitcnt lgkmcnt(7)
    v_mfma_f32_16x16x32_bf16 v[90:93], v[178:181], v[142:145], v[90:93]
    ds_read_b64_tr_b16 v[192:193], v33 offset:25088
    v_mfma_f32_16x16x32_bf16 v[98:101], v[174:177], v[134:137], 0
    ds_read_b64_tr_b16 v[194:195], v33 offset:28672
    v_mfma_f32_16x16x32_bf16 v[98:101], v[178:181], v[146:149], v[98:101]
    ds_read_b64_tr_b16 v[196:197], v33 offset:29184
    s_waitcnt lgkmcnt(7)
    v_mfma_f32_16x16x32_bf16 v[102:105], v[126:129], v[182:185], 0
    s_waitcnt lgkmcnt(4)
    v_mfma_f32_16x16x32_bf16 v[102:105], v[138:141], v[186:189], v[102:105]
    v_mfma_f32_16x16x32_bf16 v[110:113], v[130:133], v[182:185], 0
    v_mfma_f32_16x16x32_bf16 v[110:113], v[142:145], v[186:189], v[110:113]
    v_mfma_f32_16x16x32_bf16 v[118:121], v[134:137], v[182:185], 0
    v_mfma_f32_16x16x32_bf16 v[118:121], v[146:149], v[186:189], v[118:121]
    s_waitcnt lgkmcnt(2)
    v_mfma_f32_16x16x32_bf16 v[106:109], v[126:129], v[190:193], 0
    s_waitcnt lgkmcnt(0)
    v_mfma_f32_16x16x32_bf16 v[106:109], v[138:141], v[194:197], v[106:109]
    v_mfma_f32_16x16x32_bf16 v[114:117], v[130:133], v[190:193], 0
    s_barrier
    ds_read_b128 v[154:157], v28 offset:12288
    ds_read_b64_tr_b16 v[174:175], v32 offset:32768
    ds_read_b64_tr_b16 v[176:177], v32 offset:33280
    ds_read_b128 v[166:169], v29 offset:12288
    ds_read_b64_tr_b16 v[178:179], v32 offset:36864
    ds_read_b64_tr_b16 v[180:181], v32 offset:37376
    ds_read_b128 v[158:161], v28 offset:14336
    ds_read_b128 v[170:173], v29 offset:14336
    ds_read_b64_tr_b16 v[182:183], v33 offset:32768
    ds_read_b64_tr_b16 v[184:185], v33 offset:33280
    ds_read_b64_tr_b16 v[186:187], v33 offset:36864
    ds_read_b64_tr_b16 v[188:189], v33 offset:37376
    v_mfma_f32_16x16x32_bf16 v[114:117], v[142:145], v[194:197], v[114:117]
    v_mfma_f32_16x16x32_bf16 v[122:125], v[134:137], v[190:193], 0
    ds_read_b64_tr_b16 v[190:191], v32 offset:40960
    v_mfma_f32_16x16x32_bf16 v[122:125], v[146:149], v[194:197], v[122:125]
    ds_read_b64_tr_b16 v[192:193], v32 offset:41472
    s_waitcnt lgkmcnt(11)
    v_mfma_f32_16x16x32_bf16 v[62:65], v[174:177], v[154:157], v[62:65]
    ds_read_b64_tr_b16 v[194:195], v32 offset:45056
    s_waitcnt lgkmcnt(9)
    v_mfma_f32_16x16x32_bf16 v[62:65], v[178:181], v[166:169], v[62:65]
    ds_read_b64_tr_b16 v[196:197], v32 offset:45568
    s_waitcnt lgkmcnt(9)
    v_mfma_f32_16x16x32_bf16 v[70:73], v[174:177], v[158:161], v[70:73]
    ds_read_b64_tr_b16 v[174:175], v33 offset:40960
    s_waitcnt lgkmcnt(9)
    v_mfma_f32_16x16x32_bf16 v[70:73], v[178:181], v[170:173], v[70:73]
    ds_read_b64_tr_b16 v[176:177], v33 offset:41472
    s_waitcnt lgkmcnt(8)
    v_mfma_f32_16x16x32_bf16 v[66:69], v[182:185], v[154:157], v[66:69]
    ds_read_b64_tr_b16 v[178:179], v33 offset:45056
    s_waitcnt lgkmcnt(7)
    v_mfma_f32_16x16x32_bf16 v[66:69], v[186:189], v[166:169], v[66:69]
    ds_read_b64_tr_b16 v[180:181], v33 offset:45568
    v_mfma_f32_16x16x32_bf16 v[74:77], v[182:185], v[158:161], v[74:77]
    ds_read_b128 v[150:153], v28 offset:10240
    v_mfma_f32_16x16x32_bf16 v[74:77], v[186:189], v[170:173], v[74:77]
    ds_read_b64_tr_b16 v[182:183], v34 offset:0
    s_waitcnt lgkmcnt(8)
    v_mfma_f32_16x16x32_bf16 v[86:89], v[190:193], v[154:157], v[86:89]
    ds_read_b64_tr_b16 v[184:185], v34 offset:512
    s_waitcnt lgkmcnt(7)
    v_mfma_f32_16x16x32_bf16 v[86:89], v[194:197], v[166:169], v[86:89]
    ds_read_b128 v[162:165], v29 offset:10240
    v_mfma_f32_16x16x32_bf16 v[94:97], v[190:193], v[158:161], v[94:97]
    ds_read_b64_tr_b16 v[186:187], v34 offset:4096
    ds_read_b64_tr_b16 v[188:189], v34 offset:4608
    v_mfma_f32_16x16x32_bf16 v[94:97], v[194:197], v[170:173], v[94:97]
    ds_read_b64_tr_b16 v[190:191], v35 offset:0
    s_waitcnt lgkmcnt(9)
    v_mfma_f32_16x16x32_bf16 v[90:93], v[174:177], v[154:157], v[90:93]
    ds_read_b64_tr_b16 v[192:193], v35 offset:512
    s_waitcnt lgkmcnt(8)
    v_mfma_f32_16x16x32_bf16 v[90:93], v[178:181], v[166:169], v[90:93]
    ds_read_b64_tr_b16 v[194:195], v35 offset:4096
    v_mfma_f32_16x16x32_bf16 v[98:101], v[174:177], v[158:161], v[98:101]
    ds_read_b64_tr_b16 v[196:197], v35 offset:4608
    v_mfma_f32_16x16x32_bf16 v[98:101], v[178:181], v[170:173], v[98:101]
    s_waitcnt lgkmcnt(7)
    v_mfma_f32_16x16x32_bf16 v[102:105], v[150:153], v[182:185], v[102:105]
    s_waitcnt lgkmcnt(4)
    v_mfma_f32_16x16x32_bf16 v[102:105], v[162:165], v[186:189], v[102:105]
    v_mfma_f32_16x16x32_bf16 v[110:113], v[154:157], v[182:185], v[110:113]
    v_mfma_f32_16x16x32_bf16 v[110:113], v[166:169], v[186:189], v[110:113]
    v_mfma_f32_16x16x32_bf16 v[118:121], v[158:161], v[182:185], v[118:121]
    v_mfma_f32_16x16x32_bf16 v[118:121], v[170:173], v[186:189], v[118:121]
    s_waitcnt lgkmcnt(2)
    v_mfma_f32_16x16x32_bf16 v[106:109], v[150:153], v[190:193], v[106:109]
    s_waitcnt lgkmcnt(0)
    v_mfma_f32_16x16x32_bf16 v[106:109], v[162:165], v[194:197], v[106:109]
    v_mfma_f32_16x16x32_bf16 v[114:117], v[154:157], v[190:193], v[114:117]
    s_barrier
    ds_read_b128 v[130:133], v28 offset:22528
    ds_read_b64_tr_b16 v[174:175], v34 offset:8192
    ds_read_b64_tr_b16 v[176:177], v34 offset:8704
    ds_read_b128 v[142:145], v29 offset:22528
    ds_read_b64_tr_b16 v[178:179], v34 offset:12288
    ds_read_b64_tr_b16 v[180:181], v34 offset:12800
    ds_read_b128 v[134:137], v28 offset:24576
    ds_read_b128 v[146:149], v29 offset:24576
    ds_read_b64_tr_b16 v[182:183], v35 offset:8192
    ds_read_b64_tr_b16 v[184:185], v35 offset:8704
    ds_read_b64_tr_b16 v[186:187], v35 offset:12288
    ds_read_b64_tr_b16 v[188:189], v35 offset:12800
    v_mfma_f32_16x16x32_bf16 v[114:117], v[166:169], v[194:197], v[114:117]
    v_mfma_f32_16x16x32_bf16 v[122:125], v[158:161], v[190:193], v[122:125]
    ds_read_b64_tr_b16 v[190:191], v34 offset:16384
    v_mfma_f32_16x16x32_bf16 v[122:125], v[170:173], v[194:197], v[122:125]
    ds_read_b64_tr_b16 v[192:193], v34 offset:16896
    s_waitcnt lgkmcnt(11)
    v_mfma_f32_16x16x32_bf16 v[62:65], v[174:177], v[130:133], v[62:65]
    ds_read_b64_tr_b16 v[194:195], v34 offset:20480
    s_waitcnt lgkmcnt(9)
    v_mfma_f32_16x16x32_bf16 v[62:65], v[178:181], v[142:145], v[62:65]
    ds_read_b64_tr_b16 v[196:197], v34 offset:20992
    s_waitcnt lgkmcnt(9)
    v_mfma_f32_16x16x32_bf16 v[70:73], v[174:177], v[134:137], v[70:73]
    ds_read_b64_tr_b16 v[174:175], v35 offset:16384
    s_waitcnt lgkmcnt(9)
    v_mfma_f32_16x16x32_bf16 v[70:73], v[178:181], v[146:149], v[70:73]
    ds_read_b64_tr_b16 v[176:177], v35 offset:16896
    s_waitcnt lgkmcnt(8)
    v_mfma_f32_16x16x32_bf16 v[66:69], v[182:185], v[130:133], v[66:69]
    ds_read_b64_tr_b16 v[178:179], v35 offset:20480
    s_waitcnt lgkmcnt(7)
    v_mfma_f32_16x16x32_bf16 v[66:69], v[186:189], v[142:145], v[66:69]
    ds_read_b64_tr_b16 v[180:181], v35 offset:20992
    v_mfma_f32_16x16x32_bf16 v[74:77], v[182:185], v[134:137], v[74:77]
    ds_read_b128 v[126:129], v28 offset:20480
    v_mfma_f32_16x16x32_bf16 v[74:77], v[186:189], v[146:149], v[74:77]
    ds_read_b64_tr_b16 v[182:183], v34 offset:24576
    s_waitcnt lgkmcnt(8)
    v_mfma_f32_16x16x32_bf16 v[86:89], v[190:193], v[130:133], v[86:89]
    ds_read_b64_tr_b16 v[184:185], v34 offset:25088
    s_waitcnt lgkmcnt(7)
    v_mfma_f32_16x16x32_bf16 v[86:89], v[194:197], v[142:145], v[86:89]
    ds_read_b128 v[138:141], v29 offset:20480
    v_mfma_f32_16x16x32_bf16 v[94:97], v[190:193], v[134:137], v[94:97]
    ds_read_b64_tr_b16 v[186:187], v34 offset:28672
    ds_read_b64_tr_b16 v[188:189], v34 offset:29184
    v_mfma_f32_16x16x32_bf16 v[94:97], v[194:197], v[146:149], v[94:97]
    ds_read_b64_tr_b16 v[190:191], v35 offset:24576
    s_waitcnt lgkmcnt(9)
    v_mfma_f32_16x16x32_bf16 v[90:93], v[174:177], v[130:133], v[90:93]
    ds_read_b64_tr_b16 v[192:193], v35 offset:25088
    s_waitcnt lgkmcnt(8)
    v_mfma_f32_16x16x32_bf16 v[90:93], v[178:181], v[142:145], v[90:93]
    ds_read_b64_tr_b16 v[194:195], v35 offset:28672
    v_mfma_f32_16x16x32_bf16 v[98:101], v[174:177], v[134:137], v[98:101]
    ds_read_b64_tr_b16 v[196:197], v35 offset:29184
    v_mfma_f32_16x16x32_bf16 v[98:101], v[178:181], v[146:149], v[98:101]
    s_waitcnt lgkmcnt(7)
    v_mfma_f32_16x16x32_bf16 v[102:105], v[126:129], v[182:185], v[102:105]
    s_waitcnt lgkmcnt(4)
    v_mfma_f32_16x16x32_bf16 v[102:105], v[138:141], v[186:189], v[102:105]
    v_mfma_f32_16x16x32_bf16 v[110:113], v[130:133], v[182:185], v[110:113]
    v_mfma_f32_16x16x32_bf16 v[110:113], v[142:145], v[186:189], v[110:113]
    v_mfma_f32_16x16x32_bf16 v[118:121], v[134:137], v[182:185], v[118:121]
    v_mfma_f32_16x16x32_bf16 v[118:121], v[146:149], v[186:189], v[118:121]
    s_waitcnt lgkmcnt(2)
    v_mfma_f32_16x16x32_bf16 v[106:109], v[126:129], v[190:193], v[106:109]
    s_waitcnt lgkmcnt(0)
    v_mfma_f32_16x16x32_bf16 v[106:109], v[138:141], v[194:197], v[106:109]
    v_mfma_f32_16x16x32_bf16 v[114:117], v[130:133], v[190:193], v[114:117]
    s_barrier
    ds_read_b128 v[154:157], v28 offset:32768
    ds_read_b64_tr_b16 v[174:175], v34 offset:32768
    ds_read_b64_tr_b16 v[176:177], v34 offset:33280
    ds_read_b128 v[166:169], v29 offset:32768
    ds_read_b64_tr_b16 v[178:179], v34 offset:36864
    ds_read_b64_tr_b16 v[180:181], v34 offset:37376
    ds_read_b128 v[158:161], v28 offset:34816
    ds_read_b128 v[170:173], v29 offset:34816
    ds_read_b64_tr_b16 v[182:183], v35 offset:32768
    ds_read_b64_tr_b16 v[184:185], v35 offset:33280
    ds_read_b64_tr_b16 v[186:187], v35 offset:36864
    ds_read_b64_tr_b16 v[188:189], v35 offset:37376
    v_mfma_f32_16x16x32_bf16 v[114:117], v[142:145], v[194:197], v[114:117]
    v_mfma_f32_16x16x32_bf16 v[122:125], v[134:137], v[190:193], v[122:125]
    ds_read_b64_tr_b16 v[190:191], v32 offset:0
    v_mfma_f32_16x16x32_bf16 v[122:125], v[146:149], v[194:197], v[122:125]
    ds_read_b64_tr_b16 v[192:193], v32 offset:512
    s_waitcnt lgkmcnt(11)
    v_mfma_f32_16x16x32_bf16 v[62:65], v[174:177], v[154:157], v[62:65]
    ds_read_b64_tr_b16 v[194:195], v32 offset:4096
    s_waitcnt lgkmcnt(9)
    v_mfma_f32_16x16x32_bf16 v[62:65], v[178:181], v[166:169], v[62:65]
    ds_read_b64_tr_b16 v[196:197], v32 offset:4608
    s_waitcnt lgkmcnt(9)
    v_mfma_f32_16x16x32_bf16 v[70:73], v[174:177], v[158:161], v[70:73]
    ds_read_b64_tr_b16 v[174:175], v33 offset:0
    s_waitcnt lgkmcnt(9)
    v_mfma_f32_16x16x32_bf16 v[70:73], v[178:181], v[170:173], v[70:73]
    ds_read_b64_tr_b16 v[176:177], v33 offset:512
    s_waitcnt lgkmcnt(8)
    v_mfma_f32_16x16x32_bf16 v[66:69], v[182:185], v[154:157], v[66:69]
    ds_read_b64_tr_b16 v[178:179], v33 offset:4096
    s_waitcnt lgkmcnt(7)
    v_mfma_f32_16x16x32_bf16 v[66:69], v[186:189], v[166:169], v[66:69]
    ds_read_b64_tr_b16 v[180:181], v33 offset:4608
    v_mfma_f32_16x16x32_bf16 v[74:77], v[182:185], v[158:161], v[74:77]
    ds_read_b128 v[150:153], v28 offset:30720
    v_mfma_f32_16x16x32_bf16 v[74:77], v[186:189], v[170:173], v[74:77]
    ds_read_b64_tr_b16 v[182:183], v32 offset:8192
    s_waitcnt lgkmcnt(8)
    v_mfma_f32_16x16x32_bf16 v[86:89], v[190:193], v[154:157], v[86:89]
    ds_read_b64_tr_b16 v[184:185], v32 offset:8704
    s_waitcnt lgkmcnt(7)
    v_mfma_f32_16x16x32_bf16 v[86:89], v[194:197], v[166:169], v[86:89]
    ds_read_b128 v[162:165], v29 offset:30720
    v_mfma_f32_16x16x32_bf16 v[94:97], v[190:193], v[158:161], v[94:97]
    ds_read_b64_tr_b16 v[186:187], v32 offset:12288
    ds_read_b64_tr_b16 v[188:189], v32 offset:12800
    v_mfma_f32_16x16x32_bf16 v[94:97], v[194:197], v[170:173], v[94:97]
    ds_read_b64_tr_b16 v[190:191], v33 offset:8192
    s_waitcnt lgkmcnt(9)
    v_mfma_f32_16x16x32_bf16 v[90:93], v[174:177], v[154:157], v[90:93]
    ds_read_b64_tr_b16 v[192:193], v33 offset:8704
    s_waitcnt lgkmcnt(8)
    v_mfma_f32_16x16x32_bf16 v[90:93], v[178:181], v[166:169], v[90:93]
    ds_read_b64_tr_b16 v[194:195], v33 offset:12288
    v_mfma_f32_16x16x32_bf16 v[98:101], v[174:177], v[158:161], v[98:101]
    ds_read_b64_tr_b16 v[196:197], v33 offset:12800
    v_mfma_f32_16x16x32_bf16 v[98:101], v[178:181], v[170:173], v[98:101]
    s_waitcnt lgkmcnt(7)
    v_mfma_f32_16x16x32_bf16 v[102:105], v[150:153], v[182:185], v[102:105]
    s_waitcnt lgkmcnt(4)
    v_mfma_f32_16x16x32_bf16 v[102:105], v[162:165], v[186:189], v[102:105]
    v_mfma_f32_16x16x32_bf16 v[110:113], v[154:157], v[182:185], v[110:113]
    v_mfma_f32_16x16x32_bf16 v[110:113], v[166:169], v[186:189], v[110:113]
    v_mfma_f32_16x16x32_bf16 v[118:121], v[158:161], v[182:185], v[118:121]
    v_mfma_f32_16x16x32_bf16 v[118:121], v[170:173], v[186:189], v[118:121]
    s_waitcnt lgkmcnt(2)
    v_mfma_f32_16x16x32_bf16 v[106:109], v[150:153], v[190:193], v[106:109]
    s_waitcnt lgkmcnt(0)
    v_mfma_f32_16x16x32_bf16 v[106:109], v[162:165], v[194:197], v[106:109]
    v_mfma_f32_16x16x32_bf16 v[114:117], v[154:157], v[190:193], v[114:117]
    s_barrier
    ds_read_b128 v[130:133], v30 offset:2048
    ds_read_b64_tr_b16 v[174:175], v32 offset:16384
    ds_read_b64_tr_b16 v[176:177], v32 offset:16896
    ds_read_b128 v[142:145], v31 offset:2048
    ds_read_b64_tr_b16 v[178:179], v32 offset:20480
    ds_read_b64_tr_b16 v[180:181], v32 offset:20992
    ds_read_b128 v[134:137], v30 offset:4096
    ds_read_b128 v[146:149], v31 offset:4096
    ds_read_b64_tr_b16 v[182:183], v33 offset:16384
    ds_read_b64_tr_b16 v[184:185], v33 offset:16896
    ds_read_b64_tr_b16 v[186:187], v33 offset:20480
    ds_read_b64_tr_b16 v[188:189], v33 offset:20992
    v_mfma_f32_16x16x32_bf16 v[114:117], v[166:169], v[194:197], v[114:117]
    v_mfma_f32_16x16x32_bf16 v[122:125], v[158:161], v[190:193], v[122:125]
    ds_read_b64_tr_b16 v[190:191], v32 offset:24576
    v_mfma_f32_16x16x32_bf16 v[122:125], v[170:173], v[194:197], v[122:125]
    ds_read_b64_tr_b16 v[192:193], v32 offset:25088
    s_waitcnt lgkmcnt(11)
    v_mfma_f32_16x16x32_bf16 v[62:65], v[174:177], v[130:133], v[62:65]
    ds_read_b64_tr_b16 v[194:195], v32 offset:28672
    s_waitcnt lgkmcnt(9)
    v_mfma_f32_16x16x32_bf16 v[62:65], v[178:181], v[142:145], v[62:65]
    ds_read_b64_tr_b16 v[196:197], v32 offset:29184
    s_waitcnt lgkmcnt(9)
    v_mfma_f32_16x16x32_bf16 v[70:73], v[174:177], v[134:137], v[70:73]
    ds_read_b64_tr_b16 v[174:175], v33 offset:24576
    s_waitcnt lgkmcnt(9)
    v_mfma_f32_16x16x32_bf16 v[70:73], v[178:181], v[146:149], v[70:73]
    ds_read_b64_tr_b16 v[176:177], v33 offset:25088
    s_waitcnt lgkmcnt(8)
    v_mfma_f32_16x16x32_bf16 v[66:69], v[182:185], v[130:133], v[66:69]
    ds_read_b64_tr_b16 v[178:179], v33 offset:28672
    s_waitcnt lgkmcnt(7)
    v_mfma_f32_16x16x32_bf16 v[66:69], v[186:189], v[142:145], v[66:69]
    ds_read_b64_tr_b16 v[180:181], v33 offset:29184
    v_mfma_f32_16x16x32_bf16 v[74:77], v[182:185], v[134:137], v[74:77]
    ds_read_b128 v[126:129], v30 offset:0
    v_mfma_f32_16x16x32_bf16 v[74:77], v[186:189], v[146:149], v[74:77]
    ds_read_b64_tr_b16 v[182:183], v32 offset:32768
    s_waitcnt lgkmcnt(8)
    v_mfma_f32_16x16x32_bf16 v[86:89], v[190:193], v[130:133], v[86:89]
    ds_read_b64_tr_b16 v[184:185], v32 offset:33280
    s_waitcnt lgkmcnt(7)
    v_mfma_f32_16x16x32_bf16 v[86:89], v[194:197], v[142:145], v[86:89]
    ds_read_b128 v[138:141], v31 offset:0
    v_mfma_f32_16x16x32_bf16 v[94:97], v[190:193], v[134:137], v[94:97]
    ds_read_b64_tr_b16 v[186:187], v32 offset:36864
    ds_read_b64_tr_b16 v[188:189], v32 offset:37376
    v_mfma_f32_16x16x32_bf16 v[94:97], v[194:197], v[146:149], v[94:97]
    ds_read_b64_tr_b16 v[190:191], v33 offset:32768
    s_waitcnt lgkmcnt(9)
    v_mfma_f32_16x16x32_bf16 v[90:93], v[174:177], v[130:133], v[90:93]
    ds_read_b64_tr_b16 v[192:193], v33 offset:33280
    s_waitcnt lgkmcnt(8)
    v_mfma_f32_16x16x32_bf16 v[90:93], v[178:181], v[142:145], v[90:93]
    ds_read_b64_tr_b16 v[194:195], v33 offset:36864
    v_mfma_f32_16x16x32_bf16 v[98:101], v[174:177], v[134:137], v[98:101]
    ds_read_b64_tr_b16 v[196:197], v33 offset:37376
    v_mfma_f32_16x16x32_bf16 v[98:101], v[178:181], v[146:149], v[98:101]
    s_waitcnt lgkmcnt(7)
    v_mfma_f32_16x16x32_bf16 v[102:105], v[126:129], v[182:185], v[102:105]
    s_waitcnt lgkmcnt(4)
    v_mfma_f32_16x16x32_bf16 v[102:105], v[138:141], v[186:189], v[102:105]
    v_mfma_f32_16x16x32_bf16 v[110:113], v[130:133], v[182:185], v[110:113]
    v_mfma_f32_16x16x32_bf16 v[110:113], v[142:145], v[186:189], v[110:113]
    v_mfma_f32_16x16x32_bf16 v[118:121], v[134:137], v[182:185], v[118:121]
    v_mfma_f32_16x16x32_bf16 v[118:121], v[146:149], v[186:189], v[118:121]
    s_waitcnt lgkmcnt(2)
    v_mfma_f32_16x16x32_bf16 v[106:109], v[126:129], v[190:193], v[106:109]
    s_waitcnt lgkmcnt(0)
    v_mfma_f32_16x16x32_bf16 v[106:109], v[138:141], v[194:197], v[106:109]
    v_mfma_f32_16x16x32_bf16 v[114:117], v[130:133], v[190:193], v[114:117]
    s_barrier
    ds_read_b128 v[154:157], v30 offset:12288
    ds_read_b64_tr_b16 v[174:175], v32 offset:40960
    ds_read_b64_tr_b16 v[176:177], v32 offset:41472
    ds_read_b128 v[166:169], v31 offset:12288
    ds_read_b64_tr_b16 v[178:179], v32 offset:45056
    ds_read_b64_tr_b16 v[180:181], v32 offset:45568
    ds_read_b128 v[158:161], v30 offset:14336
    ds_read_b128 v[170:173], v31 offset:14336
    ds_read_b64_tr_b16 v[182:183], v33 offset:40960
    ds_read_b64_tr_b16 v[184:185], v33 offset:41472
    ds_read_b64_tr_b16 v[186:187], v33 offset:45056
    ds_read_b64_tr_b16 v[188:189], v33 offset:45568
    ds_read_b64_tr_b16 v[198:199], v34 offset:0
    v_mfma_f32_16x16x32_bf16 v[114:117], v[142:145], v[194:197], v[114:117]
    ds_read_b64_tr_b16 v[200:201], v34 offset:512
    v_mfma_f32_16x16x32_bf16 v[122:125], v[134:137], v[190:193], v[122:125]
    ds_read_b64_tr_b16 v[202:203], v34 offset:4096
    v_mfma_f32_16x16x32_bf16 v[122:125], v[146:149], v[194:197], v[122:125]
    ds_read_b64_tr_b16 v[204:205], v34 offset:4608
    s_waitcnt lgkmcnt(13)
    v_mfma_f32_16x16x32_bf16 v[62:65], v[174:177], v[154:157], v[62:65]
    ds_read_b64_tr_b16 v[190:191], v35 offset:0
    s_waitcnt lgkmcnt(11)
    v_mfma_f32_16x16x32_bf16 v[62:65], v[178:181], v[166:169], v[62:65]
    ds_read_b64_tr_b16 v[192:193], v35 offset:512
    s_waitcnt lgkmcnt(11)
    v_mfma_f32_16x16x32_bf16 v[70:73], v[174:177], v[158:161], v[70:73]
    ds_read_b64_tr_b16 v[194:195], v35 offset:4096
    s_waitcnt lgkmcnt(11)
    v_mfma_f32_16x16x32_bf16 v[70:73], v[178:181], v[170:173], v[70:73]
    ds_read_b64_tr_b16 v[196:197], v35 offset:4608
    s_waitcnt lgkmcnt(10)
    v_mfma_f32_16x16x32_bf16 v[66:69], v[182:185], v[154:157], v[66:69]
    s_waitcnt lgkmcnt(8)
    v_mfma_f32_16x16x32_bf16 v[66:69], v[186:189], v[166:169], v[66:69]
    v_mfma_f32_16x16x32_bf16 v[74:77], v[182:185], v[158:161], v[74:77]
    v_mfma_f32_16x16x32_bf16 v[74:77], v[186:189], v[170:173], v[74:77]
    s_waitcnt lgkmcnt(6)
    v_mfma_f32_16x16x32_bf16 v[86:89], v[198:201], v[154:157], v[86:89]
    s_waitcnt lgkmcnt(4)
    v_mfma_f32_16x16x32_bf16 v[86:89], v[202:205], v[166:169], v[86:89]
    v_mfma_f32_16x16x32_bf16 v[94:97], v[198:201], v[158:161], v[94:97]
    v_mfma_f32_16x16x32_bf16 v[94:97], v[202:205], v[170:173], v[94:97]
    s_waitcnt lgkmcnt(2)
    v_mfma_f32_16x16x32_bf16 v[90:93], v[190:193], v[154:157], v[90:93]
    s_waitcnt lgkmcnt(0)
    v_mfma_f32_16x16x32_bf16 v[90:93], v[194:197], v[166:169], v[90:93]
    v_mfma_f32_16x16x32_bf16 v[98:101], v[190:193], v[158:161], v[98:101]
    s_barrier
    ds_read_b128 v[130:133], v30 offset:22528
    ds_read_b64_tr_b16 v[174:175], v34 offset:8192
    ds_read_b64_tr_b16 v[176:177], v34 offset:8704
    ds_read_b128 v[142:145], v31 offset:22528
    ds_read_b64_tr_b16 v[178:179], v34 offset:12288
    ds_read_b64_tr_b16 v[180:181], v34 offset:12800
    ds_read_b128 v[134:137], v30 offset:24576
    ds_read_b128 v[146:149], v31 offset:24576
    ds_read_b64_tr_b16 v[182:183], v35 offset:8192
    ds_read_b64_tr_b16 v[184:185], v35 offset:8704
    ds_read_b64_tr_b16 v[186:187], v35 offset:12288
    ds_read_b64_tr_b16 v[188:189], v35 offset:12800
    ds_read_b64_tr_b16 v[198:199], v34 offset:16384
    v_mfma_f32_16x16x32_bf16 v[98:101], v[194:197], v[170:173], v[98:101]
    ds_read_b64_tr_b16 v[200:201], v34 offset:16896
    s_waitcnt lgkmcnt(11)
    v_mfma_f32_16x16x32_bf16 v[62:65], v[174:177], v[130:133], v[62:65]
    ds_read_b64_tr_b16 v[202:203], v34 offset:20480
    s_waitcnt lgkmcnt(9)
    v_mfma_f32_16x16x32_bf16 v[62:65], v[178:181], v[142:145], v[62:65]
    ds_read_b64_tr_b16 v[204:205], v34 offset:20992
    s_waitcnt lgkmcnt(9)
    v_mfma_f32_16x16x32_bf16 v[70:73], v[174:177], v[134:137], v[70:73]
    ds_read_b64_tr_b16 v[190:191], v35 offset:16384
    s_waitcnt lgkmcnt(9)
    v_mfma_f32_16x16x32_bf16 v[70:73], v[178:181], v[146:149], v[70:73]
    ds_read_b64_tr_b16 v[192:193], v35 offset:16896
    s_waitcnt lgkmcnt(8)
    v_mfma_f32_16x16x32_bf16 v[66:69], v[182:185], v[130:133], v[66:69]
    ds_read_b64_tr_b16 v[194:195], v35 offset:20480
    ds_read_b64_tr_b16 v[196:197], v35 offset:20992
    v_cvt_pk_bf16_f32 v150, v62, v63
    v_cvt_pk_bf16_f32 v151, v64, v65
    s_waitcnt lgkmcnt(8)
    v_mfma_f32_16x16x32_bf16 v[66:69], v[186:189], v[142:145], v[66:69]
    ds_read_b128 v[126:129], v30 offset:20480
    v_cndmask_b32 v158, 0, v150, s[54:55]
    v_cndmask_b32 v150, v150, 0, s[54:55]
    v_mfma_f32_16x16x32_bf16 v[74:77], v[182:185], v[134:137], v[74:77]
    ds_read_b128 v[138:141], v31 offset:20480
    v_cndmask_b32 v159, 0, v151, s[54:55]
    v_cndmask_b32 v151, v151, 0, s[54:55]
    v_mfma_f32_16x16x32_bf16 v[74:77], v[186:189], v[146:149], v[74:77]
    v_cvt_pk_bf16_f32 v154, v70, v71
    v_cvt_pk_bf16_f32 v155, v72, v73
    s_waitcnt lgkmcnt(8)
    v_mfma_f32_16x16x32_bf16 v[86:89], v[198:201], v[130:133], v[86:89]
    v_cndmask_b32 v162, 0, v154, s[54:55]
    v_cndmask_b32 v154, v154, 0, s[54:55]
    s_waitcnt lgkmcnt(6)
    v_mfma_f32_16x16x32_bf16 v[86:89], v[202:205], v[142:145], v[86:89]
    v_cndmask_b32 v163, 0, v155, s[54:55]
    v_cndmask_b32 v155, v155, 0, s[54:55]
    s_waitcnt lgkmcnt(4)
    v_mfma_f32_16x16x32_bf16 v[90:93], v[190:193], v[130:133], v[90:93]
    v_cvt_pk_bf16_f32 v152, v66, v67
    v_cvt_pk_bf16_f32 v153, v68, v69
    s_waitcnt lgkmcnt(2)
    v_mfma_f32_16x16x32_bf16 v[90:93], v[194:197], v[142:145], v[90:93]
    v_cndmask_b32 v160, 0, v152, s[56:57]
    v_cndmask_b32 v152, v152, 0, s[56:57]
    v_mfma_f32_16x16x32_bf16 v[94:97], v[198:201], v[134:137], v[94:97]
    v_cndmask_b32 v161, 0, v153, s[56:57]
    v_cndmask_b32 v153, v153, 0, s[56:57]
    v_mfma_f32_16x16x32_bf16 v[94:97], v[202:205], v[146:149], v[94:97]
    v_cvt_pk_bf16_f32 v156, v74, v75
    v_cvt_pk_bf16_f32 v157, v76, v77
    v_mfma_f32_16x16x32_bf16 v[98:101], v[190:193], v[134:137], v[98:101]
    v_cndmask_b32 v164, 0, v156, s[56:57]
    v_cndmask_b32 v156, v156, 0, s[56:57]
    v_mfma_f32_16x16x32_bf16 v[98:101], v[194:197], v[146:149], v[98:101]
    ds_read_b32 v40, v5 offset:4
    v_cndmask_b32 v165, 0, v157, s[56:57]
    v_cndmask_b32 v157, v157, 0, s[56:57]
    ds_read_b32 v48, v220 offset:56
    ds_read_b128 v[226:229], v218
    v_cvt_pk_bf16_f32 v230, v86, v87
    v_cvt_pk_bf16_f32 v231, v88, v89
    v_cvt_pk_bf16_f32 v232, v90, v91
    v_cvt_pk_bf16_f32 v233, v92, v93
    s_nop 1
    v_mfma_f32_16x16x32_bf16 v[66:69], v[230:233], v[150:153], 0
    v_mfma_f32_16x16x32_bf16 v[70:73], v[230:233], v[154:157], 0
    v_cvt_pk_bf16_f32 v234, v94, v95
    v_cvt_pk_bf16_f32 v235, v96, v97
    v_cvt_pk_bf16_f32 v236, v98, v99
    v_cvt_pk_bf16_f32 v237, v100, v101
    s_nop 1
    v_mfma_f32_16x16x32_bf16 v[74:77], v[234:237], v[154:157], 0
    v_mfma_f32_16x16x32_bf16 v[178:181], v[230:233], v[158:161], 0
    v_mfma_f32_16x16x32_bf16 v[182:185], v[230:233], v[162:165], 0
    v_mfma_f32_16x16x32_bf16 v[186:189], v[234:237], v[162:165], 0
    s_waitcnt lgkmcnt(0)
    v_cmp_ne_u32 vcc, 0, v48
    s_nop 0
    s_cbranch_vccnz D_dK
    s_mov_b32 s9, 0
D_lK:
    ds_read_b32 v48, v220 offset:56
    ds_read_b128 v[226:229], v218
    s_add_u32 s9, s9, 1
    s_cmp_gt_u32 s9, 1600000
    s_waitcnt lgkmcnt(0)
    s_cbranch_scc1 D_dK
    v_cmp_eq_u32 vcc, 0, v48
    s_nop 0
    s_cbranch_vccnz D_lK
            D_dK:

    v_mfma_f32_16x16x32_bf16 v[62:65], v[226:229], v[150:153], 0
    v_mfma_f32_16x16x32_bf16 v[174:177], v[226:229], v[158:161], 0
    v_readfirstlane_b32 s63, v40
    v_cndmask_b32 v74, v74, v75, s[44:45]
    ds_read_b32 v40, v5 offset:32
    v_cndmask_b32 v76, v76, v77, s[44:45]
    ds_read_b64_tr_b16 v[166:167], v34 offset:32768
    v_cndmask_b32 v70, v70, v71, s[44:45]
    ds_read_b64_tr_b16 v[168:169], v34 offset:33280
    v_cndmask_b32 v72, v72, v73, s[44:45]
    ds_read_b64_tr_b16 v[170:171], v35 offset:32768
    v_cndmask_b32 v212, v70, v74, s[46:47]
    ds_read_b64_tr_b16 v[172:173], v35 offset:33280
    v_cndmask_b32 v213, v72, v76, s[48:49]
    ds_read_b64_tr_b16 v[198:199], v34 offset:36864
    v_cndmask_b32 v66, v66, v67, s[44:45]
    ds_read_b64_tr_b16 v[200:201], v34 offset:37376
    v_cndmask_b32 v68, v68, v69, s[44:45]
    ds_read_b64_tr_b16 v[202:203], v35 offset:36864
    v_cndmask_b32 v62, v62, v63, s[44:45]
    ds_read_b64_tr_b16 v[204:205], v35 offset:37376
    v_cndmask_b32 v64, v64, v65, s[44:45]
    v_cndmask_b32 v210, v62, v66, s[46:47]
    v_cndmask_b32 v211, v64, v68, s[48:49]
    v_and_or_b32 v94, v210, v46, v50
    v_and_or_b32 v95, v211, v46, v51
    v_and_or_b32 v96, v212, v46, v52
    v_and_or_b32 v97, v213, v46, v53
    s_sub_u32 s63, s63, 1
    s_cbranch_scc1 C_mr1
C_md1:
    s_cmp_lg_u32 s101, 0
    s_cbranch_scc1 SM_jS1
    s_cmp_eq_u32 s63, 0
    s_cbranch_scc1 SM_sS1
    buffer_store_dwordx4 v[94:97], v4, s[36:39], s15 offen
SM_jS1:
    v_cndmask_b32 v186, v186, v187, s[44:45]
    v_cndmask_b32 v188, v188, v189, s[44:45]
    v_cndmask_b32 v182, v182, v183, s[44:45]
    v_cndmask_b32 v184, v184, v185, s[44:45]
    v_cndmask_b32 v208, v182, v186, s[46:47]
    v_cndmask_b32 v209, v184, v188, s[48:49]
    v_cndmask_b32 v178, v178, v179, s[44:45]
    v_cndmask_b32 v180, v180, v181, s[44:45]
    v_cndmask_b32 v174, v174, v175, s[44:45]
    v_cndmask_b32 v176, v176, v177, s[44:45]
    v_cndmask_b32 v206, v174, v178, s[46:47]
    v_cndmask_b32 v207, v176, v180, s[48:49]
    ds_write_b128 v42, v[206:209]
    ds_write_b32 v47, v5 offset:16
    s_waitcnt lgkmcnt(10)
    v_cmp_gt_u32 vcc, 4, v40
    s_nop 0
    s_cbranch_vccnz C_vr1
C_vd1:
    s_waitcnt lgkmcnt(8)
    v_mfma_f32_16x16x32_bf16 v[102:105], v[126:129], v[166:169], v[102:105]
    ds_read_b128 v[150:153], v30 offset:10240
    s_waitcnt lgkmcnt(5)
    v_mfma_f32_16x16x32_bf16 v[102:105], v[138:141], v[198:201], v[102:105]
    ds_read_b64_tr_b16 v[182:183], v34 offset:24576
    v_mfma_f32_16x16x32_bf16 v[110:113], v[130:133], v[166:169], v[110:113]
    ds_read_b64_tr_b16 v[184:185], v34 offset:25088
    v_mfma_f32_16x16x32_bf16 v[110:113], v[142:145], v[198:201], v[110:113]
    ds_read_b128 v[162:165], v31 offset:10240
    v_mfma_f32_16x16x32_bf16 v[118:121], v[134:137], v[166:169], v[118:121]
    ds_read_b64_tr_b16 v[190:191], v34 offset:28672
    v_mfma_f32_16x16x32_bf16 v[118:121], v[146:149], v[198:201], v[118:121]
    ds_read_b64_tr_b16 v[192:193], v34 offset:29184
    v_mfma_f32_16x16x32_bf16 v[106:109], v[126:129], v[170:173], v[106:109]
    ds_read_b64_tr_b16 v[186:187], v35 offset:24576
    ds_read_b64_tr_b16 v[188:189], v35 offset:25088
    s_waitcnt lgkmcnt(10)
    v_mfma_f32_16x16x32_bf16 v[106:109], v[138:141], v[202:205], v[106:109]
    ds_read_b64_tr_b16 v[194:195], v35 offset:28672
    ds_read_b64_tr_b16 v[196:197], v35 offset:29184
    v_mfma_f32_16x16x32_bf16 v[114:117], v[130:133], v[170:173], v[114:117]
    ds_read_b128 v[154:157], v30 offset:12288
    v_mfma_f32_16x16x32_bf16 v[114:117], v[142:145], v[202:205], v[114:117]
    ds_read_b128 v[174:177], v31 offset:12288
    v_mfma_f32_16x16x32_bf16 v[122:125], v[134:137], v[170:173], v[122:125]
    ds_read_b128 v[158:161], v30 offset:14336
    v_mfma_f32_16x16x32_bf16 v[122:125], v[146:149], v[202:205], v[122:125]
    ds_read_b128 v[178:181], v31 offset:14336
    s_waitcnt lgkmcnt(11)
    v_mfma_f32_16x16x32_bf16 v[102:105], v[150:153], v[182:185], v[102:105]
    s_waitcnt lgkmcnt(8)
    v_mfma_f32_16x16x32_bf16 v[102:105], v[162:165], v[190:193], v[102:105]
    s_waitcnt lgkmcnt(6)
    v_mfma_f32_16x16x32_bf16 v[106:109], v[150:153], v[186:189], v[106:109]
    s_waitcnt lgkmcnt(4)
    v_mfma_f32_16x16x32_bf16 v[106:109], v[162:165], v[194:197], v[106:109]
    s_waitcnt lgkmcnt(3)
    v_mfma_f32_16x16x32_bf16 v[110:113], v[154:157], v[182:185], v[110:113]
    s_nop 1
    v_cvt_pk_bf16_f32 v226, v102, v103
    v_cvt_pk_bf16_f32 v227, v104, v105
    ds_write_b64 v219, v[226:227] offset:0
    s_waitcnt lgkmcnt(3)
    v_mfma_f32_16x16x32_bf16 v[110:113], v[174:177], v[190:193], v[110:113]
    v_mfma_f32_16x16x32_bf16 v[114:117], v[154:157], v[186:189], v[114:117]
    v_cvt_pk_bf16_f32 v232, v106, v107
    v_cvt_pk_bf16_f32 v233, v108, v109
    ds_write_b64 v219, v[232:233] offset:8
    v_mfma_f32_16x16x32_bf16 v[114:117], v[174:177], v[194:197], v[114:117]
    ds_write_b32 v221, v5 offset:68
    s_waitcnt lgkmcnt(4)
    v_mfma_f32_16x16x32_bf16 v[118:121], v[158:161], v[182:185], v[118:121]
    v_cvt_pk_bf16_f32 v228, v110, v111
    v_cvt_pk_bf16_f32 v229, v112, v113
    s_waitcnt lgkmcnt(3)
    v_mfma_f32_16x16x32_bf16 v[118:121], v[178:181], v[190:193], v[118:121]
    v_mfma_f32_16x16x32_bf16 v[122:125], v[158:161], v[186:189], v[122:125]
    v_cvt_pk_bf16_f32 v234, v114, v115
    v_cvt_pk_bf16_f32 v235, v116, v117
    v_mfma_f32_16x16x32_bf16 v[122:125], v[178:181], v[194:197], v[122:125]
    v_cndmask_b32 v126, 0, v226, s[58:59]
    v_cndmask_b32 v226, v226, 0, s[58:59]
    v_cndmask_b32 v127, 0, v227, s[58:59]
    v_cndmask_b32 v227, v227, 0, s[58:59]
    buffer_load_dwordx4 v[214:217], v4, s[36:39], s100 offen sc1
    v_cvt_pk_bf16_f32 v230, v118, v119
    v_cvt_pk_bf16_f32 v231, v120, v121
    s_nop 0
    v_cvt_pk_bf16_f32 v236, v122, v123
    v_cvt_pk_bf16_f32 v237, v124, v125
    v_cndmask_b32 v132, 0, v232, s[60:61]
    v_cndmask_b32 v232, v232, 0, s[60:61]
    v_cndmask_b32 v133, 0, v233, s[60:61]
    v_cndmask_b32 v233, v233, 0, s[60:61]
    v_cndmask_b32 v128, 0, v228, s[58:59]
    v_cndmask_b32 v228, v228, 0, s[58:59]
    v_cndmask_b32 v129, 0, v229, s[58:59]
    v_cndmask_b32 v229, v229, 0, s[58:59]
    v_cndmask_b32 v134, 0, v234, s[60:61]
    v_cndmask_b32 v234, v234, 0, s[60:61]
    v_cndmask_b32 v135, 0, v235, s[60:61]
    v_cndmask_b32 v235, v235, 0, s[60:61]
    v_cndmask_b32 v130, 0, v230, s[58:59]
    v_cndmask_b32 v230, v230, 0, s[58:59]
    v_cndmask_b32 v131, 0, v231, s[58:59]
    v_cndmask_b32 v231, v231, 0, s[58:59]
    v_cndmask_b32 v136, 0, v236, s[60:61]
    v_cndmask_b32 v236, v236, 0, s[60:61]
    v_cndmask_b32 v137, 0, v237, s[60:61]
    v_cndmask_b32 v237, v237, 0, s[60:61]
    s_waitcnt lgkmcnt(0)
C_join:
    s_mov_b32 s9, 0
    s_add_u32 s19, s100, 14336
    s_cmp_lg_u32 s101, 0
    s_cbranch_scc1 C_sv
    s_mov_b32 s40, 0x0c0c0400
    s_mov_b32 s41, 0x05040100
        C_sl:
    s_waitcnt vmcnt(0)
    v_perm_b32 v2, v215, v214, s40
    v_perm_b32 v3, v217, v216, s40
    v_and_b32 v214, v46, v214
    v_perm_b32 v2, v3, v2, s41
    v_and_b32 v215, v46, v215
    v_cmp_ne_u32 vcc, s12, v2
    v_and_b32 v216, v46, v216
    v_and_b32 v217, v46, v217

    s_cbranch_vccz C_sk
    buffer_load_dwordx4 v[214:217], v4, s[36:39], s100 offen sc1
    s_add_u32 s9, s9, 1
    s_cmp_lt_u32 s9, 200000
    s_cbranch_scc1 C_sl
    s_waitcnt vmcnt(0)
C_sk:
    v_pk_add_f32 v[210:211], v[210:211], v[214:215]
    v_pk_add_f32 v[212:213], v[212:213], v[216:217]
C_sv:
    v_max_f32 v222, v210, v211
    v_max_f32 v223, v212, v213
    v_mov_b32 v224, v222
    v_mov_b32 v225, v223
    s_mov_b64 exec, 1
    ds_add_u32 v5, v44 offset:80
    s_mov_b64 exec, -1
    v_permlane16_swap_b32 v222, v224
    v_permlane16_swap_b32 v223, v225
    v_max_f32 v222, v222, v224
    v_max_f32 v223, v223, v225
    v_mov_b32 v224, v222
    v_mov_b32 v225, v223
    s_nop 0
    v_permlane32_swap_b32 v222, v224
    v_permlane32_swap_b32 v223, v225
    v_max_f32 v222, v222, v224
    v_max_f32 v223, v223, v225
    v_mul_f32 v222, s0, v222
    v_mul_f32 v223, s0, v223
    v_fma_f32 v210, v210, s0, -v222
    v_fma_f32 v211, v211, s0, -v222
    v_fma_f32 v212, v212, s0, -v223
    v_fma_f32 v213, v213, s0, -v223
    v_exp_f32 v210, v210
    v_exp_f32 v211, v211
    v_exp_f32 v212, v212
    v_exp_f32 v213, v213
    v_add_f32 v222, v210, v211
    v_add_f32 v223, v212, v213
    v_mov_b32 v224, v222
    v_mov_b32 v225, v223
    ds_read_b32 v48, v47 offset:40
    ds_read_b128 v[78:81], v43 offset:12288
    ds_read_b128 v[82:85], v43 offset:13312
    ds_read_b32 v7, v5 offset:12
    v_permlane16_swap_b32 v222, v224
    v_permlane16_swap_b32 v223, v225
    v_add_f32 v222, v222, v224
    v_add_f32 v223, v223, v225
    v_mov_b32 v224, v222
    v_mov_b32 v225, v223
    s_nop 0
    v_permlane32_swap_b32 v222, v224
    v_permlane32_swap_b32 v223, v225
    v_add_f32 v222, v222, v224
    v_add_f32 v223, v223, v225
    v_rcp_f32 v222, v222
    v_rcp_f32 v223, v223
    s_waitcnt lgkmcnt(0)
    v_cmp_eq_u32 vcc, 0, v48
    v_mul_f32 v210, v210, v222
    v_mul_f32 v211, v211, v222
    v_mul_f32 v212, v212, v223
    v_mul_f32 v213, v213, v223
    v_cvt_pk_bf16_f32 v210, v210, v210
    v_cvt_pk_bf16_f32 v211, v211, v211
    v_cvt_pk_bf16_f32 v212, v212, v212
    v_cvt_pk_bf16_f32 v213, v213, v213
    s_cbranch_vccnz C_pr
C_pd:
    v_mfma_f32_16x16x32_bf16 v[62:65], v[126:129], v[78:81], 0
    v_and_b32 v86, v36, v210
    v_and_b32 v87, v37, v211
    v_mfma_f32_16x16x32_bf16 v[66:69], v[132:135], v[78:81], 0
    v_and_b32 v88, v38, v210
    v_and_b32 v89, v39, v211
    v_mfma_f32_16x16x32_bf16 v[70:73], v[128:131], v[82:85], 0
    v_and_b32 v90, v36, v212
    v_and_b32 v91, v37, v213
    v_mfma_f32_16x16x32_bf16 v[74:77], v[134:137], v[82:85], 0
    v_and_b32 v92, v38, v212
    v_and_b32 v93, v39, v213
    v_mfma_f32_16x16x32_bf16 v[62:65], v[226:229], v[86:89], v[62:65]
    v_mfma_f32_16x16x32_bf16 v[66:69], v[232:235], v[86:89], v[66:69]
    v_mfma_f32_16x16x32_bf16 v[70:73], v[228:231], v[90:93], v[70:73]
    v_mfma_f32_16x16x32_bf16 v[74:77], v[234:237], v[90:93], v[74:77]
    s_cmp_eq_u32 s63, 0
    s_cbranch_scc1 SM_sO
    s_nop 2
    v_cvt_pk_bf16_f32 v54, v62, v63
    v_cvt_pk_bf16_f32 v55, v64, v65
    v_cvt_pk_bf16_f32 v56, v66, v67
    v_cvt_pk_bf16_f32 v57, v68, v69
    buffer_store_dwordx4 v[54:57], v4, s[36:39], s100 offen nt
    v_cvt_pk_bf16_f32 v58, v70, v71
    v_cvt_pk_bf16_f32 v59, v72, v73
    v_cvt_pk_bf16_f32 v60, v74, v75
    v_cvt_pk_bf16_f32 v61, v76, v77
    buffer_store_dwordx4 v[58:61], v4, s[36:39], s19 offen nt
SM_jO:
    v_cmp_gt_u32 vcc, 4, v7
    s_nop 0
    s_cbranch_vccz W_dW
    s_mov_b32 s9, 0
        W_lW:
    ds_read_b32 v2, v5 offset:12
    s_add_u32 s9, s9, 1
    s_cmp_gt_u32 s9, 1600000
    s_cbranch_scc1 W_dW
    s_waitcnt lgkmcnt(0)
    v_cmp_gt_u32 vcc, 4, v2
    s_nop 0
    s_cbranch_vccnz W_lW
        W_dW:

    ds_read_b64_tr_b16 v[76:77], v16 offset:0
    ds_read_b64_tr_b16 v[78:79], v16 offset:2048
    ds_read_b64_tr_b16 v[80:81], v17 offset:0
    ds_read_b64_tr_b16 v[82:83], v17 offset:2048
    ds_read_b64_tr_b16 v[84:85], v18 offset:0
    ds_read_b64_tr_b16 v[86:87], v18 offset:2048
    ds_read_b64_tr_b16 v[88:89], v19 offset:0
    ds_read_b64_tr_b16 v[90:91], v19 offset:2048
    ds_read_b64_tr_b16 v[92:93], v16 offset:4096
    ds_read_b64_tr_b16 v[94:95], v16 offset:6144
    ds_read_b64_tr_b16 v[96:97], v17 offset:4096
    ds_read_b64_tr_b16 v[98:99], v17 offset:6144
    ds_read_b64_tr_b16 v[100:101], v18 offset:4096
    ds_read_b64_tr_b16 v[102:103], v18 offset:6144
    ds_read_b64_tr_b16 v[104:105], v19 offset:4096
    ds_read_b64_tr_b16 v[106:107], v19 offset:6144
    ds_read_b64_tr_b16 v[108:109], v16 offset:8192
    ds_read_b64_tr_b16 v[110:111], v16 offset:10240
    ds_read_b64_tr_b16 v[112:113], v17 offset:8192
    ds_read_b64_tr_b16 v[114:115], v17 offset:10240
    ds_read_b64_tr_b16 v[116:117], v18 offset:8192
    ds_read_b64_tr_b16 v[118:119], v18 offset:10240
    ds_read_b64_tr_b16 v[120:121], v19 offset:8192
    ds_read_b64_tr_b16 v[122:123], v19 offset:10240
    ds_read_b64_tr_b16 v[124:125], v16 offset:12288
    ds_read_b64_tr_b16 v[126:127], v16 offset:14336
    ds_read_b64_tr_b16 v[128:129], v17 offset:12288
    ds_read_b64_tr_b16 v[130:131], v17 offset:14336
    ds_read_b64_tr_b16 v[132:133], v18 offset:12288
    ds_read_b64_tr_b16 v[134:135], v18 offset:14336
    ds_read_b64_tr_b16 v[136:137], v19 offset:12288
    ds_read_b64_tr_b16 v[138:139], v19 offset:14336
    s_waitcnt vmcnt(0)
    s_mov_b64 exec, 1
    s_cmp_eq_u32 s63, 0
    s_cbranch_scc1 SM_sF
    buffer_store_dwordx2 v[14:15], v6, s[36:39], s21 offen
SM_jF:
    s_mov_b64 exec, -1
    ds_read_b64_tr_b16 v[140:141], v16 offset:16384
    ds_read_b64_tr_b16 v[142:143], v16 offset:18432
    ds_read_b64_tr_b16 v[144:145], v17 offset:16384
    ds_read_b64_tr_b16 v[146:147], v17 offset:18432
    ds_read_b64_tr_b16 v[148:149], v18 offset:16384
    ds_read_b64_tr_b16 v[150:151], v18 offset:18432
    ds_read_b64_tr_b16 v[152:153], v19 offset:16384
    ds_read_b64_tr_b16 v[154:155], v19 offset:18432
    ds_read_b64_tr_b16 v[156:157], v16 offset:20480
    ds_read_b64_tr_b16 v[158:159], v16 offset:22528
    ds_read_b64_tr_b16 v[160:161], v17 offset:20480
    ds_read_b64_tr_b16 v[162:163], v17 offset:22528
    ds_read_b64_tr_b16 v[164:165], v18 offset:20480
    ds_read_b64_tr_b16 v[166:167], v18 offset:22528
    ds_read_b64_tr_b16 v[168:169], v19 offset:20480
    ds_read_b64_tr_b16 v[170:171], v19 offset:22528
    ds_read_b64_tr_b16 v[172:173], v16 offset:24576
    ds_read_b64_tr_b16 v[174:175], v16 offset:26624
    ds_read_b64_tr_b16 v[176:177], v17 offset:24576
    ds_read_b64_tr_b16 v[178:179], v17 offset:26624
    ds_read_b64_tr_b16 v[180:181], v18 offset:24576
    ds_read_b64_tr_b16 v[182:183], v18 offset:26624
    ds_read_b64_tr_b16 v[184:185], v19 offset:24576
    ds_read_b64_tr_b16 v[186:187], v19 offset:26624
    buffer_load_dwordx2 v[12:13], v8, s[36:39], s20 offen sc1
    ds_read_b64_tr_b16 v[188:189], v16 offset:28672
    ds_read_b64_tr_b16 v[190:191], v16 offset:30720
    ds_read_b64_tr_b16 v[192:193], v17 offset:28672
    ds_read_b64_tr_b16 v[194:195], v17 offset:30720
    ds_read_b64_tr_b16 v[196:197], v18 offset:28672
    ds_read_b64_tr_b16 v[198:199], v18 offset:30720
    ds_read_b64_tr_b16 v[200:201], v19 offset:28672
    ds_read_b64_tr_b16 v[202:203], v19 offset:30720
    ds_read_b64_tr_b16 v[204:205], v16 offset:32768
    ds_read_b64_tr_b16 v[206:207], v16 offset:34816
    ds_read_b64_tr_b16 v[208:209], v17 offset:32768
    ds_read_b64_tr_b16 v[210:211], v17 offset:34816
    ds_read_b64_tr_b16 v[212:213], v18 offset:32768
    ds_read_b64_tr_b16 v[214:215], v18 offset:34816
    ds_read_b64_tr_b16 v[216:217], v19 offset:32768
    ds_read_b64_tr_b16 v[218:219], v19 offset:34816
    ds_read_b64_tr_b16 v[220:221], v16 offset:36864
    ds_read_b64_tr_b16 v[222:223], v16 offset:38912
    ds_read_b64_tr_b16 v[224:225], v17 offset:36864
    ds_read_b64_tr_b16 v[226:227], v17 offset:38912
    ds_read_b64_tr_b16 v[228:229], v18 offset:36864
    ds_read_b64_tr_b16 v[230:231], v18 offset:38912
    ds_read_b64_tr_b16 v[232:233], v19 offset:36864
    ds_read_b64_tr_b16 v[234:235], v19 offset:38912
    s_mov_b32 s9, 0
        P_lO:
    s_waitcnt vmcnt(0)
    v_cmp_ne_u64 vcc, s[12:13], v[12:13]
    s_nop 0
    s_cbranch_vccz P_dO
    buffer_load_dwordx2 v[12:13], v8, s[36:39], s20 offen sc1
    s_add_u32 s9, s9, 1
    s_cmp_lt_u32 s9, 200000
    s_cbranch_scc1 P_lO
    s_waitcnt vmcnt(0)
        P_dO:

    buffer_load_dwordx4 v[40:43], v4, s[36:39], s22 offen offset:0 sc1
    buffer_load_dwordx4 v[44:47], v4, s[36:39], s22 offen offset:1024 sc1
    buffer_load_dwordx4 v[48:51], v4, s[36:39], s22 offen offset:2048 sc1
    buffer_load_dwordx4 v[52:55], v4, s[36:39], s22 offen offset:3072 sc1
    s_add_u32 s22, s22, 4096
    buffer_load_dwordx4 v[56:59], v4, s[36:39], s22 offen offset:0 sc1
    buffer_load_dwordx4 v[60:63], v4, s[36:39], s22 offen offset:1024 sc1
    s_waitcnt lgkmcnt(0)
    s_mov_b32 s9, 0
        W_lW2:
    ds_read_b32 v2, v5 offset:36
    s_add_u32 s9, s9, 1
    s_cmp_gt_u32 s9, 1600000
    s_cbranch_scc1 W_dW2
    s_waitcnt lgkmcnt(0)
    v_cmp_gt_u32 vcc, 4, v2
    s_nop 0
    s_cbranch_vccnz W_lW2
        W_dW2:

    s_waitcnt vmcnt(5)
    v_mfma_f32_16x16x32_bf16 v[24:27], v[76:79], v[40:43], 0
    buffer_load_dwordx4 v[64:67], v4, s[36:39], s22 offen offset:2048 sc1
    ds_read_b64_tr_b16 v[76:77], v16 offset:40960
    ds_read_b64_tr_b16 v[78:79], v16 offset:43008
    v_mfma_f32_16x16x32_bf16 v[28:31], v[80:83], v[40:43], 0
    ds_read_b64_tr_b16 v[80:81], v17 offset:40960
    ds_read_b64_tr_b16 v[82:83], v17 offset:43008
    v_mfma_f32_16x16x32_bf16 v[32:35], v[84:87], v[40:43], 0
    ds_read_b64_tr_b16 v[84:85], v18 offset:40960
    ds_read_b64_tr_b16 v[86:87], v18 offset:43008
    v_mfma_f32_16x16x32_bf16 v[36:39], v[88:91], v[40:43], 0
    ds_read_b64_tr_b16 v[88:89], v19 offset:40960
    ds_read_b64_tr_b16 v[90:91], v19 offset:43008
    s_waitcnt vmcnt(5)
    v_mfma_f32_16x16x32_bf16 v[24:27], v[92:95], v[44:47], v[24:27]
    buffer_load_dwordx4 v[68:71], v4, s[36:39], s22 offen offset:3072 sc1
    s_add_u32 s22, s22, 4096
    ds_read_b64_tr_b16 v[92:93], v16 offset:45056
    ds_read_b64_tr_b16 v[94:95], v16 offset:47104
    v_mfma_f32_16x16x32_bf16 v[28:31], v[96:99], v[44:47], v[28:31]
    ds_read_b64_tr_b16 v[96:97], v17 offset:45056
    ds_read_b64_tr_b16 v[98:99], v17 offset:47104
    v_mfma_f32_16x16x32_bf16 v[32:35], v[100:103], v[44:47], v[32:35]
    ds_read_b64_tr_b16 v[100:101], v18 offset:45056
    ds_read_b64_tr_b16 v[102:103], v18 offset:47104
    v_mfma_f32_16x16x32_bf16 v[36:39], v[104:107], v[44:47], v[36:39]
    ds_read_b64_tr_b16 v[104:105], v19 offset:45056
    ds_read_b64_tr_b16 v[106:107], v19 offset:47104
    s_waitcnt vmcnt(5)
    v_mfma_f32_16x16x32_bf16 v[24:27], v[108:111], v[48:51], v[24:27]
    buffer_load_dwordx4 v[72:75], v4, s[36:39], s22 offen offset:0 sc1
    ds_read_b64_tr_b16 v[108:109], v16 offset:49152
    ds_read_b64_tr_b16 v[110:111], v16 offset:51200
    v_mfma_f32_16x16x32_bf16 v[28:31], v[112:115], v[48:51], v[28:31]
    ds_read_b64_tr_b16 v[112:113], v17 offset:49152
    ds_read_b64_tr_b16 v[114:115], v17 offset:51200
    v_mfma_f32_16x16x32_bf16 v[32:35], v[116:119], v[48:51], v[32:35]
    ds_read_b64_tr_b16 v[116:117], v18 offset:49152
    ds_read_b64_tr_b16 v[118:119], v18 offset:51200
    v_mfma_f32_16x16x32_bf16 v[36:39], v[120:123], v[48:51], v[36:39]
    ds_read_b64_tr_b16 v[120:121], v19 offset:49152
    ds_read_b64_tr_b16 v[122:123], v19 offset:51200
    s_waitcnt vmcnt(5)
    v_mfma_f32_16x16x32_bf16 v[24:27], v[124:127], v[52:55], v[24:27]
    buffer_load_dwordx4 v[40:43], v4, s[36:39], s22 offen offset:1024 sc1
    ds_read_b64_tr_b16 v[124:125], v16 offset:53248
    ds_read_b64_tr_b16 v[126:127], v16 offset:55296
    v_mfma_f32_16x16x32_bf16 v[28:31], v[128:131], v[52:55], v[28:31]
    ds_read_b64_tr_b16 v[128:129], v17 offset:53248
    ds_read_b64_tr_b16 v[130:131], v17 offset:55296
    v_mfma_f32_16x16x32_bf16 v[32:35], v[132:135], v[52:55], v[32:35]
    ds_read_b64_tr_b16 v[132:133], v18 offset:53248
    ds_read_b64_tr_b16 v[134:135], v18 offset:55296
    v_mfma_f32_16x16x32_bf16 v[36:39], v[136:139], v[52:55], v[36:39]
    ds_read_b64_tr_b16 v[136:137], v19 offset:53248
    ds_read_b64_tr_b16 v[138:139], v19 offset:55296
    s_waitcnt vmcnt(5)
    v_mfma_f32_16x16x32_bf16 v[24:27], v[140:143], v[56:59], v[24:27]
    buffer_load_dwordx4 v[44:47], v4, s[36:39], s22 offen offset:2048 sc1
    v_mfma_f32_16x16x32_bf16 v[28:31], v[144:147], v[56:59], v[28:31]
    v_mfma_f32_16x16x32_bf16 v[32:35], v[148:151], v[56:59], v[32:35]
    v_mfma_f32_16x16x32_bf16 v[36:39], v[152:155], v[56:59], v[36:39]
    s_waitcnt vmcnt(5)
    v_mfma_f32_16x16x32_bf16 v[24:27], v[156:159], v[60:63], v[24:27]
    buffer_load_dwordx4 v[48:51], v4, s[36:39], s22 offen offset:3072 sc1
    s_add_u32 s22, s22, 4096
    v_mfma_f32_16x16x32_bf16 v[28:31], v[160:163], v[60:63], v[28:31]
    v_mfma_f32_16x16x32_bf16 v[32:35], v[164:167], v[60:63], v[32:35]
    v_mfma_f32_16x16x32_bf16 v[36:39], v[168:171], v[60:63], v[36:39]
    s_waitcnt vmcnt(5)
    v_mfma_f32_16x16x32_bf16 v[24:27], v[172:175], v[64:67], v[24:27]
    buffer_load_dwordx4 v[52:55], v4, s[36:39], s22 offen offset:0 sc1
    v_mfma_f32_16x16x32_bf16 v[28:31], v[176:179], v[64:67], v[28:31]
    v_mfma_f32_16x16x32_bf16 v[32:35], v[180:183], v[64:67], v[32:35]
    v_mfma_f32_16x16x32_bf16 v[36:39], v[184:187], v[64:67], v[36:39]
    s_waitcnt vmcnt(5)
    v_mfma_f32_16x16x32_bf16 v[24:27], v[188:191], v[68:71], v[24:27]
    buffer_load_dwordx4 v[56:59], v4, s[36:39], s22 offen offset:1024 sc1
    v_mfma_f32_16x16x32_bf16 v[28:31], v[192:195], v[68:71], v[28:31]
    v_mfma_f32_16x16x32_bf16 v[32:35], v[196:199], v[68:71], v[32:35]
    v_mfma_f32_16x16x32_bf16 v[36:39], v[200:203], v[68:71], v[36:39]
    s_waitcnt vmcnt(5)
    v_mfma_f32_16x16x32_bf16 v[24:27], v[204:207], v[72:75], v[24:27]
    v_mfma_f32_16x16x32_bf16 v[28:31], v[208:211], v[72:75], v[28:31]
    v_mfma_f32_16x16x32_bf16 v[32:35], v[212:215], v[72:75], v[32:35]
    v_mfma_f32_16x16x32_bf16 v[36:39], v[216:219], v[72:75], v[36:39]
    s_waitcnt vmcnt(4)
    v_mfma_f32_16x16x32_bf16 v[24:27], v[220:223], v[40:43], v[24:27]
    v_mfma_f32_16x16x32_bf16 v[28:31], v[224:227], v[40:43], v[28:31]
    v_mfma_f32_16x16x32_bf16 v[32:35], v[228:231], v[40:43], v[32:35]
    v_mfma_f32_16x16x32_bf16 v[36:39], v[232:235], v[40:43], v[36:39]
    s_waitcnt vmcnt(3)
    s_waitcnt lgkmcnt(15)
    v_mfma_f32_16x16x32_bf16 v[24:27], v[76:79], v[44:47], v[24:27]
    v_mfma_f32_16x16x32_bf16 v[28:31], v[80:83], v[44:47], v[28:31]
    v_mfma_f32_16x16x32_bf16 v[32:35], v[84:87], v[44:47], v[32:35]
    v_mfma_f32_16x16x32_bf16 v[36:39], v[88:91], v[44:47], v[36:39]
    s_waitcnt vmcnt(2)
    v_mfma_f32_16x16x32_bf16 v[24:27], v[92:95], v[48:51], v[24:27]
    v_mfma_f32_16x16x32_bf16 v[28:31], v[96:99], v[48:51], v[28:31]
    v_mfma_f32_16x16x32_bf16 v[32:35], v[100:103], v[48:51], v[32:35]
    v_mfma_f32_16x16x32_bf16 v[36:39], v[104:107], v[48:51], v[36:39]
    s_waitcnt vmcnt(1)
    s_waitcnt lgkmcnt(14)
    v_mfma_f32_16x16x32_bf16 v[24:27], v[108:111], v[52:55], v[24:27]
    s_waitcnt lgkmcnt(12)
    v_mfma_f32_16x16x32_bf16 v[28:31], v[112:115], v[52:55], v[28:31]
    s_waitcnt lgkmcnt(10)
    v_mfma_f32_16x16x32_bf16 v[32:35], v[116:119], v[52:55], v[32:35]
    s_waitcnt lgkmcnt(8)
    v_mfma_f32_16x16x32_bf16 v[36:39], v[120:123], v[52:55], v[36:39]
    s_waitcnt vmcnt(0)
    s_waitcnt lgkmcnt(6)
    v_mfma_f32_16x16x32_bf16 v[24:27], v[124:127], v[56:59], v[24:27]
    s_waitcnt lgkmcnt(4)
    v_mfma_f32_16x16x32_bf16 v[28:31], v[128:131], v[56:59], v[28:31]
    s_waitcnt lgkmcnt(2)
    v_mfma_f32_16x16x32_bf16 v[32:35], v[132:135], v[56:59], v[32:35]
    s_waitcnt lgkmcnt(0)
    v_mfma_f32_16x16x32_bf16 v[36:39], v[136:139], v[56:59], v[36:39]
    s_nop 1
    v_cvt_pk_bf16_f32 v156, v24, v25
    v_cvt_pk_bf16_f32 v157, v26, v27
    ds_write_b64 v20, v[156:157]
    v_cvt_pk_bf16_f32 v158, v28, v29
    v_cvt_pk_bf16_f32 v159, v30, v31
    ds_write_b64 v21, v[158:159]
    v_cvt_pk_bf16_f32 v160, v32, v33
    v_cvt_pk_bf16_f32 v161, v34, v35
    ds_write_b64 v22, v[160:161]
    v_cvt_pk_bf16_f32 v162, v36, v37
    v_cvt_pk_bf16_f32 v163, v38, v39
    ds_write_b64 v23, v[162:163]
    ds_read_b128 v[172:175], v9
    ds_read_b128 v[176:179], v9 offset:1024
    s_waitcnt lgkmcnt(1)
    buffer_store_dwordx4 v[172:175], v10, s[32:35], s23 offen nt
    s_waitcnt lgkmcnt(0)
    buffer_store_dwordx4 v[176:179], v10, s[32:35], s28 offen nt

    s_add_u32 s40, s7, s62
    s_cmp_lg_u32 s40, 0
    s_cbranch_scc1 C_end
    s_add_u32 s40, s10, 16
    v_mov_b32 v2, s40
    s_lshl_b32 s40, s8, 7
    s_mov_b64 exec, 1
    buffer_store_dword v2, v6, s[36:39], s40 offen
        C_end:

    s_endpgm
X_cH:
    s_mov_b32 s9, 0
        X_lH:
    v_cmp_ne_u64 vcc, s[28:29], v[18:19]
    s_nop 0
    s_cbranch_vccz X_okH
    v_subrev_u32 v18, s12, v18
    v_cmp_ne_u32 s[42:43], s13, v19
    v_cmp_le_u32 vcc, 8, v18
    s_nop 0
    s_or_b64 vcc, vcc, s[42:43]
    s_cbranch_vccz X_nH
    buffer_load_dwordx2 v[18:19], v20, s[36:39], s30 offen sc1
    s_add_u32 s9, s9, 1
    s_cmp_lt_u32 s9, 200000
    s_waitcnt vmcnt(0)
    s_cbranch_scc1 X_lH
        X_nH:
    s_mov_b32 s101, 0
    s_branch X_okH
S_cls0:
    s_cmp_eq_u32 s57, 0
    s_cbranch_scc0 S_cls1
    v_cmp_eq_u32 s[42:43], 0, v3
    v_mov_b32 v4, 0x3f80
    s_nop 0
    v_cndmask_b32 v28, v28, v4, s[42:43]
    v_mov_b32 v32, 0
    v_mov_b32 v40, 0
    v_cndmask_b32 v29, v29, v4, s[42:43]
    v_mov_b32 v33, 0
    v_mov_b32 v41, 0
    v_cndmask_b32 v30, v30, v4, s[42:43]
    v_mov_b32 v34, 0
    v_mov_b32 v42, 0
    v_cndmask_b32 v31, v31, v4, s[42:43]
    v_mov_b32 v35, 0
    v_mov_b32 v43, 0
    s_branch S_reg
S_cls1:
    v_mov_b32 v32, v28
    v_mov_b32 v28, 0
    v_mov_b32 v40, v36
    v_mov_b32 v36, 0
    v_mov_b32 v33, v29
    v_mov_b32 v29, 0
    v_mov_b32 v41, v37
    v_mov_b32 v37, 0
    v_mov_b32 v34, v30
    v_mov_b32 v30, 0
    v_mov_b32 v42, v38
    v_mov_b32 v38, 0
    v_mov_b32 v35, v31
    v_mov_b32 v31, 0
    v_mov_b32 v43, v39
    v_mov_b32 v39, 0
    s_branch S_reg
S_gr:
    s_add_u32 s9, s9, 1
    s_cmp_gt_u32 s9, 200000
    s_cbranch_scc1 S_gk
    buffer_load_dwordx4 v44, s[36:39], s60 offen offset:0 sc1 lds
    buffer_load_dwordx4 v45, s[36:39], s60 offen offset:1024 sc1 lds
    buffer_load_dwordx4 v44, s[36:39], s60 offen offset:2048 sc1 lds
    buffer_load_dwordx4 v45, s[36:39], s60 offen offset:3072 sc1 lds
    s_branch S_gc
S_x0:
    v_cmp_eq_u32 s[42:43], 0, v3
    v_mov_b32 v4, 0x3f800000
    s_nop 0
    v_cndmask_b32 v32, 0, v4, s[42:43]
    v_cndmask_b32 v33, 0, v4, s[42:43]
    v_cndmask_b32 v34, 0, v4, s[42:43]
    v_cndmask_b32 v35, 0, v4, s[42:43]
    s_nop 1
    v_mfma_f32_16x16x32_bf16 v[170:173], v[166:169], v[32:35], 0
    v_mfma_f32_16x16x32_bf16 v[178:181], v[174:177], v[32:35], 0
    v_mfma_f32_16x16x32_bf16 v[186:189], v[182:185], v[32:35], 0
    v_mfma_f32_16x16x32_bf16 v[194:197], v[190:193], v[32:35], 0
    s_lshl_b32 s40, s3, 11
    s_add_u32 s40, s40, 32768
    v_add_u32 v4, s40, v47
    s_nop 1
    v_cvt_pk_bf16_f32 v36, v170, v171
    v_cvt_pk_bf16_f32 v37, v172, v173
    v_cvt_pk_bf16_f32 v38, v178, v179
    v_cvt_pk_bf16_f32 v39, v180, v181
    ds_write_b128 v4, v[36:39] offset:32768
    v_cvt_pk_bf16_f32 v40, v186, v187
    v_cvt_pk_bf16_f32 v41, v188, v189
    v_cvt_pk_bf16_f32 v42, v194, v195
    v_cvt_pk_bf16_f32 v43, v196, v197
    ds_write_b128 v4, v[40:43] offset:33792
    s_branch S_x1
S_y0:
    v_add_u32 v4, 32768, v47
    ds_read_b128 v[166:169], v4 offset:32768
    ds_read_b128 v[170:173], v4 offset:33792
    ds_read_b128 v[174:177], v4 offset:34816
    ds_read_b128 v[178:181], v4 offset:35840
    ds_read_b128 v[182:185], v4 offset:36864
    ds_read_b128 v[186:189], v4 offset:37888
    ds_read_b128 v[190:193], v4 offset:38912
    ds_read_b128 v[194:197], v4 offset:39936
    s_waitcnt lgkmcnt(0)
    v_mfma_f32_16x16x32_bf16 v[206:209], v[102:105], v[166:169], v[206:209]
    v_mfma_f32_16x16x32_bf16 v[206:209], v[106:109], v[170:173], v[206:209]
    v_mfma_f32_16x16x32_bf16 v[210:213], v[110:113], v[174:177], v[210:213]
    v_mfma_f32_16x16x32_bf16 v[210:213], v[114:117], v[178:181], v[210:213]
    v_mfma_f32_16x16x32_bf16 v[222:225], v[134:137], v[182:185], v[222:225]
    v_mfma_f32_16x16x32_bf16 v[222:225], v[138:141], v[186:189], v[222:225]
    v_mfma_f32_16x16x32_bf16 v[226:229], v[142:145], v[190:193], v[226:229]
    v_mfma_f32_16x16x32_bf16 v[226:229], v[146:149], v[194:197], v[226:229]
    s_nop 7
    s_branch S_y1
C_mr0:
    s_mov_b32 s9, 0
        W_lM0:
    ds_read_b32 v2, v5 offset:4
    s_add_u32 s9, s9, 1
    s_cmp_gt_u32 s9, 1600000
    s_cbranch_scc1 W_dM0
    s_waitcnt lgkmcnt(0)
    v_cmp_gt_u32 vcc, 1, v2
    s_nop 0
    s_cbranch_vccnz W_lM0
        W_dM0:

    s_waitcnt lgkmcnt(0)
    v_readfirstlane_b32 s63, v2
    s_nop 0
    s_lshr_b32 s63, s63, 1
    s_branch C_md0
SM_sS0:
    buffer_store_dwordx4 v[94:97], v4, s[36:39], s15 offen sc1
    s_branch SM_jS0
C_vr0:
    s_mov_b32 s9, 0
        W_lV0:
    ds_read_b32 v2, v5 offset:32
    s_add_u32 s9, s9, 1
    s_cmp_gt_u32 s9, 1600000
    s_cbranch_scc1 W_dV0
    s_waitcnt lgkmcnt(0)
    v_cmp_gt_u32 vcc, 4, v2
    s_nop 0
    s_cbranch_vccnz W_lV0
        W_dV0:

    ds_read_b64_tr_b16 v[166:167], v34 offset:32768
    ds_read_b64_tr_b16 v[168:169], v34 offset:33280
    ds_read_b64_tr_b16 v[170:171], v35 offset:32768
    ds_read_b64_tr_b16 v[172:173], v35 offset:33280
    ds_read_b64_tr_b16 v[198:199], v34 offset:36864
    ds_read_b64_tr_b16 v[200:201], v34 offset:37376
    ds_read_b64_tr_b16 v[202:203], v35 offset:36864
    ds_read_b64_tr_b16 v[204:205], v35 offset:37376
    s_waitcnt lgkmcnt(0)
    s_branch C_vd0
C_mr1:
    s_mov_b32 s9, 0
        W_lM1:
    ds_read_b32 v2, v5 offset:4
    s_add_u32 s9, s9, 1
    s_cmp_gt_u32 s9, 1600000
    s_cbranch_scc1 W_dM1
    s_waitcnt lgkmcnt(0)
    v_cmp_gt_u32 vcc, 1, v2
    s_nop 0
    s_cbranch_vccnz W_lM1
        W_dM1:

    s_waitcnt lgkmcnt(0)
    v_readfirstlane_b32 s63, v2
    s_nop 0
    s_lshr_b32 s63, s63, 1
    s_branch C_md1
SM_sS1:
    buffer_store_dwordx4 v[94:97], v4, s[36:39], s15 offen sc1
    s_branch SM_jS1
C_vr1:
    s_mov_b32 s9, 0
        W_lV1:
    ds_read_b32 v2, v5 offset:32
    s_add_u32 s9, s9, 1
    s_cmp_gt_u32 s9, 1600000
    s_cbranch_scc1 W_dV1
    s_waitcnt lgkmcnt(0)
    v_cmp_gt_u32 vcc, 4, v2
    s_nop 0
    s_cbranch_vccnz W_lV1
        W_dV1:

    ds_read_b64_tr_b16 v[166:167], v34 offset:32768
    ds_read_b64_tr_b16 v[168:169], v34 offset:33280
    ds_read_b64_tr_b16 v[170:171], v35 offset:32768
    ds_read_b64_tr_b16 v[172:173], v35 offset:33280
    ds_read_b64_tr_b16 v[198:199], v34 offset:36864
    ds_read_b64_tr_b16 v[200:201], v34 offset:37376
    ds_read_b64_tr_b16 v[202:203], v35 offset:36864
    ds_read_b64_tr_b16 v[204:205], v35 offset:37376
    s_waitcnt lgkmcnt(0)
    s_branch C_vd1
C_pr:
    s_mov_b32 s9, 0
        C_pl:
    ds_read_b32 v48, v47 offset:40
    ds_read_b128 v[78:81], v43 offset:12288
    ds_read_b128 v[82:85], v43 offset:13312
    s_add_u32 s9, s9, 1
    s_cmp_gt_u32 s9, 1600000
    s_waitcnt lgkmcnt(0)
    s_cbranch_scc1 C_pd
    v_cmp_eq_u32 vcc, 0, v48
    s_nop 0
    s_cbranch_vccnz C_pl
    s_branch C_pd
SM_sO:
    s_nop 7
    v_cvt_pk_bf16_f32 v54, v62, v63
    v_cvt_pk_bf16_f32 v55, v64, v65
    v_cvt_pk_bf16_f32 v56, v66, v67
    v_cvt_pk_bf16_f32 v57, v68, v69
    buffer_store_dwordx4 v[54:57], v4, s[36:39], s100 offen sc1
    v_cvt_pk_bf16_f32 v58, v70, v71
    v_cvt_pk_bf16_f32 v59, v72, v73
    v_cvt_pk_bf16_f32 v60, v74, v75
    v_cvt_pk_bf16_f32 v61, v76, v77
    buffer_store_dwordx4 v[58:61], v4, s[36:39], s19 offen sc1
    s_branch SM_jO
SM_sF:
    buffer_store_dwordx2 v[14:15], v6, s[36:39], s21 offen sc1
    s_branch SM_jF
K_exit:
    s_endpgm
.fill 7168, 4, 0xbf810000
.section .rodata,"a"
.p2align 6
.amdhsa_kernel concat_heads__sliding_local_dilated__spectral_fnet__prompt_kernel
  .amdhsa_next_free_vgpr 256
  .amdhsa_next_free_sgpr 102
  .amdhsa_accum_offset 256
  .amdhsa_group_segment_fixed_size 0
  .amdhsa_kernarg_size 88
  .amdhsa_user_sgpr_count 2
  .amdhsa_user_sgpr_kernarg_segment_ptr 1
  .amdhsa_system_sgpr_workgroup_id_x 1
.end_amdhsa_kernel
```

```asm
; @launch grid=(256,1,1) block=(512,1,1) lds=163840
.amdgcn_target "amdgcn-amd-amdhsa--gfx950"
.text
.p2align 12
.fill 832, 4, 0xbf810000
.globl concat_heads__sliding_local_dilated__spectral_fnet__prompt_kernel
.p2align 8
.type concat_heads__sliding_local_dilated__spectral_fnet__prompt_kernel,@function
concat_heads__sliding_local_dilated__spectral_fnet__prompt_kernel:
    s_load_dwordx2 s[16:17], s[0:1], 0
    s_load_dwordx2 s[20:21], s[0:1], 8
    s_load_dwordx2 s[28:29], s[0:1], 24
    s_load_dwordx2 s[36:37], s[0:1], 80
    s_load_dwordx2 s[24:25], s[0:1], 16
    s_load_dwordx2 s[32:33], s[0:1], 64
    v_lshrrev_b32 v1, 6, v0
    s_cmp_ge_u32 s2, 256
    s_cbranch_scc1 K_exit
    v_readfirstlane_b32 s3, v1
    s_and_b32 s4, s2, 7
    s_lshr_b32 s5, s2, 3
    s_sub_u32 s5, s5, 4
    s_and_b32 s5, s5, 31
    s_cmp_lg_u32 s3, 7
    s_cbranch_scc1 K_nopf
    s_getpc_b64 s[44:45]
    s_mov_b32 s46, 28672
    s_mov_b32 s47, 0x00020000
    s_mul_i32 s40, s5, 896
    v_and_b32 v1, 63, v0
    v_min_u32 v1, 6, v1
    v_lshlrev_b32 v1, 7, v1
    buffer_load_dword v255, v1, s[44:47], s40 offen
        K_nopf:
    s_mul_i32 s6, s5, 37
    s_lshr_b32 s6, s6, 8
    s_mul_i32 s40, s6, 7
    s_sub_u32 s7, s5, s40
    s_mov_b32 s38, 0x10000000
    s_mov_b32 s39, 0x00020000
    s_lshl_b32 s8, s4, 2
    s_cmp_lt_u32 s5, 28
    s_cbranch_scc1 K_a

    s_add_u32 s8, s8, s7
    s_mov_b32 s30, 1835008
    s_mov_b32 s31, 0x00020000
    s_lshl_b32 s40, s3, 7
    s_add_u32 s40, s40, s8
    v_and_b32 v4, 32, v0
    v_add_u32 v4, s40, v4
    v_and_b32 v5, 31, v0
    v_lshlrev_b32 v5, 4, v5
    v_mov_b32 v6, 896
    v_mad_u32_u24 v7, v4, v6, v5
    v_add_u32 v5, 384, v5
    v_sub_u32 v8, 960, v4
    v_mad_u32_u24 v8, v8, v6, v5
    v_sub_u32 v9, 2048, v4
    v_and_b32 v9, 2047, v9
    v_mad_u32_u24 v9, v9, v6, v5
    s_lshl_b32 s42, s3, 13
    s_mov_b32 m0, s42
    s_mov_b32 s52, 57344
    s_mov_b32 s53, 917504
    s_mov_b32 s54, 974848
    s_waitcnt lgkmcnt(0)

    buffer_load_dwordx4 v7, s[28:31], 0 offen nt lds
    s_add_u32 m0, m0, 1024
    s_nop 0
    buffer_load_dwordx4 v7, s[28:31], s52 offen nt lds
    s_add_u32 m0, m0, 1024
    s_nop 0
    buffer_load_dwordx4 v9, s[28:31], 0 offen nt lds
    s_add_u32 m0, m0, 1024
    s_nop 0
    buffer_load_dwordx4 v8, s[28:31], s53 offen nt lds
    s_add_u32 m0, m0, 1024
    s_load_dwordx2 s[10:11], s[36:37], 4096
    s_branch K_spare2
K_a:
    s_add_u32 s8, s8, s6
    s_cmp_ge_u32 s3, 4
    s_cbranch_scc1 K_c
    s_setprio 2
    s_mov_b32 s44, s4
    s_add_u32 s44, s44, s7
    s_mul_i32 s40, s44, 65
    s_lshr_b32 s40, s40, 8
    s_mul_i32 s40, s40, 4
    s_sub_u32 s44, s44, s40
    s_lshl_b32 s44, s44, 2
    s_lshr_b32 s44, 0x6420, s44
    s_and_b32 s44, s44, 7
    s_mov_b32 s18, 1835008
    s_mov_b32 s19, 0x00020000
    s_mov_b32 s22, 1204224
    s_mov_b32 s23, 0x00020000
    v_and_b32 v1, 63, v0
    v_lshrrev_b32 v6, 3, v1
    v_and_b32 v7, 7, v1
    v_lshrrev_b32 v8, 4, v1
    v_xor_b32 v3, v7, v8
    v_mul_u32_u24 v23, 896, v6
    v_lshl_add_u32 v21, v3, 4, v23
    v_xor_b32 v22, 64, v21
    v_add_u32 v22, 6144, v22
    s_lshl_b32 s40, s3, 5
    v_xor_b32 v23, s40, v21
    v_and_b32 v2, 2, v6
    v_xor_b32 v2, v7, v2
    v_mul_u32_u24 v3, 2688, v6
    v_lshl_add_u32 v24, v2, 4, v3
    v_xor_b32 v25, 64, v24
    v_add_u32 v25, 20480, v25
    v_add_u32 v26, 896, v24
    v_add_u32 v27, 896, v25
    v_add_u32 v28, 1792, v24
    v_add_u32 v29, 1792, v25
    s_mov_b32 s45, s44
    s_lshl_b32 s40, s8, 6
    s_lshl_b32 s41, s3, 4
    s_add_u32 s42, s40, s41
    s_mul_i32 s46, s42, 896
    s_mul_i32 s48, s41, 2688
    s_lshl_b32 s42, s7, 7
    s_add_u32 s48, s48, s42
    s_sub_u32 s40, s40, 16
    s_max_i32 s40, s40, 0
    s_lshl_b32 s41, s3, 2
    s_add_u32 s40, s40, s41
    s_mul_i32 s47, s40, 896
    s_lshl_b32 s50, s3, 11
    s_lshl_b32 s49, s3, 9

    s_lshl_b32 s40, s44, 7
    s_add_u32 s51, s40, s46
    s_add_u32 s52, s40, s47
    s_mul_i32 s53, s44, 172032
    s_add_u32 s53, s53, s48
    s_add_u32 m0, s50, 2048
    s_add_u32 s44, s44, 1
    s_cmp_eq_u32 s44, 7
    s_cselect_b32 s44, 0, s44
    s_waitcnt lgkmcnt(0)
    buffer_load_dwordx4 v21, s[16:19], s51 offen lds
    buffer_load_dwordx4 v22, s[16:19], s51 offen offset:1024 lds
    s_add_u32 m0, s49, 0
    s_mov_b32 exec_hi, 0
    buffer_load_dwordx4 v23, s[16:19], s52 offen lds
    s_mov_b32 exec_hi, -1
    s_add_u32 m0, s50, 79872
    s_nop 0
    buffer_load_dwordx4 v24, s[20:23], s53 offen lds
    buffer_load_dwordx4 v25, s[20:23], s53 offen offset:1024 lds
    s_add_u32 m0, s50, 88064
    s_nop 0
    buffer_load_dwordx4 v26, s[20:23], s53 offen lds
    buffer_load_dwordx4 v27, s[20:23], s53 offen offset:1024 lds
    s_add_u32 m0, s50, 96256
    s_mul_i32 s53, s45, 172032
    s_add_u32 s53, s53, s48
    s_add_u32 s45, s45, 1
    s_cmp_eq_u32 s45, 7
    s_cselect_b32 s45, 0, s45
    buffer_load_dwordx4 v28, s[20:23], s53 offen lds
    buffer_load_dwordx4 v29, s[20:23], s53 offen offset:1024 lds
    s_lshl_b32 s40, s44, 7
    s_add_u32 s51, s40, s46
    s_add_u32 s52, s40, s47
    s_mul_i32 s53, s44, 172032
    s_add_u32 s53, s53, s48
    s_add_u32 m0, s50, 12288
    s_add_u32 s44, s44, 1
    s_cmp_eq_u32 s44, 7
    s_cselect_b32 s44, 0, s44
    buffer_load_dwordx4 v21, s[16:19], s51 offen lds
    buffer_load_dwordx4 v22, s[16:19], s51 offen offset:1024 lds
    s_lshl_b32 s56, s8, 7
    s_load_dwordx2 s[10:11], s[36:37], s56
    s_lshl_b32 s30, s8, 10
    s_add_u32 s30, s30, 65536
    s_getreg_b32 s28, hwreg(HW_REG_XCC_ID, 0, 3)
    v_min_u32 v20, 6, v1
    v_lshlrev_b32 v20, 3, v20
    s_mov_b32 s26, 401408
    s_mov_b32 s27, 0x00020000
    s_mov_b32 s34, 3670016
    s_mov_b32 s35, 0x00020000
    s_lshr_b32 s58, s3, 1
    s_and_b32 s59, s3, 1
    v_and_b32 v9, 15, v1
    v_mov_b32 v4, 0
    v_mov_b32 v14, 1
    v_mov_b32 v5, 161792
    v_and_b32 v50, 6, v6
    v_xor_b32 v50, v7, v50
    v_mul_u32_u24 v51, 896, v6
    v_lshl_add_u32 v10, v50, 4, v51
    v_add_u32 v11, 6144, v10
    s_mov_b32 s54, s6
    s_mul_i32 s55, s3, 14336
    s_lshl_b32 s56, s7, 7
    s_add_u32 s55, s55, s56
    s_and_b32 s56, s3, 1
    s_lshl_b32 s57, s7, 1
    s_add_u32 s56, s56, s57
    s_lshl_b32 s15, s56, 10
    s_lshl_b32 s56, s8, 2
    s_and_b32 s57, s3, 2
    s_add_u32 s56, s56, s57
    s_mul_i32 s57, s56, 14336
    s_add_u32 s15, s15, s57
    s_add_u32 s15, s15, 2097152
    s_lshl_b32 s100, s56, 6
    s_add_u32 s100, s100, 16384
    v_lshlrev_b32 v50, 7, v7
    v_and_b32 v51, 1, v6
    v_mul_u32_u24 v51, 14336, v51
    v_add3_u32 v12, v50, v51, s15
    v_mov_b32 v50, s100
    v_cmp_le_u32 vcc, 16, v1
    s_nop 1
    v_cndmask_b32 v12, v12, v50, vcc
    v_and_b32 v50, 1, v9
    v_cmp_eq_u32 s[42:43], 1, v50
    v_lshl_add_u32 v50, v8, 2, v50
    v_cmp_le_u32 s[0:1], v50, v9
    v_add_u32 v50, 2, v50
    v_cmp_le_u32 s[12:13], v50, v9
    v_mov_b32 v50, 0xffff
    v_mov_b32 v51, 0xffff0000
    v_cndmask_b32 v50, v50, v51, s[42:43]
    v_cndmask_b32 v52, v50, 0, s[0:1]
    v_cndmask_b32 v53, v50, 0, s[12:13]
    v_cndmask_b32 v54, 0, v50, s[0:1]
    v_cndmask_b32 v55, 0, v50, s[12:13]
    v_lshlrev_b32 v50, 4, v1
    s_add_u32 s56, s50, 4096
    v_add_u32 v56, s56, v50
    s_xor_b32 s56, s50, 2048
    s_add_u32 s56, s56, 4096
    v_add_u32 v57, s56, v50
    v_add_u32 v59, s50, v50
    v_lshl_add_u32 v58, s58, 3, v5
    v_lshl_add_u32 v60, s3, 2, v5
    s_cmp_eq_u32 s7, 3
    s_cselect_b32 s56, 0, 1.0
    v_mov_b32 v61, s56
    s_mov_b32 s31, 0x3e8b97f6
K_h2:
    s_add_u32 m0, s49, 10240
    s_mov_b32 exec_hi, 0
    buffer_load_dwordx4 v23, s[16:19], s52 offen lds
    s_mov_b32 exec_hi, -1
    s_add_u32 m0, s50, 104448
    s_nop 0
    buffer_load_dwordx4 v24, s[20:23], s53 offen lds
    buffer_load_dwordx4 v25, s[20:23], s53 offen offset:1024 lds
    s_add_u32 m0, s50, 112640
    s_nop 0
    buffer_load_dwordx4 v26, s[20:23], s53 offen lds
    buffer_load_dwordx4 v27, s[20:23], s53 offen offset:1024 lds
    s_add_u32 m0, s50, 120832
    s_mul_i32 s53, s45, 172032
    s_add_u32 s53, s53, s48
    s_add_u32 s45, s45, 1
    s_cmp_eq_u32 s45, 7
    s_cselect_b32 s45, 0, s45
    buffer_load_dwordx4 v28, s[20:23], s53 offen lds
    buffer_load_dwordx4 v29, s[20:23], s53 offen offset:1024 lds
    s_lshl_b32 s40, s44, 7
    s_add_u32 s51, s40, s46
    s_add_u32 s52, s40, s47
    s_mul_i32 s53, s44, 172032
    s_add_u32 s53, s53, s48
    s_add_u32 m0, s50, 22528
    s_add_u32 s44, s44, 1
    s_cmp_eq_u32 s44, 7
    s_cselect_b32 s44, 0, s44
    buffer_load_dwordx4 v21, s[16:19], s51 offen lds
    s_waitcnt lgkmcnt(0)
    s_add_u32 s12, s10, 0x5a3c9671
    s_xor_b32 s13, s11, 0x2b7e1516
    s_add_u32 s28, s28, s12
    s_mov_b32 s29, s13
    s_waitcnt vmcnt(10)
    s_barrier
    buffer_load_dwordx4 v22, s[16:19], s51 offen offset:1024 lds
    s_add_u32 m0, s49, 20480
    s_mov_b32 exec_hi, 0
    buffer_load_dwordx4 v23, s[16:19], s52 offen lds
    s_mov_b32 exec_hi, -1
    s_add_u32 m0, s50, 129024
    s_nop 0
    buffer_load_dwordx4 v24, s[20:23], s53 offen lds
    buffer_load_dwordx4 v25, s[20:23], s53 offen offset:1024 lds
    s_add_u32 m0, s50, 137216
    s_nop 0
    buffer_load_dwordx4 v26, s[20:23], s53 offen lds
    buffer_load_dwordx4 v27, s[20:23], s53 offen offset:1024 lds
    s_add_u32 m0, s50, 145408
    s_mul_i32 s53, s45, 172032
    s_add_u32 s53, s53, s48
    s_add_u32 s45, s45, 1
    s_cmp_eq_u32 s45, 7
    s_cselect_b32 s45, 0, s45
    buffer_load_dwordx4 v28, s[20:23], s53 offen lds
    buffer_load_dwordx4 v29, s[20:23], s53 offen offset:1024 lds
    s_lshl_b32 s40, s44, 7
    s_add_u32 s51, s40, s46
    s_add_u32 s52, s40, s47
    s_mul_i32 s53, s44, 172032
    s_add_u32 s53, s53, s48
    s_add_u32 m0, s50, 32768
    s_add_u32 s44, s44, 1
    s_cmp_eq_u32 s44, 7
    s_cselect_b32 s44, 0, s44
    buffer_load_dwordx4 v21, s[16:19], s51 offen lds
    buffer_load_dwordx4 v22, s[16:19], s51 offen offset:1024 lds
    s_add_u32 m0, s49, 30720
    s_mov_b32 exec_hi, 0
    buffer_load_dwordx4 v23, s[16:19], s52 offen lds
    s_mov_b32 exec_hi, -1
    s_waitcnt vmcnt(12)
    s_barrier
    s_add_u32 m0, s50, 153600
    s_nop 0
    buffer_load_dwordx4 v24, s[20:23], s53 offen lds
    buffer_load_dwordx4 v25, s[20:23], s53 offen offset:1024 lds
    s_add_u32 m0, s50, 71680
    s_nop 0
    buffer_load_dwordx4 v26, s[20:23], s53 offen lds
    buffer_load_dwordx4 v27, s[20:23], s53 offen offset:1024 lds
    s_add_u32 m0, s50, 79872
    s_mul_i32 s53, s45, 172032
    s_add_u32 s53, s53, s48
    s_add_u32 s45, s45, 1
    s_cmp_eq_u32 s45, 7
    s_cselect_b32 s45, 0, s45
    buffer_load_dwordx4 v28, s[20:23], s53 offen lds
    buffer_load_dwordx4 v29, s[20:23], s53 offen offset:1024 lds
    s_lshl_b32 s40, s44, 7
    s_add_u32 s51, s40, s46
    s_add_u32 s52, s40, s47
    s_mul_i32 s53, s44, 172032
    s_add_u32 s53, s53, s48
    s_add_u32 m0, s50, 43008
    s_add_u32 s44, s44, 1
    s_cmp_eq_u32 s44, 7
    s_cselect_b32 s44, 0, s44
    buffer_load_dwordx4 v21, s[16:19], s51 offen lds
    buffer_load_dwordx4 v22, s[16:19], s51 offen offset:1024 lds
    s_add_u32 m0, s49, 40960
    s_mov_b32 exec_hi, 0
    buffer_load_dwordx4 v23, s[16:19], s52 offen lds
    s_mov_b32 exec_hi, -1
    s_waitcnt vmcnt(12)
    s_barrier
    s_add_u32 m0, s50, 88064
    s_nop 0
    buffer_load_dwordx4 v24, s[20:23], s53 offen lds
    buffer_load_dwordx4 v25, s[20:23], s53 offen offset:1024 lds
    s_add_u32 m0, s50, 96256
    s_nop 0
    buffer_load_dwordx4 v26, s[20:23], s53 offen lds
    buffer_load_dwordx4 v27, s[20:23], s53 offen offset:1024 lds
    s_add_u32 m0, s50, 104448
    s_mul_i32 s53, s45, 172032
    s_add_u32 s53, s53, s48
    s_add_u32 s45, s45, 1
    s_cmp_eq_u32 s45, 7
    s_cselect_b32 s45, 0, s45
    buffer_load_dwordx4 v28, s[20:23], s53 offen lds
    buffer_load_dwordx4 v29, s[20:23], s53 offen offset:1024 lds
    s_lshl_b32 s40, s44, 7
    s_add_u32 s51, s40, s46
    s_add_u32 s52, s40, s47
    s_mul_i32 s53, s44, 172032
    s_add_u32 s53, s53, s48
    s_add_u32 m0, s50, 53248
    s_add_u32 s44, s44, 1
    s_cmp_eq_u32 s44, 7
    s_cselect_b32 s44, 0, s44
    buffer_load_dwordx4 v21, s[16:19], s51 offen lds
    buffer_load_dwordx4 v22, s[16:19], s51 offen offset:1024 lds
    s_add_u32 m0, s49, 51200
    s_mov_b32 exec_hi, 0
    buffer_load_dwordx4 v23, s[16:19], s52 offen lds
    s_mov_b32 exec_hi, -1
    s_waitcnt vmcnt(12)
    s_barrier
    s_add_u32 m0, s50, 112640
    s_nop 0
    buffer_load_dwordx4 v24, s[20:23], s53 offen lds
    buffer_load_dwordx4 v25, s[20:23], s53 offen offset:1024 lds
    s_add_u32 m0, s50, 120832
    s_nop 0
    buffer_load_dwordx4 v26, s[20:23], s53 offen lds
    buffer_load_dwordx4 v27, s[20:23], s53 offen offset:1024 lds
    buffer_load_dwordx2 v[18:19], v20, s[36:39], s30 offen sc1
    s_lshl_b32 s40, s44, 7
    s_add_u32 s51, s40, s46
    s_add_u32 s52, s40, s47
    s_mul_i32 s53, s44, 172032
    s_add_u32 s53, s53, s48
    s_add_u32 m0, s50, 63488
    s_add_u32 s44, s44, 1
    s_cmp_eq_u32 s44, 7
    s_cselect_b32 s44, 0, s44
    buffer_load_dwordx4 v21, s[16:19], s51 offen lds
    buffer_load_dwordx4 v22, s[16:19], s51 offen offset:1024 lds
    s_add_u32 m0, s49, 61440
    s_mov_b32 exec_hi, 0
    buffer_load_dwordx4 v23, s[16:19], s52 offen lds
    s_mov_b32 exec_hi, -1
    s_add_u32 m0, s50, 129024
    s_nop 0
    buffer_load_dwordx4 v24, s[20:23], s53 offen lds
    s_waitcnt vmcnt(12)
    s_barrier
    buffer_load_dwordx4 v25, s[20:23], s53 offen offset:1024 lds
    s_add_u32 m0, s50, 137216
    s_nop 0
    buffer_load_dwordx4 v26, s[20:23], s53 offen lds
    buffer_load_dwordx4 v27, s[20:23], s53 offen offset:1024 lds
    s_add_u32 m0, s50, 145408
    s_mul_i32 s53, s45, 172032
    s_add_u32 s53, s53, s48
    s_add_u32 s45, s45, 1
    s_cmp_eq_u32 s45, 7
    s_cselect_b32 s45, 0, s45
    buffer_load_dwordx4 v28, s[20:23], s53 offen lds
    buffer_load_dwordx4 v29, s[20:23], s53 offen offset:1024 lds
    s_add_u32 m0, s50, 153600
    s_mul_i32 s53, s45, 172032
    s_add_u32 s53, s53, s48
    s_add_u32 s45, s45, 1
    s_cmp_eq_u32 s45, 7
    s_cselect_b32 s45, 0, s45
    buffer_load_dwordx4 v28, s[20:23], s53 offen lds
    s_waitcnt vmcnt(11)
    s_barrier
    buffer_load_dwordx4 v29, s[20:23], s53 offen offset:1024 lds
    s_lshl_b32 s40, s54, 13
    s_add_u32 s40, s40, s50
    s_add_u32 m0, s40, 71680
    s_mul_i32 s40, s54, 57344
    s_add_u32 s40, s40, s55
    s_add_u32 s54, s54, 1
    s_cmp_eq_u32 s54, 5
    s_cselect_b32 s54, 0, s54
    buffer_load_dwordx4 v10, s[24:27], s40 offen lds
    buffer_load_dwordx4 v11, s[24:27], s40 offen offset:1024 lds
    s_lshl_b32 s40, s54, 13
    s_add_u32 s40, s40, s50
    s_add_u32 m0, s40, 71680
    s_mul_i32 s40, s54, 57344
    s_add_u32 s40, s40, s55
    s_add_u32 s54, s54, 1
    s_cmp_eq_u32 s54, 5
    s_cselect_b32 s54, 0, s54
    buffer_load_dwordx4 v10, s[24:27], s40 offen lds
    buffer_load_dwordx4 v11, s[24:27], s40 offen offset:1024 lds
    s_waitcnt lgkmcnt(0)
    s_waitcnt vmcnt(8)
    s_barrier
    s_mov_b32 s101, 1

    v_cmp_ne_u32 vcc, s28, v18
    v_cmp_ne_u32 s[42:43], s29, v19
    s_nop 0
    s_or_b64 vcc, vcc, s[42:43]
    s_cbranch_vccnz X_cH
        X_okH:

    v_add_u32 v2, s101, v14
    ds_write_b32 v5, v2 offset:4
    s_setprio 0
    s_lshl_b32 s40, s54, 13
    s_add_u32 s40, s40, s50
    s_add_u32 m0, s40, 71680
    s_mul_i32 s40, s54, 57344
    s_add_u32 s40, s40, s55
    s_add_u32 s54, s54, 1
    s_cmp_eq_u32 s54, 5
    s_cselect_b32 s54, 0, s54
    buffer_load_dwordx4 v10, s[24:27], s40 offen lds
    buffer_load_dwordx4 v11, s[24:27], s40 offen offset:1024 lds
    buffer_load_dword v13, v12, s[36:39], 0 offen sc1
    s_lshl_b32 s40, s54, 13
    s_add_u32 s40, s40, s50
    s_add_u32 m0, s40, 71680
    s_mul_i32 s40, s54, 57344
    s_add_u32 s40, s40, s55
    s_add_u32 s54, s54, 1
    s_cmp_eq_u32 s54, 5
    s_cselect_b32 s54, 0, s54
    buffer_load_dwordx4 v10, s[24:27], s40 offen lds
    buffer_load_dwordx4 v11, s[24:27], s40 offen offset:1024 lds
    s_lshl_b32 s40, s54, 13
    s_add_u32 s40, s40, s50
    s_add_u32 m0, s40, 71680
    s_mul_i32 s40, s54, 57344
    s_add_u32 s40, s40, s55
    s_add_u32 s54, s54, 1
    s_cmp_eq_u32 s54, 5
    s_cselect_b32 s54, 0, s54
    buffer_load_dwordx4 v10, s[24:27], s40 offen lds
    buffer_load_dwordx4 v11, s[24:27], s40 offen offset:1024 lds
    s_waitcnt vmcnt(11)
    s_mov_b64 exec, 1
    ds_add_u32 v5, v14 offset:32
    s_mov_b64 exec, -1
    s_mov_b32 s9, 0
    s_setprio 0
        H_il:

    ds_read_b64 v[62:63], v58 offset:16
    ds_read_b128 v[30:33], v56
    ds_read_b128 v[34:37], v57
    s_add_u32 s9, s9, 1
    s_cmp_gt_u32 s9, 1600000
    s_cbranch_scc1 H_id
    s_waitcnt lgkmcnt(2)
    v_and_b32 v62, v62, v63
    v_cmp_eq_u32 vcc, 0, v62
    s_waitcnt lgkmcnt(0)
    s_cbranch_vccnz H_il
        H_id:
    s_waitcnt lgkmcnt(0)

    v_fma_f32 v30, v34, v61, v30
    v_fma_f32 v31, v35, v61, v31
    v_fma_f32 v32, v36, v61, v32
    v_fma_f32 v33, v37, v61, v33
    v_max_f32 v62, v30, v31
    v_max_f32 v63, v32, v33
    v_mov_b32 v64, v62
    v_mov_b32 v65, v63
    s_nop 0
    v_permlane16_swap_b32 v62, v64
    v_permlane16_swap_b32 v63, v65
    v_max_f32 v62, v62, v64
    v_max_f32 v63, v63, v65
    v_mov_b32 v64, v62
    v_mov_b32 v65, v63
    s_nop 0
    v_permlane32_swap_b32 v62, v64
    v_permlane32_swap_b32 v63, v65
    v_max_f32 v62, v62, v64
    v_max_f32 v63, v63, v65
    v_mul_f32 v62, s31, v62
    v_mul_f32 v63, s31, v63
    v_fma_f32 v30, v30, s31, -v62
    v_fma_f32 v31, v31, s31, -v62
    v_fma_f32 v32, v32, s31, -v63
    v_fma_f32 v33, v33, s31, -v63
    v_exp_f32 v30, v30
    v_exp_f32 v31, v31
    v_exp_f32 v32, v32
    v_exp_f32 v33, v33
    v_add_f32 v62, v30, v31
    v_add_f32 v63, v32, v33
    v_mov_b32 v64, v62
    v_mov_b32 v65, v63
    s_nop 0
    v_permlane16_swap_b32 v62, v64
    v_permlane16_swap_b32 v63, v65
    v_add_f32 v62, v62, v64
    v_add_f32 v63, v63, v65
    v_mov_b32 v64, v62
    v_mov_b32 v65, v63
    s_nop 0
    v_permlane32_swap_b32 v62, v64
    v_permlane32_swap_b32 v63, v65
    v_add_f32 v62, v62, v64
    v_add_f32 v63, v63, v65
    v_rcp_f32 v62, v62
    v_rcp_f32 v63, v63
    v_mul_f32 v30, v30, v62
    v_mul_f32 v31, v31, v62
    v_mul_f32 v32, v32, v63
    v_mul_f32 v33, v33, v63
    v_cvt_pk_bf16_f32 v30, v30, v30
    v_cvt_pk_bf16_f32 v31, v31, v31
    v_cvt_pk_bf16_f32 v32, v32, v32
    v_cvt_pk_bf16_f32 v33, v33, v33
    v_and_b32 v38, v52, v30
    v_and_b32 v39, v53, v31
    v_and_b32 v40, v54, v30
    v_and_b32 v41, v55, v31
    ds_write_b128 v59, v[38:41] offset:12288
    v_and_b32 v42, v52, v32
    v_and_b32 v43, v53, v33
    v_and_b32 v44, v54, v32
    v_and_b32 v45, v55, v33
    ds_write_b128 v59, v[42:45] offset:13312
    ds_write_b32 v60, v5 offset:40
    s_setprio 0
    s_waitcnt vmcnt(0)
    s_mov_b64 exec, 1
    ds_add_u32 v5, v14 offset:12
    s_mov_b64 exec, -1
    s_mov_b32 s9, 0
        W_lR:
    ds_read_b32 v2, v5 offset:80
    s_add_u32 s9, s9, 1
    s_cmp_gt_u32 s9, 1600000
    s_cbranch_scc1 W_dR
    s_waitcnt lgkmcnt(0)
    v_cmp_gt_u32 vcc, 4, v2

    s_nop 0
    s_cbranch_vccnz W_lR
W_dR:
    s_add_u32 m0, s50, 112640
    s_add_u32 s40, s55, 286720
    buffer_load_dwordx4 v10, s[24:27], s40 offen lds
    buffer_load_dwordx4 v11, s[24:27], s40 offen offset:1024 lds
    s_add_u32 m0, s50, 120832
    s_add_u32 s40, s55, 344064
    buffer_load_dwordx4 v10, s[24:27], s40 offen lds
    buffer_load_dwordx4 v11, s[24:27], s40 offen offset:1024 lds
    s_waitcnt vmcnt(0)
    s_mov_b64 exec, 1
    ds_add_u32 v5, v14 offset:36
    s_endpgm
K_spare2:
    buffer_load_dwordx4 v7, s[28:31], s53 offen nt lds
    s_add_u32 m0, m0, 1024
    s_mov_b32 s26, 401408
    s_mov_b32 s27, 0x00020000
    s_mov_b32 s34, 3670016
    s_mov_b32 s35, 0x00020000
    v_and_b32 v6, 15, v0
    v_lshlrev_b32 v6, 4, v6
    v_bfe_u32 v4, v0, 4, 2
    v_lshl_add_u32 v4, v4, 9, s42
    v_add_u32 v10, v4, v6
    v_sub_u32 v11, v4, v6
    v_add_u32 v11, 432, v11
    v_mov_b32 v12, 0
    s_and_b32 s55, s3, 3
    s_lshr_b32 s56, s3, 2
    v_and_b32 v1, 63, v0
    v_lshrrev_b32 v2, 4, v1
    v_and_b32 v3, 15, v1
    s_lshl_b32 s61, s55, 3
    v_lshrrev_b32 v4, 1, v3
    v_add_u32 v4, s61, v4
    v_and_b32 v5, 1, v3
    v_cvt_f32_u32 v79, v5
    v_mul_f32 v79, 0x3e800000, v79
    v_lshl_add_u32 v5, v4, 1, v5
    v_cmp_eq_u32 vcc, 1, v5
    s_nop 1
    v_cndmask_b32 v4, v4, 32, vcc
    v_cndmask_b32 v79, v79, 0, vcc
    v_cvt_f32_u32 v78, v4
    v_mul_f32 v78, 0x3c800000, v78
    v_lshlrev_b32 v4, 3, v2
    v_cvt_f32_u32 v4, v4
    v_fma_f32 v79, v78, v4, v79
    v_cos_f32 v100, v78
    s_nop 0
    v_add_f32 v100, v100, v100
    v_fmamk_f32 v84, v78, 0x0, v79
    v_fmamk_f32 v85, v78, 0x3f800000, v79
    v_fmamk_f32 v92, v78, 0x42000000, v79
    v_fmamk_f32 v93, v78, 0x42040000, v79
    v_cos_f32 v84, v84
    v_cos_f32 v85, v85
    v_cos_f32 v92, v92
    v_cos_f32 v93, v93
    v_fma_f32 v86, v100, v85, -v84
    v_fma_f32 v94, v100, v93, -v92
    v_fma_f32 v87, v100, v86, -v85
    v_fma_f32 v95, v100, v94, -v93
    v_fma_f32 v88, v100, v87, -v86
    v_fma_f32 v96, v100, v95, -v94
    v_fma_f32 v89, v100, v88, -v87
    v_fma_f32 v97, v100, v96, -v95
    v_fma_f32 v90, v100, v89, -v88
    v_fma_f32 v98, v100, v97, -v96
    v_fma_f32 v91, v100, v90, -v89
    v_fma_f32 v99, v100, v98, -v97
    v_cvt_pk_bf16_f32 v20, v84, v85
    v_cvt_pk_bf16_f32 v21, v86, v87
    v_cvt_pk_bf16_f32 v22, v88, v89
    v_cvt_pk_bf16_f32 v23, v90, v91
    v_cvt_pk_bf16_f32 v24, v92, v93
    v_cvt_pk_bf16_f32 v25, v94, v95
    v_cvt_pk_bf16_f32 v26, v96, v97
    v_cvt_pk_bf16_f32 v27, v98, v99
    v_lshrrev_b32 v4, 4, v0
    v_and_b32 v5, 3, v4
    v_lshlrev_b32 v5, 6, v5
    v_lshlrev_b32 v13, 1, v6
    v_xor_b32 v13, v13, v5
    v_bfe_u32 v5, v4, 3, 1
    v_lshl_add_u32 v13, v5, 4, v13
    v_lshl_add_u32 v13, v4, 9, v13
    v_add_u32 v13, 65536, v13
    v_xor_b32 v14, 16, v13
    v_lshrrev_b32 v4, 2, v3
    v_lshl_add_u32 v5, v2, 3, v4
    v_lshlrev_b32 v5, 9, v5
    v_lshl_add_u32 v5, v4, 6, v5
    v_and_b32 v4, 1, v1
    v_lshl_add_u32 v5, v4, 5, v5
    v_bfe_u32 v4, v1, 1, 1
    v_lshl_add_u32 v5, v4, 3, v5
    v_and_b32 v4, 1, v2
    v_xor_b32 v4, s56, v4
    v_lshl_add_u32 v16, v4, 4, v5
    v_add_u32 v16, 65536, v16
    v_xor_b32 v17, 64, v16
    v_xor_b32 v18, 128, v16
    v_xor_b32 v19, 192, v16
    v_lshlrev_b32 v15, 16, v2
    v_lshrrev_b32 v4, 3, v3
    v_lshl_add_u32 v15, v4, 13, v15
    v_and_b32 v4, 7, v3
    v_lshl_add_u32 v15, v4, 4, v15
    v_lshlrev_b32 v68, 16, v4
    v_mov_b32 v5, 0xffff0000
    v_add_u32 v69, s56, v3
    v_cmp_eq_u32 vcc, 0, v69
    s_nop 1
    v_cndmask_b32 v69, v5, 0, vcc
    v_add_u32 v4, 256, v11
    v_cmp_eq_u32 vcc, 15, v3
    s_nop 1
    v_cndmask_b32 v11, v11, v4, vcc
    s_lshl_b32 s50, s8, 3
    s_add_u32 s50, s50, s3
    s_mul_i32 s50, s50, 1568
    s_and_b32 s50, s50, 0xffffff80
    buffer_load_dwordx4 v7, s[28:31], s54 offen nt lds
    s_add_u32 m0, m0, 1024
    v_min_u32 v77, 12, v1
    v_lshlrev_b32 v77, 7, v77
    s_lshl_b32 s59, s55, 18
    s_lshl_b32 s61, s56, 14
    s_add_u32 s59, s59, s61
    s_lshl_b32 s61, s8, 7
    s_add_u32 s59, s59, s61
    s_add_u32 s59, s59, 1048576
    v_lshlrev_b32 v47, 4, v1
    v_and_b32 v4, 16, v1
    v_lshlrev_b32 v4, 1, v4
    v_xor_b32 v44, v47, v4
    v_xor_b32 v45, 64, v44
    s_lshl_b32 s60, s8, 3
    s_add_u32 s60, s60, s3
    s_lshl_b32 s60, s60, 12
    s_add_u32 s60, s60, 1048576
    s_lshl_b32 s61, s55, 14
    s_add_u32 s61, s61, 98304
    v_add_u32 v51, s61, v47
    v_cmp_eq_u32 s[42:43], 0, v2
    s_nop 1
    v_cndmask_b32 v80, 1.0, 0.5, s[42:43]
    v_and_b32 v4, 1, v2
    v_mov_b32 v5, 0xffff
    v_cmp_eq_u32 s[42:43], 1, v4
    s_nop 1
    v_cndmask_b32 v83, -1, v5, s[42:43]
    v_cndmask_b32 v78, 1.0, 0, s[42:43]
    v_cmp_eq_u32 s[42:43], 1, v2
    s_nop 1
    v_cndmask_b32 v79, v78, 0.5, s[42:43]
    s_cmp_eq_u32 s56, 0
    s_cselect_b64 s[42:43], -1, 0
    v_cndmask_b32 v81, v78, v79, s[42:43]
    v_cndmask_b32 v82, v79, v78, s[42:43]
    v_lshlrev_b32 v4, 6, v4
    v_and_b32 v5, 2, v2
    v_add_u32 v4, v4, v5
    v_cvt_f32_u32 v79, v4
    s_lshl_b32 s61, s55, 5
    s_add_u32 s61, s61, s56
    v_lshl_add_u32 v4, v3, 1, s61
    v_cvt_f32_u32 v78, v4
    v_mul_f32 v78, 0x3b124925, v78
    v_mul_f32 v79, v78, v79
    s_lshl_b32 s61, s56, 13
    v_add_u32 v5, s61, v51
    v_mul_f32 v100, 0x40800000, v78
    v_cos_f32 v100, v100
    buffer_load_dwordx4 v8, s[28:31], s52 offen nt lds
    s_add_u32 m0, m0, 1024
    v_add_f32 v100, v100, v100
    v_fmamk_f32 v84, v78, 0x0, v79
    v_fmamk_f32 v85, v78, 0x40800000, v79
    v_cos_f32 v84, v84
    v_cos_f32 v85, v85
    s_nop 0
    v_fma_f32 v86, v100, v85, -v84
    v_fma_f32 v87, v100, v86, -v85
    v_fma_f32 v88, v100, v87, -v86
    v_fma_f32 v89, v100, v88, -v87
    v_fma_f32 v90, v100, v89, -v88
    v_fma_f32 v91, v100, v90, -v89
    v_fma_f32 v92, v100, v91, -v90
    v_fma_f32 v93, v100, v92, -v91
    v_fma_f32 v94, v100, v93, -v92
    v_fma_f32 v95, v100, v94, -v93
    v_fma_f32 v96, v100, v95, -v94
    v_fma_f32 v97, v100, v96, -v95
    v_fma_f32 v98, v100, v97, -v96
    v_fma_f32 v99, v100, v98, -v97
    v_mul_f32 v84, v84, v80
    v_mul_f32 v96, v96, v81
    v_cvt_pk_bf16_f32 v60, v84, v88
    v_cvt_pk_bf16_f32 v61, v92, v96
    v_cvt_pk_bf16_f32 v62, v85, v89
    v_cvt_pk_bf16_f32 v63, v93, v97
    v_and_b32 v63, v83, v63
    ds_write_b128 v5, v[60:63] offset:0
    v_cvt_pk_bf16_f32 v64, v86, v90
    v_cvt_pk_bf16_f32 v65, v94, v98
    v_cvt_pk_bf16_f32 v66, v87, v91
    v_cvt_pk_bf16_f32 v67, v95, v99
    v_and_b32 v65, v83, v65
    v_and_b32 v67, v83, v67
    ds_write_b128 v5, v[64:67] offset:1024
    v_fmamk_f32 v84, v78, 0x0, v79
    v_fmamk_f32 v85, v78, 0x40800000, v79
    v_sin_f32 v84, v84
    v_sin_f32 v85, v85
    s_nop 0
    v_fma_f32 v86, v100, v85, -v84
    v_fma_f32 v87, v100, v86, -v85
    buffer_load_dwordx4 v8, s[28:31], 0 offen nt lds
    s_add_u32 m0, m0, 1024
    v_fma_f32 v88, v100, v87, -v86
    v_fma_f32 v89, v100, v88, -v87
    v_fma_f32 v90, v100, v89, -v88
    v_fma_f32 v91, v100, v90, -v89
    v_fma_f32 v92, v100, v91, -v90
    v_fma_f32 v93, v100, v92, -v91
    v_fma_f32 v94, v100, v93, -v92
    v_fma_f32 v95, v100, v94, -v93
    v_fma_f32 v96, v100, v95, -v94
    v_fma_f32 v97, v100, v96, -v95
    s_waitcnt lgkmcnt(0)
    s_add_u32 s12, s10, 0x5a3c9671
    s_xor_b32 s13, s11, 0x2b7e1516
    s_lshl_b32 s51, s12, 12
    s_xor_b32 s51, s51, s13
    s_and_b32 s51, s51, 0xbfff0000
    v_xor_b32 v68, s51, v68

    v_mov_b32 v74, s12
    v_mov_b32 v75, s13
    s_waitcnt vmcnt(4)
    ds_read_b128 v[102:105], v10 offset:0
    ds_read_b128 v[106:109], v11 offset:2112
    ds_read_b128 v[114:117], v10 offset:2112
    ds_read_b128 v[110:113], v11 offset:0
    s_waitcnt lgkmcnt(2)
    v_mov_b32 v118, v102
    v_lshlrev_b32 v122, 16, v103
    v_lshlrev_b32 v136, 16, v109
    v_and_b32 v123, 0xffff0000, v103
    v_and_b32 v137, 0xffff0000, v108
    v_pk_add_f32 v[122:123], v[122:123], v[136:137]
    v_mov_b32_dpp v118, v106 row_shr:1 row_mask:0xf bank_mask:0xf
    v_lshlrev_b32 v124, 16, v104
    v_lshlrev_b32 v136, 16, v108
    v_and_b32 v125, 0xffff0000, v104
    v_and_b32 v137, 0xffff0000, v107
    v_pk_add_f32 v[124:125], v[124:125], v[136:137]
    v_lshlrev_b32 v126, 16, v105
    v_lshlrev_b32 v136, 16, v107
    v_and_b32 v127, 0xffff0000, v105
    v_and_b32 v137, 0xffff0000, v106
    v_pk_add_f32 v[126:127], v[126:127], v[136:137]
    v_lshlrev_b32 v120, 16, v102
    v_lshlrev_b32 v136, 16, v118
    v_and_b32 v121, 0xffff0000, v102
    v_and_b32 v137, 0xffff0000, v109
    v_pk_add_f32 v[120:121], v[120:121], v[136:137]
    s_waitcnt lgkmcnt(0)
    v_lshlrev_b32 v130, 16, v115
    v_lshlrev_b32 v136, 16, v113
    v_and_b32 v131, 0xffff0000, v115
    v_and_b32 v137, 0xffff0000, v112
    v_pk_add_f32 v[130:131], v[130:131], v[136:137]
    v_mov_b32_dpp v119, v110 row_ror:1 row_mask:0xf bank_mask:0xf
    v_lshlrev_b32 v132, 16, v116
    v_lshlrev_b32 v136, 16, v112
    v_and_b32 v133, 0xffff0000, v116
    v_and_b32 v137, 0xffff0000, v111
    v_pk_add_f32 v[132:133], v[132:133], v[136:137]
    v_lshlrev_b32 v134, 16, v117
    v_lshlrev_b32 v136, 16, v111
    v_and_b32 v135, 0xffff0000, v117
    v_and_b32 v137, 0xffff0000, v110
    v_pk_add_f32 v[134:135], v[134:135], v[136:137]
    v_lshlrev_b32 v128, 16, v114
    v_lshlrev_b32 v136, 16, v119
    v_and_b32 v129, 0xffff0000, v114
    v_and_b32 v137, 0xffff0000, v113
    v_pk_add_f32 v[128:129], v[128:129], v[136:137]
    v_pk_add_f32 v[146:147], v[120:121], v[128:129]
    v_pk_add_f32 v[148:149], v[122:123], v[130:131]
    v_pk_add_f32 v[150:151], v[124:125], v[132:133]
    v_pk_add_f32 v[152:153], v[126:127], v[134:135]
    v_cvt_pk_bf16_f32 v138, v146, v148
    v_cvt_pk_bf16_f32 v139, v150, v152
    v_cvt_pk_bf16_f32 v140, v147, v149
    v_cvt_pk_bf16_f32 v141, v151, v153
    ds_write_b128 v13, v[138:141] offset:0
    v_pk_add_f32 v[146:147], v[120:121], v[128:129] neg_lo:[0,1] neg_hi:[0,1]
    v_pk_add_f32 v[148:149], v[122:123], v[130:131] neg_lo:[0,1] neg_hi:[0,1]
    v_pk_add_f32 v[150:151], v[124:125], v[132:133] neg_lo:[0,1] neg_hi:[0,1]
    v_pk_add_f32 v[152:153], v[126:127], v[134:135] neg_lo:[0,1] neg_hi:[0,1]
    v_cvt_pk_bf16_f32 v142, v146, v148
    v_cvt_pk_bf16_f32 v143, v150, v152
    v_cvt_pk_bf16_f32 v144, v147, v149
    v_cvt_pk_bf16_f32 v145, v151, v153
    ds_write_b128 v14, v[142:145] offset:0
    s_waitcnt lgkmcnt(0)
    s_barrier
    ds_read_b64_tr_b16 v[154:155], v16 offset:0
    ds_read_b64_tr_b16 v[156:157], v16 offset:2048
    ds_read_b64_tr_b16 v[158:159], v17 offset:0
    ds_read_b64_tr_b16 v[160:161], v17 offset:2048
    ds_read_b64_tr_b16 v[162:163], v18 offset:0
    ds_read_b64_tr_b16 v[164:165], v18 offset:2048
    ds_read_b64_tr_b16 v[166:167], v19 offset:0
    ds_read_b64_tr_b16 v[168:169], v19 offset:2048
    s_waitcnt lgkmcnt(6)
    v_mfma_f32_16x16x32_bf16 v[170:173], v[20:23], v[154:157], 0
    ds_read_b64_tr_b16 v[154:155], v16 offset:256
    ds_read_b64_tr_b16 v[156:157], v16 offset:2304
    s_waitcnt lgkmcnt(6)
    v_mfma_f32_16x16x32_bf16 v[174:177], v[20:23], v[158:161], 0
    ds_read_b64_tr_b16 v[158:159], v17 offset:256
    ds_read_b64_tr_b16 v[160:161], v17 offset:2304
    s_waitcnt lgkmcnt(6)
    v_mfma_f32_16x16x32_bf16 v[178:181], v[20:23], v[162:165], 0
    ds_read_b64_tr_b16 v[162:163], v18 offset:256
    ds_read_b64_tr_b16 v[164:165], v18 offset:2304
    s_waitcnt lgkmcnt(6)
    v_mfma_f32_16x16x32_bf16 v[182:185], v[20:23], v[166:169], 0
    ds_read_b64_tr_b16 v[166:167], v19 offset:256
    ds_read_b64_tr_b16 v[168:169], v19 offset:2304
    s_waitcnt lgkmcnt(6)
    v_mfma_f32_16x16x32_bf16 v[186:189], v[20:23], v[154:157], 0
    s_waitcnt lgkmcnt(4)
    v_mfma_f32_16x16x32_bf16 v[190:193], v[20:23], v[158:161], 0
    s_waitcnt lgkmcnt(2)
    v_mfma_f32_16x16x32_bf16 v[194:197], v[20:23], v[162:165], 0
    s_waitcnt lgkmcnt(0)
    v_mfma_f32_16x16x32_bf16 v[198:201], v[20:23], v[166:169], 0
    s_waitcnt vmcnt(0)
    buffer_load_dword v255, v77, s[24:27], s50 offen
    ds_read_b128 v[102:105], v10 offset:4096
    ds_read_b128 v[106:109], v11 offset:6208
    ds_read_b128 v[114:117], v10 offset:6208
    ds_read_b128 v[110:113], v11 offset:4096
    s_waitcnt lgkmcnt(2)
    v_mov_b32 v118, v102
    v_lshlrev_b32 v122, 16, v103
    v_lshlrev_b32 v136, 16, v109
    v_and_b32 v123, 0xffff0000, v103
    v_and_b32 v137, 0xffff0000, v108
    v_pk_add_f32 v[122:123], v[122:123], v[136:137]
    v_mov_b32_dpp v118, v106 row_shr:1 row_mask:0xf bank_mask:0xf
    v_lshlrev_b32 v124, 16, v104
    v_lshlrev_b32 v136, 16, v108
    v_and_b32 v125, 0xffff0000, v104
    v_and_b32 v137, 0xffff0000, v107
    v_pk_add_f32 v[124:125], v[124:125], v[136:137]
    v_lshlrev_b32 v126, 16, v105
    v_lshlrev_b32 v136, 16, v107
    v_and_b32 v127, 0xffff0000, v105
    v_and_b32 v137, 0xffff0000, v106
    v_pk_add_f32 v[126:127], v[126:127], v[136:137]
    v_lshlrev_b32 v120, 16, v102
    v_lshlrev_b32 v136, 16, v118
    v_and_b32 v121, 0xffff0000, v102
    v_and_b32 v137, 0xffff0000, v109
    v_pk_add_f32 v[120:121], v[120:121], v[136:137]
    s_waitcnt lgkmcnt(0)
    v_lshlrev_b32 v130, 16, v115
    v_lshlrev_b32 v136, 16, v113
    v_and_b32 v131, 0xffff0000, v115
    v_and_b32 v137, 0xffff0000, v112
    v_pk_add_f32 v[130:131], v[130:131], v[136:137]
    v_mov_b32_dpp v119, v110 row_ror:1 row_mask:0xf bank_mask:0xf
    v_lshlrev_b32 v132, 16, v116
    v_lshlrev_b32 v136, 16, v112
    v_and_b32 v133, 0xffff0000, v116
    v_and_b32 v137, 0xffff0000, v111
    v_pk_add_f32 v[132:133], v[132:133], v[136:137]
    v_lshlrev_b32 v134, 16, v117
    v_lshlrev_b32 v136, 16, v111
    v_and_b32 v135, 0xffff0000, v117
    v_and_b32 v137, 0xffff0000, v110
    v_pk_add_f32 v[134:135], v[134:135], v[136:137]
    v_lshlrev_b32 v128, 16, v114
    v_lshlrev_b32 v136, 16, v119
    v_and_b32 v129, 0xffff0000, v114
    v_and_b32 v137, 0xffff0000, v113
    v_pk_add_f32 v[128:129], v[128:129], v[136:137]
    v_pk_add_f32 v[146:147], v[120:121], v[128:129]
    v_pk_add_f32 v[148:149], v[122:123], v[130:131]
    v_pk_add_f32 v[150:151], v[124:125], v[132:133]
    v_pk_add_f32 v[152:153], v[126:127], v[134:135]
    v_cvt_pk_bf16_f32 v138, v146, v148
    v_cvt_pk_bf16_f32 v139, v150, v152
    v_cvt_pk_bf16_f32 v140, v147, v149
    v_cvt_pk_bf16_f32 v141, v151, v153
    ds_write_b128 v13, v[138:141] offset:16384
    v_pk_add_f32 v[146:147], v[120:121], v[128:129] neg_lo:[0,1] neg_hi:[0,1]
    v_pk_add_f32 v[148:149], v[122:123], v[130:131] neg_lo:[0,1] neg_hi:[0,1]
    v_pk_add_f32 v[150:151], v[124:125], v[132:133] neg_lo:[0,1] neg_hi:[0,1]
    v_pk_add_f32 v[152:153], v[126:127], v[134:135] neg_lo:[0,1] neg_hi:[0,1]
    v_cvt_pk_bf16_f32 v142, v146, v148
    v_cvt_pk_bf16_f32 v143, v150, v152
    v_cvt_pk_bf16_f32 v144, v147, v149
    v_cvt_pk_bf16_f32 v145, v151, v153
    ds_write_b128 v14, v[142:145] offset:16384
    s_cmp_lg_u32 s3, 0
    s_cbranch_scc1 S_nw
    s_lshl_b32 s40, s8, 7
    s_add_u32 s40, s40, 32768
    buffer_load_dword v255, v12, s[36:39], s40 offen
S_nw:
    s_waitcnt lgkmcnt(0)
    s_barrier
    ds_read_b64_tr_b16 v[154:155], v16 offset:16384
    ds_read_b64_tr_b16 v[156:157], v16 offset:18432
    ds_read_b64_tr_b16 v[158:159], v17 offset:16384
    ds_read_b64_tr_b16 v[160:161], v17 offset:18432
    ds_read_b64_tr_b16 v[162:163], v18 offset:16384
    ds_read_b64_tr_b16 v[164:165], v18 offset:18432
    ds_read_b64_tr_b16 v[166:167], v19 offset:16384
    ds_read_b64_tr_b16 v[168:169], v19 offset:18432
    s_waitcnt lgkmcnt(6)
    v_mfma_f32_16x16x32_bf16 v[170:173], v[24:27], v[154:157], v[170:173]
    ds_read_b64_tr_b16 v[154:155], v16 offset:16640
    ds_read_b64_tr_b16 v[156:157], v16 offset:18688
    s_waitcnt lgkmcnt(6)
    v_mfma_f32_16x16x32_bf16 v[174:177], v[24:27], v[158:161], v[174:177]
    ds_read_b64_tr_b16 v[158:159], v17 offset:16640
    ds_read_b64_tr_b16 v[160:161], v17 offset:18688
    s_waitcnt lgkmcnt(6)
    v_mfma_f32_16x16x32_bf16 v[178:181], v[24:27], v[162:165], v[178:181]
    ds_read_b64_tr_b16 v[162:163], v18 offset:16640
    ds_read_b64_tr_b16 v[164:165], v18 offset:18688
    s_waitcnt lgkmcnt(6)
    v_mfma_f32_16x16x32_bf16 v[182:185], v[24:27], v[166:169], v[182:185]
    ds_read_b64_tr_b16 v[166:167], v19 offset:16640
    ds_read_b64_tr_b16 v[168:169], v19 offset:18688
    s_waitcnt lgkmcnt(6)
    v_mfma_f32_16x16x32_bf16 v[186:189], v[24:27], v[154:157], v[186:189]
    s_waitcnt lgkmcnt(4)
    v_mfma_f32_16x16x32_bf16 v[190:193], v[24:27], v[158:161], v[190:193]
    s_waitcnt lgkmcnt(2)
    v_mfma_f32_16x16x32_bf16 v[194:197], v[24:27], v[162:165], v[194:197]
    s_waitcnt lgkmcnt(0)
    v_mfma_f32_16x16x32_bf16 v[198:201], v[24:27], v[166:169], v[198:201]
    v_cvt_pk_bf16_f32 v102, v170, v174
    v_cvt_pk_bf16_f32 v103, v178, v182
    s_nop 1
    v_cvt_pk_bf16_f32 v104, v186, v190
    s_nop 2
    v_cvt_pk_bf16_f32 v105, v194, v198
    v_bfi_b32 v105, v69, v68, v105
    s_add_u32 s41, s59, 0
    buffer_store_dwordx4 v[102:105], v15, s[36:39], s41 offen sc1
    v_cvt_pk_bf16_f32 v106, v171, v175
    v_cvt_pk_bf16_f32 v107, v179, v183
    v_cvt_pk_bf16_f32 v108, v187, v191
    v_cvt_pk_bf16_f32 v109, v195, v199
    v_bfi_b32 v109, v69, v68, v109
    s_add_u32 s41, s59, 4096
    buffer_store_dwordx4 v[106:109], v15, s[36:39], s41 offen sc1
    v_cvt_pk_bf16_f32 v110, v172, v176
    v_cvt_pk_bf16_f32 v111, v180, v184
    v_cvt_pk_bf16_f32 v112, v188, v192
    v_cvt_pk_bf16_f32 v113, v196, v200
    v_bfi_b32 v113, v69, v68, v113
    s_add_u32 s41, s59, 32768
    buffer_store_dwordx4 v[110:113], v15, s[36:39], s41 offen sc1
    v_cvt_pk_bf16_f32 v114, v173, v177
    v_cvt_pk_bf16_f32 v115, v181, v185
    v_cvt_pk_bf16_f32 v116, v189, v193
    v_cvt_pk_bf16_f32 v117, v197, v201
    v_bfi_b32 v117, v69, v68, v117
    s_add_u32 s41, s59, 36864
    buffer_store_dwordx4 v[114:117], v15, s[36:39], s41 offen sc1
    s_cmp_lg_u32 s3, 0
    s_cbranch_scc1 S_nh
    s_lshl_b32 s40, s8, 7
    s_add_u32 s40, s40, 32768
    s_mov_b64 exec, 1
    buffer_store_dwordx2 v[74:75], v12, s[36:39], s40 offen sc1
    s_mov_b64 exec, -1
            S_nh:

    s_barrier

    s_cmp_lg_u32 s3, 0
    s_cbranch_scc1 S_nf
    v_lshlrev_b32 v76, 2, v3
    v_add_u32 v76, 81920, v76
    ds_write_b32 v76, v12
        S_nf:

    s_lshl_b32 s40, s7, 3
    s_add_u32 s40, s40, s3
    s_mul_i32 s40, s40, 3584
    s_add_u32 s40, s40, 286720
    v_min_u32 v77, 27, v1
    v_lshlrev_b32 v77, 7, v77
    buffer_load_dword v255, v77, s[24:27], s40 offen

    v_fma_f32 v98, v100, v97, -v96
    v_fma_f32 v99, v100, v98, -v97
    v_mul_f32 v96, v96, v82
    v_cvt_pk_bf16_f32 v60, v84, v88
    v_cvt_pk_bf16_f32 v61, v92, v96
    v_cvt_pk_bf16_f32 v62, v85, v89
    v_cvt_pk_bf16_f32 v63, v93, v97
    v_and_b32 v63, v83, v63
    ds_write_b128 v5, v[60:63] offset:4096
    v_cvt_pk_bf16_f32 v64, v86, v90
    v_cvt_pk_bf16_f32 v65, v94, v98
    v_cvt_pk_bf16_f32 v66, v87, v91
    v_cvt_pk_bf16_f32 v67, v95, v99
    v_and_b32 v65, v83, v65
    v_and_b32 v67, v83, v67
    ds_write_b128 v5, v[64:67] offset:5120
    v_fmamk_f32 v84, v78, 0x3f800000, v79
    v_fmamk_f32 v85, v78, 0x40a00000, v79
    v_cos_f32 v84, v84
    v_cos_f32 v85, v85
    s_nop 0
    v_fma_f32 v86, v100, v85, -v84
    v_fma_f32 v87, v100, v86, -v85
    v_fma_f32 v88, v100, v87, -v86
    v_fma_f32 v89, v100, v88, -v87
    v_fma_f32 v90, v100, v89, -v88
    v_fma_f32 v91, v100, v90, -v89
    v_fma_f32 v92, v100, v91, -v90
    v_fma_f32 v93, v100, v92, -v91
    v_fma_f32 v94, v100, v93, -v92
    v_fma_f32 v95, v100, v94, -v93
    v_fma_f32 v96, v100, v95, -v94
    v_fma_f32 v97, v100, v96, -v95
    v_fma_f32 v98, v100, v97, -v96
    v_fma_f32 v99, v100, v98, -v97
    v_cvt_pk_bf16_f32 v60, v84, v88
    v_cvt_pk_bf16_f32 v61, v92, v96
    v_cvt_pk_bf16_f32 v62, v85, v89
    v_cvt_pk_bf16_f32 v63, v93, v97
    v_and_b32 v61, v83, v61
    v_and_b32 v63, v83, v63
    ds_write_b128 v5, v[60:63] offset:2048
    v_cvt_pk_bf16_f32 v64, v86, v90
    v_cvt_pk_bf16_f32 v65, v94, v98
    v_cvt_pk_bf16_f32 v66, v87, v91
    v_cvt_pk_bf16_f32 v67, v95, v99
    v_and_b32 v65, v83, v65
    v_and_b32 v67, v83, v67
    ds_write_b128 v5, v[64:67] offset:3072
    v_fmamk_f32 v84, v78, 0x3f800000, v79
    v_fmamk_f32 v85, v78, 0x40a00000, v79
    v_sin_f32 v84, v84
    v_sin_f32 v85, v85
    s_nop 0
    v_fma_f32 v86, v100, v85, -v84
    v_fma_f32 v87, v100, v86, -v85
    v_fma_f32 v88, v100, v87, -v86
    v_fma_f32 v89, v100, v88, -v87
    v_fma_f32 v90, v100, v89, -v88
    v_fma_f32 v91, v100, v90, -v89
    v_fma_f32 v92, v100, v91, -v90
    v_fma_f32 v93, v100, v92, -v91
    v_fma_f32 v94, v100, v93, -v92
    v_fma_f32 v95, v100, v94, -v93
    v_fma_f32 v96, v100, v95, -v94
    v_fma_f32 v97, v100, v96, -v95
    v_fma_f32 v98, v100, v97, -v96
    v_fma_f32 v99, v100, v98, -v97
    v_cvt_pk_bf16_f32 v60, v84, v88
    v_cvt_pk_bf16_f32 v61, v92, v96
    v_cvt_pk_bf16_f32 v62, v85, v89
    v_cvt_pk_bf16_f32 v63, v93, v97
    v_and_b32 v61, v83, v61
    v_and_b32 v63, v83, v63
    ds_write_b128 v5, v[60:63] offset:6144
    v_cvt_pk_bf16_f32 v64, v86, v90
    v_cvt_pk_bf16_f32 v65, v94, v98
    v_cvt_pk_bf16_f32 v66, v87, v91
    v_cvt_pk_bf16_f32 v67, v95, v99
    v_and_b32 v65, v83, v65
    v_and_b32 v67, v83, v67
    ds_write_b128 v5, v[64:67] offset:7168
    v_bfe_u32 v70, v44, 4, 3
    v_xor_b32 v71, 4, v70
    s_lshr_b32 s61, s3, 1
    v_mov_b32 v5, 0xffff0000
    v_add_u32 v4, s61, v70
    v_cmp_eq_u32 s[42:43], 0, v4
    s_nop 1
    v_cndmask_b32 v72, v5, 0, s[42:43]
    v_add_u32 v4, s61, v71
    v_cmp_eq_u32 s[42:43], 0, v4
    s_nop 1
    v_cndmask_b32 v73, v5, 0, s[42:43]
    v_lshlrev_b32 v70, 16, v70
    v_lshlrev_b32 v71, 16, v71
    s_mov_b32 s57, s56
    s_add_u32 s63, s8, 1024
    s_cmp_eq_u32 s8, 0
    s_cselect_b32 s63, 32, s63
    s_cmp_eq_u32 s57, 0
    s_cselect_b32 s58, s8, s63
    v_lshl_add_u32 v4, v3, 6, s58
    v_cvt_f32_u32 v78, v4
    v_mul_f32 v78, 0x3a000000, v78
    v_lshlrev_b32 v4, 3, v2
    v_cvt_f32_u32 v4, v4
    v_mul_f32 v79, v78, v4
    v_and_b32 v76, 31, v1
    v_lshlrev_b32 v76, 7, v76
    s_mov_b32 s50, 32768
    s_cmp_lg_u32 s3, 1
    s_cbranch_scc1 S_p0
    buffer_load_dword v20, v76, s[36:39], s50 offen sc1
        S_p0:

    v_cos_f32 v100, v78
    s_nop 0
    v_add_f32 v100, v100, v100
    v_fmamk_f32 v84, v78, 0x0, v79
    v_fmamk_f32 v85, v78, 0x3f800000, v79
    v_fmamk_f32 v92, v78, 0x0, v79
    v_fmamk_f32 v93, v78, 0x3f800000, v79
    v_cos_f32 v84, v84
    v_cos_f32 v85, v85
    v_sin_f32 v92, v92
    v_sin_f32 v93, v93
    v_fma_f32 v86, v100, v85, -v84
    v_fma_f32 v94, v100, v93, -v92
    v_fma_f32 v87, v100, v86, -v85
    v_fma_f32 v95, v100, v94, -v93
    v_fma_f32 v88, v100, v87, -v86
    v_fma_f32 v96, v100, v95, -v94
    v_fma_f32 v89, v100, v88, -v87
    v_fma_f32 v97, v100, v96, -v95
    v_fma_f32 v90, v100, v89, -v88
    v_fma_f32 v98, v100, v97, -v96
    v_fma_f32 v91, v100, v90, -v89
    v_fma_f32 v99, v100, v98, -v97
    v_cvt_pk_bf16_f32 v28, v84, v85
    v_cvt_pk_bf16_f32 v32, v92, v93
    v_mov_b32 v40, v28
    v_xor_b32 v36, 0x80008000, v32
    v_cvt_pk_bf16_f32 v29, v86, v87
    v_cvt_pk_bf16_f32 v33, v94, v95
    v_mov_b32 v41, v29
    v_xor_b32 v37, 0x80008000, v33
    v_cvt_pk_bf16_f32 v30, v88, v89
    v_cvt_pk_bf16_f32 v34, v96, v97
    v_mov_b32 v42, v30
    v_xor_b32 v38, 0x80008000, v34
    v_cvt_pk_bf16_f32 v31, v90, v91
    v_cvt_pk_bf16_f32 v35, v98, v99
    v_mov_b32 v43, v31
    v_xor_b32 v39, 0x80008000, v35
    s_cmp_eq_u32 s8, 0
    s_cbranch_scc1 S_cls0
S_reg:
    v_lshrrev_b32 v4, 2, v3
    s_cmp_lg_u32 s3, 1
    s_cbranch_scc1 P_dB
    s_mov_b32 s9, 0
P_lB:
    buffer_load_dword v21, v76, s[36:39], s50 offen sc1
    s_waitcnt vmcnt(1)
    v_cmp_ne_u32 vcc, s12, v20
    s_nop 0
    s_cbranch_vccz P_dB
    buffer_load_dword v20, v76, s[36:39], s50 offen sc1
    s_waitcnt vmcnt(1)
    v_cmp_ne_u32 vcc, s12, v21
    s_nop 0
    s_cbranch_vccz P_dB
    s_add_u32 s9, s9, 1
    s_cmp_lt_u32 s9, 200000
    s_cbranch_scc1 P_lB
P_dB:
    s_lshl_b32 s40, s3, 12
    s_add_u32 m0, s40, 0
    s_waitcnt lgkmcnt(0)
    s_barrier
    buffer_load_dwordx4 v44, s[36:39], s60 offen offset:0 sc1 lds
    buffer_load_dwordx4 v45, s[36:39], s60 offen offset:1024 sc1 lds
    buffer_load_dwordx4 v44, s[36:39], s60 offen offset:2048 sc1 lds
    buffer_load_dwordx4 v45, s[36:39], s60 offen offset:3072 sc1 lds
    ds_read_b128 v[102:105], v51 offset:0
    ds_read_b128 v[106:109], v51 offset:1024
    ds_read_b128 v[110:113], v51 offset:2048
    ds_read_b128 v[114:117], v51 offset:3072
    ds_read_b128 v[118:121], v51 offset:4096
    ds_read_b128 v[122:125], v51 offset:5120
    ds_read_b128 v[126:129], v51 offset:6144
    ds_read_b128 v[130:133], v51 offset:7168
    ds_read_b128 v[134:137], v51 offset:8192
    ds_read_b128 v[138:141], v51 offset:9216
    ds_read_b128 v[142:145], v51 offset:10240
    ds_read_b128 v[146:149], v51 offset:11264
    ds_read_b128 v[150:153], v51 offset:12288
    ds_read_b128 v[154:157], v51 offset:13312
    ds_read_b128 v[158:161], v51 offset:14336
    ds_read_b128 v[162:165], v51 offset:15360
    v_lshl_add_u32 v4, v2, 3, v4
    v_lshlrev_b32 v4, 7, v4
    v_and_b32 v5, 3, v1
    v_lshl_add_u32 v4, v5, 3, v4
    v_bfe_u32 v5, v1, 3, 2
    v_lshl_add_u32 v4, v5, 5, v4
    s_lshl_b32 s61, s55, 13
    s_add_u32 s61, s61, 0
    v_add_u32 v46, s61, v4
    v_mov_b32 v52, 81920
    v_lshl_add_u32 v52, s56, 2, v52
    v_mov_b32 v59, 1
    s_lshl_b32 s61, s56, 11
    v_add_u32 v53, s61, v47
    s_lshl_b32 s61, s56, 4
    v_add_u32 v4, s61, v3
    v_mul_u32_u24 v4, 528, v4
    v_add_u32 v4, 98304, v4
    v_lshl_add_u32 v5, s55, 2, v2
    v_lshl_add_u32 v48, v5, 4, v4
    s_and_b32 s61, s3, 1
    s_lshl_b32 s61, s61, 3
    v_lshrrev_b32 v4, 3, v1
    v_add_u32 v4, s61, v4
    v_and_b32 v5, 7, v1
    v_lshlrev_b32 v5, 4, v5
    s_and_b32 s61, s3, 2
    s_add_u32 s61, s61, s56
    s_mul_i32 s61, s61, 8448
    s_add_u32 s61, s61, 98304
    v_mul_u32_u24 v78, 528, v4
    v_add3_u32 v49, v78, v5, s61
    v_add_u32 v79, s61, v78
    s_bitcmp1_b32 s3, 1
    s_cselect_b32 s62, -1, 1
    s_mul_i32 s62, s62, 16896
    v_add_u32 v55, s62, v79
    s_cmp_eq_u32 s56, 0
    s_cselect_b32 s61, s8, s63
    v_lshl_add_u32 v50, v4, 6, s61
    v_sub_u32 v78, 2048, v50
    v_mov_b32 v4, 1024
    v_cmp_eq_u32 s[42:43], 0, v50
    s_nop 1
    v_cndmask_b32 v78, v78, v4, s[42:43]
    v_cndmask_b32 v55, v55, v79, s[42:43]
    s_bitcmp1_b32 s3, 1
    s_cselect_b64 s[42:43], -1, 0
    v_cndmask_b32 v50, v50, v78, s[42:43]
    v_mov_b32 v78, 1792
    v_mad_u32_u24 v50, v50, v78, v5
    v_sub_u32 v55, v55, v5
    v_and_b32 v4, 4, v1
    v_lshl_add_u32 v54, v4, 5, v49
    v_lshl_add_u32 v57, v4, 5, v50
    v_lshlrev_b32 v4, 4, v4
    v_sub_u32 v56, v55, v4
    v_mov_b32 v58, 0xffff
    v_xor_b32 v230, 32, v46
    v_xor_b32 v231, 64, v46
    v_xor_b32 v232, 96, v46
    s_lshl_b32 s40, s55, 13
    s_lshl_b32 s41, s57, 11
    s_add_u32 s40, s40, s41
    v_add_u32 v233, s40, v47
    s_lshl_b32 s40, s3, 12
    v_add_u32 v5, s40, v47
    v_xor_b32 v70, s51, v70
    v_xor_b32 v71, s51, v71
    s_mov_b32 s9, 0
        S_gc:

    s_waitcnt vmcnt(3)
    ds_read_b32 v84, v5 offset:12
    s_waitcnt vmcnt(2)
    ds_read_b32 v85, v5 offset:1036
    s_waitcnt vmcnt(1)
    ds_read_b32 v86, v5 offset:2060
    s_waitcnt vmcnt(0)
    ds_read_b32 v87, v5 offset:3084
    s_waitcnt lgkmcnt(1)
    v_xor_b32 v84, v70, v84
    v_xor_b32 v86, v70, v86
    v_xor_b32 v85, v71, v85
    v_or_b32 v84, v84, v86
    v_and_b32 v84, v72, v84
    v_and_or_b32 v84, v73, v85, v84
    s_waitcnt lgkmcnt(0)
    v_xor_b32 v87, v71, v87
    v_and_or_b32 v84, v73, v87, v84
    v_cmp_ne_u32 vcc, 0, v84
    s_nop 0
    s_cbranch_vccnz S_gr
        S_gk:
    s_barrier

    s_cmp_lg_u32 s56, 0
    s_cbranch_scc1 S_np
    s_setprio 1
S_np:
    ds_read_b64_tr_b16 v[166:167], v46 offset:0
    ds_read_b64_tr_b16 v[168:169], v46 offset:512
    ds_read_b64_tr_b16 v[170:171], v46 offset:4096
    ds_read_b64_tr_b16 v[172:173], v46 offset:4608
    ds_read_b64_tr_b16 v[174:175], v230 offset:0
    ds_read_b64_tr_b16 v[176:177], v230 offset:512
    ds_read_b64_tr_b16 v[178:179], v230 offset:4096
    ds_read_b64_tr_b16 v[180:181], v230 offset:4608
    ds_read_b64_tr_b16 v[182:183], v231 offset:0
    ds_read_b64_tr_b16 v[184:185], v231 offset:512
    ds_read_b64_tr_b16 v[186:187], v231 offset:4096
    ds_read_b64_tr_b16 v[188:189], v231 offset:4608
    ds_read_b64_tr_b16 v[190:191], v232 offset:0
    ds_read_b64_tr_b16 v[192:193], v232 offset:512
    ds_read_b64_tr_b16 v[194:195], v232 offset:4096
    ds_read_b64_tr_b16 v[196:197], v232 offset:4608
    s_waitcnt lgkmcnt(14)
    v_mfma_f32_16x16x32_bf16 v[198:201], v[166:169], v[28:31], 0
    s_waitcnt lgkmcnt(12)
    v_mfma_f32_16x16x32_bf16 v[198:201], v[170:173], v[32:35], v[198:201]
    v_mfma_f32_16x16x32_bf16 v[214:217], v[166:169], v[36:39], 0
    v_mfma_f32_16x16x32_bf16 v[214:217], v[170:173], v[40:43], v[214:217]
    s_waitcnt lgkmcnt(10)
    v_mfma_f32_16x16x32_bf16 v[202:205], v[174:177], v[28:31], 0
    s_waitcnt lgkmcnt(8)
    v_mfma_f32_16x16x32_bf16 v[202:205], v[178:181], v[32:35], v[202:205]
    v_mfma_f32_16x16x32_bf16 v[218:221], v[174:177], v[36:39], 0
    v_mfma_f32_16x16x32_bf16 v[218:221], v[178:181], v[40:43], v[218:221]
    s_waitcnt lgkmcnt(6)
    v_mfma_f32_16x16x32_bf16 v[206:209], v[182:185], v[28:31], 0
    s_waitcnt lgkmcnt(4)
    v_mfma_f32_16x16x32_bf16 v[206:209], v[186:189], v[32:35], v[206:209]
    v_cvt_pk_bf16_f32 v234, v198, v199
    v_cvt_pk_bf16_f32 v235, v200, v201
    v_cvt_pk_bf16_f32 v236, v202, v203
    v_cvt_pk_bf16_f32 v237, v204, v205
    ds_write_b128 v233, v[234:237] offset:32768
    v_mfma_f32_16x16x32_bf16 v[222:225], v[182:185], v[36:39], 0
    v_mfma_f32_16x16x32_bf16 v[222:225], v[186:189], v[40:43], v[222:225]
    v_cvt_pk_bf16_f32 v238, v214, v215
    v_cvt_pk_bf16_f32 v239, v216, v217
    v_cvt_pk_bf16_f32 v240, v218, v219
    v_cvt_pk_bf16_f32 v241, v220, v221
    ds_write_b128 v233, v[238:241] offset:36864
    s_waitcnt lgkmcnt(4)
    v_mfma_f32_16x16x32_bf16 v[210:213], v[190:193], v[28:31], 0
    s_waitcnt lgkmcnt(2)
    v_mfma_f32_16x16x32_bf16 v[210:213], v[194:197], v[32:35], v[210:213]
    v_mfma_f32_16x16x32_bf16 v[226:229], v[190:193], v[36:39], 0
    v_mfma_f32_16x16x32_bf16 v[226:229], v[194:197], v[40:43], v[226:229]
    s_add_u32 s40, s8, s57
    s_cmp_eq_u32 s40, 0
    s_cbranch_scc1 S_x0
S_x1:
    v_cvt_pk_bf16_f32 v166, v206, v207
    v_cvt_pk_bf16_f32 v167, v208, v209
    s_nop 0
    v_cvt_pk_bf16_f32 v168, v210, v211
    v_cvt_pk_bf16_f32 v169, v212, v213
    ds_write_b128 v233, v[166:169] offset:33792
    v_cvt_pk_bf16_f32 v170, v222, v223
    v_cvt_pk_bf16_f32 v171, v224, v225
    v_cvt_pk_bf16_f32 v172, v226, v227
    v_cvt_pk_bf16_f32 v173, v228, v229
    ds_write_b128 v233, v[170:173] offset:37888
    s_mov_b64 exec, 1
    ds_add_u32 v52, v59 offset:8
    s_mov_b64 exec, -1
    s_mov_b32 s9, 0
        W_lU:
    ds_read_b32 v4, v52 offset:8
    s_add_u32 s9, s9, 1
    s_cmp_gt_u32 s9, 1600000
    s_cbranch_scc1 W_dU
    s_waitcnt lgkmcnt(0)
    v_cmp_gt_u32 vcc, 4, v4

    s_nop 0
    s_cbranch_vccnz W_lU
W_dU:
    ds_read_b128 v[166:169], v53 offset:32768
    ds_read_b128 v[170:173], v53 offset:33792
    ds_read_b128 v[174:177], v53 offset:40960
    ds_read_b128 v[178:181], v53 offset:41984
    ds_read_b128 v[182:185], v53 offset:49152
    ds_read_b128 v[186:189], v53 offset:50176
    ds_read_b128 v[190:193], v53 offset:57344
    s_waitcnt lgkmcnt(6)
    v_mfma_f32_16x16x32_bf16 v[198:201], v[102:105], v[166:169], 0
    ds_read_b128 v[194:197], v53 offset:58368
    s_waitcnt lgkmcnt(6)
    v_mfma_f32_16x16x32_bf16 v[198:201], v[106:109], v[170:173], v[198:201]
    ds_read_b128 v[166:169], v53 offset:53248
    s_waitcnt lgkmcnt(6)
    v_mfma_f32_16x16x32_bf16 v[202:205], v[110:113], v[174:177], 0
    ds_read_b128 v[170:173], v53 offset:54272
    s_waitcnt lgkmcnt(6)
    v_mfma_f32_16x16x32_bf16 v[202:205], v[114:117], v[178:181], v[202:205]
    ds_read_b128 v[174:177], v53 offset:61440
    s_waitcnt lgkmcnt(6)
    v_mfma_f32_16x16x32_bf16 v[214:217], v[134:137], v[182:185], 0
    ds_read_b128 v[178:181], v53 offset:62464
    s_waitcnt lgkmcnt(6)
    v_mfma_f32_16x16x32_bf16 v[214:217], v[138:141], v[186:189], v[214:217]
    ds_read_b128 v[182:185], v53 offset:36864
    s_waitcnt lgkmcnt(6)
    v_mfma_f32_16x16x32_bf16 v[218:221], v[142:145], v[190:193], 0
    ds_read_b128 v[186:189], v53 offset:37888
    s_waitcnt lgkmcnt(6)
    v_mfma_f32_16x16x32_bf16 v[218:221], v[146:149], v[194:197], v[218:221]
    ds_read_b128 v[190:193], v53 offset:45056
    s_waitcnt lgkmcnt(6)
    v_mfma_f32_16x16x32_bf16 v[206:209], v[118:121], v[166:169], 0
    ds_read_b128 v[194:197], v53 offset:46080
    s_waitcnt lgkmcnt(6)
    v_mfma_f32_16x16x32_bf16 v[206:209], v[122:125], v[170:173], v[206:209]
    s_waitcnt lgkmcnt(5)
    v_mfma_f32_16x16x32_bf16 v[210:213], v[126:129], v[174:177], 0
    v_pk_add_f32 v[84:85], v[198:199], v[202:203]
    v_pk_add_f32 v[86:87], v[200:201], v[204:205]
    s_waitcnt lgkmcnt(4)
    v_mfma_f32_16x16x32_bf16 v[210:213], v[130:133], v[178:181], v[210:213]
    v_pk_add_f32 v[202:203], v[198:199], v[202:203] neg_lo:[0,1] neg_hi:[0,1]
    v_pk_add_f32 v[204:205], v[200:201], v[204:205] neg_lo:[0,1] neg_hi:[0,1]
    s_waitcnt lgkmcnt(3)
    v_mfma_f32_16x16x32_bf16 v[222:225], v[150:153], v[182:185], 0
    v_pk_add_f32 v[88:89], v[214:215], v[218:219]
    s_waitcnt lgkmcnt(2)
    v_mfma_f32_16x16x32_bf16 v[222:225], v[154:157], v[186:189], v[222:225]
    v_pk_add_f32 v[90:91], v[216:217], v[220:221]
    s_waitcnt lgkmcnt(1)
    v_mfma_f32_16x16x32_bf16 v[226:229], v[158:161], v[190:193], 0
    v_pk_add_f32 v[218:219], v[214:215], v[218:219] neg_lo:[0,1] neg_hi:[0,1]
    s_waitcnt lgkmcnt(0)
    v_mfma_f32_16x16x32_bf16 v[226:229], v[162:165], v[194:197], v[226:229]
    v_pk_add_f32 v[220:221], v[216:217], v[220:221] neg_lo:[0,1] neg_hi:[0,1]
    s_add_u32 s40, s8, s56
    s_cmp_eq_u32 s40, 0
    s_cbranch_scc1 S_y0
S_y1:
    v_pk_add_f32 v[198:199], v[206:207], v[210:211]
    v_pk_add_f32 v[200:201], v[208:209], v[212:213]
    v_pk_add_f32 v[210:211], v[206:207], v[210:211] neg_lo:[0,1] neg_hi:[0,1]
    v_pk_add_f32 v[212:213], v[208:209], v[212:213] neg_lo:[0,1] neg_hi:[0,1]
    v_pk_add_f32 v[214:215], v[222:223], v[226:227]
    v_pk_add_f32 v[216:217], v[224:225], v[228:229]
    v_pk_add_f32 v[226:227], v[222:223], v[226:227] neg_lo:[0,1] neg_hi:[0,1]
    v_pk_add_f32 v[228:229], v[224:225], v[228:229] neg_lo:[0,1] neg_hi:[0,1]
    v_pk_add_f32 v[206:207], v[84:85], v[198:199]
    v_pk_add_f32 v[208:209], v[86:87], v[200:201]
    v_pk_add_f32 v[222:223], v[88:89], v[214:215]
    v_pk_add_f32 v[224:225], v[90:91], v[216:217]
    v_cvt_pk_bf16_f32 v166, v206, v222
    v_cvt_pk_bf16_f32 v167, v207, v223
    v_cvt_pk_bf16_f32 v168, v208, v224
    v_cvt_pk_bf16_f32 v169, v209, v225
    ds_write_b128 v48, v[166:169] offset:0
    v_pk_add_f32 v[206:207], v[84:85], v[198:199] neg_lo:[0,1] neg_hi:[0,1]
    v_pk_add_f32 v[208:209], v[86:87], v[200:201] neg_lo:[0,1] neg_hi:[0,1]
    v_pk_add_f32 v[222:223], v[88:89], v[214:215] neg_lo:[0,1] neg_hi:[0,1]
    v_pk_add_f32 v[224:225], v[90:91], v[216:217] neg_lo:[0,1] neg_hi:[0,1]
    v_cvt_pk_bf16_f32 v170, v206, v222
    v_cvt_pk_bf16_f32 v171, v207, v223
    v_cvt_pk_bf16_f32 v172, v208, v224
    v_cvt_pk_bf16_f32 v173, v209, v225
    ds_write_b128 v48, v[170:173] offset:16896
    v_pk_add_f32 v[206:207], v[202:203], v[210:211]
    v_pk_add_f32 v[208:209], v[204:205], v[212:213]
    v_pk_add_f32 v[222:223], v[218:219], v[226:227]
    v_pk_add_f32 v[224:225], v[220:221], v[228:229]
    v_cvt_pk_bf16_f32 v174, v206, v222
    v_cvt_pk_bf16_f32 v175, v207, v223
    v_cvt_pk_bf16_f32 v176, v208, v224
    v_cvt_pk_bf16_f32 v177, v209, v225
    ds_write_b128 v48, v[174:177] offset:256
    v_pk_add_f32 v[206:207], v[202:203], v[210:211] neg_lo:[0,1] neg_hi:[0,1]
    v_pk_add_f32 v[208:209], v[204:205], v[212:213] neg_lo:[0,1] neg_hi:[0,1]
    v_pk_add_f32 v[222:223], v[218:219], v[226:227] neg_lo:[0,1] neg_hi:[0,1]
    v_pk_add_f32 v[224:225], v[220:221], v[228:229] neg_lo:[0,1] neg_hi:[0,1]
    v_cvt_pk_bf16_f32 v178, v206, v222
    v_cvt_pk_bf16_f32 v179, v207, v223
    v_cvt_pk_bf16_f32 v180, v208, v224
    v_cvt_pk_bf16_f32 v181, v209, v225
    ds_write_b128 v48, v[178:181] offset:17152
    s_mov_b64 exec, 1
    ds_add_u32 v52, v59
    s_mov_b64 exec, -1
    s_mov_b32 s9, 0
        W_lO:
    ds_read_b32 v4, v52 offset:0
    s_add_u32 s9, s9, 1
    s_cmp_gt_u32 s9, 1600000
    s_cbranch_scc1 W_dO
    s_waitcnt lgkmcnt(0)
    v_cmp_gt_u32 vcc, 4, v4

    s_nop 0
    s_cbranch_vccnz W_lO
W_dO:
    v_and_b32 v4, 4, v1
    v_lshl_add_u32 v5, v4, 6, v50
    ds_read_b128 v[102:105], v49 offset:0
    ds_read_b128 v[106:109], v49 offset:128
    ds_read_b128 v[110:113], v49 offset:320
    ds_read_b128 v[114:117], v54 offset:256
    ds_read_b128 v[118:121], v55 offset:432
    ds_read_b32 v122, v55 offset:448
    ds_read_b128 v[126:129], v55 offset:112
    ds_read_b32 v130, v55 offset:128
    ds_read_b128 v[134:137], v56 offset:304
    ds_read_b32 v138, v56 offset:320
    s_waitcnt lgkmcnt(9)
    buffer_store_dwordx4 v[102:105], v50, s[32:35], 0 offen offset:896 nt
    s_waitcnt lgkmcnt(8)
    buffer_store_dwordx4 v[106:109], v50, s[32:35], 0 offen offset:1024 nt
    s_waitcnt lgkmcnt(7)
    buffer_store_dwordx4 v[110:113], v50, s[32:35], 0 offen offset:1408 nt
    s_waitcnt lgkmcnt(6)
    buffer_store_dwordx4 v[114:117], v57, s[32:35], 0 offen offset:1344 nt
    s_waitcnt lgkmcnt(4)
    v_bfi_b32 v142, v58, v122, v121
    v_bfi_b32 v143, v58, v121, v120
    v_bfi_b32 v144, v58, v120, v119
    v_bfi_b32 v145, v58, v119, v118
    buffer_store_dwordx4 v[142:145], v50, s[32:35], 0 offen offset:1152 nt
    s_waitcnt lgkmcnt(2)
    v_bfi_b32 v146, v58, v130, v129
    v_bfi_b32 v147, v58, v129, v128
    v_bfi_b32 v148, v58, v128, v127
    v_bfi_b32 v149, v58, v127, v126
    buffer_store_dwordx4 v[146:149], v50, s[32:35], 0 offen offset:1664 nt
    s_waitcnt lgkmcnt(0)
    v_bfi_b32 v150, v58, v138, v137
    v_bfi_b32 v151, v58, v137, v136
    v_bfi_b32 v152, v58, v136, v135
    v_bfi_b32 v153, v58, v135, v134
    buffer_store_dwordx4 v[150:153], v5, s[32:35], 0 offen offset:1280 nt
    s_add_u32 s40, s8, s3
    s_cmp_lg_u32 s40, 0
    s_cbranch_scc1 S_end
    s_add_u32 s40, s10, 16
    v_mov_b32 v4, s40
    s_mov_b32 s40, 4096
    s_mov_b64 exec, 1
    buffer_store_dword v4, v12, s[36:39], s40 offen
        S_end:

    s_endpgm
    s_endpgm
    s_endpgm
    s_endpgm
    s_endpgm
    s_endpgm
    s_endpgm
    s_endpgm
    s_endpgm
    s_endpgm
    s_endpgm
    s_endpgm
    s_endpgm
    s_endpgm
    s_endpgm
    s_endpgm
    s_endpgm
    s_endpgm
    s_endpgm
    s_endpgm
    s_endpgm
    s_endpgm
    s_endpgm
    s_endpgm
    s_endpgm
    s_endpgm
    s_endpgm
    s_endpgm
    s_endpgm
    s_endpgm
    s_endpgm
    s_endpgm
    s_endpgm
    s_endpgm
    s_endpgm
    s_endpgm
    s_endpgm
    s_endpgm
    s_endpgm
    s_endpgm
    s_endpgm
    s_endpgm
    s_endpgm
    s_endpgm
    s_endpgm
    s_endpgm
    s_endpgm
    s_endpgm
    s_endpgm
    s_endpgm
    s_endpgm
    s_endpgm
    s_endpgm
    s_endpgm
    s_endpgm
    s_endpgm
    s_endpgm
    s_endpgm
    s_endpgm
    s_endpgm
    s_endpgm
    s_endpgm
    s_endpgm
    s_endpgm
    s_endpgm
    s_endpgm
    s_endpgm
    s_endpgm
    s_endpgm
    s_endpgm
    s_endpgm
    s_endpgm
    s_endpgm
    s_endpgm
    s_endpgm
    s_endpgm
    s_endpgm
    s_endpgm
    s_endpgm
    s_endpgm
    s_endpgm
    s_endpgm
    s_endpgm
    s_endpgm
    s_endpgm
    s_endpgm
    s_endpgm
    s_endpgm
    s_endpgm
    s_endpgm
    s_endpgm
    s_endpgm
    s_endpgm
    s_endpgm
    s_endpgm
    s_endpgm
    s_endpgm
    s_endpgm
    s_endpgm
    s_endpgm
    s_endpgm
    s_endpgm
    s_endpgm
    s_endpgm
    s_endpgm
    s_endpgm
    s_endpgm
    s_endpgm
    s_endpgm
    s_endpgm
    s_endpgm
    s_endpgm
    s_endpgm
    s_endpgm
    s_endpgm
    s_endpgm
    s_endpgm
    s_endpgm
    s_endpgm
    s_endpgm
    s_endpgm
    s_endpgm
    s_endpgm
    s_endpgm
    s_endpgm
    s_endpgm
    s_endpgm
    s_endpgm
    s_endpgm
K_c:
    s_lshl_b32 s40, s8, 7
    s_waitcnt lgkmcnt(0)
    s_load_dwordx2 s[10:11], s[36:37], s40
    s_lshl_b32 s14, s8, 10
    s_add_u32 s14, s14, 65536
    s_getreg_b32 s52, hwreg(HW_REG_XCC_ID, 0, 3)
    s_mov_b32 s26, 401408
    s_mov_b32 s27, 0x00020000
    s_mov_b32 s34, 3670016
    s_mov_b32 s35, 0x00020000
    s_sub_u32 s62, s3, 4
    s_lshr_b32 s16, s62, 1
    s_and_b32 s17, s62, 1
    s_lshl_b32 s29, s62, 11
    v_and_b32 v1, 63, v0
    v_lshlrev_b32 v4, 4, v1
    s_lshl_b32 s1, s5, 3
    s_add_u32 s1, s1, s4
    s_mul_i32 s1, s1, 1792
    v_min_u32 v41, 13, v1
    v_lshlrev_b32 v41, 7, v41
    v_lshrrev_b32 v24, 4, v1
    v_and_b32 v25, 15, v1
    v_lshrrev_b32 v26, 3, v1
    v_and_b32 v27, 7, v1
    v_mov_b32 v5, 161792
    v_mov_b32 v6, 0
    v_lshl_add_u32 v2, v1, 2, v5
    ds_write_b32 v2, v6
    v_lshrrev_b32 v3, 1, v25
    v_xor_b32 v3, v3, v24
    v_lshlrev_b32 v3, 4, v3
    v_lshl_add_u32 v3, v25, 7, v3
    s_lshr_b32 s18, s62, 1
    s_lshl_b32 s18, s18, 12
    v_add_u32 v28, s18, v3
    v_xor_b32 v29, 64, v28
    v_add_u32 v30, 40960, v28
    v_add_u32 v31, 40960, v29
    v_lshrrev_b32 v3, 2, v25
    v_lshl_add_u32 v3, v24, 3, v3
    v_lshlrev_b32 v3, 7, v3
    v_and_b32 v7, 3, v1
    v_lshl_add_u32 v3, v7, 3, v3
    v_bfe_u32 v7, v1, 3, 2
    s_and_b32 s18, s62, 1
    s_lshl_b32 s18, s18, 1
    v_xor_b32 v7, s18, v7
    v_lshl_add_u32 v3, v7, 5, v3
    v_add_u32 v32, 71680, v3
    v_xor_b32 v33, 32, v32
    v_add_u32 v34, 49152, v32
    v_add_u32 v35, 49152, v33
    s_and_b32 s18, s62, 1
    s_lshl_b32 s19, s7, 1
    s_add_u32 s18, s18, s19
    s_cmp_ge_u32 s18, 7
    s_cselect_b32 s19, 14, 7
    s_sub_u32 s18, s19, s18
    v_cmp_gt_u32 s[54:55], s18, v24
    v_add_u32 v2, 4, v24
    v_cmp_gt_u32 s[56:57], s18, v2
    s_bitcmp0_b32 s62, 0
    s_cselect_b64 vcc, -1, 0
    s_xor_b64 s[54:55], s[54:55], vcc
    s_xor_b64 s[56:57], s[56:57], vcc
    v_lshrrev_b32 v3, 2, v25
    s_and_b32 s18, s62, 1
    s_lshl_b32 s19, s7, 1
    s_add_u32 s18, s18, s19
    s_cmp_ge_u32 s18, 7
    s_cselect_b32 s19, 14, 7
    s_sub_u32 s18, s19, s18
    v_cmp_gt_u32 s[58:59], s18, v3
    v_add_u32 v2, 4, v3
    v_cmp_gt_u32 s[60:61], s18, v2
    s_bitcmp0_b32 s62, 0
    s_cselect_b64 vcc, -1, 0
    s_xor_b64 s[58:59], s[58:59], vcc
    s_xor_b64 s[60:61], s[60:61], vcc
    s_and_b32 s18, s62, 1
    s_lshl_b32 s19, s7, 1
    s_add_u32 s18, s18, s19
    s_lshl_b32 s100, s18, 10
    s_lshl_b32 s18, s8, 2
    s_and_b32 s19, s62, 2
    s_add_u32 s18, s18, s19
    s_mul_i32 s19, s18, 14336
    s_add_u32 s100, s100, s19
    s_add_u32 s100, s100, 2097152
    s_lshl_b32 s20, s18, 6
    s_add_u32 s20, s20, 16384
    s_lshl_b32 s18, s17, 11
    s_sub_u32 s18, s18, 1024
    s_add_u32 s15, s100, s18
    s_lshl_b32 s19, s7, 1
    s_add_u32 s18, s17, s19
    s_lshl_b32 s18, s18, 3
    s_add_u32 s21, s20, s18
    v_and_b32 v2, 1, v25
    v_cmp_eq_u32 s[44:45], 1, v2
    v_lshl_add_u32 v2, v24, 2, v2
    v_cmp_le_u32 s[46:47], v2, v25
    v_add_u32 v2, 2, v2
    v_cmp_le_u32 s[48:49], v2, v25
    v_mov_b32 v2, 0xffff
    v_mov_b32 v3, 0xffff0000
    v_cndmask_b32 v2, v2, v3, s[44:45]
    v_cndmask_b32 v36, v2, 0, s[46:47]
    v_cndmask_b32 v37, v2, 0, s[48:49]
    v_cndmask_b32 v38, 0, v2, s[46:47]
    v_cndmask_b32 v39, 0, v2, s[48:49]
    s_add_u32 s18, s8, s16
    s_cmp_eq_u32 s18, 0
    s_cselect_b64 s[50:51], -1, 0
    s_mul_i32 s18, s17, 6
    s_cmp_eq_u32 s18, s7
    s_cselect_b32 s101, 1, 0
    v_mov_b32 v44, 1
    v_mov_b32 v45, 0xf149f2ca
    v_mov_b32 v46, 0xffffff00
    s_mov_b32 s0, 0x3e8b97f6
    s_add_u32 s18, s29, 4096
    v_add_u32 v42, s18, v4
    v_add_u32 v43, s29, v4
    v_lshl_add_u32 v47, s62, 2, v5
    v_lshl_add_u32 v218, s17, 10, v4
    v_add_u32 v219, 2048, v218
    v_lshl_add_u32 v220, s17, 2, v5
    v_lshl_add_u32 v221, s17, 3, v5
    s_lshl_b32 s18, s7, 7
    v_min_u32 v8, 13, v1
    v_lshlrev_b32 v8, 3, v8
    v_lshrrev_b32 v2, 2, v1
    v_bfe_u32 v3, v1, 3, 2
    v_lshlrev_b32 v3, 5, v3
    v_lshl_add_u32 v2, v2, 7, v3
    v_and_b32 v3, 3, v1
    v_lshl_add_u32 v2, v3, 3, v2
    v_add_u32 v16, 71680, v2
    v_xor_b32 v17, 32, v16
    v_xor_b32 v18, 64, v16
    v_xor_b32 v19, 96, v16
    s_add_u32 s19, s29, 4096
    v_lshrrev_b32 v2, 1, v24
    v_xor_b32 v2, v2, v27
    v_lshlrev_b32 v2, 4, v2
    v_lshl_add_u32 v2, v25, 7, v2
    v_and_b32 v3, 1, v24
    v_lshl_add_u32 v2, v3, 3, v2
    v_add_u32 v20, s19, v2
    v_xor_b32 v21, 32, v20
    v_xor_b32 v22, 64, v20
    v_xor_b32 v23, 96, v20
    v_mul_u32_u24 v10, 1792, v26
    v_lshl_add_u32 v10, v27, 4, v10
    v_xor_b32 v3, v27, v26
    v_lshlrev_b32 v3, 4, v3
    v_lshl_add_u32 v2, v26, 7, v3
    v_add_u32 v9, s19, v2
    s_lshl_b32 s19, s8, 2
    s_add_u32 s19, s19, s62
    s_mul_i32 s22, s19, 14336
    s_add_u32 s22, s22, 2097152
    s_mul_i32 s23, s19, 28672
    s_add_u32 s23, s23, s18
    s_add_u32 s28, s23, 14336
    s_waitcnt lgkmcnt(0)
    s_add_u32 s12, s10, 0x5a3c9671
    s_xor_b32 s13, s11, 0x2b7e1516
    s_add_u32 s52, s52, s12
    s_mov_b32 s53, s13
    v_mov_b32 v14, s12
    v_mov_b32 v15, s13
    s_bfe_u32 s40, s12, 0x80000
    v_mov_b32 v50, s40
    s_bfe_u32 s40, s12, 0x80008
    v_mov_b32 v51, s40
    s_bfe_u32 s40, s12, 0x80010
    v_mov_b32 v52, s40
    s_bfe_u32 s40, s12, 0x80018
    v_mov_b32 v53, s40
    s_setprio 3
    s_cmp_lg_u32 s62, 0
    s_cbranch_scc1 C_nox
    v_mov_b32 v12, s52
    v_mov_b32 v13, s53
    s_lshl_b32 s41, s7, 3
    s_add_u32 s40, s14, s41
    s_mov_b64 exec, 1
    buffer_store_dwordx2 v[12:13], v6, s[36:39], s40 offen sc1
    s_mov_b64 exec, -1

C_nox:

    s_cmp_lg_u32 s16, 0
    s_cbranch_scc1 C_tp1
    s_barrier
    ds_read_b128 v[130:133], v28 offset:2048
    ds_read_b64_tr_b16 v[174:175], v32 offset:8192
    ds_read_b64_tr_b16 v[176:177], v32 offset:8704
    ds_read_b128 v[142:145], v29 offset:2048
    ds_read_b64_tr_b16 v[178:179], v32 offset:12288
    ds_read_b64_tr_b16 v[180:181], v32 offset:12800
    ds_read_b128 v[134:137], v28 offset:4096
    ds_read_b128 v[146:149], v29 offset:4096
    ds_read_b64_tr_b16 v[182:183], v33 offset:8192
    ds_read_b64_tr_b16 v[184:185], v33 offset:8704
    ds_read_b64_tr_b16 v[186:187], v33 offset:12288
    ds_read_b64_tr_b16 v[188:189], v33 offset:12800
    s_waitcnt lgkmcnt(9)
    v_mfma_f32_16x16x32_bf16 v[62:65], v[174:177], v[130:133], 0
    ds_read_b128 v[126:129], v28 offset:0
    s_waitcnt lgkmcnt(7)
    v_mfma_f32_16x16x32_bf16 v[62:65], v[178:181], v[142:145], v[62:65]
    ds_read_b64_tr_b16 v[190:191], v32 offset:16384
    ds_read_b64_tr_b16 v[192:193], v32 offset:16896
    s_waitcnt lgkmcnt(8)
    v_mfma_f32_16x16x32_bf16 v[70:73], v[174:177], v[134:137], 0
    ds_read_b128 v[138:141], v29 offset:0
    ds_read_b64_tr_b16 v[194:195], v32 offset:20480
    s_waitcnt lgkmcnt(9)
    v_mfma_f32_16x16x32_bf16 v[70:73], v[178:181], v[146:149], v[70:73]
    ds_read_b64_tr_b16 v[196:197], v32 offset:20992
    s_waitcnt lgkmcnt(8)
    v_mfma_f32_16x16x32_bf16 v[66:69], v[182:185], v[130:133], 0
    ds_read_b64_tr_b16 v[174:175], v33 offset:16384
    s_waitcnt lgkmcnt(7)
    v_mfma_f32_16x16x32_bf16 v[66:69], v[186:189], v[142:145], v[66:69]
    ds_read_b64_tr_b16 v[176:177], v33 offset:16896
    v_mfma_f32_16x16x32_bf16 v[74:77], v[182:185], v[134:137], 0
    ds_read_b64_tr_b16 v[178:179], v33 offset:20480
    v_mfma_f32_16x16x32_bf16 v[74:77], v[186:189], v[146:149], v[74:77]
    ds_read_b64_tr_b16 v[180:181], v33 offset:20992
    s_waitcnt lgkmcnt(7)
    v_mfma_f32_16x16x32_bf16 v[78:81], v[190:193], v[126:129], 0
    ds_read_b64_tr_b16 v[182:183], v32 offset:24576
    s_waitcnt lgkmcnt(5)
    v_mfma_f32_16x16x32_bf16 v[78:81], v[194:197], v[138:141], v[78:81]
    ds_read_b64_tr_b16 v[184:185], v32 offset:25088
    v_mfma_f32_16x16x32_bf16 v[86:89], v[190:193], v[130:133], 0
    ds_read_b64_tr_b16 v[186:187], v32 offset:28672
    v_mfma_f32_16x16x32_bf16 v[86:89], v[194:197], v[142:145], v[86:89]
    ds_read_b64_tr_b16 v[188:189], v32 offset:29184
    v_mfma_f32_16x16x32_bf16 v[94:97], v[190:193], v[134:137], 0
    ds_read_b64_tr_b16 v[190:191], v33 offset:24576
    v_mfma_f32_16x16x32_bf16 v[94:97], v[194:197], v[146:149], v[94:97]
    ds_read_b64_tr_b16 v[192:193], v33 offset:25088
    s_waitcnt lgkmcnt(8)
    v_mfma_f32_16x16x32_bf16 v[82:85], v[174:177], v[126:129], 0
    ds_read_b64_tr_b16 v[194:195], v33 offset:28672
    s_waitcnt lgkmcnt(7)
    v_mfma_f32_16x16x32_bf16 v[82:85], v[178:181], v[138:141], v[82:85]
    ds_read_b64_tr_b16 v[196:197], v33 offset:29184
    v_mfma_f32_16x16x32_bf16 v[90:93], v[174:177], v[130:133], 0
    v_mfma_f32_16x16x32_bf16 v[90:93], v[178:181], v[142:145], v[90:93]
    v_mfma_f32_16x16x32_bf16 v[98:101], v[174:177], v[134:137], 0
    v_mfma_f32_16x16x32_bf16 v[98:101], v[178:181], v[146:149], v[98:101]
    s_waitcnt lgkmcnt(6)
    v_mfma_f32_16x16x32_bf16 v[102:105], v[126:129], v[182:185], 0
    s_waitcnt lgkmcnt(4)
    v_mfma_f32_16x16x32_bf16 v[102:105], v[138:141], v[186:189], v[102:105]
    v_mfma_f32_16x16x32_bf16 v[110:113], v[130:133], v[182:185], 0
    v_mfma_f32_16x16x32_bf16 v[110:113], v[142:145], v[186:189], v[110:113]
    s_waitcnt lgkmcnt(2)
    v_mfma_f32_16x16x32_bf16 v[106:109], v[126:129], v[190:193], 0
    s_waitcnt lgkmcnt(0)
    s_barrier
    ds_read_b128 v[154:157], v28 offset:12288
    ds_read_b64_tr_b16 v[174:175], v32 offset:32768
    ds_read_b64_tr_b16 v[176:177], v32 offset:33280
    ds_read_b128 v[166:169], v29 offset:12288
    ds_read_b64_tr_b16 v[178:179], v32 offset:36864
    ds_read_b64_tr_b16 v[180:181], v32 offset:37376
    ds_read_b128 v[158:161], v28 offset:14336
    ds_read_b128 v[170:173], v29 offset:14336
    ds_read_b64_tr_b16 v[182:183], v33 offset:32768
    ds_read_b64_tr_b16 v[184:185], v33 offset:33280
    ds_read_b64_tr_b16 v[186:187], v33 offset:36864
    ds_read_b64_tr_b16 v[188:189], v33 offset:37376
    ds_read_b128 v[150:153], v28 offset:10240
    v_mfma_f32_16x16x32_bf16 v[106:109], v[138:141], v[194:197], v[106:109]
    v_mfma_f32_16x16x32_bf16 v[114:117], v[130:133], v[190:193], 0
    ds_read_b64_tr_b16 v[190:191], v32 offset:40960
    v_mfma_f32_16x16x32_bf16 v[114:117], v[142:145], v[194:197], v[114:117]
    ds_read_b64_tr_b16 v[192:193], v32 offset:41472
    s_waitcnt lgkmcnt(12)
    v_mfma_f32_16x16x32_bf16 v[62:65], v[174:177], v[154:157], v[62:65]
    ds_read_b128 v[162:165], v29 offset:10240
    s_waitcnt lgkmcnt(10)
    v_mfma_f32_16x16x32_bf16 v[62:65], v[178:181], v[166:169], v[62:65]
    ds_read_b64_tr_b16 v[194:195], v32 offset:45056
    s_waitcnt lgkmcnt(10)
    v_mfma_f32_16x16x32_bf16 v[70:73], v[174:177], v[158:161], v[70:73]
    ds_read_b64_tr_b16 v[196:197], v32 offset:45568
    s_waitcnt lgkmcnt(10)
    v_mfma_f32_16x16x32_bf16 v[70:73], v[178:181], v[170:173], v[70:73]
    ds_read_b64_tr_b16 v[174:175], v33 offset:40960
    s_waitcnt lgkmcnt(9)
    v_mfma_f32_16x16x32_bf16 v[66:69], v[182:185], v[154:157], v[66:69]
    ds_read_b64_tr_b16 v[176:177], v33 offset:41472
    s_waitcnt lgkmcnt(8)
    v_mfma_f32_16x16x32_bf16 v[66:69], v[186:189], v[166:169], v[66:69]
    ds_read_b64_tr_b16 v[178:179], v33 offset:45056
    v_mfma_f32_16x16x32_bf16 v[74:77], v[182:185], v[158:161], v[74:77]
    ds_read_b64_tr_b16 v[180:181], v33 offset:45568
    v_mfma_f32_16x16x32_bf16 v[74:77], v[186:189], v[170:173], v[74:77]
    ds_read_b64_tr_b16 v[182:183], v34 offset:0
    s_waitcnt lgkmcnt(8)
    v_mfma_f32_16x16x32_bf16 v[78:81], v[190:193], v[150:153], v[78:81]
    ds_read_b64_tr_b16 v[184:185], v34 offset:512
    s_waitcnt lgkmcnt(6)
    v_mfma_f32_16x16x32_bf16 v[78:81], v[194:197], v[162:165], v[78:81]
    ds_read_b64_tr_b16 v[186:187], v34 offset:4096
    v_mfma_f32_16x16x32_bf16 v[86:89], v[190:193], v[154:157], v[86:89]
    ds_read_b64_tr_b16 v[188:189], v34 offset:4608
    v_mfma_f32_16x16x32_bf16 v[86:89], v[194:197], v[166:169], v[86:89]
    v_mfma_f32_16x16x32_bf16 v[94:97], v[190:193], v[158:161], v[94:97]
    ds_read_b64_tr_b16 v[190:191], v35 offset:0
    v_mfma_f32_16x16x32_bf16 v[94:97], v[194:197], v[170:173], v[94:97]
    ds_read_b64_tr_b16 v[192:193], v35 offset:512
    s_waitcnt lgkmcnt(8)
    v_mfma_f32_16x16x32_bf16 v[82:85], v[174:177], v[150:153], v[82:85]
    ds_read_b64_tr_b16 v[194:195], v35 offset:4096
    s_waitcnt lgkmcnt(7)
    v_mfma_f32_16x16x32_bf16 v[82:85], v[178:181], v[162:165], v[82:85]
    ds_read_b64_tr_b16 v[196:197], v35 offset:4608
    v_mfma_f32_16x16x32_bf16 v[90:93], v[174:177], v[154:157], v[90:93]
    v_mfma_f32_16x16x32_bf16 v[90:93], v[178:181], v[166:169], v[90:93]
    v_mfma_f32_16x16x32_bf16 v[98:101], v[174:177], v[158:161], v[98:101]
    v_mfma_f32_16x16x32_bf16 v[98:101], v[178:181], v[170:173], v[98:101]
    s_waitcnt lgkmcnt(6)
    v_mfma_f32_16x16x32_bf16 v[102:105], v[150:153], v[182:185], v[102:105]
    s_waitcnt lgkmcnt(4)
    v_mfma_f32_16x16x32_bf16 v[102:105], v[162:165], v[186:189], v[102:105]
    v_mfma_f32_16x16x32_bf16 v[110:113], v[154:157], v[182:185], v[110:113]
    v_mfma_f32_16x16x32_bf16 v[110:113], v[166:169], v[186:189], v[110:113]
    s_waitcnt lgkmcnt(2)
    v_mfma_f32_16x16x32_bf16 v[106:109], v[150:153], v[190:193], v[106:109]
    s_waitcnt lgkmcnt(0)
    s_barrier
    ds_read_b128 v[130:133], v28 offset:22528
    ds_read_b64_tr_b16 v[174:175], v34 offset:8192
    ds_read_b64_tr_b16 v[176:177], v34 offset:8704
    ds_read_b128 v[142:145], v29 offset:22528
    ds_read_b64_tr_b16 v[178:179], v34 offset:12288
    ds_read_b64_tr_b16 v[180:181], v34 offset:12800
    ds_read_b128 v[134:137], v28 offset:24576
    ds_read_b128 v[146:149], v29 offset:24576
    ds_read_b64_tr_b16 v[182:183], v35 offset:8192
    ds_read_b64_tr_b16 v[184:185], v35 offset:8704
    ds_read_b64_tr_b16 v[186:187], v35 offset:12288
    ds_read_b64_tr_b16 v[188:189], v35 offset:12800
    ds_read_b128 v[126:129], v28 offset:20480
    v_mfma_f32_16x16x32_bf16 v[106:109], v[162:165], v[194:197], v[106:109]
    v_mfma_f32_16x16x32_bf16 v[114:117], v[154:157], v[190:193], v[114:117]
    ds_read_b64_tr_b16 v[190:191], v34 offset:16384
    v_mfma_f32_16x16x32_bf16 v[114:117], v[166:169], v[194:197], v[114:117]
    ds_read_b64_tr_b16 v[192:193], v34 offset:16896
    s_waitcnt lgkmcnt(12)
    v_mfma_f32_16x16x32_bf16 v[62:65], v[174:177], v[130:133], v[62:65]
    ds_read_b128 v[138:141], v29 offset:20480
    s_waitcnt lgkmcnt(10)
    v_mfma_f32_16x16x32_bf16 v[62:65], v[178:181], v[142:145], v[62:65]
    ds_read_b64_tr_b16 v[194:195], v34 offset:20480
    s_waitcnt lgkmcnt(10)
    v_mfma_f32_16x16x32_bf16 v[70:73], v[174:177], v[134:137], v[70:73]
    ds_read_b64_tr_b16 v[196:197], v34 offset:20992
    s_waitcnt lgkmcnt(10)
    v_mfma_f32_16x16x32_bf16 v[70:73], v[178:181], v[146:149], v[70:73]
    ds_read_b64_tr_b16 v[174:175], v35 offset:16384
    s_waitcnt lgkmcnt(9)
    v_mfma_f32_16x16x32_bf16 v[66:69], v[182:185], v[130:133], v[66:69]
    ds_read_b64_tr_b16 v[176:177], v35 offset:16896
    s_waitcnt lgkmcnt(8)
    v_mfma_f32_16x16x32_bf16 v[66:69], v[186:189], v[142:145], v[66:69]
    ds_read_b64_tr_b16 v[178:179], v35 offset:20480
    v_mfma_f32_16x16x32_bf16 v[74:77], v[182:185], v[134:137], v[74:77]
    ds_read_b64_tr_b16 v[180:181], v35 offset:20992
    v_mfma_f32_16x16x32_bf16 v[74:77], v[186:189], v[146:149], v[74:77]
    ds_read_b64_tr_b16 v[182:183], v34 offset:24576
    s_waitcnt lgkmcnt(8)
    v_mfma_f32_16x16x32_bf16 v[78:81], v[190:193], v[126:129], v[78:81]
    ds_read_b64_tr_b16 v[184:185], v34 offset:25088
    s_waitcnt lgkmcnt(6)
    v_mfma_f32_16x16x32_bf16 v[78:81], v[194:197], v[138:141], v[78:81]
    ds_read_b64_tr_b16 v[186:187], v34 offset:28672
    v_mfma_f32_16x16x32_bf16 v[86:89], v[190:193], v[130:133], v[86:89]
    ds_read_b64_tr_b16 v[188:189], v34 offset:29184
    v_mfma_f32_16x16x32_bf16 v[86:89], v[194:197], v[142:145], v[86:89]
    v_mfma_f32_16x16x32_bf16 v[94:97], v[190:193], v[134:137], v[94:97]
    ds_read_b64_tr_b16 v[190:191], v35 offset:24576
    v_mfma_f32_16x16x32_bf16 v[94:97], v[194:197], v[146:149], v[94:97]
    ds_read_b64_tr_b16 v[192:193], v35 offset:25088
    s_waitcnt lgkmcnt(8)
    v_mfma_f32_16x16x32_bf16 v[82:85], v[174:177], v[126:129], v[82:85]
    ds_read_b64_tr_b16 v[194:195], v35 offset:28672
    s_waitcnt lgkmcnt(7)
    v_mfma_f32_16x16x32_bf16 v[82:85], v[178:181], v[138:141], v[82:85]
    ds_read_b64_tr_b16 v[196:197], v35 offset:29184
    v_mfma_f32_16x16x32_bf16 v[90:93], v[174:177], v[130:133], v[90:93]
    v_mfma_f32_16x16x32_bf16 v[90:93], v[178:181], v[142:145], v[90:93]
    v_mfma_f32_16x16x32_bf16 v[98:101], v[174:177], v[134:137], v[98:101]
    v_mfma_f32_16x16x32_bf16 v[98:101], v[178:181], v[146:149], v[98:101]
    s_waitcnt lgkmcnt(6)
    v_mfma_f32_16x16x32_bf16 v[102:105], v[126:129], v[182:185], v[102:105]
    s_waitcnt lgkmcnt(4)
    v_mfma_f32_16x16x32_bf16 v[102:105], v[138:141], v[186:189], v[102:105]
    v_mfma_f32_16x16x32_bf16 v[110:113], v[130:133], v[182:185], v[110:113]
    v_mfma_f32_16x16x32_bf16 v[110:113], v[142:145], v[186:189], v[110:113]
    s_waitcnt lgkmcnt(2)
    v_mfma_f32_16x16x32_bf16 v[106:109], v[126:129], v[190:193], v[106:109]
    s_waitcnt lgkmcnt(0)
    s_barrier
    ds_read_b128 v[154:157], v28 offset:32768
    ds_read_b64_tr_b16 v[174:175], v34 offset:32768
    ds_read_b64_tr_b16 v[176:177], v34 offset:33280
    ds_read_b128 v[166:169], v29 offset:32768
    ds_read_b64_tr_b16 v[178:179], v34 offset:36864
    ds_read_b64_tr_b16 v[180:181], v34 offset:37376
    ds_read_b128 v[158:161], v28 offset:34816
    ds_read_b128 v[170:173], v29 offset:34816
    ds_read_b64_tr_b16 v[182:183], v35 offset:32768
    ds_read_b64_tr_b16 v[184:185], v35 offset:33280
    ds_read_b64_tr_b16 v[186:187], v35 offset:36864
    ds_read_b64_tr_b16 v[188:189], v35 offset:37376
    ds_read_b128 v[150:153], v28 offset:30720
    v_mfma_f32_16x16x32_bf16 v[106:109], v[138:141], v[194:197], v[106:109]
    v_mfma_f32_16x16x32_bf16 v[114:117], v[130:133], v[190:193], v[114:117]
    ds_read_b64_tr_b16 v[190:191], v32 offset:0
    v_mfma_f32_16x16x32_bf16 v[114:117], v[142:145], v[194:197], v[114:117]
    ds_read_b64_tr_b16 v[192:193], v32 offset:512
    s_waitcnt lgkmcnt(12)
    v_mfma_f32_16x16x32_bf16 v[62:65], v[174:177], v[154:157], v[62:65]
    ds_read_b128 v[162:165], v29 offset:30720
    s_waitcnt lgkmcnt(10)
    v_mfma_f32_16x16x32_bf16 v[62:65], v[178:181], v[166:169], v[62:65]
    ds_read_b64_tr_b16 v[194:195], v32 offset:4096
    s_waitcnt lgkmcnt(10)
    v_mfma_f32_16x16x32_bf16 v[70:73], v[174:177], v[158:161], v[70:73]
    ds_read_b64_tr_b16 v[196:197], v32 offset:4608
    s_waitcnt lgkmcnt(10)
    v_mfma_f32_16x16x32_bf16 v[70:73], v[178:181], v[170:173], v[70:73]
    ds_read_b64_tr_b16 v[174:175], v33 offset:0
    s_waitcnt lgkmcnt(9)
    v_mfma_f32_16x16x32_bf16 v[66:69], v[182:185], v[154:157], v[66:69]
    ds_read_b64_tr_b16 v[176:177], v33 offset:512
    s_waitcnt lgkmcnt(8)
    v_mfma_f32_16x16x32_bf16 v[66:69], v[186:189], v[166:169], v[66:69]
    ds_read_b64_tr_b16 v[178:179], v33 offset:4096
    v_mfma_f32_16x16x32_bf16 v[74:77], v[182:185], v[158:161], v[74:77]
    ds_read_b64_tr_b16 v[180:181], v33 offset:4608
    v_mfma_f32_16x16x32_bf16 v[74:77], v[186:189], v[170:173], v[74:77]
    ds_read_b64_tr_b16 v[182:183], v32 offset:8192
    s_waitcnt lgkmcnt(8)
    v_mfma_f32_16x16x32_bf16 v[78:81], v[190:193], v[150:153], v[78:81]
    ds_read_b64_tr_b16 v[184:185], v32 offset:8704
    s_waitcnt lgkmcnt(6)
    v_mfma_f32_16x16x32_bf16 v[78:81], v[194:197], v[162:165], v[78:81]
    ds_read_b64_tr_b16 v[186:187], v32 offset:12288
    v_mfma_f32_16x16x32_bf16 v[86:89], v[190:193], v[154:157], v[86:89]
    ds_read_b64_tr_b16 v[188:189], v32 offset:12800
    v_mfma_f32_16x16x32_bf16 v[86:89], v[194:197], v[166:169], v[86:89]
    v_mfma_f32_16x16x32_bf16 v[94:97], v[190:193], v[158:161], v[94:97]
    ds_read_b64_tr_b16 v[190:191], v33 offset:8192
    v_mfma_f32_16x16x32_bf16 v[94:97], v[194:197], v[170:173], v[94:97]
    ds_read_b64_tr_b16 v[192:193], v33 offset:8704
    s_waitcnt lgkmcnt(8)
    v_mfma_f32_16x16x32_bf16 v[82:85], v[174:177], v[150:153], v[82:85]
    ds_read_b64_tr_b16 v[194:195], v33 offset:12288
    s_waitcnt lgkmcnt(7)
    v_mfma_f32_16x16x32_bf16 v[82:85], v[178:181], v[162:165], v[82:85]
    ds_read_b64_tr_b16 v[196:197], v33 offset:12800
    v_mfma_f32_16x16x32_bf16 v[90:93], v[174:177], v[154:157], v[90:93]
    v_mfma_f32_16x16x32_bf16 v[90:93], v[178:181], v[166:169], v[90:93]
    v_mfma_f32_16x16x32_bf16 v[98:101], v[174:177], v[158:161], v[98:101]
    v_mfma_f32_16x16x32_bf16 v[98:101], v[178:181], v[170:173], v[98:101]
    s_waitcnt lgkmcnt(6)
    v_mfma_f32_16x16x32_bf16 v[102:105], v[150:153], v[182:185], v[102:105]
    s_waitcnt lgkmcnt(4)
    v_mfma_f32_16x16x32_bf16 v[102:105], v[162:165], v[186:189], v[102:105]
    v_mfma_f32_16x16x32_bf16 v[110:113], v[154:157], v[182:185], v[110:113]
    v_mfma_f32_16x16x32_bf16 v[110:113], v[166:169], v[186:189], v[110:113]
    s_waitcnt lgkmcnt(2)
    v_mfma_f32_16x16x32_bf16 v[106:109], v[150:153], v[190:193], v[106:109]
    s_waitcnt lgkmcnt(0)
    s_barrier
    ds_read_b128 v[130:133], v30 offset:2048
    ds_read_b64_tr_b16 v[174:175], v32 offset:16384
    ds_read_b64_tr_b16 v[176:177], v32 offset:16896
    ds_read_b128 v[142:145], v31 offset:2048
    ds_read_b64_tr_b16 v[178:179], v32 offset:20480
    ds_read_b64_tr_b16 v[180:181], v32 offset:20992
    ds_read_b128 v[134:137], v30 offset:4096
    ds_read_b128 v[146:149], v31 offset:4096
    ds_read_b64_tr_b16 v[182:183], v33 offset:16384
    ds_read_b64_tr_b16 v[184:185], v33 offset:16896
    ds_read_b64_tr_b16 v[186:187], v33 offset:20480
    ds_read_b64_tr_b16 v[188:189], v33 offset:20992
    ds_read_b128 v[126:129], v30 offset:0
    v_mfma_f32_16x16x32_bf16 v[106:109], v[162:165], v[194:197], v[106:109]
    v_mfma_f32_16x16x32_bf16 v[114:117], v[154:157], v[190:193], v[114:117]
    ds_read_b64_tr_b16 v[190:191], v32 offset:24576
    v_mfma_f32_16x16x32_bf16 v[114:117], v[166:169], v[194:197], v[114:117]
    ds_read_b64_tr_b16 v[192:193], v32 offset:25088
    s_waitcnt lgkmcnt(12)
    v_mfma_f32_16x16x32_bf16 v[62:65], v[174:177], v[130:133], v[62:65]
    ds_read_b128 v[138:141], v31 offset:0
    s_waitcnt lgkmcnt(10)
    v_mfma_f32_16x16x32_bf16 v[62:65], v[178:181], v[142:145], v[62:65]
    ds_read_b64_tr_b16 v[194:195], v32 offset:28672
    s_waitcnt lgkmcnt(10)
    v_mfma_f32_16x16x32_bf16 v[70:73], v[174:177], v[134:137], v[70:73]
    ds_read_b64_tr_b16 v[196:197], v32 offset:29184
    s_waitcnt lgkmcnt(10)
    v_mfma_f32_16x16x32_bf16 v[70:73], v[178:181], v[146:149], v[70:73]
    ds_read_b64_tr_b16 v[174:175], v33 offset:24576
    s_waitcnt lgkmcnt(9)
    v_mfma_f32_16x16x32_bf16 v[66:69], v[182:185], v[130:133], v[66:69]
    ds_read_b64_tr_b16 v[176:177], v33 offset:25088
    s_waitcnt lgkmcnt(8)
    v_mfma_f32_16x16x32_bf16 v[66:69], v[186:189], v[142:145], v[66:69]
    ds_read_b64_tr_b16 v[178:179], v33 offset:28672
    v_mfma_f32_16x16x32_bf16 v[74:77], v[182:185], v[134:137], v[74:77]
    ds_read_b64_tr_b16 v[180:181], v33 offset:29184
    v_mfma_f32_16x16x32_bf16 v[74:77], v[186:189], v[146:149], v[74:77]
    ds_read_b64_tr_b16 v[182:183], v32 offset:32768
    s_waitcnt lgkmcnt(8)
    v_mfma_f32_16x16x32_bf16 v[78:81], v[190:193], v[126:129], v[78:81]
    ds_read_b64_tr_b16 v[184:185], v32 offset:33280
    s_waitcnt lgkmcnt(6)
    v_mfma_f32_16x16x32_bf16 v[78:81], v[194:197], v[138:141], v[78:81]
    ds_read_b64_tr_b16 v[186:187], v32 offset:36864
    v_mfma_f32_16x16x32_bf16 v[86:89], v[190:193], v[130:133], v[86:89]
    ds_read_b64_tr_b16 v[188:189], v32 offset:37376
    v_mfma_f32_16x16x32_bf16 v[86:89], v[194:197], v[142:145], v[86:89]
    v_mfma_f32_16x16x32_bf16 v[94:97], v[190:193], v[134:137], v[94:97]
    ds_read_b64_tr_b16 v[190:191], v33 offset:32768
    v_mfma_f32_16x16x32_bf16 v[94:97], v[194:197], v[146:149], v[94:97]
    ds_read_b64_tr_b16 v[192:193], v33 offset:33280
    s_waitcnt lgkmcnt(8)
    v_mfma_f32_16x16x32_bf16 v[82:85], v[174:177], v[126:129], v[82:85]
    ds_read_b64_tr_b16 v[194:195], v33 offset:36864
    s_waitcnt lgkmcnt(7)
    v_mfma_f32_16x16x32_bf16 v[82:85], v[178:181], v[138:141], v[82:85]
    ds_read_b64_tr_b16 v[196:197], v33 offset:37376
    v_mfma_f32_16x16x32_bf16 v[90:93], v[174:177], v[130:133], v[90:93]
    v_mfma_f32_16x16x32_bf16 v[90:93], v[178:181], v[142:145], v[90:93]
    v_mfma_f32_16x16x32_bf16 v[98:101], v[174:177], v[134:137], v[98:101]
    v_mfma_f32_16x16x32_bf16 v[98:101], v[178:181], v[146:149], v[98:101]
    s_waitcnt lgkmcnt(6)
    v_mfma_f32_16x16x32_bf16 v[102:105], v[126:129], v[182:185], v[102:105]
    s_waitcnt lgkmcnt(4)
    v_mfma_f32_16x16x32_bf16 v[102:105], v[138:141], v[186:189], v[102:105]
    v_mfma_f32_16x16x32_bf16 v[110:113], v[130:133], v[182:185], v[110:113]
    v_mfma_f32_16x16x32_bf16 v[110:113], v[142:145], v[186:189], v[110:113]
    s_waitcnt lgkmcnt(2)
    v_mfma_f32_16x16x32_bf16 v[106:109], v[126:129], v[190:193], v[106:109]
    s_waitcnt lgkmcnt(0)
    s_barrier
    ds_read_b128 v[154:157], v30 offset:12288
    ds_read_b64_tr_b16 v[174:175], v32 offset:40960
    ds_read_b64_tr_b16 v[176:177], v32 offset:41472
    ds_read_b128 v[166:169], v31 offset:12288
    ds_read_b64_tr_b16 v[178:179], v32 offset:45056
    ds_read_b64_tr_b16 v[180:181], v32 offset:45568
    ds_read_b128 v[158:161], v30 offset:14336
    ds_read_b128 v[170:173], v31 offset:14336
    ds_read_b64_tr_b16 v[182:183], v33 offset:40960
    ds_read_b64_tr_b16 v[184:185], v33 offset:41472
    ds_read_b64_tr_b16 v[186:187], v33 offset:45056
    ds_read_b64_tr_b16 v[188:189], v33 offset:45568
    ds_read_b128 v[150:153], v30 offset:10240
    v_mfma_f32_16x16x32_bf16 v[106:109], v[138:141], v[194:197], v[106:109]
    ds_read_b64_tr_b16 v[198:199], v34 offset:0
    v_mfma_f32_16x16x32_bf16 v[114:117], v[130:133], v[190:193], v[114:117]
    ds_read_b64_tr_b16 v[200:201], v34 offset:512
    v_mfma_f32_16x16x32_bf16 v[114:117], v[142:145], v[194:197], v[114:117]
    ds_read_b128 v[162:165], v31 offset:10240
    s_waitcnt lgkmcnt(13)
    v_mfma_f32_16x16x32_bf16 v[62:65], v[174:177], v[154:157], v[62:65]
    ds_read_b64_tr_b16 v[202:203], v34 offset:4096
    s_waitcnt lgkmcnt(11)
    v_mfma_f32_16x16x32_bf16 v[62:65], v[178:181], v[166:169], v[62:65]
    ds_read_b64_tr_b16 v[204:205], v34 offset:4608
    s_waitcnt lgkmcnt(11)
    v_mfma_f32_16x16x32_bf16 v[70:73], v[174:177], v[158:161], v[70:73]
    ds_read_b64_tr_b16 v[190:191], v35 offset:0
    s_waitcnt lgkmcnt(11)
    v_mfma_f32_16x16x32_bf16 v[70:73], v[178:181], v[170:173], v[70:73]
    ds_read_b64_tr_b16 v[192:193], v35 offset:512
    s_waitcnt lgkmcnt(10)
    v_mfma_f32_16x16x32_bf16 v[66:69], v[182:185], v[154:157], v[66:69]
    ds_read_b64_tr_b16 v[194:195], v35 offset:4096
    s_waitcnt lgkmcnt(9)
    v_mfma_f32_16x16x32_bf16 v[66:69], v[186:189], v[166:169], v[66:69]
    ds_read_b64_tr_b16 v[196:197], v35 offset:4608
    v_mfma_f32_16x16x32_bf16 v[74:77], v[182:185], v[158:161], v[74:77]
    v_mfma_f32_16x16x32_bf16 v[74:77], v[186:189], v[170:173], v[74:77]
    s_waitcnt lgkmcnt(7)
    v_mfma_f32_16x16x32_bf16 v[78:81], v[198:201], v[150:153], v[78:81]
    s_waitcnt lgkmcnt(4)
    v_mfma_f32_16x16x32_bf16 v[78:81], v[202:205], v[162:165], v[78:81]
    v_mfma_f32_16x16x32_bf16 v[86:89], v[198:201], v[154:157], v[86:89]
    v_mfma_f32_16x16x32_bf16 v[86:89], v[202:205], v[166:169], v[86:89]
    v_mfma_f32_16x16x32_bf16 v[94:97], v[198:201], v[158:161], v[94:97]
    v_mfma_f32_16x16x32_bf16 v[94:97], v[202:205], v[170:173], v[94:97]
    s_waitcnt lgkmcnt(2)
    v_mfma_f32_16x16x32_bf16 v[82:85], v[190:193], v[150:153], v[82:85]
    s_waitcnt lgkmcnt(0)
    v_mfma_f32_16x16x32_bf16 v[82:85], v[194:197], v[162:165], v[82:85]
    v_mfma_f32_16x16x32_bf16 v[90:93], v[190:193], v[154:157], v[90:93]
    v_mfma_f32_16x16x32_bf16 v[90:93], v[194:197], v[166:169], v[90:93]
    v_mfma_f32_16x16x32_bf16 v[98:101], v[190:193], v[158:161], v[98:101]
    s_barrier
    ds_read_b128 v[134:137], v30 offset:24576
    ds_read_b64_tr_b16 v[174:175], v34 offset:16384
    ds_read_b64_tr_b16 v[176:177], v34 offset:16896
    ds_read_b128 v[146:149], v31 offset:24576
    ds_read_b64_tr_b16 v[178:179], v34 offset:20480
    ds_read_b64_tr_b16 v[180:181], v34 offset:20992
    ds_read_b64_tr_b16 v[182:183], v35 offset:16384
    ds_read_b64_tr_b16 v[184:185], v35 offset:16896
    ds_read_b64_tr_b16 v[186:187], v35 offset:20480
    ds_read_b64_tr_b16 v[188:189], v35 offset:20992
    ds_read_b128 v[130:133], v30 offset:22528
    ds_read_b64_tr_b16 v[198:199], v34 offset:8192
    ds_read_b64_tr_b16 v[200:201], v34 offset:8704
    ds_read_b128 v[142:145], v31 offset:22528
    ds_read_b64_tr_b16 v[202:203], v34 offset:12288
    ds_read_b64_tr_b16 v[204:205], v34 offset:12800
    ds_read_b64_tr_b16 v[190:191], v35 offset:8192
    v_mfma_f32_16x16x32_bf16 v[98:101], v[194:197], v[170:173], v[98:101]
    ds_read_b64_tr_b16 v[192:193], v35 offset:8704
    s_waitcnt lgkmcnt(15)
    v_mfma_f32_16x16x32_bf16 v[94:97], v[174:177], v[134:137], v[94:97]
    ds_read_b64_tr_b16 v[194:195], v35 offset:12288
    s_waitcnt lgkmcnt(13)
    v_mfma_f32_16x16x32_bf16 v[94:97], v[178:181], v[146:149], v[94:97]
    ds_read_b64_tr_b16 v[196:197], v35 offset:12800
    s_waitcnt lgkmcnt(12)
    v_mfma_f32_16x16x32_bf16 v[98:101], v[182:185], v[134:137], v[98:101]
    ds_read_b128 v[126:129], v30 offset:20480
    s_waitcnt lgkmcnt(11)
    v_mfma_f32_16x16x32_bf16 v[98:101], v[186:189], v[146:149], v[98:101]
    ds_read_b128 v[138:141], v31 offset:20480
    s_waitcnt lgkmcnt(9)
    v_mfma_f32_16x16x32_bf16 v[62:65], v[198:201], v[130:133], v[62:65]
    s_waitcnt lgkmcnt(6)
    v_mfma_f32_16x16x32_bf16 v[62:65], v[202:205], v[142:145], v[62:65]
    v_mfma_f32_16x16x32_bf16 v[70:73], v[198:201], v[134:137], v[70:73]
    v_cvt_pk_bf16_f32 v234, v94, v95
    v_cvt_pk_bf16_f32 v235, v96, v97
    v_cvt_pk_bf16_f32 v236, v98, v99
    v_mfma_f32_16x16x32_bf16 v[70:73], v[202:205], v[146:149], v[70:73]
    v_cvt_pk_bf16_f32 v237, v100, v101
    ds_write_b128 v218, v[234:237]
    ds_write_b32 v220, v5 offset:56
    s_waitcnt lgkmcnt(6)
    v_mfma_f32_16x16x32_bf16 v[66:69], v[190:193], v[130:133], v[66:69]
    v_cvt_pk_bf16_f32 v150, v62, v63
    v_cvt_pk_bf16_f32 v151, v64, v65
    s_waitcnt lgkmcnt(4)
    v_mfma_f32_16x16x32_bf16 v[66:69], v[194:197], v[142:145], v[66:69]
    v_cndmask_b32 v158, 0, v150, s[54:55]
    v_cndmask_b32 v150, v150, 0, s[54:55]
    v_mfma_f32_16x16x32_bf16 v[74:77], v[190:193], v[134:137], v[74:77]
    v_cndmask_b32 v159, 0, v151, s[54:55]
    v_cndmask_b32 v151, v151, 0, s[54:55]
    v_mfma_f32_16x16x32_bf16 v[74:77], v[194:197], v[146:149], v[74:77]
    v_cvt_pk_bf16_f32 v154, v70, v71
    v_cvt_pk_bf16_f32 v155, v72, v73
    s_waitcnt lgkmcnt(3)
    v_mfma_f32_16x16x32_bf16 v[78:81], v[174:177], v[126:129], v[78:81]
    v_cndmask_b32 v162, 0, v154, s[54:55]
    v_cndmask_b32 v154, v154, 0, s[54:55]
    s_waitcnt lgkmcnt(2)
    v_mfma_f32_16x16x32_bf16 v[78:81], v[178:181], v[138:141], v[78:81]
    v_cndmask_b32 v163, 0, v155, s[54:55]
    v_cndmask_b32 v155, v155, 0, s[54:55]
    v_mfma_f32_16x16x32_bf16 v[82:85], v[182:185], v[126:129], v[82:85]
    v_cvt_pk_bf16_f32 v152, v66, v67
    v_cvt_pk_bf16_f32 v153, v68, v69
    v_mfma_f32_16x16x32_bf16 v[82:85], v[186:189], v[138:141], v[82:85]
    v_cndmask_b32 v160, 0, v152, s[56:57]
    v_cndmask_b32 v152, v152, 0, s[56:57]
    v_mfma_f32_16x16x32_bf16 v[86:89], v[174:177], v[130:133], v[86:89]
    v_cndmask_b32 v161, 0, v153, s[56:57]
    v_cndmask_b32 v153, v153, 0, s[56:57]
    v_mfma_f32_16x16x32_bf16 v[86:89], v[178:181], v[142:145], v[86:89]
    v_cvt_pk_bf16_f32 v156, v74, v75
    v_cvt_pk_bf16_f32 v157, v76, v77
    v_mfma_f32_16x16x32_bf16 v[90:93], v[182:185], v[130:133], v[90:93]
    v_cndmask_b32 v164, 0, v156, s[56:57]
    v_cndmask_b32 v156, v156, 0, s[56:57]
    v_mfma_f32_16x16x32_bf16 v[90:93], v[186:189], v[142:145], v[90:93]
    ds_read_b32 v40, v5 offset:4
    v_cndmask_b32 v165, 0, v157, s[56:57]
    v_cndmask_b32 v157, v157, 0, s[56:57]
    v_cvt_pk_bf16_f32 v226, v78, v79
    v_cvt_pk_bf16_f32 v227, v80, v81
    v_cvt_pk_bf16_f32 v228, v82, v83
    v_cvt_pk_bf16_f32 v229, v84, v85
    s_nop 1
    v_mfma_f32_16x16x32_bf16 v[62:65], v[226:229], v[150:153], 0
    v_mfma_f32_16x16x32_bf16 v[74:77], v[234:237], v[154:157], 0
    v_cvt_pk_bf16_f32 v230, v86, v87
    v_cvt_pk_bf16_f32 v231, v88, v89
    v_cvt_pk_bf16_f32 v232, v90, v91
    v_cvt_pk_bf16_f32 v233, v92, v93
    s_nop 1
    v_mfma_f32_16x16x32_bf16 v[66:69], v[230:233], v[150:153], 0
    v_mfma_f32_16x16x32_bf16 v[70:73], v[230:233], v[154:157], 0
    v_mfma_f32_16x16x32_bf16 v[174:177], v[226:229], v[158:161], 0
    v_mfma_f32_16x16x32_bf16 v[178:181], v[230:233], v[158:161], 0
    v_mfma_f32_16x16x32_bf16 v[182:185], v[230:233], v[162:165], 0
    v_mfma_f32_16x16x32_bf16 v[186:189], v[234:237], v[162:165], 0
    s_waitcnt lgkmcnt(0)
    v_readfirstlane_b32 s63, v40
    s_nop 0
    v_cndmask_b32 v66, v66, v67, s[44:45]
    ds_read_b32 v40, v5 offset:32
    v_cndmask_b32 v68, v68, v69, s[44:45]
    ds_read_b64_tr_b16 v[166:167], v34 offset:32768
    v_cndmask_b32 v62, v62, v63, s[44:45]
    ds_read_b64_tr_b16 v[168:169], v34 offset:33280
    v_cndmask_b32 v64, v64, v65, s[44:45]
    ds_read_b64_tr_b16 v[170:171], v35 offset:32768
    v_cndmask_b32 v62, v62, v45, s[50:51]
    ds_read_b64_tr_b16 v[172:173], v35 offset:33280
    v_cndmask_b32 v64, v64, v45, s[50:51]
    ds_read_b64_tr_b16 v[198:199], v34 offset:36864
    v_cndmask_b32 v210, v62, v66, s[46:47]
    ds_read_b64_tr_b16 v[200:201], v34 offset:37376
    v_cndmask_b32 v211, v64, v68, s[48:49]
    ds_read_b64_tr_b16 v[202:203], v35 offset:36864
    v_cndmask_b32 v74, v74, v75, s[44:45]
    ds_read_b64_tr_b16 v[204:205], v35 offset:37376
    v_cndmask_b32 v76, v76, v77, s[44:45]
    v_cndmask_b32 v70, v70, v71, s[44:45]
    v_cndmask_b32 v72, v72, v73, s[44:45]
    v_cndmask_b32 v212, v70, v74, s[46:47]
    v_cndmask_b32 v213, v72, v76, s[48:49]
    v_and_or_b32 v94, v210, v46, v50
    v_and_or_b32 v95, v211, v46, v51
    v_and_or_b32 v96, v212, v46, v52
    v_and_or_b32 v97, v213, v46, v53
    s_sub_u32 s63, s63, 1
    s_cbranch_scc1 C_mr0
C_md0:
    s_cmp_lg_u32 s101, 0
    s_cbranch_scc1 SM_jS0
    s_cmp_eq_u32 s63, 0
    s_cbranch_scc1 SM_sS0
    buffer_store_dwordx4 v[94:97], v4, s[36:39], s15 offen
SM_jS0:
    v_cndmask_b32 v178, v178, v179, s[44:45]
    v_cndmask_b32 v180, v180, v181, s[44:45]
    v_cndmask_b32 v174, v174, v175, s[44:45]
    v_cndmask_b32 v176, v176, v177, s[44:45]
    v_cndmask_b32 v174, v174, v45, s[50:51]
    v_cndmask_b32 v176, v176, v45, s[50:51]
    v_cndmask_b32 v206, v174, v178, s[46:47]
    v_cndmask_b32 v207, v176, v180, s[48:49]
    v_cndmask_b32 v186, v186, v187, s[44:45]
    v_cndmask_b32 v188, v188, v189, s[44:45]
    v_cndmask_b32 v182, v182, v183, s[44:45]
    v_cndmask_b32 v184, v184, v185, s[44:45]
    v_cndmask_b32 v208, v182, v186, s[46:47]
    v_cndmask_b32 v209, v184, v188, s[48:49]
    ds_write_b128 v42, v[206:209]
    ds_write_b32 v47, v5 offset:16
    s_waitcnt lgkmcnt(10)
    v_cmp_gt_u32 vcc, 4, v40
    s_nop 0
    s_cbranch_vccnz C_vr0
C_vd0:
    s_waitcnt lgkmcnt(8)
    v_mfma_f32_16x16x32_bf16 v[102:105], v[126:129], v[166:169], v[102:105]
    ds_read_b128 v[150:153], v30 offset:10240
    ds_read_b64_tr_b16 v[182:183], v34 offset:24576
    s_waitcnt lgkmcnt(6)
    v_mfma_f32_16x16x32_bf16 v[102:105], v[138:141], v[198:201], v[102:105]
    ds_read_b64_tr_b16 v[184:185], v34 offset:25088
    ds_read_b128 v[162:165], v31 offset:10240
    v_mfma_f32_16x16x32_bf16 v[110:113], v[130:133], v[166:169], v[110:113]
    ds_read_b64_tr_b16 v[190:191], v34 offset:28672
    ds_read_b64_tr_b16 v[192:193], v34 offset:29184
    v_mfma_f32_16x16x32_bf16 v[110:113], v[142:145], v[198:201], v[110:113]
    ds_read_b64_tr_b16 v[186:187], v35 offset:24576
    ds_read_b64_tr_b16 v[188:189], v35 offset:25088
    v_mfma_f32_16x16x32_bf16 v[106:109], v[126:129], v[170:173], v[106:109]
    ds_read_b64_tr_b16 v[194:195], v35 offset:28672
    ds_read_b64_tr_b16 v[196:197], v35 offset:29184
    s_waitcnt lgkmcnt(12)
    v_mfma_f32_16x16x32_bf16 v[106:109], v[138:141], v[202:205], v[106:109]
    ds_read_b128 v[154:157], v30 offset:12288
    ds_read_b128 v[174:177], v31 offset:12288
    v_mfma_f32_16x16x32_bf16 v[114:117], v[130:133], v[170:173], v[114:117]
    v_mfma_f32_16x16x32_bf16 v[114:117], v[142:145], v[202:205], v[114:117]
    s_waitcnt lgkmcnt(9)
    v_mfma_f32_16x16x32_bf16 v[102:105], v[150:153], v[182:185], v[102:105]
    s_waitcnt lgkmcnt(6)
    v_mfma_f32_16x16x32_bf16 v[102:105], v[162:165], v[190:193], v[102:105]
    s_waitcnt lgkmcnt(4)
    v_mfma_f32_16x16x32_bf16 v[106:109], v[150:153], v[186:189], v[106:109]
    s_waitcnt lgkmcnt(2)
    v_mfma_f32_16x16x32_bf16 v[106:109], v[162:165], v[194:197], v[106:109]
    s_waitcnt lgkmcnt(1)
    v_mfma_f32_16x16x32_bf16 v[110:113], v[154:157], v[182:185], v[110:113]
    s_nop 1
    v_cvt_pk_bf16_f32 v226, v102, v103
    v_cvt_pk_bf16_f32 v227, v104, v105
    s_waitcnt lgkmcnt(0)
    v_mfma_f32_16x16x32_bf16 v[110:113], v[174:177], v[190:193], v[110:113]
    v_mfma_f32_16x16x32_bf16 v[114:117], v[154:157], v[186:189], v[114:117]
    v_cvt_pk_bf16_f32 v232, v106, v107
    v_cvt_pk_bf16_f32 v233, v108, v109
    v_mfma_f32_16x16x32_bf16 v[114:117], v[174:177], v[194:197], v[114:117]
    ds_read_b32 v48, v221 offset:68
    ds_read_b64 v[230:231], v219 offset:0
    ds_read_b64 v[236:237], v219 offset:8
    v_cndmask_b32 v126, 0, v226, s[58:59]
    v_cndmask_b32 v226, v226, 0, s[58:59]
    v_cndmask_b32 v127, 0, v227, s[58:59]
    v_cndmask_b32 v227, v227, 0, s[58:59]
    buffer_load_dwordx4 v[214:217], v4, s[36:39], s100 offen sc1
    v_cvt_pk_bf16_f32 v228, v110, v111
    v_cvt_pk_bf16_f32 v229, v112, v113
    v_cvt_pk_bf16_f32 v234, v114, v115
    v_cvt_pk_bf16_f32 v235, v116, v117
    v_cndmask_b32 v132, 0, v232, s[60:61]
    v_cndmask_b32 v232, v232, 0, s[60:61]
    v_cndmask_b32 v133, 0, v233, s[60:61]
    v_cndmask_b32 v233, v233, 0, s[60:61]
    v_cndmask_b32 v128, 0, v228, s[58:59]
    v_cndmask_b32 v228, v228, 0, s[58:59]
    v_cndmask_b32 v129, 0, v229, s[58:59]
    v_cndmask_b32 v229, v229, 0, s[58:59]
    v_cndmask_b32 v134, 0, v234, s[60:61]
    v_cndmask_b32 v234, v234, 0, s[60:61]
    v_cndmask_b32 v135, 0, v235, s[60:61]
    v_cndmask_b32 v235, v235, 0, s[60:61]
    s_waitcnt lgkmcnt(0)
    v_cmp_ne_u32 vcc, 0, v48
    s_nop 0
    s_cbranch_vccnz D_dV0
    s_mov_b32 s9, 0
D_lV0:
    ds_read_b32 v48, v221 offset:68
    ds_read_b64 v[230:231], v219 offset:0
    ds_read_b64 v[236:237], v219 offset:8
    s_add_u32 s9, s9, 1
    s_cmp_gt_u32 s9, 1600000
    s_waitcnt lgkmcnt(0)
    s_cbranch_scc1 D_dV0
    v_cmp_eq_u32 vcc, 0, v48
    s_nop 0
    s_cbranch_vccnz D_lV0
            D_dV0:

    v_cndmask_b32 v130, 0, v230, s[58:59]
    v_cndmask_b32 v230, v230, 0, s[58:59]
    v_cndmask_b32 v131, 0, v231, s[58:59]
    v_cndmask_b32 v231, v231, 0, s[58:59]
    v_cndmask_b32 v136, 0, v236, s[60:61]
    v_cndmask_b32 v236, v236, 0, s[60:61]
    v_cndmask_b32 v137, 0, v237, s[60:61]
    v_cndmask_b32 v237, v237, 0, s[60:61]
    s_branch C_join
C_tp1:
    s_barrier
    ds_read_b128 v[130:133], v28 offset:2048
    ds_read_b64_tr_b16 v[174:175], v32 offset:8192
    ds_read_b64_tr_b16 v[176:177], v32 offset:8704
    ds_read_b128 v[142:145], v29 offset:2048
    ds_read_b64_tr_b16 v[178:179], v32 offset:12288
    ds_read_b64_tr_b16 v[180:181], v32 offset:12800
    ds_read_b128 v[134:137], v28 offset:4096
    ds_read_b128 v[146:149], v29 offset:4096
    ds_read_b64_tr_b16 v[182:183], v33 offset:8192
    ds_read_b64_tr_b16 v[184:185], v33 offset:8704
    ds_read_b64_tr_b16 v[186:187], v33 offset:12288
    ds_read_b64_tr_b16 v[188:189], v33 offset:12800
    s_waitcnt lgkmcnt(9)
    v_mfma_f32_16x16x32_bf16 v[62:65], v[174:177], v[130:133], 0
    ds_read_b64_tr_b16 v[190:191], v32 offset:16384
    s_waitcnt lgkmcnt(7)
    v_mfma_f32_16x16x32_bf16 v[62:65], v[178:181], v[142:145], v[62:65]
    ds_read_b64_tr_b16 v[192:193], v32 offset:16896
    s_waitcnt lgkmcnt(7)
    v_mfma_f32_16x16x32_bf16 v[70:73], v[174:177], v[134:137], 0
    ds_read_b64_tr_b16 v[194:195], v32 offset:20480
    ds_read_b64_tr_b16 v[196:197], v32 offset:20992
    s_waitcnt lgkmcnt(8)
    v_mfma_f32_16x16x32_bf16 v[70:73], v[178:181], v[146:149], v[70:73]
    ds_read_b64_tr_b16 v[174:175], v33 offset:16384
    s_waitcnt lgkmcnt(7)
    v_mfma_f32_16x16x32_bf16 v[66:69], v[182:185], v[130:133], 0
    ds_read_b64_tr_b16 v[176:177], v33 offset:16896
    s_waitcnt lgkmcnt(6)
    v_mfma_f32_16x16x32_bf16 v[66:69], v[186:189], v[142:145], v[66:69]
    ds_read_b64_tr_b16 v[178:179], v33 offset:20480
    v_mfma_f32_16x16x32_bf16 v[74:77], v[182:185], v[134:137], 0
    ds_read_b64_tr_b16 v[180:181], v33 offset:20992
    v_mfma_f32_16x16x32_bf16 v[74:77], v[186:189], v[146:149], v[74:77]
    ds_read_b128 v[126:129], v28 offset:0
    s_waitcnt lgkmcnt(7)
    v_mfma_f32_16x16x32_bf16 v[86:89], v[190:193], v[130:133], 0
    ds_read_b64_tr_b16 v[182:183], v32 offset:24576
    s_waitcnt lgkmcnt(6)
    v_mfma_f32_16x16x32_bf16 v[86:89], v[194:197], v[142:145], v[86:89]
    ds_read_b64_tr_b16 v[184:185], v32 offset:25088
    v_mfma_f32_16x16x32_bf16 v[94:97], v[190:193], v[134:137], 0
    ds_read_b128 v[138:141], v29 offset:0
    ds_read_b64_tr_b16 v[186:187], v32 offset:28672
    v_mfma_f32_16x16x32_bf16 v[94:97], v[194:197], v[146:149], v[94:97]
    ds_read_b64_tr_b16 v[188:189], v32 offset:29184
    s_waitcnt lgkmcnt(8)
    v_mfma_f32_16x16x32_bf16 v[90:93], v[174:177], v[130:133], 0
    ds_read_b64_tr_b16 v[190:191], v33 offset:24576
    s_waitcnt lgkmcnt(7)
    v_mfma_f32_16x16x32_bf16 v[90:93], v[178:181], v[142:145], v[90:93]
    ds_read_b64_tr_b16 v[192:193], v33 offset:25088
    v_mfma_f32_16x16x32_bf16 v[98:101], v[174:177], v[134:137], 0
    ds_read_b64_tr_b16 v[194:195], v33 offset:28672
    v_mfma_f32_16x16x32_bf16 v[98:101], v[178:181], v[146:149], v[98:101]
    ds_read_b64_tr_b16 v[196:197], v33 offset:29184
    s_waitcnt lgkmcnt(7)
    v_mfma_f32_16x16x32_bf16 v[102:105], v[126:129], v[182:185], 0
    s_waitcnt lgkmcnt(4)
    v_mfma_f32_16x16x32_bf16 v[102:105], v[138:141], v[186:189], v[102:105]
    v_mfma_f32_16x16x32_bf16 v[110:113], v[130:133], v[182:185], 0
    v_mfma_f32_16x16x32_bf16 v[110:113], v[142:145], v[186:189], v[110:113]
    v_mfma_f32_16x16x32_bf16 v[118:121], v[134:137], v[182:185], 0
    v_mfma_f32_16x16x32_bf16 v[118:121], v[146:149], v[186:189], v[118:121]
    s_waitcnt lgkmcnt(2)
    v_mfma_f32_16x16x32_bf16 v[106:109], v[126:129], v[190:193], 0
    s_waitcnt lgkmcnt(0)
    v_mfma_f32_16x16x32_bf16 v[106:109], v[138:141], v[194:197], v[106:109]
    v_mfma_f32_16x16x32_bf16 v[114:117], v[130:133], v[190:193], 0
    s_barrier
    ds_read_b128 v[154:157], v28 offset:12288
    ds_read_b64_tr_b16 v[174:175], v32 offset:32768
    ds_read_b64_tr_b16 v[176:177], v32 offset:33280
    ds_read_b128 v[166:169], v29 offset:12288
    ds_read_b64_tr_b16 v[178:179], v32 offset:36864
    ds_read_b64_tr_b16 v[180:181], v32 offset:37376
    ds_read_b128 v[158:161], v28 offset:14336
    ds_read_b128 v[170:173], v29 offset:14336
    ds_read_b64_tr_b16 v[182:183], v33 offset:32768
    ds_read_b64_tr_b16 v[184:185], v33 offset:33280
    ds_read_b64_tr_b16 v[186:187], v33 offset:36864
    ds_read_b64_tr_b16 v[188:189], v33 offset:37376
    v_mfma_f32_16x16x32_bf16 v[114:117], v[142:145], v[194:197], v[114:117]
    v_mfma_f32_16x16x32_bf16 v[122:125], v[134:137], v[190:193], 0
    ds_read_b64_tr_b16 v[190:191], v32 offset:40960
    v_mfma_f32_16x16x32_bf16 v[122:125], v[146:149], v[194:197], v[122:125]
    ds_read_b64_tr_b16 v[192:193], v32 offset:41472
    s_waitcnt lgkmcnt(11)
    v_mfma_f32_16x16x32_bf16 v[62:65], v[174:177], v[154:157], v[62:65]
    ds_read_b64_tr_b16 v[194:195], v32 offset:45056
    s_waitcnt lgkmcnt(9)
    v_mfma_f32_16x16x32_bf16 v[62:65], v[178:181], v[166:169], v[62:65]
    ds_read_b64_tr_b16 v[196:197], v32 offset:45568
    s_waitcnt lgkmcnt(9)
    v_mfma_f32_16x16x32_bf16 v[70:73], v[174:177], v[158:161], v[70:73]
    ds_read_b64_tr_b16 v[174:175], v33 offset:40960
    s_waitcnt lgkmcnt(9)
    v_mfma_f32_16x16x32_bf16 v[70:73], v[178:181], v[170:173], v[70:73]
    ds_read_b64_tr_b16 v[176:177], v33 offset:41472
    s_waitcnt lgkmcnt(8)
    v_mfma_f32_16x16x32_bf16 v[66:69], v[182:185], v[154:157], v[66:69]
    ds_read_b64_tr_b16 v[178:179], v33 offset:45056
    s_waitcnt lgkmcnt(7)
    v_mfma_f32_16x16x32_bf16 v[66:69], v[186:189], v[166:169], v[66:69]
    ds_read_b64_tr_b16 v[180:181], v33 offset:45568
    v_mfma_f32_16x16x32_bf16 v[74:77], v[182:185], v[158:161], v[74:77]
    ds_read_b128 v[150:153], v28 offset:10240
    v_mfma_f32_16x16x32_bf16 v[74:77], v[186:189], v[170:173], v[74:77]
    ds_read_b64_tr_b16 v[182:183], v34 offset:0
    s_waitcnt lgkmcnt(8)
    v_mfma_f32_16x16x32_bf16 v[86:89], v[190:193], v[154:157], v[86:89]
    ds_read_b64_tr_b16 v[184:185], v34 offset:512
    s_waitcnt lgkmcnt(7)
    v_mfma_f32_16x16x32_bf16 v[86:89], v[194:197], v[166:169], v[86:89]
    ds_read_b128 v[162:165], v29 offset:10240
    v_mfma_f32_16x16x32_bf16 v[94:97], v[190:193], v[158:161], v[94:97]
    ds_read_b64_tr_b16 v[186:187], v34 offset:4096
    ds_read_b64_tr_b16 v[188:189], v34 offset:4608
    v_mfma_f32_16x16x32_bf16 v[94:97], v[194:197], v[170:173], v[94:97]
    ds_read_b64_tr_b16 v[190:191], v35 offset:0
    s_waitcnt lgkmcnt(9)
    v_mfma_f32_16x16x32_bf16 v[90:93], v[174:177], v[154:157], v[90:93]
    ds_read_b64_tr_b16 v[192:193], v35 offset:512
    s_waitcnt lgkmcnt(8)
    v_mfma_f32_16x16x32_bf16 v[90:93], v[178:181], v[166:169], v[90:93]
    ds_read_b64_tr_b16 v[194:195], v35 offset:4096
    v_mfma_f32_16x16x32_bf16 v[98:101], v[174:177], v[158:161], v[98:101]
    ds_read_b64_tr_b16 v[196:197], v35 offset:4608
    v_mfma_f32_16x16x32_bf16 v[98:101], v[178:181], v[170:173], v[98:101]
    s_waitcnt lgkmcnt(7)
    v_mfma_f32_16x16x32_bf16 v[102:105], v[150:153], v[182:185], v[102:105]
    s_waitcnt lgkmcnt(4)
    v_mfma_f32_16x16x32_bf16 v[102:105], v[162:165], v[186:189], v[102:105]
    v_mfma_f32_16x16x32_bf16 v[110:113], v[154:157], v[182:185], v[110:113]
    v_mfma_f32_16x16x32_bf16 v[110:113], v[166:169], v[186:189], v[110:113]
    v_mfma_f32_16x16x32_bf16 v[118:121], v[158:161], v[182:185], v[118:121]
    v_mfma_f32_16x16x32_bf16 v[118:121], v[170:173], v[186:189], v[118:121]
    s_waitcnt lgkmcnt(2)
    v_mfma_f32_16x16x32_bf16 v[106:109], v[150:153], v[190:193], v[106:109]
    s_waitcnt lgkmcnt(0)
    v_mfma_f32_16x16x32_bf16 v[106:109], v[162:165], v[194:197], v[106:109]
    v_mfma_f32_16x16x32_bf16 v[114:117], v[154:157], v[190:193], v[114:117]
    s_barrier
    ds_read_b128 v[130:133], v28 offset:22528
    ds_read_b64_tr_b16 v[174:175], v34 offset:8192
    ds_read_b64_tr_b16 v[176:177], v34 offset:8704
    ds_read_b128 v[142:145], v29 offset:22528
    ds_read_b64_tr_b16 v[178:179], v34 offset:12288
    ds_read_b64_tr_b16 v[180:181], v34 offset:12800
    ds_read_b128 v[134:137], v28 offset:24576
    ds_read_b128 v[146:149], v29 offset:24576
    ds_read_b64_tr_b16 v[182:183], v35 offset:8192
    ds_read_b64_tr_b16 v[184:185], v35 offset:8704
    ds_read_b64_tr_b16 v[186:187], v35 offset:12288
    ds_read_b64_tr_b16 v[188:189], v35 offset:12800
    v_mfma_f32_16x16x32_bf16 v[114:117], v[166:169], v[194:197], v[114:117]
    v_mfma_f32_16x16x32_bf16 v[122:125], v[158:161], v[190:193], v[122:125]
    ds_read_b64_tr_b16 v[190:191], v34 offset:16384
    v_mfma_f32_16x16x32_bf16 v[122:125], v[170:173], v[194:197], v[122:125]
    ds_read_b64_tr_b16 v[192:193], v34 offset:16896
    s_waitcnt lgkmcnt(11)
    v_mfma_f32_16x16x32_bf16 v[62:65], v[174:177], v[130:133], v[62:65]
    ds_read_b64_tr_b16 v[194:195], v34 offset:20480
    s_waitcnt lgkmcnt(9)
    v_mfma_f32_16x16x32_bf16 v[62:65], v[178:181], v[142:145], v[62:65]
    ds_read_b64_tr_b16 v[196:197], v34 offset:20992
    s_waitcnt lgkmcnt(9)
    v_mfma_f32_16x16x32_bf16 v[70:73], v[174:177], v[134:137], v[70:73]
    ds_read_b64_tr_b16 v[174:175], v35 offset:16384
    s_waitcnt lgkmcnt(9)
    v_mfma_f32_16x16x32_bf16 v[70:73], v[178:181], v[146:149], v[70:73]
    ds_read_b64_tr_b16 v[176:177], v35 offset:16896
    s_waitcnt lgkmcnt(8)
    v_mfma_f32_16x16x32_bf16 v[66:69], v[182:185], v[130:133], v[66:69]
    ds_read_b64_tr_b16 v[178:179], v35 offset:20480
    s_waitcnt lgkmcnt(7)
    v_mfma_f32_16x16x32_bf16 v[66:69], v[186:189], v[142:145], v[66:69]
    ds_read_b64_tr_b16 v[180:181], v35 offset:20992
    v_mfma_f32_16x16x32_bf16 v[74:77], v[182:185], v[134:137], v[74:77]
    ds_read_b128 v[126:129], v28 offset:20480
    v_mfma_f32_16x16x32_bf16 v[74:77], v[186:189], v[146:149], v[74:77]
    ds_read_b64_tr_b16 v[182:183], v34 offset:24576
    s_waitcnt lgkmcnt(8)
    v_mfma_f32_16x16x32_bf16 v[86:89], v[190:193], v[130:133], v[86:89]
    ds_read_b64_tr_b16 v[184:185], v34 offset:25088
    s_waitcnt lgkmcnt(7)
    v_mfma_f32_16x16x32_bf16 v[86:89], v[194:197], v[142:145], v[86:89]
    ds_read_b128 v[138:141], v29 offset:20480
    v_mfma_f32_16x16x32_bf16 v[94:97], v[190:193], v[134:137], v[94:97]
    ds_read_b64_tr_b16 v[186:187], v34 offset:28672
    ds_read_b64_tr_b16 v[188:189], v34 offset:29184
    v_mfma_f32_16x16x32_bf16 v[94:97], v[194:197], v[146:149], v[94:97]
    ds_read_b64_tr_b16 v[190:191], v35 offset:24576
    s_waitcnt lgkmcnt(9)
    v_mfma_f32_16x16x32_bf16 v[90:93], v[174:177], v[130:133], v[90:93]
    ds_read_b64_tr_b16 v[192:193], v35 offset:25088
    s_waitcnt lgkmcnt(8)
    v_mfma_f32_16x16x32_bf16 v[90:93], v[178:181], v[142:145], v[90:93]
    ds_read_b64_tr_b16 v[194:195], v35 offset:28672
    v_mfma_f32_16x16x32_bf16 v[98:101], v[174:177], v[134:137], v[98:101]
    ds_read_b64_tr_b16 v[196:197], v35 offset:29184
    v_mfma_f32_16x16x32_bf16 v[98:101], v[178:181], v[146:149], v[98:101]
    s_waitcnt lgkmcnt(7)
    v_mfma_f32_16x16x32_bf16 v[102:105], v[126:129], v[182:185], v[102:105]
    s_waitcnt lgkmcnt(4)
    v_mfma_f32_16x16x32_bf16 v[102:105], v[138:141], v[186:189], v[102:105]
    v_mfma_f32_16x16x32_bf16 v[110:113], v[130:133], v[182:185], v[110:113]
    v_mfma_f32_16x16x32_bf16 v[110:113], v[142:145], v[186:189], v[110:113]
    v_mfma_f32_16x16x32_bf16 v[118:121], v[134:137], v[182:185], v[118:121]
    v_mfma_f32_16x16x32_bf16 v[118:121], v[146:149], v[186:189], v[118:121]
    s_waitcnt lgkmcnt(2)
    v_mfma_f32_16x16x32_bf16 v[106:109], v[126:129], v[190:193], v[106:109]
    s_waitcnt lgkmcnt(0)
    v_mfma_f32_16x16x32_bf16 v[106:109], v[138:141], v[194:197], v[106:109]
    v_mfma_f32_16x16x32_bf16 v[114:117], v[130:133], v[190:193], v[114:117]
    s_barrier
    ds_read_b128 v[154:157], v28 offset:32768
    ds_read_b64_tr_b16 v[174:175], v34 offset:32768
    ds_read_b64_tr_b16 v[176:177], v34 offset:33280
    ds_read_b128 v[166:169], v29 offset:32768
    ds_read_b64_tr_b16 v[178:179], v34 offset:36864
    ds_read_b64_tr_b16 v[180:181], v34 offset:37376
    ds_read_b128 v[158:161], v28 offset:34816
    ds_read_b128 v[170:173], v29 offset:34816
    ds_read_b64_tr_b16 v[182:183], v35 offset:32768
    ds_read_b64_tr_b16 v[184:185], v35 offset:33280
    ds_read_b64_tr_b16 v[186:187], v35 offset:36864
    ds_read_b64_tr_b16 v[188:189], v35 offset:37376
    v_mfma_f32_16x16x32_bf16 v[114:117], v[142:145], v[194:197], v[114:117]
    v_mfma_f32_16x16x32_bf16 v[122:125], v[134:137], v[190:193], v[122:125]
    ds_read_b64_tr_b16 v[190:191], v32 offset:0
    v_mfma_f32_16x16x32_bf16 v[122:125], v[146:149], v[194:197], v[122:125]
    ds_read_b64_tr_b16 v[192:193], v32 offset:512
    s_waitcnt lgkmcnt(11)
    v_mfma_f32_16x16x32_bf16 v[62:65], v[174:177], v[154:157], v[62:65]
    ds_read_b64_tr_b16 v[194:195], v32 offset:4096
    s_waitcnt lgkmcnt(9)
    v_mfma_f32_16x16x32_bf16 v[62:65], v[178:181], v[166:169], v[62:65]
    ds_read_b64_tr_b16 v[196:197], v32 offset:4608
    s_waitcnt lgkmcnt(9)
    v_mfma_f32_16x16x32_bf16 v[70:73], v[174:177], v[158:161], v[70:73]
    ds_read_b64_tr_b16 v[174:175], v33 offset:0
    s_waitcnt lgkmcnt(9)
    v_mfma_f32_16x16x32_bf16 v[70:73], v[178:181], v[170:173], v[70:73]
    ds_read_b64_tr_b16 v[176:177], v33 offset:512
    s_waitcnt lgkmcnt(8)
    v_mfma_f32_16x16x32_bf16 v[66:69], v[182:185], v[154:157], v[66:69]
    ds_read_b64_tr_b16 v[178:179], v33 offset:4096
    s_waitcnt lgkmcnt(7)
    v_mfma_f32_16x16x32_bf16 v[66:69], v[186:189], v[166:169], v[66:69]
    ds_read_b64_tr_b16 v[180:181], v33 offset:4608
    v_mfma_f32_16x16x32_bf16 v[74:77], v[182:185], v[158:161], v[74:77]
    ds_read_b128 v[150:153], v28 offset:30720
    v_mfma_f32_16x16x32_bf16 v[74:77], v[186:189], v[170:173], v[74:77]
    ds_read_b64_tr_b16 v[182:183], v32 offset:8192
    s_waitcnt lgkmcnt(8)
    v_mfma_f32_16x16x32_bf16 v[86:89], v[190:193], v[154:157], v[86:89]
    ds_read_b64_tr_b16 v[184:185], v32 offset:8704
    s_waitcnt lgkmcnt(7)
    v_mfma_f32_16x16x32_bf16 v[86:89], v[194:197], v[166:169], v[86:89]
    ds_read_b128 v[162:165], v29 offset:30720
    v_mfma_f32_16x16x32_bf16 v[94:97], v[190:193], v[158:161], v[94:97]
    ds_read_b64_tr_b16 v[186:187], v32 offset:12288
    ds_read_b64_tr_b16 v[188:189], v32 offset:12800
    v_mfma_f32_16x16x32_bf16 v[94:97], v[194:197], v[170:173], v[94:97]
    ds_read_b64_tr_b16 v[190:191], v33 offset:8192
    s_waitcnt lgkmcnt(9)
    v_mfma_f32_16x16x32_bf16 v[90:93], v[174:177], v[154:157], v[90:93]
    ds_read_b64_tr_b16 v[192:193], v33 offset:8704
    s_waitcnt lgkmcnt(8)
    v_mfma_f32_16x16x32_bf16 v[90:93], v[178:181], v[166:169], v[90:93]
    ds_read_b64_tr_b16 v[194:195], v33 offset:12288
    v_mfma_f32_16x16x32_bf16 v[98:101], v[174:177], v[158:161], v[98:101]
    ds_read_b64_tr_b16 v[196:197], v33 offset:12800
    v_mfma_f32_16x16x32_bf16 v[98:101], v[178:181], v[170:173], v[98:101]
    s_waitcnt lgkmcnt(7)
    v_mfma_f32_16x16x32_bf16 v[102:105], v[150:153], v[182:185], v[102:105]
    s_waitcnt lgkmcnt(4)
    v_mfma_f32_16x16x32_bf16 v[102:105], v[162:165], v[186:189], v[102:105]
    v_mfma_f32_16x16x32_bf16 v[110:113], v[154:157], v[182:185], v[110:113]
    v_mfma_f32_16x16x32_bf16 v[110:113], v[166:169], v[186:189], v[110:113]
    v_mfma_f32_16x16x32_bf16 v[118:121], v[158:161], v[182:185], v[118:121]
    v_mfma_f32_16x16x32_bf16 v[118:121], v[170:173], v[186:189], v[118:121]
    s_waitcnt lgkmcnt(2)
    v_mfma_f32_16x16x32_bf16 v[106:109], v[150:153], v[190:193], v[106:109]
    s_waitcnt lgkmcnt(0)
    v_mfma_f32_16x16x32_bf16 v[106:109], v[162:165], v[194:197], v[106:109]
    v_mfma_f32_16x16x32_bf16 v[114:117], v[154:157], v[190:193], v[114:117]
    s_barrier
    ds_read_b128 v[130:133], v30 offset:2048
    ds_read_b64_tr_b16 v[174:175], v32 offset:16384
    ds_read_b64_tr_b16 v[176:177], v32 offset:16896
    ds_read_b128 v[142:145], v31 offset:2048
    ds_read_b64_tr_b16 v[178:179], v32 offset:20480
    ds_read_b64_tr_b16 v[180:181], v32 offset:20992
    ds_read_b128 v[134:137], v30 offset:4096
    ds_read_b128 v[146:149], v31 offset:4096
    ds_read_b64_tr_b16 v[182:183], v33 offset:16384
    ds_read_b64_tr_b16 v[184:185], v33 offset:16896
    ds_read_b64_tr_b16 v[186:187], v33 offset:20480
    ds_read_b64_tr_b16 v[188:189], v33 offset:20992
    v_mfma_f32_16x16x32_bf16 v[114:117], v[166:169], v[194:197], v[114:117]
    v_mfma_f32_16x16x32_bf16 v[122:125], v[158:161], v[190:193], v[122:125]
    ds_read_b64_tr_b16 v[190:191], v32 offset:24576
    v_mfma_f32_16x16x32_bf16 v[122:125], v[170:173], v[194:197], v[122:125]
    ds_read_b64_tr_b16 v[192:193], v32 offset:25088
    s_waitcnt lgkmcnt(11)
    v_mfma_f32_16x16x32_bf16 v[62:65], v[174:177], v[130:133], v[62:65]
    ds_read_b64_tr_b16 v[194:195], v32 offset:28672
    s_waitcnt lgkmcnt(9)
    v_mfma_f32_16x16x32_bf16 v[62:65], v[178:181], v[142:145], v[62:65]
    ds_read_b64_tr_b16 v[196:197], v32 offset:29184
    s_waitcnt lgkmcnt(9)
    v_mfma_f32_16x16x32_bf16 v[70:73], v[174:177], v[134:137], v[70:73]
    ds_read_b64_tr_b16 v[174:175], v33 offset:24576
    s_waitcnt lgkmcnt(9)
    v_mfma_f32_16x16x32_bf16 v[70:73], v[178:181], v[146:149], v[70:73]
    ds_read_b64_tr_b16 v[176:177], v33 offset:25088
    s_waitcnt lgkmcnt(8)
    v_mfma_f32_16x16x32_bf16 v[66:69], v[182:185], v[130:133], v[66:69]
    ds_read_b64_tr_b16 v[178:179], v33 offset:28672
    s_waitcnt lgkmcnt(7)
    v_mfma_f32_16x16x32_bf16 v[66:69], v[186:189], v[142:145], v[66:69]
    ds_read_b64_tr_b16 v[180:181], v33 offset:29184
    v_mfma_f32_16x16x32_bf16 v[74:77], v[182:185], v[134:137], v[74:77]
    ds_read_b128 v[126:129], v30 offset:0
    v_mfma_f32_16x16x32_bf16 v[74:77], v[186:189], v[146:149], v[74:77]
    ds_read_b64_tr_b16 v[182:183], v32 offset:32768
    s_waitcnt lgkmcnt(8)
    v_mfma_f32_16x16x32_bf16 v[86:89], v[190:193], v[130:133], v[86:89]
    ds_read_b64_tr_b16 v[184:185], v32 offset:33280
    s_waitcnt lgkmcnt(7)
    v_mfma_f32_16x16x32_bf16 v[86:89], v[194:197], v[142:145], v[86:89]
    ds_read_b128 v[138:141], v31 offset:0
    v_mfma_f32_16x16x32_bf16 v[94:97], v[190:193], v[134:137], v[94:97]
    ds_read_b64_tr_b16 v[186:187], v32 offset:36864
    ds_read_b64_tr_b16 v[188:189], v32 offset:37376
    v_mfma_f32_16x16x32_bf16 v[94:97], v[194:197], v[146:149], v[94:97]
    ds_read_b64_tr_b16 v[190:191], v33 offset:32768
    s_waitcnt lgkmcnt(9)
    v_mfma_f32_16x16x32_bf16 v[90:93], v[174:177], v[130:133], v[90:93]
    ds_read_b64_tr_b16 v[192:193], v33 offset:33280
    s_waitcnt lgkmcnt(8)
    v_mfma_f32_16x16x32_bf16 v[90:93], v[178:181], v[142:145], v[90:93]
    ds_read_b64_tr_b16 v[194:195], v33 offset:36864
    v_mfma_f32_16x16x32_bf16 v[98:101], v[174:177], v[134:137], v[98:101]
    ds_read_b64_tr_b16 v[196:197], v33 offset:37376
    v_mfma_f32_16x16x32_bf16 v[98:101], v[178:181], v[146:149], v[98:101]
    s_waitcnt lgkmcnt(7)
    v_mfma_f32_16x16x32_bf16 v[102:105], v[126:129], v[182:185], v[102:105]
    s_waitcnt lgkmcnt(4)
    v_mfma_f32_16x16x32_bf16 v[102:105], v[138:141], v[186:189], v[102:105]
    v_mfma_f32_16x16x32_bf16 v[110:113], v[130:133], v[182:185], v[110:113]
    v_mfma_f32_16x16x32_bf16 v[110:113], v[142:145], v[186:189], v[110:113]
    v_mfma_f32_16x16x32_bf16 v[118:121], v[134:137], v[182:185], v[118:121]
    v_mfma_f32_16x16x32_bf16 v[118:121], v[146:149], v[186:189], v[118:121]
    s_waitcnt lgkmcnt(2)
    v_mfma_f32_16x16x32_bf16 v[106:109], v[126:129], v[190:193], v[106:109]
    s_waitcnt lgkmcnt(0)
    v_mfma_f32_16x16x32_bf16 v[106:109], v[138:141], v[194:197], v[106:109]
    v_mfma_f32_16x16x32_bf16 v[114:117], v[130:133], v[190:193], v[114:117]
    s_barrier
    ds_read_b128 v[154:157], v30 offset:12288
    ds_read_b64_tr_b16 v[174:175], v32 offset:40960
    ds_read_b64_tr_b16 v[176:177], v32 offset:41472
    ds_read_b128 v[166:169], v31 offset:12288
    ds_read_b64_tr_b16 v[178:179], v32 offset:45056
    ds_read_b64_tr_b16 v[180:181], v32 offset:45568
    ds_read_b128 v[158:161], v30 offset:14336
    ds_read_b128 v[170:173], v31 offset:14336
    ds_read_b64_tr_b16 v[182:183], v33 offset:40960
    ds_read_b64_tr_b16 v[184:185], v33 offset:41472
    ds_read_b64_tr_b16 v[186:187], v33 offset:45056
    ds_read_b64_tr_b16 v[188:189], v33 offset:45568
    ds_read_b64_tr_b16 v[198:199], v34 offset:0
    v_mfma_f32_16x16x32_bf16 v[114:117], v[142:145], v[194:197], v[114:117]
    ds_read_b64_tr_b16 v[200:201], v34 offset:512
    v_mfma_f32_16x16x32_bf16 v[122:125], v[134:137], v[190:193], v[122:125]
    ds_read_b64_tr_b16 v[202:203], v34 offset:4096
    v_mfma_f32_16x16x32_bf16 v[122:125], v[146:149], v[194:197], v[122:125]
    ds_read_b64_tr_b16 v[204:205], v34 offset:4608
    s_waitcnt lgkmcnt(13)
    v_mfma_f32_16x16x32_bf16 v[62:65], v[174:177], v[154:157], v[62:65]
    ds_read_b64_tr_b16 v[190:191], v35 offset:0
    s_waitcnt lgkmcnt(11)
    v_mfma_f32_16x16x32_bf16 v[62:65], v[178:181], v[166:169], v[62:65]
    ds_read_b64_tr_b16 v[192:193], v35 offset:512
    s_waitcnt lgkmcnt(11)
    v_mfma_f32_16x16x32_bf16 v[70:73], v[174:177], v[158:161], v[70:73]
    ds_read_b64_tr_b16 v[194:195], v35 offset:4096
    s_waitcnt lgkmcnt(11)
    v_mfma_f32_16x16x32_bf16 v[70:73], v[178:181], v[170:173], v[70:73]
    ds_read_b64_tr_b16 v[196:197], v35 offset:4608
    s_waitcnt lgkmcnt(10)
    v_mfma_f32_16x16x32_bf16 v[66:69], v[182:185], v[154:157], v[66:69]
    s_waitcnt lgkmcnt(8)
    v_mfma_f32_16x16x32_bf16 v[66:69], v[186:189], v[166:169], v[66:69]
    v_mfma_f32_16x16x32_bf16 v[74:77], v[182:185], v[158:161], v[74:77]
    v_mfma_f32_16x16x32_bf16 v[74:77], v[186:189], v[170:173], v[74:77]
    s_waitcnt lgkmcnt(6)
    v_mfma_f32_16x16x32_bf16 v[86:89], v[198:201], v[154:157], v[86:89]
    s_waitcnt lgkmcnt(4)
    v_mfma_f32_16x16x32_bf16 v[86:89], v[202:205], v[166:169], v[86:89]
    v_mfma_f32_16x16x32_bf16 v[94:97], v[198:201], v[158:161], v[94:97]
    v_mfma_f32_16x16x32_bf16 v[94:97], v[202:205], v[170:173], v[94:97]
    s_waitcnt lgkmcnt(2)
    v_mfma_f32_16x16x32_bf16 v[90:93], v[190:193], v[154:157], v[90:93]
    s_waitcnt lgkmcnt(0)
    v_mfma_f32_16x16x32_bf16 v[90:93], v[194:197], v[166:169], v[90:93]
    v_mfma_f32_16x16x32_bf16 v[98:101], v[190:193], v[158:161], v[98:101]
    s_barrier
    ds_read_b128 v[130:133], v30 offset:22528
    ds_read_b64_tr_b16 v[174:175], v34 offset:8192
    ds_read_b64_tr_b16 v[176:177], v34 offset:8704
    ds_read_b128 v[142:145], v31 offset:22528
    ds_read_b64_tr_b16 v[178:179], v34 offset:12288
    ds_read_b64_tr_b16 v[180:181], v34 offset:12800
    ds_read_b128 v[134:137], v30 offset:24576
    ds_read_b128 v[146:149], v31 offset:24576
    ds_read_b64_tr_b16 v[182:183], v35 offset:8192
    ds_read_b64_tr_b16 v[184:185], v35 offset:8704
    ds_read_b64_tr_b16 v[186:187], v35 offset:12288
    ds_read_b64_tr_b16 v[188:189], v35 offset:12800
    ds_read_b64_tr_b16 v[198:199], v34 offset:16384
    v_mfma_f32_16x16x32_bf16 v[98:101], v[194:197], v[170:173], v[98:101]
    ds_read_b64_tr_b16 v[200:201], v34 offset:16896
    s_waitcnt lgkmcnt(11)
    v_mfma_f32_16x16x32_bf16 v[62:65], v[174:177], v[130:133], v[62:65]
    ds_read_b64_tr_b16 v[202:203], v34 offset:20480
    s_waitcnt lgkmcnt(9)
    v_mfma_f32_16x16x32_bf16 v[62:65], v[178:181], v[142:145], v[62:65]
    ds_read_b64_tr_b16 v[204:205], v34 offset:20992
    s_waitcnt lgkmcnt(9)
    v_mfma_f32_16x16x32_bf16 v[70:73], v[174:177], v[134:137], v[70:73]
    ds_read_b64_tr_b16 v[190:191], v35 offset:16384
    s_waitcnt lgkmcnt(9)
    v_mfma_f32_16x16x32_bf16 v[70:73], v[178:181], v[146:149], v[70:73]
    ds_read_b64_tr_b16 v[192:193], v35 offset:16896
    s_waitcnt lgkmcnt(8)
    v_mfma_f32_16x16x32_bf16 v[66:69], v[182:185], v[130:133], v[66:69]
    ds_read_b64_tr_b16 v[194:195], v35 offset:20480
    ds_read_b64_tr_b16 v[196:197], v35 offset:20992
    v_cvt_pk_bf16_f32 v150, v62, v63
    v_cvt_pk_bf16_f32 v151, v64, v65
    s_waitcnt lgkmcnt(8)
    v_mfma_f32_16x16x32_bf16 v[66:69], v[186:189], v[142:145], v[66:69]
    ds_read_b128 v[126:129], v30 offset:20480
    v_cndmask_b32 v158, 0, v150, s[54:55]
    v_cndmask_b32 v150, v150, 0, s[54:55]
    v_mfma_f32_16x16x32_bf16 v[74:77], v[182:185], v[134:137], v[74:77]
    ds_read_b128 v[138:141], v31 offset:20480
    v_cndmask_b32 v159, 0, v151, s[54:55]
    v_cndmask_b32 v151, v151, 0, s[54:55]
    v_mfma_f32_16x16x32_bf16 v[74:77], v[186:189], v[146:149], v[74:77]
    v_cvt_pk_bf16_f32 v154, v70, v71
    v_cvt_pk_bf16_f32 v155, v72, v73
    s_waitcnt lgkmcnt(8)
    v_mfma_f32_16x16x32_bf16 v[86:89], v[198:201], v[130:133], v[86:89]
    v_cndmask_b32 v162, 0, v154, s[54:55]
    v_cndmask_b32 v154, v154, 0, s[54:55]
    s_waitcnt lgkmcnt(6)
    v_mfma_f32_16x16x32_bf16 v[86:89], v[202:205], v[142:145], v[86:89]
    v_cndmask_b32 v163, 0, v155, s[54:55]
    v_cndmask_b32 v155, v155, 0, s[54:55]
    s_waitcnt lgkmcnt(4)
    v_mfma_f32_16x16x32_bf16 v[90:93], v[190:193], v[130:133], v[90:93]
    v_cvt_pk_bf16_f32 v152, v66, v67
    v_cvt_pk_bf16_f32 v153, v68, v69
    s_waitcnt lgkmcnt(2)
    v_mfma_f32_16x16x32_bf16 v[90:93], v[194:197], v[142:145], v[90:93]
    v_cndmask_b32 v160, 0, v152, s[56:57]
    v_cndmask_b32 v152, v152, 0, s[56:57]
    v_mfma_f32_16x16x32_bf16 v[94:97], v[198:201], v[134:137], v[94:97]
    v_cndmask_b32 v161, 0, v153, s[56:57]
    v_cndmask_b32 v153, v153, 0, s[56:57]
    v_mfma_f32_16x16x32_bf16 v[94:97], v[202:205], v[146:149], v[94:97]
    v_cvt_pk_bf16_f32 v156, v74, v75
    v_cvt_pk_bf16_f32 v157, v76, v77
    v_mfma_f32_16x16x32_bf16 v[98:101], v[190:193], v[134:137], v[98:101]
    v_cndmask_b32 v164, 0, v156, s[56:57]
    v_cndmask_b32 v156, v156, 0, s[56:57]
    v_mfma_f32_16x16x32_bf16 v[98:101], v[194:197], v[146:149], v[98:101]
    ds_read_b32 v40, v5 offset:4
    v_cndmask_b32 v165, 0, v157, s[56:57]
    v_cndmask_b32 v157, v157, 0, s[56:57]
    ds_read_b32 v48, v220 offset:56
    ds_read_b128 v[226:229], v218
    v_cvt_pk_bf16_f32 v230, v86, v87
    v_cvt_pk_bf16_f32 v231, v88, v89
    v_cvt_pk_bf16_f32 v232, v90, v91
    v_cvt_pk_bf16_f32 v233, v92, v93
    s_nop 1
    v_mfma_f32_16x16x32_bf16 v[66:69], v[230:233], v[150:153], 0
    v_mfma_f32_16x16x32_bf16 v[70:73], v[230:233], v[154:157], 0
    v_cvt_pk_bf16_f32 v234, v94, v95
    v_cvt_pk_bf16_f32 v235, v96, v97
    v_cvt_pk_bf16_f32 v236, v98, v99
    v_cvt_pk_bf16_f32 v237, v100, v101
    s_nop 1
    v_mfma_f32_16x16x32_bf16 v[74:77], v[234:237], v[154:157], 0
    v_mfma_f32_16x16x32_bf16 v[178:181], v[230:233], v[158:161], 0
    v_mfma_f32_16x16x32_bf16 v[182:185], v[230:233], v[162:165], 0
    v_mfma_f32_16x16x32_bf16 v[186:189], v[234:237], v[162:165], 0
    s_waitcnt lgkmcnt(0)
    v_cmp_ne_u32 vcc, 0, v48
    s_nop 0
    s_cbranch_vccnz D_dK
    s_mov_b32 s9, 0
D_lK:
    ds_read_b32 v48, v220 offset:56
    ds_read_b128 v[226:229], v218
    s_add_u32 s9, s9, 1
    s_cmp_gt_u32 s9, 1600000
    s_waitcnt lgkmcnt(0)
    s_cbranch_scc1 D_dK
    v_cmp_eq_u32 vcc, 0, v48
    s_nop 0
    s_cbranch_vccnz D_lK
            D_dK:

    v_mfma_f32_16x16x32_bf16 v[62:65], v[226:229], v[150:153], 0
    v_mfma_f32_16x16x32_bf16 v[174:177], v[226:229], v[158:161], 0
    v_readfirstlane_b32 s63, v40
    v_cndmask_b32 v74, v74, v75, s[44:45]
    ds_read_b32 v40, v5 offset:32
    v_cndmask_b32 v76, v76, v77, s[44:45]
    ds_read_b64_tr_b16 v[166:167], v34 offset:32768
    v_cndmask_b32 v70, v70, v71, s[44:45]
    ds_read_b64_tr_b16 v[168:169], v34 offset:33280
    v_cndmask_b32 v72, v72, v73, s[44:45]
    ds_read_b64_tr_b16 v[170:171], v35 offset:32768
    v_cndmask_b32 v212, v70, v74, s[46:47]
    ds_read_b64_tr_b16 v[172:173], v35 offset:33280
    v_cndmask_b32 v213, v72, v76, s[48:49]
    ds_read_b64_tr_b16 v[198:199], v34 offset:36864
    v_cndmask_b32 v66, v66, v67, s[44:45]
    ds_read_b64_tr_b16 v[200:201], v34 offset:37376
    v_cndmask_b32 v68, v68, v69, s[44:45]
    ds_read_b64_tr_b16 v[202:203], v35 offset:36864
    v_cndmask_b32 v62, v62, v63, s[44:45]
    ds_read_b64_tr_b16 v[204:205], v35 offset:37376
    v_cndmask_b32 v64, v64, v65, s[44:45]
    v_cndmask_b32 v210, v62, v66, s[46:47]
    v_cndmask_b32 v211, v64, v68, s[48:49]
    v_and_or_b32 v94, v210, v46, v50
    v_and_or_b32 v95, v211, v46, v51
    v_and_or_b32 v96, v212, v46, v52
    v_and_or_b32 v97, v213, v46, v53
    s_sub_u32 s63, s63, 1
    s_cbranch_scc1 C_mr1
C_md1:
    s_cmp_lg_u32 s101, 0
    s_cbranch_scc1 SM_jS1
    s_cmp_eq_u32 s63, 0
    s_cbranch_scc1 SM_sS1
    buffer_store_dwordx4 v[94:97], v4, s[36:39], s15 offen
SM_jS1:
    v_cndmask_b32 v186, v186, v187, s[44:45]
    v_cndmask_b32 v188, v188, v189, s[44:45]
    v_cndmask_b32 v182, v182, v183, s[44:45]
    v_cndmask_b32 v184, v184, v185, s[44:45]
    v_cndmask_b32 v208, v182, v186, s[46:47]
    v_cndmask_b32 v209, v184, v188, s[48:49]
    v_cndmask_b32 v178, v178, v179, s[44:45]
    v_cndmask_b32 v180, v180, v181, s[44:45]
    v_cndmask_b32 v174, v174, v175, s[44:45]
    v_cndmask_b32 v176, v176, v177, s[44:45]
    v_cndmask_b32 v206, v174, v178, s[46:47]
    v_cndmask_b32 v207, v176, v180, s[48:49]
    ds_write_b128 v42, v[206:209]
    ds_write_b32 v47, v5 offset:16
    s_waitcnt lgkmcnt(10)
    v_cmp_gt_u32 vcc, 4, v40
    s_nop 0
    s_cbranch_vccnz C_vr1
C_vd1:
    s_waitcnt lgkmcnt(8)
    v_mfma_f32_16x16x32_bf16 v[102:105], v[126:129], v[166:169], v[102:105]
    ds_read_b128 v[150:153], v30 offset:10240
    s_waitcnt lgkmcnt(5)
    v_mfma_f32_16x16x32_bf16 v[102:105], v[138:141], v[198:201], v[102:105]
    ds_read_b64_tr_b16 v[182:183], v34 offset:24576
    v_mfma_f32_16x16x32_bf16 v[110:113], v[130:133], v[166:169], v[110:113]
    ds_read_b64_tr_b16 v[184:185], v34 offset:25088
    v_mfma_f32_16x16x32_bf16 v[110:113], v[142:145], v[198:201], v[110:113]
    ds_read_b128 v[162:165], v31 offset:10240
    v_mfma_f32_16x16x32_bf16 v[118:121], v[134:137], v[166:169], v[118:121]
    ds_read_b64_tr_b16 v[190:191], v34 offset:28672
    v_mfma_f32_16x16x32_bf16 v[118:121], v[146:149], v[198:201], v[118:121]
    ds_read_b64_tr_b16 v[192:193], v34 offset:29184
    v_mfma_f32_16x16x32_bf16 v[106:109], v[126:129], v[170:173], v[106:109]
    ds_read_b64_tr_b16 v[186:187], v35 offset:24576
    ds_read_b64_tr_b16 v[188:189], v35 offset:25088
    s_waitcnt lgkmcnt(10)
    v_mfma_f32_16x16x32_bf16 v[106:109], v[138:141], v[202:205], v[106:109]
    ds_read_b64_tr_b16 v[194:195], v35 offset:28672
    ds_read_b64_tr_b16 v[196:197], v35 offset:29184
    v_mfma_f32_16x16x32_bf16 v[114:117], v[130:133], v[170:173], v[114:117]
    ds_read_b128 v[154:157], v30 offset:12288
    v_mfma_f32_16x16x32_bf16 v[114:117], v[142:145], v[202:205], v[114:117]
    ds_read_b128 v[174:177], v31 offset:12288
    v_mfma_f32_16x16x32_bf16 v[122:125], v[134:137], v[170:173], v[122:125]
    ds_read_b128 v[158:161], v30 offset:14336
    v_mfma_f32_16x16x32_bf16 v[122:125], v[146:149], v[202:205], v[122:125]
    ds_read_b128 v[178:181], v31 offset:14336
    s_waitcnt lgkmcnt(11)
    v_mfma_f32_16x16x32_bf16 v[102:105], v[150:153], v[182:185], v[102:105]
    s_waitcnt lgkmcnt(8)
    v_mfma_f32_16x16x32_bf16 v[102:105], v[162:165], v[190:193], v[102:105]
    s_waitcnt lgkmcnt(6)
    v_mfma_f32_16x16x32_bf16 v[106:109], v[150:153], v[186:189], v[106:109]
    s_waitcnt lgkmcnt(4)
    v_mfma_f32_16x16x32_bf16 v[106:109], v[162:165], v[194:197], v[106:109]
    s_waitcnt lgkmcnt(3)
    v_mfma_f32_16x16x32_bf16 v[110:113], v[154:157], v[182:185], v[110:113]
    s_nop 1
    v_cvt_pk_bf16_f32 v226, v102, v103
    v_cvt_pk_bf16_f32 v227, v104, v105
    ds_write_b64 v219, v[226:227] offset:0
    s_waitcnt lgkmcnt(3)
    v_mfma_f32_16x16x32_bf16 v[110:113], v[174:177], v[190:193], v[110:113]
    v_mfma_f32_16x16x32_bf16 v[114:117], v[154:157], v[186:189], v[114:117]
    v_cvt_pk_bf16_f32 v232, v106, v107
    v_cvt_pk_bf16_f32 v233, v108, v109
    ds_write_b64 v219, v[232:233] offset:8
    v_mfma_f32_16x16x32_bf16 v[114:117], v[174:177], v[194:197], v[114:117]
    ds_write_b32 v221, v5 offset:68
    s_waitcnt lgkmcnt(4)
    v_mfma_f32_16x16x32_bf16 v[118:121], v[158:161], v[182:185], v[118:121]
    v_cvt_pk_bf16_f32 v228, v110, v111
    v_cvt_pk_bf16_f32 v229, v112, v113
    s_waitcnt lgkmcnt(3)
    v_mfma_f32_16x16x32_bf16 v[118:121], v[178:181], v[190:193], v[118:121]
    v_mfma_f32_16x16x32_bf16 v[122:125], v[158:161], v[186:189], v[122:125]
    v_cvt_pk_bf16_f32 v234, v114, v115
    v_cvt_pk_bf16_f32 v235, v116, v117
    v_mfma_f32_16x16x32_bf16 v[122:125], v[178:181], v[194:197], v[122:125]
    v_cndmask_b32 v126, 0, v226, s[58:59]
    v_cndmask_b32 v226, v226, 0, s[58:59]
    v_cndmask_b32 v127, 0, v227, s[58:59]
    v_cndmask_b32 v227, v227, 0, s[58:59]
    buffer_load_dwordx4 v[214:217], v4, s[36:39], s100 offen sc1
    v_cvt_pk_bf16_f32 v230, v118, v119
    v_cvt_pk_bf16_f32 v231, v120, v121
    s_nop 0
    v_cvt_pk_bf16_f32 v236, v122, v123
    v_cvt_pk_bf16_f32 v237, v124, v125
    v_cndmask_b32 v132, 0, v232, s[60:61]
    v_cndmask_b32 v232, v232, 0, s[60:61]
    v_cndmask_b32 v133, 0, v233, s[60:61]
    v_cndmask_b32 v233, v233, 0, s[60:61]
    v_cndmask_b32 v128, 0, v228, s[58:59]
    v_cndmask_b32 v228, v228, 0, s[58:59]
    v_cndmask_b32 v129, 0, v229, s[58:59]
    v_cndmask_b32 v229, v229, 0, s[58:59]
    v_cndmask_b32 v134, 0, v234, s[60:61]
    v_cndmask_b32 v234, v234, 0, s[60:61]
    v_cndmask_b32 v135, 0, v235, s[60:61]
    v_cndmask_b32 v235, v235, 0, s[60:61]
    v_cndmask_b32 v130, 0, v230, s[58:59]
    v_cndmask_b32 v230, v230, 0, s[58:59]
    v_cndmask_b32 v131, 0, v231, s[58:59]
    v_cndmask_b32 v231, v231, 0, s[58:59]
    v_cndmask_b32 v136, 0, v236, s[60:61]
    v_cndmask_b32 v236, v236, 0, s[60:61]
    v_cndmask_b32 v137, 0, v237, s[60:61]
    v_cndmask_b32 v237, v237, 0, s[60:61]
    s_waitcnt lgkmcnt(0)
C_join:
    s_mov_b32 s9, 0
    s_add_u32 s19, s100, 14336
    s_cmp_lg_u32 s101, 0
    s_cbranch_scc1 C_sv
    s_mov_b32 s40, 0x0c0c0400
    s_mov_b32 s41, 0x05040100
        C_sl:
    s_waitcnt vmcnt(0)
    v_perm_b32 v2, v215, v214, s40
    v_perm_b32 v3, v217, v216, s40
    v_and_b32 v214, v46, v214
    v_perm_b32 v2, v3, v2, s41
    v_and_b32 v215, v46, v215
    v_cmp_ne_u32 vcc, s12, v2
    v_and_b32 v216, v46, v216
    v_and_b32 v217, v46, v217

    s_cbranch_vccz C_sk
    buffer_load_dwordx4 v[214:217], v4, s[36:39], s100 offen sc1
    s_add_u32 s9, s9, 1
    s_cmp_lt_u32 s9, 200000
    s_cbranch_scc1 C_sl
    s_waitcnt vmcnt(0)
C_sk:
    v_pk_add_f32 v[210:211], v[210:211], v[214:215]
    v_pk_add_f32 v[212:213], v[212:213], v[216:217]
C_sv:
    v_max_f32 v222, v210, v211
    v_max_f32 v223, v212, v213
    v_mov_b32 v224, v222
    v_mov_b32 v225, v223
    s_mov_b64 exec, 1
    ds_add_u32 v5, v44 offset:80
    s_mov_b64 exec, -1
    v_permlane16_swap_b32 v222, v224
    v_permlane16_swap_b32 v223, v225
    v_max_f32 v222, v222, v224
    v_max_f32 v223, v223, v225
    v_mov_b32 v224, v222
    v_mov_b32 v225, v223
    s_nop 0
    v_permlane32_swap_b32 v222, v224
    v_permlane32_swap_b32 v223, v225
    v_max_f32 v222, v222, v224
    v_max_f32 v223, v223, v225
    v_mul_f32 v222, s0, v222
    v_mul_f32 v223, s0, v223
    v_fma_f32 v210, v210, s0, -v222
    v_fma_f32 v211, v211, s0, -v222
    v_fma_f32 v212, v212, s0, -v223
    v_fma_f32 v213, v213, s0, -v223
    v_exp_f32 v210, v210
    v_exp_f32 v211, v211
    v_exp_f32 v212, v212
    v_exp_f32 v213, v213
    v_add_f32 v222, v210, v211
    v_add_f32 v223, v212, v213
    v_mov_b32 v224, v222
    v_mov_b32 v225, v223
    ds_read_b32 v48, v47 offset:40
    ds_read_b128 v[78:81], v43 offset:12288
    ds_read_b128 v[82:85], v43 offset:13312
    ds_read_b32 v7, v5 offset:12
    v_permlane16_swap_b32 v222, v224
    v_permlane16_swap_b32 v223, v225
    v_add_f32 v222, v222, v224
    v_add_f32 v223, v223, v225
    v_mov_b32 v224, v222
    v_mov_b32 v225, v223
    s_nop 0
    v_permlane32_swap_b32 v222, v224
    v_permlane32_swap_b32 v223, v225
    v_add_f32 v222, v222, v224
    v_add_f32 v223, v223, v225
    v_rcp_f32 v222, v222
    v_rcp_f32 v223, v223
    s_waitcnt lgkmcnt(0)
    v_cmp_eq_u32 vcc, 0, v48
    v_mul_f32 v210, v210, v222
    v_mul_f32 v211, v211, v222
    v_mul_f32 v212, v212, v223
    v_mul_f32 v213, v213, v223
    v_cvt_pk_bf16_f32 v210, v210, v210
    v_cvt_pk_bf16_f32 v211, v211, v211
    v_cvt_pk_bf16_f32 v212, v212, v212
    v_cvt_pk_bf16_f32 v213, v213, v213
    s_cbranch_vccnz C_pr
C_pd:
    v_mfma_f32_16x16x32_bf16 v[62:65], v[126:129], v[78:81], 0
    v_and_b32 v86, v36, v210
    v_and_b32 v87, v37, v211
    v_mfma_f32_16x16x32_bf16 v[66:69], v[132:135], v[78:81], 0
    v_and_b32 v88, v38, v210
    v_and_b32 v89, v39, v211
    v_mfma_f32_16x16x32_bf16 v[70:73], v[128:131], v[82:85], 0
    v_and_b32 v90, v36, v212
    v_and_b32 v91, v37, v213
    v_mfma_f32_16x16x32_bf16 v[74:77], v[134:137], v[82:85], 0
    v_and_b32 v92, v38, v212
    v_and_b32 v93, v39, v213
    v_mfma_f32_16x16x32_bf16 v[62:65], v[226:229], v[86:89], v[62:65]
    v_mfma_f32_16x16x32_bf16 v[66:69], v[232:235], v[86:89], v[66:69]
    v_mfma_f32_16x16x32_bf16 v[70:73], v[228:231], v[90:93], v[70:73]
    v_mfma_f32_16x16x32_bf16 v[74:77], v[234:237], v[90:93], v[74:77]
    s_cmp_eq_u32 s63, 0
    s_cbranch_scc1 SM_sO
    s_nop 2
    v_cvt_pk_bf16_f32 v54, v62, v63
    v_cvt_pk_bf16_f32 v55, v64, v65
    v_cvt_pk_bf16_f32 v56, v66, v67
    v_cvt_pk_bf16_f32 v57, v68, v69
    buffer_store_dwordx4 v[54:57], v4, s[36:39], s100 offen nt
    v_cvt_pk_bf16_f32 v58, v70, v71
    v_cvt_pk_bf16_f32 v59, v72, v73
    v_cvt_pk_bf16_f32 v60, v74, v75
    v_cvt_pk_bf16_f32 v61, v76, v77
    buffer_store_dwordx4 v[58:61], v4, s[36:39], s19 offen nt
SM_jO:
    v_cmp_gt_u32 vcc, 4, v7
    s_nop 0
    s_cbranch_vccz W_dW
    s_mov_b32 s9, 0
        W_lW:
    ds_read_b32 v2, v5 offset:12
    s_add_u32 s9, s9, 1
    s_cmp_gt_u32 s9, 1600000
    s_cbranch_scc1 W_dW
    s_waitcnt lgkmcnt(0)
    v_cmp_gt_u32 vcc, 4, v2

    s_nop 0
    s_cbranch_vccnz W_lW
W_dW:
    ds_read_b64_tr_b16 v[76:77], v16 offset:0
    ds_read_b64_tr_b16 v[78:79], v16 offset:2048
    ds_read_b64_tr_b16 v[80:81], v17 offset:0
    ds_read_b64_tr_b16 v[82:83], v17 offset:2048
    ds_read_b64_tr_b16 v[84:85], v18 offset:0
    ds_read_b64_tr_b16 v[86:87], v18 offset:2048
    ds_read_b64_tr_b16 v[88:89], v19 offset:0
    ds_read_b64_tr_b16 v[90:91], v19 offset:2048
    ds_read_b64_tr_b16 v[92:93], v16 offset:4096
    ds_read_b64_tr_b16 v[94:95], v16 offset:6144
    ds_read_b64_tr_b16 v[96:97], v17 offset:4096
    ds_read_b64_tr_b16 v[98:99], v17 offset:6144
    ds_read_b64_tr_b16 v[100:101], v18 offset:4096
    ds_read_b64_tr_b16 v[102:103], v18 offset:6144
    ds_read_b64_tr_b16 v[104:105], v19 offset:4096
    ds_read_b64_tr_b16 v[106:107], v19 offset:6144
    ds_read_b64_tr_b16 v[108:109], v16 offset:8192
    ds_read_b64_tr_b16 v[110:111], v16 offset:10240
    ds_read_b64_tr_b16 v[112:113], v17 offset:8192
    ds_read_b64_tr_b16 v[114:115], v17 offset:10240
    ds_read_b64_tr_b16 v[116:117], v18 offset:8192
    ds_read_b64_tr_b16 v[118:119], v18 offset:10240
    ds_read_b64_tr_b16 v[120:121], v19 offset:8192
    ds_read_b64_tr_b16 v[122:123], v19 offset:10240
    ds_read_b64_tr_b16 v[124:125], v16 offset:12288
    ds_read_b64_tr_b16 v[126:127], v16 offset:14336
    ds_read_b64_tr_b16 v[128:129], v17 offset:12288
    ds_read_b64_tr_b16 v[130:131], v17 offset:14336
    ds_read_b64_tr_b16 v[132:133], v18 offset:12288
    ds_read_b64_tr_b16 v[134:135], v18 offset:14336
    ds_read_b64_tr_b16 v[136:137], v19 offset:12288
    ds_read_b64_tr_b16 v[138:139], v19 offset:14336
    s_waitcnt vmcnt(0)
    s_mov_b64 exec, 1
    s_cmp_eq_u32 s63, 0
    s_cbranch_scc1 SM_sF
    buffer_store_dwordx2 v[14:15], v6, s[36:39], s21 offen
SM_jF:
    s_mov_b64 exec, -1
    ds_read_b64_tr_b16 v[140:141], v16 offset:16384
    ds_read_b64_tr_b16 v[142:143], v16 offset:18432
    ds_read_b64_tr_b16 v[144:145], v17 offset:16384
    ds_read_b64_tr_b16 v[146:147], v17 offset:18432
    ds_read_b64_tr_b16 v[148:149], v18 offset:16384
    ds_read_b64_tr_b16 v[150:151], v18 offset:18432
    ds_read_b64_tr_b16 v[152:153], v19 offset:16384
    ds_read_b64_tr_b16 v[154:155], v19 offset:18432
    ds_read_b64_tr_b16 v[156:157], v16 offset:20480
    ds_read_b64_tr_b16 v[158:159], v16 offset:22528
    ds_read_b64_tr_b16 v[160:161], v17 offset:20480
    ds_read_b64_tr_b16 v[162:163], v17 offset:22528
    ds_read_b64_tr_b16 v[164:165], v18 offset:20480
    ds_read_b64_tr_b16 v[166:167], v18 offset:22528
    ds_read_b64_tr_b16 v[168:169], v19 offset:20480
    ds_read_b64_tr_b16 v[170:171], v19 offset:22528
    ds_read_b64_tr_b16 v[172:173], v16 offset:24576
    ds_read_b64_tr_b16 v[174:175], v16 offset:26624
    ds_read_b64_tr_b16 v[176:177], v17 offset:24576
    ds_read_b64_tr_b16 v[178:179], v17 offset:26624
    ds_read_b64_tr_b16 v[180:181], v18 offset:24576
    ds_read_b64_tr_b16 v[182:183], v18 offset:26624
    ds_read_b64_tr_b16 v[184:185], v19 offset:24576
    ds_read_b64_tr_b16 v[186:187], v19 offset:26624
    buffer_load_dwordx2 v[12:13], v8, s[36:39], s20 offen sc1
    ds_read_b64_tr_b16 v[188:189], v16 offset:28672
    ds_read_b64_tr_b16 v[190:191], v16 offset:30720
    ds_read_b64_tr_b16 v[192:193], v17 offset:28672
    ds_read_b64_tr_b16 v[194:195], v17 offset:30720
    ds_read_b64_tr_b16 v[196:197], v18 offset:28672
    ds_read_b64_tr_b16 v[198:199], v18 offset:30720
    ds_read_b64_tr_b16 v[200:201], v19 offset:28672
    ds_read_b64_tr_b16 v[202:203], v19 offset:30720
    ds_read_b64_tr_b16 v[204:205], v16 offset:32768
    ds_read_b64_tr_b16 v[206:207], v16 offset:34816
    ds_read_b64_tr_b16 v[208:209], v17 offset:32768
    ds_read_b64_tr_b16 v[210:211], v17 offset:34816
    ds_read_b64_tr_b16 v[212:213], v18 offset:32768
    ds_read_b64_tr_b16 v[214:215], v18 offset:34816
    ds_read_b64_tr_b16 v[216:217], v19 offset:32768
    ds_read_b64_tr_b16 v[218:219], v19 offset:34816
    ds_read_b64_tr_b16 v[220:221], v16 offset:36864
    ds_read_b64_tr_b16 v[222:223], v16 offset:38912
    ds_read_b64_tr_b16 v[224:225], v17 offset:36864
    ds_read_b64_tr_b16 v[226:227], v17 offset:38912
    ds_read_b64_tr_b16 v[228:229], v18 offset:36864
    ds_read_b64_tr_b16 v[230:231], v18 offset:38912
    ds_read_b64_tr_b16 v[232:233], v19 offset:36864
    ds_read_b64_tr_b16 v[234:235], v19 offset:38912
    s_mov_b32 s9, 0
        P_lO:
    s_waitcnt vmcnt(0)
    v_cmp_ne_u64 vcc, s[12:13], v[12:13]
    s_nop 0
    s_cbranch_vccz P_dO
    buffer_load_dwordx2 v[12:13], v8, s[36:39], s20 offen sc1
    s_add_u32 s9, s9, 1
    s_cmp_lt_u32 s9, 200000
    s_cbranch_scc1 P_lO
    s_waitcnt vmcnt(0)
        P_dO:

    buffer_load_dwordx4 v[40:43], v4, s[36:39], s22 offen offset:0 sc1
    buffer_load_dwordx4 v[44:47], v4, s[36:39], s22 offen offset:1024 sc1
    buffer_load_dwordx4 v[48:51], v4, s[36:39], s22 offen offset:2048 sc1
    buffer_load_dwordx4 v[52:55], v4, s[36:39], s22 offen offset:3072 sc1
    s_add_u32 s22, s22, 4096
    buffer_load_dwordx4 v[56:59], v4, s[36:39], s22 offen offset:0 sc1
    buffer_load_dwordx4 v[60:63], v4, s[36:39], s22 offen offset:1024 sc1
    s_waitcnt lgkmcnt(0)
    s_mov_b32 s9, 0
        W_lW2:
    ds_read_b32 v2, v5 offset:36
    s_add_u32 s9, s9, 1
    s_cmp_gt_u32 s9, 1600000
    s_cbranch_scc1 W_dW2
    s_waitcnt lgkmcnt(0)
    v_cmp_gt_u32 vcc, 4, v2

    s_nop 0
    s_cbranch_vccnz W_lW2
W_dW2:
    s_waitcnt vmcnt(5)
    v_mfma_f32_16x16x32_bf16 v[24:27], v[76:79], v[40:43], 0
    buffer_load_dwordx4 v[64:67], v4, s[36:39], s22 offen offset:2048 sc1
    ds_read_b64_tr_b16 v[76:77], v16 offset:40960
    ds_read_b64_tr_b16 v[78:79], v16 offset:43008
    v_mfma_f32_16x16x32_bf16 v[28:31], v[80:83], v[40:43], 0
    ds_read_b64_tr_b16 v[80:81], v17 offset:40960
    ds_read_b64_tr_b16 v[82:83], v17 offset:43008
    v_mfma_f32_16x16x32_bf16 v[32:35], v[84:87], v[40:43], 0
    ds_read_b64_tr_b16 v[84:85], v18 offset:40960
    ds_read_b64_tr_b16 v[86:87], v18 offset:43008
    v_mfma_f32_16x16x32_bf16 v[36:39], v[88:91], v[40:43], 0
    ds_read_b64_tr_b16 v[88:89], v19 offset:40960
    ds_read_b64_tr_b16 v[90:91], v19 offset:43008
    s_waitcnt vmcnt(5)
    v_mfma_f32_16x16x32_bf16 v[24:27], v[92:95], v[44:47], v[24:27]
    buffer_load_dwordx4 v[68:71], v4, s[36:39], s22 offen offset:3072 sc1
    s_add_u32 s22, s22, 4096
    ds_read_b64_tr_b16 v[92:93], v16 offset:45056
    ds_read_b64_tr_b16 v[94:95], v16 offset:47104
    v_mfma_f32_16x16x32_bf16 v[28:31], v[96:99], v[44:47], v[28:31]
    ds_read_b64_tr_b16 v[96:97], v17 offset:45056
    ds_read_b64_tr_b16 v[98:99], v17 offset:47104
    v_mfma_f32_16x16x32_bf16 v[32:35], v[100:103], v[44:47], v[32:35]
    ds_read_b64_tr_b16 v[100:101], v18 offset:45056
    ds_read_b64_tr_b16 v[102:103], v18 offset:47104
    v_mfma_f32_16x16x32_bf16 v[36:39], v[104:107], v[44:47], v[36:39]
    ds_read_b64_tr_b16 v[104:105], v19 offset:45056
    ds_read_b64_tr_b16 v[106:107], v19 offset:47104
    s_waitcnt vmcnt(5)
    v_mfma_f32_16x16x32_bf16 v[24:27], v[108:111], v[48:51], v[24:27]
    buffer_load_dwordx4 v[72:75], v4, s[36:39], s22 offen offset:0 sc1
    ds_read_b64_tr_b16 v[108:109], v16 offset:49152
    ds_read_b64_tr_b16 v[110:111], v16 offset:51200
    v_mfma_f32_16x16x32_bf16 v[28:31], v[112:115], v[48:51], v[28:31]
    ds_read_b64_tr_b16 v[112:113], v17 offset:49152
    ds_read_b64_tr_b16 v[114:115], v17 offset:51200
    v_mfma_f32_16x16x32_bf16 v[32:35], v[116:119], v[48:51], v[32:35]
    ds_read_b64_tr_b16 v[116:117], v18 offset:49152
    ds_read_b64_tr_b16 v[118:119], v18 offset:51200
    v_mfma_f32_16x16x32_bf16 v[36:39], v[120:123], v[48:51], v[36:39]
    ds_read_b64_tr_b16 v[120:121], v19 offset:49152
    ds_read_b64_tr_b16 v[122:123], v19 offset:51200
    s_waitcnt vmcnt(5)
    v_mfma_f32_16x16x32_bf16 v[24:27], v[124:127], v[52:55], v[24:27]
    buffer_load_dwordx4 v[40:43], v4, s[36:39], s22 offen offset:1024 sc1
    ds_read_b64_tr_b16 v[124:125], v16 offset:53248
    ds_read_b64_tr_b16 v[126:127], v16 offset:55296
    v_mfma_f32_16x16x32_bf16 v[28:31], v[128:131], v[52:55], v[28:31]
    ds_read_b64_tr_b16 v[128:129], v17 offset:53248
    ds_read_b64_tr_b16 v[130:131], v17 offset:55296
    v_mfma_f32_16x16x32_bf16 v[32:35], v[132:135], v[52:55], v[32:35]
    ds_read_b64_tr_b16 v[132:133], v18 offset:53248
    ds_read_b64_tr_b16 v[134:135], v18 offset:55296
    v_mfma_f32_16x16x32_bf16 v[36:39], v[136:139], v[52:55], v[36:39]
    ds_read_b64_tr_b16 v[136:137], v19 offset:53248
    ds_read_b64_tr_b16 v[138:139], v19 offset:55296
    s_waitcnt vmcnt(5)
    v_mfma_f32_16x16x32_bf16 v[24:27], v[140:143], v[56:59], v[24:27]
    buffer_load_dwordx4 v[44:47], v4, s[36:39], s22 offen offset:2048 sc1
    v_mfma_f32_16x16x32_bf16 v[28:31], v[144:147], v[56:59], v[28:31]
    v_mfma_f32_16x16x32_bf16 v[32:35], v[148:151], v[56:59], v[32:35]
    v_mfma_f32_16x16x32_bf16 v[36:39], v[152:155], v[56:59], v[36:39]
    s_waitcnt vmcnt(5)
    v_mfma_f32_16x16x32_bf16 v[24:27], v[156:159], v[60:63], v[24:27]
    buffer_load_dwordx4 v[48:51], v4, s[36:39], s22 offen offset:3072 sc1
    s_add_u32 s22, s22, 4096
    v_mfma_f32_16x16x32_bf16 v[28:31], v[160:163], v[60:63], v[28:31]
    v_mfma_f32_16x16x32_bf16 v[32:35], v[164:167], v[60:63], v[32:35]
    v_mfma_f32_16x16x32_bf16 v[36:39], v[168:171], v[60:63], v[36:39]
    s_waitcnt vmcnt(5)
    v_mfma_f32_16x16x32_bf16 v[24:27], v[172:175], v[64:67], v[24:27]
    buffer_load_dwordx4 v[52:55], v4, s[36:39], s22 offen offset:0 sc1
    v_mfma_f32_16x16x32_bf16 v[28:31], v[176:179], v[64:67], v[28:31]
    v_mfma_f32_16x16x32_bf16 v[32:35], v[180:183], v[64:67], v[32:35]
    v_mfma_f32_16x16x32_bf16 v[36:39], v[184:187], v[64:67], v[36:39]
    s_waitcnt vmcnt(5)
    v_mfma_f32_16x16x32_bf16 v[24:27], v[188:191], v[68:71], v[24:27]
    buffer_load_dwordx4 v[56:59], v4, s[36:39], s22 offen offset:1024 sc1
    v_mfma_f32_16x16x32_bf16 v[28:31], v[192:195], v[68:71], v[28:31]
    v_mfma_f32_16x16x32_bf16 v[32:35], v[196:199], v[68:71], v[32:35]
    v_mfma_f32_16x16x32_bf16 v[36:39], v[200:203], v[68:71], v[36:39]
    s_waitcnt vmcnt(5)
    v_mfma_f32_16x16x32_bf16 v[24:27], v[204:207], v[72:75], v[24:27]
    v_mfma_f32_16x16x32_bf16 v[28:31], v[208:211], v[72:75], v[28:31]
    v_mfma_f32_16x16x32_bf16 v[32:35], v[212:215], v[72:75], v[32:35]
    v_mfma_f32_16x16x32_bf16 v[36:39], v[216:219], v[72:75], v[36:39]
    s_waitcnt vmcnt(4)
    v_mfma_f32_16x16x32_bf16 v[24:27], v[220:223], v[40:43], v[24:27]
    v_mfma_f32_16x16x32_bf16 v[28:31], v[224:227], v[40:43], v[28:31]
    v_mfma_f32_16x16x32_bf16 v[32:35], v[228:231], v[40:43], v[32:35]
    v_mfma_f32_16x16x32_bf16 v[36:39], v[232:235], v[40:43], v[36:39]
    s_waitcnt vmcnt(3)
    s_waitcnt lgkmcnt(15)
    v_mfma_f32_16x16x32_bf16 v[24:27], v[76:79], v[44:47], v[24:27]
    v_mfma_f32_16x16x32_bf16 v[28:31], v[80:83], v[44:47], v[28:31]
    v_mfma_f32_16x16x32_bf16 v[32:35], v[84:87], v[44:47], v[32:35]
    v_mfma_f32_16x16x32_bf16 v[36:39], v[88:91], v[44:47], v[36:39]
    s_waitcnt vmcnt(2)
    v_mfma_f32_16x16x32_bf16 v[24:27], v[92:95], v[48:51], v[24:27]
    v_mfma_f32_16x16x32_bf16 v[28:31], v[96:99], v[48:51], v[28:31]
    v_mfma_f32_16x16x32_bf16 v[32:35], v[100:103], v[48:51], v[32:35]
    v_mfma_f32_16x16x32_bf16 v[36:39], v[104:107], v[48:51], v[36:39]
    s_waitcnt vmcnt(1)
    s_waitcnt lgkmcnt(14)
    v_mfma_f32_16x16x32_bf16 v[24:27], v[108:111], v[52:55], v[24:27]
    s_waitcnt lgkmcnt(12)
    v_mfma_f32_16x16x32_bf16 v[28:31], v[112:115], v[52:55], v[28:31]
    s_waitcnt lgkmcnt(10)
    v_mfma_f32_16x16x32_bf16 v[32:35], v[116:119], v[52:55], v[32:35]
    s_waitcnt lgkmcnt(8)
    v_mfma_f32_16x16x32_bf16 v[36:39], v[120:123], v[52:55], v[36:39]
    s_waitcnt vmcnt(0)
    s_waitcnt lgkmcnt(6)
    v_mfma_f32_16x16x32_bf16 v[24:27], v[124:127], v[56:59], v[24:27]
    s_waitcnt lgkmcnt(4)
    v_mfma_f32_16x16x32_bf16 v[28:31], v[128:131], v[56:59], v[28:31]
    s_waitcnt lgkmcnt(2)
    v_mfma_f32_16x16x32_bf16 v[32:35], v[132:135], v[56:59], v[32:35]
    s_waitcnt lgkmcnt(0)
    v_mfma_f32_16x16x32_bf16 v[36:39], v[136:139], v[56:59], v[36:39]
    s_nop 1
    v_cvt_pk_bf16_f32 v156, v24, v25
    v_cvt_pk_bf16_f32 v157, v26, v27
    ds_write_b64 v20, v[156:157]
    v_cvt_pk_bf16_f32 v158, v28, v29
    v_cvt_pk_bf16_f32 v159, v30, v31
    ds_write_b64 v21, v[158:159]
    v_cvt_pk_bf16_f32 v160, v32, v33
    v_cvt_pk_bf16_f32 v161, v34, v35
    ds_write_b64 v22, v[160:161]
    v_cvt_pk_bf16_f32 v162, v36, v37
    v_cvt_pk_bf16_f32 v163, v38, v39
    ds_write_b64 v23, v[162:163]
    ds_read_b128 v[172:175], v9
    ds_read_b128 v[176:179], v9 offset:1024
    s_waitcnt lgkmcnt(1)
    buffer_store_dwordx4 v[172:175], v10, s[32:35], s23 offen nt
    s_waitcnt lgkmcnt(0)
    buffer_store_dwordx4 v[176:179], v10, s[32:35], s28 offen nt

    s_add_u32 s40, s7, s62
    s_cmp_lg_u32 s40, 0
    s_cbranch_scc1 C_end
    s_add_u32 s40, s10, 16
    v_mov_b32 v2, s40
    s_lshl_b32 s40, s8, 7
    s_mov_b64 exec, 1
    buffer_store_dword v2, v6, s[36:39], s40 offen
        C_end:

    s_endpgm
K_cold:
X_cH:
    s_mov_b32 s9, 0
        X_lH:
    v_cmp_ne_u64 vcc, s[28:29], v[18:19]
    s_nop 0
    s_cbranch_vccz X_okH
    v_subrev_u32 v18, s12, v18
    v_cmp_ne_u32 s[42:43], s13, v19
    v_cmp_le_u32 vcc, 8, v18
    s_nop 0
    s_or_b64 vcc, vcc, s[42:43]
    s_cbranch_vccz X_nH
    buffer_load_dwordx2 v[18:19], v20, s[36:39], s30 offen sc1
    s_add_u32 s9, s9, 1
    s_cmp_lt_u32 s9, 200000
    s_waitcnt vmcnt(0)
    s_cbranch_scc1 X_lH
        X_nH:
    s_mov_b32 s101, 0
    s_branch X_okH
S_cls0:
    s_cmp_eq_u32 s57, 0
    s_cbranch_scc0 S_cls1
    v_cmp_eq_u32 s[42:43], 0, v3
    v_mov_b32 v4, 0x3f80
    s_nop 0
    v_cndmask_b32 v28, v28, v4, s[42:43]
    v_mov_b32 v32, 0
    v_mov_b32 v40, 0
    v_cndmask_b32 v29, v29, v4, s[42:43]
    v_mov_b32 v33, 0
    v_mov_b32 v41, 0
    v_cndmask_b32 v30, v30, v4, s[42:43]
    v_mov_b32 v34, 0
    v_mov_b32 v42, 0
    v_cndmask_b32 v31, v31, v4, s[42:43]
    v_mov_b32 v35, 0
    v_mov_b32 v43, 0
    s_branch S_reg
S_cls1:
    v_mov_b32 v32, v28
    v_mov_b32 v28, 0
    v_mov_b32 v40, v36
    v_mov_b32 v36, 0
    v_mov_b32 v33, v29
    v_mov_b32 v29, 0
    v_mov_b32 v41, v37
    v_mov_b32 v37, 0
    v_mov_b32 v34, v30
    v_mov_b32 v30, 0
    v_mov_b32 v42, v38
    v_mov_b32 v38, 0
    v_mov_b32 v35, v31
    v_mov_b32 v31, 0
    v_mov_b32 v43, v39
    v_mov_b32 v39, 0
    s_branch S_reg
S_gr:
    s_add_u32 s9, s9, 1
    s_cmp_gt_u32 s9, 200000
    s_cbranch_scc1 S_gk
    buffer_load_dwordx4 v44, s[36:39], s60 offen offset:0 sc1 lds
    buffer_load_dwordx4 v45, s[36:39], s60 offen offset:1024 sc1 lds
    buffer_load_dwordx4 v44, s[36:39], s60 offen offset:2048 sc1 lds
    buffer_load_dwordx4 v45, s[36:39], s60 offen offset:3072 sc1 lds
    s_branch S_gc
S_x0:
    v_cmp_eq_u32 s[42:43], 0, v3
    v_mov_b32 v4, 0x3f800000
    s_nop 0
    v_cndmask_b32 v32, 0, v4, s[42:43]
    v_cndmask_b32 v33, 0, v4, s[42:43]
    v_cndmask_b32 v34, 0, v4, s[42:43]
    v_cndmask_b32 v35, 0, v4, s[42:43]
    s_nop 1
    v_mfma_f32_16x16x32_bf16 v[170:173], v[166:169], v[32:35], 0
    v_mfma_f32_16x16x32_bf16 v[178:181], v[174:177], v[32:35], 0
    v_mfma_f32_16x16x32_bf16 v[186:189], v[182:185], v[32:35], 0
    v_mfma_f32_16x16x32_bf16 v[194:197], v[190:193], v[32:35], 0
    s_lshl_b32 s40, s3, 11
    s_add_u32 s40, s40, 32768
    v_add_u32 v4, s40, v47
    s_nop 1
    v_cvt_pk_bf16_f32 v36, v170, v171
    v_cvt_pk_bf16_f32 v37, v172, v173
    v_cvt_pk_bf16_f32 v38, v178, v179
    v_cvt_pk_bf16_f32 v39, v180, v181
    ds_write_b128 v4, v[36:39] offset:32768
    v_cvt_pk_bf16_f32 v40, v186, v187
    v_cvt_pk_bf16_f32 v41, v188, v189
    v_cvt_pk_bf16_f32 v42, v194, v195
    v_cvt_pk_bf16_f32 v43, v196, v197
    ds_write_b128 v4, v[40:43] offset:33792
    s_branch S_x1
S_y0:
    v_add_u32 v4, 32768, v47
    ds_read_b128 v[166:169], v4 offset:32768
    ds_read_b128 v[170:173], v4 offset:33792
    ds_read_b128 v[174:177], v4 offset:34816
    ds_read_b128 v[178:181], v4 offset:35840
    ds_read_b128 v[182:185], v4 offset:36864
    ds_read_b128 v[186:189], v4 offset:37888
    ds_read_b128 v[190:193], v4 offset:38912
    ds_read_b128 v[194:197], v4 offset:39936
    s_waitcnt lgkmcnt(0)
    v_mfma_f32_16x16x32_bf16 v[206:209], v[102:105], v[166:169], v[206:209]
    v_mfma_f32_16x16x32_bf16 v[206:209], v[106:109], v[170:173], v[206:209]
    v_mfma_f32_16x16x32_bf16 v[210:213], v[110:113], v[174:177], v[210:213]
    v_mfma_f32_16x16x32_bf16 v[210:213], v[114:117], v[178:181], v[210:213]
    v_mfma_f32_16x16x32_bf16 v[222:225], v[134:137], v[182:185], v[222:225]
    v_mfma_f32_16x16x32_bf16 v[222:225], v[138:141], v[186:189], v[222:225]
    v_mfma_f32_16x16x32_bf16 v[226:229], v[142:145], v[190:193], v[226:229]
    v_mfma_f32_16x16x32_bf16 v[226:229], v[146:149], v[194:197], v[226:229]
    s_nop 7
    s_branch S_y1
C_mr0:
    s_mov_b32 s9, 0
        W_lM0:
    ds_read_b32 v2, v5 offset:4
    s_add_u32 s9, s9, 1
    s_cmp_gt_u32 s9, 1600000
    s_cbranch_scc1 W_dM0
    s_waitcnt lgkmcnt(0)
    v_cmp_gt_u32 vcc, 1, v2

    s_nop 0
    s_cbranch_vccnz W_lM0
W_dM0:
    s_waitcnt lgkmcnt(0)
    v_readfirstlane_b32 s63, v2
    s_nop 0
    s_lshr_b32 s63, s63, 1
    s_branch C_md0
SM_sS0:
    buffer_store_dwordx4 v[94:97], v4, s[36:39], s15 offen sc1
    s_branch SM_jS0
C_vr0:
    s_mov_b32 s9, 0
        W_lV0:
    ds_read_b32 v2, v5 offset:32
    s_add_u32 s9, s9, 1
    s_cmp_gt_u32 s9, 1600000
    s_cbranch_scc1 W_dV0
    s_waitcnt lgkmcnt(0)
    v_cmp_gt_u32 vcc, 4, v2

    s_nop 0
    s_cbranch_vccnz W_lV0
W_dV0:
    ds_read_b64_tr_b16 v[166:167], v34 offset:32768
    ds_read_b64_tr_b16 v[168:169], v34 offset:33280
    ds_read_b64_tr_b16 v[170:171], v35 offset:32768
    ds_read_b64_tr_b16 v[172:173], v35 offset:33280
    ds_read_b64_tr_b16 v[198:199], v34 offset:36864
    ds_read_b64_tr_b16 v[200:201], v34 offset:37376
    ds_read_b64_tr_b16 v[202:203], v35 offset:36864
    ds_read_b64_tr_b16 v[204:205], v35 offset:37376
    s_waitcnt lgkmcnt(0)
    s_branch C_vd0
C_mr1:
    s_mov_b32 s9, 0
        W_lM1:
    ds_read_b32 v2, v5 offset:4
    s_add_u32 s9, s9, 1
    s_cmp_gt_u32 s9, 1600000
    s_cbranch_scc1 W_dM1
    s_waitcnt lgkmcnt(0)
    v_cmp_gt_u32 vcc, 1, v2

    s_nop 0
    s_cbranch_vccnz W_lM1
W_dM1:
    s_waitcnt lgkmcnt(0)
    v_readfirstlane_b32 s63, v2
    s_nop 0
    s_lshr_b32 s63, s63, 1
    s_branch C_md1
SM_sS1:
    buffer_store_dwordx4 v[94:97], v4, s[36:39], s15 offen sc1
    s_branch SM_jS1
C_vr1:
    s_mov_b32 s9, 0
        W_lV1:
    ds_read_b32 v2, v5 offset:32
    s_add_u32 s9, s9, 1
    s_cmp_gt_u32 s9, 1600000
    s_cbranch_scc1 W_dV1
    s_waitcnt lgkmcnt(0)
    v_cmp_gt_u32 vcc, 4, v2

    s_nop 0
    s_cbranch_vccnz W_lV1
W_dV1:
    ds_read_b64_tr_b16 v[166:167], v34 offset:32768
    ds_read_b64_tr_b16 v[168:169], v34 offset:33280
    ds_read_b64_tr_b16 v[170:171], v35 offset:32768
    ds_read_b64_tr_b16 v[172:173], v35 offset:33280
    ds_read_b64_tr_b16 v[198:199], v34 offset:36864
    ds_read_b64_tr_b16 v[200:201], v34 offset:37376
    ds_read_b64_tr_b16 v[202:203], v35 offset:36864
    ds_read_b64_tr_b16 v[204:205], v35 offset:37376
    s_waitcnt lgkmcnt(0)
    s_branch C_vd1
C_pr:
    s_mov_b32 s9, 0
        C_pl:
    ds_read_b32 v48, v47 offset:40
    ds_read_b128 v[78:81], v43 offset:12288
    ds_read_b128 v[82:85], v43 offset:13312
    s_add_u32 s9, s9, 1
    s_cmp_gt_u32 s9, 1600000
    s_waitcnt lgkmcnt(0)
    s_cbranch_scc1 C_pd
    v_cmp_eq_u32 vcc, 0, v48
    s_nop 0
    s_cbranch_vccnz C_pl
    s_branch C_pd
SM_sO:
    s_nop 7
    v_cvt_pk_bf16_f32 v54, v62, v63
    v_cvt_pk_bf16_f32 v55, v64, v65
    v_cvt_pk_bf16_f32 v56, v66, v67
    v_cvt_pk_bf16_f32 v57, v68, v69
    buffer_store_dwordx4 v[54:57], v4, s[36:39], s100 offen sc1
    v_cvt_pk_bf16_f32 v58, v70, v71
    v_cvt_pk_bf16_f32 v59, v72, v73
    v_cvt_pk_bf16_f32 v60, v74, v75
    v_cvt_pk_bf16_f32 v61, v76, v77
    buffer_store_dwordx4 v[58:61], v4, s[36:39], s19 offen sc1
    s_branch SM_jO
SM_sF:
    buffer_store_dwordx2 v[14:15], v6, s[36:39], s21 offen sc1
    s_branch SM_jF
K_exit:
    s_endpgm
.fill 7168, 4, 0xbf810000
.section .rodata,"a"
.p2align 6
.amdhsa_kernel concat_heads__sliding_local_dilated__spectral_fnet__prompt_kernel
  .amdhsa_next_free_vgpr 256
  .amdhsa_next_free_sgpr 102
  .amdhsa_accum_offset 256
  .amdhsa_group_segment_fixed_size 0
  .amdhsa_kernarg_size 88
  .amdhsa_user_sgpr_count 2
  .amdhsa_user_sgpr_kernarg_segment_ptr 1
  .amdhsa_system_sgpr_workgroup_id_x 1
.end_amdhsa_kernel
```

```asm
; @launch grid=(256,1,1) block=(512,1,1) lds=163840
.amdgcn_target "amdgcn-amd-amdhsa--gfx950"
.text
.p2align 12
.fill 832, 4, 0xbf810000
.globl concat_heads__sliding_local_dilated__spectral_fnet__prompt_kernel
.p2align 8
.type concat_heads__sliding_local_dilated__spectral_fnet__prompt_kernel,@function
concat_heads__sliding_local_dilated__spectral_fnet__prompt_kernel:
    s_load_dwordx2 s[16:17], s[0:1], 0
    s_load_dwordx2 s[20:21], s[0:1], 8
    s_load_dwordx2 s[28:29], s[0:1], 24
    s_load_dwordx2 s[36:37], s[0:1], 80
    s_load_dwordx2 s[24:25], s[0:1], 16
    s_load_dwordx2 s[32:33], s[0:1], 64
    v_lshrrev_b32 v1, 6, v0
    s_cmp_ge_u32 s2, 256
    s_cbranch_scc1 K_exit
    v_readfirstlane_b32 s3, v1
    s_and_b32 s4, s2, 7
    s_lshr_b32 s5, s2, 3
    s_sub_u32 s5, s5, 4
    s_and_b32 s5, s5, 31
    s_cmp_lg_u32 s3, 7
    s_cbranch_scc1 K_nopf
    s_getpc_b64 s[44:45]
    s_mov_b32 s46, 28672
    s_mov_b32 s47, 0x00020000
    s_mul_i32 s40, s5, 896
    v_and_b32 v1, 63, v0
    v_min_u32 v1, 6, v1
    v_lshlrev_b32 v1, 7, v1
    buffer_load_dword v255, v1, s[44:47], s40 offen
        K_nopf:
    s_mul_i32 s6, s5, 37
    s_lshr_b32 s6, s6, 8
    s_mul_i32 s40, s6, 7
    s_sub_u32 s7, s5, s40
    s_mov_b32 s38, 0x10000000
    s_mov_b32 s39, 0x00020000
    s_lshl_b32 s8, s4, 2
    s_cmp_lt_u32 s5, 28
    s_cbranch_scc1 K_a

    s_add_u32 s8, s8, s7
    s_mov_b32 s30, 1835008
    s_mov_b32 s31, 0x00020000
    s_lshl_b32 s40, s3, 7
    s_add_u32 s40, s40, s8
    v_and_b32 v4, 32, v0
    v_add_u32 v4, s40, v4
    v_and_b32 v5, 31, v0
    v_lshlrev_b32 v5, 4, v5
    v_mov_b32 v6, 896
    v_mad_u32_u24 v7, v4, v6, v5
    v_add_u32 v5, 384, v5
    v_sub_u32 v8, 960, v4
    v_mad_u32_u24 v8, v8, v6, v5
    v_sub_u32 v9, 2048, v4
    v_and_b32 v9, 2047, v9
    v_mad_u32_u24 v9, v9, v6, v5
    s_lshl_b32 s42, s3, 13
    s_mov_b32 m0, s42
    s_mov_b32 s52, 57344
    s_mov_b32 s53, 917504
    s_mov_b32 s54, 974848
    s_waitcnt lgkmcnt(0)

    buffer_load_dwordx4 v7, s[28:31], 0 offen nt lds
    s_add_u32 m0, m0, 1024
    s_nop 0
    buffer_load_dwordx4 v7, s[28:31], s52 offen nt lds
    s_add_u32 m0, m0, 1024
    s_nop 0
    buffer_load_dwordx4 v9, s[28:31], 0 offen nt lds
    s_add_u32 m0, m0, 1024
    s_nop 0
    buffer_load_dwordx4 v8, s[28:31], s53 offen nt lds
    s_add_u32 m0, m0, 1024
    s_load_dwordx2 s[10:11], s[36:37], 4096
    s_branch K_spare2
K_a:
    s_add_u32 s8, s8, s6
    s_cmp_ge_u32 s3, 4
    s_cbranch_scc1 K_c
    s_setprio 2
    s_mov_b32 s44, s4
    s_add_u32 s44, s44, s7
    s_mul_i32 s40, s44, 65
    s_lshr_b32 s40, s40, 8
    s_mul_i32 s40, s40, 4
    s_sub_u32 s44, s44, s40
    s_lshl_b32 s44, s44, 2
    s_lshr_b32 s44, 0x6420, s44
    s_and_b32 s44, s44, 7
    s_mov_b32 s18, 1835008
    s_mov_b32 s19, 0x00020000
    s_mov_b32 s22, 1204224
    s_mov_b32 s23, 0x00020000
    v_and_b32 v1, 63, v0
    v_lshrrev_b32 v6, 3, v1
    v_and_b32 v7, 7, v1
    v_lshrrev_b32 v8, 4, v1
    v_xor_b32 v3, v7, v8
    v_mul_u32_u24 v23, 896, v6
    v_lshl_add_u32 v21, v3, 4, v23
    v_xor_b32 v22, 64, v21
    v_add_u32 v22, 6144, v22
    s_lshl_b32 s40, s3, 5
    v_xor_b32 v23, s40, v21
    v_and_b32 v2, 2, v6
    v_xor_b32 v2, v7, v2
    v_mul_u32_u24 v3, 2688, v6
    v_lshl_add_u32 v24, v2, 4, v3
    v_xor_b32 v25, 64, v24
    v_add_u32 v25, 20480, v25
    v_add_u32 v26, 896, v24
    v_add_u32 v27, 896, v25
    v_add_u32 v28, 1792, v24
    v_add_u32 v29, 1792, v25
    s_mov_b32 s45, s44
    s_lshl_b32 s40, s8, 6
    s_lshl_b32 s41, s3, 4
    s_add_u32 s42, s40, s41
    s_mul_i32 s46, s42, 896
    s_mul_i32 s48, s41, 2688
    s_lshl_b32 s42, s7, 7
    s_add_u32 s48, s48, s42
    s_sub_u32 s40, s40, 16
    s_max_i32 s40, s40, 0
    s_lshl_b32 s41, s3, 2
    s_add_u32 s40, s40, s41
    s_mul_i32 s47, s40, 896
    s_lshl_b32 s50, s3, 11
    s_lshl_b32 s49, s3, 9

    s_lshl_b32 s40, s44, 7
    s_add_u32 s51, s40, s46
    s_add_u32 s52, s40, s47
    s_mul_i32 s53, s44, 172032
    s_add_u32 s53, s53, s48
    s_add_u32 m0, s50, 2048
    s_add_u32 s44, s44, 1
    s_cmp_eq_u32 s44, 7
    s_cselect_b32 s44, 0, s44
    s_waitcnt lgkmcnt(0)
    buffer_load_dwordx4 v21, s[16:19], s51 offen lds
    buffer_load_dwordx4 v22, s[16:19], s51 offen offset:1024 lds
    s_add_u32 m0, s49, 0
    s_mov_b32 exec_hi, 0
    buffer_load_dwordx4 v23, s[16:19], s52 offen lds
    s_mov_b32 exec_hi, -1
    s_add_u32 m0, s50, 79872
    s_nop 0
    buffer_load_dwordx4 v24, s[20:23], s53 offen lds
    buffer_load_dwordx4 v25, s[20:23], s53 offen offset:1024 lds
    s_add_u32 m0, s50, 88064
    s_nop 0
    buffer_load_dwordx4 v26, s[20:23], s53 offen lds
    buffer_load_dwordx4 v27, s[20:23], s53 offen offset:1024 lds
    s_add_u32 m0, s50, 96256
    s_mul_i32 s53, s45, 172032
    s_add_u32 s53, s53, s48
    s_add_u32 s45, s45, 1
    s_cmp_eq_u32 s45, 7
    s_cselect_b32 s45, 0, s45
    buffer_load_dwordx4 v28, s[20:23], s53 offen lds
    buffer_load_dwordx4 v29, s[20:23], s53 offen offset:1024 lds
    s_lshl_b32 s40, s44, 7
    s_add_u32 s51, s40, s46
    s_add_u32 s52, s40, s47
    s_mul_i32 s53, s44, 172032
    s_add_u32 s53, s53, s48
    s_add_u32 m0, s50, 12288
    s_add_u32 s44, s44, 1
    s_cmp_eq_u32 s44, 7
    s_cselect_b32 s44, 0, s44
    buffer_load_dwordx4 v21, s[16:19], s51 offen lds
    buffer_load_dwordx4 v22, s[16:19], s51 offen offset:1024 lds
    s_lshl_b32 s56, s8, 7
    s_load_dwordx2 s[10:11], s[36:37], s56
    s_lshl_b32 s30, s8, 10
    s_add_u32 s30, s30, 65536
    s_getreg_b32 s28, hwreg(HW_REG_XCC_ID, 0, 3)
    v_min_u32 v20, 6, v1
    v_lshlrev_b32 v20, 3, v20
    s_mov_b32 s26, 401408
    s_mov_b32 s27, 0x00020000
    s_mov_b32 s34, 3670016
    s_mov_b32 s35, 0x00020000
    s_lshr_b32 s58, s3, 1
    s_and_b32 s59, s3, 1
    v_and_b32 v9, 15, v1
    v_mov_b32 v4, 0
    v_mov_b32 v14, 1
    v_mov_b32 v5, 161792
    v_and_b32 v50, 6, v6
    v_xor_b32 v50, v7, v50
    v_mul_u32_u24 v51, 896, v6
    v_lshl_add_u32 v10, v50, 4, v51
    v_add_u32 v11, 6144, v10
    s_mov_b32 s54, s6
    s_mul_i32 s55, s3, 14336
    s_lshl_b32 s56, s7, 7
    s_add_u32 s55, s55, s56
    s_and_b32 s56, s3, 1
    s_lshl_b32 s57, s7, 1
    s_add_u32 s56, s56, s57
    s_lshl_b32 s15, s56, 10
    s_lshl_b32 s56, s8, 2
    s_and_b32 s57, s3, 2
    s_add_u32 s56, s56, s57
    s_mul_i32 s57, s56, 14336
    s_add_u32 s15, s15, s57
    s_add_u32 s15, s15, 2097152
    s_lshl_b32 s100, s56, 6
    s_add_u32 s100, s100, 16384
    v_lshlrev_b32 v50, 7, v7
    v_and_b32 v51, 1, v6
    v_mul_u32_u24 v51, 14336, v51
    v_add3_u32 v12, v50, v51, s15
    v_mov_b32 v50, s100
    v_cmp_le_u32 vcc, 16, v1
    s_nop 1
    v_cndmask_b32 v12, v12, v50, vcc
    v_and_b32 v50, 1, v9
    v_cmp_eq_u32 s[42:43], 1, v50
    v_lshl_add_u32 v50, v8, 2, v50
    v_cmp_le_u32 s[0:1], v50, v9
    v_add_u32 v50, 2, v50
    v_cmp_le_u32 s[12:13], v50, v9
    v_mov_b32 v50, 0xffff
    v_mov_b32 v51, 0xffff0000
    v_cndmask_b32 v50, v50, v51, s[42:43]
    v_cndmask_b32 v52, v50, 0, s[0:1]
    v_cndmask_b32 v53, v50, 0, s[12:13]
    v_cndmask_b32 v54, 0, v50, s[0:1]
    v_cndmask_b32 v55, 0, v50, s[12:13]
    v_lshlrev_b32 v50, 4, v1
    s_add_u32 s56, s50, 4096
    v_add_u32 v56, s56, v50
    s_xor_b32 s56, s50, 2048
    s_add_u32 s56, s56, 4096
    v_add_u32 v57, s56, v50
    v_add_u32 v59, s50, v50
    v_lshl_add_u32 v58, s58, 3, v5
    v_lshl_add_u32 v60, s3, 2, v5
    s_cmp_eq_u32 s7, 3
    s_cselect_b32 s56, 0, 1.0
    v_mov_b32 v61, s56
    s_mov_b32 s31, 0x3e8b97f6
K_h2:
    s_add_u32 m0, s49, 10240
    s_mov_b32 exec_hi, 0
    buffer_load_dwordx4 v23, s[16:19], s52 offen lds
    s_mov_b32 exec_hi, -1
    s_add_u32 m0, s50, 104448
    s_nop 0
    buffer_load_dwordx4 v24, s[20:23], s53 offen lds
    buffer_load_dwordx4 v25, s[20:23], s53 offen offset:1024 lds
    s_add_u32 m0, s50, 112640
    s_nop 0
    buffer_load_dwordx4 v26, s[20:23], s53 offen lds
    buffer_load_dwordx4 v27, s[20:23], s53 offen offset:1024 lds
    s_add_u32 m0, s50, 120832
    s_mul_i32 s53, s45, 172032
    s_add_u32 s53, s53, s48
    s_add_u32 s45, s45, 1
    s_cmp_eq_u32 s45, 7
    s_cselect_b32 s45, 0, s45
    buffer_load_dwordx4 v28, s[20:23], s53 offen lds
    buffer_load_dwordx4 v29, s[20:23], s53 offen offset:1024 lds
    s_lshl_b32 s40, s44, 7
    s_add_u32 s51, s40, s46
    s_add_u32 s52, s40, s47
    s_mul_i32 s53, s44, 172032
    s_add_u32 s53, s53, s48
    s_add_u32 m0, s50, 22528
    s_add_u32 s44, s44, 1
    s_cmp_eq_u32 s44, 7
    s_cselect_b32 s44, 0, s44
    buffer_load_dwordx4 v21, s[16:19], s51 offen lds
    s_waitcnt lgkmcnt(0)
    s_add_u32 s12, s10, 0x5a3c9671
    s_xor_b32 s13, s11, 0x2b7e1516
    s_add_u32 s28, s28, s12
    s_mov_b32 s29, s13
    s_waitcnt vmcnt(10)
    s_barrier
    buffer_load_dwordx4 v22, s[16:19], s51 offen offset:1024 lds
    s_add_u32 m0, s49, 20480
    s_mov_b32 exec_hi, 0
    buffer_load_dwordx4 v23, s[16:19], s52 offen lds
    s_mov_b32 exec_hi, -1
    s_add_u32 m0, s50, 129024
    s_nop 0
    buffer_load_dwordx4 v24, s[20:23], s53 offen lds
    buffer_load_dwordx4 v25, s[20:23], s53 offen offset:1024 lds
    s_add_u32 m0, s50, 137216
    s_nop 0
    buffer_load_dwordx4 v26, s[20:23], s53 offen lds
    buffer_load_dwordx4 v27, s[20:23], s53 offen offset:1024 lds
    s_add_u32 m0, s50, 145408
    s_mul_i32 s53, s45, 172032
    s_add_u32 s53, s53, s48
    s_add_u32 s45, s45, 1
    s_cmp_eq_u32 s45, 7
    s_cselect_b32 s45, 0, s45
    buffer_load_dwordx4 v28, s[20:23], s53 offen lds
    buffer_load_dwordx4 v29, s[20:23], s53 offen offset:1024 lds
    s_lshl_b32 s40, s44, 7
    s_add_u32 s51, s40, s46
    s_add_u32 s52, s40, s47
    s_mul_i32 s53, s44, 172032
    s_add_u32 s53, s53, s48
    s_add_u32 m0, s50, 32768
    s_add_u32 s44, s44, 1
    s_cmp_eq_u32 s44, 7
    s_cselect_b32 s44, 0, s44
    buffer_load_dwordx4 v21, s[16:19], s51 offen lds
    buffer_load_dwordx4 v22, s[16:19], s51 offen offset:1024 lds
    s_add_u32 m0, s49, 30720
    s_mov_b32 exec_hi, 0
    buffer_load_dwordx4 v23, s[16:19], s52 offen lds
    s_mov_b32 exec_hi, -1
    s_waitcnt vmcnt(12)
    s_barrier
    s_add_u32 m0, s50, 153600
    s_nop 0
    buffer_load_dwordx4 v24, s[20:23], s53 offen lds
    buffer_load_dwordx4 v25, s[20:23], s53 offen offset:1024 lds
    s_add_u32 m0, s50, 71680
    s_nop 0
    buffer_load_dwordx4 v26, s[20:23], s53 offen lds
    buffer_load_dwordx4 v27, s[20:23], s53 offen offset:1024 lds
    s_add_u32 m0, s50, 79872
    s_mul_i32 s53, s45, 172032
    s_add_u32 s53, s53, s48
    s_add_u32 s45, s45, 1
    s_cmp_eq_u32 s45, 7
    s_cselect_b32 s45, 0, s45
    buffer_load_dwordx4 v28, s[20:23], s53 offen lds
    buffer_load_dwordx4 v29, s[20:23], s53 offen offset:1024 lds
    s_lshl_b32 s40, s44, 7
    s_add_u32 s51, s40, s46
    s_add_u32 s52, s40, s47
    s_mul_i32 s53, s44, 172032
    s_add_u32 s53, s53, s48
    s_add_u32 m0, s50, 43008
    s_add_u32 s44, s44, 1
    s_cmp_eq_u32 s44, 7
    s_cselect_b32 s44, 0, s44
    buffer_load_dwordx4 v21, s[16:19], s51 offen lds
    buffer_load_dwordx4 v22, s[16:19], s51 offen offset:1024 lds
    s_add_u32 m0, s49, 40960
    s_mov_b32 exec_hi, 0
    buffer_load_dwordx4 v23, s[16:19], s52 offen lds
    s_mov_b32 exec_hi, -1
    s_waitcnt vmcnt(12)
    s_barrier
    s_add_u32 m0, s50, 88064
    s_nop 0
    buffer_load_dwordx4 v24, s[20:23], s53 offen lds
    buffer_load_dwordx4 v25, s[20:23], s53 offen offset:1024 lds
    s_add_u32 m0, s50, 96256
    s_nop 0
    buffer_load_dwordx4 v26, s[20:23], s53 offen lds
    buffer_load_dwordx4 v27, s[20:23], s53 offen offset:1024 lds
    s_add_u32 m0, s50, 104448
    s_mul_i32 s53, s45, 172032
    s_add_u32 s53, s53, s48
    s_add_u32 s45, s45, 1
    s_cmp_eq_u32 s45, 7
    s_cselect_b32 s45, 0, s45
    buffer_load_dwordx4 v28, s[20:23], s53 offen lds
    buffer_load_dwordx4 v29, s[20:23], s53 offen offset:1024 lds
    s_lshl_b32 s40, s44, 7
    s_add_u32 s51, s40, s46
    s_add_u32 s52, s40, s47
    s_mul_i32 s53, s44, 172032
    s_add_u32 s53, s53, s48
    s_add_u32 m0, s50, 53248
    s_add_u32 s44, s44, 1
    s_cmp_eq_u32 s44, 7
    s_cselect_b32 s44, 0, s44
    buffer_load_dwordx4 v21, s[16:19], s51 offen lds
    buffer_load_dwordx4 v22, s[16:19], s51 offen offset:1024 lds
    s_add_u32 m0, s49, 51200
    s_mov_b32 exec_hi, 0
    buffer_load_dwordx4 v23, s[16:19], s52 offen lds
    s_mov_b32 exec_hi, -1
    s_waitcnt vmcnt(12)
    s_barrier
    s_add_u32 m0, s50, 112640
    s_nop 0
    buffer_load_dwordx4 v24, s[20:23], s53 offen lds
    buffer_load_dwordx4 v25, s[20:23], s53 offen offset:1024 lds
    s_add_u32 m0, s50, 120832
    s_nop 0
    buffer_load_dwordx4 v26, s[20:23], s53 offen lds
    buffer_load_dwordx4 v27, s[20:23], s53 offen offset:1024 lds
    buffer_load_dwordx2 v[18:19], v20, s[36:39], s30 offen sc1
    s_lshl_b32 s40, s44, 7
    s_add_u32 s51, s40, s46
    s_add_u32 s52, s40, s47
    s_mul_i32 s53, s44, 172032
    s_add_u32 s53, s53, s48
    s_add_u32 m0, s50, 63488
    s_add_u32 s44, s44, 1
    s_cmp_eq_u32 s44, 7
    s_cselect_b32 s44, 0, s44
    buffer_load_dwordx4 v21, s[16:19], s51 offen lds
    buffer_load_dwordx4 v22, s[16:19], s51 offen offset:1024 lds
    s_add_u32 m0, s49, 61440
    s_mov_b32 exec_hi, 0
    buffer_load_dwordx4 v23, s[16:19], s52 offen lds
    s_mov_b32 exec_hi, -1
    s_add_u32 m0, s50, 129024
    s_nop 0
    buffer_load_dwordx4 v24, s[20:23], s53 offen lds
    s_waitcnt vmcnt(12)
    s_barrier
    buffer_load_dwordx4 v25, s[20:23], s53 offen offset:1024 lds
    s_add_u32 m0, s50, 137216
    s_nop 0
    buffer_load_dwordx4 v26, s[20:23], s53 offen lds
    buffer_load_dwordx4 v27, s[20:23], s53 offen offset:1024 lds
    s_add_u32 m0, s50, 145408
    s_mul_i32 s53, s45, 172032
    s_add_u32 s53, s53, s48
    s_add_u32 s45, s45, 1
    s_cmp_eq_u32 s45, 7
    s_cselect_b32 s45, 0, s45
    buffer_load_dwordx4 v28, s[20:23], s53 offen lds
    buffer_load_dwordx4 v29, s[20:23], s53 offen offset:1024 lds
    s_add_u32 m0, s50, 153600
    s_mul_i32 s53, s45, 172032
    s_add_u32 s53, s53, s48
    s_add_u32 s45, s45, 1
    s_cmp_eq_u32 s45, 7
    s_cselect_b32 s45, 0, s45
    buffer_load_dwordx4 v28, s[20:23], s53 offen lds
    s_waitcnt vmcnt(11)
    s_barrier
    buffer_load_dwordx4 v29, s[20:23], s53 offen offset:1024 lds
    s_lshl_b32 s40, s54, 13
    s_add_u32 s40, s40, s50
    s_add_u32 m0, s40, 71680
    s_mul_i32 s40, s54, 57344
    s_add_u32 s40, s40, s55
    s_add_u32 s54, s54, 1
    s_cmp_eq_u32 s54, 5
    s_cselect_b32 s54, 0, s54
    buffer_load_dwordx4 v10, s[24:27], s40 offen lds
    buffer_load_dwordx4 v11, s[24:27], s40 offen offset:1024 lds
    s_waitcnt vmcnt(8)
    s_barrier
    s_lshl_b32 s40, s54, 13
    s_add_u32 s40, s40, s50
    s_add_u32 m0, s40, 71680
    s_mul_i32 s40, s54, 57344
    s_add_u32 s40, s40, s55
    s_add_u32 s54, s54, 1
    s_cmp_eq_u32 s54, 5
    s_cselect_b32 s54, 0, s54
    buffer_load_dwordx4 v10, s[24:27], s40 offen lds
    buffer_load_dwordx4 v11, s[24:27], s40 offen offset:1024 lds
    s_waitcnt vmcnt(8)
    s_barrier
    s_mov_b32 s101, 1

    v_cmp_ne_u32 vcc, s28, v18
    v_cmp_ne_u32 s[42:43], s29, v19
    s_nop 0
    s_or_b64 vcc, vcc, s[42:43]
    s_cbranch_vccnz X_cH
        X_okH:

    v_add_u32 v2, s101, v14
    ds_write_b32 v5, v2 offset:4
    s_setprio 0
    s_lshl_b32 s40, s54, 13
    s_add_u32 s40, s40, s50
    s_add_u32 m0, s40, 71680
    s_mul_i32 s40, s54, 57344
    s_add_u32 s40, s40, s55
    s_add_u32 s54, s54, 1
    s_cmp_eq_u32 s54, 5
    s_cselect_b32 s54, 0, s54
    buffer_load_dwordx4 v10, s[24:27], s40 offen lds
    buffer_load_dwordx4 v11, s[24:27], s40 offen offset:1024 lds
    buffer_load_dword v13, v12, s[36:39], 0 offen sc1
    s_lshl_b32 s40, s54, 13
    s_add_u32 s40, s40, s50
    s_add_u32 m0, s40, 71680
    s_mul_i32 s40, s54, 57344
    s_add_u32 s40, s40, s55
    s_add_u32 s54, s54, 1
    s_cmp_eq_u32 s54, 5
    s_cselect_b32 s54, 0, s54
    buffer_load_dwordx4 v10, s[24:27], s40 offen lds
    buffer_load_dwordx4 v11, s[24:27], s40 offen offset:1024 lds
    s_lshl_b32 s40, s54, 13
    s_add_u32 s40, s40, s50
    s_add_u32 m0, s40, 71680
    s_mul_i32 s40, s54, 57344
    s_add_u32 s40, s40, s55
    s_add_u32 s54, s54, 1
    s_cmp_eq_u32 s54, 5
    s_cselect_b32 s54, 0, s54
    buffer_load_dwordx4 v10, s[24:27], s40 offen lds
    buffer_load_dwordx4 v11, s[24:27], s40 offen offset:1024 lds
    s_waitcnt vmcnt(11)
    s_mov_b64 exec, 1
    ds_add_u32 v5, v14 offset:32
    s_mov_b64 exec, -1
    s_mov_b32 s9, 0
    s_setprio 0
        H_il:

    ds_read_b64 v[62:63], v58 offset:16
    ds_read_b128 v[30:33], v56
    ds_read_b128 v[34:37], v57
    s_add_u32 s9, s9, 1
    s_cmp_gt_u32 s9, 1600000
    s_cbranch_scc1 H_id
    s_waitcnt lgkmcnt(2)
    v_and_b32 v62, v62, v63
    v_cmp_eq_u32 vcc, 0, v62
    s_waitcnt lgkmcnt(0)
    s_cbranch_vccnz H_il
        H_id:
    s_waitcnt lgkmcnt(0)

    v_fma_f32 v30, v34, v61, v30
    v_fma_f32 v31, v35, v61, v31
    v_fma_f32 v32, v36, v61, v32
    v_fma_f32 v33, v37, v61, v33
    v_mul_f32 v30, s31, v30
    v_mul_f32 v31, s31, v31
    v_mul_f32 v32, s31, v32
    v_mul_f32 v33, s31, v33
    v_max_f32 v62, v30, v31
    v_max_f32 v63, v32, v33
    v_mov_b32 v64, v62
    v_mov_b32 v65, v63
    s_nop 0
    v_permlane16_swap_b32 v62, v64
    v_permlane16_swap_b32 v63, v65
    v_max_f32 v62, v62, v64
    v_max_f32 v63, v63, v65
    v_mov_b32 v64, v62
    v_mov_b32 v65, v63
    s_nop 0
    v_permlane32_swap_b32 v62, v64
    v_permlane32_swap_b32 v63, v65
    v_max_f32 v62, v62, v64
    v_max_f32 v63, v63, v65
    v_sub_f32 v30, v30, v62
    v_sub_f32 v31, v31, v62
    v_sub_f32 v32, v32, v63
    v_sub_f32 v33, v33, v63
    v_exp_f32 v30, v30
    v_exp_f32 v31, v31
    v_exp_f32 v32, v32
    v_exp_f32 v33, v33
    v_add_f32 v62, v30, v31
    v_add_f32 v63, v32, v33
    v_mov_b32 v64, v62
    v_mov_b32 v65, v63
    s_nop 0
    v_permlane16_swap_b32 v62, v64
    v_permlane16_swap_b32 v63, v65
    v_add_f32 v62, v62, v64
    v_add_f32 v63, v63, v65
    v_mov_b32 v64, v62
    v_mov_b32 v65, v63
    s_nop 0
    v_permlane32_swap_b32 v62, v64
    v_permlane32_swap_b32 v63, v65
    v_add_f32 v62, v62, v64
    v_add_f32 v63, v63, v65
    v_rcp_f32 v62, v62
    v_rcp_f32 v63, v63
    v_mul_f32 v30, v30, v62
    v_mul_f32 v31, v31, v62
    v_mul_f32 v32, v32, v63
    v_mul_f32 v33, v33, v63
    v_cvt_pk_bf16_f32 v30, v30, v30
    v_cvt_pk_bf16_f32 v31, v31, v31
    v_cvt_pk_bf16_f32 v32, v32, v32
    v_cvt_pk_bf16_f32 v33, v33, v33
    v_and_b32 v38, v52, v30
    v_and_b32 v39, v53, v31
    v_and_b32 v40, v54, v30
    v_and_b32 v41, v55, v31
    ds_write_b128 v59, v[38:41] offset:12288
    v_and_b32 v42, v52, v32
    v_and_b32 v43, v53, v33
    v_and_b32 v44, v54, v32
    v_and_b32 v45, v55, v33
    ds_write_b128 v59, v[42:45] offset:13312
    ds_write_b32 v60, v5 offset:40
    s_setprio 0
    s_waitcnt vmcnt(0)
    s_mov_b64 exec, 1
    ds_add_u32 v5, v14 offset:12
    s_mov_b64 exec, -1
    s_mov_b32 s9, 0
        W_lR:
    ds_read_b32 v2, v5 offset:80
    s_add_u32 s9, s9, 1
    s_cmp_gt_u32 s9, 1600000
    s_cbranch_scc1 W_dR
    s_waitcnt lgkmcnt(0)
    v_cmp_gt_u32 vcc, 4, v2

    s_nop 0
    s_cbranch_vccnz W_lR
W_dR:
    s_add_u32 m0, s50, 112640
    s_add_u32 s40, s55, 286720
    buffer_load_dwordx4 v10, s[24:27], s40 offen lds
    buffer_load_dwordx4 v11, s[24:27], s40 offen offset:1024 lds
    s_add_u32 m0, s50, 120832
    s_add_u32 s40, s55, 344064
    buffer_load_dwordx4 v10, s[24:27], s40 offen lds
    buffer_load_dwordx4 v11, s[24:27], s40 offen offset:1024 lds
    s_waitcnt vmcnt(0)
    s_mov_b64 exec, 1
    ds_add_u32 v5, v14 offset:36
    s_endpgm
K_spare2:
    buffer_load_dwordx4 v7, s[28:31], s53 offen nt lds
    s_add_u32 m0, m0, 1024
    s_mov_b32 s26, 401408
    s_mov_b32 s27, 0x00020000
    s_mov_b32 s34, 3670016
    s_mov_b32 s35, 0x00020000
    v_and_b32 v6, 15, v0
    v_lshlrev_b32 v6, 4, v6
    v_bfe_u32 v4, v0, 4, 2
    v_lshl_add_u32 v4, v4, 9, s42
    v_add_u32 v10, v4, v6
    v_sub_u32 v11, v4, v6
    v_add_u32 v11, 432, v11
    v_mov_b32 v12, 0
    s_and_b32 s55, s3, 3
    s_lshr_b32 s56, s3, 2
    v_and_b32 v1, 63, v0
    v_lshrrev_b32 v2, 4, v1
    v_and_b32 v3, 15, v1
    s_lshl_b32 s61, s55, 3
    v_lshrrev_b32 v4, 1, v3
    v_and_b32 v4, 4, v4
    v_and_or_b32 v4, v3, 3, v4
    v_add_u32 v4, s61, v4
    v_bfe_u32 v5, v3, 2, 1
    v_cvt_f32_u32 v97, v5
    v_mul_f32 v97, 0x3e800000, v97
    v_lshl_add_u32 v5, v4, 1, v5
    v_cmp_eq_u32 vcc, 1, v5
    s_nop 1
    v_cndmask_b32 v4, v4, 32, vcc
    v_cndmask_b32 v97, v97, 0, vcc
    v_cvt_f32_u32 v96, v4
    v_mul_f32 v96, 0x3c800000, v96
    v_lshlrev_b32 v4, 3, v2
    v_cvt_f32_u32 v4, v4
    v_fma_f32 v97, v96, v4, v97
    v_cos_f32 v118, v96
    s_nop 0
    v_add_f32 v118, v118, v118
    v_fmamk_f32 v102, v96, 0x0, v97
    v_fmamk_f32 v103, v96, 0x3f800000, v97
    v_fmamk_f32 v110, v96, 0x42000000, v97
    v_fmamk_f32 v111, v96, 0x42040000, v97
    v_cos_f32 v102, v102
    v_cos_f32 v103, v103
    v_cos_f32 v110, v110
    v_cos_f32 v111, v111
    v_fma_f32 v104, v118, v103, -v102
    v_fma_f32 v112, v118, v111, -v110
    v_fma_f32 v105, v118, v104, -v103
    v_fma_f32 v113, v118, v112, -v111
    v_fma_f32 v106, v118, v105, -v104
    v_fma_f32 v114, v118, v113, -v112
    v_fma_f32 v107, v118, v106, -v105
    v_fma_f32 v115, v118, v114, -v113
    v_fma_f32 v108, v118, v107, -v106
    v_fma_f32 v116, v118, v115, -v114
    v_fma_f32 v109, v118, v108, -v107
    v_fma_f32 v117, v118, v116, -v115
    v_cvt_pk_bf16_f32 v20, v102, v103
    v_cvt_pk_bf16_f32 v21, v104, v105
    v_cvt_pk_bf16_f32 v22, v106, v107
    v_cvt_pk_bf16_f32 v23, v108, v109
    v_cvt_pk_bf16_f32 v24, v110, v111
    v_cvt_pk_bf16_f32 v25, v112, v113
    v_cvt_pk_bf16_f32 v26, v114, v115
    v_cvt_pk_bf16_f32 v27, v116, v117
    v_lshrrev_b32 v4, 4, v0
    v_and_b32 v5, 3, v4
    v_lshlrev_b32 v5, 6, v5
    v_lshlrev_b32 v13, 1, v6
    v_xor_b32 v13, v13, v5
    v_bfe_u32 v5, v4, 3, 1
    v_lshl_add_u32 v13, v5, 4, v13
    v_lshl_add_u32 v13, v4, 9, v13
    v_add_u32 v13, 65536, v13
    v_xor_b32 v14, 16, v13
    v_lshrrev_b32 v4, 2, v3
    v_lshl_add_u32 v5, v2, 3, v4
    v_lshlrev_b32 v5, 9, v5
    v_lshl_add_u32 v5, v4, 6, v5
    v_and_b32 v4, 1, v1
    v_lshl_add_u32 v5, v4, 5, v5
    v_bfe_u32 v4, v1, 1, 1
    v_lshl_add_u32 v5, v4, 3, v5
    v_and_b32 v4, 1, v2
    v_xor_b32 v4, s56, v4
    v_lshl_add_u32 v16, v4, 4, v5
    v_add_u32 v16, 65536, v16
    v_xor_b32 v17, 64, v16
    v_xor_b32 v18, 128, v16
    v_xor_b32 v19, 192, v16
    v_and_b32 v15, 32, v1
    v_lshrrev_b32 v4, 2, v3
    v_add_lshl_u32 v15, v15, v4, 12
    v_and_b32 v4, 16, v1
    v_lshl_add_u32 v15, v4, 2, v15
    v_and_b32 v4, 3, v3
    v_lshl_add_u32 v15, v4, 4, v15
    v_and_b32 v4, 7, v3
    v_lshlrev_b32 v86, 16, v4
    v_mov_b32 v5, 0xffff0000
    v_add_u32 v87, s56, v3
    v_cmp_eq_u32 vcc, 0, v87
    s_nop 1
    v_cndmask_b32 v87, v5, 0, vcc
    v_add_u32 v4, 256, v11
    buffer_load_dwordx4 v7, s[28:31], s54 offen nt lds
    s_add_u32 m0, m0, 1024
    v_cmp_eq_u32 vcc, 15, v3
    s_nop 1
    v_cndmask_b32 v11, v11, v4, vcc
    s_lshl_b32 s50, s8, 3
    s_add_u32 s50, s50, s3
    s_mul_i32 s50, s50, 1568
    s_and_b32 s50, s50, 0xffffff80
    v_min_u32 v95, 12, v1
    v_lshlrev_b32 v95, 7, v95
    s_lshl_b32 s59, s55, 18
    s_lshl_b32 s61, s56, 14
    s_add_u32 s59, s59, s61
    s_lshl_b32 s61, s8, 7
    s_add_u32 s59, s59, s61
    s_add_u32 s59, s59, 1048576
    v_lshlrev_b32 v63, 4, v1
    v_and_b32 v4, 32, v1
    v_xor_b32 v60, v63, v4
    s_lshl_b32 s60, s8, 3
    s_add_u32 s60, s60, s3
    s_lshl_b32 s60, s60, 12
    s_add_u32 s60, s60, 1048576
    s_add_u32 s63, s8, 1024
    s_cmp_eq_u32 s8, 0
    s_cselect_b32 s63, 32, s63
    v_lshl_add_u32 v4, v3, 6, s8
    v_cvt_f32_u32 v96, v4
    v_mul_f32 v96, 0x3a000000, v96
    v_lshlrev_b32 v4, 2, v2
    v_cvt_f32_u32 v4, v4
    v_mul_f32 v97, v96, v4
    v_cos_f32 v118, v96
    s_nop 0
    v_add_f32 v118, v118, v118
    v_fmamk_f32 v102, v96, 0x0, v97
    v_fmamk_f32 v103, v96, 0x3f800000, v97
    v_fmamk_f32 v106, v96, 0x0, v97
    v_fmamk_f32 v107, v96, 0x3f800000, v97
    v_fmamk_f32 v110, v96, 0x41800000, v97
    v_fmamk_f32 v111, v96, 0x41880000, v97
    v_fmamk_f32 v114, v96, 0x41800000, v97
    v_fmamk_f32 v115, v96, 0x41880000, v97
    v_cos_f32 v102, v102
    v_cos_f32 v103, v103
    v_sin_f32 v106, v106
    buffer_load_dwordx4 v8, s[28:31], s52 offen nt lds
    s_add_u32 m0, m0, 1024
    v_sin_f32 v107, v107
    v_cos_f32 v110, v110
    v_cos_f32 v111, v111
    v_sin_f32 v114, v114
    v_sin_f32 v115, v115
    v_fma_f32 v104, v118, v103, -v102
    v_fma_f32 v108, v118, v107, -v106
    v_fma_f32 v112, v118, v111, -v110
    v_fma_f32 v116, v118, v115, -v114
    v_fma_f32 v105, v118, v104, -v103
    v_fma_f32 v109, v118, v108, -v107
    v_fma_f32 v113, v118, v112, -v111
    v_fma_f32 v117, v118, v116, -v115
    s_cmp_eq_u32 s8, 0
    s_cbranch_scc1 S_cls0
    v_cvt_pk_bf16_f32 v28, v102, v106
    v_cvt_pk_bf16_f32 v36, -v106, v102
    v_mov_b32 v44, v28
    v_mov_b32 v52, v36
    v_cvt_pk_bf16_f32 v29, v103, v107
    v_cvt_pk_bf16_f32 v37, -v107, v103
    v_xor_b32 v45, 0x80008000, v29
    v_xor_b32 v53, 0x80008000, v37
    v_cvt_pk_bf16_f32 v30, v104, v108
    v_cvt_pk_bf16_f32 v38, -v108, v104
    v_mov_b32 v46, v30
    v_mov_b32 v54, v38
    v_cvt_pk_bf16_f32 v31, v105, v109
    v_cvt_pk_bf16_f32 v39, -v109, v105
    v_xor_b32 v47, 0x80008000, v31
    v_xor_b32 v55, 0x80008000, v39
    v_cvt_pk_bf16_f32 v32, v110, v114
    v_cvt_pk_bf16_f32 v40, -v114, v110
    v_mov_b32 v48, v32
    v_mov_b32 v56, v40
    v_cvt_pk_bf16_f32 v33, v111, v115
    v_cvt_pk_bf16_f32 v41, -v115, v111
    v_xor_b32 v49, 0x80008000, v33
    v_xor_b32 v57, 0x80008000, v41
    v_cvt_pk_bf16_f32 v34, v112, v116
    v_cvt_pk_bf16_f32 v42, -v116, v112
    v_mov_b32 v50, v34
    v_mov_b32 v58, v42
    v_cvt_pk_bf16_f32 v35, v113, v117
    v_cvt_pk_bf16_f32 v43, -v117, v113
    v_xor_b32 v51, 0x80008000, v35
    v_xor_b32 v59, 0x80008000, v43
S_reg:
    s_lshl_b32 s61, s55, 14
    s_add_u32 s61, s61, 98304
    v_add_u32 v67, s61, v63
    v_cmp_eq_u32 s[42:43], 0, v2
    s_nop 1
    v_cndmask_b32 v98, 1.0, 0.5, s[42:43]
    v_and_b32 v4, 1, v2
    v_mov_b32 v5, 0xffff
    v_cmp_eq_u32 s[42:43], 1, v4
    s_nop 1
    v_cndmask_b32 v101, -1, v5, s[42:43]
    v_cndmask_b32 v96, 1.0, 0, s[42:43]
    v_cmp_eq_u32 s[42:43], 1, v2
    s_nop 1
    v_cndmask_b32 v97, v96, 0.5, s[42:43]
    s_cmp_eq_u32 s56, 0
    s_cselect_b64 s[42:43], -1, 0
    v_cndmask_b32 v99, v96, v97, s[42:43]
    v_cndmask_b32 v100, v97, v96, s[42:43]
    v_lshlrev_b32 v4, 6, v4
    v_and_b32 v5, 2, v2
    v_add_u32 v4, v4, v5
    v_cvt_f32_u32 v97, v4
    s_lshl_b32 s61, s55, 5
    s_add_u32 s61, s61, s56
    v_lshl_add_u32 v4, v3, 1, s61
    v_cvt_f32_u32 v96, v4
    v_mul_f32 v96, 0x3b124925, v96
    v_mul_f32 v97, v96, v97
    s_lshl_b32 s61, s56, 13
    v_add_u32 v5, s61, v67
    v_mul_f32 v118, 0x40800000, v96
    v_cos_f32 v118, v118
    s_nop 0
    v_add_f32 v118, v118, v118
    v_fmamk_f32 v102, v96, 0x0, v97
    v_fmamk_f32 v103, v96, 0x40800000, v97
    buffer_load_dwordx4 v8, s[28:31], 0 offen nt lds
    s_add_u32 m0, m0, 1024
    v_cos_f32 v102, v102
    v_cos_f32 v103, v103
    s_nop 0
    v_fma_f32 v104, v118, v103, -v102
    v_fma_f32 v105, v118, v104, -v103
    v_fma_f32 v106, v118, v105, -v104
    v_fma_f32 v107, v118, v106, -v105
    v_fma_f32 v108, v118, v107, -v106
    v_fma_f32 v109, v118, v108, -v107
    v_fma_f32 v110, v118, v109, -v108
    v_fma_f32 v111, v118, v110, -v109
    s_waitcnt lgkmcnt(0)
    s_add_u32 s12, s10, 0x5a3c9671
    s_xor_b32 s13, s11, 0x2b7e1516
    s_lshl_b32 s51, s12, 12
    s_xor_b32 s51, s51, s13
    s_and_b32 s51, s51, 0xbfff0000
    v_xor_b32 v86, s51, v86

    v_mov_b32 v92, s12
    v_mov_b32 v93, s13
    s_waitcnt vmcnt(4)
    ds_read_b128 v[120:123], v10 offset:0
    ds_read_b128 v[124:127], v11 offset:2112
    ds_read_b128 v[132:135], v10 offset:2112
    ds_read_b128 v[128:131], v11 offset:0
    s_waitcnt lgkmcnt(2)
    v_mov_b32 v136, v120
    v_lshlrev_b32 v140, 16, v121
    v_lshlrev_b32 v154, 16, v127
    v_and_b32 v141, 0xffff0000, v121
    v_and_b32 v155, 0xffff0000, v126
    v_pk_add_f32 v[140:141], v[140:141], v[154:155]
    v_mov_b32_dpp v136, v124 row_shr:1 row_mask:0xf bank_mask:0xf
    v_lshlrev_b32 v142, 16, v122
    v_lshlrev_b32 v154, 16, v126
    v_and_b32 v143, 0xffff0000, v122
    v_and_b32 v155, 0xffff0000, v125
    v_pk_add_f32 v[142:143], v[142:143], v[154:155]
    v_lshlrev_b32 v144, 16, v123
    v_lshlrev_b32 v154, 16, v125
    v_and_b32 v145, 0xffff0000, v123
    v_and_b32 v155, 0xffff0000, v124
    v_pk_add_f32 v[144:145], v[144:145], v[154:155]
    v_lshlrev_b32 v138, 16, v120
    v_lshlrev_b32 v154, 16, v136
    v_and_b32 v139, 0xffff0000, v120
    v_and_b32 v155, 0xffff0000, v127
    v_pk_add_f32 v[138:139], v[138:139], v[154:155]
    s_waitcnt lgkmcnt(0)
    v_lshlrev_b32 v148, 16, v133
    v_lshlrev_b32 v154, 16, v131
    v_and_b32 v149, 0xffff0000, v133
    v_and_b32 v155, 0xffff0000, v130
    v_pk_add_f32 v[148:149], v[148:149], v[154:155]
    v_mov_b32_dpp v137, v128 row_ror:1 row_mask:0xf bank_mask:0xf
    v_lshlrev_b32 v150, 16, v134
    v_lshlrev_b32 v154, 16, v130
    v_and_b32 v151, 0xffff0000, v134
    v_and_b32 v155, 0xffff0000, v129
    v_pk_add_f32 v[150:151], v[150:151], v[154:155]
    v_lshlrev_b32 v152, 16, v135
    v_lshlrev_b32 v154, 16, v129
    v_and_b32 v153, 0xffff0000, v135
    v_and_b32 v155, 0xffff0000, v128
    v_pk_add_f32 v[152:153], v[152:153], v[154:155]
    v_lshlrev_b32 v146, 16, v132
    v_lshlrev_b32 v154, 16, v137
    v_and_b32 v147, 0xffff0000, v132
    v_and_b32 v155, 0xffff0000, v131
    v_pk_add_f32 v[146:147], v[146:147], v[154:155]
    v_pk_add_f32 v[164:165], v[138:139], v[146:147]
    v_pk_add_f32 v[166:167], v[140:141], v[148:149]
    v_pk_add_f32 v[168:169], v[142:143], v[150:151]
    v_pk_add_f32 v[170:171], v[144:145], v[152:153]
    v_cvt_pk_bf16_f32 v156, v164, v166
    v_cvt_pk_bf16_f32 v157, v168, v170
    v_cvt_pk_bf16_f32 v158, v165, v167
    v_cvt_pk_bf16_f32 v159, v169, v171
    ds_write_b128 v13, v[156:159] offset:0
    v_pk_add_f32 v[164:165], v[138:139], v[146:147] neg_lo:[0,1] neg_hi:[0,1]
    v_pk_add_f32 v[166:167], v[140:141], v[148:149] neg_lo:[0,1] neg_hi:[0,1]
    v_pk_add_f32 v[168:169], v[142:143], v[150:151] neg_lo:[0,1] neg_hi:[0,1]
    v_pk_add_f32 v[170:171], v[144:145], v[152:153] neg_lo:[0,1] neg_hi:[0,1]
    v_cvt_pk_bf16_f32 v160, v164, v166
    v_cvt_pk_bf16_f32 v161, v168, v170
    v_cvt_pk_bf16_f32 v162, v165, v167
    v_cvt_pk_bf16_f32 v163, v169, v171
    ds_write_b128 v14, v[160:163] offset:0
    s_waitcnt lgkmcnt(0)
    s_barrier
    ds_read_b64_tr_b16 v[172:173], v16 offset:0
    ds_read_b64_tr_b16 v[174:175], v16 offset:2048
    ds_read_b64_tr_b16 v[176:177], v17 offset:0
    ds_read_b64_tr_b16 v[178:179], v17 offset:2048
    ds_read_b64_tr_b16 v[180:181], v18 offset:0
    ds_read_b64_tr_b16 v[182:183], v18 offset:2048
    ds_read_b64_tr_b16 v[184:185], v19 offset:0
    ds_read_b64_tr_b16 v[186:187], v19 offset:2048
    s_waitcnt lgkmcnt(6)
    v_mfma_f32_16x16x32_bf16 v[188:191], v[20:23], v[172:175], 0
    ds_read_b64_tr_b16 v[172:173], v16 offset:256
    ds_read_b64_tr_b16 v[174:175], v16 offset:2304
    s_waitcnt lgkmcnt(6)
    v_mfma_f32_16x16x32_bf16 v[192:195], v[20:23], v[176:179], 0
    ds_read_b64_tr_b16 v[176:177], v17 offset:256
    ds_read_b64_tr_b16 v[178:179], v17 offset:2304
    s_waitcnt lgkmcnt(6)
    v_mfma_f32_16x16x32_bf16 v[196:199], v[20:23], v[180:183], 0
    ds_read_b64_tr_b16 v[180:181], v18 offset:256
    ds_read_b64_tr_b16 v[182:183], v18 offset:2304
    s_waitcnt lgkmcnt(6)
    v_mfma_f32_16x16x32_bf16 v[200:203], v[20:23], v[184:187], 0
    ds_read_b64_tr_b16 v[184:185], v19 offset:256
    ds_read_b64_tr_b16 v[186:187], v19 offset:2304
    s_waitcnt lgkmcnt(6)
    v_mfma_f32_16x16x32_bf16 v[204:207], v[20:23], v[172:175], 0
    s_waitcnt lgkmcnt(4)
    v_mfma_f32_16x16x32_bf16 v[208:211], v[20:23], v[176:179], 0
    s_waitcnt lgkmcnt(2)
    v_mfma_f32_16x16x32_bf16 v[212:215], v[20:23], v[180:183], 0
    s_waitcnt lgkmcnt(0)
    v_mfma_f32_16x16x32_bf16 v[216:219], v[20:23], v[184:187], 0
    s_waitcnt vmcnt(0)
    buffer_load_dword v255, v95, s[24:27], s50 offen
    ds_read_b128 v[120:123], v10 offset:4096
    ds_read_b128 v[124:127], v11 offset:6208
    ds_read_b128 v[132:135], v10 offset:6208
    ds_read_b128 v[128:131], v11 offset:4096
    s_waitcnt lgkmcnt(2)
    v_mov_b32 v136, v120
    v_lshlrev_b32 v140, 16, v121
    v_lshlrev_b32 v154, 16, v127
    v_and_b32 v141, 0xffff0000, v121
    v_and_b32 v155, 0xffff0000, v126
    v_pk_add_f32 v[140:141], v[140:141], v[154:155]
    v_mov_b32_dpp v136, v124 row_shr:1 row_mask:0xf bank_mask:0xf
    v_lshlrev_b32 v142, 16, v122
    v_lshlrev_b32 v154, 16, v126
    v_and_b32 v143, 0xffff0000, v122
    v_and_b32 v155, 0xffff0000, v125
    v_pk_add_f32 v[142:143], v[142:143], v[154:155]
    v_lshlrev_b32 v144, 16, v123
    v_lshlrev_b32 v154, 16, v125
    v_and_b32 v145, 0xffff0000, v123
    v_and_b32 v155, 0xffff0000, v124
    v_pk_add_f32 v[144:145], v[144:145], v[154:155]
    v_lshlrev_b32 v138, 16, v120
    v_lshlrev_b32 v154, 16, v136
    v_and_b32 v139, 0xffff0000, v120
    v_and_b32 v155, 0xffff0000, v127
    v_pk_add_f32 v[138:139], v[138:139], v[154:155]
    s_waitcnt lgkmcnt(0)
    v_lshlrev_b32 v148, 16, v133
    v_lshlrev_b32 v154, 16, v131
    v_and_b32 v149, 0xffff0000, v133
    v_and_b32 v155, 0xffff0000, v130
    v_pk_add_f32 v[148:149], v[148:149], v[154:155]
    v_mov_b32_dpp v137, v128 row_ror:1 row_mask:0xf bank_mask:0xf
    v_lshlrev_b32 v150, 16, v134
    v_lshlrev_b32 v154, 16, v130
    v_and_b32 v151, 0xffff0000, v134
    v_and_b32 v155, 0xffff0000, v129
    v_pk_add_f32 v[150:151], v[150:151], v[154:155]
    v_lshlrev_b32 v152, 16, v135
    v_lshlrev_b32 v154, 16, v129
    v_and_b32 v153, 0xffff0000, v135
    v_and_b32 v155, 0xffff0000, v128
    v_pk_add_f32 v[152:153], v[152:153], v[154:155]
    v_lshlrev_b32 v146, 16, v132
    v_lshlrev_b32 v154, 16, v137
    v_and_b32 v147, 0xffff0000, v132
    v_and_b32 v155, 0xffff0000, v131
    v_pk_add_f32 v[146:147], v[146:147], v[154:155]
    v_pk_add_f32 v[164:165], v[138:139], v[146:147]
    v_pk_add_f32 v[166:167], v[140:141], v[148:149]
    v_pk_add_f32 v[168:169], v[142:143], v[150:151]
    v_pk_add_f32 v[170:171], v[144:145], v[152:153]
    v_cvt_pk_bf16_f32 v156, v164, v166
    v_cvt_pk_bf16_f32 v157, v168, v170
    v_cvt_pk_bf16_f32 v158, v165, v167
    v_cvt_pk_bf16_f32 v159, v169, v171
    ds_write_b128 v13, v[156:159] offset:16384
    v_pk_add_f32 v[164:165], v[138:139], v[146:147] neg_lo:[0,1] neg_hi:[0,1]
    v_pk_add_f32 v[166:167], v[140:141], v[148:149] neg_lo:[0,1] neg_hi:[0,1]
    v_pk_add_f32 v[168:169], v[142:143], v[150:151] neg_lo:[0,1] neg_hi:[0,1]
    v_pk_add_f32 v[170:171], v[144:145], v[152:153] neg_lo:[0,1] neg_hi:[0,1]
    v_cvt_pk_bf16_f32 v160, v164, v166
    v_cvt_pk_bf16_f32 v161, v168, v170
    v_cvt_pk_bf16_f32 v162, v165, v167
    v_cvt_pk_bf16_f32 v163, v169, v171
    ds_write_b128 v14, v[160:163] offset:16384
    s_cmp_lg_u32 s3, 0
    s_cbranch_scc1 S_nw
    s_lshl_b32 s40, s8, 7
    s_add_u32 s40, s40, 32768
    buffer_load_dword v255, v12, s[36:39], s40 offen
S_nw:
    s_waitcnt lgkmcnt(0)
    s_barrier
    ds_read_b64_tr_b16 v[172:173], v16 offset:16384
    ds_read_b64_tr_b16 v[174:175], v16 offset:18432
    ds_read_b64_tr_b16 v[176:177], v17 offset:16384
    ds_read_b64_tr_b16 v[178:179], v17 offset:18432
    ds_read_b64_tr_b16 v[180:181], v18 offset:16384
    ds_read_b64_tr_b16 v[182:183], v18 offset:18432
    ds_read_b64_tr_b16 v[184:185], v19 offset:16384
    ds_read_b64_tr_b16 v[186:187], v19 offset:18432
    s_waitcnt lgkmcnt(6)
    v_mfma_f32_16x16x32_bf16 v[188:191], v[24:27], v[172:175], v[188:191]
    ds_read_b64_tr_b16 v[172:173], v16 offset:16640
    ds_read_b64_tr_b16 v[174:175], v16 offset:18688
    s_waitcnt lgkmcnt(6)
    v_mfma_f32_16x16x32_bf16 v[192:195], v[24:27], v[176:179], v[192:195]
    ds_read_b64_tr_b16 v[176:177], v17 offset:16640
    ds_read_b64_tr_b16 v[178:179], v17 offset:18688
    s_waitcnt lgkmcnt(6)
    v_mfma_f32_16x16x32_bf16 v[196:199], v[24:27], v[180:183], v[196:199]
    ds_read_b64_tr_b16 v[180:181], v18 offset:16640
    ds_read_b64_tr_b16 v[182:183], v18 offset:18688
    s_waitcnt lgkmcnt(6)
    v_mfma_f32_16x16x32_bf16 v[200:203], v[24:27], v[184:187], v[200:203]
    ds_read_b64_tr_b16 v[184:185], v19 offset:16640
    ds_read_b64_tr_b16 v[186:187], v19 offset:18688
    s_waitcnt lgkmcnt(6)
    v_mfma_f32_16x16x32_bf16 v[204:207], v[24:27], v[172:175], v[204:207]
    s_waitcnt lgkmcnt(4)
    v_mfma_f32_16x16x32_bf16 v[208:211], v[24:27], v[176:179], v[208:211]
    s_waitcnt lgkmcnt(2)
    v_mfma_f32_16x16x32_bf16 v[212:215], v[24:27], v[180:183], v[212:215]
    s_waitcnt lgkmcnt(0)
    v_mfma_f32_16x16x32_bf16 v[216:219], v[24:27], v[184:187], v[216:219]
    v_cvt_pk_bf16_f32 v120, v188, v192
    v_cvt_pk_bf16_f32 v121, v196, v200
    s_nop 1
    v_cvt_pk_bf16_f32 v122, v204, v208
    s_nop 2
    v_cvt_pk_bf16_f32 v123, v212, v216
    v_bfi_b32 v123, v87, v86, v123
    s_add_u32 s41, s59, 0
    buffer_store_dwordx4 v[120:123], v15, s[36:39], s41 offen sc1
    v_cvt_pk_bf16_f32 v124, v189, v193
    v_cvt_pk_bf16_f32 v125, v197, v201
    v_cvt_pk_bf16_f32 v126, v205, v209
    v_cvt_pk_bf16_f32 v127, v213, v217
    v_bfi_b32 v127, v87, v86, v127
    s_add_u32 s41, s59, 32768
    buffer_store_dwordx4 v[124:127], v15, s[36:39], s41 offen sc1
    v_cvt_pk_bf16_f32 v128, v190, v194
    v_cvt_pk_bf16_f32 v129, v198, v202
    v_cvt_pk_bf16_f32 v130, v206, v210
    v_cvt_pk_bf16_f32 v131, v214, v218
    v_bfi_b32 v131, v87, v86, v131
    s_add_u32 s41, s59, 65536
    buffer_store_dwordx4 v[128:131], v15, s[36:39], s41 offen sc1
    v_cvt_pk_bf16_f32 v132, v191, v195
    v_cvt_pk_bf16_f32 v133, v199, v203
    v_cvt_pk_bf16_f32 v134, v207, v211
    v_cvt_pk_bf16_f32 v135, v215, v219
    v_bfi_b32 v135, v87, v86, v135
    s_add_u32 s41, s59, 98304
    buffer_store_dwordx4 v[132:135], v15, s[36:39], s41 offen sc1
    s_cmp_lg_u32 s3, 0
    s_cbranch_scc1 S_nh
    s_lshl_b32 s40, s8, 7
    s_add_u32 s40, s40, 32768
    s_mov_b64 exec, 1
    buffer_store_dwordx2 v[92:93], v12, s[36:39], s40 offen sc1
    s_mov_b64 exec, -1
            S_nh:

    s_barrier

    s_cmp_lg_u32 s3, 0
    s_cbranch_scc1 S_nf
    v_lshlrev_b32 v94, 2, v3
    v_add_u32 v94, 81920, v94
    ds_write_b32 v94, v12
        S_nf:

    s_lshl_b32 s40, s7, 3
    s_add_u32 s40, s40, s3
    s_mul_i32 s40, s40, 3584
    s_add_u32 s40, s40, 286720
    v_min_u32 v95, 27, v1
    v_lshlrev_b32 v95, 7, v95
    buffer_load_dword v255, v95, s[24:27], s40 offen

    v_fma_f32 v112, v118, v111, -v110
    v_fma_f32 v113, v118, v112, -v111
    v_fma_f32 v114, v118, v113, -v112
    v_fma_f32 v115, v118, v114, -v113
    v_fma_f32 v116, v118, v115, -v114
    v_fma_f32 v117, v118, v116, -v115
    v_mul_f32 v102, v102, v98
    v_mul_f32 v114, v114, v99
    v_cvt_pk_bf16_f32 v76, v102, v106
    v_cvt_pk_bf16_f32 v77, v110, v114
    v_cvt_pk_bf16_f32 v78, v103, v107
    v_cvt_pk_bf16_f32 v79, v111, v115
    v_and_b32 v79, v101, v79
    ds_write_b128 v5, v[76:79] offset:0
    v_cvt_pk_bf16_f32 v80, v104, v108
    v_cvt_pk_bf16_f32 v81, v112, v116
    v_cvt_pk_bf16_f32 v82, v105, v109
    v_cvt_pk_bf16_f32 v83, v113, v117
    v_and_b32 v81, v101, v81
    v_and_b32 v83, v101, v83
    ds_write_b128 v5, v[80:83] offset:1024
    v_fmamk_f32 v102, v96, 0x0, v97
    v_fmamk_f32 v103, v96, 0x40800000, v97
    v_sin_f32 v102, v102
    v_sin_f32 v103, v103
    s_nop 0
    v_fma_f32 v104, v118, v103, -v102
    v_fma_f32 v105, v118, v104, -v103
    v_fma_f32 v106, v118, v105, -v104
    v_fma_f32 v107, v118, v106, -v105
    v_fma_f32 v108, v118, v107, -v106
    v_fma_f32 v109, v118, v108, -v107
    v_fma_f32 v110, v118, v109, -v108
    v_fma_f32 v111, v118, v110, -v109
    v_fma_f32 v112, v118, v111, -v110
    v_fma_f32 v113, v118, v112, -v111
    v_fma_f32 v114, v118, v113, -v112
    v_fma_f32 v115, v118, v114, -v113
    v_fma_f32 v116, v118, v115, -v114
    v_fma_f32 v117, v118, v116, -v115
    v_mul_f32 v114, v114, v100
    v_cvt_pk_bf16_f32 v76, v102, v106
    v_cvt_pk_bf16_f32 v77, v110, v114
    v_cvt_pk_bf16_f32 v78, v103, v107
    v_cvt_pk_bf16_f32 v79, v111, v115
    v_and_b32 v79, v101, v79
    ds_write_b128 v5, v[76:79] offset:4096
    v_cvt_pk_bf16_f32 v80, v104, v108
    v_cvt_pk_bf16_f32 v81, v112, v116
    v_cvt_pk_bf16_f32 v82, v105, v109
    v_cvt_pk_bf16_f32 v83, v113, v117
    v_and_b32 v81, v101, v81
    v_and_b32 v83, v101, v83
    ds_write_b128 v5, v[80:83] offset:5120
    v_fmamk_f32 v102, v96, 0x3f800000, v97
    v_fmamk_f32 v103, v96, 0x40a00000, v97
    v_cos_f32 v102, v102
    v_cos_f32 v103, v103
    s_nop 0
    v_fma_f32 v104, v118, v103, -v102
    v_fma_f32 v105, v118, v104, -v103
    v_fma_f32 v106, v118, v105, -v104
    v_fma_f32 v107, v118, v106, -v105
    v_fma_f32 v108, v118, v107, -v106
    v_fma_f32 v109, v118, v108, -v107
    v_fma_f32 v110, v118, v109, -v108
    v_fma_f32 v111, v118, v110, -v109
    v_fma_f32 v112, v118, v111, -v110
    v_fma_f32 v113, v118, v112, -v111
    v_fma_f32 v114, v118, v113, -v112
    v_fma_f32 v115, v118, v114, -v113
    v_fma_f32 v116, v118, v115, -v114
    v_fma_f32 v117, v118, v116, -v115
    v_cvt_pk_bf16_f32 v76, v102, v106
    v_cvt_pk_bf16_f32 v77, v110, v114
    v_cvt_pk_bf16_f32 v78, v103, v107
    v_cvt_pk_bf16_f32 v79, v111, v115
    v_and_b32 v77, v101, v77
    v_and_b32 v79, v101, v79
    ds_write_b128 v5, v[76:79] offset:2048
    v_cvt_pk_bf16_f32 v80, v104, v108
    v_cvt_pk_bf16_f32 v81, v112, v116
    v_cvt_pk_bf16_f32 v82, v105, v109
    v_cvt_pk_bf16_f32 v83, v113, v117
    v_and_b32 v81, v101, v81
    v_and_b32 v83, v101, v83
    ds_write_b128 v5, v[80:83] offset:3072
    v_fmamk_f32 v102, v96, 0x3f800000, v97
    v_fmamk_f32 v103, v96, 0x40a00000, v97
    v_sin_f32 v102, v102
    v_sin_f32 v103, v103
    s_nop 0
    v_fma_f32 v104, v118, v103, -v102
    v_fma_f32 v105, v118, v104, -v103
    v_fma_f32 v106, v118, v105, -v104
    v_and_b32 v94, 31, v1
    v_lshlrev_b32 v94, 7, v94
    s_mov_b32 s50, 32768
    s_cmp_lg_u32 s3, 1
    s_cbranch_scc1 S_p0
    buffer_load_dword v20, v94, s[36:39], s50 offen sc1
        S_p0:

    v_fma_f32 v107, v118, v106, -v105
    v_fma_f32 v108, v118, v107, -v106
    v_fma_f32 v109, v118, v108, -v107
    v_fma_f32 v110, v118, v109, -v108
    v_fma_f32 v111, v118, v110, -v109
    v_fma_f32 v112, v118, v111, -v110
    v_fma_f32 v113, v118, v112, -v111
    v_fma_f32 v114, v118, v113, -v112
    v_fma_f32 v115, v118, v114, -v113
    v_fma_f32 v116, v118, v115, -v114
    v_fma_f32 v117, v118, v116, -v115
    v_cvt_pk_bf16_f32 v76, v102, v106
    v_cvt_pk_bf16_f32 v77, v110, v114
    v_cvt_pk_bf16_f32 v78, v103, v107
    v_cvt_pk_bf16_f32 v79, v111, v115
    v_and_b32 v77, v101, v77
    v_and_b32 v79, v101, v79
    ds_write_b128 v5, v[76:79] offset:6144
    v_cvt_pk_bf16_f32 v80, v104, v108
    v_cvt_pk_bf16_f32 v81, v112, v116
    v_cvt_pk_bf16_f32 v82, v105, v109
    v_cvt_pk_bf16_f32 v83, v113, v117
    v_and_b32 v81, v101, v81
    v_and_b32 v83, v101, v83
    ds_write_b128 v5, v[80:83] offset:7168
    v_bfe_u32 v88, v60, 4, 2
    v_mov_b32 v5, 0xffff0000
    v_add_u32 v4, s3, v88
    v_cmp_eq_u32 s[42:43], 0, v4
    s_nop 1
    v_cndmask_b32 v90, v5, 0, s[42:43]
    s_and_b32 s61, s3, 1
    s_lshl_b32 s61, s61, 2
    v_add_lshl_u32 v88, v88, s61, 16
    v_lshrrev_b32 v4, 2, v3
    v_lshl_add_u32 v4, v2, 3, v4
    v_lshlrev_b32 v4, 6, v4
    v_and_b32 v5, 3, v1
    v_lshl_add_u32 v4, v5, 3, v4
    v_and_b32 v5, 16, v1
    v_lshl_add_u32 v4, v5, 1, v4
    s_lshl_b32 s61, s3, 12
    s_cmp_lg_u32 s3, 1
    s_cbranch_scc1 P_dB
    s_mov_b32 s9, 0
P_lB:
    buffer_load_dword v21, v94, s[36:39], s50 offen sc1
    s_waitcnt vmcnt(1)
    v_cmp_ne_u32 vcc, s12, v20
    s_nop 0
    s_cbranch_vccz P_dB
    buffer_load_dword v20, v94, s[36:39], s50 offen sc1
    s_waitcnt vmcnt(1)
    v_cmp_ne_u32 vcc, s12, v21
    s_nop 0
    s_cbranch_vccz P_dB
    s_add_u32 s9, s9, 1
    s_cmp_lt_u32 s9, 200000
    s_cbranch_scc1 P_lB
P_dB:
    s_lshl_b32 s40, s3, 12
    s_add_u32 m0, s40, 0
    s_waitcnt lgkmcnt(0)
    s_barrier
    buffer_load_dwordx4 v60, s[36:39], s60 offen offset:0 sc1 lds
    buffer_load_dwordx4 v60, s[36:39], s60 offen offset:1024 sc1 lds
    buffer_load_dwordx4 v60, s[36:39], s60 offen offset:2048 sc1 lds
    buffer_load_dwordx4 v60, s[36:39], s60 offen offset:3072 sc1 lds
    ds_read_b128 v[120:123], v67 offset:0
    ds_read_b128 v[124:127], v67 offset:1024
    ds_read_b128 v[128:131], v67 offset:2048
    ds_read_b128 v[132:135], v67 offset:3072
    ds_read_b128 v[136:139], v67 offset:4096
    ds_read_b128 v[140:143], v67 offset:5120
    ds_read_b128 v[144:147], v67 offset:6144
    ds_read_b128 v[148:151], v67 offset:7168
    ds_read_b128 v[152:155], v67 offset:8192
    ds_read_b128 v[156:159], v67 offset:9216
    ds_read_b128 v[160:163], v67 offset:10240
    ds_read_b128 v[164:167], v67 offset:11264
    ds_read_b128 v[168:171], v67 offset:12288
    ds_read_b128 v[172:175], v67 offset:13312
    ds_read_b128 v[176:179], v67 offset:14336
    ds_read_b128 v[180:183], v67 offset:15360
    v_add_u32 v62, s61, v4
    v_xor_b32 v61, 32, v62
    v_add_u32 v89, s61, v63
    s_lshr_b32 s61, s3, 1
    s_lshl_b32 s61, s61, 13
    s_and_b32 s62, s3, 1
    s_lshl_b32 s62, s62, 10
    s_add_u32 s61, s61, s62
    v_add_u32 v91, s61, v63
    v_mov_b32 v68, 81920
    v_lshl_add_u32 v68, s56, 2, v68
    v_mov_b32 v75, 1
    s_lshl_b32 s61, s56, 11
    v_add_u32 v69, s61, v63
    s_lshl_b32 s61, s56, 4
    v_add_u32 v4, s61, v3
    v_mul_u32_u24 v4, 528, v4
    v_add_u32 v4, 98304, v4
    v_lshl_add_u32 v5, s55, 2, v2
    v_lshl_add_u32 v64, v5, 4, v4
    s_and_b32 s61, s3, 1
    s_lshl_b32 s61, s61, 3
    v_lshrrev_b32 v4, 3, v1
    v_add_u32 v4, s61, v4
    v_and_b32 v5, 7, v1
    v_lshlrev_b32 v5, 4, v5
    s_and_b32 s61, s3, 2
    s_add_u32 s61, s61, s56
    s_mul_i32 s61, s61, 8448
    s_add_u32 s61, s61, 98304
    v_mul_u32_u24 v96, 528, v4
    v_add3_u32 v65, v96, v5, s61
    v_add_u32 v97, s61, v96
    s_bitcmp1_b32 s3, 1
    s_cselect_b32 s62, -1, 1
    s_mul_i32 s62, s62, 16896
    v_add_u32 v71, s62, v97
    s_cmp_eq_u32 s56, 0
    s_cselect_b32 s61, s8, s63
    v_lshl_add_u32 v66, v4, 6, s61
    v_sub_u32 v96, 2048, v66
    v_mov_b32 v4, 1024
    v_cmp_eq_u32 s[42:43], 0, v66
    s_nop 1
    v_cndmask_b32 v96, v96, v4, s[42:43]
    v_cndmask_b32 v71, v71, v97, s[42:43]
    s_bitcmp1_b32 s3, 1
    s_cselect_b64 s[42:43], -1, 0
    v_cndmask_b32 v66, v66, v96, s[42:43]
    v_mov_b32 v96, 1792
    v_mad_u32_u24 v66, v66, v96, v5
    v_sub_u32 v71, v71, v5
    v_and_b32 v4, 4, v1
    v_lshl_add_u32 v70, v4, 5, v65
    v_lshl_add_u32 v73, v4, 5, v66
    v_lshlrev_b32 v4, 4, v4
    v_sub_u32 v72, v71, v4
    v_mov_b32 v74, 0xffff
    v_xor_b32 v88, s51, v88
    s_mov_b32 s9, 0
    s_waitcnt lgkmcnt(0)
S_gc:
    s_waitcnt vmcnt(2)
    ds_read_b64_tr_b16 v[184:185], v62 offset:0
    ds_read_b64_tr_b16 v[186:187], v62 offset:256
    ds_read_b64_tr_b16 v[192:193], v61 offset:0
    ds_read_b64_tr_b16 v[194:195], v61 offset:256
    ds_read_b32 v102, v89 offset:12
    ds_read_b32 v103, v89 offset:1036
    s_waitcnt lgkmcnt(4)
    v_mfma_f32_16x16x32_bf16 v[200:203], v[184:187], v[28:31], 0
    v_mfma_f32_16x16x32_bf16 v[208:211], v[184:187], v[36:39], 0
    v_mfma_f32_16x16x32_bf16 v[216:219], v[184:187], v[44:47], 0
    v_mfma_f32_16x16x32_bf16 v[224:227], v[184:187], v[52:55], 0
    s_waitcnt vmcnt(0)
    ds_read_b64_tr_b16 v[188:189], v62 offset:2048
    ds_read_b64_tr_b16 v[190:191], v62 offset:2304
    ds_read_b64_tr_b16 v[196:197], v61 offset:2048
    ds_read_b64_tr_b16 v[198:199], v61 offset:2304
    ds_read_b32 v104, v89 offset:2060
    ds_read_b32 v105, v89 offset:3084
    s_waitcnt lgkmcnt(8)
    v_mfma_f32_16x16x32_bf16 v[204:207], v[192:195], v[28:31], 0
    v_mfma_f32_16x16x32_bf16 v[212:215], v[192:195], v[36:39], 0
    v_mfma_f32_16x16x32_bf16 v[220:223], v[192:195], v[44:47], 0
    v_mfma_f32_16x16x32_bf16 v[228:231], v[192:195], v[52:55], 0
    s_waitcnt lgkmcnt(4)
    v_mfma_f32_16x16x32_bf16 v[200:203], v[188:191], v[32:35], v[200:203]
    s_waitcnt lgkmcnt(2)
    v_mfma_f32_16x16x32_bf16 v[204:207], v[196:199], v[32:35], v[204:207]
    s_waitcnt lgkmcnt(0)
    v_xor_b32 v102, v88, v102
    v_xor_b32 v103, v88, v103
    v_xor_b32 v104, v88, v104
    v_mfma_f32_16x16x32_bf16 v[208:211], v[188:191], v[40:43], v[208:211]
    v_xor_b32 v105, v88, v105
    v_or_b32 v102, v102, v103
    v_or3_b32 v102, v102, v104, v105
    v_mfma_f32_16x16x32_bf16 v[212:215], v[196:199], v[40:43], v[212:215]
    v_and_b32 v102, v90, v102
    v_cmp_ne_u32 vcc, 0, v102
    v_mfma_f32_16x16x32_bf16 v[216:219], v[188:191], v[48:51], v[216:219]
    v_mfma_f32_16x16x32_bf16 v[220:223], v[196:199], v[48:51], v[220:223]
    v_cvt_pk_bf16_f32 v232, v200, v201
    v_cvt_pk_bf16_f32 v233, v202, v203
    v_cvt_pk_bf16_f32 v234, v204, v205
    v_cvt_pk_bf16_f32 v235, v206, v207
    ds_write_b128 v91, v[232:235] offset:32768
    v_mfma_f32_16x16x32_bf16 v[224:227], v[188:191], v[56:59], v[224:227]
    v_mfma_f32_16x16x32_bf16 v[228:231], v[196:199], v[56:59], v[228:231]
    v_cvt_pk_bf16_f32 v236, v208, v209
    v_cvt_pk_bf16_f32 v237, v210, v211
    v_cvt_pk_bf16_f32 v238, v212, v213
    v_cvt_pk_bf16_f32 v239, v214, v215
    ds_write_b128 v91, v[236:239] offset:36864
    s_cbranch_vccnz S_gr
S_gk:
    v_cvt_pk_bf16_f32 v240, v216, v217
    v_cvt_pk_bf16_f32 v241, v218, v219
    v_cvt_pk_bf16_f32 v242, v220, v221
    v_cvt_pk_bf16_f32 v243, v222, v223
    ds_write_b128 v91, v[240:243] offset:34816
    v_cvt_pk_bf16_f32 v244, v224, v225
    v_cvt_pk_bf16_f32 v245, v226, v227
    v_cvt_pk_bf16_f32 v246, v228, v229
    v_cvt_pk_bf16_f32 v247, v230, v231
    ds_write_b128 v91, v[244:247] offset:38912
    s_waitcnt lgkmcnt(0)
    s_barrier
    s_cmp_lg_u32 s56, 0
    s_cbranch_scc1 S_np
    s_setprio 1
S_np:
    ds_read_b128 v[184:187], v69 offset:32768
    ds_read_b128 v[188:191], v69 offset:33792
    ds_read_b128 v[192:195], v69 offset:40960
    ds_read_b128 v[196:199], v69 offset:41984
    ds_read_b128 v[200:203], v69 offset:49152
    ds_read_b128 v[204:207], v69 offset:50176
    ds_read_b128 v[208:211], v69 offset:57344
    s_waitcnt lgkmcnt(6)
    v_mfma_f32_16x16x32_bf16 v[216:219], v[120:123], v[184:187], 0
    ds_read_b128 v[212:215], v69 offset:58368
    s_waitcnt lgkmcnt(6)
    v_mfma_f32_16x16x32_bf16 v[216:219], v[124:127], v[188:191], v[216:219]
    ds_read_b128 v[184:187], v69 offset:53248
    s_waitcnt lgkmcnt(6)
    v_mfma_f32_16x16x32_bf16 v[220:223], v[128:131], v[192:195], 0
    ds_read_b128 v[188:191], v69 offset:54272
    s_waitcnt lgkmcnt(6)
    v_mfma_f32_16x16x32_bf16 v[220:223], v[132:135], v[196:199], v[220:223]
    ds_read_b128 v[192:195], v69 offset:61440
    s_waitcnt lgkmcnt(6)
    v_mfma_f32_16x16x32_bf16 v[232:235], v[152:155], v[200:203], 0
    ds_read_b128 v[196:199], v69 offset:62464
    s_waitcnt lgkmcnt(6)
    v_mfma_f32_16x16x32_bf16 v[232:235], v[156:159], v[204:207], v[232:235]
    ds_read_b128 v[200:203], v69 offset:36864
    s_waitcnt lgkmcnt(6)
    v_mfma_f32_16x16x32_bf16 v[236:239], v[160:163], v[208:211], 0
    ds_read_b128 v[204:207], v69 offset:37888
    s_waitcnt lgkmcnt(6)
    v_mfma_f32_16x16x32_bf16 v[236:239], v[164:167], v[212:215], v[236:239]
    ds_read_b128 v[208:211], v69 offset:45056
    s_waitcnt lgkmcnt(6)
    v_mfma_f32_16x16x32_bf16 v[224:227], v[136:139], v[184:187], 0
    ds_read_b128 v[212:215], v69 offset:46080
    s_waitcnt lgkmcnt(6)
    v_mfma_f32_16x16x32_bf16 v[224:227], v[140:143], v[188:191], v[224:227]
    s_waitcnt lgkmcnt(5)
    v_mfma_f32_16x16x32_bf16 v[228:231], v[144:147], v[192:195], 0
    v_pk_add_f32 v[102:103], v[216:217], v[220:221]
    v_pk_add_f32 v[104:105], v[218:219], v[222:223]
    s_waitcnt lgkmcnt(4)
    v_mfma_f32_16x16x32_bf16 v[228:231], v[148:151], v[196:199], v[228:231]
    v_pk_add_f32 v[220:221], v[216:217], v[220:221] neg_lo:[0,1] neg_hi:[0,1]
    v_pk_add_f32 v[222:223], v[218:219], v[222:223] neg_lo:[0,1] neg_hi:[0,1]
    s_waitcnt lgkmcnt(3)
    v_mfma_f32_16x16x32_bf16 v[240:243], v[168:171], v[200:203], 0
    v_pk_add_f32 v[106:107], v[232:233], v[236:237]
    s_waitcnt lgkmcnt(2)
    v_mfma_f32_16x16x32_bf16 v[240:243], v[172:175], v[204:207], v[240:243]
    v_pk_add_f32 v[108:109], v[234:235], v[238:239]
    s_waitcnt lgkmcnt(1)
    v_mfma_f32_16x16x32_bf16 v[244:247], v[176:179], v[208:211], 0
    v_pk_add_f32 v[236:237], v[232:233], v[236:237] neg_lo:[0,1] neg_hi:[0,1]
    s_waitcnt lgkmcnt(0)
    v_mfma_f32_16x16x32_bf16 v[244:247], v[180:183], v[212:215], v[244:247]
    v_pk_add_f32 v[238:239], v[234:235], v[238:239] neg_lo:[0,1] neg_hi:[0,1]
    s_add_u32 s40, s8, s56
    s_cmp_eq_u32 s40, 0
    s_cbranch_scc1 S_y0
S_y1:
    v_pk_add_f32 v[216:217], v[224:225], v[228:229]
    v_pk_add_f32 v[218:219], v[226:227], v[230:231]
    v_pk_add_f32 v[228:229], v[224:225], v[228:229] neg_lo:[0,1] neg_hi:[0,1]
    v_pk_add_f32 v[230:231], v[226:227], v[230:231] neg_lo:[0,1] neg_hi:[0,1]
    v_pk_add_f32 v[232:233], v[240:241], v[244:245]
    v_pk_add_f32 v[234:235], v[242:243], v[246:247]
    v_pk_add_f32 v[244:245], v[240:241], v[244:245] neg_lo:[0,1] neg_hi:[0,1]
    v_pk_add_f32 v[246:247], v[242:243], v[246:247] neg_lo:[0,1] neg_hi:[0,1]
    v_pk_add_f32 v[224:225], v[102:103], v[216:217]
    v_pk_add_f32 v[226:227], v[104:105], v[218:219]
    v_pk_add_f32 v[240:241], v[106:107], v[232:233]
    v_pk_add_f32 v[242:243], v[108:109], v[234:235]
    v_cvt_pk_bf16_f32 v184, v224, v240
    v_cvt_pk_bf16_f32 v185, v225, v241
    v_cvt_pk_bf16_f32 v186, v226, v242
    v_cvt_pk_bf16_f32 v187, v227, v243
    ds_write_b128 v64, v[184:187] offset:0
    v_pk_add_f32 v[224:225], v[102:103], v[216:217] neg_lo:[0,1] neg_hi:[0,1]
    v_pk_add_f32 v[226:227], v[104:105], v[218:219] neg_lo:[0,1] neg_hi:[0,1]
    v_pk_add_f32 v[240:241], v[106:107], v[232:233] neg_lo:[0,1] neg_hi:[0,1]
    v_pk_add_f32 v[242:243], v[108:109], v[234:235] neg_lo:[0,1] neg_hi:[0,1]
    v_cvt_pk_bf16_f32 v188, v224, v240
    v_cvt_pk_bf16_f32 v189, v225, v241
    v_cvt_pk_bf16_f32 v190, v226, v242
    v_cvt_pk_bf16_f32 v191, v227, v243
    ds_write_b128 v64, v[188:191] offset:16896
    v_pk_add_f32 v[224:225], v[220:221], v[228:229]
    v_pk_add_f32 v[226:227], v[222:223], v[230:231]
    v_pk_add_f32 v[240:241], v[236:237], v[244:245]
    v_pk_add_f32 v[242:243], v[238:239], v[246:247]
    v_cvt_pk_bf16_f32 v192, v224, v240
    v_cvt_pk_bf16_f32 v193, v225, v241
    v_cvt_pk_bf16_f32 v194, v226, v242
    v_cvt_pk_bf16_f32 v195, v227, v243
    ds_write_b128 v64, v[192:195] offset:256
    v_pk_add_f32 v[224:225], v[220:221], v[228:229] neg_lo:[0,1] neg_hi:[0,1]
    v_pk_add_f32 v[226:227], v[222:223], v[230:231] neg_lo:[0,1] neg_hi:[0,1]
    v_pk_add_f32 v[240:241], v[236:237], v[244:245] neg_lo:[0,1] neg_hi:[0,1]
    v_pk_add_f32 v[242:243], v[238:239], v[246:247] neg_lo:[0,1] neg_hi:[0,1]
    v_cvt_pk_bf16_f32 v196, v224, v240
    v_cvt_pk_bf16_f32 v197, v225, v241
    v_cvt_pk_bf16_f32 v198, v226, v242
    v_cvt_pk_bf16_f32 v199, v227, v243
    ds_write_b128 v64, v[196:199] offset:17152
    s_mov_b64 exec, 1
    ds_add_u32 v68, v75
    s_mov_b64 exec, -1
    s_mov_b32 s9, 0
        W_lO:
    ds_read_b32 v4, v68 offset:0
    s_add_u32 s9, s9, 1
    s_cmp_gt_u32 s9, 1600000
    s_cbranch_scc1 W_dO
    s_waitcnt lgkmcnt(0)
    v_cmp_gt_u32 vcc, 4, v4

    s_nop 0
    s_cbranch_vccnz W_lO
W_dO:
    v_and_b32 v4, 4, v1
    v_lshl_add_u32 v5, v4, 6, v66
    ds_read_b128 v[120:123], v65 offset:0
    ds_read_b128 v[124:127], v65 offset:128
    ds_read_b128 v[128:131], v65 offset:320
    ds_read_b128 v[132:135], v70 offset:256
    ds_read_b128 v[136:139], v71 offset:432
    ds_read_b32 v140, v71 offset:448
    ds_read_b128 v[144:147], v71 offset:112
    ds_read_b32 v148, v71 offset:128
    ds_read_b128 v[152:155], v72 offset:304
    ds_read_b32 v156, v72 offset:320
    s_waitcnt lgkmcnt(9)
    buffer_store_dwordx4 v[120:123], v66, s[32:35], 0 offen offset:896 nt
    s_waitcnt lgkmcnt(8)
    buffer_store_dwordx4 v[124:127], v66, s[32:35], 0 offen offset:1024 nt
    s_waitcnt lgkmcnt(7)
    buffer_store_dwordx4 v[128:131], v66, s[32:35], 0 offen offset:1408 nt
    s_waitcnt lgkmcnt(6)
    buffer_store_dwordx4 v[132:135], v73, s[32:35], 0 offen offset:1344 nt
    s_waitcnt lgkmcnt(4)
    v_bfi_b32 v160, v74, v140, v139
    v_bfi_b32 v161, v74, v139, v138
    v_bfi_b32 v162, v74, v138, v137
    v_bfi_b32 v163, v74, v137, v136
    buffer_store_dwordx4 v[160:163], v66, s[32:35], 0 offen offset:1152 nt
    s_waitcnt lgkmcnt(2)
    v_bfi_b32 v164, v74, v148, v147
    v_bfi_b32 v165, v74, v147, v146
    v_bfi_b32 v166, v74, v146, v145
    v_bfi_b32 v167, v74, v145, v144
    buffer_store_dwordx4 v[164:167], v66, s[32:35], 0 offen offset:1664 nt
    s_waitcnt lgkmcnt(0)
    v_bfi_b32 v168, v74, v156, v155
    v_bfi_b32 v169, v74, v155, v154
    v_bfi_b32 v170, v74, v154, v153
    v_bfi_b32 v171, v74, v153, v152
    buffer_store_dwordx4 v[168:171], v5, s[32:35], 0 offen offset:1280 nt
    s_add_u32 s40, s8, s3
    s_cmp_lg_u32 s40, 0
    s_cbranch_scc1 S_end
    s_add_u32 s40, s10, 16
    v_mov_b32 v4, s40
    s_mov_b32 s40, 4096
    s_mov_b64 exec, 1
    buffer_store_dword v4, v12, s[36:39], s40 offen
        S_end:

    s_endpgm
    s_endpgm
    s_endpgm
    s_endpgm
    s_endpgm
    s_endpgm
    s_endpgm
    s_endpgm
    s_endpgm
    s_endpgm
    s_endpgm
    s_endpgm
    s_endpgm
    s_endpgm
    s_endpgm
    s_endpgm
    s_endpgm
    s_endpgm
    s_endpgm
    s_endpgm
    s_endpgm
    s_endpgm
    s_endpgm
    s_endpgm
    s_endpgm
    s_endpgm
    s_endpgm
    s_endpgm
    s_endpgm
    s_endpgm
    s_endpgm
    s_endpgm
    s_endpgm
    s_endpgm
    s_endpgm
    s_endpgm
    s_endpgm
    s_endpgm
    s_endpgm
    s_endpgm
    s_endpgm
    s_endpgm
    s_endpgm
    s_endpgm
    s_endpgm
    s_endpgm
    s_endpgm
    s_endpgm
    s_endpgm
    s_endpgm
    s_endpgm
    s_endpgm
    s_endpgm
    s_endpgm
    s_endpgm
    s_endpgm
    s_endpgm
    s_endpgm
    s_endpgm
    s_endpgm
    s_endpgm
    s_endpgm
    s_endpgm
    s_endpgm
    s_endpgm
    s_endpgm
    s_endpgm
    s_endpgm
    s_endpgm
    s_endpgm
    s_endpgm
    s_endpgm
    s_endpgm
    s_endpgm
    s_endpgm
    s_endpgm
    s_endpgm
    s_endpgm
    s_endpgm
    s_endpgm
    s_endpgm
    s_endpgm
    s_endpgm
    s_endpgm
    s_endpgm
    s_endpgm
    s_endpgm
    s_endpgm
    s_endpgm
    s_endpgm
    s_endpgm
    s_endpgm
    s_endpgm
    s_endpgm
    s_endpgm
    s_endpgm
    s_endpgm
    s_endpgm
    s_endpgm
    s_endpgm
    s_endpgm
    s_endpgm
    s_endpgm
    s_endpgm
    s_endpgm
    s_endpgm
    s_endpgm
    s_endpgm
    s_endpgm
    s_endpgm
    s_endpgm
    s_endpgm
    s_endpgm
    s_endpgm
    s_endpgm
    s_endpgm
    s_endpgm
    s_endpgm
    s_endpgm
    s_endpgm
    s_endpgm
    s_endpgm
    s_endpgm
    s_endpgm
    s_endpgm
    s_endpgm
    s_endpgm
    s_endpgm
    s_endpgm
K_c:
    s_lshl_b32 s40, s8, 7
    s_waitcnt lgkmcnt(0)
    s_load_dwordx2 s[10:11], s[36:37], s40
    s_lshl_b32 s14, s8, 10
    s_add_u32 s14, s14, 65536
    s_getreg_b32 s52, hwreg(HW_REG_XCC_ID, 0, 3)
    s_mov_b32 s26, 401408
    s_mov_b32 s27, 0x00020000
    s_mov_b32 s34, 3670016
    s_mov_b32 s35, 0x00020000
    s_sub_u32 s62, s3, 4
    s_lshr_b32 s16, s62, 1
    s_and_b32 s17, s62, 1
    s_lshl_b32 s29, s62, 11
    v_and_b32 v1, 63, v0
    v_lshlrev_b32 v4, 4, v1
    s_lshl_b32 s1, s5, 3
    s_add_u32 s1, s1, s4
    s_mul_i32 s1, s1, 1792
    v_min_u32 v41, 13, v1
    v_lshlrev_b32 v41, 7, v41
    v_lshrrev_b32 v24, 4, v1
    v_and_b32 v25, 15, v1
    v_lshrrev_b32 v26, 3, v1
    v_and_b32 v27, 7, v1
    v_mov_b32 v5, 161792
    v_mov_b32 v6, 0
    v_lshl_add_u32 v2, v1, 2, v5
    ds_write_b32 v2, v6
    v_lshrrev_b32 v3, 1, v25
    v_xor_b32 v3, v3, v24
    v_lshlrev_b32 v3, 4, v3
    v_lshl_add_u32 v3, v25, 7, v3
    s_lshr_b32 s18, s62, 1
    s_lshl_b32 s18, s18, 12
    v_add_u32 v28, s18, v3
    v_xor_b32 v29, 64, v28
    v_add_u32 v30, 40960, v28
    v_add_u32 v31, 40960, v29
    v_lshrrev_b32 v3, 2, v25
    v_lshl_add_u32 v3, v24, 3, v3
    v_lshlrev_b32 v3, 7, v3
    v_and_b32 v7, 3, v1
    v_lshl_add_u32 v3, v7, 3, v3
    v_bfe_u32 v7, v1, 3, 2
    s_and_b32 s18, s62, 1
    s_lshl_b32 s18, s18, 1
    v_xor_b32 v7, s18, v7
    v_lshl_add_u32 v3, v7, 5, v3
    v_add_u32 v32, 71680, v3
    v_xor_b32 v33, 32, v32
    v_add_u32 v34, 49152, v32
    v_add_u32 v35, 49152, v33
    s_and_b32 s18, s62, 1
    s_lshl_b32 s19, s7, 1
    s_add_u32 s18, s18, s19
    s_cmp_ge_u32 s18, 7
    s_cselect_b32 s19, 14, 7
    s_sub_u32 s18, s19, s18
    v_cmp_gt_u32 s[54:55], s18, v24
    v_add_u32 v2, 4, v24
    v_cmp_gt_u32 s[56:57], s18, v2
    s_bitcmp0_b32 s62, 0
    s_cselect_b64 vcc, -1, 0
    s_xor_b64 s[54:55], s[54:55], vcc
    s_xor_b64 s[56:57], s[56:57], vcc
    v_lshrrev_b32 v3, 2, v25
    s_and_b32 s18, s62, 1
    s_lshl_b32 s19, s7, 1
    s_add_u32 s18, s18, s19
    s_cmp_ge_u32 s18, 7
    s_cselect_b32 s19, 14, 7
    s_sub_u32 s18, s19, s18
    v_cmp_gt_u32 s[58:59], s18, v3
    v_add_u32 v2, 4, v3
    v_cmp_gt_u32 s[60:61], s18, v2
    s_bitcmp0_b32 s62, 0
    s_cselect_b64 vcc, -1, 0
    s_xor_b64 s[58:59], s[58:59], vcc
    s_xor_b64 s[60:61], s[60:61], vcc
    s_and_b32 s18, s62, 1
    s_lshl_b32 s19, s7, 1
    s_add_u32 s18, s18, s19
    s_lshl_b32 s100, s18, 10
    s_lshl_b32 s18, s8, 2
    s_and_b32 s19, s62, 2
    s_add_u32 s18, s18, s19
    s_mul_i32 s19, s18, 14336
    s_add_u32 s100, s100, s19
    s_add_u32 s100, s100, 2097152
    s_lshl_b32 s20, s18, 6
    s_add_u32 s20, s20, 16384
    s_lshl_b32 s18, s17, 11
    s_sub_u32 s18, s18, 1024
    s_add_u32 s15, s100, s18
    s_lshl_b32 s19, s7, 1
    s_add_u32 s18, s17, s19
    s_lshl_b32 s18, s18, 3
    s_add_u32 s21, s20, s18
    v_and_b32 v2, 1, v25
    v_cmp_eq_u32 s[44:45], 1, v2
    v_lshl_add_u32 v2, v24, 2, v2
    v_cmp_le_u32 s[46:47], v2, v25
    v_add_u32 v2, 2, v2
    v_cmp_le_u32 s[48:49], v2, v25
    v_mov_b32 v2, 0xffff
    v_mov_b32 v3, 0xffff0000
    v_cndmask_b32 v2, v2, v3, s[44:45]
    v_cndmask_b32 v36, v2, 0, s[46:47]
    v_cndmask_b32 v37, v2, 0, s[48:49]
    v_cndmask_b32 v38, 0, v2, s[46:47]
    v_cndmask_b32 v39, 0, v2, s[48:49]
    s_add_u32 s18, s8, s16
    s_cmp_eq_u32 s18, 0
    s_cselect_b64 s[50:51], -1, 0
    s_mul_i32 s18, s17, 6
    s_cmp_eq_u32 s18, s7
    s_cselect_b32 s101, 1, 0
    v_mov_b32 v44, 1
    v_mov_b32 v45, 0xf149f2ca
    v_mov_b32 v46, 0xffffff00
    s_mov_b32 s0, 0x3e8b97f6
    s_add_u32 s18, s29, 4096
    v_add_u32 v42, s18, v4
    v_add_u32 v43, s29, v4
    v_lshl_add_u32 v47, s62, 2, v5
    v_lshl_add_u32 v218, s17, 10, v4
    v_add_u32 v219, 2048, v218
    v_lshl_add_u32 v220, s17, 2, v5
    v_lshl_add_u32 v221, s17, 3, v5
    s_lshl_b32 s18, s7, 7
    v_min_u32 v8, 13, v1
    v_lshlrev_b32 v8, 3, v8
    v_lshrrev_b32 v2, 2, v1
    v_bfe_u32 v3, v1, 3, 2
    v_lshlrev_b32 v3, 5, v3
    v_lshl_add_u32 v2, v2, 7, v3
    v_and_b32 v3, 3, v1
    v_lshl_add_u32 v2, v3, 3, v2
    v_add_u32 v16, 71680, v2
    v_xor_b32 v17, 32, v16
    v_xor_b32 v18, 64, v16
    v_xor_b32 v19, 96, v16
    s_add_u32 s19, s29, 4096
    v_lshrrev_b32 v2, 1, v24
    v_xor_b32 v2, v2, v27
    v_lshlrev_b32 v2, 4, v2
    v_lshl_add_u32 v2, v25, 7, v2
    v_and_b32 v3, 1, v24
    v_lshl_add_u32 v2, v3, 3, v2
    v_add_u32 v20, s19, v2
    v_xor_b32 v21, 32, v20
    v_xor_b32 v22, 64, v20
    v_xor_b32 v23, 96, v20
    v_mul_u32_u24 v10, 1792, v26
    v_lshl_add_u32 v10, v27, 4, v10
    v_xor_b32 v3, v27, v26
    v_lshlrev_b32 v3, 4, v3
    v_lshl_add_u32 v2, v26, 7, v3
    v_add_u32 v9, s19, v2
    s_lshl_b32 s19, s8, 2
    s_add_u32 s19, s19, s62
    s_mul_i32 s22, s19, 14336
    s_add_u32 s22, s22, 2097152
    s_mul_i32 s23, s19, 28672
    s_add_u32 s23, s23, s18
    s_add_u32 s28, s23, 14336
    s_waitcnt lgkmcnt(0)
    s_add_u32 s12, s10, 0x5a3c9671
    s_xor_b32 s13, s11, 0x2b7e1516
    s_add_u32 s52, s52, s12
    s_mov_b32 s53, s13
    v_mov_b32 v14, s12
    v_mov_b32 v15, s13
    s_bfe_u32 s40, s12, 0x80000
    v_mov_b32 v50, s40
    s_bfe_u32 s40, s12, 0x80008
    v_mov_b32 v51, s40
    s_bfe_u32 s40, s12, 0x80010
    v_mov_b32 v52, s40
    s_bfe_u32 s40, s12, 0x80018
    v_mov_b32 v53, s40
    s_setprio 3
    s_cmp_lg_u32 s62, 0
    s_cbranch_scc1 C_nox
    v_mov_b32 v12, s52
    v_mov_b32 v13, s53
    s_lshl_b32 s41, s7, 3
    s_add_u32 s40, s14, s41
    s_mov_b64 exec, 1
    buffer_store_dwordx2 v[12:13], v6, s[36:39], s40 offen sc1
    s_mov_b64 exec, -1

C_nox:

    s_cmp_lg_u32 s16, 0
    s_cbranch_scc1 C_tp1
    s_barrier
    ds_read_b128 v[130:133], v28 offset:2048
    ds_read_b64_tr_b16 v[174:175], v32 offset:8192
    ds_read_b64_tr_b16 v[176:177], v32 offset:8704
    ds_read_b128 v[142:145], v29 offset:2048
    ds_read_b64_tr_b16 v[178:179], v32 offset:12288
    ds_read_b64_tr_b16 v[180:181], v32 offset:12800
    ds_read_b128 v[134:137], v28 offset:4096
    ds_read_b128 v[146:149], v29 offset:4096
    ds_read_b64_tr_b16 v[182:183], v33 offset:8192
    ds_read_b64_tr_b16 v[184:185], v33 offset:8704
    ds_read_b64_tr_b16 v[186:187], v33 offset:12288
    ds_read_b64_tr_b16 v[188:189], v33 offset:12800
    s_waitcnt lgkmcnt(9)
    v_mfma_f32_16x16x32_bf16 v[62:65], v[174:177], v[130:133], 0
    ds_read_b128 v[126:129], v28 offset:0
    s_waitcnt lgkmcnt(7)
    v_mfma_f32_16x16x32_bf16 v[62:65], v[178:181], v[142:145], v[62:65]
    ds_read_b64_tr_b16 v[190:191], v32 offset:16384
    ds_read_b64_tr_b16 v[192:193], v32 offset:16896
    s_waitcnt lgkmcnt(8)
    v_mfma_f32_16x16x32_bf16 v[70:73], v[174:177], v[134:137], 0
    ds_read_b128 v[138:141], v29 offset:0
    ds_read_b64_tr_b16 v[194:195], v32 offset:20480
    s_waitcnt lgkmcnt(9)
    v_mfma_f32_16x16x32_bf16 v[70:73], v[178:181], v[146:149], v[70:73]
    ds_read_b64_tr_b16 v[196:197], v32 offset:20992
    s_waitcnt lgkmcnt(8)
    v_mfma_f32_16x16x32_bf16 v[66:69], v[182:185], v[130:133], 0
    ds_read_b64_tr_b16 v[174:175], v33 offset:16384
    s_waitcnt lgkmcnt(7)
    v_mfma_f32_16x16x32_bf16 v[66:69], v[186:189], v[142:145], v[66:69]
    ds_read_b64_tr_b16 v[176:177], v33 offset:16896
    v_mfma_f32_16x16x32_bf16 v[74:77], v[182:185], v[134:137], 0
    ds_read_b64_tr_b16 v[178:179], v33 offset:20480
    v_mfma_f32_16x16x32_bf16 v[74:77], v[186:189], v[146:149], v[74:77]
    ds_read_b64_tr_b16 v[180:181], v33 offset:20992
    s_waitcnt lgkmcnt(7)
    v_mfma_f32_16x16x32_bf16 v[78:81], v[190:193], v[126:129], 0
    ds_read_b64_tr_b16 v[182:183], v32 offset:24576
    s_waitcnt lgkmcnt(5)
    v_mfma_f32_16x16x32_bf16 v[78:81], v[194:197], v[138:141], v[78:81]
    ds_read_b64_tr_b16 v[184:185], v32 offset:25088
    v_mfma_f32_16x16x32_bf16 v[86:89], v[190:193], v[130:133], 0
    ds_read_b64_tr_b16 v[186:187], v32 offset:28672
    v_mfma_f32_16x16x32_bf16 v[86:89], v[194:197], v[142:145], v[86:89]
    ds_read_b64_tr_b16 v[188:189], v32 offset:29184
    v_mfma_f32_16x16x32_bf16 v[94:97], v[190:193], v[134:137], 0
    ds_read_b64_tr_b16 v[190:191], v33 offset:24576
    v_mfma_f32_16x16x32_bf16 v[94:97], v[194:197], v[146:149], v[94:97]
    ds_read_b64_tr_b16 v[192:193], v33 offset:25088
    s_waitcnt lgkmcnt(8)
    v_mfma_f32_16x16x32_bf16 v[82:85], v[174:177], v[126:129], 0
    ds_read_b64_tr_b16 v[194:195], v33 offset:28672
    s_waitcnt lgkmcnt(7)
    v_mfma_f32_16x16x32_bf16 v[82:85], v[178:181], v[138:141], v[82:85]
    ds_read_b64_tr_b16 v[196:197], v33 offset:29184
    v_mfma_f32_16x16x32_bf16 v[90:93], v[174:177], v[130:133], 0
    v_mfma_f32_16x16x32_bf16 v[90:93], v[178:181], v[142:145], v[90:93]
    v_mfma_f32_16x16x32_bf16 v[98:101], v[174:177], v[134:137], 0
    v_mfma_f32_16x16x32_bf16 v[98:101], v[178:181], v[146:149], v[98:101]
    s_waitcnt lgkmcnt(6)
    v_mfma_f32_16x16x32_bf16 v[102:105], v[126:129], v[182:185], 0
    s_waitcnt lgkmcnt(4)
    v_mfma_f32_16x16x32_bf16 v[102:105], v[138:141], v[186:189], v[102:105]
    v_mfma_f32_16x16x32_bf16 v[110:113], v[130:133], v[182:185], 0
    v_mfma_f32_16x16x32_bf16 v[110:113], v[142:145], v[186:189], v[110:113]
    s_waitcnt lgkmcnt(2)
    v_mfma_f32_16x16x32_bf16 v[106:109], v[126:129], v[190:193], 0
    s_waitcnt lgkmcnt(0)
    s_barrier
    ds_read_b128 v[154:157], v28 offset:12288
    ds_read_b64_tr_b16 v[174:175], v32 offset:32768
    ds_read_b64_tr_b16 v[176:177], v32 offset:33280
    ds_read_b128 v[166:169], v29 offset:12288
    ds_read_b64_tr_b16 v[178:179], v32 offset:36864
    ds_read_b64_tr_b16 v[180:181], v32 offset:37376
    ds_read_b128 v[158:161], v28 offset:14336
    ds_read_b128 v[170:173], v29 offset:14336
    ds_read_b64_tr_b16 v[182:183], v33 offset:32768
    ds_read_b64_tr_b16 v[184:185], v33 offset:33280
    ds_read_b64_tr_b16 v[186:187], v33 offset:36864
    ds_read_b64_tr_b16 v[188:189], v33 offset:37376
    ds_read_b128 v[150:153], v28 offset:10240
    v_mfma_f32_16x16x32_bf16 v[106:109], v[138:141], v[194:197], v[106:109]
    v_mfma_f32_16x16x32_bf16 v[114:117], v[130:133], v[190:193], 0
    ds_read_b64_tr_b16 v[190:191], v32 offset:40960
    v_mfma_f32_16x16x32_bf16 v[114:117], v[142:145], v[194:197], v[114:117]
    ds_read_b64_tr_b16 v[192:193], v32 offset:41472
    s_waitcnt lgkmcnt(12)
    v_mfma_f32_16x16x32_bf16 v[62:65], v[174:177], v[154:157], v[62:65]
    ds_read_b128 v[162:165], v29 offset:10240
    s_waitcnt lgkmcnt(10)
    v_mfma_f32_16x16x32_bf16 v[62:65], v[178:181], v[166:169], v[62:65]
    ds_read_b64_tr_b16 v[194:195], v32 offset:45056
    s_waitcnt lgkmcnt(10)
    v_mfma_f32_16x16x32_bf16 v[70:73], v[174:177], v[158:161], v[70:73]
    ds_read_b64_tr_b16 v[196:197], v32 offset:45568
    s_waitcnt lgkmcnt(10)
    v_mfma_f32_16x16x32_bf16 v[70:73], v[178:181], v[170:173], v[70:73]
    ds_read_b64_tr_b16 v[174:175], v33 offset:40960
    s_waitcnt lgkmcnt(9)
    v_mfma_f32_16x16x32_bf16 v[66:69], v[182:185], v[154:157], v[66:69]
    ds_read_b64_tr_b16 v[176:177], v33 offset:41472
    s_waitcnt lgkmcnt(8)
    v_mfma_f32_16x16x32_bf16 v[66:69], v[186:189], v[166:169], v[66:69]
    ds_read_b64_tr_b16 v[178:179], v33 offset:45056
    v_mfma_f32_16x16x32_bf16 v[74:77], v[182:185], v[158:161], v[74:77]
    ds_read_b64_tr_b16 v[180:181], v33 offset:45568
    v_mfma_f32_16x16x32_bf16 v[74:77], v[186:189], v[170:173], v[74:77]
    ds_read_b64_tr_b16 v[182:183], v34 offset:0
    s_waitcnt lgkmcnt(8)
    v_mfma_f32_16x16x32_bf16 v[78:81], v[190:193], v[150:153], v[78:81]
    ds_read_b64_tr_b16 v[184:185], v34 offset:512
    s_waitcnt lgkmcnt(6)
    v_mfma_f32_16x16x32_bf16 v[78:81], v[194:197], v[162:165], v[78:81]
    ds_read_b64_tr_b16 v[186:187], v34 offset:4096
    v_mfma_f32_16x16x32_bf16 v[86:89], v[190:193], v[154:157], v[86:89]
    ds_read_b64_tr_b16 v[188:189], v34 offset:4608
    v_mfma_f32_16x16x32_bf16 v[86:89], v[194:197], v[166:169], v[86:89]
    v_mfma_f32_16x16x32_bf16 v[94:97], v[190:193], v[158:161], v[94:97]
    ds_read_b64_tr_b16 v[190:191], v35 offset:0
    v_mfma_f32_16x16x32_bf16 v[94:97], v[194:197], v[170:173], v[94:97]
    ds_read_b64_tr_b16 v[192:193], v35 offset:512
    s_waitcnt lgkmcnt(8)
    v_mfma_f32_16x16x32_bf16 v[82:85], v[174:177], v[150:153], v[82:85]
    ds_read_b64_tr_b16 v[194:195], v35 offset:4096
    s_waitcnt lgkmcnt(7)
    v_mfma_f32_16x16x32_bf16 v[82:85], v[178:181], v[162:165], v[82:85]
    ds_read_b64_tr_b16 v[196:197], v35 offset:4608
    v_mfma_f32_16x16x32_bf16 v[90:93], v[174:177], v[154:157], v[90:93]
    v_mfma_f32_16x16x32_bf16 v[90:93], v[178:181], v[166:169], v[90:93]
    v_mfma_f32_16x16x32_bf16 v[98:101], v[174:177], v[158:161], v[98:101]
    v_mfma_f32_16x16x32_bf16 v[98:101], v[178:181], v[170:173], v[98:101]
    s_waitcnt lgkmcnt(6)
    v_mfma_f32_16x16x32_bf16 v[102:105], v[150:153], v[182:185], v[102:105]
    s_waitcnt lgkmcnt(4)
    v_mfma_f32_16x16x32_bf16 v[102:105], v[162:165], v[186:189], v[102:105]
    v_mfma_f32_16x16x32_bf16 v[110:113], v[154:157], v[182:185], v[110:113]
    v_mfma_f32_16x16x32_bf16 v[110:113], v[166:169], v[186:189], v[110:113]
    s_waitcnt lgkmcnt(2)
    v_mfma_f32_16x16x32_bf16 v[106:109], v[150:153], v[190:193], v[106:109]
    s_waitcnt lgkmcnt(0)
    s_barrier
    ds_read_b128 v[130:133], v28 offset:22528
    ds_read_b64_tr_b16 v[174:175], v34 offset:8192
    ds_read_b64_tr_b16 v[176:177], v34 offset:8704
    ds_read_b128 v[142:145], v29 offset:22528
    ds_read_b64_tr_b16 v[178:179], v34 offset:12288
    ds_read_b64_tr_b16 v[180:181], v34 offset:12800
    ds_read_b128 v[134:137], v28 offset:24576
    ds_read_b128 v[146:149], v29 offset:24576
    ds_read_b64_tr_b16 v[182:183], v35 offset:8192
    ds_read_b64_tr_b16 v[184:185], v35 offset:8704
    ds_read_b64_tr_b16 v[186:187], v35 offset:12288
    ds_read_b64_tr_b16 v[188:189], v35 offset:12800
    ds_read_b128 v[126:129], v28 offset:20480
    v_mfma_f32_16x16x32_bf16 v[106:109], v[162:165], v[194:197], v[106:109]
    v_mfma_f32_16x16x32_bf16 v[114:117], v[154:157], v[190:193], v[114:117]
    ds_read_b64_tr_b16 v[190:191], v34 offset:16384
    v_mfma_f32_16x16x32_bf16 v[114:117], v[166:169], v[194:197], v[114:117]
    ds_read_b64_tr_b16 v[192:193], v34 offset:16896
    s_waitcnt lgkmcnt(12)
    v_mfma_f32_16x16x32_bf16 v[62:65], v[174:177], v[130:133], v[62:65]
    ds_read_b128 v[138:141], v29 offset:20480
    s_waitcnt lgkmcnt(10)
    v_mfma_f32_16x16x32_bf16 v[62:65], v[178:181], v[142:145], v[62:65]
    ds_read_b64_tr_b16 v[194:195], v34 offset:20480
    s_waitcnt lgkmcnt(10)
    v_mfma_f32_16x16x32_bf16 v[70:73], v[174:177], v[134:137], v[70:73]
    ds_read_b64_tr_b16 v[196:197], v34 offset:20992
    s_waitcnt lgkmcnt(10)
    v_mfma_f32_16x16x32_bf16 v[70:73], v[178:181], v[146:149], v[70:73]
    ds_read_b64_tr_b16 v[174:175], v35 offset:16384
    s_waitcnt lgkmcnt(9)
    v_mfma_f32_16x16x32_bf16 v[66:69], v[182:185], v[130:133], v[66:69]
    ds_read_b64_tr_b16 v[176:177], v35 offset:16896
    s_waitcnt lgkmcnt(8)
    v_mfma_f32_16x16x32_bf16 v[66:69], v[186:189], v[142:145], v[66:69]
    ds_read_b64_tr_b16 v[178:179], v35 offset:20480
    v_mfma_f32_16x16x32_bf16 v[74:77], v[182:185], v[134:137], v[74:77]
    ds_read_b64_tr_b16 v[180:181], v35 offset:20992
    v_mfma_f32_16x16x32_bf16 v[74:77], v[186:189], v[146:149], v[74:77]
    ds_read_b64_tr_b16 v[182:183], v34 offset:24576
    s_waitcnt lgkmcnt(8)
    v_mfma_f32_16x16x32_bf16 v[78:81], v[190:193], v[126:129], v[78:81]
    ds_read_b64_tr_b16 v[184:185], v34 offset:25088
    s_waitcnt lgkmcnt(6)
    v_mfma_f32_16x16x32_bf16 v[78:81], v[194:197], v[138:141], v[78:81]
    ds_read_b64_tr_b16 v[186:187], v34 offset:28672
    v_mfma_f32_16x16x32_bf16 v[86:89], v[190:193], v[130:133], v[86:89]
    ds_read_b64_tr_b16 v[188:189], v34 offset:29184
    v_mfma_f32_16x16x32_bf16 v[86:89], v[194:197], v[142:145], v[86:89]
    v_mfma_f32_16x16x32_bf16 v[94:97], v[190:193], v[134:137], v[94:97]
    ds_read_b64_tr_b16 v[190:191], v35 offset:24576
    v_mfma_f32_16x16x32_bf16 v[94:97], v[194:197], v[146:149], v[94:97]
    ds_read_b64_tr_b16 v[192:193], v35 offset:25088
    s_waitcnt lgkmcnt(8)
    v_mfma_f32_16x16x32_bf16 v[82:85], v[174:177], v[126:129], v[82:85]
    ds_read_b64_tr_b16 v[194:195], v35 offset:28672
    s_waitcnt lgkmcnt(7)
    v_mfma_f32_16x16x32_bf16 v[82:85], v[178:181], v[138:141], v[82:85]
    ds_read_b64_tr_b16 v[196:197], v35 offset:29184
    v_mfma_f32_16x16x32_bf16 v[90:93], v[174:177], v[130:133], v[90:93]
    v_mfma_f32_16x16x32_bf16 v[90:93], v[178:181], v[142:145], v[90:93]
    v_mfma_f32_16x16x32_bf16 v[98:101], v[174:177], v[134:137], v[98:101]
    v_mfma_f32_16x16x32_bf16 v[98:101], v[178:181], v[146:149], v[98:101]
    s_waitcnt lgkmcnt(6)
    v_mfma_f32_16x16x32_bf16 v[102:105], v[126:129], v[182:185], v[102:105]
    s_waitcnt lgkmcnt(4)
    v_mfma_f32_16x16x32_bf16 v[102:105], v[138:141], v[186:189], v[102:105]
    v_mfma_f32_16x16x32_bf16 v[110:113], v[130:133], v[182:185], v[110:113]
    v_mfma_f32_16x16x32_bf16 v[110:113], v[142:145], v[186:189], v[110:113]
    s_waitcnt lgkmcnt(2)
    v_mfma_f32_16x16x32_bf16 v[106:109], v[126:129], v[190:193], v[106:109]
    s_waitcnt lgkmcnt(0)
    s_barrier
    ds_read_b128 v[154:157], v28 offset:32768
    ds_read_b64_tr_b16 v[174:175], v34 offset:32768
    ds_read_b64_tr_b16 v[176:177], v34 offset:33280
    ds_read_b128 v[166:169], v29 offset:32768
    ds_read_b64_tr_b16 v[178:179], v34 offset:36864
    ds_read_b64_tr_b16 v[180:181], v34 offset:37376
    ds_read_b128 v[158:161], v28 offset:34816
    ds_read_b128 v[170:173], v29 offset:34816
    ds_read_b64_tr_b16 v[182:183], v35 offset:32768
    ds_read_b64_tr_b16 v[184:185], v35 offset:33280
    ds_read_b64_tr_b16 v[186:187], v35 offset:36864
    ds_read_b64_tr_b16 v[188:189], v35 offset:37376
    ds_read_b128 v[150:153], v28 offset:30720
    v_mfma_f32_16x16x32_bf16 v[106:109], v[138:141], v[194:197], v[106:109]
    v_mfma_f32_16x16x32_bf16 v[114:117], v[130:133], v[190:193], v[114:117]
    ds_read_b64_tr_b16 v[190:191], v32 offset:0
    v_mfma_f32_16x16x32_bf16 v[114:117], v[142:145], v[194:197], v[114:117]
    ds_read_b64_tr_b16 v[192:193], v32 offset:512
    s_waitcnt lgkmcnt(12)
    v_mfma_f32_16x16x32_bf16 v[62:65], v[174:177], v[154:157], v[62:65]
    ds_read_b128 v[162:165], v29 offset:30720
    s_waitcnt lgkmcnt(10)
    v_mfma_f32_16x16x32_bf16 v[62:65], v[178:181], v[166:169], v[62:65]
    ds_read_b64_tr_b16 v[194:195], v32 offset:4096
    s_waitcnt lgkmcnt(10)
    v_mfma_f32_16x16x32_bf16 v[70:73], v[174:177], v[158:161], v[70:73]
    ds_read_b64_tr_b16 v[196:197], v32 offset:4608
    s_waitcnt lgkmcnt(10)
    v_mfma_f32_16x16x32_bf16 v[70:73], v[178:181], v[170:173], v[70:73]
    ds_read_b64_tr_b16 v[174:175], v33 offset:0
    s_waitcnt lgkmcnt(9)
    v_mfma_f32_16x16x32_bf16 v[66:69], v[182:185], v[154:157], v[66:69]
    ds_read_b64_tr_b16 v[176:177], v33 offset:512
    s_waitcnt lgkmcnt(8)
    v_mfma_f32_16x16x32_bf16 v[66:69], v[186:189], v[166:169], v[66:69]
    ds_read_b64_tr_b16 v[178:179], v33 offset:4096
    v_mfma_f32_16x16x32_bf16 v[74:77], v[182:185], v[158:161], v[74:77]
    ds_read_b64_tr_b16 v[180:181], v33 offset:4608
    v_mfma_f32_16x16x32_bf16 v[74:77], v[186:189], v[170:173], v[74:77]
    ds_read_b64_tr_b16 v[182:183], v32 offset:8192
    s_waitcnt lgkmcnt(8)
    v_mfma_f32_16x16x32_bf16 v[78:81], v[190:193], v[150:153], v[78:81]
    ds_read_b64_tr_b16 v[184:185], v32 offset:8704
    s_waitcnt lgkmcnt(6)
    v_mfma_f32_16x16x32_bf16 v[78:81], v[194:197], v[162:165], v[78:81]
    ds_read_b64_tr_b16 v[186:187], v32 offset:12288
    v_mfma_f32_16x16x32_bf16 v[86:89], v[190:193], v[154:157], v[86:89]
    ds_read_b64_tr_b16 v[188:189], v32 offset:12800
    v_mfma_f32_16x16x32_bf16 v[86:89], v[194:197], v[166:169], v[86:89]
    v_mfma_f32_16x16x32_bf16 v[94:97], v[190:193], v[158:161], v[94:97]
    ds_read_b64_tr_b16 v[190:191], v33 offset:8192
    v_mfma_f32_16x16x32_bf16 v[94:97], v[194:197], v[170:173], v[94:97]
    ds_read_b64_tr_b16 v[192:193], v33 offset:8704
    s_waitcnt lgkmcnt(8)
    v_mfma_f32_16x16x32_bf16 v[82:85], v[174:177], v[150:153], v[82:85]
    ds_read_b64_tr_b16 v[194:195], v33 offset:12288
    s_waitcnt lgkmcnt(7)
    v_mfma_f32_16x16x32_bf16 v[82:85], v[178:181], v[162:165], v[82:85]
    ds_read_b64_tr_b16 v[196:197], v33 offset:12800
    v_mfma_f32_16x16x32_bf16 v[90:93], v[174:177], v[154:157], v[90:93]
    v_mfma_f32_16x16x32_bf16 v[90:93], v[178:181], v[166:169], v[90:93]
    v_mfma_f32_16x16x32_bf16 v[98:101], v[174:177], v[158:161], v[98:101]
    v_mfma_f32_16x16x32_bf16 v[98:101], v[178:181], v[170:173], v[98:101]
    s_waitcnt lgkmcnt(6)
    v_mfma_f32_16x16x32_bf16 v[102:105], v[150:153], v[182:185], v[102:105]
    s_waitcnt lgkmcnt(4)
    v_mfma_f32_16x16x32_bf16 v[102:105], v[162:165], v[186:189], v[102:105]
    v_mfma_f32_16x16x32_bf16 v[110:113], v[154:157], v[182:185], v[110:113]
    v_mfma_f32_16x16x32_bf16 v[110:113], v[166:169], v[186:189], v[110:113]
    s_waitcnt lgkmcnt(2)
    v_mfma_f32_16x16x32_bf16 v[106:109], v[150:153], v[190:193], v[106:109]
    s_waitcnt lgkmcnt(0)
    s_barrier
    ds_read_b128 v[130:133], v30 offset:2048
    ds_read_b64_tr_b16 v[174:175], v32 offset:16384
    ds_read_b64_tr_b16 v[176:177], v32 offset:16896
    ds_read_b128 v[142:145], v31 offset:2048
    ds_read_b64_tr_b16 v[178:179], v32 offset:20480
    ds_read_b64_tr_b16 v[180:181], v32 offset:20992
    ds_read_b128 v[134:137], v30 offset:4096
    ds_read_b128 v[146:149], v31 offset:4096
    ds_read_b64_tr_b16 v[182:183], v33 offset:16384
    ds_read_b64_tr_b16 v[184:185], v33 offset:16896
    ds_read_b64_tr_b16 v[186:187], v33 offset:20480
    ds_read_b64_tr_b16 v[188:189], v33 offset:20992
    ds_read_b128 v[126:129], v30 offset:0
    v_mfma_f32_16x16x32_bf16 v[106:109], v[162:165], v[194:197], v[106:109]
    v_mfma_f32_16x16x32_bf16 v[114:117], v[154:157], v[190:193], v[114:117]
    ds_read_b64_tr_b16 v[190:191], v32 offset:24576
    v_mfma_f32_16x16x32_bf16 v[114:117], v[166:169], v[194:197], v[114:117]
    ds_read_b64_tr_b16 v[192:193], v32 offset:25088
    s_waitcnt lgkmcnt(12)
    v_mfma_f32_16x16x32_bf16 v[62:65], v[174:177], v[130:133], v[62:65]
    ds_read_b128 v[138:141], v31 offset:0
    s_waitcnt lgkmcnt(10)
    v_mfma_f32_16x16x32_bf16 v[62:65], v[178:181], v[142:145], v[62:65]
    ds_read_b64_tr_b16 v[194:195], v32 offset:28672
    s_waitcnt lgkmcnt(10)
    v_mfma_f32_16x16x32_bf16 v[70:73], v[174:177], v[134:137], v[70:73]
    ds_read_b64_tr_b16 v[196:197], v32 offset:29184
    s_waitcnt lgkmcnt(10)
    v_mfma_f32_16x16x32_bf16 v[70:73], v[178:181], v[146:149], v[70:73]
    ds_read_b64_tr_b16 v[174:175], v33 offset:24576
    s_waitcnt lgkmcnt(9)
    v_mfma_f32_16x16x32_bf16 v[66:69], v[182:185], v[130:133], v[66:69]
    ds_read_b64_tr_b16 v[176:177], v33 offset:25088
    s_waitcnt lgkmcnt(8)
    v_mfma_f32_16x16x32_bf16 v[66:69], v[186:189], v[142:145], v[66:69]
    ds_read_b64_tr_b16 v[178:179], v33 offset:28672
    v_mfma_f32_16x16x32_bf16 v[74:77], v[182:185], v[134:137], v[74:77]
    ds_read_b64_tr_b16 v[180:181], v33 offset:29184
    v_mfma_f32_16x16x32_bf16 v[74:77], v[186:189], v[146:149], v[74:77]
    ds_read_b64_tr_b16 v[182:183], v32 offset:32768
    s_waitcnt lgkmcnt(8)
    v_mfma_f32_16x16x32_bf16 v[78:81], v[190:193], v[126:129], v[78:81]
    ds_read_b64_tr_b16 v[184:185], v32 offset:33280
    s_waitcnt lgkmcnt(6)
    v_mfma_f32_16x16x32_bf16 v[78:81], v[194:197], v[138:141], v[78:81]
    ds_read_b64_tr_b16 v[186:187], v32 offset:36864
    v_mfma_f32_16x16x32_bf16 v[86:89], v[190:193], v[130:133], v[86:89]
    ds_read_b64_tr_b16 v[188:189], v32 offset:37376
    v_mfma_f32_16x16x32_bf16 v[86:89], v[194:197], v[142:145], v[86:89]
    v_mfma_f32_16x16x32_bf16 v[94:97], v[190:193], v[134:137], v[94:97]
    ds_read_b64_tr_b16 v[190:191], v33 offset:32768
    v_mfma_f32_16x16x32_bf16 v[94:97], v[194:197], v[146:149], v[94:97]
    ds_read_b64_tr_b16 v[192:193], v33 offset:33280
    s_waitcnt lgkmcnt(8)
    v_mfma_f32_16x16x32_bf16 v[82:85], v[174:177], v[126:129], v[82:85]
    ds_read_b64_tr_b16 v[194:195], v33 offset:36864
    s_waitcnt lgkmcnt(7)
    v_mfma_f32_16x16x32_bf16 v[82:85], v[178:181], v[138:141], v[82:85]
    ds_read_b64_tr_b16 v[196:197], v33 offset:37376
    v_mfma_f32_16x16x32_bf16 v[90:93], v[174:177], v[130:133], v[90:93]
    v_mfma_f32_16x16x32_bf16 v[90:93], v[178:181], v[142:145], v[90:93]
    v_mfma_f32_16x16x32_bf16 v[98:101], v[174:177], v[134:137], v[98:101]
    v_mfma_f32_16x16x32_bf16 v[98:101], v[178:181], v[146:149], v[98:101]
    s_waitcnt lgkmcnt(6)
    v_mfma_f32_16x16x32_bf16 v[102:105], v[126:129], v[182:185], v[102:105]
    s_waitcnt lgkmcnt(4)
    v_mfma_f32_16x16x32_bf16 v[102:105], v[138:141], v[186:189], v[102:105]
    v_mfma_f32_16x16x32_bf16 v[110:113], v[130:133], v[182:185], v[110:113]
    v_mfma_f32_16x16x32_bf16 v[110:113], v[142:145], v[186:189], v[110:113]
    s_waitcnt lgkmcnt(2)
    v_mfma_f32_16x16x32_bf16 v[106:109], v[126:129], v[190:193], v[106:109]
    s_waitcnt lgkmcnt(0)
    s_barrier
    ds_read_b128 v[154:157], v30 offset:12288
    ds_read_b64_tr_b16 v[174:175], v32 offset:40960
    ds_read_b64_tr_b16 v[176:177], v32 offset:41472
    ds_read_b128 v[166:169], v31 offset:12288
    ds_read_b64_tr_b16 v[178:179], v32 offset:45056
    ds_read_b64_tr_b16 v[180:181], v32 offset:45568
    ds_read_b128 v[158:161], v30 offset:14336
    ds_read_b128 v[170:173], v31 offset:14336
    ds_read_b64_tr_b16 v[182:183], v33 offset:40960
    ds_read_b64_tr_b16 v[184:185], v33 offset:41472
    ds_read_b64_tr_b16 v[186:187], v33 offset:45056
    ds_read_b64_tr_b16 v[188:189], v33 offset:45568
    ds_read_b128 v[150:153], v30 offset:10240
    v_mfma_f32_16x16x32_bf16 v[106:109], v[138:141], v[194:197], v[106:109]
    ds_read_b64_tr_b16 v[198:199], v34 offset:0
    v_mfma_f32_16x16x32_bf16 v[114:117], v[130:133], v[190:193], v[114:117]
    ds_read_b64_tr_b16 v[200:201], v34 offset:512
    v_mfma_f32_16x16x32_bf16 v[114:117], v[142:145], v[194:197], v[114:117]
    ds_read_b128 v[162:165], v31 offset:10240
    s_waitcnt lgkmcnt(13)
    v_mfma_f32_16x16x32_bf16 v[62:65], v[174:177], v[154:157], v[62:65]
    ds_read_b64_tr_b16 v[202:203], v34 offset:4096
    s_waitcnt lgkmcnt(11)
    v_mfma_f32_16x16x32_bf16 v[62:65], v[178:181], v[166:169], v[62:65]
    ds_read_b64_tr_b16 v[204:205], v34 offset:4608
    s_waitcnt lgkmcnt(11)
    v_mfma_f32_16x16x32_bf16 v[70:73], v[174:177], v[158:161], v[70:73]
    ds_read_b64_tr_b16 v[190:191], v35 offset:0
    s_waitcnt lgkmcnt(11)
    v_mfma_f32_16x16x32_bf16 v[70:73], v[178:181], v[170:173], v[70:73]
    ds_read_b64_tr_b16 v[192:193], v35 offset:512
    s_waitcnt lgkmcnt(10)
    v_mfma_f32_16x16x32_bf16 v[66:69], v[182:185], v[154:157], v[66:69]
    ds_read_b64_tr_b16 v[194:195], v35 offset:4096
    s_waitcnt lgkmcnt(9)
    v_mfma_f32_16x16x32_bf16 v[66:69], v[186:189], v[166:169], v[66:69]
    ds_read_b64_tr_b16 v[196:197], v35 offset:4608
    v_mfma_f32_16x16x32_bf16 v[74:77], v[182:185], v[158:161], v[74:77]
    v_mfma_f32_16x16x32_bf16 v[74:77], v[186:189], v[170:173], v[74:77]
    s_waitcnt lgkmcnt(7)
    v_mfma_f32_16x16x32_bf16 v[78:81], v[198:201], v[150:153], v[78:81]
    s_waitcnt lgkmcnt(4)
    v_mfma_f32_16x16x32_bf16 v[78:81], v[202:205], v[162:165], v[78:81]
    v_mfma_f32_16x16x32_bf16 v[86:89], v[198:201], v[154:157], v[86:89]
    v_mfma_f32_16x16x32_bf16 v[86:89], v[202:205], v[166:169], v[86:89]
    v_mfma_f32_16x16x32_bf16 v[94:97], v[198:201], v[158:161], v[94:97]
    v_mfma_f32_16x16x32_bf16 v[94:97], v[202:205], v[170:173], v[94:97]
    s_waitcnt lgkmcnt(2)
    v_mfma_f32_16x16x32_bf16 v[82:85], v[190:193], v[150:153], v[82:85]
    s_waitcnt lgkmcnt(0)
    v_mfma_f32_16x16x32_bf16 v[82:85], v[194:197], v[162:165], v[82:85]
    v_mfma_f32_16x16x32_bf16 v[90:93], v[190:193], v[154:157], v[90:93]
    v_mfma_f32_16x16x32_bf16 v[90:93], v[194:197], v[166:169], v[90:93]
    v_mfma_f32_16x16x32_bf16 v[98:101], v[190:193], v[158:161], v[98:101]
    s_barrier
    ds_read_b128 v[130:133], v30 offset:22528
    ds_read_b64_tr_b16 v[174:175], v34 offset:8192
    ds_read_b64_tr_b16 v[176:177], v34 offset:8704
    ds_read_b128 v[142:145], v31 offset:22528
    ds_read_b64_tr_b16 v[178:179], v34 offset:12288
    ds_read_b64_tr_b16 v[180:181], v34 offset:12800
    ds_read_b128 v[134:137], v30 offset:24576
    ds_read_b128 v[146:149], v31 offset:24576
    ds_read_b64_tr_b16 v[182:183], v35 offset:8192
    ds_read_b64_tr_b16 v[184:185], v35 offset:8704
    ds_read_b64_tr_b16 v[186:187], v35 offset:12288
    ds_read_b64_tr_b16 v[188:189], v35 offset:12800
    ds_read_b128 v[126:129], v30 offset:20480
    v_mfma_f32_16x16x32_bf16 v[98:101], v[194:197], v[170:173], v[98:101]
    ds_read_b128 v[138:141], v31 offset:20480
    s_waitcnt lgkmcnt(11)
    v_mfma_f32_16x16x32_bf16 v[62:65], v[174:177], v[130:133], v[62:65]
    s_barrier
    ds_read_b64_tr_b16 v[198:199], v34 offset:16384
    ds_read_b64_tr_b16 v[200:201], v34 offset:16896
    ds_read_b64_tr_b16 v[202:203], v34 offset:20480
    ds_read_b64_tr_b16 v[204:205], v34 offset:20992
    ds_read_b64_tr_b16 v[190:191], v35 offset:16384
    s_waitcnt lgkmcnt(13)
    v_mfma_f32_16x16x32_bf16 v[62:65], v[178:181], v[142:145], v[62:65]
    ds_read_b64_tr_b16 v[192:193], v35 offset:16896
    s_waitcnt lgkmcnt(13)
    v_mfma_f32_16x16x32_bf16 v[70:73], v[174:177], v[134:137], v[70:73]
    ds_read_b64_tr_b16 v[194:195], v35 offset:20480
    s_waitcnt lgkmcnt(13)
    v_mfma_f32_16x16x32_bf16 v[70:73], v[178:181], v[146:149], v[70:73]
    ds_read_b64_tr_b16 v[196:197], v35 offset:20992
    s_waitcnt lgkmcnt(12)
    v_mfma_f32_16x16x32_bf16 v[66:69], v[182:185], v[130:133], v[66:69]
    v_cvt_pk_bf16_f32 v150, v62, v63
    v_cvt_pk_bf16_f32 v151, v64, v65
    s_waitcnt lgkmcnt(10)
    v_mfma_f32_16x16x32_bf16 v[66:69], v[186:189], v[142:145], v[66:69]
    v_cndmask_b32 v158, 0, v150, s[54:55]
    v_cndmask_b32 v150, v150, 0, s[54:55]
    v_mfma_f32_16x16x32_bf16 v[74:77], v[182:185], v[134:137], v[74:77]
    v_cndmask_b32 v159, 0, v151, s[54:55]
    v_cndmask_b32 v151, v151, 0, s[54:55]
    v_mfma_f32_16x16x32_bf16 v[74:77], v[186:189], v[146:149], v[74:77]
    v_cvt_pk_bf16_f32 v154, v70, v71
    v_cvt_pk_bf16_f32 v155, v72, v73
    s_waitcnt lgkmcnt(6)
    v_mfma_f32_16x16x32_bf16 v[94:97], v[198:201], v[134:137], v[94:97]
    v_cndmask_b32 v162, 0, v154, s[54:55]
    v_cndmask_b32 v154, v154, 0, s[54:55]
    s_waitcnt lgkmcnt(4)
    v_mfma_f32_16x16x32_bf16 v[94:97], v[202:205], v[146:149], v[94:97]
    v_cndmask_b32 v163, 0, v155, s[54:55]
    v_cndmask_b32 v155, v155, 0, s[54:55]
    s_waitcnt lgkmcnt(2)
    v_mfma_f32_16x16x32_bf16 v[98:101], v[190:193], v[134:137], v[98:101]
    v_cvt_pk_bf16_f32 v152, v66, v67
    v_cvt_pk_bf16_f32 v153, v68, v69
    s_waitcnt lgkmcnt(0)
    v_mfma_f32_16x16x32_bf16 v[98:101], v[194:197], v[146:149], v[98:101]
    v_cndmask_b32 v160, 0, v152, s[56:57]
    v_cndmask_b32 v152, v152, 0, s[56:57]
    v_mfma_f32_16x16x32_bf16 v[78:81], v[198:201], v[126:129], v[78:81]
    v_cndmask_b32 v161, 0, v153, s[56:57]
    v_cndmask_b32 v153, v153, 0, s[56:57]
    v_mfma_f32_16x16x32_bf16 v[78:81], v[202:205], v[138:141], v[78:81]
    v_cvt_pk_bf16_f32 v156, v74, v75
    v_cvt_pk_bf16_f32 v157, v76, v77
    v_mfma_f32_16x16x32_bf16 v[82:85], v[190:193], v[126:129], v[82:85]
    v_cndmask_b32 v164, 0, v156, s[56:57]
    v_cndmask_b32 v156, v156, 0, s[56:57]
    v_mfma_f32_16x16x32_bf16 v[82:85], v[194:197], v[138:141], v[82:85]
    v_cndmask_b32 v165, 0, v157, s[56:57]
    v_cndmask_b32 v157, v157, 0, s[56:57]
    v_mfma_f32_16x16x32_bf16 v[86:89], v[198:201], v[130:133], v[86:89]
    v_cvt_pk_bf16_f32 v234, v94, v95
    v_cvt_pk_bf16_f32 v235, v96, v97
    v_mfma_f32_16x16x32_bf16 v[86:89], v[202:205], v[142:145], v[86:89]
    v_cvt_pk_bf16_f32 v236, v98, v99
    v_cvt_pk_bf16_f32 v237, v100, v101
    v_mfma_f32_16x16x32_bf16 v[90:93], v[190:193], v[130:133], v[90:93]
    ds_write_b128 v218, v[234:237]
    ds_write_b32 v220, v5 offset:56
    v_mfma_f32_16x16x32_bf16 v[90:93], v[194:197], v[142:145], v[90:93]
    ds_read_b32 v40, v5 offset:4
    v_cvt_pk_bf16_f32 v226, v78, v79
    v_cvt_pk_bf16_f32 v227, v80, v81
    v_cvt_pk_bf16_f32 v228, v82, v83
    v_cvt_pk_bf16_f32 v229, v84, v85
    s_nop 1
    v_mfma_f32_16x16x32_bf16 v[62:65], v[226:229], v[150:153], 0
    v_mfma_f32_16x16x32_bf16 v[74:77], v[234:237], v[154:157], 0
    v_cvt_pk_bf16_f32 v230, v86, v87
    v_cvt_pk_bf16_f32 v231, v88, v89
    v_cvt_pk_bf16_f32 v232, v90, v91
    v_cvt_pk_bf16_f32 v233, v92, v93
    s_nop 1
    v_mfma_f32_16x16x32_bf16 v[66:69], v[230:233], v[150:153], 0
    v_mfma_f32_16x16x32_bf16 v[70:73], v[230:233], v[154:157], 0
    v_mfma_f32_16x16x32_bf16 v[174:177], v[226:229], v[158:161], 0
    v_mfma_f32_16x16x32_bf16 v[178:181], v[230:233], v[158:161], 0
    s_waitcnt lgkmcnt(0)
    v_readfirstlane_b32 s63, v40
    s_nop 2
    v_cndmask_b32 v66, v66, v67, s[44:45]
    v_cndmask_b32 v68, v68, v69, s[44:45]
    v_cndmask_b32 v62, v62, v63, s[44:45]
    v_cndmask_b32 v64, v64, v65, s[44:45]
    v_cndmask_b32 v62, v62, v45, s[50:51]
    v_cndmask_b32 v64, v64, v45, s[50:51]
    v_cndmask_b32 v210, v62, v66, s[46:47]
    v_cndmask_b32 v211, v64, v68, s[48:49]
    v_cndmask_b32 v74, v74, v75, s[44:45]
    v_cndmask_b32 v76, v76, v77, s[44:45]
    v_cndmask_b32 v70, v70, v71, s[44:45]
    v_cndmask_b32 v72, v72, v73, s[44:45]
    v_cndmask_b32 v212, v70, v74, s[46:47]
    v_cndmask_b32 v213, v72, v76, s[48:49]
    v_and_or_b32 v94, v210, v46, v50
    v_and_or_b32 v95, v211, v46, v51
    v_and_or_b32 v96, v212, v46, v52
    v_and_or_b32 v97, v213, v46, v53
    s_sub_u32 s63, s63, 1
    s_cbranch_scc1 C_mr0
C_md0:
    s_cmp_lg_u32 s101, 0
    s_cbranch_scc1 SM_jS0
    s_cmp_eq_u32 s63, 0
    s_cbranch_scc1 SM_sS0
    buffer_store_dwordx4 v[94:97], v4, s[36:39], s15 offen
SM_jS0:
    v_mfma_f32_16x16x32_bf16 v[182:185], v[230:233], v[162:165], 0
    v_mfma_f32_16x16x32_bf16 v[186:189], v[234:237], v[162:165], 0
    ds_read_b32 v40, v5 offset:32
    ds_read_b64_tr_b16 v[166:167], v34 offset:32768
    ds_read_b64_tr_b16 v[168:169], v34 offset:33280
    ds_read_b64_tr_b16 v[170:171], v35 offset:32768
    ds_read_b64_tr_b16 v[172:173], v35 offset:33280
    ds_read_b64_tr_b16 v[198:199], v34 offset:36864
    ds_read_b64_tr_b16 v[200:201], v34 offset:37376
    ds_read_b64_tr_b16 v[202:203], v35 offset:36864
    ds_read_b64_tr_b16 v[204:205], v35 offset:37376
    v_cndmask_b32 v178, v178, v179, s[44:45]
    v_cndmask_b32 v180, v180, v181, s[44:45]
    v_cndmask_b32 v174, v174, v175, s[44:45]
    v_cndmask_b32 v176, v176, v177, s[44:45]
    v_cndmask_b32 v174, v174, v45, s[50:51]
    v_cndmask_b32 v176, v176, v45, s[50:51]
    v_cndmask_b32 v206, v174, v178, s[46:47]
    v_cndmask_b32 v207, v176, v180, s[48:49]
    v_cndmask_b32 v186, v186, v187, s[44:45]
    v_cndmask_b32 v188, v188, v189, s[44:45]
    v_cndmask_b32 v182, v182, v183, s[44:45]
    v_cndmask_b32 v184, v184, v185, s[44:45]
    v_cndmask_b32 v208, v182, v186, s[46:47]
    v_cndmask_b32 v209, v184, v188, s[48:49]
    ds_write_b128 v42, v[206:209]
    ds_write_b32 v47, v5 offset:16
    s_waitcnt lgkmcnt(10)
    v_cmp_gt_u32 vcc, 4, v40
    s_nop 0
    s_cbranch_vccnz C_vr0
C_vd0:
    s_waitcnt lgkmcnt(8)
    v_mfma_f32_16x16x32_bf16 v[102:105], v[126:129], v[166:169], v[102:105]
    ds_read_b128 v[150:153], v30 offset:10240
    ds_read_b64_tr_b16 v[182:183], v34 offset:24576
    s_waitcnt lgkmcnt(6)
    v_mfma_f32_16x16x32_bf16 v[102:105], v[138:141], v[198:201], v[102:105]
    ds_read_b64_tr_b16 v[184:185], v34 offset:25088
    ds_read_b128 v[162:165], v31 offset:10240
    v_mfma_f32_16x16x32_bf16 v[110:113], v[130:133], v[166:169], v[110:113]
    ds_read_b64_tr_b16 v[190:191], v34 offset:28672
    ds_read_b64_tr_b16 v[192:193], v34 offset:29184
    v_mfma_f32_16x16x32_bf16 v[110:113], v[142:145], v[198:201], v[110:113]
    ds_read_b64_tr_b16 v[186:187], v35 offset:24576
    ds_read_b64_tr_b16 v[188:189], v35 offset:25088
    v_mfma_f32_16x16x32_bf16 v[106:109], v[126:129], v[170:173], v[106:109]
    ds_read_b64_tr_b16 v[194:195], v35 offset:28672
    ds_read_b64_tr_b16 v[196:197], v35 offset:29184
    s_waitcnt lgkmcnt(12)
    v_mfma_f32_16x16x32_bf16 v[106:109], v[138:141], v[202:205], v[106:109]
    ds_read_b128 v[154:157], v30 offset:12288
    ds_read_b128 v[174:177], v31 offset:12288
    v_mfma_f32_16x16x32_bf16 v[114:117], v[130:133], v[170:173], v[114:117]
    v_mfma_f32_16x16x32_bf16 v[114:117], v[142:145], v[202:205], v[114:117]
    s_waitcnt lgkmcnt(9)
    v_mfma_f32_16x16x32_bf16 v[102:105], v[150:153], v[182:185], v[102:105]
    s_waitcnt lgkmcnt(6)
    v_mfma_f32_16x16x32_bf16 v[102:105], v[162:165], v[190:193], v[102:105]
    s_waitcnt lgkmcnt(4)
    v_mfma_f32_16x16x32_bf16 v[106:109], v[150:153], v[186:189], v[106:109]
    s_waitcnt lgkmcnt(2)
    v_mfma_f32_16x16x32_bf16 v[106:109], v[162:165], v[194:197], v[106:109]
    s_waitcnt lgkmcnt(1)
    v_mfma_f32_16x16x32_bf16 v[110:113], v[154:157], v[182:185], v[110:113]
    s_nop 1
    v_cvt_pk_bf16_f32 v226, v102, v103
    v_cvt_pk_bf16_f32 v227, v104, v105
    s_waitcnt lgkmcnt(0)
    v_mfma_f32_16x16x32_bf16 v[110:113], v[174:177], v[190:193], v[110:113]
    v_mfma_f32_16x16x32_bf16 v[114:117], v[154:157], v[186:189], v[114:117]
    v_cvt_pk_bf16_f32 v232, v106, v107
    v_cvt_pk_bf16_f32 v233, v108, v109
    v_mfma_f32_16x16x32_bf16 v[114:117], v[174:177], v[194:197], v[114:117]
    ds_read_b32 v48, v221 offset:68
    ds_read_b64 v[230:231], v219 offset:0
    ds_read_b64 v[236:237], v219 offset:8
    v_cndmask_b32 v126, 0, v226, s[58:59]
    v_cndmask_b32 v226, v226, 0, s[58:59]
    v_cndmask_b32 v127, 0, v227, s[58:59]
    v_cndmask_b32 v227, v227, 0, s[58:59]
    buffer_load_dwordx4 v[214:217], v4, s[36:39], s100 offen sc1
    v_cvt_pk_bf16_f32 v228, v110, v111
    v_cvt_pk_bf16_f32 v229, v112, v113
    v_cvt_pk_bf16_f32 v234, v114, v115
    v_cvt_pk_bf16_f32 v235, v116, v117
    v_cndmask_b32 v132, 0, v232, s[60:61]
    v_cndmask_b32 v232, v232, 0, s[60:61]
    v_cndmask_b32 v133, 0, v233, s[60:61]
    v_cndmask_b32 v233, v233, 0, s[60:61]
    v_cndmask_b32 v128, 0, v228, s[58:59]
    v_cndmask_b32 v228, v228, 0, s[58:59]
    v_cndmask_b32 v129, 0, v229, s[58:59]
    v_cndmask_b32 v229, v229, 0, s[58:59]
    v_cndmask_b32 v134, 0, v234, s[60:61]
    v_cndmask_b32 v234, v234, 0, s[60:61]
    v_cndmask_b32 v135, 0, v235, s[60:61]
    v_cndmask_b32 v235, v235, 0, s[60:61]
    s_waitcnt lgkmcnt(0)
    v_cmp_ne_u32 vcc, 0, v48
    s_nop 0
    s_cbranch_vccnz D_dV0
    s_mov_b32 s9, 0
D_lV0:
    ds_read_b32 v48, v221 offset:68
    ds_read_b64 v[230:231], v219 offset:0
    ds_read_b64 v[236:237], v219 offset:8
    s_add_u32 s9, s9, 1
    s_cmp_gt_u32 s9, 1600000
    s_waitcnt lgkmcnt(0)
    s_cbranch_scc1 D_dV0
    v_cmp_eq_u32 vcc, 0, v48
    s_nop 0
    s_cbranch_vccnz D_lV0
            D_dV0:

    v_cndmask_b32 v130, 0, v230, s[58:59]
    v_cndmask_b32 v230, v230, 0, s[58:59]
    v_cndmask_b32 v131, 0, v231, s[58:59]
    v_cndmask_b32 v231, v231, 0, s[58:59]
    v_cndmask_b32 v136, 0, v236, s[60:61]
    v_cndmask_b32 v236, v236, 0, s[60:61]
    v_cndmask_b32 v137, 0, v237, s[60:61]
    v_cndmask_b32 v237, v237, 0, s[60:61]
    s_branch C_join
C_tp1:
    s_barrier
    ds_read_b128 v[130:133], v28 offset:2048
    ds_read_b64_tr_b16 v[174:175], v32 offset:8192
    ds_read_b64_tr_b16 v[176:177], v32 offset:8704
    ds_read_b128 v[142:145], v29 offset:2048
    ds_read_b64_tr_b16 v[178:179], v32 offset:12288
    ds_read_b64_tr_b16 v[180:181], v32 offset:12800
    ds_read_b128 v[134:137], v28 offset:4096
    ds_read_b128 v[146:149], v29 offset:4096
    ds_read_b64_tr_b16 v[182:183], v33 offset:8192
    ds_read_b64_tr_b16 v[184:185], v33 offset:8704
    ds_read_b64_tr_b16 v[186:187], v33 offset:12288
    ds_read_b64_tr_b16 v[188:189], v33 offset:12800
    s_waitcnt lgkmcnt(9)
    v_mfma_f32_16x16x32_bf16 v[62:65], v[174:177], v[130:133], 0
    ds_read_b64_tr_b16 v[190:191], v32 offset:16384
    s_waitcnt lgkmcnt(7)
    v_mfma_f32_16x16x32_bf16 v[62:65], v[178:181], v[142:145], v[62:65]
    ds_read_b64_tr_b16 v[192:193], v32 offset:16896
    s_waitcnt lgkmcnt(7)
    v_mfma_f32_16x16x32_bf16 v[70:73], v[174:177], v[134:137], 0
    ds_read_b64_tr_b16 v[194:195], v32 offset:20480
    ds_read_b64_tr_b16 v[196:197], v32 offset:20992
    s_waitcnt lgkmcnt(8)
    v_mfma_f32_16x16x32_bf16 v[70:73], v[178:181], v[146:149], v[70:73]
    ds_read_b64_tr_b16 v[174:175], v33 offset:16384
    s_waitcnt lgkmcnt(7)
    v_mfma_f32_16x16x32_bf16 v[66:69], v[182:185], v[130:133], 0
    ds_read_b64_tr_b16 v[176:177], v33 offset:16896
    s_waitcnt lgkmcnt(6)
    v_mfma_f32_16x16x32_bf16 v[66:69], v[186:189], v[142:145], v[66:69]
    ds_read_b64_tr_b16 v[178:179], v33 offset:20480
    v_mfma_f32_16x16x32_bf16 v[74:77], v[182:185], v[134:137], 0
    ds_read_b64_tr_b16 v[180:181], v33 offset:20992
    v_mfma_f32_16x16x32_bf16 v[74:77], v[186:189], v[146:149], v[74:77]
    ds_read_b128 v[126:129], v28 offset:0
    s_waitcnt lgkmcnt(7)
    v_mfma_f32_16x16x32_bf16 v[86:89], v[190:193], v[130:133], 0
    ds_read_b64_tr_b16 v[182:183], v32 offset:24576
    s_waitcnt lgkmcnt(6)
    v_mfma_f32_16x16x32_bf16 v[86:89], v[194:197], v[142:145], v[86:89]
    ds_read_b64_tr_b16 v[184:185], v32 offset:25088
    v_mfma_f32_16x16x32_bf16 v[94:97], v[190:193], v[134:137], 0
    ds_read_b128 v[138:141], v29 offset:0
    ds_read_b64_tr_b16 v[186:187], v32 offset:28672
    v_mfma_f32_16x16x32_bf16 v[94:97], v[194:197], v[146:149], v[94:97]
    ds_read_b64_tr_b16 v[188:189], v32 offset:29184
    s_waitcnt lgkmcnt(8)
    v_mfma_f32_16x16x32_bf16 v[90:93], v[174:177], v[130:133], 0
    ds_read_b64_tr_b16 v[190:191], v33 offset:24576
    s_waitcnt lgkmcnt(7)
    v_mfma_f32_16x16x32_bf16 v[90:93], v[178:181], v[142:145], v[90:93]
    ds_read_b64_tr_b16 v[192:193], v33 offset:25088
    v_mfma_f32_16x16x32_bf16 v[98:101], v[174:177], v[134:137], 0
    ds_read_b64_tr_b16 v[194:195], v33 offset:28672
    v_mfma_f32_16x16x32_bf16 v[98:101], v[178:181], v[146:149], v[98:101]
    ds_read_b64_tr_b16 v[196:197], v33 offset:29184
    s_waitcnt lgkmcnt(7)
    v_mfma_f32_16x16x32_bf16 v[102:105], v[126:129], v[182:185], 0
    s_waitcnt lgkmcnt(4)
    v_mfma_f32_16x16x32_bf16 v[102:105], v[138:141], v[186:189], v[102:105]
    v_mfma_f32_16x16x32_bf16 v[110:113], v[130:133], v[182:185], 0
    v_mfma_f32_16x16x32_bf16 v[110:113], v[142:145], v[186:189], v[110:113]
    v_mfma_f32_16x16x32_bf16 v[118:121], v[134:137], v[182:185], 0
    v_mfma_f32_16x16x32_bf16 v[118:121], v[146:149], v[186:189], v[118:121]
    s_waitcnt lgkmcnt(2)
    v_mfma_f32_16x16x32_bf16 v[106:109], v[126:129], v[190:193], 0
    s_waitcnt lgkmcnt(0)
    v_mfma_f32_16x16x32_bf16 v[106:109], v[138:141], v[194:197], v[106:109]
    v_mfma_f32_16x16x32_bf16 v[114:117], v[130:133], v[190:193], 0
    s_barrier
    ds_read_b128 v[154:157], v28 offset:12288
    ds_read_b64_tr_b16 v[174:175], v32 offset:32768
    ds_read_b64_tr_b16 v[176:177], v32 offset:33280
    ds_read_b128 v[166:169], v29 offset:12288
    ds_read_b64_tr_b16 v[178:179], v32 offset:36864
    ds_read_b64_tr_b16 v[180:181], v32 offset:37376
    ds_read_b128 v[158:161], v28 offset:14336
    ds_read_b128 v[170:173], v29 offset:14336
    ds_read_b64_tr_b16 v[182:183], v33 offset:32768
    ds_read_b64_tr_b16 v[184:185], v33 offset:33280
    ds_read_b64_tr_b16 v[186:187], v33 offset:36864
    ds_read_b64_tr_b16 v[188:189], v33 offset:37376
    v_mfma_f32_16x16x32_bf16 v[114:117], v[142:145], v[194:197], v[114:117]
    v_mfma_f32_16x16x32_bf16 v[122:125], v[134:137], v[190:193], 0
    ds_read_b64_tr_b16 v[190:191], v32 offset:40960
    v_mfma_f32_16x16x32_bf16 v[122:125], v[146:149], v[194:197], v[122:125]
    ds_read_b64_tr_b16 v[192:193], v32 offset:41472
    s_waitcnt lgkmcnt(11)
    v_mfma_f32_16x16x32_bf16 v[62:65], v[174:177], v[154:157], v[62:65]
    ds_read_b64_tr_b16 v[194:195], v32 offset:45056
    s_waitcnt lgkmcnt(9)
    v_mfma_f32_16x16x32_bf16 v[62:65], v[178:181], v[166:169], v[62:65]
    ds_read_b64_tr_b16 v[196:197], v32 offset:45568
    s_waitcnt lgkmcnt(9)
    v_mfma_f32_16x16x32_bf16 v[70:73], v[174:177], v[158:161], v[70:73]
    ds_read_b64_tr_b16 v[174:175], v33 offset:40960
    s_waitcnt lgkmcnt(9)
    v_mfma_f32_16x16x32_bf16 v[70:73], v[178:181], v[170:173], v[70:73]
    ds_read_b64_tr_b16 v[176:177], v33 offset:41472
    s_waitcnt lgkmcnt(8)
    v_mfma_f32_16x16x32_bf16 v[66:69], v[182:185], v[154:157], v[66:69]
    ds_read_b64_tr_b16 v[178:179], v33 offset:45056
    s_waitcnt lgkmcnt(7)
    v_mfma_f32_16x16x32_bf16 v[66:69], v[186:189], v[166:169], v[66:69]
    ds_read_b64_tr_b16 v[180:181], v33 offset:45568
    v_mfma_f32_16x16x32_bf16 v[74:77], v[182:185], v[158:161], v[74:77]
    ds_read_b128 v[150:153], v28 offset:10240
    v_mfma_f32_16x16x32_bf16 v[74:77], v[186:189], v[170:173], v[74:77]
    ds_read_b64_tr_b16 v[182:183], v34 offset:0
    s_waitcnt lgkmcnt(8)
    v_mfma_f32_16x16x32_bf16 v[86:89], v[190:193], v[154:157], v[86:89]
    ds_read_b64_tr_b16 v[184:185], v34 offset:512
    s_waitcnt lgkmcnt(7)
    v_mfma_f32_16x16x32_bf16 v[86:89], v[194:197], v[166:169], v[86:89]
    ds_read_b128 v[162:165], v29 offset:10240
    v_mfma_f32_16x16x32_bf16 v[94:97], v[190:193], v[158:161], v[94:97]
    ds_read_b64_tr_b16 v[186:187], v34 offset:4096
    ds_read_b64_tr_b16 v[188:189], v34 offset:4608
    v_mfma_f32_16x16x32_bf16 v[94:97], v[194:197], v[170:173], v[94:97]
    ds_read_b64_tr_b16 v[190:191], v35 offset:0
    s_waitcnt lgkmcnt(9)
    v_mfma_f32_16x16x32_bf16 v[90:93], v[174:177], v[154:157], v[90:93]
    ds_read_b64_tr_b16 v[192:193], v35 offset:512
    s_waitcnt lgkmcnt(8)
    v_mfma_f32_16x16x32_bf16 v[90:93], v[178:181], v[166:169], v[90:93]
    ds_read_b64_tr_b16 v[194:195], v35 offset:4096
    v_mfma_f32_16x16x32_bf16 v[98:101], v[174:177], v[158:161], v[98:101]
    ds_read_b64_tr_b16 v[196:197], v35 offset:4608
    v_mfma_f32_16x16x32_bf16 v[98:101], v[178:181], v[170:173], v[98:101]
    s_waitcnt lgkmcnt(7)
    v_mfma_f32_16x16x32_bf16 v[102:105], v[150:153], v[182:185], v[102:105]
    s_waitcnt lgkmcnt(4)
    v_mfma_f32_16x16x32_bf16 v[102:105], v[162:165], v[186:189], v[102:105]
    v_mfma_f32_16x16x32_bf16 v[110:113], v[154:157], v[182:185], v[110:113]
    v_mfma_f32_16x16x32_bf16 v[110:113], v[166:169], v[186:189], v[110:113]
    v_mfma_f32_16x16x32_bf16 v[118:121], v[158:161], v[182:185], v[118:121]
    v_mfma_f32_16x16x32_bf16 v[118:121], v[170:173], v[186:189], v[118:121]
    s_waitcnt lgkmcnt(2)
    v_mfma_f32_16x16x32_bf16 v[106:109], v[150:153], v[190:193], v[106:109]
    s_waitcnt lgkmcnt(0)
    v_mfma_f32_16x16x32_bf16 v[106:109], v[162:165], v[194:197], v[106:109]
    v_mfma_f32_16x16x32_bf16 v[114:117], v[154:157], v[190:193], v[114:117]
    s_barrier
    ds_read_b128 v[130:133], v28 offset:22528
    ds_read_b64_tr_b16 v[174:175], v34 offset:8192
    ds_read_b64_tr_b16 v[176:177], v34 offset:8704
    ds_read_b128 v[142:145], v29 offset:22528
    ds_read_b64_tr_b16 v[178:179], v34 offset:12288
    ds_read_b64_tr_b16 v[180:181], v34 offset:12800
    ds_read_b128 v[134:137], v28 offset:24576
    ds_read_b128 v[146:149], v29 offset:24576
    ds_read_b64_tr_b16 v[182:183], v35 offset:8192
    ds_read_b64_tr_b16 v[184:185], v35 offset:8704
    ds_read_b64_tr_b16 v[186:187], v35 offset:12288
    ds_read_b64_tr_b16 v[188:189], v35 offset:12800
    v_mfma_f32_16x16x32_bf16 v[114:117], v[166:169], v[194:197], v[114:117]
    v_mfma_f32_16x16x32_bf16 v[122:125], v[158:161], v[190:193], v[122:125]
    ds_read_b64_tr_b16 v[190:191], v34 offset:16384
    v_mfma_f32_16x16x32_bf16 v[122:125], v[170:173], v[194:197], v[122:125]
    ds_read_b64_tr_b16 v[192:193], v34 offset:16896
    s_waitcnt lgkmcnt(11)
    v_mfma_f32_16x16x32_bf16 v[62:65], v[174:177], v[130:133], v[62:65]
    ds_read_b64_tr_b16 v[194:195], v34 offset:20480
    s_waitcnt lgkmcnt(9)
    v_mfma_f32_16x16x32_bf16 v[62:65], v[178:181], v[142:145], v[62:65]
    ds_read_b64_tr_b16 v[196:197], v34 offset:20992
    s_waitcnt lgkmcnt(9)
    v_mfma_f32_16x16x32_bf16 v[70:73], v[174:177], v[134:137], v[70:73]
    ds_read_b64_tr_b16 v[174:175], v35 offset:16384
    s_waitcnt lgkmcnt(9)
    v_mfma_f32_16x16x32_bf16 v[70:73], v[178:181], v[146:149], v[70:73]
    ds_read_b64_tr_b16 v[176:177], v35 offset:16896
    s_waitcnt lgkmcnt(8)
    v_mfma_f32_16x16x32_bf16 v[66:69], v[182:185], v[130:133], v[66:69]
    ds_read_b64_tr_b16 v[178:179], v35 offset:20480
    s_waitcnt lgkmcnt(7)
    v_mfma_f32_16x16x32_bf16 v[66:69], v[186:189], v[142:145], v[66:69]
    ds_read_b64_tr_b16 v[180:181], v35 offset:20992
    v_mfma_f32_16x16x32_bf16 v[74:77], v[182:185], v[134:137], v[74:77]
    ds_read_b128 v[126:129], v28 offset:20480
    v_mfma_f32_16x16x32_bf16 v[74:77], v[186:189], v[146:149], v[74:77]
    ds_read_b64_tr_b16 v[182:183], v34 offset:24576
    s_waitcnt lgkmcnt(8)
    v_mfma_f32_16x16x32_bf16 v[86:89], v[190:193], v[130:133], v[86:89]
    ds_read_b64_tr_b16 v[184:185], v34 offset:25088
    s_waitcnt lgkmcnt(7)
    v_mfma_f32_16x16x32_bf16 v[86:89], v[194:197], v[142:145], v[86:89]
    ds_read_b128 v[138:141], v29 offset:20480
    v_mfma_f32_16x16x32_bf16 v[94:97], v[190:193], v[134:137], v[94:97]
    ds_read_b64_tr_b16 v[186:187], v34 offset:28672
    ds_read_b64_tr_b16 v[188:189], v34 offset:29184
    v_mfma_f32_16x16x32_bf16 v[94:97], v[194:197], v[146:149], v[94:97]
    ds_read_b64_tr_b16 v[190:191], v35 offset:24576
    s_waitcnt lgkmcnt(9)
    v_mfma_f32_16x16x32_bf16 v[90:93], v[174:177], v[130:133], v[90:93]
    ds_read_b64_tr_b16 v[192:193], v35 offset:25088
    s_waitcnt lgkmcnt(8)
    v_mfma_f32_16x16x32_bf16 v[90:93], v[178:181], v[142:145], v[90:93]
    ds_read_b64_tr_b16 v[194:195], v35 offset:28672
    v_mfma_f32_16x16x32_bf16 v[98:101], v[174:177], v[134:137], v[98:101]
    ds_read_b64_tr_b16 v[196:197], v35 offset:29184
    v_mfma_f32_16x16x32_bf16 v[98:101], v[178:181], v[146:149], v[98:101]
    s_waitcnt lgkmcnt(7)
    v_mfma_f32_16x16x32_bf16 v[102:105], v[126:129], v[182:185], v[102:105]
    s_waitcnt lgkmcnt(4)
    v_mfma_f32_16x16x32_bf16 v[102:105], v[138:141], v[186:189], v[102:105]
    v_mfma_f32_16x16x32_bf16 v[110:113], v[130:133], v[182:185], v[110:113]
    v_mfma_f32_16x16x32_bf16 v[110:113], v[142:145], v[186:189], v[110:113]
    v_mfma_f32_16x16x32_bf16 v[118:121], v[134:137], v[182:185], v[118:121]
    v_mfma_f32_16x16x32_bf16 v[118:121], v[146:149], v[186:189], v[118:121]
    s_waitcnt lgkmcnt(2)
    v_mfma_f32_16x16x32_bf16 v[106:109], v[126:129], v[190:193], v[106:109]
    s_waitcnt lgkmcnt(0)
    v_mfma_f32_16x16x32_bf16 v[106:109], v[138:141], v[194:197], v[106:109]
    v_mfma_f32_16x16x32_bf16 v[114:117], v[130:133], v[190:193], v[114:117]
    s_barrier
    ds_read_b128 v[154:157], v28 offset:32768
    ds_read_b64_tr_b16 v[174:175], v34 offset:32768
    ds_read_b64_tr_b16 v[176:177], v34 offset:33280
    ds_read_b128 v[166:169], v29 offset:32768
    ds_read_b64_tr_b16 v[178:179], v34 offset:36864
    ds_read_b64_tr_b16 v[180:181], v34 offset:37376
    ds_read_b128 v[158:161], v28 offset:34816
    ds_read_b128 v[170:173], v29 offset:34816
    ds_read_b64_tr_b16 v[182:183], v35 offset:32768
    ds_read_b64_tr_b16 v[184:185], v35 offset:33280
    ds_read_b64_tr_b16 v[186:187], v35 offset:36864
    ds_read_b64_tr_b16 v[188:189], v35 offset:37376
    v_mfma_f32_16x16x32_bf16 v[114:117], v[142:145], v[194:197], v[114:117]
    v_mfma_f32_16x16x32_bf16 v[122:125], v[134:137], v[190:193], v[122:125]
    ds_read_b64_tr_b16 v[190:191], v32 offset:0
    v_mfma_f32_16x16x32_bf16 v[122:125], v[146:149], v[194:197], v[122:125]
    ds_read_b64_tr_b16 v[192:193], v32 offset:512
    s_waitcnt lgkmcnt(11)
    v_mfma_f32_16x16x32_bf16 v[62:65], v[174:177], v[154:157], v[62:65]
    ds_read_b64_tr_b16 v[194:195], v32 offset:4096
    s_waitcnt lgkmcnt(9)
    v_mfma_f32_16x16x32_bf16 v[62:65], v[178:181], v[166:169], v[62:65]
    ds_read_b64_tr_b16 v[196:197], v32 offset:4608
    s_waitcnt lgkmcnt(9)
    v_mfma_f32_16x16x32_bf16 v[70:73], v[174:177], v[158:161], v[70:73]
    ds_read_b64_tr_b16 v[174:175], v33 offset:0
    s_waitcnt lgkmcnt(9)
    v_mfma_f32_16x16x32_bf16 v[70:73], v[178:181], v[170:173], v[70:73]
    ds_read_b64_tr_b16 v[176:177], v33 offset:512
    s_waitcnt lgkmcnt(8)
    v_mfma_f32_16x16x32_bf16 v[66:69], v[182:185], v[154:157], v[66:69]
    ds_read_b64_tr_b16 v[178:179], v33 offset:4096
    s_waitcnt lgkmcnt(7)
    v_mfma_f32_16x16x32_bf16 v[66:69], v[186:189], v[166:169], v[66:69]
    ds_read_b64_tr_b16 v[180:181], v33 offset:4608
    v_mfma_f32_16x16x32_bf16 v[74:77], v[182:185], v[158:161], v[74:77]
    ds_read_b128 v[150:153], v28 offset:30720
    v_mfma_f32_16x16x32_bf16 v[74:77], v[186:189], v[170:173], v[74:77]
    ds_read_b64_tr_b16 v[182:183], v32 offset:8192
    s_waitcnt lgkmcnt(8)
    v_mfma_f32_16x16x32_bf16 v[86:89], v[190:193], v[154:157], v[86:89]
    ds_read_b64_tr_b16 v[184:185], v32 offset:8704
    s_waitcnt lgkmcnt(7)
    v_mfma_f32_16x16x32_bf16 v[86:89], v[194:197], v[166:169], v[86:89]
    ds_read_b128 v[162:165], v29 offset:30720
    v_mfma_f32_16x16x32_bf16 v[94:97], v[190:193], v[158:161], v[94:97]
    ds_read_b64_tr_b16 v[186:187], v32 offset:12288
    ds_read_b64_tr_b16 v[188:189], v32 offset:12800
    v_mfma_f32_16x16x32_bf16 v[94:97], v[194:197], v[170:173], v[94:97]
    ds_read_b64_tr_b16 v[190:191], v33 offset:8192
    s_waitcnt lgkmcnt(9)
    v_mfma_f32_16x16x32_bf16 v[90:93], v[174:177], v[154:157], v[90:93]
    ds_read_b64_tr_b16 v[192:193], v33 offset:8704
    s_waitcnt lgkmcnt(8)
    v_mfma_f32_16x16x32_bf16 v[90:93], v[178:181], v[166:169], v[90:93]
    ds_read_b64_tr_b16 v[194:195], v33 offset:12288
    v_mfma_f32_16x16x32_bf16 v[98:101], v[174:177], v[158:161], v[98:101]
    ds_read_b64_tr_b16 v[196:197], v33 offset:12800
    v_mfma_f32_16x16x32_bf16 v[98:101], v[178:181], v[170:173], v[98:101]
    s_waitcnt lgkmcnt(7)
    v_mfma_f32_16x16x32_bf16 v[102:105], v[150:153], v[182:185], v[102:105]
    s_waitcnt lgkmcnt(4)
    v_mfma_f32_16x16x32_bf16 v[102:105], v[162:165], v[186:189], v[102:105]
    v_mfma_f32_16x16x32_bf16 v[110:113], v[154:157], v[182:185], v[110:113]
    v_mfma_f32_16x16x32_bf16 v[110:113], v[166:169], v[186:189], v[110:113]
    v_mfma_f32_16x16x32_bf16 v[118:121], v[158:161], v[182:185], v[118:121]
    v_mfma_f32_16x16x32_bf16 v[118:121], v[170:173], v[186:189], v[118:121]
    s_waitcnt lgkmcnt(2)
    v_mfma_f32_16x16x32_bf16 v[106:109], v[150:153], v[190:193], v[106:109]
    s_waitcnt lgkmcnt(0)
    v_mfma_f32_16x16x32_bf16 v[106:109], v[162:165], v[194:197], v[106:109]
    v_mfma_f32_16x16x32_bf16 v[114:117], v[154:157], v[190:193], v[114:117]
    s_barrier
    ds_read_b128 v[130:133], v30 offset:2048
    ds_read_b64_tr_b16 v[174:175], v32 offset:16384
    ds_read_b64_tr_b16 v[176:177], v32 offset:16896
    ds_read_b128 v[142:145], v31 offset:2048
    ds_read_b64_tr_b16 v[178:179], v32 offset:20480
    ds_read_b64_tr_b16 v[180:181], v32 offset:20992
    ds_read_b128 v[134:137], v30 offset:4096
    ds_read_b128 v[146:149], v31 offset:4096
    ds_read_b64_tr_b16 v[182:183], v33 offset:16384
    ds_read_b64_tr_b16 v[184:185], v33 offset:16896
    ds_read_b64_tr_b16 v[186:187], v33 offset:20480
    ds_read_b64_tr_b16 v[188:189], v33 offset:20992
    v_mfma_f32_16x16x32_bf16 v[114:117], v[166:169], v[194:197], v[114:117]
    v_mfma_f32_16x16x32_bf16 v[122:125], v[158:161], v[190:193], v[122:125]
    ds_read_b64_tr_b16 v[190:191], v32 offset:24576
    v_mfma_f32_16x16x32_bf16 v[122:125], v[170:173], v[194:197], v[122:125]
    ds_read_b64_tr_b16 v[192:193], v32 offset:25088
    s_waitcnt lgkmcnt(11)
    v_mfma_f32_16x16x32_bf16 v[62:65], v[174:177], v[130:133], v[62:65]
    ds_read_b64_tr_b16 v[194:195], v32 offset:28672
    s_waitcnt lgkmcnt(9)
    v_mfma_f32_16x16x32_bf16 v[62:65], v[178:181], v[142:145], v[62:65]
    ds_read_b64_tr_b16 v[196:197], v32 offset:29184
    s_waitcnt lgkmcnt(9)
    v_mfma_f32_16x16x32_bf16 v[70:73], v[174:177], v[134:137], v[70:73]
    ds_read_b64_tr_b16 v[174:175], v33 offset:24576
    s_waitcnt lgkmcnt(9)
    v_mfma_f32_16x16x32_bf16 v[70:73], v[178:181], v[146:149], v[70:73]
    ds_read_b64_tr_b16 v[176:177], v33 offset:25088
    s_waitcnt lgkmcnt(8)
    v_mfma_f32_16x16x32_bf16 v[66:69], v[182:185], v[130:133], v[66:69]
    ds_read_b64_tr_b16 v[178:179], v33 offset:28672
    s_waitcnt lgkmcnt(7)
    v_mfma_f32_16x16x32_bf16 v[66:69], v[186:189], v[142:145], v[66:69]
    ds_read_b64_tr_b16 v[180:181], v33 offset:29184
    v_mfma_f32_16x16x32_bf16 v[74:77], v[182:185], v[134:137], v[74:77]
    ds_read_b128 v[126:129], v30 offset:0
    v_mfma_f32_16x16x32_bf16 v[74:77], v[186:189], v[146:149], v[74:77]
    ds_read_b64_tr_b16 v[182:183], v32 offset:32768
    s_waitcnt lgkmcnt(8)
    v_mfma_f32_16x16x32_bf16 v[86:89], v[190:193], v[130:133], v[86:89]
    ds_read_b64_tr_b16 v[184:185], v32 offset:33280
    s_waitcnt lgkmcnt(7)
    v_mfma_f32_16x16x32_bf16 v[86:89], v[194:197], v[142:145], v[86:89]
    ds_read_b128 v[138:141], v31 offset:0
    v_mfma_f32_16x16x32_bf16 v[94:97], v[190:193], v[134:137], v[94:97]
    ds_read_b64_tr_b16 v[186:187], v32 offset:36864
    ds_read_b64_tr_b16 v[188:189], v32 offset:37376
    v_mfma_f32_16x16x32_bf16 v[94:97], v[194:197], v[146:149], v[94:97]
    ds_read_b64_tr_b16 v[190:191], v33 offset:32768
    s_waitcnt lgkmcnt(9)
    v_mfma_f32_16x16x32_bf16 v[90:93], v[174:177], v[130:133], v[90:93]
    ds_read_b64_tr_b16 v[192:193], v33 offset:33280
    s_waitcnt lgkmcnt(8)
    v_mfma_f32_16x16x32_bf16 v[90:93], v[178:181], v[142:145], v[90:93]
    ds_read_b64_tr_b16 v[194:195], v33 offset:36864
    v_mfma_f32_16x16x32_bf16 v[98:101], v[174:177], v[134:137], v[98:101]
    ds_read_b64_tr_b16 v[196:197], v33 offset:37376
    v_mfma_f32_16x16x32_bf16 v[98:101], v[178:181], v[146:149], v[98:101]
    s_waitcnt lgkmcnt(7)
    v_mfma_f32_16x16x32_bf16 v[102:105], v[126:129], v[182:185], v[102:105]
    s_waitcnt lgkmcnt(4)
    v_mfma_f32_16x16x32_bf16 v[102:105], v[138:141], v[186:189], v[102:105]
    v_mfma_f32_16x16x32_bf16 v[110:113], v[130:133], v[182:185], v[110:113]
    v_mfma_f32_16x16x32_bf16 v[110:113], v[142:145], v[186:189], v[110:113]
    v_mfma_f32_16x16x32_bf16 v[118:121], v[134:137], v[182:185], v[118:121]
    v_mfma_f32_16x16x32_bf16 v[118:121], v[146:149], v[186:189], v[118:121]
    s_waitcnt lgkmcnt(2)
    v_mfma_f32_16x16x32_bf16 v[106:109], v[126:129], v[190:193], v[106:109]
    s_waitcnt lgkmcnt(0)
    v_mfma_f32_16x16x32_bf16 v[106:109], v[138:141], v[194:197], v[106:109]
    v_mfma_f32_16x16x32_bf16 v[114:117], v[130:133], v[190:193], v[114:117]
    s_barrier
    ds_read_b128 v[154:157], v30 offset:12288
    ds_read_b64_tr_b16 v[174:175], v32 offset:40960
    ds_read_b64_tr_b16 v[176:177], v32 offset:41472
    ds_read_b128 v[166:169], v31 offset:12288
    ds_read_b64_tr_b16 v[178:179], v32 offset:45056
    ds_read_b64_tr_b16 v[180:181], v32 offset:45568
    ds_read_b128 v[158:161], v30 offset:14336
    ds_read_b128 v[170:173], v31 offset:14336
    ds_read_b64_tr_b16 v[182:183], v33 offset:40960
    ds_read_b64_tr_b16 v[184:185], v33 offset:41472
    ds_read_b64_tr_b16 v[186:187], v33 offset:45056
    ds_read_b64_tr_b16 v[188:189], v33 offset:45568
    ds_read_b64_tr_b16 v[198:199], v34 offset:0
    v_mfma_f32_16x16x32_bf16 v[114:117], v[142:145], v[194:197], v[114:117]
    ds_read_b64_tr_b16 v[200:201], v34 offset:512
    v_mfma_f32_16x16x32_bf16 v[122:125], v[134:137], v[190:193], v[122:125]
    ds_read_b64_tr_b16 v[202:203], v34 offset:4096
    v_mfma_f32_16x16x32_bf16 v[122:125], v[146:149], v[194:197], v[122:125]
    ds_read_b64_tr_b16 v[204:205], v34 offset:4608
    s_waitcnt lgkmcnt(13)
    v_mfma_f32_16x16x32_bf16 v[62:65], v[174:177], v[154:157], v[62:65]
    ds_read_b64_tr_b16 v[190:191], v35 offset:0
    s_waitcnt lgkmcnt(11)
    v_mfma_f32_16x16x32_bf16 v[62:65], v[178:181], v[166:169], v[62:65]
    ds_read_b64_tr_b16 v[192:193], v35 offset:512
    s_waitcnt lgkmcnt(11)
    v_mfma_f32_16x16x32_bf16 v[70:73], v[174:177], v[158:161], v[70:73]
    ds_read_b64_tr_b16 v[194:195], v35 offset:4096
    s_waitcnt lgkmcnt(11)
    v_mfma_f32_16x16x32_bf16 v[70:73], v[178:181], v[170:173], v[70:73]
    ds_read_b64_tr_b16 v[196:197], v35 offset:4608
    s_waitcnt lgkmcnt(10)
    v_mfma_f32_16x16x32_bf16 v[66:69], v[182:185], v[154:157], v[66:69]
    s_waitcnt lgkmcnt(8)
    v_mfma_f32_16x16x32_bf16 v[66:69], v[186:189], v[166:169], v[66:69]
    v_mfma_f32_16x16x32_bf16 v[74:77], v[182:185], v[158:161], v[74:77]
    v_mfma_f32_16x16x32_bf16 v[74:77], v[186:189], v[170:173], v[74:77]
    s_waitcnt lgkmcnt(6)
    v_mfma_f32_16x16x32_bf16 v[86:89], v[198:201], v[154:157], v[86:89]
    s_waitcnt lgkmcnt(4)
    v_mfma_f32_16x16x32_bf16 v[86:89], v[202:205], v[166:169], v[86:89]
    v_mfma_f32_16x16x32_bf16 v[94:97], v[198:201], v[158:161], v[94:97]
    v_mfma_f32_16x16x32_bf16 v[94:97], v[202:205], v[170:173], v[94:97]
    s_waitcnt lgkmcnt(2)
    v_mfma_f32_16x16x32_bf16 v[90:93], v[190:193], v[154:157], v[90:93]
    s_waitcnt lgkmcnt(0)
    v_mfma_f32_16x16x32_bf16 v[90:93], v[194:197], v[166:169], v[90:93]
    v_mfma_f32_16x16x32_bf16 v[98:101], v[190:193], v[158:161], v[98:101]
    s_barrier
    ds_read_b128 v[130:133], v30 offset:22528
    ds_read_b64_tr_b16 v[174:175], v34 offset:8192
    ds_read_b64_tr_b16 v[176:177], v34 offset:8704
    ds_read_b128 v[142:145], v31 offset:22528
    ds_read_b64_tr_b16 v[178:179], v34 offset:12288
    ds_read_b64_tr_b16 v[180:181], v34 offset:12800
    ds_read_b128 v[134:137], v30 offset:24576
    ds_read_b128 v[146:149], v31 offset:24576
    ds_read_b64_tr_b16 v[182:183], v35 offset:8192
    ds_read_b64_tr_b16 v[184:185], v35 offset:8704
    ds_read_b64_tr_b16 v[186:187], v35 offset:12288
    ds_read_b64_tr_b16 v[188:189], v35 offset:12800
    ds_read_b128 v[126:129], v30 offset:20480
    v_mfma_f32_16x16x32_bf16 v[98:101], v[194:197], v[170:173], v[98:101]
    ds_read_b128 v[138:141], v31 offset:20480
    s_waitcnt lgkmcnt(11)
    v_mfma_f32_16x16x32_bf16 v[62:65], v[174:177], v[130:133], v[62:65]
    s_barrier
    ds_read_b64_tr_b16 v[198:199], v34 offset:16384
    ds_read_b64_tr_b16 v[200:201], v34 offset:16896
    ds_read_b64_tr_b16 v[202:203], v34 offset:20480
    ds_read_b64_tr_b16 v[204:205], v34 offset:20992
    ds_read_b64_tr_b16 v[190:191], v35 offset:16384
    s_waitcnt lgkmcnt(13)
    v_mfma_f32_16x16x32_bf16 v[62:65], v[178:181], v[142:145], v[62:65]
    ds_read_b64_tr_b16 v[192:193], v35 offset:16896
    s_waitcnt lgkmcnt(13)
    v_mfma_f32_16x16x32_bf16 v[70:73], v[174:177], v[134:137], v[70:73]
    ds_read_b64_tr_b16 v[194:195], v35 offset:20480
    s_waitcnt lgkmcnt(13)
    v_mfma_f32_16x16x32_bf16 v[70:73], v[178:181], v[146:149], v[70:73]
    ds_read_b64_tr_b16 v[196:197], v35 offset:20992
    s_waitcnt lgkmcnt(12)
    v_mfma_f32_16x16x32_bf16 v[66:69], v[182:185], v[130:133], v[66:69]
    v_cvt_pk_bf16_f32 v150, v62, v63
    v_cvt_pk_bf16_f32 v151, v64, v65
    s_waitcnt lgkmcnt(10)
    v_mfma_f32_16x16x32_bf16 v[66:69], v[186:189], v[142:145], v[66:69]
    v_cndmask_b32 v158, 0, v150, s[54:55]
    v_cndmask_b32 v150, v150, 0, s[54:55]
    v_mfma_f32_16x16x32_bf16 v[74:77], v[182:185], v[134:137], v[74:77]
    v_cndmask_b32 v159, 0, v151, s[54:55]
    v_cndmask_b32 v151, v151, 0, s[54:55]
    v_mfma_f32_16x16x32_bf16 v[74:77], v[186:189], v[146:149], v[74:77]
    v_cvt_pk_bf16_f32 v154, v70, v71
    v_cvt_pk_bf16_f32 v155, v72, v73
    s_waitcnt lgkmcnt(6)
    v_mfma_f32_16x16x32_bf16 v[86:89], v[198:201], v[130:133], v[86:89]
    v_cndmask_b32 v162, 0, v154, s[54:55]
    v_cndmask_b32 v154, v154, 0, s[54:55]
    s_waitcnt lgkmcnt(4)
    v_mfma_f32_16x16x32_bf16 v[86:89], v[202:205], v[142:145], v[86:89]
    v_cndmask_b32 v163, 0, v155, s[54:55]
    v_cndmask_b32 v155, v155, 0, s[54:55]
    s_waitcnt lgkmcnt(2)
    v_mfma_f32_16x16x32_bf16 v[90:93], v[190:193], v[130:133], v[90:93]
    v_cvt_pk_bf16_f32 v152, v66, v67
    v_cvt_pk_bf16_f32 v153, v68, v69
    s_waitcnt lgkmcnt(0)
    v_mfma_f32_16x16x32_bf16 v[90:93], v[194:197], v[142:145], v[90:93]
    v_cndmask_b32 v160, 0, v152, s[56:57]
    v_cndmask_b32 v152, v152, 0, s[56:57]
    v_mfma_f32_16x16x32_bf16 v[94:97], v[198:201], v[134:137], v[94:97]
    v_cndmask_b32 v161, 0, v153, s[56:57]
    v_cndmask_b32 v153, v153, 0, s[56:57]
    v_mfma_f32_16x16x32_bf16 v[94:97], v[202:205], v[146:149], v[94:97]
    v_cvt_pk_bf16_f32 v156, v74, v75
    v_cvt_pk_bf16_f32 v157, v76, v77
    v_mfma_f32_16x16x32_bf16 v[98:101], v[190:193], v[134:137], v[98:101]
    v_cndmask_b32 v164, 0, v156, s[56:57]
    v_cndmask_b32 v156, v156, 0, s[56:57]
    v_mfma_f32_16x16x32_bf16 v[98:101], v[194:197], v[146:149], v[98:101]
    ds_read_b32 v40, v5 offset:4
    v_cndmask_b32 v165, 0, v157, s[56:57]
    v_cndmask_b32 v157, v157, 0, s[56:57]
    ds_read_b32 v48, v220 offset:56
    ds_read_b128 v[226:229], v218
    v_cvt_pk_bf16_f32 v230, v86, v87
    v_cvt_pk_bf16_f32 v231, v88, v89
    v_cvt_pk_bf16_f32 v232, v90, v91
    v_cvt_pk_bf16_f32 v233, v92, v93
    s_nop 1
    v_mfma_f32_16x16x32_bf16 v[66:69], v[230:233], v[150:153], 0
    v_mfma_f32_16x16x32_bf16 v[70:73], v[230:233], v[154:157], 0
    v_cvt_pk_bf16_f32 v234, v94, v95
    v_cvt_pk_bf16_f32 v235, v96, v97
    v_cvt_pk_bf16_f32 v236, v98, v99
    v_cvt_pk_bf16_f32 v237, v100, v101
    s_nop 1
    v_mfma_f32_16x16x32_bf16 v[74:77], v[234:237], v[154:157], 0
    v_mfma_f32_16x16x32_bf16 v[178:181], v[230:233], v[158:161], 0
    v_mfma_f32_16x16x32_bf16 v[182:185], v[230:233], v[162:165], 0
    s_waitcnt lgkmcnt(0)
    v_cmp_ne_u32 vcc, 0, v48
    s_nop 0
    s_cbranch_vccnz D_dK
    s_mov_b32 s9, 0
D_lK:
    ds_read_b32 v48, v220 offset:56
    ds_read_b128 v[226:229], v218
    s_add_u32 s9, s9, 1
    s_cmp_gt_u32 s9, 1600000
    s_waitcnt lgkmcnt(0)
    s_cbranch_scc1 D_dK
    v_cmp_eq_u32 vcc, 0, v48
    s_nop 0
    s_cbranch_vccnz D_lK
            D_dK:

    v_mfma_f32_16x16x32_bf16 v[62:65], v[226:229], v[150:153], 0
    v_readfirstlane_b32 s63, v40
    v_cndmask_b32 v74, v74, v75, s[44:45]
    v_cndmask_b32 v76, v76, v77, s[44:45]
    v_cndmask_b32 v70, v70, v71, s[44:45]
    v_cndmask_b32 v72, v72, v73, s[44:45]
    v_cndmask_b32 v212, v70, v74, s[46:47]
    v_cndmask_b32 v213, v72, v76, s[48:49]
    v_cndmask_b32 v66, v66, v67, s[44:45]
    v_cndmask_b32 v68, v68, v69, s[44:45]
    v_cndmask_b32 v62, v62, v63, s[44:45]
    v_cndmask_b32 v64, v64, v65, s[44:45]
    v_cndmask_b32 v210, v62, v66, s[46:47]
    v_cndmask_b32 v211, v64, v68, s[48:49]
    v_and_or_b32 v94, v210, v46, v50
    v_and_or_b32 v95, v211, v46, v51
    v_and_or_b32 v96, v212, v46, v52
    v_and_or_b32 v97, v213, v46, v53
    s_sub_u32 s63, s63, 1
    s_cbranch_scc1 C_mr1
C_md1:
    s_cmp_lg_u32 s101, 0
    s_cbranch_scc1 SM_jS1
    s_cmp_eq_u32 s63, 0
    s_cbranch_scc1 SM_sS1
    buffer_store_dwordx4 v[94:97], v4, s[36:39], s15 offen
SM_jS1:
    v_mfma_f32_16x16x32_bf16 v[174:177], v[226:229], v[158:161], 0
    v_mfma_f32_16x16x32_bf16 v[186:189], v[234:237], v[162:165], 0
    ds_read_b32 v40, v5 offset:32
    ds_read_b64_tr_b16 v[166:167], v34 offset:32768
    ds_read_b64_tr_b16 v[168:169], v34 offset:33280
    ds_read_b64_tr_b16 v[170:171], v35 offset:32768
    ds_read_b64_tr_b16 v[172:173], v35 offset:33280
    ds_read_b64_tr_b16 v[198:199], v34 offset:36864
    ds_read_b64_tr_b16 v[200:201], v34 offset:37376
    ds_read_b64_tr_b16 v[202:203], v35 offset:36864
    ds_read_b64_tr_b16 v[204:205], v35 offset:37376
    v_cndmask_b32 v186, v186, v187, s[44:45]
    v_cndmask_b32 v188, v188, v189, s[44:45]
    v_cndmask_b32 v182, v182, v183, s[44:45]
    v_cndmask_b32 v184, v184, v185, s[44:45]
    v_cndmask_b32 v208, v182, v186, s[46:47]
    v_cndmask_b32 v209, v184, v188, s[48:49]
    v_cndmask_b32 v178, v178, v179, s[44:45]
    v_cndmask_b32 v180, v180, v181, s[44:45]
    v_cndmask_b32 v174, v174, v175, s[44:45]
    v_cndmask_b32 v176, v176, v177, s[44:45]
    v_cndmask_b32 v206, v174, v178, s[46:47]
    v_cndmask_b32 v207, v176, v180, s[48:49]
    ds_write_b128 v42, v[206:209]
    ds_write_b32 v47, v5 offset:16
    s_waitcnt lgkmcnt(10)
    v_cmp_gt_u32 vcc, 4, v40
    s_nop 0
    s_cbranch_vccnz C_vr1
C_vd1:
    s_waitcnt lgkmcnt(8)
    v_mfma_f32_16x16x32_bf16 v[102:105], v[126:129], v[166:169], v[102:105]
    ds_read_b128 v[150:153], v30 offset:10240
    s_waitcnt lgkmcnt(5)
    v_mfma_f32_16x16x32_bf16 v[102:105], v[138:141], v[198:201], v[102:105]
    ds_read_b64_tr_b16 v[182:183], v34 offset:24576
    v_mfma_f32_16x16x32_bf16 v[110:113], v[130:133], v[166:169], v[110:113]
    ds_read_b64_tr_b16 v[184:185], v34 offset:25088
    v_mfma_f32_16x16x32_bf16 v[110:113], v[142:145], v[198:201], v[110:113]
    ds_read_b128 v[162:165], v31 offset:10240
    v_mfma_f32_16x16x32_bf16 v[118:121], v[134:137], v[166:169], v[118:121]
    ds_read_b64_tr_b16 v[190:191], v34 offset:28672
    v_mfma_f32_16x16x32_bf16 v[118:121], v[146:149], v[198:201], v[118:121]
    ds_read_b64_tr_b16 v[192:193], v34 offset:29184
    v_mfma_f32_16x16x32_bf16 v[106:109], v[126:129], v[170:173], v[106:109]
    ds_read_b64_tr_b16 v[186:187], v35 offset:24576
    ds_read_b64_tr_b16 v[188:189], v35 offset:25088
    s_waitcnt lgkmcnt(10)
    v_mfma_f32_16x16x32_bf16 v[106:109], v[138:141], v[202:205], v[106:109]
    ds_read_b64_tr_b16 v[194:195], v35 offset:28672
    ds_read_b64_tr_b16 v[196:197], v35 offset:29184
    v_mfma_f32_16x16x32_bf16 v[114:117], v[130:133], v[170:173], v[114:117]
    ds_read_b128 v[154:157], v30 offset:12288
    v_mfma_f32_16x16x32_bf16 v[114:117], v[142:145], v[202:205], v[114:117]
    ds_read_b128 v[174:177], v31 offset:12288
    v_mfma_f32_16x16x32_bf16 v[122:125], v[134:137], v[170:173], v[122:125]
    ds_read_b128 v[158:161], v30 offset:14336
    v_mfma_f32_16x16x32_bf16 v[122:125], v[146:149], v[202:205], v[122:125]
    ds_read_b128 v[178:181], v31 offset:14336
    s_waitcnt lgkmcnt(11)
    v_mfma_f32_16x16x32_bf16 v[102:105], v[150:153], v[182:185], v[102:105]
    s_waitcnt lgkmcnt(8)
    v_mfma_f32_16x16x32_bf16 v[102:105], v[162:165], v[190:193], v[102:105]
    s_waitcnt lgkmcnt(6)
    v_mfma_f32_16x16x32_bf16 v[106:109], v[150:153], v[186:189], v[106:109]
    s_waitcnt lgkmcnt(4)
    v_mfma_f32_16x16x32_bf16 v[106:109], v[162:165], v[194:197], v[106:109]
    s_waitcnt lgkmcnt(3)
    v_mfma_f32_16x16x32_bf16 v[110:113], v[154:157], v[182:185], v[110:113]
    s_nop 1
    v_cvt_pk_bf16_f32 v226, v102, v103
    v_cvt_pk_bf16_f32 v227, v104, v105
    ds_write_b64 v219, v[226:227] offset:0
    s_waitcnt lgkmcnt(3)
    v_mfma_f32_16x16x32_bf16 v[110:113], v[174:177], v[190:193], v[110:113]
    v_mfma_f32_16x16x32_bf16 v[114:117], v[154:157], v[186:189], v[114:117]
    v_cvt_pk_bf16_f32 v232, v106, v107
    v_cvt_pk_bf16_f32 v233, v108, v109
    ds_write_b64 v219, v[232:233] offset:8
    v_mfma_f32_16x16x32_bf16 v[114:117], v[174:177], v[194:197], v[114:117]
    ds_write_b32 v221, v5 offset:68
    s_waitcnt lgkmcnt(4)
    v_mfma_f32_16x16x32_bf16 v[118:121], v[158:161], v[182:185], v[118:121]
    v_cvt_pk_bf16_f32 v228, v110, v111
    v_cvt_pk_bf16_f32 v229, v112, v113
    s_waitcnt lgkmcnt(3)
    v_mfma_f32_16x16x32_bf16 v[118:121], v[178:181], v[190:193], v[118:121]
    v_mfma_f32_16x16x32_bf16 v[122:125], v[158:161], v[186:189], v[122:125]
    v_cvt_pk_bf16_f32 v234, v114, v115
    v_cvt_pk_bf16_f32 v235, v116, v117
    v_mfma_f32_16x16x32_bf16 v[122:125], v[178:181], v[194:197], v[122:125]
    v_cndmask_b32 v126, 0, v226, s[58:59]
    v_cndmask_b32 v226, v226, 0, s[58:59]
    v_cndmask_b32 v127, 0, v227, s[58:59]
    v_cndmask_b32 v227, v227, 0, s[58:59]
    buffer_load_dwordx4 v[214:217], v4, s[36:39], s100 offen sc1
    v_cvt_pk_bf16_f32 v230, v118, v119
    v_cvt_pk_bf16_f32 v231, v120, v121
    s_nop 0
    v_cvt_pk_bf16_f32 v236, v122, v123
    v_cvt_pk_bf16_f32 v237, v124, v125
    v_cndmask_b32 v132, 0, v232, s[60:61]
    v_cndmask_b32 v232, v232, 0, s[60:61]
    v_cndmask_b32 v133, 0, v233, s[60:61]
    v_cndmask_b32 v233, v233, 0, s[60:61]
    v_cndmask_b32 v128, 0, v228, s[58:59]
    v_cndmask_b32 v228, v228, 0, s[58:59]
    v_cndmask_b32 v129, 0, v229, s[58:59]
    v_cndmask_b32 v229, v229, 0, s[58:59]
    v_cndmask_b32 v134, 0, v234, s[60:61]
    v_cndmask_b32 v234, v234, 0, s[60:61]
    v_cndmask_b32 v135, 0, v235, s[60:61]
    v_cndmask_b32 v235, v235, 0, s[60:61]
    v_cndmask_b32 v130, 0, v230, s[58:59]
    v_cndmask_b32 v230, v230, 0, s[58:59]
    v_cndmask_b32 v131, 0, v231, s[58:59]
    v_cndmask_b32 v231, v231, 0, s[58:59]
    v_cndmask_b32 v136, 0, v236, s[60:61]
    v_cndmask_b32 v236, v236, 0, s[60:61]
    v_cndmask_b32 v137, 0, v237, s[60:61]
    v_cndmask_b32 v237, v237, 0, s[60:61]
    s_waitcnt lgkmcnt(0)
C_join:
    v_mov_b32 v12, s0
    v_mov_b32 v13, s0
    v_pk_mul_f32 v[210:211], v[210:211], v[12:13]
    v_pk_mul_f32 v[212:213], v[212:213], v[12:13]
    s_mov_b32 s9, 0
    s_add_u32 s19, s100, 14336
    s_cmp_lg_u32 s101, 0
    s_cbranch_scc1 C_sv
    s_mov_b32 s40, 0x0c0c0400
    s_mov_b32 s41, 0x05040100
    s_waitcnt vmcnt(0)
        C_sl:
    v_perm_b32 v2, v215, v214, s40
    v_perm_b32 v3, v217, v216, s40
    v_and_b32 v214, v46, v214
    v_perm_b32 v2, v3, v2, s41
    v_and_b32 v215, v46, v215
    v_cmp_ne_u32 vcc, s12, v2
    v_and_b32 v216, v46, v216
    v_and_b32 v217, v46, v217

    s_cbranch_vccz C_sk
    buffer_load_dwordx4 v[214:217], v4, s[36:39], s100 offen sc1
    s_waitcnt vmcnt(0)
    s_add_u32 s9, s9, 1
    s_cmp_lt_u32 s9, 200000
    s_cbranch_scc1 C_sl
C_sk:
    v_pk_fma_f32 v[210:211], v[214:215], v[12:13], v[210:211]
    v_pk_fma_f32 v[212:213], v[216:217], v[12:13], v[212:213]
C_sv:
    v_max_f32 v222, v210, v211
    v_max_f32 v223, v212, v213
    v_mov_b32 v224, v222
    v_mov_b32 v225, v223
    s_mov_b64 exec, 1
    ds_add_u32 v5, v44 offset:80
    s_mov_b64 exec, -1
    v_permlane16_swap_b32 v222, v224
    v_permlane16_swap_b32 v223, v225
    v_max_f32 v222, v222, v224
    v_max_f32 v223, v223, v225
    v_mov_b32 v224, v222
    v_mov_b32 v225, v223
    s_nop 0
    v_permlane32_swap_b32 v222, v224
    v_permlane32_swap_b32 v223, v225
    v_max_f32 v222, v222, v224
    v_max_f32 v223, v223, v225
    v_sub_f32 v210, v210, v222
    v_sub_f32 v211, v211, v222
    v_sub_f32 v212, v212, v223
    v_sub_f32 v213, v213, v223
    v_exp_f32 v210, v210
    v_exp_f32 v211, v211
    v_exp_f32 v212, v212
    v_exp_f32 v213, v213
    v_add_f32 v222, v210, v211
    v_add_f32 v223, v212, v213
    v_mov_b32 v224, v222
    v_mov_b32 v225, v223
    ds_read_b32 v48, v47 offset:40
    ds_read_b128 v[78:81], v43 offset:12288
    ds_read_b128 v[82:85], v43 offset:13312
    ds_read_b32 v7, v5 offset:12
    v_permlane16_swap_b32 v222, v224
    v_permlane16_swap_b32 v223, v225
    v_add_f32 v222, v222, v224
    v_add_f32 v223, v223, v225
    v_mov_b32 v224, v222
    v_mov_b32 v225, v223
    s_nop 0
    v_permlane32_swap_b32 v222, v224
    v_permlane32_swap_b32 v223, v225
    v_add_f32 v222, v222, v224
    v_add_f32 v223, v223, v225
    v_rcp_f32 v222, v222
    v_rcp_f32 v223, v223
    s_waitcnt lgkmcnt(0)
    v_cmp_eq_u32 vcc, 0, v48
    v_mul_f32 v210, v210, v222
    v_mul_f32 v211, v211, v222
    v_mul_f32 v212, v212, v223
    v_mul_f32 v213, v213, v223
    v_cvt_pk_bf16_f32 v210, v210, v210
    v_cvt_pk_bf16_f32 v211, v211, v211
    v_cvt_pk_bf16_f32 v212, v212, v212
    v_cvt_pk_bf16_f32 v213, v213, v213
    s_cbranch_vccnz C_pr
C_pd:
    v_mfma_f32_16x16x32_bf16 v[62:65], v[126:129], v[78:81], 0
    v_and_b32 v86, v36, v210
    v_and_b32 v87, v37, v211
    v_mfma_f32_16x16x32_bf16 v[66:69], v[132:135], v[78:81], 0
    v_and_b32 v88, v38, v210
    v_and_b32 v89, v39, v211
    v_mfma_f32_16x16x32_bf16 v[70:73], v[128:131], v[82:85], 0
    v_and_b32 v90, v36, v212
    v_and_b32 v91, v37, v213
    v_mfma_f32_16x16x32_bf16 v[74:77], v[134:137], v[82:85], 0
    v_and_b32 v92, v38, v212
    v_and_b32 v93, v39, v213
    v_mfma_f32_16x16x32_bf16 v[62:65], v[226:229], v[86:89], v[62:65]
    v_mfma_f32_16x16x32_bf16 v[66:69], v[232:235], v[86:89], v[66:69]
    v_mfma_f32_16x16x32_bf16 v[70:73], v[228:231], v[90:93], v[70:73]
    v_mfma_f32_16x16x32_bf16 v[74:77], v[234:237], v[90:93], v[74:77]
    s_cmp_eq_u32 s63, 0
    s_cbranch_scc1 SM_sO
    s_nop 2
    v_cvt_pk_bf16_f32 v54, v62, v63
    v_cvt_pk_bf16_f32 v55, v64, v65
    v_cvt_pk_bf16_f32 v56, v66, v67
    v_cvt_pk_bf16_f32 v57, v68, v69
    buffer_store_dwordx4 v[54:57], v4, s[36:39], s100 offen nt
    v_cvt_pk_bf16_f32 v58, v70, v71
    v_cvt_pk_bf16_f32 v59, v72, v73
    v_cvt_pk_bf16_f32 v60, v74, v75
    v_cvt_pk_bf16_f32 v61, v76, v77
    buffer_store_dwordx4 v[58:61], v4, s[36:39], s19 offen nt
SM_jO:
    v_cmp_gt_u32 vcc, 4, v7
    s_nop 0
    s_cbranch_vccz W_dW
    s_mov_b32 s9, 0
        W_lW:
    ds_read_b32 v2, v5 offset:12
    s_add_u32 s9, s9, 1
    s_cmp_gt_u32 s9, 1600000
    s_cbranch_scc1 W_dW
    s_waitcnt lgkmcnt(0)
    v_cmp_gt_u32 vcc, 4, v2

    s_nop 0
    s_cbranch_vccnz W_lW
W_dW:
    ds_read_b64_tr_b16 v[76:77], v16 offset:0
    ds_read_b64_tr_b16 v[78:79], v16 offset:2048
    ds_read_b64_tr_b16 v[80:81], v17 offset:0
    ds_read_b64_tr_b16 v[82:83], v17 offset:2048
    ds_read_b64_tr_b16 v[84:85], v18 offset:0
    ds_read_b64_tr_b16 v[86:87], v18 offset:2048
    ds_read_b64_tr_b16 v[88:89], v19 offset:0
    ds_read_b64_tr_b16 v[90:91], v19 offset:2048
    ds_read_b64_tr_b16 v[92:93], v16 offset:4096
    ds_read_b64_tr_b16 v[94:95], v16 offset:6144
    ds_read_b64_tr_b16 v[96:97], v17 offset:4096
    ds_read_b64_tr_b16 v[98:99], v17 offset:6144
    ds_read_b64_tr_b16 v[100:101], v18 offset:4096
    ds_read_b64_tr_b16 v[102:103], v18 offset:6144
    ds_read_b64_tr_b16 v[104:105], v19 offset:4096
    ds_read_b64_tr_b16 v[106:107], v19 offset:6144
    ds_read_b64_tr_b16 v[108:109], v16 offset:8192
    ds_read_b64_tr_b16 v[110:111], v16 offset:10240
    ds_read_b64_tr_b16 v[112:113], v17 offset:8192
    ds_read_b64_tr_b16 v[114:115], v17 offset:10240
    ds_read_b64_tr_b16 v[116:117], v18 offset:8192
    ds_read_b64_tr_b16 v[118:119], v18 offset:10240
    ds_read_b64_tr_b16 v[120:121], v19 offset:8192
    ds_read_b64_tr_b16 v[122:123], v19 offset:10240
    ds_read_b64_tr_b16 v[124:125], v16 offset:12288
    ds_read_b64_tr_b16 v[126:127], v16 offset:14336
    ds_read_b64_tr_b16 v[128:129], v17 offset:12288
    ds_read_b64_tr_b16 v[130:131], v17 offset:14336
    ds_read_b64_tr_b16 v[132:133], v18 offset:12288
    ds_read_b64_tr_b16 v[134:135], v18 offset:14336
    ds_read_b64_tr_b16 v[136:137], v19 offset:12288
    ds_read_b64_tr_b16 v[138:139], v19 offset:14336
    s_waitcnt vmcnt(0)
    s_mov_b64 exec, 1
    s_cmp_eq_u32 s63, 0
    s_cbranch_scc1 SM_sF
    buffer_store_dwordx2 v[14:15], v6, s[36:39], s21 offen
SM_jF:
    s_mov_b64 exec, -1
    ds_read_b64_tr_b16 v[140:141], v16 offset:16384
    ds_read_b64_tr_b16 v[142:143], v16 offset:18432
    ds_read_b64_tr_b16 v[144:145], v17 offset:16384
    ds_read_b64_tr_b16 v[146:147], v17 offset:18432
    ds_read_b64_tr_b16 v[148:149], v18 offset:16384
    ds_read_b64_tr_b16 v[150:151], v18 offset:18432
    ds_read_b64_tr_b16 v[152:153], v19 offset:16384
    ds_read_b64_tr_b16 v[154:155], v19 offset:18432
    ds_read_b64_tr_b16 v[156:157], v16 offset:20480
    ds_read_b64_tr_b16 v[158:159], v16 offset:22528
    ds_read_b64_tr_b16 v[160:161], v17 offset:20480
    ds_read_b64_tr_b16 v[162:163], v17 offset:22528
    ds_read_b64_tr_b16 v[164:165], v18 offset:20480
    ds_read_b64_tr_b16 v[166:167], v18 offset:22528
    ds_read_b64_tr_b16 v[168:169], v19 offset:20480
    ds_read_b64_tr_b16 v[170:171], v19 offset:22528
    ds_read_b64_tr_b16 v[172:173], v16 offset:24576
    ds_read_b64_tr_b16 v[174:175], v16 offset:26624
    ds_read_b64_tr_b16 v[176:177], v17 offset:24576
    ds_read_b64_tr_b16 v[178:179], v17 offset:26624
    ds_read_b64_tr_b16 v[180:181], v18 offset:24576
    ds_read_b64_tr_b16 v[182:183], v18 offset:26624
    ds_read_b64_tr_b16 v[184:185], v19 offset:24576
    ds_read_b64_tr_b16 v[186:187], v19 offset:26624
    buffer_load_dwordx2 v[12:13], v8, s[36:39], s20 offen sc1
    ds_read_b64_tr_b16 v[188:189], v16 offset:28672
    ds_read_b64_tr_b16 v[190:191], v16 offset:30720
    ds_read_b64_tr_b16 v[192:193], v17 offset:28672
    ds_read_b64_tr_b16 v[194:195], v17 offset:30720
    ds_read_b64_tr_b16 v[196:197], v18 offset:28672
    ds_read_b64_tr_b16 v[198:199], v18 offset:30720
    ds_read_b64_tr_b16 v[200:201], v19 offset:28672
    ds_read_b64_tr_b16 v[202:203], v19 offset:30720
    ds_read_b64_tr_b16 v[204:205], v16 offset:32768
    ds_read_b64_tr_b16 v[206:207], v16 offset:34816
    ds_read_b64_tr_b16 v[208:209], v17 offset:32768
    ds_read_b64_tr_b16 v[210:211], v17 offset:34816
    ds_read_b64_tr_b16 v[212:213], v18 offset:32768
    ds_read_b64_tr_b16 v[214:215], v18 offset:34816
    ds_read_b64_tr_b16 v[216:217], v19 offset:32768
    ds_read_b64_tr_b16 v[218:219], v19 offset:34816
    ds_read_b64_tr_b16 v[220:221], v16 offset:36864
    ds_read_b64_tr_b16 v[222:223], v16 offset:38912
    ds_read_b64_tr_b16 v[224:225], v17 offset:36864
    ds_read_b64_tr_b16 v[226:227], v17 offset:38912
    ds_read_b64_tr_b16 v[228:229], v18 offset:36864
    ds_read_b64_tr_b16 v[230:231], v18 offset:38912
    ds_read_b64_tr_b16 v[232:233], v19 offset:36864
    ds_read_b64_tr_b16 v[234:235], v19 offset:38912
    s_mov_b32 s9, 0
        P_lO:
    s_waitcnt vmcnt(0)
    v_cmp_ne_u64 vcc, s[12:13], v[12:13]
    s_nop 0
    s_cbranch_vccz P_dO
    buffer_load_dwordx2 v[12:13], v8, s[36:39], s20 offen sc1
    s_add_u32 s9, s9, 1
    s_cmp_lt_u32 s9, 200000
    s_cbranch_scc1 P_lO
    s_waitcnt vmcnt(0)
        P_dO:

    buffer_load_dwordx4 v[40:43], v4, s[36:39], s22 offen offset:0 sc1
    buffer_load_dwordx4 v[44:47], v4, s[36:39], s22 offen offset:1024 sc1
    buffer_load_dwordx4 v[48:51], v4, s[36:39], s22 offen offset:2048 sc1
    buffer_load_dwordx4 v[52:55], v4, s[36:39], s22 offen offset:3072 sc1
    s_add_u32 s22, s22, 4096
    buffer_load_dwordx4 v[56:59], v4, s[36:39], s22 offen offset:0 sc1
    buffer_load_dwordx4 v[60:63], v4, s[36:39], s22 offen offset:1024 sc1
    s_waitcnt lgkmcnt(0)
    s_mov_b32 s9, 0
        W_lW2:
    ds_read_b32 v2, v5 offset:36
    s_add_u32 s9, s9, 1
    s_cmp_gt_u32 s9, 1600000
    s_cbranch_scc1 W_dW2
    s_waitcnt lgkmcnt(0)
    v_cmp_gt_u32 vcc, 4, v2

    s_nop 0
    s_cbranch_vccnz W_lW2
W_dW2:
    s_waitcnt vmcnt(5)
    v_mfma_f32_16x16x32_bf16 v[24:27], v[76:79], v[40:43], 0
    buffer_load_dwordx4 v[64:67], v4, s[36:39], s22 offen offset:2048 sc1
    ds_read_b64_tr_b16 v[76:77], v16 offset:40960
    ds_read_b64_tr_b16 v[78:79], v16 offset:43008
    v_mfma_f32_16x16x32_bf16 v[28:31], v[80:83], v[40:43], 0
    ds_read_b64_tr_b16 v[80:81], v17 offset:40960
    ds_read_b64_tr_b16 v[82:83], v17 offset:43008
    v_mfma_f32_16x16x32_bf16 v[32:35], v[84:87], v[40:43], 0
    ds_read_b64_tr_b16 v[84:85], v18 offset:40960
    ds_read_b64_tr_b16 v[86:87], v18 offset:43008
    v_mfma_f32_16x16x32_bf16 v[36:39], v[88:91], v[40:43], 0
    ds_read_b64_tr_b16 v[88:89], v19 offset:40960
    ds_read_b64_tr_b16 v[90:91], v19 offset:43008
    s_waitcnt vmcnt(5)
    v_mfma_f32_16x16x32_bf16 v[24:27], v[92:95], v[44:47], v[24:27]
    buffer_load_dwordx4 v[68:71], v4, s[36:39], s22 offen offset:3072 sc1
    s_add_u32 s22, s22, 4096
    ds_read_b64_tr_b16 v[92:93], v16 offset:45056
    ds_read_b64_tr_b16 v[94:95], v16 offset:47104
    v_mfma_f32_16x16x32_bf16 v[28:31], v[96:99], v[44:47], v[28:31]
    ds_read_b64_tr_b16 v[96:97], v17 offset:45056
    ds_read_b64_tr_b16 v[98:99], v17 offset:47104
    v_mfma_f32_16x16x32_bf16 v[32:35], v[100:103], v[44:47], v[32:35]
    ds_read_b64_tr_b16 v[100:101], v18 offset:45056
    ds_read_b64_tr_b16 v[102:103], v18 offset:47104
    v_mfma_f32_16x16x32_bf16 v[36:39], v[104:107], v[44:47], v[36:39]
    ds_read_b64_tr_b16 v[104:105], v19 offset:45056
    ds_read_b64_tr_b16 v[106:107], v19 offset:47104
    s_waitcnt vmcnt(5)
    v_mfma_f32_16x16x32_bf16 v[24:27], v[108:111], v[48:51], v[24:27]
    buffer_load_dwordx4 v[72:75], v4, s[36:39], s22 offen offset:0 sc1
    ds_read_b64_tr_b16 v[108:109], v16 offset:49152
    ds_read_b64_tr_b16 v[110:111], v16 offset:51200
    v_mfma_f32_16x16x32_bf16 v[28:31], v[112:115], v[48:51], v[28:31]
    ds_read_b64_tr_b16 v[112:113], v17 offset:49152
    ds_read_b64_tr_b16 v[114:115], v17 offset:51200
    v_mfma_f32_16x16x32_bf16 v[32:35], v[116:119], v[48:51], v[32:35]
    ds_read_b64_tr_b16 v[116:117], v18 offset:49152
    ds_read_b64_tr_b16 v[118:119], v18 offset:51200
    v_mfma_f32_16x16x32_bf16 v[36:39], v[120:123], v[48:51], v[36:39]
    ds_read_b64_tr_b16 v[120:121], v19 offset:49152
    ds_read_b64_tr_b16 v[122:123], v19 offset:51200
    s_waitcnt vmcnt(5)
    v_mfma_f32_16x16x32_bf16 v[24:27], v[124:127], v[52:55], v[24:27]
    buffer_load_dwordx4 v[40:43], v4, s[36:39], s22 offen offset:1024 sc1
    ds_read_b64_tr_b16 v[124:125], v16 offset:53248
    ds_read_b64_tr_b16 v[126:127], v16 offset:55296
    v_mfma_f32_16x16x32_bf16 v[28:31], v[128:131], v[52:55], v[28:31]
    ds_read_b64_tr_b16 v[128:129], v17 offset:53248
    ds_read_b64_tr_b16 v[130:131], v17 offset:55296
    v_mfma_f32_16x16x32_bf16 v[32:35], v[132:135], v[52:55], v[32:35]
    ds_read_b64_tr_b16 v[132:133], v18 offset:53248
    ds_read_b64_tr_b16 v[134:135], v18 offset:55296
    v_mfma_f32_16x16x32_bf16 v[36:39], v[136:139], v[52:55], v[36:39]
    ds_read_b64_tr_b16 v[136:137], v19 offset:53248
    ds_read_b64_tr_b16 v[138:139], v19 offset:55296
    s_waitcnt vmcnt(5)
    v_mfma_f32_16x16x32_bf16 v[24:27], v[140:143], v[56:59], v[24:27]
    buffer_load_dwordx4 v[44:47], v4, s[36:39], s22 offen offset:2048 sc1
    v_mfma_f32_16x16x32_bf16 v[28:31], v[144:147], v[56:59], v[28:31]
    v_mfma_f32_16x16x32_bf16 v[32:35], v[148:151], v[56:59], v[32:35]
    v_mfma_f32_16x16x32_bf16 v[36:39], v[152:155], v[56:59], v[36:39]
    s_waitcnt vmcnt(5)
    v_mfma_f32_16x16x32_bf16 v[24:27], v[156:159], v[60:63], v[24:27]
    buffer_load_dwordx4 v[48:51], v4, s[36:39], s22 offen offset:3072 sc1
    s_add_u32 s22, s22, 4096
    v_mfma_f32_16x16x32_bf16 v[28:31], v[160:163], v[60:63], v[28:31]
    v_mfma_f32_16x16x32_bf16 v[32:35], v[164:167], v[60:63], v[32:35]
    v_mfma_f32_16x16x32_bf16 v[36:39], v[168:171], v[60:63], v[36:39]
    s_waitcnt vmcnt(5)
    v_mfma_f32_16x16x32_bf16 v[24:27], v[172:175], v[64:67], v[24:27]
    buffer_load_dwordx4 v[52:55], v4, s[36:39], s22 offen offset:0 sc1
    v_mfma_f32_16x16x32_bf16 v[28:31], v[176:179], v[64:67], v[28:31]
    v_mfma_f32_16x16x32_bf16 v[32:35], v[180:183], v[64:67], v[32:35]
    v_mfma_f32_16x16x32_bf16 v[36:39], v[184:187], v[64:67], v[36:39]
    s_waitcnt vmcnt(5)
    v_mfma_f32_16x16x32_bf16 v[24:27], v[188:191], v[68:71], v[24:27]
    buffer_load_dwordx4 v[56:59], v4, s[36:39], s22 offen offset:1024 sc1
    v_mfma_f32_16x16x32_bf16 v[28:31], v[192:195], v[68:71], v[28:31]
    v_mfma_f32_16x16x32_bf16 v[32:35], v[196:199], v[68:71], v[32:35]
    v_mfma_f32_16x16x32_bf16 v[36:39], v[200:203], v[68:71], v[36:39]
    s_waitcnt vmcnt(5)
    v_mfma_f32_16x16x32_bf16 v[24:27], v[204:207], v[72:75], v[24:27]
    v_mfma_f32_16x16x32_bf16 v[28:31], v[208:211], v[72:75], v[28:31]
    v_mfma_f32_16x16x32_bf16 v[32:35], v[212:215], v[72:75], v[32:35]
    v_mfma_f32_16x16x32_bf16 v[36:39], v[216:219], v[72:75], v[36:39]
    s_waitcnt vmcnt(4)
    v_mfma_f32_16x16x32_bf16 v[24:27], v[220:223], v[40:43], v[24:27]
    v_mfma_f32_16x16x32_bf16 v[28:31], v[224:227], v[40:43], v[28:31]
    v_mfma_f32_16x16x32_bf16 v[32:35], v[228:231], v[40:43], v[32:35]
    v_mfma_f32_16x16x32_bf16 v[36:39], v[232:235], v[40:43], v[36:39]
    s_waitcnt vmcnt(3)
    s_waitcnt lgkmcnt(15)
    v_mfma_f32_16x16x32_bf16 v[24:27], v[76:79], v[44:47], v[24:27]
    v_mfma_f32_16x16x32_bf16 v[28:31], v[80:83], v[44:47], v[28:31]
    v_mfma_f32_16x16x32_bf16 v[32:35], v[84:87], v[44:47], v[32:35]
    v_mfma_f32_16x16x32_bf16 v[36:39], v[88:91], v[44:47], v[36:39]
    s_waitcnt vmcnt(2)
    v_mfma_f32_16x16x32_bf16 v[24:27], v[92:95], v[48:51], v[24:27]
    v_mfma_f32_16x16x32_bf16 v[28:31], v[96:99], v[48:51], v[28:31]
    v_mfma_f32_16x16x32_bf16 v[32:35], v[100:103], v[48:51], v[32:35]
    v_mfma_f32_16x16x32_bf16 v[36:39], v[104:107], v[48:51], v[36:39]
    s_waitcnt vmcnt(1)
    s_waitcnt lgkmcnt(14)
    v_mfma_f32_16x16x32_bf16 v[24:27], v[108:111], v[52:55], v[24:27]
    s_waitcnt lgkmcnt(12)
    v_mfma_f32_16x16x32_bf16 v[28:31], v[112:115], v[52:55], v[28:31]
    s_waitcnt lgkmcnt(10)
    v_mfma_f32_16x16x32_bf16 v[32:35], v[116:119], v[52:55], v[32:35]
    s_waitcnt lgkmcnt(8)
    v_mfma_f32_16x16x32_bf16 v[36:39], v[120:123], v[52:55], v[36:39]
    s_waitcnt vmcnt(0)
    s_waitcnt lgkmcnt(6)
    v_mfma_f32_16x16x32_bf16 v[24:27], v[124:127], v[56:59], v[24:27]
    s_waitcnt lgkmcnt(4)
    v_mfma_f32_16x16x32_bf16 v[28:31], v[128:131], v[56:59], v[28:31]
    s_waitcnt lgkmcnt(2)
    v_mfma_f32_16x16x32_bf16 v[32:35], v[132:135], v[56:59], v[32:35]
    s_waitcnt lgkmcnt(0)
    v_mfma_f32_16x16x32_bf16 v[36:39], v[136:139], v[56:59], v[36:39]
    s_nop 1
    v_cvt_pk_bf16_f32 v156, v24, v25
    v_cvt_pk_bf16_f32 v157, v26, v27
    ds_write_b64 v20, v[156:157]
    v_cvt_pk_bf16_f32 v158, v28, v29
    v_cvt_pk_bf16_f32 v159, v30, v31
    ds_write_b64 v21, v[158:159]
    v_cvt_pk_bf16_f32 v160, v32, v33
    v_cvt_pk_bf16_f32 v161, v34, v35
    ds_write_b64 v22, v[160:161]
    v_cvt_pk_bf16_f32 v162, v36, v37
    v_cvt_pk_bf16_f32 v163, v38, v39
    ds_write_b64 v23, v[162:163]
    ds_read_b128 v[172:175], v9
    ds_read_b128 v[176:179], v9 offset:1024
    s_waitcnt lgkmcnt(1)
    buffer_store_dwordx4 v[172:175], v10, s[32:35], s23 offen nt
    s_waitcnt lgkmcnt(0)
    buffer_store_dwordx4 v[176:179], v10, s[32:35], s28 offen nt

    s_add_u32 s40, s7, s62
    s_cmp_lg_u32 s40, 0
    s_cbranch_scc1 C_end
    s_add_u32 s40, s10, 16
    v_mov_b32 v2, s40
    s_lshl_b32 s40, s8, 7
    s_mov_b64 exec, 1
    buffer_store_dword v2, v6, s[36:39], s40 offen
        C_end:

    s_endpgm
K_cold:
X_cH:
    s_mov_b32 s9, 0
        X_lH:
    v_cmp_ne_u64 vcc, s[28:29], v[18:19]
    s_nop 0
    s_cbranch_vccz X_okH
    v_subrev_u32 v18, s12, v18
    v_cmp_ne_u32 s[42:43], s13, v19
    v_cmp_le_u32 vcc, 8, v18
    s_nop 0
    s_or_b64 vcc, vcc, s[42:43]
    s_cbranch_vccz X_nH
    buffer_load_dwordx2 v[18:19], v20, s[36:39], s30 offen sc1
    s_add_u32 s9, s9, 1
    s_cmp_lt_u32 s9, 200000
    s_waitcnt vmcnt(0)
    s_cbranch_scc1 X_lH
        X_nH:
    s_mov_b32 s101, 0
    s_branch X_okH
S_cls0:
    v_cmp_eq_u32 s[42:43], 0, v3
    v_cvt_pk_bf16_f32 v28, v102, 0
    v_cvt_pk_bf16_f32 v36, -v106, 0
    v_cndmask_b32 v103, v103, 0, s[42:43]
    v_cndmask_b32 v107, v107, -1.0, s[42:43]
    v_cvt_pk_bf16_f32 v29, v103, 0
    v_cvt_pk_bf16_f32 v37, -v107, 0
    v_cvt_pk_bf16_f32 v30, v104, 0
    v_cvt_pk_bf16_f32 v38, -v108, 0
    v_cndmask_b32 v105, v105, 0, s[42:43]
    v_cndmask_b32 v109, v109, -1.0, s[42:43]
    v_cvt_pk_bf16_f32 v31, v105, 0
    v_cvt_pk_bf16_f32 v39, -v109, 0
    v_cvt_pk_bf16_f32 v32, v110, 0
    v_cvt_pk_bf16_f32 v40, -v114, 0
    v_cndmask_b32 v111, v111, 0, s[42:43]
    v_cndmask_b32 v115, v115, -1.0, s[42:43]
    v_cvt_pk_bf16_f32 v33, v111, 0
    v_cvt_pk_bf16_f32 v41, -v115, 0
    v_cvt_pk_bf16_f32 v34, v112, 0
    v_cvt_pk_bf16_f32 v42, -v116, 0
    v_cndmask_b32 v113, v113, 0, s[42:43]
    v_cndmask_b32 v117, v117, -1.0, s[42:43]
    v_cvt_pk_bf16_f32 v35, v113, 0
    v_cvt_pk_bf16_f32 v43, -v117, 0
    v_lshl_add_u32 v4, v3, 6, 32
    v_cvt_f32_u32 v96, v4
    v_mul_f32 v96, 0x3a000000, v96
    v_lshlrev_b32 v4, 2, v2
    v_cvt_f32_u32 v4, v4
    v_mul_f32 v97, v96, v4

    v_cos_f32 v118, v96
    s_nop 0
    v_add_f32 v118, v118, v118
    v_fmamk_f32 v102, v96, 0x0, v97
    v_fmamk_f32 v103, v96, 0x3f800000, v97
    v_fmamk_f32 v106, v96, 0x0, v97
    v_fmamk_f32 v107, v96, 0x3f800000, v97
    v_fmamk_f32 v110, v96, 0x41800000, v97
    v_fmamk_f32 v111, v96, 0x41880000, v97
    v_fmamk_f32 v114, v96, 0x41800000, v97
    v_fmamk_f32 v115, v96, 0x41880000, v97
    v_cos_f32 v102, v102
    v_cos_f32 v103, v103
    v_sin_f32 v106, v106
    v_sin_f32 v107, v107
    v_cos_f32 v110, v110
    v_cos_f32 v111, v111
    v_sin_f32 v114, v114
    v_sin_f32 v115, v115
    v_fma_f32 v104, v118, v103, -v102
    v_fma_f32 v108, v118, v107, -v106
    v_fma_f32 v112, v118, v111, -v110
    v_fma_f32 v116, v118, v115, -v114
    v_fma_f32 v105, v118, v104, -v103
    v_fma_f32 v109, v118, v108, -v107
    v_fma_f32 v113, v118, v112, -v111
    v_fma_f32 v117, v118, v116, -v115
    v_cvt_pk_bf16_f32 v44, 0, v102
    v_cvt_pk_bf16_f32 v52, 0, -v106
    v_cvt_pk_bf16_f32 v45, 0, v103
    v_cvt_pk_bf16_f32 v53, 0, -v107
    v_cvt_pk_bf16_f32 v46, 0, v104
    v_cvt_pk_bf16_f32 v54, 0, -v108
    v_cvt_pk_bf16_f32 v47, 0, v105
    v_cvt_pk_bf16_f32 v55, 0, -v109
    v_cvt_pk_bf16_f32 v48, 0, v110
    v_cvt_pk_bf16_f32 v56, 0, -v114
    v_cvt_pk_bf16_f32 v49, 0, v111
    v_cvt_pk_bf16_f32 v57, 0, -v115
    v_cvt_pk_bf16_f32 v50, 0, v112
    v_cvt_pk_bf16_f32 v58, 0, -v116
    v_cvt_pk_bf16_f32 v51, 0, v113
    v_cvt_pk_bf16_f32 v59, 0, -v117
    s_branch S_reg
S_gr:
    s_add_u32 s9, s9, 1
    s_cmp_gt_u32 s9, 200000
    s_cbranch_scc1 S_gk
    buffer_load_dwordx4 v60, s[36:39], s60 offen offset:0 sc1 lds
    buffer_load_dwordx4 v60, s[36:39], s60 offen offset:1024 sc1 lds
    buffer_load_dwordx4 v60, s[36:39], s60 offen offset:2048 sc1 lds
    buffer_load_dwordx4 v60, s[36:39], s60 offen offset:3072 sc1 lds
    s_waitcnt lgkmcnt(0)
    s_branch S_gc
S_y0:
    v_cmp_eq_u32 s[42:43], 0, v3
    v_mfma_f32_16x16x32_bf16 v[28:31], v[120:123], v[200:203], 0
    v_mfma_f32_16x16x32_bf16 v[28:31], v[124:127], v[204:207], v[28:31]
    v_mfma_f32_16x16x32_bf16 v[32:35], v[128:131], v[208:211], 0
    v_mfma_f32_16x16x32_bf16 v[32:35], v[132:135], v[212:215], v[32:35]
    v_mfma_f32_16x16x32_bf16 v[36:39], v[152:155], v[184:187], 0
    v_mfma_f32_16x16x32_bf16 v[36:39], v[156:159], v[188:191], v[36:39]
    v_mfma_f32_16x16x32_bf16 v[40:43], v[160:163], v[192:195], 0
    v_mfma_f32_16x16x32_bf16 v[40:43], v[164:167], v[196:199], v[40:43]
    s_nop 1
    v_cndmask_b32 v224, v224, v28, s[42:43]
    v_cndmask_b32 v225, v225, v29, s[42:43]
    v_cndmask_b32 v226, v226, v30, s[42:43]
    v_cndmask_b32 v227, v227, v31, s[42:43]
    v_cndmask_b32 v228, v228, v32, s[42:43]
    v_cndmask_b32 v229, v229, v33, s[42:43]
    v_cndmask_b32 v230, v230, v34, s[42:43]
    v_cndmask_b32 v231, v231, v35, s[42:43]
    v_cndmask_b32 v240, v240, v36, s[42:43]
    v_cndmask_b32 v241, v241, v37, s[42:43]
    v_cndmask_b32 v242, v242, v38, s[42:43]
    v_cndmask_b32 v243, v243, v39, s[42:43]
    v_cndmask_b32 v244, v244, v40, s[42:43]
    v_cndmask_b32 v245, v245, v41, s[42:43]
    v_cndmask_b32 v246, v246, v42, s[42:43]
    v_cndmask_b32 v247, v247, v43, s[42:43]
    s_branch S_y1
C_mr0:
    s_mov_b32 s9, 0
        W_lM0:
    ds_read_b32 v2, v5 offset:4
    s_add_u32 s9, s9, 1
    s_cmp_gt_u32 s9, 1600000
    s_cbranch_scc1 W_dM0
    s_waitcnt lgkmcnt(0)
    v_cmp_gt_u32 vcc, 1, v2

    s_nop 0
    s_cbranch_vccnz W_lM0
W_dM0:
    s_waitcnt lgkmcnt(0)
    v_readfirstlane_b32 s63, v2
    s_nop 0
    s_lshr_b32 s63, s63, 1
    s_branch C_md0
SM_sS0:
    buffer_store_dwordx4 v[94:97], v4, s[36:39], s15 offen sc1
    s_branch SM_jS0
C_vr0:
    s_mov_b32 s9, 0
        W_lV0:
    ds_read_b32 v2, v5 offset:32
    s_add_u32 s9, s9, 1
    s_cmp_gt_u32 s9, 1600000
    s_cbranch_scc1 W_dV0
    s_waitcnt lgkmcnt(0)
    v_cmp_gt_u32 vcc, 4, v2

    s_nop 0
    s_cbranch_vccnz W_lV0
W_dV0:
    ds_read_b64_tr_b16 v[166:167], v34 offset:32768
    ds_read_b64_tr_b16 v[168:169], v34 offset:33280
    ds_read_b64_tr_b16 v[170:171], v35 offset:32768
    ds_read_b64_tr_b16 v[172:173], v35 offset:33280
    ds_read_b64_tr_b16 v[198:199], v34 offset:36864
    ds_read_b64_tr_b16 v[200:201], v34 offset:37376
    ds_read_b64_tr_b16 v[202:203], v35 offset:36864
    ds_read_b64_tr_b16 v[204:205], v35 offset:37376
    s_waitcnt lgkmcnt(0)
    s_branch C_vd0
C_mr1:
    s_mov_b32 s9, 0
        W_lM1:
    ds_read_b32 v2, v5 offset:4
    s_add_u32 s9, s9, 1
    s_cmp_gt_u32 s9, 1600000
    s_cbranch_scc1 W_dM1
    s_waitcnt lgkmcnt(0)
    v_cmp_gt_u32 vcc, 1, v2

    s_nop 0
    s_cbranch_vccnz W_lM1
W_dM1:
    s_waitcnt lgkmcnt(0)
    v_readfirstlane_b32 s63, v2
    s_nop 0
    s_lshr_b32 s63, s63, 1
    s_branch C_md1
SM_sS1:
    buffer_store_dwordx4 v[94:97], v4, s[36:39], s15 offen sc1
    s_branch SM_jS1
C_vr1:
    s_mov_b32 s9, 0
        W_lV1:
    ds_read_b32 v2, v5 offset:32
    s_add_u32 s9, s9, 1
    s_cmp_gt_u32 s9, 1600000
    s_cbranch_scc1 W_dV1
    s_waitcnt lgkmcnt(0)
    v_cmp_gt_u32 vcc, 4, v2

    s_nop 0
    s_cbranch_vccnz W_lV1
W_dV1:
    ds_read_b64_tr_b16 v[166:167], v34 offset:32768
    ds_read_b64_tr_b16 v[168:169], v34 offset:33280
    ds_read_b64_tr_b16 v[170:171], v35 offset:32768
    ds_read_b64_tr_b16 v[172:173], v35 offset:33280
    ds_read_b64_tr_b16 v[198:199], v34 offset:36864
    ds_read_b64_tr_b16 v[200:201], v34 offset:37376
    ds_read_b64_tr_b16 v[202:203], v35 offset:36864
    ds_read_b64_tr_b16 v[204:205], v35 offset:37376
    s_waitcnt lgkmcnt(0)
    s_branch C_vd1
C_pr:
    s_mov_b32 s9, 0
        C_pl:
    ds_read_b32 v48, v47 offset:40
    ds_read_b128 v[78:81], v43 offset:12288
    ds_read_b128 v[82:85], v43 offset:13312
    s_add_u32 s9, s9, 1
    s_cmp_gt_u32 s9, 1600000
    s_waitcnt lgkmcnt(0)
    s_cbranch_scc1 C_pd
    v_cmp_eq_u32 vcc, 0, v48
    s_nop 0
    s_cbranch_vccnz C_pl
    s_branch C_pd
SM_sO:
    s_nop 7
    v_cvt_pk_bf16_f32 v54, v62, v63
    v_cvt_pk_bf16_f32 v55, v64, v65
    v_cvt_pk_bf16_f32 v56, v66, v67
    v_cvt_pk_bf16_f32 v57, v68, v69
    buffer_store_dwordx4 v[54:57], v4, s[36:39], s100 offen sc1
    v_cvt_pk_bf16_f32 v58, v70, v71
    v_cvt_pk_bf16_f32 v59, v72, v73
    v_cvt_pk_bf16_f32 v60, v74, v75
    v_cvt_pk_bf16_f32 v61, v76, v77
    buffer_store_dwordx4 v[58:61], v4, s[36:39], s19 offen sc1
    s_branch SM_jO
SM_sF:
    buffer_store_dwordx2 v[14:15], v6, s[36:39], s21 offen sc1
    s_branch SM_jF
K_exit:
    s_endpgm
.fill 7168, 4, 0xbf810000
.section .rodata,"a"
.p2align 6
.amdhsa_kernel concat_heads__sliding_local_dilated__spectral_fnet__prompt_kernel
  .amdhsa_next_free_vgpr 256
  .amdhsa_next_free_sgpr 102
  .amdhsa_accum_offset 256
  .amdhsa_group_segment_fixed_size 0
  .amdhsa_kernarg_size 88
  .amdhsa_user_sgpr_count 2
  .amdhsa_user_sgpr_kernarg_segment_ptr 1
  .amdhsa_system_sgpr_workgroup_id_x 1
.end_amdhsa_kernel
```

```asm
; @launch grid=(256,1,1) block=(512,1,1) lds=163840
.amdgcn_target "amdgcn-amd-amdhsa--gfx950"
.text
.p2align 12
.fill 832, 4, 0xbf810000
.globl concat_heads__sliding_local_dilated__spectral_fnet__prompt_kernel
.p2align 8
.type concat_heads__sliding_local_dilated__spectral_fnet__prompt_kernel,@function
concat_heads__sliding_local_dilated__spectral_fnet__prompt_kernel:
    s_load_dwordx2 s[16:17], s[0:1], 0
    s_load_dwordx2 s[20:21], s[0:1], 8
    s_load_dwordx2 s[28:29], s[0:1], 24
    s_load_dwordx2 s[36:37], s[0:1], 80
    s_load_dwordx2 s[24:25], s[0:1], 16
    s_load_dwordx2 s[32:33], s[0:1], 64
    v_lshrrev_b32 v1, 6, v0
    s_cmp_ge_u32 s2, 256
    s_cbranch_scc1 K_exit
    v_readfirstlane_b32 s3, v1
    s_and_b32 s4, s2, 7
    s_lshr_b32 s5, s2, 3
    s_sub_u32 s5, s5, 4
    s_and_b32 s5, s5, 31
    s_cmp_lg_u32 s3, 7
    s_cbranch_scc1 K_nopf
    s_getpc_b64 s[44:45]
    s_mov_b32 s46, 28672
    s_mov_b32 s47, 0x00020000
    s_mul_i32 s40, s5, 896
    v_and_b32 v1, 63, v0
    v_min_u32 v1, 6, v1
    v_lshlrev_b32 v1, 7, v1
    buffer_load_dword v255, v1, s[44:47], s40 offen
K_nopf:
    s_mul_i32 s6, s5, 37
    s_lshr_b32 s6, s6, 8
    s_mul_i32 s40, s6, 7
    s_sub_u32 s7, s5, s40
    s_mov_b32 s38, 0x10000000
    s_mov_b32 s39, 0x00020000
    s_lshl_b32 s8, s4, 2
    s_cmp_lt_u32 s5, 28
    s_cbranch_scc1 K_a
    s_add_u32 s8, s8, s7
    s_mov_b32 s30, 1835008
    s_mov_b32 s31, 0x00020000
    s_lshl_b32 s40, s3, 7
    s_add_u32 s40, s40, s8
    v_and_b32 v4, 32, v0
    v_add_u32 v4, s40, v4
    v_and_b32 v5, 31, v0
    v_lshlrev_b32 v5, 4, v5
    v_mov_b32 v6, 896
    v_mad_u32_u24 v7, v4, v6, v5
    v_add_u32 v5, 384, v5
    v_sub_u32 v8, 960, v4
    v_mad_u32_u24 v8, v8, v6, v5
    v_sub_u32 v9, 2048, v4
    v_and_b32 v9, 2047, v9
    v_mad_u32_u24 v9, v9, v6, v5
    s_lshl_b32 s42, s3, 13
    s_mov_b32 m0, s42
    s_mov_b32 s52, 57344
    s_mov_b32 s53, 917504
    s_mov_b32 s54, 974848
    s_waitcnt lgkmcnt(0)
    buffer_load_dwordx4 v7, s[28:31], 0 offen nt lds
    s_add_u32 m0, m0, 1024
    s_nop 0
    buffer_load_dwordx4 v7, s[28:31], s52 offen nt lds
    s_add_u32 m0, m0, 1024
    s_nop 0
    buffer_load_dwordx4 v9, s[28:31], 0 offen nt lds
    s_add_u32 m0, m0, 1024
    s_nop 0
    buffer_load_dwordx4 v8, s[28:31], s53 offen nt lds
    s_add_u32 m0, m0, 1024
    s_load_dwordx2 s[10:11], s[36:37], 4096
    s_branch K_spare2
K_a:
    s_add_u32 s8, s8, s6
    s_cmp_ge_u32 s3, 4
    s_cbranch_scc1 K_c
    s_setprio 2
    s_mov_b32 s44, s4
    s_add_u32 s44, s44, s7
    s_mul_i32 s40, s44, 65
    s_lshr_b32 s40, s40, 8
    s_mul_i32 s40, s40, 4
    s_sub_u32 s44, s44, s40
    s_lshl_b32 s44, s44, 2
    s_lshr_b32 s44, 0x6420, s44
    s_and_b32 s44, s44, 7
    s_mov_b32 s18, 1835008
    s_mov_b32 s19, 0x00020000
    s_mov_b32 s22, 1204224
    s_mov_b32 s23, 0x00020000
    v_and_b32 v1, 63, v0
    v_lshrrev_b32 v6, 3, v1
    v_and_b32 v7, 7, v1
    v_lshrrev_b32 v8, 4, v1
    v_xor_b32 v3, v7, v8
    v_mul_u32_u24 v23, 896, v6
    v_lshl_add_u32 v21, v3, 4, v23
    v_xor_b32 v22, 64, v21
    v_add_u32 v22, 6144, v22
    s_and_b32 s43, s3, 1
    s_lshl_b32 s40, s43, 6
    v_xor_b32 v23, s40, v21
    s_lshl_b32 s40, s43, 1
    s_sub_u32 s40, 2, s40
    v_sub_u32 v2, s40, v6
    v_max_i32 v2, 0, v2
    v_mul_u32_u24 v2, 896, v2
    v_add_u32 v23, v23, v2
    v_and_b32 v2, 2, v6
    v_xor_b32 v2, v7, v2
    v_mul_u32_u24 v3, 2688, v6
    v_lshl_add_u32 v24, v2, 4, v3
    v_xor_b32 v25, 64, v24
    v_add_u32 v25, 20480, v25
    v_add_u32 v26, 896, v24
    v_add_u32 v27, 896, v25
    v_add_u32 v28, 1792, v24
    v_add_u32 v29, 1792, v25
    s_mov_b32 s45, s44
    s_lshl_b32 s40, s8, 6
    s_lshl_b32 s41, s3, 4
    s_add_u32 s42, s40, s41
    s_mul_i32 s46, s42, 896
    s_mul_i32 s48, s41, 2688
    s_lshl_b32 s42, s7, 7
    s_add_u32 s48, s48, s42
    s_sub_u32 s40, s40, 16
    s_max_i32 s40, s40, 0
    s_lshl_b32 s41, s43, 3
    s_add_u32 s40, s40, s41
    s_mul_i32 s47, s40, 896
    s_lshl_b32 s50, s3, 11
    s_lshr_b32 s41, s3, 1
    s_mul_i32 s41, s41, 10240
    s_lshl_b32 s49, s43, 10
    s_add_u32 s49, s49, s41
    s_lshl_b32 s40, s44, 7
    s_add_u32 s51, s40, s46
    s_mul_i32 s53, s44, 172032
    s_add_u32 s53, s53, s48
    s_add_u32 m0, s50, 2048
    s_add_u32 s44, s44, 1
    s_cmp_eq_u32 s44, 7
    s_cselect_b32 s44, 0, s44
    s_waitcnt lgkmcnt(0)
    buffer_load_dwordx4 v21, s[16:19], s51 offen lds
    buffer_load_dwordx4 v22, s[16:19], s51 offen offset:1024 lds
    s_lshl_b32 s41, s44, 7
    s_cmp_lt_u32 s3, 2
    s_cselect_b32 s52, s40, s41
    s_add_u32 m0, s49, 0
    s_add_u32 s52, s52, s47
    buffer_load_dwordx4 v23, s[16:19], s52 offen lds
    s_add_u32 m0, s50, 79872
    s_nop 0
    buffer_load_dwordx4 v24, s[20:23], s53 offen lds
    buffer_load_dwordx4 v25, s[20:23], s53 offen offset:1024 lds
    s_add_u32 m0, s50, 88064
    s_nop 0
    buffer_load_dwordx4 v26, s[20:23], s53 offen lds
    buffer_load_dwordx4 v27, s[20:23], s53 offen offset:1024 lds
    s_add_u32 m0, s50, 96256
    s_mul_i32 s53, s45, 172032
    s_add_u32 s53, s53, s48
    s_add_u32 s45, s45, 1
    s_cmp_eq_u32 s45, 7
    s_cselect_b32 s45, 0, s45
    buffer_load_dwordx4 v28, s[20:23], s53 offen lds
    buffer_load_dwordx4 v29, s[20:23], s53 offen offset:1024 lds
    s_lshl_b32 s40, s44, 7
    s_add_u32 s51, s40, s46
    s_mul_i32 s53, s44, 172032
    s_add_u32 s53, s53, s48
    s_add_u32 m0, s50, 12288
    s_add_u32 s44, s44, 1
    s_cmp_eq_u32 s44, 7
    s_cselect_b32 s44, 0, s44
    buffer_load_dwordx4 v21, s[16:19], s51 offen lds
    buffer_load_dwordx4 v22, s[16:19], s51 offen offset:1024 lds
    s_lshl_b32 s56, s8, 7
    s_load_dwordx2 s[10:11], s[36:37], s56
    s_lshl_b32 s30, s8, 10
    s_add_u32 s30, s30, 65536
    s_getreg_b32 s28, hwreg(HW_REG_XCC_ID, 0, 3)
    v_min_u32 v20, 6, v1
    v_lshlrev_b32 v20, 3, v20
    s_mov_b32 s26, 401408
    s_mov_b32 s27, 0x00020000
    s_mov_b32 s34, 3670016
    s_mov_b32 s35, 0x00020000
    s_lshr_b32 s58, s3, 1
    s_and_b32 s59, s3, 1
    v_and_b32 v9, 15, v1
    v_mov_b32 v4, 0
    v_mov_b32 v14, 1
    v_mov_b32 v5, 161792
    v_and_b32 v50, 6, v6
    v_xor_b32 v50, v7, v50
    v_mul_u32_u24 v51, 896, v6
    v_lshl_add_u32 v10, v50, 4, v51
    v_add_u32 v11, 6144, v10
    s_mov_b32 s54, s6
    s_mul_i32 s55, s3, 14336
    s_lshl_b32 s56, s7, 7
    s_add_u32 s55, s55, s56
    s_and_b32 s56, s3, 1
    s_lshl_b32 s57, s7, 1
    s_add_u32 s56, s56, s57
    s_lshl_b32 s15, s56, 10
    s_lshl_b32 s56, s8, 2
    s_and_b32 s57, s3, 2
    s_add_u32 s56, s56, s57
    s_mul_i32 s57, s56, 14336
    s_add_u32 s15, s15, s57
    s_add_u32 s15, s15, 2097152
    s_lshl_b32 s100, s56, 6
    s_add_u32 s100, s100, 16384
    v_lshlrev_b32 v50, 7, v7
    v_and_b32 v51, 1, v6
    v_mul_u32_u24 v51, 14336, v51
    v_add3_u32 v12, v50, v51, s15
    v_mov_b32 v50, s100
    v_cmp_le_u32 vcc, 16, v1
    s_nop 1
    v_cndmask_b32 v12, v12, v50, vcc
    v_and_b32 v50, 1, v9
    v_cmp_eq_u32 s[42:43], 1, v50
    v_lshl_add_u32 v50, v8, 2, v50
    v_cmp_le_u32 s[0:1], v50, v9
    v_add_u32 v50, 2, v50
    v_cmp_le_u32 s[12:13], v50, v9
    v_mov_b32 v50, 0xffff
    v_mov_b32 v51, 0xffff0000
    v_cndmask_b32 v50, v50, v51, s[42:43]
    v_cndmask_b32 v52, v50, 0, s[0:1]
    v_cndmask_b32 v53, v50, 0, s[12:13]
    v_cndmask_b32 v54, 0, v50, s[0:1]
    v_cndmask_b32 v55, 0, v50, s[12:13]
    v_lshlrev_b32 v50, 4, v1
    s_add_u32 s56, s50, 4096
    v_add_u32 v56, s56, v50
    s_xor_b32 s56, s50, 2048
    s_add_u32 s56, s56, 4096
    v_add_u32 v57, s56, v50
    v_add_u32 v59, s50, v50
    v_lshl_add_u32 v58, s58, 3, v5
    v_lshl_add_u32 v60, s3, 2, v5
    s_cmp_eq_u32 s7, 3
    s_cselect_b32 s56, 0, 1.0
    v_mov_b32 v61, s56
    s_mov_b32 s31, 0x3e8b97f6
K_h2:
    s_add_u32 m0, s50, 104448
    s_nop 0
    buffer_load_dwordx4 v24, s[20:23], s53 offen lds
    buffer_load_dwordx4 v25, s[20:23], s53 offen offset:1024 lds
    s_add_u32 m0, s50, 112640
    s_nop 0
    buffer_load_dwordx4 v26, s[20:23], s53 offen lds
    buffer_load_dwordx4 v27, s[20:23], s53 offen offset:1024 lds
    s_add_u32 m0, s50, 120832
    s_mul_i32 s53, s45, 172032
    s_add_u32 s53, s53, s48
    s_add_u32 s45, s45, 1
    s_cmp_eq_u32 s45, 7
    s_cselect_b32 s45, 0, s45
    buffer_load_dwordx4 v28, s[20:23], s53 offen lds
    buffer_load_dwordx4 v29, s[20:23], s53 offen offset:1024 lds
    s_lshl_b32 s40, s44, 7
    s_add_u32 s51, s40, s46
    s_mul_i32 s53, s44, 172032
    s_add_u32 s53, s53, s48
    s_add_u32 m0, s50, 22528
    s_add_u32 s44, s44, 1
    s_cmp_eq_u32 s44, 7
    s_cselect_b32 s44, 0, s44
    buffer_load_dwordx4 v21, s[16:19], s51 offen lds
    buffer_load_dwordx4 v22, s[16:19], s51 offen offset:1024 lds
    s_waitcnt lgkmcnt(0)
    s_add_u32 s12, s10, 0x5a3c9671
    s_xor_b32 s13, s11, 0x2b7e1516
    s_add_u32 s28, s28, s12
    s_mov_b32 s29, s13
    s_waitcnt vmcnt(10)
    s_barrier
    s_lshl_b32 s41, s44, 7
    s_cmp_lt_u32 s3, 2
    s_cselect_b32 s52, s40, s41
    s_add_u32 m0, s49, 20480
    s_add_u32 s52, s52, s47
    buffer_load_dwordx4 v23, s[16:19], s52 offen lds
    s_add_u32 m0, s50, 129024
    s_nop 0
    buffer_load_dwordx4 v24, s[20:23], s53 offen lds
    buffer_load_dwordx4 v25, s[20:23], s53 offen offset:1024 lds
    s_add_u32 m0, s50, 137216
    s_nop 0
    buffer_load_dwordx4 v26, s[20:23], s53 offen lds
    buffer_load_dwordx4 v27, s[20:23], s53 offen offset:1024 lds
    s_add_u32 m0, s50, 145408
    s_mul_i32 s53, s45, 172032
    s_add_u32 s53, s53, s48
    s_add_u32 s45, s45, 1
    s_cmp_eq_u32 s45, 7
    s_cselect_b32 s45, 0, s45
    buffer_load_dwordx4 v28, s[20:23], s53 offen lds
    buffer_load_dwordx4 v29, s[20:23], s53 offen offset:1024 lds
    s_lshl_b32 s40, s44, 7
    s_add_u32 s51, s40, s46
    s_mul_i32 s53, s44, 172032
    s_add_u32 s53, s53, s48
    s_add_u32 m0, s50, 32768
    s_add_u32 s44, s44, 1
    s_cmp_eq_u32 s44, 7
    s_cselect_b32 s44, 0, s44
    buffer_load_dwordx4 v21, s[16:19], s51 offen lds
    buffer_load_dwordx4 v22, s[16:19], s51 offen offset:1024 lds
    s_add_u32 m0, s50, 153600
    s_nop 0
    buffer_load_dwordx4 v24, s[20:23], s53 offen lds
    s_waitcnt vmcnt(12)
    s_barrier
    buffer_load_dwordx4 v25, s[20:23], s53 offen offset:1024 lds
    s_add_u32 m0, s50, 71680
    s_nop 0
    buffer_load_dwordx4 v26, s[20:23], s53 offen lds
    buffer_load_dwordx4 v27, s[20:23], s53 offen offset:1024 lds
    s_add_u32 m0, s50, 79872
    s_mul_i32 s53, s45, 172032
    s_add_u32 s53, s53, s48
    s_add_u32 s45, s45, 1
    s_cmp_eq_u32 s45, 7
    s_cselect_b32 s45, 0, s45
    buffer_load_dwordx4 v28, s[20:23], s53 offen lds
    buffer_load_dwordx4 v29, s[20:23], s53 offen offset:1024 lds
    s_lshl_b32 s40, s44, 7
    s_add_u32 s51, s40, s46
    s_mul_i32 s53, s44, 172032
    s_add_u32 s53, s53, s48
    s_add_u32 m0, s50, 43008
    s_add_u32 s44, s44, 1
    s_cmp_eq_u32 s44, 7
    s_cselect_b32 s44, 0, s44
    buffer_load_dwordx4 v21, s[16:19], s51 offen lds
    buffer_load_dwordx4 v22, s[16:19], s51 offen offset:1024 lds
    s_lshl_b32 s41, s44, 7
    s_cmp_lt_u32 s3, 2
    s_cselect_b32 s52, s40, s41
    s_add_u32 m0, s49, 40960
    s_add_u32 s52, s52, s47
    buffer_load_dwordx4 v23, s[16:19], s52 offen lds
    s_add_u32 m0, s50, 88064
    s_nop 0
    buffer_load_dwordx4 v24, s[20:23], s53 offen lds
    s_waitcnt vmcnt(12)
    s_barrier
    buffer_load_dwordx4 v25, s[20:23], s53 offen offset:1024 lds
    s_add_u32 m0, s50, 96256
    s_nop 0
    buffer_load_dwordx4 v26, s[20:23], s53 offen lds
    buffer_load_dwordx4 v27, s[20:23], s53 offen offset:1024 lds
    s_add_u32 m0, s50, 104448
    s_mul_i32 s53, s45, 172032
    s_add_u32 s53, s53, s48
    s_add_u32 s45, s45, 1
    s_cmp_eq_u32 s45, 7
    s_cselect_b32 s45, 0, s45
    buffer_load_dwordx4 v28, s[20:23], s53 offen lds
    buffer_load_dwordx4 v29, s[20:23], s53 offen offset:1024 lds
    s_lshl_b32 s40, s44, 7
    s_add_u32 s51, s40, s46
    s_mul_i32 s53, s44, 172032
    s_add_u32 s53, s53, s48
    s_add_u32 m0, s50, 53248
    s_add_u32 s44, s44, 1
    s_cmp_eq_u32 s44, 7
    s_cselect_b32 s44, 0, s44
    buffer_load_dwordx4 v21, s[16:19], s51 offen lds
    buffer_load_dwordx4 v22, s[16:19], s51 offen offset:1024 lds
    s_add_u32 m0, s50, 112640
    s_nop 0
    buffer_load_dwordx4 v24, s[20:23], s53 offen lds
    s_waitcnt vmcnt(12)
    s_barrier
    buffer_load_dwordx4 v25, s[20:23], s53 offen offset:1024 lds
    s_add_u32 m0, s50, 120832
    s_nop 0
    buffer_load_dwordx4 v26, s[20:23], s53 offen lds
    buffer_load_dwordx4 v27, s[20:23], s53 offen offset:1024 lds
    s_cmp_lg_u32 s3, 3
    s_cbranch_scc1 H_nx
    buffer_load_dwordx2 v[18:19], v20, s[36:39], s30 offen sc1
H_nx:
    s_lshl_b32 s40, s44, 7
    s_add_u32 s51, s40, s46
    s_mul_i32 s53, s44, 172032
    s_add_u32 s53, s53, s48
    s_add_u32 m0, s50, 63488
    s_add_u32 s44, s44, 1
    s_cmp_eq_u32 s44, 7
    s_cselect_b32 s44, 0, s44
    buffer_load_dwordx4 v21, s[16:19], s51 offen lds
    buffer_load_dwordx4 v22, s[16:19], s51 offen offset:1024 lds
    s_lshl_b32 s41, s44, 7
    s_cmp_lt_u32 s3, 2
    s_cselect_b32 s52, s40, s41
    s_cbranch_scc0 H_nh
    s_add_u32 m0, s49, 61440
    s_add_u32 s52, s52, s47
    buffer_load_dwordx4 v23, s[16:19], s52 offen lds
H_nh:
    s_add_u32 m0, s50, 129024
    s_nop 0
    buffer_load_dwordx4 v24, s[20:23], s53 offen lds
    buffer_load_dwordx4 v25, s[20:23], s53 offen offset:1024 lds
    s_waitcnt vmcnt(10)
    s_barrier
    s_add_u32 m0, s50, 137216
    s_nop 0
    buffer_load_dwordx4 v26, s[20:23], s53 offen lds
    buffer_load_dwordx4 v27, s[20:23], s53 offen offset:1024 lds
    s_add_u32 m0, s50, 145408
    s_mul_i32 s53, s45, 172032
    s_add_u32 s53, s53, s48
    s_add_u32 s45, s45, 1
    s_cmp_eq_u32 s45, 7
    s_cselect_b32 s45, 0, s45
    buffer_load_dwordx4 v28, s[20:23], s53 offen lds
    buffer_load_dwordx4 v29, s[20:23], s53 offen offset:1024 lds
    s_add_u32 m0, s50, 153600
    s_mul_i32 s53, s45, 172032
    s_add_u32 s53, s53, s48
    s_add_u32 s45, s45, 1
    s_cmp_eq_u32 s45, 7
    s_cselect_b32 s45, 0, s45
    buffer_load_dwordx4 v28, s[20:23], s53 offen lds
    s_waitcnt vmcnt(9)
    s_barrier
    buffer_load_dwordx4 v29, s[20:23], s53 offen offset:1024 lds
    s_lshl_b32 s40, s54, 13
    s_add_u32 s40, s40, s50
    s_add_u32 m0, s40, 71680
    s_add_u32 s40, s54, s7
    s_sub_u32 s41, s40, 7
    s_min_u32 s40, s40, s41
    s_mul_i32 s40, s40, 57344
    s_add_u32 s40, s40, s55
    s_add_u32 s54, s54, 1
    s_cmp_eq_u32 s54, 5
    s_cselect_b32 s54, 0, s54
    buffer_load_dwordx4 v10, s[24:27], s40 offen lds
    buffer_load_dwordx4 v11, s[24:27], s40 offen offset:1024 lds
    s_waitcnt vmcnt(8)
    s_barrier
    s_lshl_b32 s40, s54, 13
    s_add_u32 s40, s40, s50
    s_add_u32 m0, s40, 71680
    s_add_u32 s40, s54, s7
    s_sub_u32 s41, s40, 7
    s_min_u32 s40, s40, s41
    s_mul_i32 s40, s40, 57344
    s_add_u32 s40, s40, s55
    s_add_u32 s54, s54, 1
    s_cmp_eq_u32 s54, 5
    s_cselect_b32 s54, 0, s54
    buffer_load_dwordx4 v10, s[24:27], s40 offen lds
    buffer_load_dwordx4 v11, s[24:27], s40 offen offset:1024 lds
    s_waitcnt vmcnt(8)
    s_barrier
    s_cmp_lg_u32 s3, 3
    s_cbranch_scc1 H_nc
    s_mov_b32 s101, 1
    v_cmp_ne_u32 vcc, s28, v18
    v_cmp_ne_u32 s[42:43], s29, v19
    s_nop 0
    s_or_b64 vcc, vcc, s[42:43]
    s_cbranch_vccnz X_cH
X_okH:
    v_add_u32 v2, s101, v14
    ds_write_b32 v5, v2 offset:4
H_nc:
    s_setprio 0
    s_lshl_b32 s40, s54, 13
    s_add_u32 s40, s40, s50
    s_add_u32 m0, s40, 71680
    s_add_u32 s40, s54, s7
    s_sub_u32 s41, s40, 7
    s_min_u32 s40, s40, s41
    s_mul_i32 s40, s40, 57344
    s_add_u32 s40, s40, s55
    s_add_u32 s54, s54, 1
    s_cmp_eq_u32 s54, 5
    s_cselect_b32 s54, 0, s54
    buffer_load_dwordx4 v10, s[24:27], s40 offen lds
    buffer_load_dwordx4 v11, s[24:27], s40 offen offset:1024 lds
    buffer_load_dword v13, v12, s[36:39], 0 offen sc1
    s_lshl_b32 s40, s54, 13
    s_add_u32 s40, s40, s50
    s_add_u32 m0, s40, 71680
    s_add_u32 s40, s54, s7
    s_sub_u32 s41, s40, 7
    s_min_u32 s40, s40, s41
    s_mul_i32 s40, s40, 57344
    s_add_u32 s40, s40, s55
    s_add_u32 s54, s54, 1
    s_cmp_eq_u32 s54, 5
    s_cselect_b32 s54, 0, s54
    buffer_load_dwordx4 v10, s[24:27], s40 offen lds
    buffer_load_dwordx4 v11, s[24:27], s40 offen offset:1024 lds
    s_lshl_b32 s40, s54, 13
    s_add_u32 s40, s40, s50
    s_add_u32 m0, s40, 71680
    s_add_u32 s40, s54, s7
    s_sub_u32 s41, s40, 7
    s_min_u32 s40, s40, s41
    s_mul_i32 s40, s40, 57344
    s_add_u32 s40, s40, s55
    s_add_u32 s54, s54, 1
    s_cmp_eq_u32 s54, 5
    s_cselect_b32 s54, 0, s54
    buffer_load_dwordx4 v10, s[24:27], s40 offen lds
    buffer_load_dwordx4 v11, s[24:27], s40 offen offset:1024 lds
    s_waitcnt vmcnt(11)
    s_mov_b64 exec, 1
    ds_add_u32 v5, v14 offset:32
    s_mov_b64 exec, -1
    s_mov_b32 s9, 0
    s_setprio 0
H_il:
    ds_read_b64 v[62:63], v58 offset:16
    ds_read_b128 v[30:33], v56
    ds_read_b128 v[34:37], v57
    s_add_u32 s9, s9, 1
    s_cmp_gt_u32 s9, 1600000
    s_cbranch_scc1 H_id
    s_waitcnt lgkmcnt(2)
    v_and_b32 v62, v62, v63
    v_cmp_eq_u32 vcc, 0, v62
    s_waitcnt lgkmcnt(0)
    s_cbranch_vccnz H_il
H_id:
    s_waitcnt lgkmcnt(0)
    v_fma_f32 v30, v34, v61, v30
    v_fma_f32 v31, v35, v61, v31
    v_fma_f32 v32, v36, v61, v32
    v_fma_f32 v33, v37, v61, v33
    v_mul_f32 v30, s31, v30
    v_mul_f32 v31, s31, v31
    v_mul_f32 v32, s31, v32
    v_mul_f32 v33, s31, v33
    v_max_f32 v62, v30, v31
    v_max_f32 v63, v32, v33
    v_mov_b32 v64, v62
    v_mov_b32 v65, v63
    s_nop 0
    v_permlane16_swap_b32 v62, v64
    v_permlane16_swap_b32 v63, v65
    v_max_f32 v62, v62, v64
    v_max_f32 v63, v63, v65
    v_mov_b32 v64, v62
    v_mov_b32 v65, v63
    s_nop 0
    v_permlane32_swap_b32 v62, v64
    v_permlane32_swap_b32 v63, v65
    v_max_f32 v62, v62, v64
    v_max_f32 v63, v63, v65
    v_sub_f32 v30, v30, v62
    v_sub_f32 v31, v31, v62
    v_sub_f32 v32, v32, v63
    v_sub_f32 v33, v33, v63
    v_exp_f32 v30, v30
    v_exp_f32 v31, v31
    v_exp_f32 v32, v32
    v_exp_f32 v33, v33
    v_add_f32 v62, v30, v31
    v_add_f32 v63, v32, v33
    v_mov_b32 v64, v62
    v_mov_b32 v65, v63
    s_nop 0
    v_permlane16_swap_b32 v62, v64
    v_permlane16_swap_b32 v63, v65
    v_add_f32 v62, v62, v64
    v_add_f32 v63, v63, v65
    v_mov_b32 v64, v62
    v_mov_b32 v65, v63
    s_nop 0
    v_permlane32_swap_b32 v62, v64
    v_permlane32_swap_b32 v63, v65
    v_add_f32 v62, v62, v64
    v_add_f32 v63, v63, v65
    v_rcp_f32 v62, v62
    v_rcp_f32 v63, v63
    v_mul_f32 v30, v30, v62
    v_mul_f32 v31, v31, v62
    v_mul_f32 v32, v32, v63
    v_mul_f32 v33, v33, v63
    v_cvt_pk_bf16_f32 v30, v30, v30
    v_cvt_pk_bf16_f32 v31, v31, v31
    v_cvt_pk_bf16_f32 v32, v32, v32
    v_cvt_pk_bf16_f32 v33, v33, v33
    v_and_b32 v38, v52, v30
    v_and_b32 v39, v53, v31
    v_and_b32 v40, v54, v30
    v_and_b32 v41, v55, v31
    ds_write_b128 v59, v[38:41] offset:12288
    v_and_b32 v42, v52, v32
    v_and_b32 v43, v53, v33
    v_and_b32 v44, v54, v32
    v_and_b32 v45, v55, v33
    ds_write_b128 v59, v[42:45] offset:13312
    ds_write_b32 v60, v5 offset:40
    s_setprio 0
    s_waitcnt vmcnt(0)
    s_mov_b64 exec, 1
    ds_add_u32 v5, v14 offset:12
    s_mov_b64 exec, -1
    s_mov_b32 s9, 0
W_lR:
    ds_read_b32 v2, v5 offset:80
    s_add_u32 s9, s9, 1
    s_cmp_gt_u32 s9, 1600000
    s_cbranch_scc1 W_dR
    s_waitcnt lgkmcnt(0)
    v_cmp_gt_u32 vcc, 4, v2
    s_nop 0
    s_cbranch_vccnz W_lR
W_dR:
    s_add_u32 m0, s50, 112640
    s_add_u32 s40, s7, 5
    s_sub_u32 s41, s40, 7
    s_min_u32 s40, s40, s41
    s_mul_i32 s40, s40, 57344
    s_add_u32 s40, s40, s55
    buffer_load_dwordx4 v10, s[24:27], s40 offen lds
    buffer_load_dwordx4 v11, s[24:27], s40 offen offset:1024 lds
    s_add_u32 m0, s50, 120832
    s_add_u32 s40, s7, 6
    s_sub_u32 s41, s40, 7
    s_min_u32 s40, s40, s41
    s_mul_i32 s40, s40, 57344
    s_add_u32 s40, s40, s55
    buffer_load_dwordx4 v10, s[24:27], s40 offen lds
    buffer_load_dwordx4 v11, s[24:27], s40 offen offset:1024 lds
    s_waitcnt vmcnt(0)
    s_mov_b64 exec, 1
    ds_add_u32 v5, v14 offset:36
    s_endpgm
K_spare2:
    buffer_load_dwordx4 v7, s[28:31], s53 offen nt lds
    s_add_u32 m0, m0, 1024
    s_mov_b32 s26, 401408
    s_mov_b32 s27, 0x00020000
    s_mov_b32 s34, 3670016
    s_mov_b32 s35, 0x00020000
    v_and_b32 v6, 15, v0
    v_lshlrev_b32 v6, 4, v6
    v_bfe_u32 v4, v0, 4, 2
    v_lshl_add_u32 v4, v4, 9, s42
    v_add_u32 v10, v4, v6
    v_sub_u32 v11, v4, v6
    v_add_u32 v11, 432, v11
    v_mov_b32 v12, 0
    s_and_b32 s55, s3, 3
    s_lshr_b32 s56, s3, 2
    v_and_b32 v1, 63, v0
    v_lshrrev_b32 v2, 4, v1
    v_and_b32 v3, 15, v1
    s_lshl_b32 s61, s55, 3
    v_lshrrev_b32 v4, 1, v3
    v_and_b32 v4, 4, v4
    v_and_or_b32 v4, v3, 3, v4
    v_add_u32 v4, s61, v4
    v_bfe_u32 v5, v3, 2, 1
    v_cvt_f32_u32 v97, v5
    v_mul_f32 v97, 0x3e800000, v97
    v_lshl_add_u32 v5, v4, 1, v5
    v_cmp_eq_u32 vcc, 1, v5
    s_nop 1
    v_cndmask_b32 v4, v4, 32, vcc
    v_cndmask_b32 v97, v97, 0, vcc
    v_cvt_f32_u32 v96, v4
    v_mul_f32 v96, 0x3c800000, v96
    v_lshlrev_b32 v4, 3, v2
    v_cvt_f32_u32 v4, v4
    v_fma_f32 v97, v96, v4, v97
    v_cos_f32 v118, v96
    s_nop 0
    v_add_f32 v118, v118, v118
    v_fmamk_f32 v102, v96, 0x0, v97
    v_fmamk_f32 v103, v96, 0x3f800000, v97
    v_fmamk_f32 v110, v96, 0x42000000, v97
    v_fmamk_f32 v111, v96, 0x42040000, v97
    v_cos_f32 v102, v102
    v_cos_f32 v103, v103
    v_cos_f32 v110, v110
    v_cos_f32 v111, v111
    v_fma_f32 v104, v118, v103, -v102
    v_fma_f32 v112, v118, v111, -v110
    v_fma_f32 v105, v118, v104, -v103
    v_fma_f32 v113, v118, v112, -v111
    v_fma_f32 v106, v118, v105, -v104
    v_fma_f32 v114, v118, v113, -v112
    v_fma_f32 v107, v118, v106, -v105
    v_fma_f32 v115, v118, v114, -v113
    v_fma_f32 v108, v118, v107, -v106
    v_fma_f32 v116, v118, v115, -v114
    v_fma_f32 v109, v118, v108, -v107
    v_fma_f32 v117, v118, v116, -v115
    v_cvt_pk_bf16_f32 v20, v102, v103
    v_cvt_pk_bf16_f32 v21, v104, v105
    v_cvt_pk_bf16_f32 v22, v106, v107
    v_cvt_pk_bf16_f32 v23, v108, v109
    v_cvt_pk_bf16_f32 v24, v110, v111
    v_cvt_pk_bf16_f32 v25, v112, v113
    v_cvt_pk_bf16_f32 v26, v114, v115
    v_cvt_pk_bf16_f32 v27, v116, v117
    v_lshrrev_b32 v4, 4, v0
    v_and_b32 v5, 3, v4
    v_lshlrev_b32 v5, 6, v5
    v_lshlrev_b32 v13, 1, v6
    v_xor_b32 v13, v13, v5
    v_bfe_u32 v5, v4, 3, 1
    v_lshl_add_u32 v13, v5, 4, v13
    v_lshl_add_u32 v13, v4, 9, v13
    v_add_u32 v13, 65536, v13
    v_xor_b32 v14, 16, v13
    v_lshrrev_b32 v4, 2, v3
    v_lshl_add_u32 v5, v2, 3, v4
    v_lshlrev_b32 v5, 9, v5
    v_lshl_add_u32 v5, v4, 6, v5
    v_and_b32 v4, 1, v1
    v_lshl_add_u32 v5, v4, 5, v5
    v_bfe_u32 v4, v1, 1, 1
    v_lshl_add_u32 v5, v4, 3, v5
    v_and_b32 v4, 1, v2
    v_xor_b32 v4, s56, v4
    v_lshl_add_u32 v16, v4, 4, v5
    v_add_u32 v16, 65536, v16
    v_xor_b32 v17, 64, v16
    v_xor_b32 v18, 128, v16
    v_xor_b32 v19, 192, v16
    v_and_b32 v15, 32, v1
    v_lshrrev_b32 v4, 2, v3
    v_add_lshl_u32 v15, v15, v4, 12
    v_and_b32 v4, 16, v1
    v_lshl_add_u32 v15, v4, 2, v15
    v_and_b32 v4, 3, v3
    v_lshl_add_u32 v15, v4, 4, v15
    v_and_b32 v4, 7, v3
    v_lshlrev_b32 v86, 16, v4
    v_mov_b32 v5, 0xffff0000
    v_add_u32 v87, s56, v3
    v_cmp_eq_u32 vcc, 0, v87
    s_nop 1
    v_cndmask_b32 v87, v5, 0, vcc
    v_add_u32 v4, 256, v11
    buffer_load_dwordx4 v7, s[28:31], s54 offen nt lds
    s_add_u32 m0, m0, 1024
    v_cmp_eq_u32 vcc, 15, v3
    s_nop 1
    v_cndmask_b32 v11, v11, v4, vcc
    s_lshl_b32 s50, s8, 3
    s_add_u32 s50, s50, s3
    s_mul_i32 s50, s50, 1568
    s_and_b32 s50, s50, 0xffffff80
    v_min_u32 v95, 12, v1
    v_lshlrev_b32 v95, 7, v95
    s_lshl_b32 s59, s55, 18
    s_lshl_b32 s61, s56, 14
    s_add_u32 s59, s59, s61
    s_lshl_b32 s61, s8, 7
    s_add_u32 s59, s59, s61
    s_add_u32 s59, s59, 1048576
    v_lshlrev_b32 v63, 4, v1
    v_and_b32 v4, 32, v1
    v_xor_b32 v60, v63, v4
    s_lshl_b32 s60, s8, 3
    s_add_u32 s60, s60, s3
    s_lshl_b32 s60, s60, 12
    s_add_u32 s60, s60, 1048576
    s_add_u32 s63, s8, 1024
    s_cmp_eq_u32 s8, 0
    s_cselect_b32 s63, 32, s63
    v_lshl_add_u32 v4, v3, 6, s8
    v_cvt_f32_u32 v96, v4
    v_mul_f32 v96, 0x3a000000, v96
    v_lshlrev_b32 v4, 2, v2
    v_cvt_f32_u32 v4, v4
    v_mul_f32 v97, v96, v4
    v_cos_f32 v118, v96
    s_nop 0
    v_add_f32 v118, v118, v118
    v_fmamk_f32 v102, v96, 0x0, v97
    v_fmamk_f32 v103, v96, 0x3f800000, v97
    v_fmamk_f32 v106, v96, 0x0, v97
    v_fmamk_f32 v107, v96, 0x3f800000, v97
    v_fmamk_f32 v110, v96, 0x41800000, v97
    v_fmamk_f32 v111, v96, 0x41880000, v97
    v_fmamk_f32 v114, v96, 0x41800000, v97
    v_fmamk_f32 v115, v96, 0x41880000, v97
    v_cos_f32 v102, v102
    v_cos_f32 v103, v103
    v_sin_f32 v106, v106
    buffer_load_dwordx4 v8, s[28:31], s52 offen nt lds
    s_add_u32 m0, m0, 1024
    v_sin_f32 v107, v107
    v_cos_f32 v110, v110
    v_cos_f32 v111, v111
    v_sin_f32 v114, v114
    v_sin_f32 v115, v115
    v_fma_f32 v104, v118, v103, -v102
    v_fma_f32 v108, v118, v107, -v106
    v_fma_f32 v112, v118, v111, -v110
    v_fma_f32 v116, v118, v115, -v114
    v_fma_f32 v105, v118, v104, -v103
    v_fma_f32 v109, v118, v108, -v107
    v_fma_f32 v113, v118, v112, -v111
    v_fma_f32 v117, v118, v116, -v115
    s_cmp_eq_u32 s8, 0
    s_cbranch_scc1 S_cls0
    v_cvt_pk_bf16_f32 v28, v102, v106
    v_cvt_pk_bf16_f32 v36, -v106, v102
    v_mov_b32 v44, v28
    v_mov_b32 v52, v36
    v_cvt_pk_bf16_f32 v29, v103, v107
    v_cvt_pk_bf16_f32 v37, -v107, v103
    v_xor_b32 v45, 0x80008000, v29
    v_xor_b32 v53, 0x80008000, v37
    v_cvt_pk_bf16_f32 v30, v104, v108
    v_cvt_pk_bf16_f32 v38, -v108, v104
    v_mov_b32 v46, v30
    v_mov_b32 v54, v38
    v_cvt_pk_bf16_f32 v31, v105, v109
    v_cvt_pk_bf16_f32 v39, -v109, v105
    v_xor_b32 v47, 0x80008000, v31
    v_xor_b32 v55, 0x80008000, v39
    v_cvt_pk_bf16_f32 v32, v110, v114
    v_cvt_pk_bf16_f32 v40, -v114, v110
    v_mov_b32 v48, v32
    v_mov_b32 v56, v40
    v_cvt_pk_bf16_f32 v33, v111, v115
    v_cvt_pk_bf16_f32 v41, -v115, v111
    v_xor_b32 v49, 0x80008000, v33
    v_xor_b32 v57, 0x80008000, v41
    v_cvt_pk_bf16_f32 v34, v112, v116
    v_cvt_pk_bf16_f32 v42, -v116, v112
    v_mov_b32 v50, v34
    v_mov_b32 v58, v42
    v_cvt_pk_bf16_f32 v35, v113, v117
    v_cvt_pk_bf16_f32 v43, -v117, v113
    v_xor_b32 v51, 0x80008000, v35
    v_xor_b32 v59, 0x80008000, v43
S_reg:
    s_lshl_b32 s61, s55, 14
    s_add_u32 s61, s61, 98304
    v_add_u32 v67, s61, v63
    v_cmp_eq_u32 s[42:43], 0, v2
    s_nop 1
    v_cndmask_b32 v98, 1.0, 0.5, s[42:43]
    v_and_b32 v4, 1, v2
    v_mov_b32 v5, 0xffff
    v_cmp_eq_u32 s[42:43], 1, v4
    s_nop 1
    v_cndmask_b32 v101, -1, v5, s[42:43]
    v_cndmask_b32 v96, 1.0, 0, s[42:43]
    v_cmp_eq_u32 s[42:43], 1, v2
    s_nop 1
    v_cndmask_b32 v97, v96, 0.5, s[42:43]
    s_cmp_eq_u32 s56, 0
    s_cselect_b64 s[42:43], -1, 0
    v_cndmask_b32 v99, v96, v97, s[42:43]
    v_cndmask_b32 v100, v97, v96, s[42:43]
    v_lshlrev_b32 v4, 6, v4
    v_and_b32 v5, 2, v2
    v_add_u32 v4, v4, v5
    v_cvt_f32_u32 v97, v4
    s_lshl_b32 s61, s55, 5
    s_add_u32 s61, s61, s56
    v_lshl_add_u32 v4, v3, 1, s61
    v_cvt_f32_u32 v96, v4
    v_mul_f32 v96, 0x3b124925, v96
    v_mul_f32 v97, v96, v97
    s_lshl_b32 s61, s56, 13
    v_add_u32 v5, s61, v67
    v_mul_f32 v118, 0x40800000, v96
    v_cos_f32 v118, v118
    s_nop 0
    v_add_f32 v118, v118, v118
    v_fmamk_f32 v102, v96, 0x0, v97
    v_fmamk_f32 v103, v96, 0x40800000, v97
    buffer_load_dwordx4 v8, s[28:31], 0 offen nt lds
    s_add_u32 m0, m0, 1024
    v_cos_f32 v102, v102
    v_cos_f32 v103, v103
    s_nop 0
    v_fma_f32 v104, v118, v103, -v102
    v_fma_f32 v105, v118, v104, -v103
    v_fma_f32 v106, v118, v105, -v104
    v_fma_f32 v107, v118, v106, -v105
    v_fma_f32 v108, v118, v107, -v106
    v_fma_f32 v109, v118, v108, -v107
    v_fma_f32 v110, v118, v109, -v108
    v_fma_f32 v111, v118, v110, -v109
    s_waitcnt lgkmcnt(0)
    s_add_u32 s12, s10, 0x5a3c9671
    s_xor_b32 s13, s11, 0x2b7e1516
    s_lshl_b32 s51, s12, 12
    s_xor_b32 s51, s51, s13
    s_and_b32 s51, s51, 0xbfff0000
    v_xor_b32 v86, s51, v86
    v_mov_b32 v92, s12
    v_mov_b32 v93, s13
    s_waitcnt vmcnt(4)
    ds_read_b128 v[120:123], v10 offset:0
    ds_read_b128 v[124:127], v11 offset:2112
    ds_read_b128 v[132:135], v10 offset:2112
    ds_read_b128 v[128:131], v11 offset:0
    s_waitcnt lgkmcnt(2)
    v_mov_b32 v136, v120
    v_lshlrev_b32 v140, 16, v121
    v_lshlrev_b32 v154, 16, v127
    v_and_b32 v141, 0xffff0000, v121
    v_and_b32 v155, 0xffff0000, v126
    v_pk_add_f32 v[140:141], v[140:141], v[154:155]
    v_mov_b32_dpp v136, v124 row_shr:1 row_mask:0xf bank_mask:0xf
    v_lshlrev_b32 v142, 16, v122
    v_lshlrev_b32 v154, 16, v126
    v_and_b32 v143, 0xffff0000, v122
    v_and_b32 v155, 0xffff0000, v125
    v_pk_add_f32 v[142:143], v[142:143], v[154:155]
    v_lshlrev_b32 v144, 16, v123
    v_lshlrev_b32 v154, 16, v125
    v_and_b32 v145, 0xffff0000, v123
    v_and_b32 v155, 0xffff0000, v124
    v_pk_add_f32 v[144:145], v[144:145], v[154:155]
    v_lshlrev_b32 v138, 16, v120
    v_lshlrev_b32 v154, 16, v136
    v_and_b32 v139, 0xffff0000, v120
    v_and_b32 v155, 0xffff0000, v127
    v_pk_add_f32 v[138:139], v[138:139], v[154:155]
    s_waitcnt lgkmcnt(0)
    v_lshlrev_b32 v148, 16, v133
    v_lshlrev_b32 v154, 16, v131
    v_and_b32 v149, 0xffff0000, v133
    v_and_b32 v155, 0xffff0000, v130
    v_pk_add_f32 v[148:149], v[148:149], v[154:155]
    v_mov_b32_dpp v137, v128 row_ror:1 row_mask:0xf bank_mask:0xf
    v_lshlrev_b32 v150, 16, v134
    v_lshlrev_b32 v154, 16, v130
    v_and_b32 v151, 0xffff0000, v134
    v_and_b32 v155, 0xffff0000, v129
    v_pk_add_f32 v[150:151], v[150:151], v[154:155]
    v_lshlrev_b32 v152, 16, v135
    v_lshlrev_b32 v154, 16, v129
    v_and_b32 v153, 0xffff0000, v135
    v_and_b32 v155, 0xffff0000, v128
    v_pk_add_f32 v[152:153], v[152:153], v[154:155]
    v_lshlrev_b32 v146, 16, v132
    v_lshlrev_b32 v154, 16, v137
    v_and_b32 v147, 0xffff0000, v132
    v_and_b32 v155, 0xffff0000, v131
    v_pk_add_f32 v[146:147], v[146:147], v[154:155]
    v_pk_add_f32 v[164:165], v[138:139], v[146:147]
    v_pk_add_f32 v[166:167], v[140:141], v[148:149]
    v_pk_add_f32 v[168:169], v[142:143], v[150:151]
    v_pk_add_f32 v[170:171], v[144:145], v[152:153]
    v_cvt_pk_bf16_f32 v156, v164, v166
    v_cvt_pk_bf16_f32 v157, v168, v170
    v_cvt_pk_bf16_f32 v158, v165, v167
    v_cvt_pk_bf16_f32 v159, v169, v171
    ds_write_b128 v13, v[156:159] offset:0
    v_pk_add_f32 v[164:165], v[138:139], v[146:147] neg_lo:[0,1] neg_hi:[0,1]
    v_pk_add_f32 v[166:167], v[140:141], v[148:149] neg_lo:[0,1] neg_hi:[0,1]
    v_pk_add_f32 v[168:169], v[142:143], v[150:151] neg_lo:[0,1] neg_hi:[0,1]
    v_pk_add_f32 v[170:171], v[144:145], v[152:153] neg_lo:[0,1] neg_hi:[0,1]
    v_cvt_pk_bf16_f32 v160, v164, v166
    v_cvt_pk_bf16_f32 v161, v168, v170
    v_cvt_pk_bf16_f32 v162, v165, v167
    v_cvt_pk_bf16_f32 v163, v169, v171
    ds_write_b128 v14, v[160:163] offset:0
    s_waitcnt lgkmcnt(0)
    s_barrier
    ds_read_b64_tr_b16 v[172:173], v16 offset:0
    ds_read_b64_tr_b16 v[174:175], v16 offset:2048
    ds_read_b64_tr_b16 v[176:177], v17 offset:0
    ds_read_b64_tr_b16 v[178:179], v17 offset:2048
    ds_read_b64_tr_b16 v[180:181], v18 offset:0
    ds_read_b64_tr_b16 v[182:183], v18 offset:2048
    ds_read_b64_tr_b16 v[184:185], v19 offset:0
    ds_read_b64_tr_b16 v[186:187], v19 offset:2048
    s_waitcnt lgkmcnt(6)
    v_mfma_f32_16x16x32_bf16 v[188:191], v[20:23], v[172:175], 0
    ds_read_b64_tr_b16 v[172:173], v16 offset:256
    ds_read_b64_tr_b16 v[174:175], v16 offset:2304
    s_waitcnt lgkmcnt(6)
    v_mfma_f32_16x16x32_bf16 v[192:195], v[20:23], v[176:179], 0
    ds_read_b64_tr_b16 v[176:177], v17 offset:256
    ds_read_b64_tr_b16 v[178:179], v17 offset:2304
    s_waitcnt lgkmcnt(6)
    v_mfma_f32_16x16x32_bf16 v[196:199], v[20:23], v[180:183], 0
    ds_read_b64_tr_b16 v[180:181], v18 offset:256
    ds_read_b64_tr_b16 v[182:183], v18 offset:2304
    s_waitcnt lgkmcnt(6)
    v_mfma_f32_16x16x32_bf16 v[200:203], v[20:23], v[184:187], 0
    ds_read_b64_tr_b16 v[184:185], v19 offset:256
    ds_read_b64_tr_b16 v[186:187], v19 offset:2304
    s_waitcnt lgkmcnt(6)
    v_mfma_f32_16x16x32_bf16 v[204:207], v[20:23], v[172:175], 0
    s_waitcnt lgkmcnt(4)
    v_mfma_f32_16x16x32_bf16 v[208:211], v[20:23], v[176:179], 0
    s_waitcnt lgkmcnt(2)
    v_mfma_f32_16x16x32_bf16 v[212:215], v[20:23], v[180:183], 0
    s_waitcnt lgkmcnt(0)
    v_mfma_f32_16x16x32_bf16 v[216:219], v[20:23], v[184:187], 0
    s_waitcnt vmcnt(0)
    buffer_load_dword v255, v95, s[24:27], s50 offen
    ds_read_b128 v[120:123], v10 offset:4096
    ds_read_b128 v[124:127], v11 offset:6208
    ds_read_b128 v[132:135], v10 offset:6208
    ds_read_b128 v[128:131], v11 offset:4096
    s_waitcnt lgkmcnt(2)
    v_mov_b32 v136, v120
    v_lshlrev_b32 v140, 16, v121
    v_lshlrev_b32 v154, 16, v127
    v_and_b32 v141, 0xffff0000, v121
    v_and_b32 v155, 0xffff0000, v126
    v_pk_add_f32 v[140:141], v[140:141], v[154:155]
    v_mov_b32_dpp v136, v124 row_shr:1 row_mask:0xf bank_mask:0xf
    v_lshlrev_b32 v142, 16, v122
    v_lshlrev_b32 v154, 16, v126
    v_and_b32 v143, 0xffff0000, v122
    v_and_b32 v155, 0xffff0000, v125
    v_pk_add_f32 v[142:143], v[142:143], v[154:155]
    v_lshlrev_b32 v144, 16, v123
    v_lshlrev_b32 v154, 16, v125
    v_and_b32 v145, 0xffff0000, v123
    v_and_b32 v155, 0xffff0000, v124
    v_pk_add_f32 v[144:145], v[144:145], v[154:155]
    v_lshlrev_b32 v138, 16, v120
    v_lshlrev_b32 v154, 16, v136
    v_and_b32 v139, 0xffff0000, v120
    v_and_b32 v155, 0xffff0000, v127
    v_pk_add_f32 v[138:139], v[138:139], v[154:155]
    s_waitcnt lgkmcnt(0)
    v_lshlrev_b32 v148, 16, v133
    v_lshlrev_b32 v154, 16, v131
    v_and_b32 v149, 0xffff0000, v133
    v_and_b32 v155, 0xffff0000, v130
    v_pk_add_f32 v[148:149], v[148:149], v[154:155]
    v_mov_b32_dpp v137, v128 row_ror:1 row_mask:0xf bank_mask:0xf
    v_lshlrev_b32 v150, 16, v134
    v_lshlrev_b32 v154, 16, v130
    v_and_b32 v151, 0xffff0000, v134
    v_and_b32 v155, 0xffff0000, v129
    v_pk_add_f32 v[150:151], v[150:151], v[154:155]
    v_lshlrev_b32 v152, 16, v135
    v_lshlrev_b32 v154, 16, v129
    v_and_b32 v153, 0xffff0000, v135
    v_and_b32 v155, 0xffff0000, v128
    v_pk_add_f32 v[152:153], v[152:153], v[154:155]
    v_lshlrev_b32 v146, 16, v132
    v_lshlrev_b32 v154, 16, v137
    v_and_b32 v147, 0xffff0000, v132
    v_and_b32 v155, 0xffff0000, v131
    v_pk_add_f32 v[146:147], v[146:147], v[154:155]
    v_pk_add_f32 v[164:165], v[138:139], v[146:147]
    v_pk_add_f32 v[166:167], v[140:141], v[148:149]
    v_pk_add_f32 v[168:169], v[142:143], v[150:151]
    v_pk_add_f32 v[170:171], v[144:145], v[152:153]
    v_cvt_pk_bf16_f32 v156, v164, v166
    v_cvt_pk_bf16_f32 v157, v168, v170
    v_cvt_pk_bf16_f32 v158, v165, v167
    v_cvt_pk_bf16_f32 v159, v169, v171
    ds_write_b128 v13, v[156:159] offset:16384
    v_pk_add_f32 v[164:165], v[138:139], v[146:147] neg_lo:[0,1] neg_hi:[0,1]
    v_pk_add_f32 v[166:167], v[140:141], v[148:149] neg_lo:[0,1] neg_hi:[0,1]
    v_pk_add_f32 v[168:169], v[142:143], v[150:151] neg_lo:[0,1] neg_hi:[0,1]
    v_pk_add_f32 v[170:171], v[144:145], v[152:153] neg_lo:[0,1] neg_hi:[0,1]
    v_cvt_pk_bf16_f32 v160, v164, v166
    v_cvt_pk_bf16_f32 v161, v168, v170
    v_cvt_pk_bf16_f32 v162, v165, v167
    v_cvt_pk_bf16_f32 v163, v169, v171
    ds_write_b128 v14, v[160:163] offset:16384
    s_cmp_lg_u32 s3, 0
    s_cbranch_scc1 S_nw
    s_lshl_b32 s40, s8, 7
    s_add_u32 s40, s40, 32768
    buffer_load_dword v255, v12, s[36:39], s40 offen
S_nw:
    s_waitcnt lgkmcnt(0)
    s_barrier
    ds_read_b64_tr_b16 v[172:173], v16 offset:16384
    ds_read_b64_tr_b16 v[174:175], v16 offset:18432
    ds_read_b64_tr_b16 v[176:177], v17 offset:16384
    ds_read_b64_tr_b16 v[178:179], v17 offset:18432
    ds_read_b64_tr_b16 v[180:181], v18 offset:16384
    ds_read_b64_tr_b16 v[182:183], v18 offset:18432
    ds_read_b64_tr_b16 v[184:185], v19 offset:16384
    ds_read_b64_tr_b16 v[186:187], v19 offset:18432
    s_waitcnt lgkmcnt(6)
    v_mfma_f32_16x16x32_bf16 v[188:191], v[24:27], v[172:175], v[188:191]
    ds_read_b64_tr_b16 v[172:173], v16 offset:16640
    ds_read_b64_tr_b16 v[174:175], v16 offset:18688
    s_waitcnt lgkmcnt(6)
    v_mfma_f32_16x16x32_bf16 v[192:195], v[24:27], v[176:179], v[192:195]
    ds_read_b64_tr_b16 v[176:177], v17 offset:16640
    ds_read_b64_tr_b16 v[178:179], v17 offset:18688
    s_waitcnt lgkmcnt(6)
    v_mfma_f32_16x16x32_bf16 v[196:199], v[24:27], v[180:183], v[196:199]
    ds_read_b64_tr_b16 v[180:181], v18 offset:16640
    ds_read_b64_tr_b16 v[182:183], v18 offset:18688
    s_waitcnt lgkmcnt(6)
    v_mfma_f32_16x16x32_bf16 v[200:203], v[24:27], v[184:187], v[200:203]
    ds_read_b64_tr_b16 v[184:185], v19 offset:16640
    ds_read_b64_tr_b16 v[186:187], v19 offset:18688
    s_waitcnt lgkmcnt(6)
    v_mfma_f32_16x16x32_bf16 v[204:207], v[24:27], v[172:175], v[204:207]
    s_waitcnt lgkmcnt(4)
    v_mfma_f32_16x16x32_bf16 v[208:211], v[24:27], v[176:179], v[208:211]
    s_waitcnt lgkmcnt(2)
    v_mfma_f32_16x16x32_bf16 v[212:215], v[24:27], v[180:183], v[212:215]
    s_waitcnt lgkmcnt(0)
    v_mfma_f32_16x16x32_bf16 v[216:219], v[24:27], v[184:187], v[216:219]
    v_cvt_pk_bf16_f32 v120, v188, v192
    v_cvt_pk_bf16_f32 v121, v196, v200
    s_nop 1
    v_cvt_pk_bf16_f32 v122, v204, v208
    s_nop 2
    v_cvt_pk_bf16_f32 v123, v212, v216
    v_bfi_b32 v123, v87, v86, v123
    s_add_u32 s41, s59, 0
    buffer_store_dwordx4 v[120:123], v15, s[36:39], s41 offen sc1
    v_cvt_pk_bf16_f32 v124, v189, v193
    v_cvt_pk_bf16_f32 v125, v197, v201
    v_cvt_pk_bf16_f32 v126, v205, v209
    v_cvt_pk_bf16_f32 v127, v213, v217
    v_bfi_b32 v127, v87, v86, v127
    s_add_u32 s41, s59, 32768
    buffer_store_dwordx4 v[124:127], v15, s[36:39], s41 offen sc1
    v_cvt_pk_bf16_f32 v128, v190, v194
    v_cvt_pk_bf16_f32 v129, v198, v202
    v_cvt_pk_bf16_f32 v130, v206, v210
    v_cvt_pk_bf16_f32 v131, v214, v218
    v_bfi_b32 v131, v87, v86, v131
    s_add_u32 s41, s59, 65536
    buffer_store_dwordx4 v[128:131], v15, s[36:39], s41 offen sc1
    v_cvt_pk_bf16_f32 v132, v191, v195
    v_cvt_pk_bf16_f32 v133, v199, v203
    v_cvt_pk_bf16_f32 v134, v207, v211
    v_cvt_pk_bf16_f32 v135, v215, v219
    v_bfi_b32 v135, v87, v86, v135
    s_add_u32 s41, s59, 98304
    buffer_store_dwordx4 v[132:135], v15, s[36:39], s41 offen sc1
    s_cmp_lg_u32 s3, 0
    s_cbranch_scc1 S_nh
    s_lshl_b32 s40, s8, 7
    s_add_u32 s40, s40, 32768
    s_mov_b64 exec, 1
    buffer_store_dwordx2 v[92:93], v12, s[36:39], s40 offen sc1
    s_mov_b64 exec, -1
S_nh:
    s_barrier
    s_cmp_lg_u32 s3, 0
    s_cbranch_scc1 S_nf
    v_lshlrev_b32 v94, 2, v3
    v_add_u32 v94, 81920, v94
    ds_write_b32 v94, v12
S_nf:
    s_lshl_b32 s40, s7, 3
    s_add_u32 s40, s40, s3
    s_mul_i32 s40, s40, 28
    v_min_u32 v24, 27, v1
    v_add_u32 v24, s40, v24
    v_and_b32 v25, 0xffffff80, v24
    v_lshrrev_b32 v26, 1, v25
    v_sub_u32 v24, v24, v26
    v_add_u32 v26, -128, v24
    v_add_u32 v24, 320, v24
    v_min_u32 v24, v24, v26
    v_mul_u32_u24 v24, 896, v24
    v_add_u32 v24, v24, v25
    buffer_load_dword v255, v24, s[24:27], 0 offen
    v_fma_f32 v112, v118, v111, -v110
    v_fma_f32 v113, v118, v112, -v111
    v_fma_f32 v114, v118, v113, -v112
    v_fma_f32 v115, v118, v114, -v113
    v_fma_f32 v116, v118, v115, -v114
    v_fma_f32 v117, v118, v116, -v115
    v_mul_f32 v102, v102, v98
    v_mul_f32 v114, v114, v99
    v_cvt_pk_bf16_f32 v76, v102, v106
    v_cvt_pk_bf16_f32 v77, v110, v114
    v_cvt_pk_bf16_f32 v78, v103, v107
    v_cvt_pk_bf16_f32 v79, v111, v115
    v_and_b32 v79, v101, v79
    ds_write_b128 v5, v[76:79] offset:0
    v_cvt_pk_bf16_f32 v80, v104, v108
    v_cvt_pk_bf16_f32 v81, v112, v116
    v_cvt_pk_bf16_f32 v82, v105, v109
    v_cvt_pk_bf16_f32 v83, v113, v117
    v_and_b32 v81, v101, v81
    v_and_b32 v83, v101, v83
    ds_write_b128 v5, v[80:83] offset:1024
    v_fmamk_f32 v102, v96, 0x0, v97
    v_fmamk_f32 v103, v96, 0x40800000, v97
    v_sin_f32 v102, v102
    v_sin_f32 v103, v103
    s_nop 0
    v_fma_f32 v104, v118, v103, -v102
    v_fma_f32 v105, v118, v104, -v103
    v_fma_f32 v106, v118, v105, -v104
    v_fma_f32 v107, v118, v106, -v105
    v_fma_f32 v108, v118, v107, -v106
    v_fma_f32 v109, v118, v108, -v107
    v_fma_f32 v110, v118, v109, -v108
    v_fma_f32 v111, v118, v110, -v109
    v_fma_f32 v112, v118, v111, -v110
    v_fma_f32 v113, v118, v112, -v111
    v_fma_f32 v114, v118, v113, -v112
    v_fma_f32 v115, v118, v114, -v113
    v_fma_f32 v116, v118, v115, -v114
    v_fma_f32 v117, v118, v116, -v115
    v_mul_f32 v114, v114, v100
    v_cvt_pk_bf16_f32 v76, v102, v106
    v_cvt_pk_bf16_f32 v77, v110, v114
    v_cvt_pk_bf16_f32 v78, v103, v107
    v_cvt_pk_bf16_f32 v79, v111, v115
    v_and_b32 v79, v101, v79
    ds_write_b128 v5, v[76:79] offset:4096
    v_cvt_pk_bf16_f32 v80, v104, v108
    v_cvt_pk_bf16_f32 v81, v112, v116
    v_cvt_pk_bf16_f32 v82, v105, v109
    v_cvt_pk_bf16_f32 v83, v113, v117
    v_and_b32 v81, v101, v81
    v_and_b32 v83, v101, v83
    ds_write_b128 v5, v[80:83] offset:5120
    v_fmamk_f32 v102, v96, 0x3f800000, v97
    v_fmamk_f32 v103, v96, 0x40a00000, v97
    v_cos_f32 v102, v102
    v_cos_f32 v103, v103
    s_nop 0
    v_fma_f32 v104, v118, v103, -v102
    v_fma_f32 v105, v118, v104, -v103
    v_fma_f32 v106, v118, v105, -v104
    v_fma_f32 v107, v118, v106, -v105
    v_fma_f32 v108, v118, v107, -v106
    v_fma_f32 v109, v118, v108, -v107
    v_fma_f32 v110, v118, v109, -v108
    v_fma_f32 v111, v118, v110, -v109
    v_fma_f32 v112, v118, v111, -v110
    v_fma_f32 v113, v118, v112, -v111
    v_fma_f32 v114, v118, v113, -v112
    v_fma_f32 v115, v118, v114, -v113
    v_fma_f32 v116, v118, v115, -v114
    v_fma_f32 v117, v118, v116, -v115
    v_cvt_pk_bf16_f32 v76, v102, v106
    v_cvt_pk_bf16_f32 v77, v110, v114
    v_cvt_pk_bf16_f32 v78, v103, v107
    v_cvt_pk_bf16_f32 v79, v111, v115
    v_and_b32 v77, v101, v77
    v_and_b32 v79, v101, v79
    ds_write_b128 v5, v[76:79] offset:2048
    v_cvt_pk_bf16_f32 v80, v104, v108
    v_cvt_pk_bf16_f32 v81, v112, v116
    v_cvt_pk_bf16_f32 v82, v105, v109
    v_cvt_pk_bf16_f32 v83, v113, v117
    v_and_b32 v81, v101, v81
    v_and_b32 v83, v101, v83
    ds_write_b128 v5, v[80:83] offset:3072
    v_fmamk_f32 v102, v96, 0x3f800000, v97
    v_fmamk_f32 v103, v96, 0x40a00000, v97
    v_sin_f32 v102, v102
    v_sin_f32 v103, v103
    s_nop 0
    v_fma_f32 v104, v118, v103, -v102
    v_fma_f32 v105, v118, v104, -v103
    v_fma_f32 v106, v118, v105, -v104
    v_and_b32 v94, 31, v1
    v_lshlrev_b32 v94, 7, v94
    s_mov_b32 s50, 32768
    s_cmp_lg_u32 s3, 1
    s_cbranch_scc1 S_p0
    buffer_load_dword v20, v94, s[36:39], s50 offen sc1
S_p0:
    v_fma_f32 v107, v118, v106, -v105
    v_fma_f32 v108, v118, v107, -v106
    v_fma_f32 v109, v118, v108, -v107
    v_fma_f32 v110, v118, v109, -v108
    v_fma_f32 v111, v118, v110, -v109
    v_fma_f32 v112, v118, v111, -v110
    v_fma_f32 v113, v118, v112, -v111
    v_fma_f32 v114, v118, v113, -v112
    v_fma_f32 v115, v118, v114, -v113
    v_fma_f32 v116, v118, v115, -v114
    v_fma_f32 v117, v118, v116, -v115
    v_cvt_pk_bf16_f32 v76, v102, v106
    v_cvt_pk_bf16_f32 v77, v110, v114
    v_cvt_pk_bf16_f32 v78, v103, v107
    v_cvt_pk_bf16_f32 v79, v111, v115
    v_and_b32 v77, v101, v77
    v_and_b32 v79, v101, v79
    ds_write_b128 v5, v[76:79] offset:6144
    v_cvt_pk_bf16_f32 v80, v104, v108
    v_cvt_pk_bf16_f32 v81, v112, v116
    v_cvt_pk_bf16_f32 v82, v105, v109
    v_cvt_pk_bf16_f32 v83, v113, v117
    v_and_b32 v81, v101, v81
    v_and_b32 v83, v101, v83
    ds_write_b128 v5, v[80:83] offset:7168
    v_bfe_u32 v88, v60, 4, 2
    v_mov_b32 v5, 0xffff0000
    v_add_u32 v4, s3, v88
    v_cmp_eq_u32 s[42:43], 0, v4
    s_nop 1
    v_cndmask_b32 v90, v5, 0, s[42:43]
    s_and_b32 s61, s3, 1
    s_lshl_b32 s61, s61, 2
    v_add_lshl_u32 v88, v88, s61, 16
    v_lshrrev_b32 v4, 2, v3
    v_lshl_add_u32 v4, v2, 3, v4
    v_lshlrev_b32 v4, 6, v4
    v_and_b32 v5, 3, v1
    v_lshl_add_u32 v4, v5, 3, v4
    v_and_b32 v5, 16, v1
    v_lshl_add_u32 v4, v5, 1, v4
    s_lshl_b32 s61, s3, 12
    s_cmp_lg_u32 s3, 1
    s_cbranch_scc1 P_dB
    s_mov_b32 s9, 0
P_lB:
    buffer_load_dword v21, v94, s[36:39], s50 offen sc1
    s_waitcnt vmcnt(1)
    v_cmp_ne_u32 vcc, s12, v20
    s_nop 0
    s_cbranch_vccz P_dB
    buffer_load_dword v20, v94, s[36:39], s50 offen sc1
    s_waitcnt vmcnt(1)
    v_cmp_ne_u32 vcc, s12, v21
    s_nop 0
    s_cbranch_vccz P_dB
    s_add_u32 s9, s9, 1
    s_cmp_lt_u32 s9, 200000
    s_cbranch_scc1 P_lB
P_dB:
    s_lshl_b32 s40, s3, 12
    s_add_u32 m0, s40, 0
    s_waitcnt lgkmcnt(0)
    s_barrier
    buffer_load_dwordx4 v60, s[36:39], s60 offen offset:0 sc1 lds
    buffer_load_dwordx4 v60, s[36:39], s60 offen offset:1024 sc1 lds
    buffer_load_dwordx4 v60, s[36:39], s60 offen offset:2048 sc1 lds
    buffer_load_dwordx4 v60, s[36:39], s60 offen offset:3072 sc1 lds
    ds_read_b128 v[120:123], v67 offset:0
    ds_read_b128 v[124:127], v67 offset:1024
    ds_read_b128 v[128:131], v67 offset:2048
    ds_read_b128 v[132:135], v67 offset:3072
    ds_read_b128 v[136:139], v67 offset:4096
    ds_read_b128 v[140:143], v67 offset:5120
    ds_read_b128 v[144:147], v67 offset:6144
    ds_read_b128 v[148:151], v67 offset:7168
    ds_read_b128 v[152:155], v67 offset:8192
    ds_read_b128 v[156:159], v67 offset:9216
    ds_read_b128 v[160:163], v67 offset:10240
    ds_read_b128 v[164:167], v67 offset:11264
    ds_read_b128 v[168:171], v67 offset:12288
    ds_read_b128 v[172:175], v67 offset:13312
    ds_read_b128 v[176:179], v67 offset:14336
    ds_read_b128 v[180:183], v67 offset:15360
    v_add_u32 v62, s61, v4
    v_xor_b32 v61, 32, v62
    v_add_u32 v89, s61, v63
    s_lshr_b32 s61, s3, 1
    s_lshl_b32 s61, s61, 13
    s_and_b32 s62, s3, 1
    s_lshl_b32 s62, s62, 10
    s_add_u32 s61, s61, s62
    v_add_u32 v91, s61, v63
    v_mov_b32 v68, 81920
    v_lshl_add_u32 v68, s56, 2, v68
    v_mov_b32 v75, 1
    s_lshl_b32 s61, s56, 11
    v_add_u32 v69, s61, v63
    s_lshl_b32 s61, s56, 4
    v_add_u32 v4, s61, v3
    v_mul_u32_u24 v4, 528, v4
    v_add_u32 v4, 98304, v4
    v_lshl_add_u32 v5, s55, 2, v2
    v_lshl_add_u32 v64, v5, 4, v4
    s_and_b32 s61, s3, 1
    s_lshl_b32 s61, s61, 3
    v_lshrrev_b32 v4, 3, v1
    v_add_u32 v4, s61, v4
    v_and_b32 v5, 7, v1
    v_lshlrev_b32 v5, 4, v5
    s_and_b32 s61, s3, 2
    s_add_u32 s61, s61, s56
    s_mul_i32 s61, s61, 8448
    s_add_u32 s61, s61, 98304
    v_mul_u32_u24 v96, 528, v4
    v_add3_u32 v65, v96, v5, s61
    v_add_u32 v97, s61, v96
    s_bitcmp1_b32 s3, 1
    s_cselect_b32 s62, -1, 1
    s_mul_i32 s62, s62, 16896
    v_add_u32 v71, s62, v97
    s_cmp_eq_u32 s56, 0
    s_cselect_b32 s61, s8, s63
    v_lshl_add_u32 v66, v4, 6, s61
    v_sub_u32 v96, 2048, v66
    v_mov_b32 v4, 1024
    v_cmp_eq_u32 s[42:43], 0, v66
    s_nop 1
    v_cndmask_b32 v96, v96, v4, s[42:43]
    v_cndmask_b32 v71, v71, v97, s[42:43]
    s_bitcmp1_b32 s3, 1
    s_cselect_b64 s[42:43], -1, 0
    v_cndmask_b32 v66, v66, v96, s[42:43]
    v_mov_b32 v96, 1792
    v_mad_u32_u24 v66, v66, v96, v5
    v_sub_u32 v71, v71, v5
    v_and_b32 v4, 4, v1
    v_lshl_add_u32 v70, v4, 5, v65
    v_lshl_add_u32 v73, v4, 5, v66
    v_lshlrev_b32 v4, 4, v4
    v_sub_u32 v72, v71, v4
    v_mov_b32 v74, 0xffff
    v_xor_b32 v88, s51, v88
    s_mov_b32 s9, 0
    s_waitcnt lgkmcnt(0)
S_gc:
    s_waitcnt vmcnt(2)
    ds_read_b64_tr_b16 v[184:185], v62 offset:0
    ds_read_b64_tr_b16 v[186:187], v62 offset:256
    ds_read_b64_tr_b16 v[192:193], v61 offset:0
    ds_read_b64_tr_b16 v[194:195], v61 offset:256
    ds_read_b32 v102, v89 offset:12
    ds_read_b32 v103, v89 offset:1036
    s_waitcnt lgkmcnt(4)
    v_mfma_f32_16x16x32_bf16 v[200:203], v[184:187], v[28:31], 0
    v_mfma_f32_16x16x32_bf16 v[208:211], v[184:187], v[36:39], 0
    v_mfma_f32_16x16x32_bf16 v[216:219], v[184:187], v[44:47], 0
    v_mfma_f32_16x16x32_bf16 v[224:227], v[184:187], v[52:55], 0
    s_waitcnt vmcnt(0)
    ds_read_b64_tr_b16 v[188:189], v62 offset:2048
    ds_read_b64_tr_b16 v[190:191], v62 offset:2304
    ds_read_b64_tr_b16 v[196:197], v61 offset:2048
    ds_read_b64_tr_b16 v[198:199], v61 offset:2304
    ds_read_b32 v104, v89 offset:2060
    ds_read_b32 v105, v89 offset:3084
    s_waitcnt lgkmcnt(8)
    v_mfma_f32_16x16x32_bf16 v[204:207], v[192:195], v[28:31], 0
    v_mfma_f32_16x16x32_bf16 v[212:215], v[192:195], v[36:39], 0
    v_mfma_f32_16x16x32_bf16 v[220:223], v[192:195], v[44:47], 0
    v_mfma_f32_16x16x32_bf16 v[228:231], v[192:195], v[52:55], 0
    s_waitcnt lgkmcnt(4)
    v_mfma_f32_16x16x32_bf16 v[200:203], v[188:191], v[32:35], v[200:203]
    s_waitcnt lgkmcnt(2)
    v_mfma_f32_16x16x32_bf16 v[204:207], v[196:199], v[32:35], v[204:207]
    s_waitcnt lgkmcnt(0)
    v_xor_b32 v102, v88, v102
    v_xor_b32 v103, v88, v103
    v_xor_b32 v104, v88, v104
    v_mfma_f32_16x16x32_bf16 v[208:211], v[188:191], v[40:43], v[208:211]
    v_xor_b32 v105, v88, v105
    v_or_b32 v102, v102, v103
    v_or3_b32 v102, v102, v104, v105
    v_mfma_f32_16x16x32_bf16 v[212:215], v[196:199], v[40:43], v[212:215]
    v_and_b32 v102, v90, v102
    v_cmp_ne_u32 vcc, 0, v102
    v_mfma_f32_16x16x32_bf16 v[216:219], v[188:191], v[48:51], v[216:219]
    v_mfma_f32_16x16x32_bf16 v[220:223], v[196:199], v[48:51], v[220:223]
    v_cvt_pk_bf16_f32 v232, v200, v201
    v_cvt_pk_bf16_f32 v233, v202, v203
    v_cvt_pk_bf16_f32 v234, v204, v205
    v_cvt_pk_bf16_f32 v235, v206, v207
    ds_write_b128 v91, v[232:235] offset:32768
    v_mfma_f32_16x16x32_bf16 v[224:227], v[188:191], v[56:59], v[224:227]
    v_mfma_f32_16x16x32_bf16 v[228:231], v[196:199], v[56:59], v[228:231]
    v_cvt_pk_bf16_f32 v236, v208, v209
    v_cvt_pk_bf16_f32 v237, v210, v211
    v_cvt_pk_bf16_f32 v238, v212, v213
    v_cvt_pk_bf16_f32 v239, v214, v215
    ds_write_b128 v91, v[236:239] offset:36864
    s_cbranch_vccnz S_gr
S_gk:
    v_cvt_pk_bf16_f32 v240, v216, v217
    v_cvt_pk_bf16_f32 v241, v218, v219
    v_cvt_pk_bf16_f32 v242, v220, v221
    v_cvt_pk_bf16_f32 v243, v222, v223
    ds_write_b128 v91, v[240:243] offset:34816
    v_cvt_pk_bf16_f32 v244, v224, v225
    v_cvt_pk_bf16_f32 v245, v226, v227
    v_cvt_pk_bf16_f32 v246, v228, v229
    v_cvt_pk_bf16_f32 v247, v230, v231
    ds_write_b128 v91, v[244:247] offset:38912
    s_waitcnt lgkmcnt(0)
    s_barrier
    s_cmp_lg_u32 s56, 0
    s_cbranch_scc1 S_np
    s_setprio 1
S_np:
    ds_read_b128 v[184:187], v69 offset:32768
    ds_read_b128 v[188:191], v69 offset:33792
    ds_read_b128 v[192:195], v69 offset:40960
    ds_read_b128 v[196:199], v69 offset:41984
    ds_read_b128 v[200:203], v69 offset:49152
    ds_read_b128 v[204:207], v69 offset:50176
    ds_read_b128 v[208:211], v69 offset:57344
    s_waitcnt lgkmcnt(6)
    v_mfma_f32_16x16x32_bf16 v[216:219], v[120:123], v[184:187], 0
    ds_read_b128 v[212:215], v69 offset:58368
    s_waitcnt lgkmcnt(6)
    v_mfma_f32_16x16x32_bf16 v[216:219], v[124:127], v[188:191], v[216:219]
    ds_read_b128 v[184:187], v69 offset:53248
    s_waitcnt lgkmcnt(6)
    v_mfma_f32_16x16x32_bf16 v[220:223], v[128:131], v[192:195], 0
    ds_read_b128 v[188:191], v69 offset:54272
    s_waitcnt lgkmcnt(6)
    v_mfma_f32_16x16x32_bf16 v[220:223], v[132:135], v[196:199], v[220:223]
    ds_read_b128 v[192:195], v69 offset:61440
    s_waitcnt lgkmcnt(6)
    v_mfma_f32_16x16x32_bf16 v[232:235], v[152:155], v[200:203], 0
    ds_read_b128 v[196:199], v69 offset:62464
    s_waitcnt lgkmcnt(6)
    v_mfma_f32_16x16x32_bf16 v[232:235], v[156:159], v[204:207], v[232:235]
    ds_read_b128 v[200:203], v69 offset:36864
    s_waitcnt lgkmcnt(6)
    v_mfma_f32_16x16x32_bf16 v[236:239], v[160:163], v[208:211], 0
    ds_read_b128 v[204:207], v69 offset:37888
    s_waitcnt lgkmcnt(6)
    v_mfma_f32_16x16x32_bf16 v[236:239], v[164:167], v[212:215], v[236:239]
    ds_read_b128 v[208:211], v69 offset:45056
    s_waitcnt lgkmcnt(6)
    v_mfma_f32_16x16x32_bf16 v[224:227], v[136:139], v[184:187], 0
    ds_read_b128 v[212:215], v69 offset:46080
    s_waitcnt lgkmcnt(6)
    v_mfma_f32_16x16x32_bf16 v[224:227], v[140:143], v[188:191], v[224:227]
    s_waitcnt lgkmcnt(5)
    v_mfma_f32_16x16x32_bf16 v[228:231], v[144:147], v[192:195], 0
    v_pk_add_f32 v[102:103], v[216:217], v[220:221]
    v_pk_add_f32 v[104:105], v[218:219], v[222:223]
    s_waitcnt lgkmcnt(4)
    v_mfma_f32_16x16x32_bf16 v[228:231], v[148:151], v[196:199], v[228:231]
    v_pk_add_f32 v[220:221], v[216:217], v[220:221] neg_lo:[0,1] neg_hi:[0,1]
    v_pk_add_f32 v[222:223], v[218:219], v[222:223] neg_lo:[0,1] neg_hi:[0,1]
    s_waitcnt lgkmcnt(3)
    v_mfma_f32_16x16x32_bf16 v[240:243], v[168:171], v[200:203], 0
    v_pk_add_f32 v[106:107], v[232:233], v[236:237]
    s_waitcnt lgkmcnt(2)
    v_mfma_f32_16x16x32_bf16 v[240:243], v[172:175], v[204:207], v[240:243]
    v_pk_add_f32 v[108:109], v[234:235], v[238:239]
    s_waitcnt lgkmcnt(1)
    v_mfma_f32_16x16x32_bf16 v[244:247], v[176:179], v[208:211], 0
    v_pk_add_f32 v[236:237], v[232:233], v[236:237] neg_lo:[0,1] neg_hi:[0,1]
    s_waitcnt lgkmcnt(0)
    v_mfma_f32_16x16x32_bf16 v[244:247], v[180:183], v[212:215], v[244:247]
    v_pk_add_f32 v[238:239], v[234:235], v[238:239] neg_lo:[0,1] neg_hi:[0,1]
    s_add_u32 s40, s8, s56
    s_cmp_eq_u32 s40, 0
    s_cbranch_scc1 S_y0
S_y1:
    v_pk_add_f32 v[216:217], v[224:225], v[228:229]
    v_pk_add_f32 v[218:219], v[226:227], v[230:231]
    v_pk_add_f32 v[228:229], v[224:225], v[228:229] neg_lo:[0,1] neg_hi:[0,1]
    v_pk_add_f32 v[230:231], v[226:227], v[230:231] neg_lo:[0,1] neg_hi:[0,1]
    v_pk_add_f32 v[232:233], v[240:241], v[244:245]
    v_pk_add_f32 v[234:235], v[242:243], v[246:247]
    v_pk_add_f32 v[244:245], v[240:241], v[244:245] neg_lo:[0,1] neg_hi:[0,1]
    v_pk_add_f32 v[246:247], v[242:243], v[246:247] neg_lo:[0,1] neg_hi:[0,1]
    v_pk_add_f32 v[224:225], v[102:103], v[216:217]
    v_pk_add_f32 v[226:227], v[104:105], v[218:219]
    v_pk_add_f32 v[240:241], v[106:107], v[232:233]
    v_pk_add_f32 v[242:243], v[108:109], v[234:235]
    v_cvt_pk_bf16_f32 v184, v224, v240
    v_cvt_pk_bf16_f32 v185, v225, v241
    v_cvt_pk_bf16_f32 v186, v226, v242
    v_cvt_pk_bf16_f32 v187, v227, v243
    ds_write_b128 v64, v[184:187] offset:0
    v_pk_add_f32 v[224:225], v[102:103], v[216:217] neg_lo:[0,1] neg_hi:[0,1]
    v_pk_add_f32 v[226:227], v[104:105], v[218:219] neg_lo:[0,1] neg_hi:[0,1]
    v_pk_add_f32 v[240:241], v[106:107], v[232:233] neg_lo:[0,1] neg_hi:[0,1]
    v_pk_add_f32 v[242:243], v[108:109], v[234:235] neg_lo:[0,1] neg_hi:[0,1]
    v_cvt_pk_bf16_f32 v188, v224, v240
    v_cvt_pk_bf16_f32 v189, v225, v241
    v_cvt_pk_bf16_f32 v190, v226, v242
    v_cvt_pk_bf16_f32 v191, v227, v243
    ds_write_b128 v64, v[188:191] offset:16896
    v_pk_add_f32 v[224:225], v[220:221], v[228:229]
    v_pk_add_f32 v[226:227], v[222:223], v[230:231]
    v_pk_add_f32 v[240:241], v[236:237], v[244:245]
    v_pk_add_f32 v[242:243], v[238:239], v[246:247]
    v_cvt_pk_bf16_f32 v192, v224, v240
    v_cvt_pk_bf16_f32 v193, v225, v241
    v_cvt_pk_bf16_f32 v194, v226, v242
    v_cvt_pk_bf16_f32 v195, v227, v243
    ds_write_b128 v64, v[192:195] offset:256
    v_pk_add_f32 v[224:225], v[220:221], v[228:229] neg_lo:[0,1] neg_hi:[0,1]
    v_pk_add_f32 v[226:227], v[222:223], v[230:231] neg_lo:[0,1] neg_hi:[0,1]
    v_pk_add_f32 v[240:241], v[236:237], v[244:245] neg_lo:[0,1] neg_hi:[0,1]
    v_pk_add_f32 v[242:243], v[238:239], v[246:247] neg_lo:[0,1] neg_hi:[0,1]
    v_cvt_pk_bf16_f32 v196, v224, v240
    v_cvt_pk_bf16_f32 v197, v225, v241
    v_cvt_pk_bf16_f32 v198, v226, v242
    v_cvt_pk_bf16_f32 v199, v227, v243
    ds_write_b128 v64, v[196:199] offset:17152
    s_mov_b64 exec, 1
    ds_add_u32 v68, v75
    s_mov_b64 exec, -1
    s_mov_b32 s9, 0
W_lO:
    ds_read_b32 v4, v68 offset:0
    s_add_u32 s9, s9, 1
    s_cmp_gt_u32 s9, 1600000
    s_cbranch_scc1 W_dO
    s_waitcnt lgkmcnt(0)
    v_cmp_gt_u32 vcc, 4, v4
    s_nop 0
    s_cbranch_vccnz W_lO
W_dO:
    v_and_b32 v4, 4, v1
    v_lshl_add_u32 v5, v4, 6, v66
    ds_read_b128 v[120:123], v65 offset:0
    ds_read_b128 v[124:127], v65 offset:128
    ds_read_b128 v[128:131], v65 offset:320
    ds_read_b128 v[132:135], v70 offset:256
    ds_read_b128 v[136:139], v71 offset:432
    ds_read_b32 v140, v71 offset:448
    ds_read_b128 v[144:147], v71 offset:112
    ds_read_b32 v148, v71 offset:128
    ds_read_b128 v[152:155], v72 offset:304
    ds_read_b32 v156, v72 offset:320
    s_waitcnt lgkmcnt(9)
    buffer_store_dwordx4 v[120:123], v66, s[32:35], 0 offen offset:896 nt
    s_waitcnt lgkmcnt(8)
    buffer_store_dwordx4 v[124:127], v66, s[32:35], 0 offen offset:1024 nt
    s_waitcnt lgkmcnt(7)
    buffer_store_dwordx4 v[128:131], v66, s[32:35], 0 offen offset:1408 nt
    s_waitcnt lgkmcnt(6)
    buffer_store_dwordx4 v[132:135], v73, s[32:35], 0 offen offset:1344 nt
    s_waitcnt lgkmcnt(4)
    v_bfi_b32 v160, v74, v140, v139
    v_bfi_b32 v161, v74, v139, v138
    v_bfi_b32 v162, v74, v138, v137
    v_bfi_b32 v163, v74, v137, v136
    buffer_store_dwordx4 v[160:163], v66, s[32:35], 0 offen offset:1152 nt
    s_waitcnt lgkmcnt(2)
    v_bfi_b32 v164, v74, v148, v147
    v_bfi_b32 v165, v74, v147, v146
    v_bfi_b32 v166, v74, v146, v145
    v_bfi_b32 v167, v74, v145, v144
    buffer_store_dwordx4 v[164:167], v66, s[32:35], 0 offen offset:1664 nt
    s_waitcnt lgkmcnt(0)
    v_bfi_b32 v168, v74, v156, v155
    v_bfi_b32 v169, v74, v155, v154
    v_bfi_b32 v170, v74, v154, v153
    v_bfi_b32 v171, v74, v153, v152
    buffer_store_dwordx4 v[168:171], v5, s[32:35], 0 offen offset:1280 nt
    s_add_u32 s40, s8, s3
    s_cmp_lg_u32 s40, 0
    s_cbranch_scc1 S_end
    s_add_u32 s40, s10, 16
    v_mov_b32 v4, s40
    s_mov_b32 s40, 4096
    s_mov_b64 exec, 1
    buffer_store_dword v4, v12, s[36:39], s40 offen
S_end:
    s_endpgm
    s_endpgm
    s_endpgm
    s_endpgm
    s_endpgm
    s_endpgm
    s_endpgm
    s_endpgm
    s_endpgm
    s_endpgm
    s_endpgm
    s_endpgm
    s_endpgm
    s_endpgm
    s_endpgm
    s_endpgm
    s_endpgm
    s_endpgm
    s_endpgm
    s_endpgm
    s_endpgm
    s_endpgm
    s_endpgm
    s_endpgm
    s_endpgm
    s_endpgm
    s_endpgm
    s_endpgm
    s_endpgm
    s_endpgm
    s_endpgm
    s_endpgm
    s_endpgm
    s_endpgm
    s_endpgm
    s_endpgm
    s_endpgm
    s_endpgm
    s_endpgm
    s_endpgm
    s_endpgm
    s_endpgm
    s_endpgm
    s_endpgm
    s_endpgm
    s_endpgm
    s_endpgm
    s_endpgm
    s_endpgm
    s_endpgm
    s_endpgm
    s_endpgm
    s_endpgm
    s_endpgm
    s_endpgm
    s_endpgm
    s_endpgm
    s_endpgm
    s_endpgm
    s_endpgm
    s_endpgm
    s_endpgm
    s_endpgm
    s_endpgm
    s_endpgm
    s_endpgm
    s_endpgm
    s_endpgm
    s_endpgm
    s_endpgm
    s_endpgm
    s_endpgm
    s_endpgm
    s_endpgm
    s_endpgm
    s_endpgm
    s_endpgm
    s_endpgm
    s_endpgm
    s_endpgm
    s_endpgm
    s_endpgm
    s_endpgm
    s_endpgm
    s_endpgm
    s_endpgm
    s_endpgm
    s_endpgm
    s_endpgm
    s_endpgm
    s_endpgm
    s_endpgm
    s_endpgm
    s_endpgm
    s_endpgm
    s_endpgm
    s_endpgm
    s_endpgm
    s_endpgm
    s_endpgm
    s_endpgm
    s_endpgm
    s_endpgm
    s_endpgm
    s_endpgm
    s_endpgm
    s_endpgm
    s_endpgm
    s_endpgm
    s_endpgm
    s_endpgm
    s_endpgm
    s_endpgm
    s_endpgm
    s_endpgm
    s_endpgm
    s_endpgm
    s_endpgm
    s_endpgm
    s_endpgm
    s_endpgm
    s_endpgm
    s_endpgm
    s_endpgm
    s_endpgm
    s_endpgm
    s_endpgm
    s_endpgm
    s_endpgm
K_c:
    s_lshl_b32 s40, s8, 7
    s_waitcnt lgkmcnt(0)
    s_load_dwordx2 s[10:11], s[36:37], s40
    s_lshl_b32 s14, s8, 10
    s_add_u32 s14, s14, 65536
    s_getreg_b32 s52, hwreg(HW_REG_XCC_ID, 0, 3)
    s_mov_b32 s26, 401408
    s_mov_b32 s27, 0x00020000
    s_mov_b32 s34, 3670016
    s_mov_b32 s35, 0x00020000
    s_sub_u32 s62, s3, 4
    s_lshr_b32 s16, s62, 1
    s_and_b32 s17, s62, 1
    s_lshl_b32 s29, s62, 11
    v_and_b32 v1, 63, v0
    v_lshlrev_b32 v4, 4, v1
    s_lshl_b32 s1, s5, 3
    s_add_u32 s1, s1, s4
    s_mul_i32 s1, s1, 1792
    v_min_u32 v46, 13, v1
    v_lshlrev_b32 v46, 7, v46
    v_lshrrev_b32 v29, 4, v1
    v_and_b32 v30, 15, v1
    v_lshrrev_b32 v31, 3, v1
    v_and_b32 v32, 7, v1
    v_mov_b32 v5, 161792
    v_mov_b32 v6, 0
    v_lshl_add_u32 v2, v1, 2, v5
    ds_write_b32 v2, v6
    v_lshrrev_b32 v3, 1, v30
    v_xor_b32 v3, v3, v29
    v_lshlrev_b32 v3, 4, v3
    v_lshl_add_u32 v3, v30, 7, v3
    s_lshr_b32 s18, s62, 1
    s_lshl_b32 s18, s18, 12
    v_add_u32 v33, s18, v3
    v_xor_b32 v34, 64, v33
    v_add_u32 v35, 40960, v33
    v_add_u32 v36, 40960, v34
    v_lshrrev_b32 v3, 2, v30
    v_lshl_add_u32 v3, v29, 3, v3
    v_lshlrev_b32 v3, 7, v3
    v_and_b32 v7, 3, v1
    v_lshl_add_u32 v3, v7, 3, v3
    v_bfe_u32 v7, v1, 3, 2
    s_and_b32 s18, s62, 1
    s_lshl_b32 s18, s18, 1
    v_xor_b32 v7, s18, v7
    v_lshl_add_u32 v3, v7, 5, v3
    v_add_u32 v37, 71680, v3
    v_xor_b32 v38, 32, v37
    v_add_u32 v39, 49152, v37
    v_add_u32 v40, 49152, v38
    s_and_b32 s18, s62, 1
    s_lshl_b32 s19, s7, 1
    s_add_u32 s18, s18, s19
    s_cmp_ge_u32 s18, 7
    s_cselect_b32 s19, 14, 7
    s_sub_u32 s18, s19, s18
    v_cmp_gt_u32 s[54:55], s18, v29
    v_add_u32 v2, 4, v29
    v_cmp_gt_u32 s[56:57], s18, v2
    s_bitcmp0_b32 s62, 0
    s_cselect_b64 vcc, -1, 0
    s_xor_b64 s[54:55], s[54:55], vcc
    s_xor_b64 s[56:57], s[56:57], vcc
    v_lshrrev_b32 v3, 2, v30
    s_and_b32 s18, s62, 1
    s_lshl_b32 s19, s7, 1
    s_add_u32 s18, s18, s19
    s_cmp_ge_u32 s18, 7
    s_cselect_b32 s19, 14, 7
    s_sub_u32 s18, s19, s18
    v_cmp_gt_u32 s[58:59], s18, v3
    v_add_u32 v2, 4, v3
    v_cmp_gt_u32 s[60:61], s18, v2
    s_bitcmp0_b32 s62, 0
    s_cselect_b64 vcc, -1, 0
    s_xor_b64 s[58:59], s[58:59], vcc
    s_xor_b64 s[60:61], s[60:61], vcc
    s_and_b32 s18, s62, 1
    s_lshl_b32 s19, s7, 1
    s_add_u32 s18, s18, s19
    s_lshl_b32 s100, s18, 10
    s_lshl_b32 s18, s8, 2
    s_and_b32 s19, s62, 2
    s_add_u32 s18, s18, s19
    s_mul_i32 s19, s18, 14336
    s_add_u32 s100, s100, s19
    s_add_u32 s100, s100, 2097152
    s_lshl_b32 s20, s18, 6
    s_add_u32 s20, s20, 16384
    s_lshl_b32 s18, s17, 11
    s_sub_u32 s18, s18, 1024
    s_add_u32 s15, s100, s18
    s_lshl_b32 s19, s7, 1
    s_add_u32 s18, s17, s19
    s_lshl_b32 s18, s18, 3
    s_add_u32 s21, s20, s18
    v_and_b32 v2, 1, v30
    v_cmp_eq_u32 s[44:45], 1, v2
    v_lshl_add_u32 v2, v29, 2, v2
    v_cmp_le_u32 s[46:47], v2, v30
    v_add_u32 v2, 2, v2
    v_cmp_le_u32 s[48:49], v2, v30
    v_mov_b32 v2, 0xffff
    v_mov_b32 v3, 0xffff0000
    v_cndmask_b32 v2, v2, v3, s[44:45]
    v_cndmask_b32 v41, v2, 0, s[46:47]
    v_cndmask_b32 v42, v2, 0, s[48:49]
    v_cndmask_b32 v43, 0, v2, s[46:47]
    v_cndmask_b32 v44, 0, v2, s[48:49]
    s_add_u32 s18, s8, s16
    s_cmp_eq_u32 s18, 0
    s_cselect_b64 s[50:51], -1, 0
    s_mul_i32 s18, s17, 6
    s_cmp_eq_u32 s18, s7
    s_cselect_b32 s101, 1, 0
    v_mov_b32 v49, 1
    v_mov_b32 v50, 0xf149f2ca
    v_mov_b32 v51, 0xffffff00
    s_mov_b32 s0, 0x3e8b97f6
    s_add_u32 s18, s29, 4096
    v_add_u32 v47, s18, v4
    v_add_u32 v48, s29, v4
    v_lshl_add_u32 v52, s62, 2, v5
    v_lshl_add_u32 v222, s17, 10, v4
    v_add_u32 v223, 2048, v222
    v_lshl_add_u32 v224, s17, 2, v5
    v_lshl_add_u32 v225, s17, 3, v5
    s_lshl_b32 s18, s7, 7
    v_min_u32 v8, 11, v1
    s_lshl_b32 s19, s7, 1
    s_add_u32 s19, s19, 2
    v_add_u32 v8, s19, v8
    v_add_u32 v2, -14, v8
    v_min_u32 v8, v8, v2
    v_lshlrev_b32 v8, 3, v8
    v_lshl_add_u32 v18, s16, 12, v222
    v_add_u32 v19, s29, v4
    v_lshl_add_u32 v20, s16, 3, v5
    v_lshrrev_b32 v2, 2, v1
    v_bfe_u32 v3, v1, 3, 2
    v_lshlrev_b32 v3, 5, v3
    v_lshl_add_u32 v2, v2, 7, v3
    v_and_b32 v3, 3, v1
    v_lshl_add_u32 v2, v3, 3, v2
    v_add_u32 v21, 71680, v2
    v_xor_b32 v22, 32, v21
    v_xor_b32 v23, 64, v21
    v_xor_b32 v24, 96, v21
    s_add_u32 s19, s29, 4096
    v_lshrrev_b32 v2, 1, v29
    v_xor_b32 v2, v2, v32
    v_lshlrev_b32 v2, 4, v2
    v_lshl_add_u32 v2, v30, 7, v2
    v_and_b32 v3, 1, v29
    v_lshl_add_u32 v2, v3, 3, v2
    v_add_u32 v25, s19, v2
    v_xor_b32 v26, 32, v25
    v_xor_b32 v27, 64, v25
    v_xor_b32 v28, 96, v25
    v_mul_u32_u24 v10, 1792, v31
    v_lshl_add_u32 v10, v32, 4, v10
    v_xor_b32 v3, v32, v31
    v_lshlrev_b32 v3, 4, v3
    v_lshl_add_u32 v2, v31, 7, v3
    v_add_u32 v9, s19, v2
    s_lshl_b32 s19, s8, 2
    s_add_u32 s19, s19, s62
    s_mul_i32 s22, s19, 14336
    s_add_u32 s22, s22, 2097152
    s_mul_i32 s23, s19, 28672
    s_add_u32 s23, s23, s18
    s_add_u32 s28, s23, 14336
    s_waitcnt lgkmcnt(0)
    s_add_u32 s40, s7, 1
    s_sub_u32 s41, s40, 7
    s_min_u32 s40, s40, s41
    s_lshl_b32 s40, s40, 11
    s_add_u32 s1, s40, s22
    s_add_u32 s40, s7, 2
    s_sub_u32 s41, s40, 7
    s_min_u32 s40, s40, s41
    s_lshl_b32 s40, s40, 11
    s_add_u32 s4, s40, s22
    s_add_u32 s40, s7, 3
    s_sub_u32 s41, s40, 7
    s_min_u32 s40, s40, s41
    s_lshl_b32 s40, s40, 11
    s_add_u32 s6, s40, s22
    s_add_u32 s40, s7, 4
    s_sub_u32 s41, s40, 7
    s_min_u32 s40, s40, s41
    s_lshl_b32 s40, s40, 11
    s_add_u32 s24, s40, s22
    s_add_u32 s40, s7, 5
    s_sub_u32 s41, s40, 7
    s_min_u32 s40, s40, s41
    s_lshl_b32 s40, s40, 11
    s_add_u32 s25, s40, s22
    s_add_u32 s40, s7, 6
    s_sub_u32 s41, s40, 7
    s_min_u32 s40, s40, s41
    s_lshl_b32 s40, s40, 11
    s_add_u32 s26, s40, s22
    s_add_u32 s12, s10, 0x5a3c9671
    s_xor_b32 s13, s11, 0x2b7e1516
    s_add_u32 s52, s52, s12
    s_mov_b32 s53, s13
    v_mov_b32 v14, s12
    v_mov_b32 v15, s13
    s_bfe_u32 s40, s12, 0x80000
    v_mov_b32 v54, s40
    s_bfe_u32 s40, s12, 0x80008
    v_mov_b32 v55, s40
    s_bfe_u32 s40, s12, 0x80010
    v_mov_b32 v56, s40
    s_bfe_u32 s40, s12, 0x80018
    v_mov_b32 v57, s40
    s_setprio 3
    s_cmp_lg_u32 s62, 0
    s_cbranch_scc1 C_nox
    v_mov_b32 v12, s52
    v_mov_b32 v13, s53
    s_lshl_b32 s41, s7, 3
    s_add_u32 s40, s14, s41
    s_mov_b64 exec, 1
    buffer_store_dwordx2 v[12:13], v6, s[36:39], s40 offen sc1
    s_mov_b64 exec, -1
C_nox:
    s_cmp_lg_u32 s16, 0
    s_cbranch_scc1 C_tp1
    s_barrier
    ds_read_b128 v[134:137], v33 offset:2048
    ds_read_b64_tr_b16 v[178:179], v37 offset:8192
    ds_read_b64_tr_b16 v[180:181], v37 offset:8704
    ds_read_b128 v[146:149], v34 offset:2048
    ds_read_b64_tr_b16 v[182:183], v37 offset:12288
    ds_read_b64_tr_b16 v[184:185], v37 offset:12800
    ds_read_b128 v[138:141], v33 offset:4096
    ds_read_b128 v[150:153], v34 offset:4096
    ds_read_b64_tr_b16 v[186:187], v38 offset:8192
    ds_read_b64_tr_b16 v[188:189], v38 offset:8704
    ds_read_b64_tr_b16 v[190:191], v38 offset:12288
    ds_read_b64_tr_b16 v[192:193], v38 offset:12800
    s_waitcnt lgkmcnt(9)
    v_mfma_f32_16x16x32_bf16 v[66:69], v[178:181], v[134:137], 0
    ds_read_b128 v[130:133], v33 offset:0
    s_waitcnt lgkmcnt(7)
    v_mfma_f32_16x16x32_bf16 v[66:69], v[182:185], v[146:149], v[66:69]
    ds_read_b64_tr_b16 v[194:195], v37 offset:16384
    ds_read_b64_tr_b16 v[196:197], v37 offset:16896
    s_waitcnt lgkmcnt(8)
    v_mfma_f32_16x16x32_bf16 v[74:77], v[178:181], v[138:141], 0
    ds_read_b128 v[142:145], v34 offset:0
    ds_read_b64_tr_b16 v[198:199], v37 offset:20480
    s_waitcnt lgkmcnt(9)
    v_mfma_f32_16x16x32_bf16 v[74:77], v[182:185], v[150:153], v[74:77]
    ds_read_b64_tr_b16 v[200:201], v37 offset:20992
    s_waitcnt lgkmcnt(8)
    v_mfma_f32_16x16x32_bf16 v[70:73], v[186:189], v[134:137], 0
    ds_read_b64_tr_b16 v[178:179], v38 offset:16384
    s_waitcnt lgkmcnt(7)
    v_mfma_f32_16x16x32_bf16 v[70:73], v[190:193], v[146:149], v[70:73]
    ds_read_b64_tr_b16 v[180:181], v38 offset:16896
    v_mfma_f32_16x16x32_bf16 v[78:81], v[186:189], v[138:141], 0
    ds_read_b64_tr_b16 v[182:183], v38 offset:20480
    v_mfma_f32_16x16x32_bf16 v[78:81], v[190:193], v[150:153], v[78:81]
    ds_read_b64_tr_b16 v[184:185], v38 offset:20992
    s_waitcnt lgkmcnt(7)
    v_mfma_f32_16x16x32_bf16 v[82:85], v[194:197], v[130:133], 0
    ds_read_b64_tr_b16 v[186:187], v37 offset:24576
    s_waitcnt lgkmcnt(5)
    v_mfma_f32_16x16x32_bf16 v[82:85], v[198:201], v[142:145], v[82:85]
    ds_read_b64_tr_b16 v[188:189], v37 offset:25088
    v_mfma_f32_16x16x32_bf16 v[90:93], v[194:197], v[134:137], 0
    ds_read_b64_tr_b16 v[190:191], v37 offset:28672
    v_mfma_f32_16x16x32_bf16 v[90:93], v[198:201], v[146:149], v[90:93]
    ds_read_b64_tr_b16 v[192:193], v37 offset:29184
    v_mfma_f32_16x16x32_bf16 v[98:101], v[194:197], v[138:141], 0
    ds_read_b64_tr_b16 v[194:195], v38 offset:24576
    v_mfma_f32_16x16x32_bf16 v[98:101], v[198:201], v[150:153], v[98:101]
    ds_read_b64_tr_b16 v[196:197], v38 offset:25088
    s_waitcnt lgkmcnt(8)
    v_mfma_f32_16x16x32_bf16 v[86:89], v[178:181], v[130:133], 0
    ds_read_b64_tr_b16 v[198:199], v38 offset:28672
    s_waitcnt lgkmcnt(7)
    v_mfma_f32_16x16x32_bf16 v[86:89], v[182:185], v[142:145], v[86:89]
    ds_read_b64_tr_b16 v[200:201], v38 offset:29184
    v_mfma_f32_16x16x32_bf16 v[94:97], v[178:181], v[134:137], 0
    v_mfma_f32_16x16x32_bf16 v[94:97], v[182:185], v[146:149], v[94:97]
    v_mfma_f32_16x16x32_bf16 v[102:105], v[178:181], v[138:141], 0
    v_mfma_f32_16x16x32_bf16 v[102:105], v[182:185], v[150:153], v[102:105]
    s_waitcnt lgkmcnt(6)
    v_mfma_f32_16x16x32_bf16 v[106:109], v[130:133], v[186:189], 0
    s_waitcnt lgkmcnt(4)
    v_mfma_f32_16x16x32_bf16 v[106:109], v[142:145], v[190:193], v[106:109]
    v_mfma_f32_16x16x32_bf16 v[114:117], v[134:137], v[186:189], 0
    v_mfma_f32_16x16x32_bf16 v[114:117], v[146:149], v[190:193], v[114:117]
    s_waitcnt lgkmcnt(2)
    v_mfma_f32_16x16x32_bf16 v[110:113], v[130:133], v[194:197], 0
    s_waitcnt lgkmcnt(0)
    s_barrier
    ds_read_b128 v[158:161], v33 offset:12288
    ds_read_b64_tr_b16 v[178:179], v37 offset:32768
    ds_read_b64_tr_b16 v[180:181], v37 offset:33280
    ds_read_b128 v[170:173], v34 offset:12288
    ds_read_b64_tr_b16 v[182:183], v37 offset:36864
    ds_read_b64_tr_b16 v[184:185], v37 offset:37376
    ds_read_b128 v[162:165], v33 offset:14336
    ds_read_b128 v[174:177], v34 offset:14336
    ds_read_b64_tr_b16 v[186:187], v38 offset:32768
    ds_read_b64_tr_b16 v[188:189], v38 offset:33280
    ds_read_b64_tr_b16 v[190:191], v38 offset:36864
    ds_read_b64_tr_b16 v[192:193], v38 offset:37376
    ds_read_b128 v[154:157], v33 offset:10240
    v_mfma_f32_16x16x32_bf16 v[110:113], v[142:145], v[198:201], v[110:113]
    v_mfma_f32_16x16x32_bf16 v[118:121], v[134:137], v[194:197], 0
    ds_read_b64_tr_b16 v[194:195], v37 offset:40960
    v_mfma_f32_16x16x32_bf16 v[118:121], v[146:149], v[198:201], v[118:121]
    ds_read_b64_tr_b16 v[196:197], v37 offset:41472
    s_waitcnt lgkmcnt(12)
    v_mfma_f32_16x16x32_bf16 v[66:69], v[178:181], v[158:161], v[66:69]
    ds_read_b128 v[166:169], v34 offset:10240
    s_waitcnt lgkmcnt(10)
    v_mfma_f32_16x16x32_bf16 v[66:69], v[182:185], v[170:173], v[66:69]
    ds_read_b64_tr_b16 v[198:199], v37 offset:45056
    s_waitcnt lgkmcnt(10)
    v_mfma_f32_16x16x32_bf16 v[74:77], v[178:181], v[162:165], v[74:77]
    ds_read_b64_tr_b16 v[200:201], v37 offset:45568
    s_waitcnt lgkmcnt(10)
    v_mfma_f32_16x16x32_bf16 v[74:77], v[182:185], v[174:177], v[74:77]
    ds_read_b64_tr_b16 v[178:179], v38 offset:40960
    s_waitcnt lgkmcnt(9)
    v_mfma_f32_16x16x32_bf16 v[70:73], v[186:189], v[158:161], v[70:73]
    ds_read_b64_tr_b16 v[180:181], v38 offset:41472
    s_waitcnt lgkmcnt(8)
    v_mfma_f32_16x16x32_bf16 v[70:73], v[190:193], v[170:173], v[70:73]
    ds_read_b64_tr_b16 v[182:183], v38 offset:45056
    v_mfma_f32_16x16x32_bf16 v[78:81], v[186:189], v[162:165], v[78:81]
    ds_read_b64_tr_b16 v[184:185], v38 offset:45568
    v_mfma_f32_16x16x32_bf16 v[78:81], v[190:193], v[174:177], v[78:81]
    ds_read_b64_tr_b16 v[186:187], v39 offset:0
    s_waitcnt lgkmcnt(8)
    v_mfma_f32_16x16x32_bf16 v[82:85], v[194:197], v[154:157], v[82:85]
    ds_read_b64_tr_b16 v[188:189], v39 offset:512
    s_waitcnt lgkmcnt(6)
    v_mfma_f32_16x16x32_bf16 v[82:85], v[198:201], v[166:169], v[82:85]
    ds_read_b64_tr_b16 v[190:191], v39 offset:4096
    v_mfma_f32_16x16x32_bf16 v[90:93], v[194:197], v[158:161], v[90:93]
    ds_read_b64_tr_b16 v[192:193], v39 offset:4608
    v_mfma_f32_16x16x32_bf16 v[90:93], v[198:201], v[170:173], v[90:93]
    v_mfma_f32_16x16x32_bf16 v[98:101], v[194:197], v[162:165], v[98:101]
    ds_read_b64_tr_b16 v[194:195], v40 offset:0
    v_mfma_f32_16x16x32_bf16 v[98:101], v[198:201], v[174:177], v[98:101]
    ds_read_b64_tr_b16 v[196:197], v40 offset:512
    s_waitcnt lgkmcnt(8)
    v_mfma_f32_16x16x32_bf16 v[86:89], v[178:181], v[154:157], v[86:89]
    ds_read_b64_tr_b16 v[198:199], v40 offset:4096
    s_waitcnt lgkmcnt(7)
    v_mfma_f32_16x16x32_bf16 v[86:89], v[182:185], v[166:169], v[86:89]
    ds_read_b64_tr_b16 v[200:201], v40 offset:4608
    v_mfma_f32_16x16x32_bf16 v[94:97], v[178:181], v[158:161], v[94:97]
    v_mfma_f32_16x16x32_bf16 v[94:97], v[182:185], v[170:173], v[94:97]
    v_mfma_f32_16x16x32_bf16 v[102:105], v[178:181], v[162:165], v[102:105]
    v_mfma_f32_16x16x32_bf16 v[102:105], v[182:185], v[174:177], v[102:105]
    s_waitcnt lgkmcnt(6)
    v_mfma_f32_16x16x32_bf16 v[106:109], v[154:157], v[186:189], v[106:109]
    s_waitcnt lgkmcnt(4)
    v_mfma_f32_16x16x32_bf16 v[106:109], v[166:169], v[190:193], v[106:109]
    v_mfma_f32_16x16x32_bf16 v[114:117], v[158:161], v[186:189], v[114:117]
    v_mfma_f32_16x16x32_bf16 v[114:117], v[170:173], v[190:193], v[114:117]
    s_waitcnt lgkmcnt(2)
    v_mfma_f32_16x16x32_bf16 v[110:113], v[154:157], v[194:197], v[110:113]
    s_waitcnt lgkmcnt(0)
    s_barrier
    ds_read_b128 v[134:137], v33 offset:22528
    ds_read_b64_tr_b16 v[178:179], v39 offset:8192
    ds_read_b64_tr_b16 v[180:181], v39 offset:8704
    ds_read_b128 v[146:149], v34 offset:22528
    ds_read_b64_tr_b16 v[182:183], v39 offset:12288
    ds_read_b64_tr_b16 v[184:185], v39 offset:12800
    ds_read_b128 v[138:141], v33 offset:24576
    ds_read_b128 v[150:153], v34 offset:24576
    ds_read_b64_tr_b16 v[186:187], v40 offset:8192
    ds_read_b64_tr_b16 v[188:189], v40 offset:8704
    ds_read_b64_tr_b16 v[190:191], v40 offset:12288
    ds_read_b64_tr_b16 v[192:193], v40 offset:12800
    ds_read_b128 v[130:133], v33 offset:20480
    v_mfma_f32_16x16x32_bf16 v[110:113], v[166:169], v[198:201], v[110:113]
    v_mfma_f32_16x16x32_bf16 v[118:121], v[158:161], v[194:197], v[118:121]
    ds_read_b64_tr_b16 v[194:195], v39 offset:16384
    v_mfma_f32_16x16x32_bf16 v[118:121], v[170:173], v[198:201], v[118:121]
    ds_read_b64_tr_b16 v[196:197], v39 offset:16896
    s_waitcnt lgkmcnt(12)
    v_mfma_f32_16x16x32_bf16 v[66:69], v[178:181], v[134:137], v[66:69]
    ds_read_b128 v[142:145], v34 offset:20480
    s_waitcnt lgkmcnt(10)
    v_mfma_f32_16x16x32_bf16 v[66:69], v[182:185], v[146:149], v[66:69]
    ds_read_b64_tr_b16 v[198:199], v39 offset:20480
    s_waitcnt lgkmcnt(10)
    v_mfma_f32_16x16x32_bf16 v[74:77], v[178:181], v[138:141], v[74:77]
    ds_read_b64_tr_b16 v[200:201], v39 offset:20992
    s_waitcnt lgkmcnt(10)
    v_mfma_f32_16x16x32_bf16 v[74:77], v[182:185], v[150:153], v[74:77]
    ds_read_b64_tr_b16 v[178:179], v40 offset:16384
    s_waitcnt lgkmcnt(9)
    v_mfma_f32_16x16x32_bf16 v[70:73], v[186:189], v[134:137], v[70:73]
    ds_read_b64_tr_b16 v[180:181], v40 offset:16896
    s_waitcnt lgkmcnt(8)
    v_mfma_f32_16x16x32_bf16 v[70:73], v[190:193], v[146:149], v[70:73]
    ds_read_b64_tr_b16 v[182:183], v40 offset:20480
    v_mfma_f32_16x16x32_bf16 v[78:81], v[186:189], v[138:141], v[78:81]
    ds_read_b64_tr_b16 v[184:185], v40 offset:20992
    v_mfma_f32_16x16x32_bf16 v[78:81], v[190:193], v[150:153], v[78:81]
    ds_read_b64_tr_b16 v[186:187], v39 offset:24576
    s_waitcnt lgkmcnt(8)
    v_mfma_f32_16x16x32_bf16 v[82:85], v[194:197], v[130:133], v[82:85]
    ds_read_b64_tr_b16 v[188:189], v39 offset:25088
    s_waitcnt lgkmcnt(6)
    v_mfma_f32_16x16x32_bf16 v[82:85], v[198:201], v[142:145], v[82:85]
    ds_read_b64_tr_b16 v[190:191], v39 offset:28672
    v_mfma_f32_16x16x32_bf16 v[90:93], v[194:197], v[134:137], v[90:93]
    ds_read_b64_tr_b16 v[192:193], v39 offset:29184
    v_mfma_f32_16x16x32_bf16 v[90:93], v[198:201], v[146:149], v[90:93]
    v_mfma_f32_16x16x32_bf16 v[98:101], v[194:197], v[138:141], v[98:101]
    ds_read_b64_tr_b16 v[194:195], v40 offset:24576
    v_mfma_f32_16x16x32_bf16 v[98:101], v[198:201], v[150:153], v[98:101]
    ds_read_b64_tr_b16 v[196:197], v40 offset:25088
    s_waitcnt lgkmcnt(8)
    v_mfma_f32_16x16x32_bf16 v[86:89], v[178:181], v[130:133], v[86:89]
    ds_read_b64_tr_b16 v[198:199], v40 offset:28672
    s_waitcnt lgkmcnt(7)
    v_mfma_f32_16x16x32_bf16 v[86:89], v[182:185], v[142:145], v[86:89]
    ds_read_b64_tr_b16 v[200:201], v40 offset:29184
    v_mfma_f32_16x16x32_bf16 v[94:97], v[178:181], v[134:137], v[94:97]
    v_mfma_f32_16x16x32_bf16 v[94:97], v[182:185], v[146:149], v[94:97]
    v_mfma_f32_16x16x32_bf16 v[102:105], v[178:181], v[138:141], v[102:105]
    v_mfma_f32_16x16x32_bf16 v[102:105], v[182:185], v[150:153], v[102:105]
    s_waitcnt lgkmcnt(6)
    v_mfma_f32_16x16x32_bf16 v[106:109], v[130:133], v[186:189], v[106:109]
    s_waitcnt lgkmcnt(4)
    v_mfma_f32_16x16x32_bf16 v[106:109], v[142:145], v[190:193], v[106:109]
    v_mfma_f32_16x16x32_bf16 v[114:117], v[134:137], v[186:189], v[114:117]
    v_mfma_f32_16x16x32_bf16 v[114:117], v[146:149], v[190:193], v[114:117]
    s_waitcnt lgkmcnt(2)
    v_mfma_f32_16x16x32_bf16 v[110:113], v[130:133], v[194:197], v[110:113]
    s_waitcnt lgkmcnt(0)
    s_barrier
    ds_read_b128 v[158:161], v33 offset:32768
    ds_read_b64_tr_b16 v[178:179], v39 offset:32768
    ds_read_b64_tr_b16 v[180:181], v39 offset:33280
    ds_read_b128 v[170:173], v34 offset:32768
    ds_read_b64_tr_b16 v[182:183], v39 offset:36864
    ds_read_b64_tr_b16 v[184:185], v39 offset:37376
    ds_read_b128 v[162:165], v33 offset:34816
    ds_read_b128 v[174:177], v34 offset:34816
    ds_read_b64_tr_b16 v[186:187], v40 offset:32768
    ds_read_b64_tr_b16 v[188:189], v40 offset:33280
    ds_read_b64_tr_b16 v[190:191], v40 offset:36864
    ds_read_b64_tr_b16 v[192:193], v40 offset:37376
    ds_read_b128 v[154:157], v33 offset:30720
    v_mfma_f32_16x16x32_bf16 v[110:113], v[142:145], v[198:201], v[110:113]
    v_mfma_f32_16x16x32_bf16 v[118:121], v[134:137], v[194:197], v[118:121]
    ds_read_b64_tr_b16 v[194:195], v37 offset:0
    v_mfma_f32_16x16x32_bf16 v[118:121], v[146:149], v[198:201], v[118:121]
    ds_read_b64_tr_b16 v[196:197], v37 offset:512
    s_waitcnt lgkmcnt(12)
    v_mfma_f32_16x16x32_bf16 v[66:69], v[178:181], v[158:161], v[66:69]
    ds_read_b128 v[166:169], v34 offset:30720
    s_waitcnt lgkmcnt(10)
    v_mfma_f32_16x16x32_bf16 v[66:69], v[182:185], v[170:173], v[66:69]
    ds_read_b64_tr_b16 v[198:199], v37 offset:4096
    s_waitcnt lgkmcnt(10)
    v_mfma_f32_16x16x32_bf16 v[74:77], v[178:181], v[162:165], v[74:77]
    ds_read_b64_tr_b16 v[200:201], v37 offset:4608
    s_waitcnt lgkmcnt(10)
    v_mfma_f32_16x16x32_bf16 v[74:77], v[182:185], v[174:177], v[74:77]
    ds_read_b64_tr_b16 v[178:179], v38 offset:0
    s_waitcnt lgkmcnt(9)
    v_mfma_f32_16x16x32_bf16 v[70:73], v[186:189], v[158:161], v[70:73]
    ds_read_b64_tr_b16 v[180:181], v38 offset:512
    s_waitcnt lgkmcnt(8)
    v_mfma_f32_16x16x32_bf16 v[70:73], v[190:193], v[170:173], v[70:73]
    ds_read_b64_tr_b16 v[182:183], v38 offset:4096
    v_mfma_f32_16x16x32_bf16 v[78:81], v[186:189], v[162:165], v[78:81]
    ds_read_b64_tr_b16 v[184:185], v38 offset:4608
    v_mfma_f32_16x16x32_bf16 v[78:81], v[190:193], v[174:177], v[78:81]
    ds_read_b64_tr_b16 v[186:187], v37 offset:8192
    s_waitcnt lgkmcnt(8)
    v_mfma_f32_16x16x32_bf16 v[82:85], v[194:197], v[154:157], v[82:85]
    ds_read_b64_tr_b16 v[188:189], v37 offset:8704
    s_waitcnt lgkmcnt(6)
    v_mfma_f32_16x16x32_bf16 v[82:85], v[198:201], v[166:169], v[82:85]
    ds_read_b64_tr_b16 v[190:191], v37 offset:12288
    v_mfma_f32_16x16x32_bf16 v[90:93], v[194:197], v[158:161], v[90:93]
    ds_read_b64_tr_b16 v[192:193], v37 offset:12800
    v_mfma_f32_16x16x32_bf16 v[90:93], v[198:201], v[170:173], v[90:93]
    v_mfma_f32_16x16x32_bf16 v[98:101], v[194:197], v[162:165], v[98:101]
    ds_read_b64_tr_b16 v[194:195], v38 offset:8192
    v_mfma_f32_16x16x32_bf16 v[98:101], v[198:201], v[174:177], v[98:101]
    ds_read_b64_tr_b16 v[196:197], v38 offset:8704
    s_waitcnt lgkmcnt(8)
    v_mfma_f32_16x16x32_bf16 v[86:89], v[178:181], v[154:157], v[86:89]
    ds_read_b64_tr_b16 v[198:199], v38 offset:12288
    s_waitcnt lgkmcnt(7)
    v_mfma_f32_16x16x32_bf16 v[86:89], v[182:185], v[166:169], v[86:89]
    ds_read_b64_tr_b16 v[200:201], v38 offset:12800
    v_mfma_f32_16x16x32_bf16 v[94:97], v[178:181], v[158:161], v[94:97]
    v_mfma_f32_16x16x32_bf16 v[94:97], v[182:185], v[170:173], v[94:97]
    v_mfma_f32_16x16x32_bf16 v[102:105], v[178:181], v[162:165], v[102:105]
    v_mfma_f32_16x16x32_bf16 v[102:105], v[182:185], v[174:177], v[102:105]
    s_waitcnt lgkmcnt(6)
    v_mfma_f32_16x16x32_bf16 v[106:109], v[154:157], v[186:189], v[106:109]
    s_waitcnt lgkmcnt(4)
    v_mfma_f32_16x16x32_bf16 v[106:109], v[166:169], v[190:193], v[106:109]
    v_mfma_f32_16x16x32_bf16 v[114:117], v[158:161], v[186:189], v[114:117]
    v_mfma_f32_16x16x32_bf16 v[114:117], v[170:173], v[190:193], v[114:117]
    s_waitcnt lgkmcnt(2)
    v_mfma_f32_16x16x32_bf16 v[110:113], v[154:157], v[194:197], v[110:113]
    s_waitcnt lgkmcnt(0)
    s_barrier
    ds_read_b128 v[134:137], v35 offset:2048
    ds_read_b64_tr_b16 v[178:179], v37 offset:16384
    ds_read_b64_tr_b16 v[180:181], v37 offset:16896
    ds_read_b128 v[146:149], v36 offset:2048
    ds_read_b64_tr_b16 v[182:183], v37 offset:20480
    ds_read_b64_tr_b16 v[184:185], v37 offset:20992
    ds_read_b128 v[138:141], v35 offset:4096
    ds_read_b128 v[150:153], v36 offset:4096
    ds_read_b64_tr_b16 v[186:187], v38 offset:16384
    ds_read_b64_tr_b16 v[188:189], v38 offset:16896
    ds_read_b64_tr_b16 v[190:191], v38 offset:20480
    ds_read_b64_tr_b16 v[192:193], v38 offset:20992
    ds_read_b128 v[130:133], v35 offset:0
    v_mfma_f32_16x16x32_bf16 v[110:113], v[166:169], v[198:201], v[110:113]
    v_mfma_f32_16x16x32_bf16 v[118:121], v[158:161], v[194:197], v[118:121]
    ds_read_b64_tr_b16 v[194:195], v37 offset:24576
    v_mfma_f32_16x16x32_bf16 v[118:121], v[170:173], v[198:201], v[118:121]
    ds_read_b64_tr_b16 v[196:197], v37 offset:25088
    s_waitcnt lgkmcnt(12)
    v_mfma_f32_16x16x32_bf16 v[66:69], v[178:181], v[134:137], v[66:69]
    ds_read_b128 v[142:145], v36 offset:0
    s_waitcnt lgkmcnt(10)
    v_mfma_f32_16x16x32_bf16 v[66:69], v[182:185], v[146:149], v[66:69]
    ds_read_b64_tr_b16 v[198:199], v37 offset:28672
    s_waitcnt lgkmcnt(10)
    v_mfma_f32_16x16x32_bf16 v[74:77], v[178:181], v[138:141], v[74:77]
    ds_read_b64_tr_b16 v[200:201], v37 offset:29184
    s_waitcnt lgkmcnt(10)
    v_mfma_f32_16x16x32_bf16 v[74:77], v[182:185], v[150:153], v[74:77]
    ds_read_b64_tr_b16 v[178:179], v38 offset:24576
    s_waitcnt lgkmcnt(9)
    v_mfma_f32_16x16x32_bf16 v[70:73], v[186:189], v[134:137], v[70:73]
    ds_read_b64_tr_b16 v[180:181], v38 offset:25088
    s_waitcnt lgkmcnt(8)
    v_mfma_f32_16x16x32_bf16 v[70:73], v[190:193], v[146:149], v[70:73]
    ds_read_b64_tr_b16 v[182:183], v38 offset:28672
    v_mfma_f32_16x16x32_bf16 v[78:81], v[186:189], v[138:141], v[78:81]
    ds_read_b64_tr_b16 v[184:185], v38 offset:29184
    v_mfma_f32_16x16x32_bf16 v[78:81], v[190:193], v[150:153], v[78:81]
    ds_read_b64_tr_b16 v[186:187], v37 offset:32768
    s_waitcnt lgkmcnt(8)
    v_mfma_f32_16x16x32_bf16 v[82:85], v[194:197], v[130:133], v[82:85]
    ds_read_b64_tr_b16 v[188:189], v37 offset:33280
    s_waitcnt lgkmcnt(6)
    v_mfma_f32_16x16x32_bf16 v[82:85], v[198:201], v[142:145], v[82:85]
    ds_read_b64_tr_b16 v[190:191], v37 offset:36864
    v_mfma_f32_16x16x32_bf16 v[90:93], v[194:197], v[134:137], v[90:93]
    ds_read_b64_tr_b16 v[192:193], v37 offset:37376
    v_mfma_f32_16x16x32_bf16 v[90:93], v[198:201], v[146:149], v[90:93]
    v_mfma_f32_16x16x32_bf16 v[98:101], v[194:197], v[138:141], v[98:101]
    ds_read_b64_tr_b16 v[194:195], v38 offset:32768
    v_mfma_f32_16x16x32_bf16 v[98:101], v[198:201], v[150:153], v[98:101]
    ds_read_b64_tr_b16 v[196:197], v38 offset:33280
    s_waitcnt lgkmcnt(8)
    v_mfma_f32_16x16x32_bf16 v[86:89], v[178:181], v[130:133], v[86:89]
    ds_read_b64_tr_b16 v[198:199], v38 offset:36864
    s_waitcnt lgkmcnt(7)
    v_mfma_f32_16x16x32_bf16 v[86:89], v[182:185], v[142:145], v[86:89]
    ds_read_b64_tr_b16 v[200:201], v38 offset:37376
    v_mfma_f32_16x16x32_bf16 v[94:97], v[178:181], v[134:137], v[94:97]
    v_mfma_f32_16x16x32_bf16 v[94:97], v[182:185], v[146:149], v[94:97]
    v_mfma_f32_16x16x32_bf16 v[102:105], v[178:181], v[138:141], v[102:105]
    v_mfma_f32_16x16x32_bf16 v[102:105], v[182:185], v[150:153], v[102:105]
    s_waitcnt lgkmcnt(6)
    v_mfma_f32_16x16x32_bf16 v[106:109], v[130:133], v[186:189], v[106:109]
    s_waitcnt lgkmcnt(4)
    v_mfma_f32_16x16x32_bf16 v[106:109], v[142:145], v[190:193], v[106:109]
    v_mfma_f32_16x16x32_bf16 v[114:117], v[134:137], v[186:189], v[114:117]
    v_mfma_f32_16x16x32_bf16 v[114:117], v[146:149], v[190:193], v[114:117]
    s_waitcnt lgkmcnt(2)
    v_mfma_f32_16x16x32_bf16 v[110:113], v[130:133], v[194:197], v[110:113]
    s_waitcnt lgkmcnt(0)
    s_barrier
    ds_read_b128 v[158:161], v35 offset:12288
    ds_read_b64_tr_b16 v[178:179], v37 offset:40960
    ds_read_b64_tr_b16 v[180:181], v37 offset:41472
    ds_read_b128 v[170:173], v36 offset:12288
    ds_read_b64_tr_b16 v[182:183], v37 offset:45056
    ds_read_b64_tr_b16 v[184:185], v37 offset:45568
    ds_read_b128 v[162:165], v35 offset:14336
    ds_read_b128 v[174:177], v36 offset:14336
    ds_read_b64_tr_b16 v[186:187], v38 offset:40960
    ds_read_b64_tr_b16 v[188:189], v38 offset:41472
    ds_read_b64_tr_b16 v[190:191], v38 offset:45056
    ds_read_b64_tr_b16 v[192:193], v38 offset:45568
    ds_read_b128 v[154:157], v35 offset:10240
    v_mfma_f32_16x16x32_bf16 v[110:113], v[142:145], v[198:201], v[110:113]
    ds_read_b64_tr_b16 v[202:203], v39 offset:0
    v_mfma_f32_16x16x32_bf16 v[118:121], v[134:137], v[194:197], v[118:121]
    ds_read_b64_tr_b16 v[204:205], v39 offset:512
    v_mfma_f32_16x16x32_bf16 v[118:121], v[146:149], v[198:201], v[118:121]
    ds_read_b128 v[166:169], v36 offset:10240
    s_waitcnt lgkmcnt(13)
    v_mfma_f32_16x16x32_bf16 v[66:69], v[178:181], v[158:161], v[66:69]
    ds_read_b64_tr_b16 v[206:207], v39 offset:4096
    s_waitcnt lgkmcnt(11)
    v_mfma_f32_16x16x32_bf16 v[66:69], v[182:185], v[170:173], v[66:69]
    ds_read_b64_tr_b16 v[208:209], v39 offset:4608
    s_waitcnt lgkmcnt(11)
    v_mfma_f32_16x16x32_bf16 v[74:77], v[178:181], v[162:165], v[74:77]
    ds_read_b64_tr_b16 v[194:195], v40 offset:0
    s_waitcnt lgkmcnt(11)
    v_mfma_f32_16x16x32_bf16 v[74:77], v[182:185], v[174:177], v[74:77]
    ds_read_b64_tr_b16 v[196:197], v40 offset:512
    s_waitcnt lgkmcnt(10)
    v_mfma_f32_16x16x32_bf16 v[70:73], v[186:189], v[158:161], v[70:73]
    ds_read_b64_tr_b16 v[198:199], v40 offset:4096
    s_waitcnt lgkmcnt(9)
    v_mfma_f32_16x16x32_bf16 v[70:73], v[190:193], v[170:173], v[70:73]
    ds_read_b64_tr_b16 v[200:201], v40 offset:4608
    v_mfma_f32_16x16x32_bf16 v[78:81], v[186:189], v[162:165], v[78:81]
    v_mfma_f32_16x16x32_bf16 v[78:81], v[190:193], v[174:177], v[78:81]
    s_waitcnt lgkmcnt(7)
    v_mfma_f32_16x16x32_bf16 v[82:85], v[202:205], v[154:157], v[82:85]
    s_waitcnt lgkmcnt(4)
    v_mfma_f32_16x16x32_bf16 v[82:85], v[206:209], v[166:169], v[82:85]
    v_mfma_f32_16x16x32_bf16 v[90:93], v[202:205], v[158:161], v[90:93]
    v_mfma_f32_16x16x32_bf16 v[90:93], v[206:209], v[170:173], v[90:93]
    v_mfma_f32_16x16x32_bf16 v[98:101], v[202:205], v[162:165], v[98:101]
    v_mfma_f32_16x16x32_bf16 v[98:101], v[206:209], v[174:177], v[98:101]
    s_waitcnt lgkmcnt(2)
    v_mfma_f32_16x16x32_bf16 v[86:89], v[194:197], v[154:157], v[86:89]
    s_waitcnt lgkmcnt(0)
    v_mfma_f32_16x16x32_bf16 v[86:89], v[198:201], v[166:169], v[86:89]
    v_mfma_f32_16x16x32_bf16 v[94:97], v[194:197], v[158:161], v[94:97]
    v_mfma_f32_16x16x32_bf16 v[94:97], v[198:201], v[170:173], v[94:97]
    v_mfma_f32_16x16x32_bf16 v[102:105], v[194:197], v[162:165], v[102:105]
    s_barrier
    ds_read_b128 v[134:137], v35 offset:22528
    ds_read_b64_tr_b16 v[178:179], v39 offset:8192
    ds_read_b64_tr_b16 v[180:181], v39 offset:8704
    ds_read_b128 v[146:149], v36 offset:22528
    ds_read_b64_tr_b16 v[182:183], v39 offset:12288
    ds_read_b64_tr_b16 v[184:185], v39 offset:12800
    ds_read_b128 v[138:141], v35 offset:24576
    ds_read_b128 v[150:153], v36 offset:24576
    ds_read_b64_tr_b16 v[186:187], v40 offset:8192
    ds_read_b64_tr_b16 v[188:189], v40 offset:8704
    ds_read_b64_tr_b16 v[190:191], v40 offset:12288
    ds_read_b64_tr_b16 v[192:193], v40 offset:12800
    ds_read_b128 v[130:133], v35 offset:20480
    v_mfma_f32_16x16x32_bf16 v[102:105], v[198:201], v[174:177], v[102:105]
    ds_read_b128 v[142:145], v36 offset:20480
    s_waitcnt lgkmcnt(11)
    v_mfma_f32_16x16x32_bf16 v[66:69], v[178:181], v[134:137], v[66:69]
    s_barrier
    ds_read_b64_tr_b16 v[202:203], v39 offset:16384
    ds_read_b64_tr_b16 v[204:205], v39 offset:16896
    ds_read_b64_tr_b16 v[206:207], v39 offset:20480
    ds_read_b64_tr_b16 v[208:209], v39 offset:20992
    ds_read_b64_tr_b16 v[194:195], v40 offset:16384
    s_waitcnt lgkmcnt(13)
    v_mfma_f32_16x16x32_bf16 v[66:69], v[182:185], v[146:149], v[66:69]
    ds_read_b64_tr_b16 v[196:197], v40 offset:16896
    s_waitcnt lgkmcnt(13)
    v_mfma_f32_16x16x32_bf16 v[74:77], v[178:181], v[138:141], v[74:77]
    ds_read_b64_tr_b16 v[198:199], v40 offset:20480
    s_waitcnt lgkmcnt(13)
    v_mfma_f32_16x16x32_bf16 v[74:77], v[182:185], v[150:153], v[74:77]
    ds_read_b64_tr_b16 v[200:201], v40 offset:20992
    s_waitcnt lgkmcnt(12)
    v_mfma_f32_16x16x32_bf16 v[70:73], v[186:189], v[134:137], v[70:73]
    v_cvt_pk_bf16_f32 v154, v66, v67
    v_cvt_pk_bf16_f32 v155, v68, v69
    s_waitcnt lgkmcnt(10)
    v_mfma_f32_16x16x32_bf16 v[70:73], v[190:193], v[146:149], v[70:73]
    v_cndmask_b32 v162, 0, v154, s[54:55]
    v_cndmask_b32 v154, v154, 0, s[54:55]
    v_mfma_f32_16x16x32_bf16 v[78:81], v[186:189], v[138:141], v[78:81]
    v_cndmask_b32 v163, 0, v155, s[54:55]
    v_cndmask_b32 v155, v155, 0, s[54:55]
    v_mfma_f32_16x16x32_bf16 v[78:81], v[190:193], v[150:153], v[78:81]
    v_cvt_pk_bf16_f32 v158, v74, v75
    v_cvt_pk_bf16_f32 v159, v76, v77
    s_waitcnt lgkmcnt(6)
    v_mfma_f32_16x16x32_bf16 v[98:101], v[202:205], v[138:141], v[98:101]
    v_cndmask_b32 v166, 0, v158, s[54:55]
    v_cndmask_b32 v158, v158, 0, s[54:55]
    s_waitcnt lgkmcnt(4)
    v_mfma_f32_16x16x32_bf16 v[98:101], v[206:209], v[150:153], v[98:101]
    v_cndmask_b32 v167, 0, v159, s[54:55]
    v_cndmask_b32 v159, v159, 0, s[54:55]
    s_waitcnt lgkmcnt(2)
    v_mfma_f32_16x16x32_bf16 v[102:105], v[194:197], v[138:141], v[102:105]
    v_cvt_pk_bf16_f32 v156, v70, v71
    v_cvt_pk_bf16_f32 v157, v72, v73
    s_waitcnt lgkmcnt(0)
    v_mfma_f32_16x16x32_bf16 v[102:105], v[198:201], v[150:153], v[102:105]
    v_cndmask_b32 v164, 0, v156, s[56:57]
    v_cndmask_b32 v156, v156, 0, s[56:57]
    v_mfma_f32_16x16x32_bf16 v[82:85], v[202:205], v[130:133], v[82:85]
    v_cndmask_b32 v165, 0, v157, s[56:57]
    v_cndmask_b32 v157, v157, 0, s[56:57]
    v_mfma_f32_16x16x32_bf16 v[82:85], v[206:209], v[142:145], v[82:85]
    v_cvt_pk_bf16_f32 v160, v78, v79
    v_cvt_pk_bf16_f32 v161, v80, v81
    v_mfma_f32_16x16x32_bf16 v[86:89], v[194:197], v[130:133], v[86:89]
    v_cndmask_b32 v168, 0, v160, s[56:57]
    v_cndmask_b32 v160, v160, 0, s[56:57]
    v_mfma_f32_16x16x32_bf16 v[86:89], v[198:201], v[142:145], v[86:89]
    v_cndmask_b32 v169, 0, v161, s[56:57]
    v_cndmask_b32 v161, v161, 0, s[56:57]
    v_mfma_f32_16x16x32_bf16 v[90:93], v[202:205], v[134:137], v[90:93]
    v_cvt_pk_bf16_f32 v238, v98, v99
    v_cvt_pk_bf16_f32 v239, v100, v101
    v_mfma_f32_16x16x32_bf16 v[90:93], v[206:209], v[146:149], v[90:93]
    v_cvt_pk_bf16_f32 v240, v102, v103
    v_cvt_pk_bf16_f32 v241, v104, v105
    v_mfma_f32_16x16x32_bf16 v[94:97], v[194:197], v[134:137], v[94:97]
    ds_write_b128 v222, v[238:241]
    ds_write_b32 v224, v5 offset:56
    v_mfma_f32_16x16x32_bf16 v[94:97], v[198:201], v[146:149], v[94:97]
    ds_read_b32 v45, v5 offset:4
    v_cvt_pk_bf16_f32 v230, v82, v83
    v_cvt_pk_bf16_f32 v231, v84, v85
    v_cvt_pk_bf16_f32 v232, v86, v87
    v_cvt_pk_bf16_f32 v233, v88, v89
    s_nop 1
    v_mfma_f32_16x16x32_bf16 v[66:69], v[230:233], v[154:157], 0
    v_mfma_f32_16x16x32_bf16 v[78:81], v[238:241], v[158:161], 0
    v_cvt_pk_bf16_f32 v234, v90, v91
    v_cvt_pk_bf16_f32 v235, v92, v93
    v_cvt_pk_bf16_f32 v236, v94, v95
    v_cvt_pk_bf16_f32 v237, v96, v97
    s_nop 1
    v_mfma_f32_16x16x32_bf16 v[70:73], v[234:237], v[154:157], 0
    v_mfma_f32_16x16x32_bf16 v[74:77], v[234:237], v[158:161], 0
    v_mfma_f32_16x16x32_bf16 v[178:181], v[230:233], v[162:165], 0
    v_mfma_f32_16x16x32_bf16 v[182:185], v[234:237], v[162:165], 0
    s_waitcnt lgkmcnt(0)
    v_readfirstlane_b32 s63, v45
    s_nop 2
    v_cndmask_b32 v70, v70, v71, s[44:45]
    v_cndmask_b32 v72, v72, v73, s[44:45]
    v_cndmask_b32 v66, v66, v67, s[44:45]
    v_cndmask_b32 v68, v68, v69, s[44:45]
    v_cndmask_b32 v66, v66, v50, s[50:51]
    v_cndmask_b32 v68, v68, v50, s[50:51]
    v_cndmask_b32 v214, v66, v70, s[46:47]
    v_cndmask_b32 v215, v68, v72, s[48:49]
    v_cndmask_b32 v78, v78, v79, s[44:45]
    v_cndmask_b32 v80, v80, v81, s[44:45]
    v_cndmask_b32 v74, v74, v75, s[44:45]
    v_cndmask_b32 v76, v76, v77, s[44:45]
    v_cndmask_b32 v216, v74, v78, s[46:47]
    v_cndmask_b32 v217, v76, v80, s[48:49]
    v_and_or_b32 v98, v214, v51, v54
    v_and_or_b32 v99, v215, v51, v55
    v_and_or_b32 v100, v216, v51, v56
    v_and_or_b32 v101, v217, v51, v57
    s_sub_u32 s63, s63, 1
    s_cbranch_scc1 C_mr0
C_md0:
    s_cmp_lg_u32 s101, 0
    s_cbranch_scc1 SM_jS0
    s_cmp_eq_u32 s63, 0
    s_cbranch_scc1 SM_sS0
    buffer_store_dwordx4 v[98:101], v4, s[36:39], s15 offen
SM_jS0:
    v_mfma_f32_16x16x32_bf16 v[186:189], v[234:237], v[166:169], 0
    v_mfma_f32_16x16x32_bf16 v[190:193], v[238:241], v[166:169], 0
    ds_read_b32 v45, v5 offset:32
    ds_read_b64_tr_b16 v[170:171], v39 offset:32768
    ds_read_b64_tr_b16 v[172:173], v39 offset:33280
    ds_read_b64_tr_b16 v[174:175], v40 offset:32768
    ds_read_b64_tr_b16 v[176:177], v40 offset:33280
    ds_read_b64_tr_b16 v[202:203], v39 offset:36864
    ds_read_b64_tr_b16 v[204:205], v39 offset:37376
    ds_read_b64_tr_b16 v[206:207], v40 offset:36864
    ds_read_b64_tr_b16 v[208:209], v40 offset:37376
    v_cndmask_b32 v182, v182, v183, s[44:45]
    v_cndmask_b32 v184, v184, v185, s[44:45]
    v_cndmask_b32 v178, v178, v179, s[44:45]
    v_cndmask_b32 v180, v180, v181, s[44:45]
    v_cndmask_b32 v178, v178, v50, s[50:51]
    v_cndmask_b32 v180, v180, v50, s[50:51]
    v_cndmask_b32 v210, v178, v182, s[46:47]
    v_cndmask_b32 v211, v180, v184, s[48:49]
    v_cndmask_b32 v190, v190, v191, s[44:45]
    v_cndmask_b32 v192, v192, v193, s[44:45]
    v_cndmask_b32 v186, v186, v187, s[44:45]
    v_cndmask_b32 v188, v188, v189, s[44:45]
    v_cndmask_b32 v212, v186, v190, s[46:47]
    v_cndmask_b32 v213, v188, v192, s[48:49]
    ds_write_b128 v47, v[210:213]
    ds_write_b32 v52, v5 offset:16
    s_waitcnt lgkmcnt(10)
    v_cmp_gt_u32 vcc, 4, v45
    s_nop 0
    s_cbranch_vccnz C_vr0
C_vd0:
    s_waitcnt lgkmcnt(8)
    v_mfma_f32_16x16x32_bf16 v[106:109], v[130:133], v[170:173], v[106:109]
    ds_read_b128 v[154:157], v35 offset:10240
    ds_read_b64_tr_b16 v[186:187], v39 offset:24576
    s_waitcnt lgkmcnt(6)
    v_mfma_f32_16x16x32_bf16 v[106:109], v[142:145], v[202:205], v[106:109]
    ds_read_b64_tr_b16 v[188:189], v39 offset:25088
    ds_read_b128 v[166:169], v36 offset:10240
    v_mfma_f32_16x16x32_bf16 v[114:117], v[134:137], v[170:173], v[114:117]
    ds_read_b64_tr_b16 v[194:195], v39 offset:28672
    ds_read_b64_tr_b16 v[196:197], v39 offset:29184
    v_mfma_f32_16x16x32_bf16 v[114:117], v[146:149], v[202:205], v[114:117]
    ds_read_b64_tr_b16 v[190:191], v40 offset:24576
    ds_read_b64_tr_b16 v[192:193], v40 offset:25088
    v_mfma_f32_16x16x32_bf16 v[110:113], v[130:133], v[174:177], v[110:113]
    ds_read_b64_tr_b16 v[198:199], v40 offset:28672
    ds_read_b64_tr_b16 v[200:201], v40 offset:29184
    s_waitcnt lgkmcnt(12)
    v_mfma_f32_16x16x32_bf16 v[110:113], v[142:145], v[206:209], v[110:113]
    ds_read_b128 v[158:161], v35 offset:12288
    ds_read_b128 v[178:181], v36 offset:12288
    v_mfma_f32_16x16x32_bf16 v[118:121], v[134:137], v[174:177], v[118:121]
    v_mfma_f32_16x16x32_bf16 v[118:121], v[146:149], v[206:209], v[118:121]
    s_waitcnt lgkmcnt(9)
    v_mfma_f32_16x16x32_bf16 v[106:109], v[154:157], v[186:189], v[106:109]
    s_waitcnt lgkmcnt(6)
    v_mfma_f32_16x16x32_bf16 v[106:109], v[166:169], v[194:197], v[106:109]
    s_waitcnt lgkmcnt(4)
    v_mfma_f32_16x16x32_bf16 v[110:113], v[154:157], v[190:193], v[110:113]
    s_waitcnt lgkmcnt(2)
    v_mfma_f32_16x16x32_bf16 v[110:113], v[166:169], v[198:201], v[110:113]
    s_waitcnt lgkmcnt(1)
    v_mfma_f32_16x16x32_bf16 v[114:117], v[158:161], v[186:189], v[114:117]
    s_nop 1
    v_cvt_pk_bf16_f32 v230, v106, v107
    v_cvt_pk_bf16_f32 v231, v108, v109
    s_waitcnt lgkmcnt(0)
    v_mfma_f32_16x16x32_bf16 v[114:117], v[178:181], v[194:197], v[114:117]
    v_mfma_f32_16x16x32_bf16 v[118:121], v[158:161], v[190:193], v[118:121]
    v_cvt_pk_bf16_f32 v236, v110, v111
    v_cvt_pk_bf16_f32 v237, v112, v113
    v_mfma_f32_16x16x32_bf16 v[118:121], v[178:181], v[198:201], v[118:121]
    ds_read_b32 v53, v225 offset:68
    ds_read_b64 v[234:235], v223 offset:0
    ds_read_b64 v[240:241], v223 offset:8
    v_cndmask_b32 v130, 0, v230, s[58:59]
    v_cndmask_b32 v230, v230, 0, s[58:59]
    v_cndmask_b32 v131, 0, v231, s[58:59]
    v_cndmask_b32 v231, v231, 0, s[58:59]
    buffer_load_dwordx4 v[218:221], v4, s[36:39], s100 offen sc1
    v_cvt_pk_bf16_f32 v232, v114, v115
    v_cvt_pk_bf16_f32 v233, v116, v117
    v_cvt_pk_bf16_f32 v238, v118, v119
    v_cvt_pk_bf16_f32 v239, v120, v121
    v_cndmask_b32 v136, 0, v236, s[60:61]
    v_cndmask_b32 v236, v236, 0, s[60:61]
    v_cndmask_b32 v137, 0, v237, s[60:61]
    v_cndmask_b32 v237, v237, 0, s[60:61]
    v_cndmask_b32 v132, 0, v232, s[58:59]
    v_cndmask_b32 v232, v232, 0, s[58:59]
    v_cndmask_b32 v133, 0, v233, s[58:59]
    v_cndmask_b32 v233, v233, 0, s[58:59]
    v_cndmask_b32 v138, 0, v238, s[60:61]
    v_cndmask_b32 v238, v238, 0, s[60:61]
    v_cndmask_b32 v139, 0, v239, s[60:61]
    v_cndmask_b32 v239, v239, 0, s[60:61]
    s_waitcnt lgkmcnt(0)
    v_cmp_ne_u32 vcc, 0, v53
    s_nop 0
    s_cbranch_vccnz D_dV0
    s_mov_b32 s9, 0
D_lV0:
    ds_read_b32 v53, v225 offset:68
    ds_read_b64 v[234:235], v223 offset:0
    ds_read_b64 v[240:241], v223 offset:8
    s_add_u32 s9, s9, 1
    s_cmp_gt_u32 s9, 1600000
    s_waitcnt lgkmcnt(0)
    s_cbranch_scc1 D_dV0
    v_cmp_eq_u32 vcc, 0, v53
    s_nop 0
    s_cbranch_vccnz D_lV0
D_dV0:
    v_cndmask_b32 v134, 0, v234, s[58:59]
    v_cndmask_b32 v234, v234, 0, s[58:59]
    v_cndmask_b32 v135, 0, v235, s[58:59]
    v_cndmask_b32 v235, v235, 0, s[58:59]
    v_cndmask_b32 v140, 0, v240, s[60:61]
    v_cndmask_b32 v240, v240, 0, s[60:61]
    v_cndmask_b32 v141, 0, v241, s[60:61]
    v_cndmask_b32 v241, v241, 0, s[60:61]
    s_branch C_join
C_tp1:
    s_barrier
    ds_read_b128 v[134:137], v33 offset:2048
    ds_read_b64_tr_b16 v[178:179], v37 offset:8192
    ds_read_b64_tr_b16 v[180:181], v37 offset:8704
    ds_read_b128 v[146:149], v34 offset:2048
    ds_read_b64_tr_b16 v[182:183], v37 offset:12288
    ds_read_b64_tr_b16 v[184:185], v37 offset:12800
    ds_read_b128 v[138:141], v33 offset:4096
    ds_read_b128 v[150:153], v34 offset:4096
    ds_read_b64_tr_b16 v[186:187], v38 offset:8192
    ds_read_b64_tr_b16 v[188:189], v38 offset:8704
    ds_read_b64_tr_b16 v[190:191], v38 offset:12288
    ds_read_b64_tr_b16 v[192:193], v38 offset:12800
    s_waitcnt lgkmcnt(9)
    v_mfma_f32_16x16x32_bf16 v[66:69], v[178:181], v[134:137], 0
    ds_read_b64_tr_b16 v[194:195], v37 offset:16384
    s_waitcnt lgkmcnt(7)
    v_mfma_f32_16x16x32_bf16 v[66:69], v[182:185], v[146:149], v[66:69]
    ds_read_b64_tr_b16 v[196:197], v37 offset:16896
    s_waitcnt lgkmcnt(7)
    v_mfma_f32_16x16x32_bf16 v[74:77], v[178:181], v[138:141], 0
    ds_read_b64_tr_b16 v[198:199], v37 offset:20480
    ds_read_b64_tr_b16 v[200:201], v37 offset:20992
    s_waitcnt lgkmcnt(8)
    v_mfma_f32_16x16x32_bf16 v[74:77], v[182:185], v[150:153], v[74:77]
    ds_read_b64_tr_b16 v[178:179], v38 offset:16384
    s_waitcnt lgkmcnt(7)
    v_mfma_f32_16x16x32_bf16 v[70:73], v[186:189], v[134:137], 0
    ds_read_b64_tr_b16 v[180:181], v38 offset:16896
    s_waitcnt lgkmcnt(6)
    v_mfma_f32_16x16x32_bf16 v[70:73], v[190:193], v[146:149], v[70:73]
    ds_read_b64_tr_b16 v[182:183], v38 offset:20480
    v_mfma_f32_16x16x32_bf16 v[78:81], v[186:189], v[138:141], 0
    ds_read_b64_tr_b16 v[184:185], v38 offset:20992
    v_mfma_f32_16x16x32_bf16 v[78:81], v[190:193], v[150:153], v[78:81]
    ds_read_b128 v[130:133], v33 offset:0
    s_waitcnt lgkmcnt(7)
    v_mfma_f32_16x16x32_bf16 v[90:93], v[194:197], v[134:137], 0
    ds_read_b64_tr_b16 v[186:187], v37 offset:24576
    s_waitcnt lgkmcnt(6)
    v_mfma_f32_16x16x32_bf16 v[90:93], v[198:201], v[146:149], v[90:93]
    ds_read_b64_tr_b16 v[188:189], v37 offset:25088
    v_mfma_f32_16x16x32_bf16 v[98:101], v[194:197], v[138:141], 0
    ds_read_b128 v[142:145], v34 offset:0
    ds_read_b64_tr_b16 v[190:191], v37 offset:28672
    v_mfma_f32_16x16x32_bf16 v[98:101], v[198:201], v[150:153], v[98:101]
    ds_read_b64_tr_b16 v[192:193], v37 offset:29184
    s_waitcnt lgkmcnt(8)
    v_mfma_f32_16x16x32_bf16 v[94:97], v[178:181], v[134:137], 0
    ds_read_b64_tr_b16 v[194:195], v38 offset:24576
    s_waitcnt lgkmcnt(7)
    v_mfma_f32_16x16x32_bf16 v[94:97], v[182:185], v[146:149], v[94:97]
    ds_read_b64_tr_b16 v[196:197], v38 offset:25088
    v_mfma_f32_16x16x32_bf16 v[102:105], v[178:181], v[138:141], 0
    ds_read_b64_tr_b16 v[198:199], v38 offset:28672
    v_mfma_f32_16x16x32_bf16 v[102:105], v[182:185], v[150:153], v[102:105]
    ds_read_b64_tr_b16 v[200:201], v38 offset:29184
    s_waitcnt lgkmcnt(7)
    v_mfma_f32_16x16x32_bf16 v[106:109], v[130:133], v[186:189], 0
    s_waitcnt lgkmcnt(4)
    v_mfma_f32_16x16x32_bf16 v[106:109], v[142:145], v[190:193], v[106:109]
    v_mfma_f32_16x16x32_bf16 v[114:117], v[134:137], v[186:189], 0
    v_mfma_f32_16x16x32_bf16 v[114:117], v[146:149], v[190:193], v[114:117]
    v_mfma_f32_16x16x32_bf16 v[122:125], v[138:141], v[186:189], 0
    v_mfma_f32_16x16x32_bf16 v[122:125], v[150:153], v[190:193], v[122:125]
    s_waitcnt lgkmcnt(2)
    v_mfma_f32_16x16x32_bf16 v[110:113], v[130:133], v[194:197], 0
    s_waitcnt lgkmcnt(0)
    v_mfma_f32_16x16x32_bf16 v[110:113], v[142:145], v[198:201], v[110:113]
    v_mfma_f32_16x16x32_bf16 v[118:121], v[134:137], v[194:197], 0
    s_barrier
    ds_read_b128 v[158:161], v33 offset:12288
    ds_read_b64_tr_b16 v[178:179], v37 offset:32768
    ds_read_b64_tr_b16 v[180:181], v37 offset:33280
    ds_read_b128 v[170:173], v34 offset:12288
    ds_read_b64_tr_b16 v[182:183], v37 offset:36864
    ds_read_b64_tr_b16 v[184:185], v37 offset:37376
    ds_read_b128 v[162:165], v33 offset:14336
    ds_read_b128 v[174:177], v34 offset:14336
    ds_read_b64_tr_b16 v[186:187], v38 offset:32768
    ds_read_b64_tr_b16 v[188:189], v38 offset:33280
    ds_read_b64_tr_b16 v[190:191], v38 offset:36864
    ds_read_b64_tr_b16 v[192:193], v38 offset:37376
    v_mfma_f32_16x16x32_bf16 v[118:121], v[146:149], v[198:201], v[118:121]
    v_mfma_f32_16x16x32_bf16 v[126:129], v[138:141], v[194:197], 0
    ds_read_b64_tr_b16 v[194:195], v37 offset:40960
    v_mfma_f32_16x16x32_bf16 v[126:129], v[150:153], v[198:201], v[126:129]
    ds_read_b64_tr_b16 v[196:197], v37 offset:41472
    s_waitcnt lgkmcnt(11)
    v_mfma_f32_16x16x32_bf16 v[66:69], v[178:181], v[158:161], v[66:69]
    ds_read_b64_tr_b16 v[198:199], v37 offset:45056
    s_waitcnt lgkmcnt(9)
    v_mfma_f32_16x16x32_bf16 v[66:69], v[182:185], v[170:173], v[66:69]
    ds_read_b64_tr_b16 v[200:201], v37 offset:45568
    s_waitcnt lgkmcnt(9)
    v_mfma_f32_16x16x32_bf16 v[74:77], v[178:181], v[162:165], v[74:77]
    ds_read_b64_tr_b16 v[178:179], v38 offset:40960
    s_waitcnt lgkmcnt(9)
    v_mfma_f32_16x16x32_bf16 v[74:77], v[182:185], v[174:177], v[74:77]
    ds_read_b64_tr_b16 v[180:181], v38 offset:41472
    s_waitcnt lgkmcnt(8)
    v_mfma_f32_16x16x32_bf16 v[70:73], v[186:189], v[158:161], v[70:73]
    ds_read_b64_tr_b16 v[182:183], v38 offset:45056
    s_waitcnt lgkmcnt(7)
    v_mfma_f32_16x16x32_bf16 v[70:73], v[190:193], v[170:173], v[70:73]
    ds_read_b64_tr_b16 v[184:185], v38 offset:45568
    v_mfma_f32_16x16x32_bf16 v[78:81], v[186:189], v[162:165], v[78:81]
    ds_read_b128 v[154:157], v33 offset:10240
    v_mfma_f32_16x16x32_bf16 v[78:81], v[190:193], v[174:177], v[78:81]
    ds_read_b64_tr_b16 v[186:187], v39 offset:0
    s_waitcnt lgkmcnt(8)
    v_mfma_f32_16x16x32_bf16 v[90:93], v[194:197], v[158:161], v[90:93]
    ds_read_b64_tr_b16 v[188:189], v39 offset:512
    s_waitcnt lgkmcnt(7)
    v_mfma_f32_16x16x32_bf16 v[90:93], v[198:201], v[170:173], v[90:93]
    ds_read_b128 v[166:169], v34 offset:10240
    v_mfma_f32_16x16x32_bf16 v[98:101], v[194:197], v[162:165], v[98:101]
    ds_read_b64_tr_b16 v[190:191], v39 offset:4096
    ds_read_b64_tr_b16 v[192:193], v39 offset:4608
    v_mfma_f32_16x16x32_bf16 v[98:101], v[198:201], v[174:177], v[98:101]
    ds_read_b64_tr_b16 v[194:195], v40 offset:0
    s_waitcnt lgkmcnt(9)
    v_mfma_f32_16x16x32_bf16 v[94:97], v[178:181], v[158:161], v[94:97]
    ds_read_b64_tr_b16 v[196:197], v40 offset:512
    s_waitcnt lgkmcnt(8)
    v_mfma_f32_16x16x32_bf16 v[94:97], v[182:185], v[170:173], v[94:97]
    ds_read_b64_tr_b16 v[198:199], v40 offset:4096
    v_mfma_f32_16x16x32_bf16 v[102:105], v[178:181], v[162:165], v[102:105]
    ds_read_b64_tr_b16 v[200:201], v40 offset:4608
    v_mfma_f32_16x16x32_bf16 v[102:105], v[182:185], v[174:177], v[102:105]
    s_waitcnt lgkmcnt(7)
    v_mfma_f32_16x16x32_bf16 v[106:109], v[154:157], v[186:189], v[106:109]
    s_waitcnt lgkmcnt(4)
    v_mfma_f32_16x16x32_bf16 v[106:109], v[166:169], v[190:193], v[106:109]
    v_mfma_f32_16x16x32_bf16 v[114:117], v[158:161], v[186:189], v[114:117]
    v_mfma_f32_16x16x32_bf16 v[114:117], v[170:173], v[190:193], v[114:117]
    v_mfma_f32_16x16x32_bf16 v[122:125], v[162:165], v[186:189], v[122:125]
    v_mfma_f32_16x16x32_bf16 v[122:125], v[174:177], v[190:193], v[122:125]
    s_waitcnt lgkmcnt(2)
    v_mfma_f32_16x16x32_bf16 v[110:113], v[154:157], v[194:197], v[110:113]
    s_waitcnt lgkmcnt(0)
    v_mfma_f32_16x16x32_bf16 v[110:113], v[166:169], v[198:201], v[110:113]
    v_mfma_f32_16x16x32_bf16 v[118:121], v[158:161], v[194:197], v[118:121]
    s_barrier
    ds_read_b128 v[134:137], v33 offset:22528
    ds_read_b64_tr_b16 v[178:179], v39 offset:8192
    ds_read_b64_tr_b16 v[180:181], v39 offset:8704
    ds_read_b128 v[146:149], v34 offset:22528
    ds_read_b64_tr_b16 v[182:183], v39 offset:12288
    ds_read_b64_tr_b16 v[184:185], v39 offset:12800
    ds_read_b128 v[138:141], v33 offset:24576
    ds_read_b128 v[150:153], v34 offset:24576
    ds_read_b64_tr_b16 v[186:187], v40 offset:8192
    ds_read_b64_tr_b16 v[188:189], v40 offset:8704
    ds_read_b64_tr_b16 v[190:191], v40 offset:12288
    ds_read_b64_tr_b16 v[192:193], v40 offset:12800
    v_mfma_f32_16x16x32_bf16 v[118:121], v[170:173], v[198:201], v[118:121]
    v_mfma_f32_16x16x32_bf16 v[126:129], v[162:165], v[194:197], v[126:129]
    ds_read_b64_tr_b16 v[194:195], v39 offset:16384
    v_mfma_f32_16x16x32_bf16 v[126:129], v[174:177], v[198:201], v[126:129]
    ds_read_b64_tr_b16 v[196:197], v39 offset:16896
    s_waitcnt lgkmcnt(11)
    v_mfma_f32_16x16x32_bf16 v[66:69], v[178:181], v[134:137], v[66:69]
    ds_read_b64_tr_b16 v[198:199], v39 offset:20480
    s_waitcnt lgkmcnt(9)
    v_mfma_f32_16x16x32_bf16 v[66:69], v[182:185], v[146:149], v[66:69]
    ds_read_b64_tr_b16 v[200:201], v39 offset:20992
    s_waitcnt lgkmcnt(9)
    v_mfma_f32_16x16x32_bf16 v[74:77], v[178:181], v[138:141], v[74:77]
    ds_read_b64_tr_b16 v[178:179], v40 offset:16384
    s_waitcnt lgkmcnt(9)
    v_mfma_f32_16x16x32_bf16 v[74:77], v[182:185], v[150:153], v[74:77]
    ds_read_b64_tr_b16 v[180:181], v40 offset:16896
    s_waitcnt lgkmcnt(8)
    v_mfma_f32_16x16x32_bf16 v[70:73], v[186:189], v[134:137], v[70:73]
    ds_read_b64_tr_b16 v[182:183], v40 offset:20480
    s_waitcnt lgkmcnt(7)
    v_mfma_f32_16x16x32_bf16 v[70:73], v[190:193], v[146:149], v[70:73]
    ds_read_b64_tr_b16 v[184:185], v40 offset:20992
    v_mfma_f32_16x16x32_bf16 v[78:81], v[186:189], v[138:141], v[78:81]
    ds_read_b128 v[130:133], v33 offset:20480
    v_mfma_f32_16x16x32_bf16 v[78:81], v[190:193], v[150:153], v[78:81]
    ds_read_b64_tr_b16 v[186:187], v39 offset:24576
    s_waitcnt lgkmcnt(8)
    v_mfma_f32_16x16x32_bf16 v[90:93], v[194:197], v[134:137], v[90:93]
    ds_read_b64_tr_b16 v[188:189], v39 offset:25088
    s_waitcnt lgkmcnt(7)
    v_mfma_f32_16x16x32_bf16 v[90:93], v[198:201], v[146:149], v[90:93]
    ds_read_b128 v[142:145], v34 offset:20480
    v_mfma_f32_16x16x32_bf16 v[98:101], v[194:197], v[138:141], v[98:101]
    ds_read_b64_tr_b16 v[190:191], v39 offset:28672
    ds_read_b64_tr_b16 v[192:193], v39 offset:29184
    v_mfma_f32_16x16x32_bf16 v[98:101], v[198:201], v[150:153], v[98:101]
    ds_read_b64_tr_b16 v[194:195], v40 offset:24576
    s_waitcnt lgkmcnt(9)
    v_mfma_f32_16x16x32_bf16 v[94:97], v[178:181], v[134:137], v[94:97]
    ds_read_b64_tr_b16 v[196:197], v40 offset:25088
    s_waitcnt lgkmcnt(8)
    v_mfma_f32_16x16x32_bf16 v[94:97], v[182:185], v[146:149], v[94:97]
    ds_read_b64_tr_b16 v[198:199], v40 offset:28672
    v_mfma_f32_16x16x32_bf16 v[102:105], v[178:181], v[138:141], v[102:105]
    ds_read_b64_tr_b16 v[200:201], v40 offset:29184
    v_mfma_f32_16x16x32_bf16 v[102:105], v[182:185], v[150:153], v[102:105]
    s_waitcnt lgkmcnt(7)
    v_mfma_f32_16x16x32_bf16 v[106:109], v[130:133], v[186:189], v[106:109]
    s_waitcnt lgkmcnt(4)
    v_mfma_f32_16x16x32_bf16 v[106:109], v[142:145], v[190:193], v[106:109]
    v_mfma_f32_16x16x32_bf16 v[114:117], v[134:137], v[186:189], v[114:117]
    v_mfma_f32_16x16x32_bf16 v[114:117], v[146:149], v[190:193], v[114:117]
    v_mfma_f32_16x16x32_bf16 v[122:125], v[138:141], v[186:189], v[122:125]
    v_mfma_f32_16x16x32_bf16 v[122:125], v[150:153], v[190:193], v[122:125]
    s_waitcnt lgkmcnt(2)
    v_mfma_f32_16x16x32_bf16 v[110:113], v[130:133], v[194:197], v[110:113]
    s_waitcnt lgkmcnt(0)
    v_mfma_f32_16x16x32_bf16 v[110:113], v[142:145], v[198:201], v[110:113]
    v_mfma_f32_16x16x32_bf16 v[118:121], v[134:137], v[194:197], v[118:121]
    s_barrier
    ds_read_b128 v[158:161], v33 offset:32768
    ds_read_b64_tr_b16 v[178:179], v39 offset:32768
    ds_read_b64_tr_b16 v[180:181], v39 offset:33280
    ds_read_b128 v[170:173], v34 offset:32768
    ds_read_b64_tr_b16 v[182:183], v39 offset:36864
    ds_read_b64_tr_b16 v[184:185], v39 offset:37376
    ds_read_b128 v[162:165], v33 offset:34816
    ds_read_b128 v[174:177], v34 offset:34816
    ds_read_b64_tr_b16 v[186:187], v40 offset:32768
    ds_read_b64_tr_b16 v[188:189], v40 offset:33280
    ds_read_b64_tr_b16 v[190:191], v40 offset:36864
    ds_read_b64_tr_b16 v[192:193], v40 offset:37376
    v_mfma_f32_16x16x32_bf16 v[118:121], v[146:149], v[198:201], v[118:121]
    v_mfma_f32_16x16x32_bf16 v[126:129], v[138:141], v[194:197], v[126:129]
    ds_read_b64_tr_b16 v[194:195], v37 offset:0
    v_mfma_f32_16x16x32_bf16 v[126:129], v[150:153], v[198:201], v[126:129]
    ds_read_b64_tr_b16 v[196:197], v37 offset:512
    s_waitcnt lgkmcnt(11)
    v_mfma_f32_16x16x32_bf16 v[66:69], v[178:181], v[158:161], v[66:69]
    ds_read_b64_tr_b16 v[198:199], v37 offset:4096
    s_waitcnt lgkmcnt(9)
    v_mfma_f32_16x16x32_bf16 v[66:69], v[182:185], v[170:173], v[66:69]
    ds_read_b64_tr_b16 v[200:201], v37 offset:4608
    s_waitcnt lgkmcnt(9)
    v_mfma_f32_16x16x32_bf16 v[74:77], v[178:181], v[162:165], v[74:77]
    ds_read_b64_tr_b16 v[178:179], v38 offset:0
    s_waitcnt lgkmcnt(9)
    v_mfma_f32_16x16x32_bf16 v[74:77], v[182:185], v[174:177], v[74:77]
    ds_read_b64_tr_b16 v[180:181], v38 offset:512
    s_waitcnt lgkmcnt(8)
    v_mfma_f32_16x16x32_bf16 v[70:73], v[186:189], v[158:161], v[70:73]
    ds_read_b64_tr_b16 v[182:183], v38 offset:4096
    s_waitcnt lgkmcnt(7)
    v_mfma_f32_16x16x32_bf16 v[70:73], v[190:193], v[170:173], v[70:73]
    ds_read_b64_tr_b16 v[184:185], v38 offset:4608
    v_mfma_f32_16x16x32_bf16 v[78:81], v[186:189], v[162:165], v[78:81]
    ds_read_b128 v[154:157], v33 offset:30720
    v_mfma_f32_16x16x32_bf16 v[78:81], v[190:193], v[174:177], v[78:81]
    ds_read_b64_tr_b16 v[186:187], v37 offset:8192
    s_waitcnt lgkmcnt(8)
    v_mfma_f32_16x16x32_bf16 v[90:93], v[194:197], v[158:161], v[90:93]
    ds_read_b64_tr_b16 v[188:189], v37 offset:8704
    s_waitcnt lgkmcnt(7)
    v_mfma_f32_16x16x32_bf16 v[90:93], v[198:201], v[170:173], v[90:93]
    ds_read_b128 v[166:169], v34 offset:30720
    v_mfma_f32_16x16x32_bf16 v[98:101], v[194:197], v[162:165], v[98:101]
    ds_read_b64_tr_b16 v[190:191], v37 offset:12288
    ds_read_b64_tr_b16 v[192:193], v37 offset:12800
    v_mfma_f32_16x16x32_bf16 v[98:101], v[198:201], v[174:177], v[98:101]
    ds_read_b64_tr_b16 v[194:195], v38 offset:8192
    s_waitcnt lgkmcnt(9)
    v_mfma_f32_16x16x32_bf16 v[94:97], v[178:181], v[158:161], v[94:97]
    ds_read_b64_tr_b16 v[196:197], v38 offset:8704
    s_waitcnt lgkmcnt(8)
    v_mfma_f32_16x16x32_bf16 v[94:97], v[182:185], v[170:173], v[94:97]
    ds_read_b64_tr_b16 v[198:199], v38 offset:12288
    v_mfma_f32_16x16x32_bf16 v[102:105], v[178:181], v[162:165], v[102:105]
    ds_read_b64_tr_b16 v[200:201], v38 offset:12800
    v_mfma_f32_16x16x32_bf16 v[102:105], v[182:185], v[174:177], v[102:105]
    s_waitcnt lgkmcnt(7)
    v_mfma_f32_16x16x32_bf16 v[106:109], v[154:157], v[186:189], v[106:109]
    s_waitcnt lgkmcnt(4)
    v_mfma_f32_16x16x32_bf16 v[106:109], v[166:169], v[190:193], v[106:109]
    v_mfma_f32_16x16x32_bf16 v[114:117], v[158:161], v[186:189], v[114:117]
    v_mfma_f32_16x16x32_bf16 v[114:117], v[170:173], v[190:193], v[114:117]
    v_mfma_f32_16x16x32_bf16 v[122:125], v[162:165], v[186:189], v[122:125]
    v_mfma_f32_16x16x32_bf16 v[122:125], v[174:177], v[190:193], v[122:125]
    s_waitcnt lgkmcnt(2)
    v_mfma_f32_16x16x32_bf16 v[110:113], v[154:157], v[194:197], v[110:113]
    s_waitcnt lgkmcnt(0)
    v_mfma_f32_16x16x32_bf16 v[110:113], v[166:169], v[198:201], v[110:113]
    v_mfma_f32_16x16x32_bf16 v[118:121], v[158:161], v[194:197], v[118:121]
    s_barrier
    ds_read_b128 v[134:137], v35 offset:2048
    ds_read_b64_tr_b16 v[178:179], v37 offset:16384
    ds_read_b64_tr_b16 v[180:181], v37 offset:16896
    ds_read_b128 v[146:149], v36 offset:2048
    ds_read_b64_tr_b16 v[182:183], v37 offset:20480
    ds_read_b64_tr_b16 v[184:185], v37 offset:20992
    ds_read_b128 v[138:141], v35 offset:4096
    ds_read_b128 v[150:153], v36 offset:4096
    ds_read_b64_tr_b16 v[186:187], v38 offset:16384
    ds_read_b64_tr_b16 v[188:189], v38 offset:16896
    ds_read_b64_tr_b16 v[190:191], v38 offset:20480
    ds_read_b64_tr_b16 v[192:193], v38 offset:20992
    v_mfma_f32_16x16x32_bf16 v[118:121], v[170:173], v[198:201], v[118:121]
    v_mfma_f32_16x16x32_bf16 v[126:129], v[162:165], v[194:197], v[126:129]
    ds_read_b64_tr_b16 v[194:195], v37 offset:24576
    v_mfma_f32_16x16x32_bf16 v[126:129], v[174:177], v[198:201], v[126:129]
    ds_read_b64_tr_b16 v[196:197], v37 offset:25088
    s_waitcnt lgkmcnt(11)
    v_mfma_f32_16x16x32_bf16 v[66:69], v[178:181], v[134:137], v[66:69]
    ds_read_b64_tr_b16 v[198:199], v37 offset:28672
    s_waitcnt lgkmcnt(9)
    v_mfma_f32_16x16x32_bf16 v[66:69], v[182:185], v[146:149], v[66:69]
    ds_read_b64_tr_b16 v[200:201], v37 offset:29184
    s_waitcnt lgkmcnt(9)
    v_mfma_f32_16x16x32_bf16 v[74:77], v[178:181], v[138:141], v[74:77]
    ds_read_b64_tr_b16 v[178:179], v38 offset:24576
    s_waitcnt lgkmcnt(9)
    v_mfma_f32_16x16x32_bf16 v[74:77], v[182:185], v[150:153], v[74:77]
    ds_read_b64_tr_b16 v[180:181], v38 offset:25088
    s_waitcnt lgkmcnt(8)
    v_mfma_f32_16x16x32_bf16 v[70:73], v[186:189], v[134:137], v[70:73]
    ds_read_b64_tr_b16 v[182:183], v38 offset:28672
    s_waitcnt lgkmcnt(7)
    v_mfma_f32_16x16x32_bf16 v[70:73], v[190:193], v[146:149], v[70:73]
    ds_read_b64_tr_b16 v[184:185], v38 offset:29184
    v_mfma_f32_16x16x32_bf16 v[78:81], v[186:189], v[138:141], v[78:81]
    ds_read_b128 v[130:133], v35 offset:0
    v_mfma_f32_16x16x32_bf16 v[78:81], v[190:193], v[150:153], v[78:81]
    ds_read_b64_tr_b16 v[186:187], v37 offset:32768
    s_waitcnt lgkmcnt(8)
    v_mfma_f32_16x16x32_bf16 v[90:93], v[194:197], v[134:137], v[90:93]
    ds_read_b64_tr_b16 v[188:189], v37 offset:33280
    s_waitcnt lgkmcnt(7)
    v_mfma_f32_16x16x32_bf16 v[90:93], v[198:201], v[146:149], v[90:93]
    ds_read_b128 v[142:145], v36 offset:0
    v_mfma_f32_16x16x32_bf16 v[98:101], v[194:197], v[138:141], v[98:101]
    ds_read_b64_tr_b16 v[190:191], v37 offset:36864
    ds_read_b64_tr_b16 v[192:193], v37 offset:37376
    v_mfma_f32_16x16x32_bf16 v[98:101], v[198:201], v[150:153], v[98:101]
    ds_read_b64_tr_b16 v[194:195], v38 offset:32768
    s_waitcnt lgkmcnt(9)
    v_mfma_f32_16x16x32_bf16 v[94:97], v[178:181], v[134:137], v[94:97]
    ds_read_b64_tr_b16 v[196:197], v38 offset:33280
    s_waitcnt lgkmcnt(8)
    v_mfma_f32_16x16x32_bf16 v[94:97], v[182:185], v[146:149], v[94:97]
    ds_read_b64_tr_b16 v[198:199], v38 offset:36864
    v_mfma_f32_16x16x32_bf16 v[102:105], v[178:181], v[138:141], v[102:105]
    ds_read_b64_tr_b16 v[200:201], v38 offset:37376
    v_mfma_f32_16x16x32_bf16 v[102:105], v[182:185], v[150:153], v[102:105]
    s_waitcnt lgkmcnt(7)
    v_mfma_f32_16x16x32_bf16 v[106:109], v[130:133], v[186:189], v[106:109]
    s_waitcnt lgkmcnt(4)
    v_mfma_f32_16x16x32_bf16 v[106:109], v[142:145], v[190:193], v[106:109]
    v_mfma_f32_16x16x32_bf16 v[114:117], v[134:137], v[186:189], v[114:117]
    v_mfma_f32_16x16x32_bf16 v[114:117], v[146:149], v[190:193], v[114:117]
    v_mfma_f32_16x16x32_bf16 v[122:125], v[138:141], v[186:189], v[122:125]
    v_mfma_f32_16x16x32_bf16 v[122:125], v[150:153], v[190:193], v[122:125]
    s_waitcnt lgkmcnt(2)
    v_mfma_f32_16x16x32_bf16 v[110:113], v[130:133], v[194:197], v[110:113]
    s_waitcnt lgkmcnt(0)
    v_mfma_f32_16x16x32_bf16 v[110:113], v[142:145], v[198:201], v[110:113]
    v_mfma_f32_16x16x32_bf16 v[118:121], v[134:137], v[194:197], v[118:121]
    s_barrier
    ds_read_b128 v[158:161], v35 offset:12288
    ds_read_b64_tr_b16 v[178:179], v37 offset:40960
    ds_read_b64_tr_b16 v[180:181], v37 offset:41472
    ds_read_b128 v[170:173], v36 offset:12288
    ds_read_b64_tr_b16 v[182:183], v37 offset:45056
    ds_read_b64_tr_b16 v[184:185], v37 offset:45568
    ds_read_b128 v[162:165], v35 offset:14336
    ds_read_b128 v[174:177], v36 offset:14336
    ds_read_b64_tr_b16 v[186:187], v38 offset:40960
    ds_read_b64_tr_b16 v[188:189], v38 offset:41472
    ds_read_b64_tr_b16 v[190:191], v38 offset:45056
    ds_read_b64_tr_b16 v[192:193], v38 offset:45568
    ds_read_b64_tr_b16 v[202:203], v39 offset:0
    v_mfma_f32_16x16x32_bf16 v[118:121], v[146:149], v[198:201], v[118:121]
    ds_read_b64_tr_b16 v[204:205], v39 offset:512
    v_mfma_f32_16x16x32_bf16 v[126:129], v[138:141], v[194:197], v[126:129]
    ds_read_b64_tr_b16 v[206:207], v39 offset:4096
    v_mfma_f32_16x16x32_bf16 v[126:129], v[150:153], v[198:201], v[126:129]
    ds_read_b64_tr_b16 v[208:209], v39 offset:4608
    s_waitcnt lgkmcnt(13)
    v_mfma_f32_16x16x32_bf16 v[66:69], v[178:181], v[158:161], v[66:69]
    ds_read_b64_tr_b16 v[194:195], v40 offset:0
    s_waitcnt lgkmcnt(11)
    v_mfma_f32_16x16x32_bf16 v[66:69], v[182:185], v[170:173], v[66:69]
    ds_read_b64_tr_b16 v[196:197], v40 offset:512
    s_waitcnt lgkmcnt(11)
    v_mfma_f32_16x16x32_bf16 v[74:77], v[178:181], v[162:165], v[74:77]
    ds_read_b64_tr_b16 v[198:199], v40 offset:4096
    s_waitcnt lgkmcnt(11)
    v_mfma_f32_16x16x32_bf16 v[74:77], v[182:185], v[174:177], v[74:77]
    ds_read_b64_tr_b16 v[200:201], v40 offset:4608
    s_waitcnt lgkmcnt(10)
    v_mfma_f32_16x16x32_bf16 v[70:73], v[186:189], v[158:161], v[70:73]
    s_waitcnt lgkmcnt(8)
    v_mfma_f32_16x16x32_bf16 v[70:73], v[190:193], v[170:173], v[70:73]
    v_mfma_f32_16x16x32_bf16 v[78:81], v[186:189], v[162:165], v[78:81]
    v_mfma_f32_16x16x32_bf16 v[78:81], v[190:193], v[174:177], v[78:81]
    s_waitcnt lgkmcnt(6)
    v_mfma_f32_16x16x32_bf16 v[90:93], v[202:205], v[158:161], v[90:93]
    s_waitcnt lgkmcnt(4)
    v_mfma_f32_16x16x32_bf16 v[90:93], v[206:209], v[170:173], v[90:93]
    v_mfma_f32_16x16x32_bf16 v[98:101], v[202:205], v[162:165], v[98:101]
    v_mfma_f32_16x16x32_bf16 v[98:101], v[206:209], v[174:177], v[98:101]
    s_waitcnt lgkmcnt(2)
    v_mfma_f32_16x16x32_bf16 v[94:97], v[194:197], v[158:161], v[94:97]
    s_waitcnt lgkmcnt(0)
    v_mfma_f32_16x16x32_bf16 v[94:97], v[198:201], v[170:173], v[94:97]
    v_mfma_f32_16x16x32_bf16 v[102:105], v[194:197], v[162:165], v[102:105]
    s_barrier
    ds_read_b128 v[134:137], v35 offset:22528
    ds_read_b64_tr_b16 v[178:179], v39 offset:8192
    ds_read_b64_tr_b16 v[180:181], v39 offset:8704
    ds_read_b128 v[146:149], v36 offset:22528
    ds_read_b64_tr_b16 v[182:183], v39 offset:12288
    ds_read_b64_tr_b16 v[184:185], v39 offset:12800
    ds_read_b128 v[138:141], v35 offset:24576
    ds_read_b128 v[150:153], v36 offset:24576
    ds_read_b64_tr_b16 v[186:187], v40 offset:8192
    ds_read_b64_tr_b16 v[188:189], v40 offset:8704
    ds_read_b64_tr_b16 v[190:191], v40 offset:12288
    ds_read_b64_tr_b16 v[192:193], v40 offset:12800
    ds_read_b128 v[130:133], v35 offset:20480
    v_mfma_f32_16x16x32_bf16 v[102:105], v[198:201], v[174:177], v[102:105]
    ds_read_b128 v[142:145], v36 offset:20480
    s_waitcnt lgkmcnt(11)
    v_mfma_f32_16x16x32_bf16 v[66:69], v[178:181], v[134:137], v[66:69]
    s_barrier
    ds_read_b64_tr_b16 v[202:203], v39 offset:16384
    ds_read_b64_tr_b16 v[204:205], v39 offset:16896
    ds_read_b64_tr_b16 v[206:207], v39 offset:20480
    ds_read_b64_tr_b16 v[208:209], v39 offset:20992
    ds_read_b64_tr_b16 v[194:195], v40 offset:16384
    s_waitcnt lgkmcnt(13)
    v_mfma_f32_16x16x32_bf16 v[66:69], v[182:185], v[146:149], v[66:69]
    ds_read_b64_tr_b16 v[196:197], v40 offset:16896
    s_waitcnt lgkmcnt(13)
    v_mfma_f32_16x16x32_bf16 v[74:77], v[178:181], v[138:141], v[74:77]
    ds_read_b64_tr_b16 v[198:199], v40 offset:20480
    s_waitcnt lgkmcnt(13)
    v_mfma_f32_16x16x32_bf16 v[74:77], v[182:185], v[150:153], v[74:77]
    ds_read_b64_tr_b16 v[200:201], v40 offset:20992
    s_waitcnt lgkmcnt(12)
    v_mfma_f32_16x16x32_bf16 v[70:73], v[186:189], v[134:137], v[70:73]
    v_cvt_pk_bf16_f32 v154, v66, v67
    v_cvt_pk_bf16_f32 v155, v68, v69
    s_waitcnt lgkmcnt(10)
    v_mfma_f32_16x16x32_bf16 v[70:73], v[190:193], v[146:149], v[70:73]
    v_cndmask_b32 v162, 0, v154, s[54:55]
    v_cndmask_b32 v154, v154, 0, s[54:55]
    v_mfma_f32_16x16x32_bf16 v[78:81], v[186:189], v[138:141], v[78:81]
    v_cndmask_b32 v163, 0, v155, s[54:55]
    v_cndmask_b32 v155, v155, 0, s[54:55]
    v_mfma_f32_16x16x32_bf16 v[78:81], v[190:193], v[150:153], v[78:81]
    v_cvt_pk_bf16_f32 v158, v74, v75
    v_cvt_pk_bf16_f32 v159, v76, v77
    s_waitcnt lgkmcnt(6)
    v_mfma_f32_16x16x32_bf16 v[90:93], v[202:205], v[134:137], v[90:93]
    v_cndmask_b32 v166, 0, v158, s[54:55]
    v_cndmask_b32 v158, v158, 0, s[54:55]
    s_waitcnt lgkmcnt(4)
    v_mfma_f32_16x16x32_bf16 v[90:93], v[206:209], v[146:149], v[90:93]
    v_cndmask_b32 v167, 0, v159, s[54:55]
    v_cndmask_b32 v159, v159, 0, s[54:55]
    s_waitcnt lgkmcnt(2)
    v_mfma_f32_16x16x32_bf16 v[94:97], v[194:197], v[134:137], v[94:97]
    v_cvt_pk_bf16_f32 v156, v70, v71
    v_cvt_pk_bf16_f32 v157, v72, v73
    s_waitcnt lgkmcnt(0)
    v_mfma_f32_16x16x32_bf16 v[94:97], v[198:201], v[146:149], v[94:97]
    v_cndmask_b32 v164, 0, v156, s[56:57]
    v_cndmask_b32 v156, v156, 0, s[56:57]
    v_mfma_f32_16x16x32_bf16 v[98:101], v[202:205], v[138:141], v[98:101]
    v_cndmask_b32 v165, 0, v157, s[56:57]
    v_cndmask_b32 v157, v157, 0, s[56:57]
    v_mfma_f32_16x16x32_bf16 v[98:101], v[206:209], v[150:153], v[98:101]
    v_cvt_pk_bf16_f32 v160, v78, v79
    v_cvt_pk_bf16_f32 v161, v80, v81
    v_mfma_f32_16x16x32_bf16 v[102:105], v[194:197], v[138:141], v[102:105]
    v_cndmask_b32 v168, 0, v160, s[56:57]
    v_cndmask_b32 v160, v160, 0, s[56:57]
    v_mfma_f32_16x16x32_bf16 v[102:105], v[198:201], v[150:153], v[102:105]
    ds_read_b32 v45, v5 offset:4
    v_cndmask_b32 v169, 0, v161, s[56:57]
    v_cndmask_b32 v161, v161, 0, s[56:57]
    ds_read_b32 v53, v224 offset:56
    ds_read_b128 v[230:233], v222
    v_cvt_pk_bf16_f32 v234, v90, v91
    v_cvt_pk_bf16_f32 v235, v92, v93
    v_cvt_pk_bf16_f32 v236, v94, v95
    v_cvt_pk_bf16_f32 v237, v96, v97
    s_nop 1
    v_mfma_f32_16x16x32_bf16 v[70:73], v[234:237], v[154:157], 0
    v_mfma_f32_16x16x32_bf16 v[74:77], v[234:237], v[158:161], 0
    v_cvt_pk_bf16_f32 v238, v98, v99
    v_cvt_pk_bf16_f32 v239, v100, v101
    v_cvt_pk_bf16_f32 v240, v102, v103
    v_cvt_pk_bf16_f32 v241, v104, v105
    s_nop 1
    v_mfma_f32_16x16x32_bf16 v[78:81], v[238:241], v[158:161], 0
    v_mfma_f32_16x16x32_bf16 v[182:185], v[234:237], v[162:165], 0
    v_mfma_f32_16x16x32_bf16 v[186:189], v[234:237], v[166:169], 0
    s_waitcnt lgkmcnt(0)
    v_cmp_ne_u32 vcc, 0, v53
    s_nop 0
    s_cbranch_vccnz D_dK
    s_mov_b32 s9, 0
D_lK:
    ds_read_b32 v53, v224 offset:56
    ds_read_b128 v[230:233], v222
    s_add_u32 s9, s9, 1
    s_cmp_gt_u32 s9, 1600000
    s_waitcnt lgkmcnt(0)
    s_cbranch_scc1 D_dK
    v_cmp_eq_u32 vcc, 0, v53
    s_nop 0
    s_cbranch_vccnz D_lK
D_dK:
    v_mfma_f32_16x16x32_bf16 v[66:69], v[230:233], v[154:157], 0
    v_readfirstlane_b32 s63, v45
    v_cndmask_b32 v78, v78, v79, s[44:45]
    v_cndmask_b32 v80, v80, v81, s[44:45]
    v_cndmask_b32 v74, v74, v75, s[44:45]
    v_cndmask_b32 v76, v76, v77, s[44:45]
    v_cndmask_b32 v216, v74, v78, s[46:47]
    v_cndmask_b32 v217, v76, v80, s[48:49]
    v_cndmask_b32 v70, v70, v71, s[44:45]
    v_cndmask_b32 v72, v72, v73, s[44:45]
    v_cndmask_b32 v66, v66, v67, s[44:45]
    v_cndmask_b32 v68, v68, v69, s[44:45]
    v_cndmask_b32 v214, v66, v70, s[46:47]
    v_cndmask_b32 v215, v68, v72, s[48:49]
    v_and_or_b32 v98, v214, v51, v54
    v_and_or_b32 v99, v215, v51, v55
    v_and_or_b32 v100, v216, v51, v56
    v_and_or_b32 v101, v217, v51, v57
    s_sub_u32 s63, s63, 1
    s_cbranch_scc1 C_mr1
C_md1:
    s_cmp_lg_u32 s101, 0
    s_cbranch_scc1 SM_jS1
    s_cmp_eq_u32 s63, 0
    s_cbranch_scc1 SM_sS1
    buffer_store_dwordx4 v[98:101], v4, s[36:39], s15 offen
SM_jS1:
    v_mfma_f32_16x16x32_bf16 v[178:181], v[230:233], v[162:165], 0
    v_mfma_f32_16x16x32_bf16 v[190:193], v[238:241], v[166:169], 0
    ds_read_b32 v45, v5 offset:32
    ds_read_b64_tr_b16 v[170:171], v39 offset:32768
    ds_read_b64_tr_b16 v[172:173], v39 offset:33280
    ds_read_b64_tr_b16 v[174:175], v40 offset:32768
    ds_read_b64_tr_b16 v[176:177], v40 offset:33280
    ds_read_b64_tr_b16 v[202:203], v39 offset:36864
    ds_read_b64_tr_b16 v[204:205], v39 offset:37376
    ds_read_b64_tr_b16 v[206:207], v40 offset:36864
    ds_read_b64_tr_b16 v[208:209], v40 offset:37376
    v_cndmask_b32 v190, v190, v191, s[44:45]
    v_cndmask_b32 v192, v192, v193, s[44:45]
    v_cndmask_b32 v186, v186, v187, s[44:45]
    v_cndmask_b32 v188, v188, v189, s[44:45]
    v_cndmask_b32 v212, v186, v190, s[46:47]
    v_cndmask_b32 v213, v188, v192, s[48:49]
    v_cndmask_b32 v182, v182, v183, s[44:45]
    v_cndmask_b32 v184, v184, v185, s[44:45]
    v_cndmask_b32 v178, v178, v179, s[44:45]
    v_cndmask_b32 v180, v180, v181, s[44:45]
    v_cndmask_b32 v210, v178, v182, s[46:47]
    v_cndmask_b32 v211, v180, v184, s[48:49]
    ds_write_b128 v47, v[210:213]
    ds_write_b32 v52, v5 offset:16
    s_waitcnt lgkmcnt(10)
    v_cmp_gt_u32 vcc, 4, v45
    s_nop 0
    s_cbranch_vccnz C_vr1
C_vd1:
    s_waitcnt lgkmcnt(8)
    v_mfma_f32_16x16x32_bf16 v[106:109], v[130:133], v[170:173], v[106:109]
    ds_read_b128 v[154:157], v35 offset:10240
    s_waitcnt lgkmcnt(5)
    v_mfma_f32_16x16x32_bf16 v[106:109], v[142:145], v[202:205], v[106:109]
    ds_read_b64_tr_b16 v[186:187], v39 offset:24576
    v_mfma_f32_16x16x32_bf16 v[114:117], v[134:137], v[170:173], v[114:117]
    ds_read_b64_tr_b16 v[188:189], v39 offset:25088
    v_mfma_f32_16x16x32_bf16 v[114:117], v[146:149], v[202:205], v[114:117]
    ds_read_b128 v[166:169], v36 offset:10240
    v_mfma_f32_16x16x32_bf16 v[122:125], v[138:141], v[170:173], v[122:125]
    ds_read_b64_tr_b16 v[194:195], v39 offset:28672
    v_mfma_f32_16x16x32_bf16 v[122:125], v[150:153], v[202:205], v[122:125]
    ds_read_b64_tr_b16 v[196:197], v39 offset:29184
    v_mfma_f32_16x16x32_bf16 v[110:113], v[130:133], v[174:177], v[110:113]
    ds_read_b64_tr_b16 v[190:191], v40 offset:24576
    ds_read_b64_tr_b16 v[192:193], v40 offset:25088
    s_waitcnt lgkmcnt(10)
    v_mfma_f32_16x16x32_bf16 v[110:113], v[142:145], v[206:209], v[110:113]
    ds_read_b64_tr_b16 v[198:199], v40 offset:28672
    ds_read_b64_tr_b16 v[200:201], v40 offset:29184
    v_mfma_f32_16x16x32_bf16 v[118:121], v[134:137], v[174:177], v[118:121]
    ds_read_b128 v[158:161], v35 offset:12288
    v_mfma_f32_16x16x32_bf16 v[118:121], v[146:149], v[206:209], v[118:121]
    ds_read_b128 v[178:181], v36 offset:12288
    v_mfma_f32_16x16x32_bf16 v[126:129], v[138:141], v[174:177], v[126:129]
    ds_read_b128 v[162:165], v35 offset:14336
    v_mfma_f32_16x16x32_bf16 v[126:129], v[150:153], v[206:209], v[126:129]
    ds_read_b128 v[182:185], v36 offset:14336
    s_waitcnt lgkmcnt(11)
    v_mfma_f32_16x16x32_bf16 v[106:109], v[154:157], v[186:189], v[106:109]
    s_waitcnt lgkmcnt(8)
    v_mfma_f32_16x16x32_bf16 v[106:109], v[166:169], v[194:197], v[106:109]
    s_waitcnt lgkmcnt(6)
    v_mfma_f32_16x16x32_bf16 v[110:113], v[154:157], v[190:193], v[110:113]
    s_waitcnt lgkmcnt(4)
    v_mfma_f32_16x16x32_bf16 v[110:113], v[166:169], v[198:201], v[110:113]
    s_waitcnt lgkmcnt(3)
    v_mfma_f32_16x16x32_bf16 v[114:117], v[158:161], v[186:189], v[114:117]
    s_nop 1
    v_cvt_pk_bf16_f32 v230, v106, v107
    v_cvt_pk_bf16_f32 v231, v108, v109
    ds_write_b64 v223, v[230:231] offset:0
    s_waitcnt lgkmcnt(3)
    v_mfma_f32_16x16x32_bf16 v[114:117], v[178:181], v[194:197], v[114:117]
    v_mfma_f32_16x16x32_bf16 v[118:121], v[158:161], v[190:193], v[118:121]
    v_cvt_pk_bf16_f32 v236, v110, v111
    v_cvt_pk_bf16_f32 v237, v112, v113
    ds_write_b64 v223, v[236:237] offset:8
    v_mfma_f32_16x16x32_bf16 v[118:121], v[178:181], v[198:201], v[118:121]
    ds_write_b32 v225, v5 offset:68
    s_waitcnt lgkmcnt(4)
    v_mfma_f32_16x16x32_bf16 v[122:125], v[162:165], v[186:189], v[122:125]
    v_cvt_pk_bf16_f32 v232, v114, v115
    v_cvt_pk_bf16_f32 v233, v116, v117
    s_waitcnt lgkmcnt(3)
    v_mfma_f32_16x16x32_bf16 v[122:125], v[182:185], v[194:197], v[122:125]
    v_mfma_f32_16x16x32_bf16 v[126:129], v[162:165], v[190:193], v[126:129]
    v_cvt_pk_bf16_f32 v238, v118, v119
    v_cvt_pk_bf16_f32 v239, v120, v121
    v_mfma_f32_16x16x32_bf16 v[126:129], v[182:185], v[198:201], v[126:129]
    v_cndmask_b32 v130, 0, v230, s[58:59]
    v_cndmask_b32 v230, v230, 0, s[58:59]
    v_cndmask_b32 v131, 0, v231, s[58:59]
    v_cndmask_b32 v231, v231, 0, s[58:59]
    buffer_load_dwordx4 v[218:221], v4, s[36:39], s100 offen sc1
    v_cvt_pk_bf16_f32 v234, v122, v123
    v_cvt_pk_bf16_f32 v235, v124, v125
    s_nop 0
    v_cvt_pk_bf16_f32 v240, v126, v127
    v_cvt_pk_bf16_f32 v241, v128, v129
    v_cndmask_b32 v136, 0, v236, s[60:61]
    v_cndmask_b32 v236, v236, 0, s[60:61]
    v_cndmask_b32 v137, 0, v237, s[60:61]
    v_cndmask_b32 v237, v237, 0, s[60:61]
    v_cndmask_b32 v132, 0, v232, s[58:59]
    v_cndmask_b32 v232, v232, 0, s[58:59]
    v_cndmask_b32 v133, 0, v233, s[58:59]
    v_cndmask_b32 v233, v233, 0, s[58:59]
    v_cndmask_b32 v138, 0, v238, s[60:61]
    v_cndmask_b32 v238, v238, 0, s[60:61]
    v_cndmask_b32 v139, 0, v239, s[60:61]
    v_cndmask_b32 v239, v239, 0, s[60:61]
    v_cndmask_b32 v134, 0, v234, s[58:59]
    v_cndmask_b32 v234, v234, 0, s[58:59]
    v_cndmask_b32 v135, 0, v235, s[58:59]
    v_cndmask_b32 v235, v235, 0, s[58:59]
    v_cndmask_b32 v140, 0, v240, s[60:61]
    v_cndmask_b32 v240, v240, 0, s[60:61]
    v_cndmask_b32 v141, 0, v241, s[60:61]
    v_cndmask_b32 v241, v241, 0, s[60:61]
    s_waitcnt lgkmcnt(0)
C_join:
    v_mov_b32 v12, s0
    v_mov_b32 v13, s0
    v_pk_mul_f32 v[214:215], v[214:215], v[12:13]
    v_pk_mul_f32 v[216:217], v[216:217], v[12:13]
    s_mov_b32 s9, 0
    s_add_u32 s19, s100, 14336
    s_cmp_lg_u32 s101, 0
    s_cbranch_scc1 C_sv
    s_mov_b32 s40, 0x0c0c0400
    s_mov_b32 s41, 0x05040100
    s_waitcnt vmcnt(0)
C_sl:
    v_perm_b32 v2, v219, v218, s40
    v_perm_b32 v3, v221, v220, s40
    v_and_b32 v218, v51, v218
    v_perm_b32 v2, v3, v2, s41
    v_and_b32 v219, v51, v219
    v_cmp_ne_u32 vcc, s12, v2
    v_and_b32 v220, v51, v220
    v_and_b32 v221, v51, v221
    s_cbranch_vccz C_sk
    buffer_load_dwordx4 v[218:221], v4, s[36:39], s100 offen sc1
    s_waitcnt vmcnt(0)
    s_add_u32 s9, s9, 1
    s_cmp_lt_u32 s9, 200000
    s_cbranch_scc1 C_sl
C_sk:
    v_pk_fma_f32 v[214:215], v[218:219], v[12:13], v[214:215]
    v_pk_fma_f32 v[216:217], v[220:221], v[12:13], v[216:217]
C_sv:
    v_max_f32 v226, v214, v215
    v_max_f32 v227, v216, v217
    v_mov_b32 v228, v226
    v_mov_b32 v229, v227
    s_mov_b64 exec, 1
    ds_add_u32 v5, v49 offset:80
    s_mov_b64 exec, -1
    v_permlane16_swap_b32 v226, v228
    v_permlane16_swap_b32 v227, v229
    v_max_f32 v226, v226, v228
    v_max_f32 v227, v227, v229
    v_mov_b32 v228, v226
    v_mov_b32 v229, v227
    s_nop 0
    v_permlane32_swap_b32 v226, v228
    v_permlane32_swap_b32 v227, v229
    v_max_f32 v226, v226, v228
    v_max_f32 v227, v227, v229
    v_sub_f32 v214, v214, v226
    v_sub_f32 v215, v215, v226
    v_sub_f32 v216, v216, v227
    v_sub_f32 v217, v217, v227
    v_exp_f32 v214, v214
    v_exp_f32 v215, v215
    v_exp_f32 v216, v216
    v_exp_f32 v217, v217
    v_add_f32 v226, v214, v215
    v_add_f32 v227, v216, v217
    v_mov_b32 v228, v226
    v_mov_b32 v229, v227
    ds_read_b32 v53, v52 offset:40
    ds_read_b128 v[82:85], v48 offset:12288
    ds_read_b128 v[86:89], v48 offset:13312
    ds_read_b32 v7, v5 offset:12
    v_permlane16_swap_b32 v226, v228
    v_permlane16_swap_b32 v227, v229
    v_add_f32 v226, v226, v228
    v_add_f32 v227, v227, v229
    v_mov_b32 v228, v226
    v_mov_b32 v229, v227
    s_nop 0
    v_permlane32_swap_b32 v226, v228
    v_permlane32_swap_b32 v227, v229
    v_add_f32 v226, v226, v228
    v_add_f32 v227, v227, v229
    v_rcp_f32 v226, v226
    v_rcp_f32 v227, v227
    s_waitcnt lgkmcnt(0)
    v_cmp_eq_u32 vcc, 0, v53
    v_mul_f32 v214, v214, v226
    v_mul_f32 v215, v215, v226
    v_mul_f32 v216, v216, v227
    v_mul_f32 v217, v217, v227
    v_cvt_pk_bf16_f32 v214, v214, v214
    v_cvt_pk_bf16_f32 v215, v215, v215
    v_cvt_pk_bf16_f32 v216, v216, v216
    v_cvt_pk_bf16_f32 v217, v217, v217
    s_cbranch_vccnz C_pr
C_pd:
    v_mfma_f32_16x16x32_bf16 v[66:69], v[130:133], v[82:85], 0
    v_and_b32 v90, v41, v214
    v_and_b32 v91, v42, v215
    v_mfma_f32_16x16x32_bf16 v[70:73], v[136:139], v[82:85], 0
    v_and_b32 v92, v43, v214
    v_and_b32 v93, v44, v215
    v_mfma_f32_16x16x32_bf16 v[74:77], v[132:135], v[86:89], 0
    v_and_b32 v94, v41, v216
    v_and_b32 v95, v42, v217
    v_mfma_f32_16x16x32_bf16 v[78:81], v[138:141], v[86:89], 0
    v_and_b32 v96, v43, v216
    v_and_b32 v97, v44, v217
    v_mfma_f32_16x16x32_bf16 v[66:69], v[230:233], v[90:93], v[66:69]
    v_mfma_f32_16x16x32_bf16 v[70:73], v[236:239], v[90:93], v[70:73]
    v_mfma_f32_16x16x32_bf16 v[74:77], v[232:235], v[94:97], v[74:77]
    v_mfma_f32_16x16x32_bf16 v[78:81], v[238:241], v[94:97], v[78:81]
    s_cmp_eq_u32 s63, 0
    s_cbranch_scc1 SM_sO
    s_nop 2
    v_cvt_pk_bf16_f32 v58, v66, v67
    v_cvt_pk_bf16_f32 v59, v68, v69
    v_cvt_pk_bf16_f32 v60, v70, v71
    v_cvt_pk_bf16_f32 v61, v72, v73
    buffer_store_dwordx4 v[58:61], v4, s[36:39], s100 offen nt
    v_cvt_pk_bf16_f32 v62, v74, v75
    v_cvt_pk_bf16_f32 v63, v76, v77
    v_cvt_pk_bf16_f32 v64, v78, v79
    v_cvt_pk_bf16_f32 v65, v80, v81
    buffer_store_dwordx4 v[62:65], v4, s[36:39], s19 offen nt
SM_jO:
    ds_write_b128 v18, v[58:61] offset:20480
    ds_write_b128 v18, v[62:65] offset:22528
    ds_write_b32 v52, v5 offset:96
    v_cmp_gt_u32 vcc, 4, v7
    s_nop 0
    s_cbranch_vccz W_dW
    s_mov_b32 s9, 0
W_lW:
    ds_read_b32 v2, v5 offset:12
    s_add_u32 s9, s9, 1
    s_cmp_gt_u32 s9, 1600000
    s_cbranch_scc1 W_dW
    s_waitcnt lgkmcnt(0)
    v_cmp_gt_u32 vcc, 4, v2
    s_nop 0
    s_cbranch_vccnz W_lW
W_dW:
    ds_read_b64_tr_b16 v[82:83], v21 offset:0
    ds_read_b64_tr_b16 v[84:85], v21 offset:2048
    ds_read_b64_tr_b16 v[86:87], v22 offset:0
    ds_read_b64_tr_b16 v[88:89], v22 offset:2048
    ds_read_b64_tr_b16 v[90:91], v23 offset:0
    ds_read_b64_tr_b16 v[92:93], v23 offset:2048
    ds_read_b64_tr_b16 v[94:95], v24 offset:0
    ds_read_b64_tr_b16 v[96:97], v24 offset:2048
    ds_read_b64_tr_b16 v[98:99], v21 offset:4096
    ds_read_b64_tr_b16 v[100:101], v21 offset:6144
    ds_read_b64_tr_b16 v[102:103], v22 offset:4096
    ds_read_b64_tr_b16 v[104:105], v22 offset:6144
    ds_read_b64_tr_b16 v[106:107], v23 offset:4096
    ds_read_b64_tr_b16 v[108:109], v23 offset:6144
    ds_read_b64_tr_b16 v[110:111], v24 offset:4096
    ds_read_b64_tr_b16 v[112:113], v24 offset:6144
    s_waitcnt vmcnt(0)
    s_mov_b64 exec, 1
    s_cmp_eq_u32 s63, 0
    s_cbranch_scc1 SM_sF
    buffer_store_dwordx2 v[14:15], v6, s[36:39], s21 offen
SM_jF:
    s_mov_b64 exec, -1
    ds_read_b64_tr_b16 v[114:115], v21 offset:8192
    ds_read_b64_tr_b16 v[116:117], v21 offset:10240
    ds_read_b64_tr_b16 v[118:119], v22 offset:8192
    ds_read_b64_tr_b16 v[120:121], v22 offset:10240
    ds_read_b64_tr_b16 v[122:123], v23 offset:8192
    ds_read_b64_tr_b16 v[124:125], v23 offset:10240
    ds_read_b64_tr_b16 v[126:127], v24 offset:8192
    ds_read_b64_tr_b16 v[128:129], v24 offset:10240
    ds_read_b64_tr_b16 v[130:131], v21 offset:12288
    ds_read_b64_tr_b16 v[132:133], v21 offset:14336
    ds_read_b64_tr_b16 v[134:135], v22 offset:12288
    ds_read_b64_tr_b16 v[136:137], v22 offset:14336
    ds_read_b64_tr_b16 v[138:139], v23 offset:12288
    ds_read_b64_tr_b16 v[140:141], v23 offset:14336
    ds_read_b64_tr_b16 v[142:143], v24 offset:12288
    ds_read_b64_tr_b16 v[144:145], v24 offset:14336
    ds_read_b64_tr_b16 v[146:147], v21 offset:16384
    ds_read_b64_tr_b16 v[148:149], v21 offset:18432
    ds_read_b64_tr_b16 v[150:151], v22 offset:16384
    ds_read_b64_tr_b16 v[152:153], v22 offset:18432
    ds_read_b64_tr_b16 v[154:155], v23 offset:16384
    ds_read_b64_tr_b16 v[156:157], v23 offset:18432
    ds_read_b64_tr_b16 v[158:159], v24 offset:16384
    ds_read_b64_tr_b16 v[160:161], v24 offset:18432
    s_waitcnt lgkmcnt(0)
    s_mov_b32 s9, 0
C_wl:
    ds_read_b64 v[16:17], v20 offset:96
    ds_read_b128 v[46:49], v19 offset:20480
    ds_read_b128 v[50:53], v19 offset:21504
    s_add_u32 s9, s9, 1
    s_cmp_gt_u32 s9, 1600000
    s_cbranch_scc1 C_wd
    s_waitcnt lgkmcnt(2)
    v_and_b32 v16, v16, v17
    v_cmp_eq_u32 vcc, 0, v16
    s_waitcnt lgkmcnt(0)
    s_cbranch_vccnz C_wl
C_wd:
    s_waitcnt lgkmcnt(0)
    v_mfma_f32_16x16x32_bf16 v[30:33], v[82:85], v[46:49], 0
    ds_read_b64_tr_b16 v[162:163], v21 offset:20480
    v_mfma_f32_16x16x32_bf16 v[30:33], v[98:101], v[50:53], v[30:33]
    ds_read_b64_tr_b16 v[164:165], v21 offset:22528
    v_mfma_f32_16x16x32_bf16 v[34:37], v[86:89], v[46:49], 0
    ds_read_b64_tr_b16 v[166:167], v22 offset:20480
    v_mfma_f32_16x16x32_bf16 v[34:37], v[102:105], v[50:53], v[34:37]
    ds_read_b64_tr_b16 v[168:169], v22 offset:22528
    v_mfma_f32_16x16x32_bf16 v[38:41], v[90:93], v[46:49], 0
    ds_read_b64_tr_b16 v[170:171], v23 offset:20480
    v_mfma_f32_16x16x32_bf16 v[38:41], v[106:109], v[50:53], v[38:41]
    ds_read_b64_tr_b16 v[172:173], v23 offset:22528
    v_mfma_f32_16x16x32_bf16 v[42:45], v[94:97], v[46:49], 0
    ds_read_b64_tr_b16 v[174:175], v24 offset:20480
    v_mfma_f32_16x16x32_bf16 v[42:45], v[110:113], v[50:53], v[42:45]
    ds_read_b64_tr_b16 v[176:177], v24 offset:22528
    ds_read_b64_tr_b16 v[178:179], v21 offset:24576
    ds_read_b64_tr_b16 v[180:181], v21 offset:26624
    ds_read_b64_tr_b16 v[182:183], v22 offset:24576
    ds_read_b64_tr_b16 v[184:185], v22 offset:26624
    ds_read_b64_tr_b16 v[186:187], v23 offset:24576
    ds_read_b64_tr_b16 v[188:189], v23 offset:26624
    ds_read_b64_tr_b16 v[190:191], v24 offset:24576
    ds_read_b64_tr_b16 v[192:193], v24 offset:26624
    buffer_load_dwordx2 v[12:13], v8, s[36:39], s20 offen sc1
    ds_read_b64_tr_b16 v[194:195], v21 offset:28672
    ds_read_b64_tr_b16 v[196:197], v21 offset:30720
    ds_read_b64_tr_b16 v[198:199], v22 offset:28672
    ds_read_b64_tr_b16 v[200:201], v22 offset:30720
    ds_read_b64_tr_b16 v[202:203], v23 offset:28672
    ds_read_b64_tr_b16 v[204:205], v23 offset:30720
    ds_read_b64_tr_b16 v[206:207], v24 offset:28672
    ds_read_b64_tr_b16 v[208:209], v24 offset:30720
    ds_read_b64_tr_b16 v[210:211], v21 offset:32768
    ds_read_b64_tr_b16 v[212:213], v21 offset:34816
    ds_read_b64_tr_b16 v[214:215], v22 offset:32768
    ds_read_b64_tr_b16 v[216:217], v22 offset:34816
    ds_read_b64_tr_b16 v[218:219], v23 offset:32768
    ds_read_b64_tr_b16 v[220:221], v23 offset:34816
    ds_read_b64_tr_b16 v[222:223], v24 offset:32768
    ds_read_b64_tr_b16 v[224:225], v24 offset:34816
    ds_read_b64_tr_b16 v[226:227], v21 offset:36864
    ds_read_b64_tr_b16 v[228:229], v21 offset:38912
    ds_read_b64_tr_b16 v[230:231], v22 offset:36864
    ds_read_b64_tr_b16 v[232:233], v22 offset:38912
    ds_read_b64_tr_b16 v[234:235], v23 offset:36864
    ds_read_b64_tr_b16 v[236:237], v23 offset:38912
    ds_read_b64_tr_b16 v[238:239], v24 offset:36864
    ds_read_b64_tr_b16 v[240:241], v24 offset:38912
    s_mov_b32 s9, 0
P_lO:
    s_waitcnt vmcnt(0)
    v_cmp_ne_u64 vcc, s[12:13], v[12:13]
    s_nop 0
    s_cbranch_vccz P_dO
    buffer_load_dwordx2 v[12:13], v8, s[36:39], s20 offen sc1
    s_add_u32 s9, s9, 1
    s_cmp_lt_u32 s9, 200000
    s_cbranch_scc1 P_lO
    s_waitcnt vmcnt(0)
P_dO:
    buffer_load_dwordx4 v[54:57], v4, s[36:39], s1 offen offset:0 sc1
    buffer_load_dwordx4 v[58:61], v4, s[36:39], s1 offen offset:1024 sc1
    buffer_load_dwordx4 v[62:65], v4, s[36:39], s4 offen offset:0 sc1
    buffer_load_dwordx4 v[66:69], v4, s[36:39], s4 offen offset:1024 sc1
    buffer_load_dwordx4 v[70:73], v4, s[36:39], s6 offen offset:0 sc1
C_go:
    s_waitcnt lgkmcnt(0)
    s_mov_b32 s9, 0
W_lW2:
    ds_read_b32 v2, v5 offset:36
    s_add_u32 s9, s9, 1
    s_cmp_gt_u32 s9, 1600000
    s_cbranch_scc1 W_dW2
    s_waitcnt lgkmcnt(0)
    v_cmp_gt_u32 vcc, 4, v2
    s_nop 0
    s_cbranch_vccnz W_lW2
W_dW2:
    ds_read_b64_tr_b16 v[82:83], v21 offset:40960
    ds_read_b64_tr_b16 v[84:85], v21 offset:43008
    ds_read_b64_tr_b16 v[86:87], v22 offset:40960
    ds_read_b64_tr_b16 v[88:89], v22 offset:43008
    ds_read_b64_tr_b16 v[90:91], v23 offset:40960
    ds_read_b64_tr_b16 v[92:93], v23 offset:43008
    ds_read_b64_tr_b16 v[94:95], v24 offset:40960
    ds_read_b64_tr_b16 v[96:97], v24 offset:43008
    s_waitcnt vmcnt(4)
    v_mfma_f32_16x16x32_bf16 v[30:33], v[114:117], v[54:57], v[30:33]
    buffer_load_dwordx4 v[74:77], v4, s[36:39], s6 offen offset:1024 sc1
    v_mfma_f32_16x16x32_bf16 v[34:37], v[118:121], v[54:57], v[34:37]
    ds_read_b64_tr_b16 v[98:99], v21 offset:45056
    v_mfma_f32_16x16x32_bf16 v[38:41], v[122:125], v[54:57], v[38:41]
    ds_read_b64_tr_b16 v[100:101], v21 offset:47104
    v_mfma_f32_16x16x32_bf16 v[42:45], v[126:129], v[54:57], v[42:45]
    ds_read_b64_tr_b16 v[102:103], v22 offset:45056
    s_waitcnt vmcnt(4)
    v_mfma_f32_16x16x32_bf16 v[30:33], v[130:133], v[58:61], v[30:33]
    buffer_load_dwordx4 v[78:81], v4, s[36:39], s24 offen offset:0 sc1
    v_mfma_f32_16x16x32_bf16 v[34:37], v[134:137], v[58:61], v[34:37]
    ds_read_b64_tr_b16 v[104:105], v22 offset:47104
    v_mfma_f32_16x16x32_bf16 v[38:41], v[138:141], v[58:61], v[38:41]
    ds_read_b64_tr_b16 v[106:107], v23 offset:45056
    v_mfma_f32_16x16x32_bf16 v[42:45], v[142:145], v[58:61], v[42:45]
    ds_read_b64_tr_b16 v[108:109], v23 offset:47104
    s_waitcnt vmcnt(4)
    v_mfma_f32_16x16x32_bf16 v[30:33], v[146:149], v[62:65], v[30:33]
    buffer_load_dwordx4 v[46:49], v4, s[36:39], s24 offen offset:1024 sc1
    v_mfma_f32_16x16x32_bf16 v[34:37], v[150:153], v[62:65], v[34:37]
    ds_read_b64_tr_b16 v[110:111], v24 offset:45056
    v_mfma_f32_16x16x32_bf16 v[38:41], v[154:157], v[62:65], v[38:41]
    ds_read_b64_tr_b16 v[112:113], v24 offset:47104
    v_mfma_f32_16x16x32_bf16 v[42:45], v[158:161], v[62:65], v[42:45]
    ds_read_b64_tr_b16 v[114:115], v21 offset:49152
    s_waitcnt vmcnt(4)
    v_mfma_f32_16x16x32_bf16 v[30:33], v[162:165], v[66:69], v[30:33]
    buffer_load_dwordx4 v[50:53], v4, s[36:39], s25 offen offset:0 sc1
    v_mfma_f32_16x16x32_bf16 v[34:37], v[166:169], v[66:69], v[34:37]
    ds_read_b64_tr_b16 v[116:117], v21 offset:51200
    v_mfma_f32_16x16x32_bf16 v[38:41], v[170:173], v[66:69], v[38:41]
    ds_read_b64_tr_b16 v[118:119], v22 offset:49152
    v_mfma_f32_16x16x32_bf16 v[42:45], v[174:177], v[66:69], v[42:45]
    ds_read_b64_tr_b16 v[120:121], v22 offset:51200
    s_waitcnt vmcnt(4)
    v_mfma_f32_16x16x32_bf16 v[30:33], v[178:181], v[70:73], v[30:33]
    buffer_load_dwordx4 v[54:57], v4, s[36:39], s25 offen offset:1024 sc1
    v_mfma_f32_16x16x32_bf16 v[34:37], v[182:185], v[70:73], v[34:37]
    ds_read_b64_tr_b16 v[122:123], v23 offset:49152
    v_mfma_f32_16x16x32_bf16 v[38:41], v[186:189], v[70:73], v[38:41]
    ds_read_b64_tr_b16 v[124:125], v23 offset:51200
    v_mfma_f32_16x16x32_bf16 v[42:45], v[190:193], v[70:73], v[42:45]
    ds_read_b64_tr_b16 v[126:127], v24 offset:49152
    s_waitcnt vmcnt(4)
    v_mfma_f32_16x16x32_bf16 v[30:33], v[194:197], v[74:77], v[30:33]
    buffer_load_dwordx4 v[58:61], v4, s[36:39], s26 offen offset:0 sc1
    v_mfma_f32_16x16x32_bf16 v[34:37], v[198:201], v[74:77], v[34:37]
    ds_read_b64_tr_b16 v[128:129], v24 offset:51200
    v_mfma_f32_16x16x32_bf16 v[38:41], v[202:205], v[74:77], v[38:41]
    ds_read_b64_tr_b16 v[130:131], v21 offset:53248
    v_mfma_f32_16x16x32_bf16 v[42:45], v[206:209], v[74:77], v[42:45]
    ds_read_b64_tr_b16 v[132:133], v21 offset:55296
    s_waitcnt vmcnt(4)
    v_mfma_f32_16x16x32_bf16 v[30:33], v[210:213], v[78:81], v[30:33]
    buffer_load_dwordx4 v[62:65], v4, s[36:39], s26 offen offset:1024 sc1
    v_mfma_f32_16x16x32_bf16 v[34:37], v[214:217], v[78:81], v[34:37]
    ds_read_b64_tr_b16 v[134:135], v22 offset:53248
    v_mfma_f32_16x16x32_bf16 v[38:41], v[218:221], v[78:81], v[38:41]
    ds_read_b64_tr_b16 v[136:137], v22 offset:55296
    v_mfma_f32_16x16x32_bf16 v[42:45], v[222:225], v[78:81], v[42:45]
    ds_read_b64_tr_b16 v[138:139], v23 offset:53248
    s_waitcnt vmcnt(4)
    v_mfma_f32_16x16x32_bf16 v[30:33], v[226:229], v[46:49], v[30:33]
    ds_read_b64_tr_b16 v[140:141], v23 offset:55296
    v_mfma_f32_16x16x32_bf16 v[34:37], v[230:233], v[46:49], v[34:37]
    ds_read_b64_tr_b16 v[142:143], v24 offset:53248
    v_mfma_f32_16x16x32_bf16 v[38:41], v[234:237], v[46:49], v[38:41]
    ds_read_b64_tr_b16 v[144:145], v24 offset:55296
    v_mfma_f32_16x16x32_bf16 v[42:45], v[238:241], v[46:49], v[42:45]
    s_waitcnt vmcnt(3)
    s_waitcnt lgkmcnt(15)
    v_mfma_f32_16x16x32_bf16 v[30:33], v[82:85], v[50:53], v[30:33]
    v_mfma_f32_16x16x32_bf16 v[34:37], v[86:89], v[50:53], v[34:37]
    v_mfma_f32_16x16x32_bf16 v[38:41], v[90:93], v[50:53], v[38:41]
    v_mfma_f32_16x16x32_bf16 v[42:45], v[94:97], v[50:53], v[42:45]
    s_waitcnt vmcnt(2)
    v_mfma_f32_16x16x32_bf16 v[30:33], v[98:101], v[54:57], v[30:33]
    v_mfma_f32_16x16x32_bf16 v[34:37], v[102:105], v[54:57], v[34:37]
    v_mfma_f32_16x16x32_bf16 v[38:41], v[106:109], v[54:57], v[38:41]
    v_mfma_f32_16x16x32_bf16 v[42:45], v[110:113], v[54:57], v[42:45]
    s_waitcnt vmcnt(1)
    s_waitcnt lgkmcnt(14)
    v_mfma_f32_16x16x32_bf16 v[30:33], v[114:117], v[58:61], v[30:33]
    s_waitcnt lgkmcnt(12)
    v_mfma_f32_16x16x32_bf16 v[34:37], v[118:121], v[58:61], v[34:37]
    s_waitcnt lgkmcnt(10)
    v_mfma_f32_16x16x32_bf16 v[38:41], v[122:125], v[58:61], v[38:41]
    s_waitcnt lgkmcnt(8)
    v_mfma_f32_16x16x32_bf16 v[42:45], v[126:129], v[58:61], v[42:45]
    s_waitcnt vmcnt(0)
    s_waitcnt lgkmcnt(6)
    v_mfma_f32_16x16x32_bf16 v[30:33], v[130:133], v[62:65], v[30:33]
    s_waitcnt lgkmcnt(4)
    v_mfma_f32_16x16x32_bf16 v[34:37], v[134:137], v[62:65], v[34:37]
    s_waitcnt lgkmcnt(2)
    v_mfma_f32_16x16x32_bf16 v[38:41], v[138:141], v[62:65], v[38:41]
    s_waitcnt lgkmcnt(0)
    v_mfma_f32_16x16x32_bf16 v[42:45], v[142:145], v[62:65], v[42:45]
    s_nop 1
    v_cvt_pk_bf16_f32 v162, v30, v31
    v_cvt_pk_bf16_f32 v163, v32, v33
    ds_write_b64 v25, v[162:163]
    v_cvt_pk_bf16_f32 v164, v34, v35
    v_cvt_pk_bf16_f32 v165, v36, v37
    ds_write_b64 v26, v[164:165]
    v_cvt_pk_bf16_f32 v166, v38, v39
    v_cvt_pk_bf16_f32 v167, v40, v41
    ds_write_b64 v27, v[166:167]
    v_cvt_pk_bf16_f32 v168, v42, v43
    v_cvt_pk_bf16_f32 v169, v44, v45
    ds_write_b64 v28, v[168:169]
    ds_read_b128 v[178:181], v9
    ds_read_b128 v[182:185], v9 offset:1024
    s_waitcnt lgkmcnt(1)
    buffer_store_dwordx4 v[178:181], v10, s[32:35], s23 offen nt
    s_waitcnt lgkmcnt(0)
    buffer_store_dwordx4 v[182:185], v10, s[32:35], s28 offen nt
    s_add_u32 s40, s7, s62
    s_cmp_lg_u32 s40, 0
    s_cbranch_scc1 C_end
    s_add_u32 s40, s10, 16
    v_mov_b32 v2, s40
    s_lshl_b32 s40, s8, 7
    s_mov_b64 exec, 1
    buffer_store_dword v2, v6, s[36:39], s40 offen
C_end:
    s_endpgm
K_cold:
X_cH:
    s_mov_b32 s9, 0
X_lH:
    v_cmp_ne_u64 vcc, s[28:29], v[18:19]
    s_nop 0
    s_cbranch_vccz X_okH
    v_subrev_u32 v18, s12, v18
    v_cmp_ne_u32 s[42:43], s13, v19
    v_cmp_le_u32 vcc, 8, v18
    s_nop 0
    s_or_b64 vcc, vcc, s[42:43]
    s_cbranch_vccz X_nH
    buffer_load_dwordx2 v[18:19], v20, s[36:39], s30 offen sc1
    s_add_u32 s9, s9, 1
    s_cmp_lt_u32 s9, 200000
    s_waitcnt vmcnt(0)
    s_cbranch_scc1 X_lH
X_nH:
    s_mov_b32 s101, 0
    s_branch X_okH
S_cls0:
    v_cmp_eq_u32 s[42:43], 0, v3
    v_cvt_pk_bf16_f32 v28, v102, 0
    v_cvt_pk_bf16_f32 v36, -v106, 0
    v_cndmask_b32 v103, v103, 0, s[42:43]
    v_cndmask_b32 v107, v107, -1.0, s[42:43]
    v_cvt_pk_bf16_f32 v29, v103, 0
    v_cvt_pk_bf16_f32 v37, -v107, 0
    v_cvt_pk_bf16_f32 v30, v104, 0
    v_cvt_pk_bf16_f32 v38, -v108, 0
    v_cndmask_b32 v105, v105, 0, s[42:43]
    v_cndmask_b32 v109, v109, -1.0, s[42:43]
    v_cvt_pk_bf16_f32 v31, v105, 0
    v_cvt_pk_bf16_f32 v39, -v109, 0
    v_cvt_pk_bf16_f32 v32, v110, 0
    v_cvt_pk_bf16_f32 v40, -v114, 0
    v_cndmask_b32 v111, v111, 0, s[42:43]
    v_cndmask_b32 v115, v115, -1.0, s[42:43]
    v_cvt_pk_bf16_f32 v33, v111, 0
    v_cvt_pk_bf16_f32 v41, -v115, 0
    v_cvt_pk_bf16_f32 v34, v112, 0
    v_cvt_pk_bf16_f32 v42, -v116, 0
    v_cndmask_b32 v113, v113, 0, s[42:43]
    v_cndmask_b32 v117, v117, -1.0, s[42:43]
    v_cvt_pk_bf16_f32 v35, v113, 0
    v_cvt_pk_bf16_f32 v43, -v117, 0
    v_lshl_add_u32 v4, v3, 6, 32
    v_cvt_f32_u32 v96, v4
    v_mul_f32 v96, 0x3a000000, v96
    v_lshlrev_b32 v4, 2, v2
    v_cvt_f32_u32 v4, v4
    v_mul_f32 v97, v96, v4
    v_cos_f32 v118, v96
    s_nop 0
    v_add_f32 v118, v118, v118
    v_fmamk_f32 v102, v96, 0x0, v97
    v_fmamk_f32 v103, v96, 0x3f800000, v97
    v_fmamk_f32 v106, v96, 0x0, v97
    v_fmamk_f32 v107, v96, 0x3f800000, v97
    v_fmamk_f32 v110, v96, 0x41800000, v97
    v_fmamk_f32 v111, v96, 0x41880000, v97
    v_fmamk_f32 v114, v96, 0x41800000, v97
    v_fmamk_f32 v115, v96, 0x41880000, v97
    v_cos_f32 v102, v102
    v_cos_f32 v103, v103
    v_sin_f32 v106, v106
    v_sin_f32 v107, v107
    v_cos_f32 v110, v110
    v_cos_f32 v111, v111
    v_sin_f32 v114, v114
    v_sin_f32 v115, v115
    v_fma_f32 v104, v118, v103, -v102
    v_fma_f32 v108, v118, v107, -v106
    v_fma_f32 v112, v118, v111, -v110
    v_fma_f32 v116, v118, v115, -v114
    v_fma_f32 v105, v118, v104, -v103
    v_fma_f32 v109, v118, v108, -v107
    v_fma_f32 v113, v118, v112, -v111
    v_fma_f32 v117, v118, v116, -v115
    v_cvt_pk_bf16_f32 v44, 0, v102
    v_cvt_pk_bf16_f32 v52, 0, -v106
    v_cvt_pk_bf16_f32 v45, 0, v103
    v_cvt_pk_bf16_f32 v53, 0, -v107
    v_cvt_pk_bf16_f32 v46, 0, v104
    v_cvt_pk_bf16_f32 v54, 0, -v108
    v_cvt_pk_bf16_f32 v47, 0, v105
    v_cvt_pk_bf16_f32 v55, 0, -v109
    v_cvt_pk_bf16_f32 v48, 0, v110
    v_cvt_pk_bf16_f32 v56, 0, -v114
    v_cvt_pk_bf16_f32 v49, 0, v111
    v_cvt_pk_bf16_f32 v57, 0, -v115
    v_cvt_pk_bf16_f32 v50, 0, v112
    v_cvt_pk_bf16_f32 v58, 0, -v116
    v_cvt_pk_bf16_f32 v51, 0, v113
    v_cvt_pk_bf16_f32 v59, 0, -v117
    s_branch S_reg
S_gr:
    s_add_u32 s9, s9, 1
    s_cmp_gt_u32 s9, 200000
    s_cbranch_scc1 S_gk
    buffer_load_dwordx4 v60, s[36:39], s60 offen offset:0 sc1 lds
    buffer_load_dwordx4 v60, s[36:39], s60 offen offset:1024 sc1 lds
    buffer_load_dwordx4 v60, s[36:39], s60 offen offset:2048 sc1 lds
    buffer_load_dwordx4 v60, s[36:39], s60 offen offset:3072 sc1 lds
    s_waitcnt lgkmcnt(0)
    s_branch S_gc
S_y0:
    v_cmp_eq_u32 s[42:43], 0, v3
    v_mfma_f32_16x16x32_bf16 v[28:31], v[120:123], v[200:203], 0
    v_mfma_f32_16x16x32_bf16 v[28:31], v[124:127], v[204:207], v[28:31]
    v_mfma_f32_16x16x32_bf16 v[32:35], v[128:131], v[208:211], 0
    v_mfma_f32_16x16x32_bf16 v[32:35], v[132:135], v[212:215], v[32:35]
    v_mfma_f32_16x16x32_bf16 v[36:39], v[152:155], v[184:187], 0
    v_mfma_f32_16x16x32_bf16 v[36:39], v[156:159], v[188:191], v[36:39]
    v_mfma_f32_16x16x32_bf16 v[40:43], v[160:163], v[192:195], 0
    v_mfma_f32_16x16x32_bf16 v[40:43], v[164:167], v[196:199], v[40:43]
    s_nop 1
    v_cndmask_b32 v224, v224, v28, s[42:43]
    v_cndmask_b32 v225, v225, v29, s[42:43]
    v_cndmask_b32 v226, v226, v30, s[42:43]
    v_cndmask_b32 v227, v227, v31, s[42:43]
    v_cndmask_b32 v228, v228, v32, s[42:43]
    v_cndmask_b32 v229, v229, v33, s[42:43]
    v_cndmask_b32 v230, v230, v34, s[42:43]
    v_cndmask_b32 v231, v231, v35, s[42:43]
    v_cndmask_b32 v240, v240, v36, s[42:43]
    v_cndmask_b32 v241, v241, v37, s[42:43]
    v_cndmask_b32 v242, v242, v38, s[42:43]
    v_cndmask_b32 v243, v243, v39, s[42:43]
    v_cndmask_b32 v244, v244, v40, s[42:43]
    v_cndmask_b32 v245, v245, v41, s[42:43]
    v_cndmask_b32 v246, v246, v42, s[42:43]
    v_cndmask_b32 v247, v247, v43, s[42:43]
    s_branch S_y1
C_mr0:
    s_mov_b32 s9, 0
W_lM0:
    ds_read_b32 v2, v5 offset:4
    s_add_u32 s9, s9, 1
    s_cmp_gt_u32 s9, 1600000
    s_cbranch_scc1 W_dM0
    s_waitcnt lgkmcnt(0)
    v_cmp_gt_u32 vcc, 1, v2
    s_nop 0
    s_cbranch_vccnz W_lM0
W_dM0:
    s_waitcnt lgkmcnt(0)
    v_readfirstlane_b32 s63, v2
    s_nop 0
    s_lshr_b32 s63, s63, 1
    s_branch C_md0
SM_sS0:
    buffer_store_dwordx4 v[98:101], v4, s[36:39], s15 offen sc1
    s_branch SM_jS0
C_vr0:
    s_mov_b32 s9, 0
W_lV0:
    ds_read_b32 v2, v5 offset:32
    s_add_u32 s9, s9, 1
    s_cmp_gt_u32 s9, 1600000
    s_cbranch_scc1 W_dV0
    s_waitcnt lgkmcnt(0)
    v_cmp_gt_u32 vcc, 4, v2
    s_nop 0
    s_cbranch_vccnz W_lV0
W_dV0:
    ds_read_b64_tr_b16 v[170:171], v39 offset:32768
    ds_read_b64_tr_b16 v[172:173], v39 offset:33280
    ds_read_b64_tr_b16 v[174:175], v40 offset:32768
    ds_read_b64_tr_b16 v[176:177], v40 offset:33280
    ds_read_b64_tr_b16 v[202:203], v39 offset:36864
    ds_read_b64_tr_b16 v[204:205], v39 offset:37376
    ds_read_b64_tr_b16 v[206:207], v40 offset:36864
    ds_read_b64_tr_b16 v[208:209], v40 offset:37376
    s_waitcnt lgkmcnt(0)
    s_branch C_vd0
C_mr1:
    s_mov_b32 s9, 0
W_lM1:
    ds_read_b32 v2, v5 offset:4
    s_add_u32 s9, s9, 1
    s_cmp_gt_u32 s9, 1600000
    s_cbranch_scc1 W_dM1
    s_waitcnt lgkmcnt(0)
    v_cmp_gt_u32 vcc, 1, v2
    s_nop 0
    s_cbranch_vccnz W_lM1
W_dM1:
    s_waitcnt lgkmcnt(0)
    v_readfirstlane_b32 s63, v2
    s_nop 0
    s_lshr_b32 s63, s63, 1
    s_branch C_md1
SM_sS1:
    buffer_store_dwordx4 v[98:101], v4, s[36:39], s15 offen sc1
    s_branch SM_jS1
C_vr1:
    s_mov_b32 s9, 0
W_lV1:
    ds_read_b32 v2, v5 offset:32
    s_add_u32 s9, s9, 1
    s_cmp_gt_u32 s9, 1600000
    s_cbranch_scc1 W_dV1
    s_waitcnt lgkmcnt(0)
    v_cmp_gt_u32 vcc, 4, v2
    s_nop 0
    s_cbranch_vccnz W_lV1
W_dV1:
    ds_read_b64_tr_b16 v[170:171], v39 offset:32768
    ds_read_b64_tr_b16 v[172:173], v39 offset:33280
    ds_read_b64_tr_b16 v[174:175], v40 offset:32768
    ds_read_b64_tr_b16 v[176:177], v40 offset:33280
    ds_read_b64_tr_b16 v[202:203], v39 offset:36864
    ds_read_b64_tr_b16 v[204:205], v39 offset:37376
    ds_read_b64_tr_b16 v[206:207], v40 offset:36864
    ds_read_b64_tr_b16 v[208:209], v40 offset:37376
    s_waitcnt lgkmcnt(0)
    s_branch C_vd1
C_pr:
    s_mov_b32 s9, 0
C_pl:
    ds_read_b32 v53, v52 offset:40
    ds_read_b128 v[82:85], v48 offset:12288
    ds_read_b128 v[86:89], v48 offset:13312
    s_add_u32 s9, s9, 1
    s_cmp_gt_u32 s9, 1600000
    s_waitcnt lgkmcnt(0)
    s_cbranch_scc1 C_pd
    v_cmp_eq_u32 vcc, 0, v53
    s_nop 0
    s_cbranch_vccnz C_pl
    s_branch C_pd
SM_sO:
    s_nop 7
    v_cvt_pk_bf16_f32 v58, v66, v67
    v_cvt_pk_bf16_f32 v59, v68, v69
    v_cvt_pk_bf16_f32 v60, v70, v71
    v_cvt_pk_bf16_f32 v61, v72, v73
    buffer_store_dwordx4 v[58:61], v4, s[36:39], s100 offen sc1
    v_cvt_pk_bf16_f32 v62, v74, v75
    v_cvt_pk_bf16_f32 v63, v76, v77
    v_cvt_pk_bf16_f32 v64, v78, v79
    v_cvt_pk_bf16_f32 v65, v80, v81
    buffer_store_dwordx4 v[62:65], v4, s[36:39], s19 offen sc1
    s_branch SM_jO
SM_sF:
    buffer_store_dwordx2 v[14:15], v6, s[36:39], s21 offen sc1
    s_branch SM_jF
K_exit:
    s_endpgm
.fill 7168, 4, 0xbf810000
.section .rodata,"a"
.p2align 6
.amdhsa_kernel concat_heads__sliding_local_dilated__spectral_fnet__prompt_kernel
  .amdhsa_next_free_vgpr 256
  .amdhsa_next_free_sgpr 102
  .amdhsa_accum_offset 256
  .amdhsa_group_segment_fixed_size 0
  .amdhsa_kernarg_size 88
  .amdhsa_user_sgpr_count 2
  .amdhsa_user_sgpr_kernarg_segment_ptr 1
  .amdhsa_system_sgpr_workgroup_id_x 1
.end_amdhsa_kernel
```

```asm
; @launch grid=(256,1,1) block=(512,1,1) lds=163840
.amdgcn_target "amdgcn-amd-amdhsa--gfx950"
.text
.p2align 12
.fill 832, 4, 0xbf810000
.globl concat_heads__sliding_local_dilated__spectral_fnet__prompt_kernel
.p2align 8
.type concat_heads__sliding_local_dilated__spectral_fnet__prompt_kernel,@function
concat_heads__sliding_local_dilated__spectral_fnet__prompt_kernel:
    s_load_dwordx2 s[16:17], s[0:1], 0
    s_load_dwordx2 s[20:21], s[0:1], 8
    s_load_dwordx2 s[28:29], s[0:1], 24
    s_load_dwordx2 s[36:37], s[0:1], 80
    s_load_dwordx2 s[24:25], s[0:1], 16
    s_load_dwordx2 s[32:33], s[0:1], 64
    v_lshrrev_b32 v1, 6, v0
    s_cmp_ge_u32 s2, 256
    s_cbranch_scc1 K_exit
    v_readfirstlane_b32 s3, v1
    s_and_b32 s4, s2, 7
    s_lshr_b32 s5, s2, 3
    s_sub_u32 s5, s5, 4
    s_and_b32 s5, s5, 31
    s_cmp_lg_u32 s3, 7
    s_cbranch_scc1 K_nopf
    s_getpc_b64 s[44:45]
    s_mov_b32 s46, 28672
    s_mov_b32 s47, 0x00020000
    s_mul_i32 s40, s5, 896
    v_and_b32 v1, 63, v0
    v_min_u32 v1, 6, v1
    v_lshlrev_b32 v1, 7, v1
    buffer_load_dword v255, v1, s[44:47], s40 offen
K_nopf:
    s_mul_i32 s6, s5, 37
    s_lshr_b32 s6, s6, 8
    s_mul_i32 s40, s6, 7
    s_sub_u32 s7, s5, s40
    s_mov_b32 s38, 0x10000000
    s_mov_b32 s39, 0x00020000
    s_lshl_b32 s8, s4, 2
    s_cmp_lt_u32 s5, 28
    s_cbranch_scc1 K_a
    s_add_u32 s8, s8, s7
    s_mov_b32 s30, 1835008
    s_mov_b32 s31, 0x00020000
    s_lshl_b32 s40, s3, 7
    s_add_u32 s40, s40, s8
    v_and_b32 v4, 32, v0
    v_add_u32 v4, s40, v4
    v_and_b32 v5, 31, v0
    v_lshlrev_b32 v5, 4, v5
    v_mov_b32 v6, 896
    v_mad_u32_u24 v7, v4, v6, v5
    v_add_u32 v5, 384, v5
    v_sub_u32 v8, 960, v4
    v_mad_u32_u24 v8, v8, v6, v5
    v_sub_u32 v9, 2048, v4
    v_and_b32 v9, 2047, v9
    v_mad_u32_u24 v9, v9, v6, v5
    s_lshl_b32 s42, s3, 13
    s_mov_b32 m0, s42
    s_mov_b32 s52, 57344
    s_mov_b32 s53, 917504
    s_mov_b32 s54, 974848
    s_waitcnt lgkmcnt(0)
    buffer_load_dwordx4 v7, s[28:31], 0 offen nt lds
    s_add_u32 m0, m0, 1024
    s_nop 0
    buffer_load_dwordx4 v7, s[28:31], s52 offen nt lds
    s_add_u32 m0, m0, 1024
    s_nop 0
    buffer_load_dwordx4 v9, s[28:31], 0 offen nt lds
    s_add_u32 m0, m0, 1024
    s_nop 0
    buffer_load_dwordx4 v8, s[28:31], s53 offen nt lds
    s_add_u32 m0, m0, 1024
    s_load_dwordx2 s[10:11], s[36:37], 4096
    s_branch K_spare2
K_a:
    s_add_u32 s8, s8, s6
    s_cmp_ge_u32 s3, 4
    s_cbranch_scc1 K_c
    s_setprio 2
    s_mov_b32 s44, s4
    s_add_u32 s44, s44, s7
    s_mul_i32 s40, s44, 65
    s_lshr_b32 s40, s40, 8
    s_mul_i32 s40, s40, 4
    s_sub_u32 s44, s44, s40
    s_lshl_b32 s44, s44, 2
    s_lshr_b32 s44, 0x6420, s44
    s_and_b32 s44, s44, 7
    s_mov_b32 s18, 1835008
    s_mov_b32 s19, 0x00020000
    s_mov_b32 s22, 1204224
    s_mov_b32 s23, 0x00020000
    v_and_b32 v1, 63, v0
    v_lshrrev_b32 v6, 3, v1
    v_and_b32 v7, 7, v1
    v_lshrrev_b32 v8, 4, v1
    v_xor_b32 v3, v7, v8
    v_mul_u32_u24 v23, 896, v6
    v_lshl_add_u32 v21, v3, 4, v23
    v_xor_b32 v22, 64, v21
    v_add_u32 v22, 6144, v22
    s_and_b32 s43, s3, 1
    s_lshl_b32 s40, s43, 6
    v_xor_b32 v23, s40, v21
    s_lshl_b32 s40, s43, 1
    s_sub_u32 s40, 2, s40
    v_sub_u32 v2, s40, v6
    v_max_i32 v2, 0, v2
    v_mul_u32_u24 v2, 896, v2
    v_add_u32 v23, v23, v2
    v_and_b32 v2, 2, v6
    v_xor_b32 v2, v7, v2
    v_mul_u32_u24 v3, 2688, v6
    v_lshl_add_u32 v24, v2, 4, v3
    v_xor_b32 v25, 64, v24
    v_add_u32 v25, 20480, v25
    v_add_u32 v26, 896, v24
    v_add_u32 v27, 896, v25
    v_add_u32 v28, 1792, v24
    v_add_u32 v29, 1792, v25
    s_mov_b32 s45, s44
    s_lshl_b32 s40, s8, 6
    s_lshl_b32 s41, s3, 4
    s_add_u32 s42, s40, s41
    s_mul_i32 s46, s42, 896
    s_mul_i32 s48, s41, 2688
    s_lshl_b32 s42, s7, 7
    s_add_u32 s48, s48, s42
    s_sub_u32 s40, s40, 16
    s_max_i32 s40, s40, 0
    s_lshl_b32 s41, s43, 3
    s_add_u32 s40, s40, s41
    s_mul_i32 s47, s40, 896
    s_lshl_b32 s50, s3, 11
    s_lshr_b32 s41, s3, 1
    s_mul_i32 s41, s41, 10240
    s_lshl_b32 s49, s43, 10
    s_add_u32 s49, s49, s41
    s_lshl_b32 s40, s44, 7
    s_add_u32 s51, s40, s46
    s_mul_i32 s53, s44, 172032
    s_add_u32 s53, s53, s48
    s_add_u32 m0, s50, 2048
    s_add_u32 s44, s44, 1
    s_cmp_eq_u32 s44, 7
    s_cselect_b32 s44, 0, s44
    s_waitcnt lgkmcnt(0)
    buffer_load_dwordx4 v21, s[16:19], s51 offen lds
    buffer_load_dwordx4 v22, s[16:19], s51 offen offset:1024 lds
    s_lshl_b32 s41, s44, 7
    s_cmp_lt_u32 s3, 2
    s_cselect_b32 s52, s40, s41
    s_add_u32 m0, s49, 0
    s_add_u32 s52, s52, s47
    buffer_load_dwordx4 v23, s[16:19], s52 offen lds
    s_add_u32 m0, s50, 79872
    s_nop 0
    buffer_load_dwordx4 v24, s[20:23], s53 offen lds
    buffer_load_dwordx4 v25, s[20:23], s53 offen offset:1024 lds
    s_add_u32 m0, s50, 88064
    s_nop 0
    buffer_load_dwordx4 v26, s[20:23], s53 offen lds
    buffer_load_dwordx4 v27, s[20:23], s53 offen offset:1024 lds
    s_add_u32 m0, s50, 96256
    s_mul_i32 s53, s45, 172032
    s_add_u32 s53, s53, s48
    s_add_u32 s45, s45, 1
    s_cmp_eq_u32 s45, 7
    s_cselect_b32 s45, 0, s45
    buffer_load_dwordx4 v28, s[20:23], s53 offen lds
    buffer_load_dwordx4 v29, s[20:23], s53 offen offset:1024 lds
    s_lshl_b32 s40, s44, 7
    s_add_u32 s51, s40, s46
    s_mul_i32 s53, s44, 172032
    s_add_u32 s53, s53, s48
    s_add_u32 m0, s50, 12288
    s_add_u32 s44, s44, 1
    s_cmp_eq_u32 s44, 7
    s_cselect_b32 s44, 0, s44
    buffer_load_dwordx4 v21, s[16:19], s51 offen lds
    buffer_load_dwordx4 v22, s[16:19], s51 offen offset:1024 lds
    s_lshl_b32 s56, s8, 7
    s_load_dwordx2 s[10:11], s[36:37], s56
    s_lshl_b32 s30, s8, 10
    s_add_u32 s30, s30, 65536
    s_getreg_b32 s28, hwreg(HW_REG_XCC_ID, 0, 3)
    v_min_u32 v20, 6, v1
    v_lshlrev_b32 v20, 3, v20
    s_mov_b32 s26, 401408
    s_mov_b32 s27, 0x00020000
    s_mov_b32 s34, 3670016
    s_mov_b32 s35, 0x00020000
    s_lshr_b32 s58, s3, 1
    s_and_b32 s59, s3, 1
    v_and_b32 v9, 15, v1
    v_mov_b32 v4, 0
    v_mov_b32 v14, 1
    v_mov_b32 v5, 161792
    v_and_b32 v50, 6, v6
    v_xor_b32 v50, v7, v50
    v_mul_u32_u24 v51, 896, v6
    v_lshl_add_u32 v10, v50, 4, v51
    v_add_u32 v11, 6144, v10
    s_mov_b32 s54, s6
    s_mul_i32 s55, s3, 14336
    s_lshl_b32 s56, s7, 7
    s_add_u32 s55, s55, s56
    s_and_b32 s56, s3, 1
    s_lshl_b32 s57, s7, 1
    s_add_u32 s56, s56, s57
    s_lshl_b32 s15, s56, 10
    s_lshl_b32 s56, s8, 2
    s_and_b32 s57, s3, 2
    s_add_u32 s56, s56, s57
    s_mul_i32 s57, s56, 14336
    s_add_u32 s15, s15, s57
    s_add_u32 s15, s15, 2097152
    s_lshl_b32 s100, s56, 6
    s_add_u32 s100, s100, 16384
    v_lshlrev_b32 v50, 7, v7
    v_and_b32 v51, 1, v6
    v_mul_u32_u24 v51, 14336, v51
    v_add3_u32 v12, v50, v51, s15
    v_mov_b32 v50, s100
    v_cmp_le_u32 vcc, 16, v1
    s_nop 1
    v_cndmask_b32 v12, v12, v50, vcc
    v_and_b32 v50, 1, v9
    v_cmp_eq_u32 s[42:43], 1, v50
    v_lshl_add_u32 v50, v8, 2, v50
    v_cmp_le_u32 s[0:1], v50, v9
    v_add_u32 v50, 2, v50
    v_cmp_le_u32 s[12:13], v50, v9
    v_mov_b32 v50, 0xffff
    v_mov_b32 v51, 0xffff0000
    v_cndmask_b32 v50, v50, v51, s[42:43]
    v_cndmask_b32 v52, v50, 0, s[0:1]
    v_cndmask_b32 v53, v50, 0, s[12:13]
    v_cndmask_b32 v54, 0, v50, s[0:1]
    v_cndmask_b32 v55, 0, v50, s[12:13]
    v_lshlrev_b32 v50, 4, v1
    s_add_u32 s56, s50, 4096
    v_add_u32 v56, s56, v50
    s_xor_b32 s56, s50, 2048
    s_add_u32 s56, s56, 4096
    v_add_u32 v57, s56, v50
    v_add_u32 v59, s50, v50
    v_lshl_add_u32 v58, s58, 3, v5
    v_lshl_add_u32 v60, s3, 2, v5
    s_cmp_eq_u32 s7, 3
    s_cselect_b32 s56, 0, 1.0
    v_mov_b32 v61, s56
    s_mov_b32 s31, 0x3e8b97f6
K_h2:
    s_add_u32 m0, s50, 104448
    s_nop 0
    buffer_load_dwordx4 v24, s[20:23], s53 offen lds
    buffer_load_dwordx4 v25, s[20:23], s53 offen offset:1024 lds
    s_add_u32 m0, s50, 112640
    s_nop 0
    buffer_load_dwordx4 v26, s[20:23], s53 offen lds
    buffer_load_dwordx4 v27, s[20:23], s53 offen offset:1024 lds
    s_add_u32 m0, s50, 120832
    s_mul_i32 s53, s45, 172032
    s_add_u32 s53, s53, s48
    s_add_u32 s45, s45, 1
    s_cmp_eq_u32 s45, 7
    s_cselect_b32 s45, 0, s45
    buffer_load_dwordx4 v28, s[20:23], s53 offen lds
    buffer_load_dwordx4 v29, s[20:23], s53 offen offset:1024 lds
    s_lshl_b32 s40, s44, 7
    s_add_u32 s51, s40, s46
    s_mul_i32 s53, s44, 172032
    s_add_u32 s53, s53, s48
    s_add_u32 m0, s50, 22528
    s_add_u32 s44, s44, 1
    s_cmp_eq_u32 s44, 7
    s_cselect_b32 s44, 0, s44
    buffer_load_dwordx4 v21, s[16:19], s51 offen lds
    buffer_load_dwordx4 v22, s[16:19], s51 offen offset:1024 lds
    s_waitcnt lgkmcnt(0)
    s_add_u32 s12, s10, 0x5a3c9671
    s_xor_b32 s13, s11, 0x2b7e1516
    s_add_u32 s28, s28, s12
    s_mov_b32 s29, s13
    s_waitcnt vmcnt(10)
    s_barrier
    s_lshl_b32 s41, s44, 7
    s_cmp_lt_u32 s3, 2
    s_cselect_b32 s52, s40, s41
    s_add_u32 m0, s49, 20480
    s_add_u32 s52, s52, s47
    buffer_load_dwordx4 v23, s[16:19], s52 offen lds
    s_add_u32 m0, s50, 129024
    s_nop 0
    buffer_load_dwordx4 v24, s[20:23], s53 offen lds
    buffer_load_dwordx4 v25, s[20:23], s53 offen offset:1024 lds
    s_add_u32 m0, s50, 137216
    s_nop 0
    buffer_load_dwordx4 v26, s[20:23], s53 offen lds
    buffer_load_dwordx4 v27, s[20:23], s53 offen offset:1024 lds
    s_add_u32 m0, s50, 145408
    s_mul_i32 s53, s45, 172032
    s_add_u32 s53, s53, s48
    s_add_u32 s45, s45, 1
    s_cmp_eq_u32 s45, 7
    s_cselect_b32 s45, 0, s45
    buffer_load_dwordx4 v28, s[20:23], s53 offen lds
    buffer_load_dwordx4 v29, s[20:23], s53 offen offset:1024 lds
    s_lshl_b32 s40, s44, 7
    s_add_u32 s51, s40, s46
    s_mul_i32 s53, s44, 172032
    s_add_u32 s53, s53, s48
    s_add_u32 m0, s50, 32768
    s_add_u32 s44, s44, 1
    s_cmp_eq_u32 s44, 7
    s_cselect_b32 s44, 0, s44
    buffer_load_dwordx4 v21, s[16:19], s51 offen lds
    buffer_load_dwordx4 v22, s[16:19], s51 offen offset:1024 lds
    s_add_u32 m0, s50, 153600
    s_nop 0
    buffer_load_dwordx4 v24, s[20:23], s53 offen lds
    s_waitcnt vmcnt(12)
    s_barrier
    buffer_load_dwordx4 v25, s[20:23], s53 offen offset:1024 lds
    s_add_u32 m0, s50, 71680
    s_nop 0
    buffer_load_dwordx4 v26, s[20:23], s53 offen lds
    buffer_load_dwordx4 v27, s[20:23], s53 offen offset:1024 lds
    s_add_u32 m0, s50, 79872
    s_mul_i32 s53, s45, 172032
    s_add_u32 s53, s53, s48
    s_add_u32 s45, s45, 1
    s_cmp_eq_u32 s45, 7
    s_cselect_b32 s45, 0, s45
    buffer_load_dwordx4 v28, s[20:23], s53 offen lds
    buffer_load_dwordx4 v29, s[20:23], s53 offen offset:1024 lds
    s_lshl_b32 s40, s44, 7
    s_add_u32 s51, s40, s46
    s_mul_i32 s53, s44, 172032
    s_add_u32 s53, s53, s48
    s_add_u32 m0, s50, 43008
    s_add_u32 s44, s44, 1
    s_cmp_eq_u32 s44, 7
    s_cselect_b32 s44, 0, s44
    buffer_load_dwordx4 v21, s[16:19], s51 offen lds
    buffer_load_dwordx4 v22, s[16:19], s51 offen offset:1024 lds
    s_lshl_b32 s41, s44, 7
    s_cmp_lt_u32 s3, 2
    s_cselect_b32 s52, s40, s41
    s_add_u32 m0, s49, 40960
    s_add_u32 s52, s52, s47
    buffer_load_dwordx4 v23, s[16:19], s52 offen lds
    s_add_u32 m0, s50, 88064
    s_nop 0
    buffer_load_dwordx4 v24, s[20:23], s53 offen lds
    s_waitcnt vmcnt(12)
    s_barrier
    buffer_load_dwordx4 v25, s[20:23], s53 offen offset:1024 lds
    s_add_u32 m0, s50, 96256
    s_nop 0
    buffer_load_dwordx4 v26, s[20:23], s53 offen lds
    buffer_load_dwordx4 v27, s[20:23], s53 offen offset:1024 lds
    s_add_u32 m0, s50, 104448
    s_mul_i32 s53, s45, 172032
    s_add_u32 s53, s53, s48
    s_add_u32 s45, s45, 1
    s_cmp_eq_u32 s45, 7
    s_cselect_b32 s45, 0, s45
    buffer_load_dwordx4 v28, s[20:23], s53 offen lds
    buffer_load_dwordx4 v29, s[20:23], s53 offen offset:1024 lds
    s_lshl_b32 s40, s44, 7
    s_add_u32 s51, s40, s46
    s_mul_i32 s53, s44, 172032
    s_add_u32 s53, s53, s48
    s_add_u32 m0, s50, 53248
    s_add_u32 s44, s44, 1
    s_cmp_eq_u32 s44, 7
    s_cselect_b32 s44, 0, s44
    buffer_load_dwordx4 v21, s[16:19], s51 offen lds
    buffer_load_dwordx4 v22, s[16:19], s51 offen offset:1024 lds
    s_add_u32 m0, s50, 112640
    s_nop 0
    buffer_load_dwordx4 v24, s[20:23], s53 offen lds
    s_waitcnt vmcnt(12)
    s_barrier
    buffer_load_dwordx4 v25, s[20:23], s53 offen offset:1024 lds
    s_add_u32 m0, s50, 120832
    s_nop 0
    buffer_load_dwordx4 v26, s[20:23], s53 offen lds
    buffer_load_dwordx4 v27, s[20:23], s53 offen offset:1024 lds
    s_cmp_lg_u32 s3, 3
    s_cbranch_scc1 H_nx
    buffer_load_dwordx2 v[18:19], v20, s[36:39], s30 offen sc1
H_nx:
    s_lshl_b32 s40, s44, 7
    s_add_u32 s51, s40, s46
    s_mul_i32 s53, s44, 172032
    s_add_u32 s53, s53, s48
    s_add_u32 m0, s50, 63488
    s_add_u32 s44, s44, 1
    s_cmp_eq_u32 s44, 7
    s_cselect_b32 s44, 0, s44
    buffer_load_dwordx4 v21, s[16:19], s51 offen lds
    buffer_load_dwordx4 v22, s[16:19], s51 offen offset:1024 lds
    s_lshl_b32 s41, s44, 7
    s_cmp_lt_u32 s3, 2
    s_cselect_b32 s52, s40, s41
    s_cbranch_scc0 H_nh
    s_add_u32 m0, s49, 61440
    s_add_u32 s52, s52, s47
    buffer_load_dwordx4 v23, s[16:19], s52 offen lds
H_nh:
    s_add_u32 m0, s50, 129024
    s_nop 0
    buffer_load_dwordx4 v24, s[20:23], s53 offen lds
    buffer_load_dwordx4 v25, s[20:23], s53 offen offset:1024 lds
    s_waitcnt vmcnt(10)
    s_barrier
    s_add_u32 m0, s50, 137216
    s_nop 0
    buffer_load_dwordx4 v26, s[20:23], s53 offen lds
    buffer_load_dwordx4 v27, s[20:23], s53 offen offset:1024 lds
    s_add_u32 m0, s50, 145408
    s_mul_i32 s53, s45, 172032
    s_add_u32 s53, s53, s48
    s_add_u32 s45, s45, 1
    s_cmp_eq_u32 s45, 7
    s_cselect_b32 s45, 0, s45
    buffer_load_dwordx4 v28, s[20:23], s53 offen lds
    buffer_load_dwordx4 v29, s[20:23], s53 offen offset:1024 lds
    s_add_u32 m0, s50, 153600
    s_mul_i32 s53, s45, 172032
    s_add_u32 s53, s53, s48
    s_add_u32 s45, s45, 1
    s_cmp_eq_u32 s45, 7
    s_cselect_b32 s45, 0, s45
    buffer_load_dwordx4 v28, s[20:23], s53 offen lds
    s_waitcnt vmcnt(9)
    s_barrier
    buffer_load_dwordx4 v29, s[20:23], s53 offen offset:1024 lds
    s_lshl_b32 s40, s54, 13
    s_add_u32 s40, s40, s50
    s_add_u32 m0, s40, 71680
    s_add_u32 s40, s54, s7
    s_sub_u32 s41, s40, 7
    s_min_u32 s40, s40, s41
    s_mul_i32 s40, s40, 57344
    s_add_u32 s40, s40, s55
    s_add_u32 s54, s54, 1
    s_cmp_eq_u32 s54, 5
    s_cselect_b32 s54, 0, s54
    buffer_load_dwordx4 v10, s[24:27], s40 offen lds
    buffer_load_dwordx4 v11, s[24:27], s40 offen offset:1024 lds
    s_waitcnt vmcnt(8)
    s_barrier
    s_lshl_b32 s40, s54, 13
    s_add_u32 s40, s40, s50
    s_add_u32 m0, s40, 71680
    s_add_u32 s40, s54, s7
    s_sub_u32 s41, s40, 7
    s_min_u32 s40, s40, s41
    s_mul_i32 s40, s40, 57344
    s_add_u32 s40, s40, s55
    s_add_u32 s54, s54, 1
    s_cmp_eq_u32 s54, 5
    s_cselect_b32 s54, 0, s54
    buffer_load_dwordx4 v10, s[24:27], s40 offen lds
    buffer_load_dwordx4 v11, s[24:27], s40 offen offset:1024 lds
    s_waitcnt vmcnt(8)
    s_barrier
    s_cmp_lg_u32 s3, 3
    s_cbranch_scc1 H_nc
    s_mov_b32 s101, 1
    v_cmp_ne_u32 vcc, s28, v18
    v_cmp_ne_u32 s[42:43], s29, v19
    s_nop 0
    s_or_b64 vcc, vcc, s[42:43]
    s_cbranch_vccnz X_cH
X_okH:
    v_add_u32 v2, s101, v14
    ds_write_b32 v5, v2 offset:4
H_nc:
    s_setprio 0
    s_lshl_b32 s40, s54, 13
    s_add_u32 s40, s40, s50
    s_add_u32 m0, s40, 71680
    s_add_u32 s40, s54, s7
    s_sub_u32 s41, s40, 7
    s_min_u32 s40, s40, s41
    s_mul_i32 s40, s40, 57344
    s_add_u32 s40, s40, s55
    s_add_u32 s54, s54, 1
    s_cmp_eq_u32 s54, 5
    s_cselect_b32 s54, 0, s54
    buffer_load_dwordx4 v10, s[24:27], s40 offen lds
    buffer_load_dwordx4 v11, s[24:27], s40 offen offset:1024 lds
    buffer_load_dword v13, v12, s[36:39], 0 offen sc1
    s_lshl_b32 s40, s54, 13
    s_add_u32 s40, s40, s50
    s_add_u32 m0, s40, 71680
    s_add_u32 s40, s54, s7
    s_sub_u32 s41, s40, 7
    s_min_u32 s40, s40, s41
    s_mul_i32 s40, s40, 57344
    s_add_u32 s40, s40, s55
    s_add_u32 s54, s54, 1
    s_cmp_eq_u32 s54, 5
    s_cselect_b32 s54, 0, s54
    buffer_load_dwordx4 v10, s[24:27], s40 offen lds
    buffer_load_dwordx4 v11, s[24:27], s40 offen offset:1024 lds
    s_lshl_b32 s40, s54, 13
    s_add_u32 s40, s40, s50
    s_add_u32 m0, s40, 71680
    s_add_u32 s40, s54, s7
    s_sub_u32 s41, s40, 7
    s_min_u32 s40, s40, s41
    s_mul_i32 s40, s40, 57344
    s_add_u32 s40, s40, s55
    s_add_u32 s54, s54, 1
    s_cmp_eq_u32 s54, 5
    s_cselect_b32 s54, 0, s54
    buffer_load_dwordx4 v10, s[24:27], s40 offen lds
    buffer_load_dwordx4 v11, s[24:27], s40 offen offset:1024 lds
    s_waitcnt vmcnt(11)
    s_mov_b64 exec, 1
    ds_add_u32 v5, v14 offset:32
    s_mov_b64 exec, -1
    s_mov_b32 s9, 0
    s_setprio 0
H_il:
    ds_read_b64 v[62:63], v58 offset:16
    ds_read_b128 v[30:33], v56
    ds_read_b128 v[34:37], v57
    s_add_u32 s9, s9, 1
    s_cmp_gt_u32 s9, 1600000
    s_cbranch_scc1 H_id
    s_waitcnt lgkmcnt(2)
    v_and_b32 v62, v62, v63
    v_cmp_eq_u32 vcc, 0, v62
    s_waitcnt lgkmcnt(0)
    s_cbranch_vccnz H_il
H_id:
    s_waitcnt lgkmcnt(0)
    v_fma_f32 v30, v34, v61, v30
    v_fma_f32 v31, v35, v61, v31
    v_fma_f32 v32, v36, v61, v32
    v_fma_f32 v33, v37, v61, v33
    v_mul_f32 v30, s31, v30
    v_mul_f32 v31, s31, v31
    v_mul_f32 v32, s31, v32
    v_mul_f32 v33, s31, v33
    v_max_f32 v62, v30, v31
    v_max_f32 v63, v32, v33
    v_mov_b32 v64, v62
    v_mov_b32 v65, v63
    s_nop 0
    v_permlane16_swap_b32 v62, v64
    v_permlane16_swap_b32 v63, v65
    v_max_f32 v62, v62, v64
    v_max_f32 v63, v63, v65
    v_mov_b32 v64, v62
    v_mov_b32 v65, v63
    s_nop 0
    v_permlane32_swap_b32 v62, v64
    v_permlane32_swap_b32 v63, v65
    v_max_f32 v62, v62, v64
    v_max_f32 v63, v63, v65
    v_sub_f32 v30, v30, v62
    v_sub_f32 v31, v31, v62
    v_sub_f32 v32, v32, v63
    v_sub_f32 v33, v33, v63
    v_exp_f32 v30, v30
    v_exp_f32 v31, v31
    v_exp_f32 v32, v32
    v_exp_f32 v33, v33
    v_add_f32 v62, v30, v31
    v_add_f32 v63, v32, v33
    v_mov_b32 v64, v62
    v_mov_b32 v65, v63
    s_nop 0
    v_permlane16_swap_b32 v62, v64
    v_permlane16_swap_b32 v63, v65
    v_add_f32 v62, v62, v64
    v_add_f32 v63, v63, v65
    v_mov_b32 v64, v62
    v_mov_b32 v65, v63
    s_nop 0
    v_permlane32_swap_b32 v62, v64
    v_permlane32_swap_b32 v63, v65
    v_add_f32 v62, v62, v64
    v_add_f32 v63, v63, v65
    v_rcp_f32 v62, v62
    v_rcp_f32 v63, v63
    v_mul_f32 v30, v30, v62
    v_mul_f32 v31, v31, v62
    v_mul_f32 v32, v32, v63
    v_mul_f32 v33, v33, v63
    v_cvt_pk_bf16_f32 v30, v30, v30
    v_cvt_pk_bf16_f32 v31, v31, v31
    v_cvt_pk_bf16_f32 v32, v32, v32
    v_cvt_pk_bf16_f32 v33, v33, v33
    v_and_b32 v38, v52, v30
    v_and_b32 v39, v53, v31
    v_and_b32 v40, v54, v30
    v_and_b32 v41, v55, v31
    ds_write_b128 v59, v[38:41] offset:12288
    v_and_b32 v42, v52, v32
    v_and_b32 v43, v53, v33
    v_and_b32 v44, v54, v32
    v_and_b32 v45, v55, v33
    ds_write_b128 v59, v[42:45] offset:13312
    ds_write_b32 v60, v5 offset:40
    s_setprio 0
    s_waitcnt vmcnt(0)
    s_mov_b64 exec, 1
    ds_add_u32 v5, v14 offset:12
    s_mov_b64 exec, -1
    s_mov_b32 s9, 0
W_lR:
    ds_read_b32 v2, v5 offset:80
    s_add_u32 s9, s9, 1
    s_cmp_gt_u32 s9, 1600000
    s_cbranch_scc1 W_dR
    s_waitcnt lgkmcnt(0)
    v_cmp_gt_u32 vcc, 4, v2
    s_nop 0
    s_cbranch_vccnz W_lR
W_dR:
    s_add_u32 m0, s50, 112640
    s_add_u32 s40, s7, 5
    s_sub_u32 s41, s40, 7
    s_min_u32 s40, s40, s41
    s_mul_i32 s40, s40, 57344
    s_add_u32 s40, s40, s55
    buffer_load_dwordx4 v10, s[24:27], s40 offen lds
    buffer_load_dwordx4 v11, s[24:27], s40 offen offset:1024 lds
    s_add_u32 m0, s50, 120832
    s_add_u32 s40, s7, 6
    s_sub_u32 s41, s40, 7
    s_min_u32 s40, s40, s41
    s_mul_i32 s40, s40, 57344
    s_add_u32 s40, s40, s55
    buffer_load_dwordx4 v10, s[24:27], s40 offen lds
    buffer_load_dwordx4 v11, s[24:27], s40 offen offset:1024 lds
    s_waitcnt vmcnt(0)
    s_mov_b64 exec, 1
    ds_add_u32 v5, v14 offset:36
    s_endpgm
K_spare2:
    buffer_load_dwordx4 v7, s[28:31], s53 offen nt lds
    s_add_u32 m0, m0, 1024
    s_mov_b32 s26, 401408
    s_mov_b32 s27, 0x00020000
    s_mov_b32 s34, 3670016
    s_mov_b32 s35, 0x00020000
    v_and_b32 v6, 15, v0
    v_lshlrev_b32 v6, 4, v6
    v_bfe_u32 v4, v0, 4, 2
    v_lshl_add_u32 v4, v4, 9, s42
    v_add_u32 v10, v4, v6
    v_sub_u32 v11, v4, v6
    v_add_u32 v11, 432, v11
    v_mov_b32 v12, 0
    s_and_b32 s55, s3, 3
    s_lshr_b32 s56, s3, 2
    v_and_b32 v1, 63, v0
    v_lshrrev_b32 v2, 4, v1
    v_and_b32 v3, 15, v1
    s_lshl_b32 s61, s55, 3
    v_lshrrev_b32 v4, 1, v3
    v_and_b32 v4, 4, v4
    v_and_or_b32 v4, v3, 3, v4
    v_add_u32 v4, s61, v4
    v_bfe_u32 v5, v3, 2, 1
    v_cvt_f32_u32 v97, v5
    v_mul_f32 v97, 0x3e800000, v97
    v_lshl_add_u32 v5, v4, 1, v5
    v_cmp_eq_u32 vcc, 1, v5
    s_nop 1
    v_cndmask_b32 v4, v4, 32, vcc
    v_cndmask_b32 v97, v97, 0, vcc
    v_cvt_f32_u32 v96, v4
    v_mul_f32 v96, 0x3c800000, v96
    v_lshlrev_b32 v4, 3, v2
    v_cvt_f32_u32 v4, v4
    v_fma_f32 v97, v96, v4, v97
    v_cos_f32 v118, v96
    s_nop 0
    v_add_f32 v118, v118, v118
    v_fmamk_f32 v102, v96, 0x0, v97
    v_fmamk_f32 v103, v96, 0x3f800000, v97
    v_fmamk_f32 v110, v96, 0x42000000, v97
    v_fmamk_f32 v111, v96, 0x42040000, v97
    v_cos_f32 v102, v102
    v_cos_f32 v103, v103
    v_cos_f32 v110, v110
    v_cos_f32 v111, v111
    v_fma_f32 v104, v118, v103, -v102
    v_fma_f32 v112, v118, v111, -v110
    v_fma_f32 v105, v118, v104, -v103
    v_fma_f32 v113, v118, v112, -v111
    v_fma_f32 v106, v118, v105, -v104
    v_fma_f32 v114, v118, v113, -v112
    v_fma_f32 v107, v118, v106, -v105
    v_fma_f32 v115, v118, v114, -v113
    v_fma_f32 v108, v118, v107, -v106
    v_fma_f32 v116, v118, v115, -v114
    v_fma_f32 v109, v118, v108, -v107
    v_fma_f32 v117, v118, v116, -v115
    v_cvt_pk_bf16_f32 v20, v102, v103
    v_cvt_pk_bf16_f32 v21, v104, v105
    v_cvt_pk_bf16_f32 v22, v106, v107
    v_cvt_pk_bf16_f32 v23, v108, v109
    v_cvt_pk_bf16_f32 v24, v110, v111
    v_cvt_pk_bf16_f32 v25, v112, v113
    v_cvt_pk_bf16_f32 v26, v114, v115
    v_cvt_pk_bf16_f32 v27, v116, v117
    v_lshrrev_b32 v4, 4, v0
    v_and_b32 v5, 3, v4
    v_lshlrev_b32 v5, 6, v5
    v_lshlrev_b32 v13, 1, v6
    v_xor_b32 v13, v13, v5
    v_bfe_u32 v5, v4, 3, 1
    v_lshl_add_u32 v13, v5, 4, v13
    v_lshl_add_u32 v13, v4, 9, v13
    v_add_u32 v13, 65536, v13
    v_xor_b32 v14, 16, v13
    v_lshrrev_b32 v4, 2, v3
    v_lshl_add_u32 v5, v2, 3, v4
    v_lshlrev_b32 v5, 9, v5
    v_lshl_add_u32 v5, v4, 6, v5
    v_and_b32 v4, 1, v1
    v_lshl_add_u32 v5, v4, 5, v5
    v_bfe_u32 v4, v1, 1, 1
    v_lshl_add_u32 v5, v4, 3, v5
    v_and_b32 v4, 1, v2
    v_xor_b32 v4, s56, v4
    v_lshl_add_u32 v16, v4, 4, v5
    v_add_u32 v16, 65536, v16
    v_xor_b32 v17, 64, v16
    v_xor_b32 v18, 128, v16
    v_xor_b32 v19, 192, v16
    v_and_b32 v15, 32, v1
    v_lshrrev_b32 v4, 2, v3
    v_add_lshl_u32 v15, v15, v4, 12
    v_and_b32 v4, 16, v1
    v_lshl_add_u32 v15, v4, 2, v15
    v_and_b32 v4, 3, v3
    v_lshl_add_u32 v15, v4, 4, v15
    v_and_b32 v4, 7, v3
    v_lshlrev_b32 v86, 16, v4
    v_mov_b32 v5, 0xffff0000
    v_add_u32 v87, s56, v3
    v_cmp_eq_u32 vcc, 0, v87
    s_nop 1
    v_cndmask_b32 v87, v5, 0, vcc
    v_add_u32 v4, 256, v11
    buffer_load_dwordx4 v7, s[28:31], s54 offen nt lds
    s_add_u32 m0, m0, 1024
    v_cmp_eq_u32 vcc, 15, v3
    s_nop 1
    v_cndmask_b32 v11, v11, v4, vcc
    s_lshl_b32 s50, s8, 3
    s_add_u32 s50, s50, s3
    s_mul_i32 s50, s50, 1568
    s_and_b32 s50, s50, 0xffffff80
    v_min_u32 v95, 12, v1
    v_lshlrev_b32 v95, 7, v95
    s_lshl_b32 s59, s55, 18
    s_lshl_b32 s61, s56, 14
    s_add_u32 s59, s59, s61
    s_lshl_b32 s61, s8, 7
    s_add_u32 s59, s59, s61
    s_add_u32 s59, s59, 1048576
    v_lshlrev_b32 v63, 4, v1
    v_and_b32 v4, 32, v1
    v_xor_b32 v60, v63, v4
    s_lshl_b32 s60, s8, 3
    s_add_u32 s60, s60, s3
    s_lshl_b32 s60, s60, 12
    s_add_u32 s60, s60, 1048576
    s_add_u32 s63, s8, 1024
    s_cmp_eq_u32 s8, 0
    s_cselect_b32 s63, 32, s63
    v_lshl_add_u32 v4, v3, 6, s8
    v_cvt_f32_u32 v96, v4
    v_mul_f32 v96, 0x3a000000, v96
    v_lshlrev_b32 v4, 2, v2
    v_cvt_f32_u32 v4, v4
    v_mul_f32 v97, v96, v4
    v_cos_f32 v118, v96
    s_nop 0
    v_add_f32 v118, v118, v118
    v_fmamk_f32 v102, v96, 0x0, v97
    v_fmamk_f32 v103, v96, 0x3f800000, v97
    v_fmamk_f32 v106, v96, 0x0, v97
    v_fmamk_f32 v107, v96, 0x3f800000, v97
    v_fmamk_f32 v110, v96, 0x41800000, v97
    v_fmamk_f32 v111, v96, 0x41880000, v97
    v_fmamk_f32 v114, v96, 0x41800000, v97
    v_fmamk_f32 v115, v96, 0x41880000, v97
    v_cos_f32 v102, v102
    v_cos_f32 v103, v103
    v_sin_f32 v106, v106
    buffer_load_dwordx4 v8, s[28:31], s52 offen nt lds
    s_add_u32 m0, m0, 1024
    v_sin_f32 v107, v107
    v_cos_f32 v110, v110
    v_cos_f32 v111, v111
    v_sin_f32 v114, v114
    v_sin_f32 v115, v115
    v_fma_f32 v104, v118, v103, -v102
    v_fma_f32 v108, v118, v107, -v106
    v_fma_f32 v112, v118, v111, -v110
    v_fma_f32 v116, v118, v115, -v114
    v_fma_f32 v105, v118, v104, -v103
    v_fma_f32 v109, v118, v108, -v107
    v_fma_f32 v113, v118, v112, -v111
    v_fma_f32 v117, v118, v116, -v115
    s_cmp_eq_u32 s8, 0
    s_cbranch_scc1 S_cls0
    v_cvt_pk_bf16_f32 v28, v102, v106
    v_cvt_pk_bf16_f32 v36, -v106, v102
    v_mov_b32 v44, v28
    v_mov_b32 v52, v36
    v_cvt_pk_bf16_f32 v29, v103, v107
    v_cvt_pk_bf16_f32 v37, -v107, v103
    v_xor_b32 v45, 0x80008000, v29
    v_xor_b32 v53, 0x80008000, v37
    v_cvt_pk_bf16_f32 v30, v104, v108
    v_cvt_pk_bf16_f32 v38, -v108, v104
    v_mov_b32 v46, v30
    v_mov_b32 v54, v38
    v_cvt_pk_bf16_f32 v31, v105, v109
    v_cvt_pk_bf16_f32 v39, -v109, v105
    v_xor_b32 v47, 0x80008000, v31
    v_xor_b32 v55, 0x80008000, v39
    v_cvt_pk_bf16_f32 v32, v110, v114
    v_cvt_pk_bf16_f32 v40, -v114, v110
    v_mov_b32 v48, v32
    v_mov_b32 v56, v40
    v_cvt_pk_bf16_f32 v33, v111, v115
    v_cvt_pk_bf16_f32 v41, -v115, v111
    v_xor_b32 v49, 0x80008000, v33
    v_xor_b32 v57, 0x80008000, v41
    v_cvt_pk_bf16_f32 v34, v112, v116
    v_cvt_pk_bf16_f32 v42, -v116, v112
    v_mov_b32 v50, v34
    v_mov_b32 v58, v42
    v_cvt_pk_bf16_f32 v35, v113, v117
    v_cvt_pk_bf16_f32 v43, -v117, v113
    v_xor_b32 v51, 0x80008000, v35
    v_xor_b32 v59, 0x80008000, v43
S_reg:
    s_lshl_b32 s61, s55, 14
    s_add_u32 s61, s61, 98304
    v_add_u32 v67, s61, v63
    v_cmp_eq_u32 s[42:43], 0, v2
    s_nop 1
    v_cndmask_b32 v98, 1.0, 0.5, s[42:43]
    v_and_b32 v4, 1, v2
    v_mov_b32 v5, 0xffff
    v_cmp_eq_u32 s[42:43], 1, v4
    s_nop 1
    v_cndmask_b32 v101, -1, v5, s[42:43]
    v_cndmask_b32 v96, 1.0, 0, s[42:43]
    v_cmp_eq_u32 s[42:43], 1, v2
    s_nop 1
    v_cndmask_b32 v97, v96, 0.5, s[42:43]
    s_cmp_eq_u32 s56, 0
    s_cselect_b64 s[42:43], -1, 0
    v_cndmask_b32 v99, v96, v97, s[42:43]
    v_cndmask_b32 v100, v97, v96, s[42:43]
    v_lshlrev_b32 v4, 6, v4
    v_and_b32 v5, 2, v2
    v_add_u32 v4, v4, v5
    v_cvt_f32_u32 v97, v4
    s_lshl_b32 s61, s55, 5
    s_add_u32 s61, s61, s56
    v_lshl_add_u32 v4, v3, 1, s61
    v_cvt_f32_u32 v96, v4
    v_mul_f32 v96, 0x3b124925, v96
    v_mul_f32 v97, v96, v97
    s_lshl_b32 s61, s56, 13
    v_add_u32 v5, s61, v67
    v_mul_f32 v118, 0x40800000, v96
    v_cos_f32 v118, v118
    s_nop 0
    v_add_f32 v118, v118, v118
    v_fmamk_f32 v102, v96, 0x0, v97
    v_fmamk_f32 v103, v96, 0x40800000, v97
    buffer_load_dwordx4 v8, s[28:31], 0 offen nt lds
    s_add_u32 m0, m0, 1024
    v_cos_f32 v102, v102
    v_cos_f32 v103, v103
    s_nop 0
    v_fma_f32 v104, v118, v103, -v102
    v_fma_f32 v105, v118, v104, -v103
    v_fma_f32 v106, v118, v105, -v104
    v_fma_f32 v107, v118, v106, -v105
    v_fma_f32 v108, v118, v107, -v106
    v_fma_f32 v109, v118, v108, -v107
    v_fma_f32 v110, v118, v109, -v108
    v_fma_f32 v111, v118, v110, -v109
    s_waitcnt lgkmcnt(0)
    s_add_u32 s12, s10, 0x5a3c9671
    s_xor_b32 s13, s11, 0x2b7e1516
    s_lshl_b32 s51, s12, 12
    s_xor_b32 s51, s51, s13
    s_and_b32 s51, s51, 0xbfff0000
    v_xor_b32 v86, s51, v86
    v_mov_b32 v92, s12
    v_mov_b32 v93, s13
    s_waitcnt vmcnt(4)
    ds_read_b128 v[120:123], v10 offset:0
    ds_read_b128 v[124:127], v11 offset:2112
    ds_read_b128 v[132:135], v10 offset:2112
    ds_read_b128 v[128:131], v11 offset:0
    s_waitcnt lgkmcnt(2)
    v_mov_b32 v136, v120
    v_lshlrev_b32 v140, 16, v121
    v_lshlrev_b32 v154, 16, v127
    v_and_b32 v141, 0xffff0000, v121
    v_and_b32 v155, 0xffff0000, v126
    v_pk_add_f32 v[140:141], v[140:141], v[154:155]
    v_mov_b32_dpp v136, v124 row_shr:1 row_mask:0xf bank_mask:0xf
    v_lshlrev_b32 v142, 16, v122
    v_lshlrev_b32 v154, 16, v126
    v_and_b32 v143, 0xffff0000, v122
    v_and_b32 v155, 0xffff0000, v125
    v_pk_add_f32 v[142:143], v[142:143], v[154:155]
    v_lshlrev_b32 v144, 16, v123
    v_lshlrev_b32 v154, 16, v125
    v_and_b32 v145, 0xffff0000, v123
    v_and_b32 v155, 0xffff0000, v124
    v_pk_add_f32 v[144:145], v[144:145], v[154:155]
    v_lshlrev_b32 v138, 16, v120
    v_lshlrev_b32 v154, 16, v136
    v_and_b32 v139, 0xffff0000, v120
    v_and_b32 v155, 0xffff0000, v127
    v_pk_add_f32 v[138:139], v[138:139], v[154:155]
    s_waitcnt lgkmcnt(0)
    v_lshlrev_b32 v148, 16, v133
    v_lshlrev_b32 v154, 16, v131
    v_and_b32 v149, 0xffff0000, v133
    v_and_b32 v155, 0xffff0000, v130
    v_pk_add_f32 v[148:149], v[148:149], v[154:155]
    v_mov_b32_dpp v137, v128 row_ror:1 row_mask:0xf bank_mask:0xf
    v_lshlrev_b32 v150, 16, v134
    v_lshlrev_b32 v154, 16, v130
    v_and_b32 v151, 0xffff0000, v134
    v_and_b32 v155, 0xffff0000, v129
    v_pk_add_f32 v[150:151], v[150:151], v[154:155]
    v_lshlrev_b32 v152, 16, v135
    v_lshlrev_b32 v154, 16, v129
    v_and_b32 v153, 0xffff0000, v135
    v_and_b32 v155, 0xffff0000, v128
    v_pk_add_f32 v[152:153], v[152:153], v[154:155]
    v_lshlrev_b32 v146, 16, v132
    v_lshlrev_b32 v154, 16, v137
    v_and_b32 v147, 0xffff0000, v132
    v_and_b32 v155, 0xffff0000, v131
    v_pk_add_f32 v[146:147], v[146:147], v[154:155]
    v_pk_add_f32 v[164:165], v[138:139], v[146:147]
    v_pk_add_f32 v[166:167], v[140:141], v[148:149]
    v_pk_add_f32 v[168:169], v[142:143], v[150:151]
    v_pk_add_f32 v[170:171], v[144:145], v[152:153]
    v_cvt_pk_bf16_f32 v156, v164, v166
    v_cvt_pk_bf16_f32 v157, v168, v170
    v_cvt_pk_bf16_f32 v158, v165, v167
    v_cvt_pk_bf16_f32 v159, v169, v171
    ds_write_b128 v13, v[156:159] offset:0
    v_pk_add_f32 v[164:165], v[138:139], v[146:147] neg_lo:[0,1] neg_hi:[0,1]
    v_pk_add_f32 v[166:167], v[140:141], v[148:149] neg_lo:[0,1] neg_hi:[0,1]
    v_pk_add_f32 v[168:169], v[142:143], v[150:151] neg_lo:[0,1] neg_hi:[0,1]
    v_pk_add_f32 v[170:171], v[144:145], v[152:153] neg_lo:[0,1] neg_hi:[0,1]
    v_cvt_pk_bf16_f32 v160, v164, v166
    v_cvt_pk_bf16_f32 v161, v168, v170
    v_cvt_pk_bf16_f32 v162, v165, v167
    v_cvt_pk_bf16_f32 v163, v169, v171
    ds_write_b128 v14, v[160:163] offset:0
    s_waitcnt lgkmcnt(0)
    s_barrier
    ds_read_b64_tr_b16 v[172:173], v16 offset:0
    ds_read_b64_tr_b16 v[174:175], v16 offset:2048
    ds_read_b64_tr_b16 v[176:177], v17 offset:0
    ds_read_b64_tr_b16 v[178:179], v17 offset:2048
    ds_read_b64_tr_b16 v[180:181], v18 offset:0
    ds_read_b64_tr_b16 v[182:183], v18 offset:2048
    ds_read_b64_tr_b16 v[184:185], v19 offset:0
    ds_read_b64_tr_b16 v[186:187], v19 offset:2048
    s_waitcnt lgkmcnt(6)
    v_mfma_f32_16x16x32_bf16 v[188:191], v[20:23], v[172:175], 0
    ds_read_b64_tr_b16 v[172:173], v16 offset:256
    ds_read_b64_tr_b16 v[174:175], v16 offset:2304
    s_waitcnt lgkmcnt(6)
    v_mfma_f32_16x16x32_bf16 v[192:195], v[20:23], v[176:179], 0
    ds_read_b64_tr_b16 v[176:177], v17 offset:256
    ds_read_b64_tr_b16 v[178:179], v17 offset:2304
    s_waitcnt lgkmcnt(6)
    v_mfma_f32_16x16x32_bf16 v[196:199], v[20:23], v[180:183], 0
    ds_read_b64_tr_b16 v[180:181], v18 offset:256
    ds_read_b64_tr_b16 v[182:183], v18 offset:2304
    s_waitcnt lgkmcnt(6)
    v_mfma_f32_16x16x32_bf16 v[200:203], v[20:23], v[184:187], 0
    ds_read_b64_tr_b16 v[184:185], v19 offset:256
    ds_read_b64_tr_b16 v[186:187], v19 offset:2304
    s_waitcnt lgkmcnt(6)
    v_mfma_f32_16x16x32_bf16 v[204:207], v[20:23], v[172:175], 0
    s_waitcnt lgkmcnt(4)
    v_mfma_f32_16x16x32_bf16 v[208:211], v[20:23], v[176:179], 0
    s_waitcnt lgkmcnt(2)
    v_mfma_f32_16x16x32_bf16 v[212:215], v[20:23], v[180:183], 0
    s_waitcnt lgkmcnt(0)
    v_mfma_f32_16x16x32_bf16 v[216:219], v[20:23], v[184:187], 0
    s_waitcnt vmcnt(0)
    buffer_load_dword v255, v95, s[24:27], s50 offen
    ds_read_b128 v[120:123], v10 offset:4096
    ds_read_b128 v[124:127], v11 offset:6208
    ds_read_b128 v[132:135], v10 offset:6208
    ds_read_b128 v[128:131], v11 offset:4096
    s_waitcnt lgkmcnt(2)
    v_mov_b32 v136, v120
    v_lshlrev_b32 v140, 16, v121
    v_lshlrev_b32 v154, 16, v127
    v_and_b32 v141, 0xffff0000, v121
    v_and_b32 v155, 0xffff0000, v126
    v_pk_add_f32 v[140:141], v[140:141], v[154:155]
    v_mov_b32_dpp v136, v124 row_shr:1 row_mask:0xf bank_mask:0xf
    v_lshlrev_b32 v142, 16, v122
    v_lshlrev_b32 v154, 16, v126
    v_and_b32 v143, 0xffff0000, v122
    v_and_b32 v155, 0xffff0000, v125
    v_pk_add_f32 v[142:143], v[142:143], v[154:155]
    v_lshlrev_b32 v144, 16, v123
    v_lshlrev_b32 v154, 16, v125
    v_and_b32 v145, 0xffff0000, v123
    v_and_b32 v155, 0xffff0000, v124
    v_pk_add_f32 v[144:145], v[144:145], v[154:155]
    v_lshlrev_b32 v138, 16, v120
    v_lshlrev_b32 v154, 16, v136
    v_and_b32 v139, 0xffff0000, v120
    v_and_b32 v155, 0xffff0000, v127
    v_pk_add_f32 v[138:139], v[138:139], v[154:155]
    s_waitcnt lgkmcnt(0)
    v_lshlrev_b32 v148, 16, v133
    v_lshlrev_b32 v154, 16, v131
    v_and_b32 v149, 0xffff0000, v133
    v_and_b32 v155, 0xffff0000, v130
    v_pk_add_f32 v[148:149], v[148:149], v[154:155]
    v_mov_b32_dpp v137, v128 row_ror:1 row_mask:0xf bank_mask:0xf
    v_lshlrev_b32 v150, 16, v134
    v_lshlrev_b32 v154, 16, v130
    v_and_b32 v151, 0xffff0000, v134
    v_and_b32 v155, 0xffff0000, v129
    v_pk_add_f32 v[150:151], v[150:151], v[154:155]
    v_lshlrev_b32 v152, 16, v135
    v_lshlrev_b32 v154, 16, v129
    v_and_b32 v153, 0xffff0000, v135
    v_and_b32 v155, 0xffff0000, v128
    v_pk_add_f32 v[152:153], v[152:153], v[154:155]
    v_lshlrev_b32 v146, 16, v132
    v_lshlrev_b32 v154, 16, v137
    v_and_b32 v147, 0xffff0000, v132
    v_and_b32 v155, 0xffff0000, v131
    v_pk_add_f32 v[146:147], v[146:147], v[154:155]
    v_pk_add_f32 v[164:165], v[138:139], v[146:147]
    v_pk_add_f32 v[166:167], v[140:141], v[148:149]
    v_pk_add_f32 v[168:169], v[142:143], v[150:151]
    v_pk_add_f32 v[170:171], v[144:145], v[152:153]
    v_cvt_pk_bf16_f32 v156, v164, v166
    v_cvt_pk_bf16_f32 v157, v168, v170
    v_cvt_pk_bf16_f32 v158, v165, v167
    v_cvt_pk_bf16_f32 v159, v169, v171
    ds_write_b128 v13, v[156:159] offset:16384
    v_pk_add_f32 v[164:165], v[138:139], v[146:147] neg_lo:[0,1] neg_hi:[0,1]
    v_pk_add_f32 v[166:167], v[140:141], v[148:149] neg_lo:[0,1] neg_hi:[0,1]
    v_pk_add_f32 v[168:169], v[142:143], v[150:151] neg_lo:[0,1] neg_hi:[0,1]
    v_pk_add_f32 v[170:171], v[144:145], v[152:153] neg_lo:[0,1] neg_hi:[0,1]
    v_cvt_pk_bf16_f32 v160, v164, v166
    v_cvt_pk_bf16_f32 v161, v168, v170
    v_cvt_pk_bf16_f32 v162, v165, v167
    v_cvt_pk_bf16_f32 v163, v169, v171
    ds_write_b128 v14, v[160:163] offset:16384
    s_cmp_lg_u32 s3, 0
    s_cbranch_scc1 S_nw
    s_lshl_b32 s40, s8, 7
    s_add_u32 s40, s40, 32768
    buffer_load_dword v255, v12, s[36:39], s40 offen
S_nw:
    s_waitcnt lgkmcnt(0)
    s_barrier
    ds_read_b64_tr_b16 v[172:173], v16 offset:16384
    ds_read_b64_tr_b16 v[174:175], v16 offset:18432
    ds_read_b64_tr_b16 v[176:177], v17 offset:16384
    ds_read_b64_tr_b16 v[178:179], v17 offset:18432
    ds_read_b64_tr_b16 v[180:181], v18 offset:16384
    ds_read_b64_tr_b16 v[182:183], v18 offset:18432
    ds_read_b64_tr_b16 v[184:185], v19 offset:16384
    ds_read_b64_tr_b16 v[186:187], v19 offset:18432
    s_waitcnt lgkmcnt(6)
    v_mfma_f32_16x16x32_bf16 v[188:191], v[24:27], v[172:175], v[188:191]
    ds_read_b64_tr_b16 v[172:173], v16 offset:16640
    ds_read_b64_tr_b16 v[174:175], v16 offset:18688
    s_waitcnt lgkmcnt(6)
    v_mfma_f32_16x16x32_bf16 v[192:195], v[24:27], v[176:179], v[192:195]
    ds_read_b64_tr_b16 v[176:177], v17 offset:16640
    ds_read_b64_tr_b16 v[178:179], v17 offset:18688
    s_waitcnt lgkmcnt(6)
    v_mfma_f32_16x16x32_bf16 v[196:199], v[24:27], v[180:183], v[196:199]
    ds_read_b64_tr_b16 v[180:181], v18 offset:16640
    ds_read_b64_tr_b16 v[182:183], v18 offset:18688
    s_waitcnt lgkmcnt(6)
    v_mfma_f32_16x16x32_bf16 v[200:203], v[24:27], v[184:187], v[200:203]
    ds_read_b64_tr_b16 v[184:185], v19 offset:16640
    ds_read_b64_tr_b16 v[186:187], v19 offset:18688
    s_waitcnt lgkmcnt(6)
    v_mfma_f32_16x16x32_bf16 v[204:207], v[24:27], v[172:175], v[204:207]
    s_waitcnt lgkmcnt(4)
    v_mfma_f32_16x16x32_bf16 v[208:211], v[24:27], v[176:179], v[208:211]
    s_waitcnt lgkmcnt(2)
    v_mfma_f32_16x16x32_bf16 v[212:215], v[24:27], v[180:183], v[212:215]
    s_waitcnt lgkmcnt(0)
    v_mfma_f32_16x16x32_bf16 v[216:219], v[24:27], v[184:187], v[216:219]
    v_cvt_pk_bf16_f32 v120, v188, v192
    v_cvt_pk_bf16_f32 v121, v196, v200
    s_nop 1
    v_cvt_pk_bf16_f32 v122, v204, v208
    s_nop 2
    v_cvt_pk_bf16_f32 v123, v212, v216
    v_bfi_b32 v123, v87, v86, v123
    s_add_u32 s41, s59, 0
    buffer_store_dwordx4 v[120:123], v15, s[36:39], s41 offen sc1
    v_cvt_pk_bf16_f32 v124, v189, v193
    v_cvt_pk_bf16_f32 v125, v197, v201
    v_cvt_pk_bf16_f32 v126, v205, v209
    v_cvt_pk_bf16_f32 v127, v213, v217
    v_bfi_b32 v127, v87, v86, v127
    s_add_u32 s41, s59, 32768
    buffer_store_dwordx4 v[124:127], v15, s[36:39], s41 offen sc1
    v_cvt_pk_bf16_f32 v128, v190, v194
    v_cvt_pk_bf16_f32 v129, v198, v202
    v_cvt_pk_bf16_f32 v130, v206, v210
    v_cvt_pk_bf16_f32 v131, v214, v218
    v_bfi_b32 v131, v87, v86, v131
    s_add_u32 s41, s59, 65536
    buffer_store_dwordx4 v[128:131], v15, s[36:39], s41 offen sc1
    v_cvt_pk_bf16_f32 v132, v191, v195
    v_cvt_pk_bf16_f32 v133, v199, v203
    v_cvt_pk_bf16_f32 v134, v207, v211
    v_cvt_pk_bf16_f32 v135, v215, v219
    v_bfi_b32 v135, v87, v86, v135
    s_add_u32 s41, s59, 98304
    buffer_store_dwordx4 v[132:135], v15, s[36:39], s41 offen sc1
    s_cmp_lg_u32 s3, 0
    s_cbranch_scc1 S_nh
    s_lshl_b32 s40, s8, 7
    s_add_u32 s40, s40, 32768
    s_mov_b64 exec, 1
    buffer_store_dwordx2 v[92:93], v12, s[36:39], s40 offen sc1
    s_mov_b64 exec, -1
S_nh:
    s_barrier
    s_cmp_lg_u32 s3, 0
    s_cbranch_scc1 S_nf
    v_lshlrev_b32 v94, 2, v3
    v_add_u32 v94, 81920, v94
    ds_write_b32 v94, v12
S_nf:
    s_lshl_b32 s40, s7, 3
    s_add_u32 s40, s40, s3
    s_mul_i32 s40, s40, 28
    v_min_u32 v24, 27, v1
    v_add_u32 v24, s40, v24
    v_and_b32 v25, 0xffffff80, v24
    v_lshrrev_b32 v26, 1, v25
    v_sub_u32 v24, v24, v26
    v_add_u32 v26, -128, v24
    v_add_u32 v24, 320, v24
    v_min_u32 v24, v24, v26
    v_mul_u32_u24 v24, 896, v24
    v_add_u32 v24, v24, v25
    buffer_load_dword v255, v24, s[24:27], 0 offen
    v_fma_f32 v112, v118, v111, -v110
    v_fma_f32 v113, v118, v112, -v111
    v_fma_f32 v114, v118, v113, -v112
    v_fma_f32 v115, v118, v114, -v113
    v_fma_f32 v116, v118, v115, -v114
    v_fma_f32 v117, v118, v116, -v115
    v_mul_f32 v102, v102, v98
    v_mul_f32 v114, v114, v99
    v_cvt_pk_bf16_f32 v76, v102, v106
    v_cvt_pk_bf16_f32 v77, v110, v114
    v_cvt_pk_bf16_f32 v78, v103, v107
    v_cvt_pk_bf16_f32 v79, v111, v115
    v_and_b32 v79, v101, v79
    ds_write_b128 v5, v[76:79] offset:0
    v_cvt_pk_bf16_f32 v80, v104, v108
    v_cvt_pk_bf16_f32 v81, v112, v116
    v_cvt_pk_bf16_f32 v82, v105, v109
    v_cvt_pk_bf16_f32 v83, v113, v117
    v_and_b32 v81, v101, v81
    v_and_b32 v83, v101, v83
    ds_write_b128 v5, v[80:83] offset:1024
    v_fmamk_f32 v102, v96, 0x0, v97
    v_fmamk_f32 v103, v96, 0x40800000, v97
    v_sin_f32 v102, v102
    v_sin_f32 v103, v103
    s_nop 0
    v_fma_f32 v104, v118, v103, -v102
    v_fma_f32 v105, v118, v104, -v103
    v_fma_f32 v106, v118, v105, -v104
    v_fma_f32 v107, v118, v106, -v105
    v_fma_f32 v108, v118, v107, -v106
    v_fma_f32 v109, v118, v108, -v107
    v_fma_f32 v110, v118, v109, -v108
    v_fma_f32 v111, v118, v110, -v109
    v_fma_f32 v112, v118, v111, -v110
    v_fma_f32 v113, v118, v112, -v111
    v_fma_f32 v114, v118, v113, -v112
    v_fma_f32 v115, v118, v114, -v113
    v_fma_f32 v116, v118, v115, -v114
    v_fma_f32 v117, v118, v116, -v115
    v_mul_f32 v114, v114, v100
    v_cvt_pk_bf16_f32 v76, v102, v106
    v_cvt_pk_bf16_f32 v77, v110, v114
    v_cvt_pk_bf16_f32 v78, v103, v107
    v_cvt_pk_bf16_f32 v79, v111, v115
    v_and_b32 v79, v101, v79
    ds_write_b128 v5, v[76:79] offset:4096
    v_cvt_pk_bf16_f32 v80, v104, v108
    v_cvt_pk_bf16_f32 v81, v112, v116
    v_cvt_pk_bf16_f32 v82, v105, v109
    v_cvt_pk_bf16_f32 v83, v113, v117
    v_and_b32 v81, v101, v81
    v_and_b32 v83, v101, v83
    ds_write_b128 v5, v[80:83] offset:5120
    v_fmamk_f32 v102, v96, 0x3f800000, v97
    v_fmamk_f32 v103, v96, 0x40a00000, v97
    v_cos_f32 v102, v102
    v_cos_f32 v103, v103
    s_nop 0
    v_fma_f32 v104, v118, v103, -v102
    v_fma_f32 v105, v118, v104, -v103
    v_fma_f32 v106, v118, v105, -v104
    v_fma_f32 v107, v118, v106, -v105
    v_fma_f32 v108, v118, v107, -v106
    v_fma_f32 v109, v118, v108, -v107
    v_fma_f32 v110, v118, v109, -v108
    v_fma_f32 v111, v118, v110, -v109
    v_fma_f32 v112, v118, v111, -v110
    v_fma_f32 v113, v118, v112, -v111
    v_fma_f32 v114, v118, v113, -v112
    v_fma_f32 v115, v118, v114, -v113
    v_fma_f32 v116, v118, v115, -v114
    v_fma_f32 v117, v118, v116, -v115
    v_cvt_pk_bf16_f32 v76, v102, v106
    v_cvt_pk_bf16_f32 v77, v110, v114
    v_cvt_pk_bf16_f32 v78, v103, v107
    v_cvt_pk_bf16_f32 v79, v111, v115
    v_and_b32 v77, v101, v77
    v_and_b32 v79, v101, v79
    ds_write_b128 v5, v[76:79] offset:2048
    v_cvt_pk_bf16_f32 v80, v104, v108
    v_cvt_pk_bf16_f32 v81, v112, v116
    v_cvt_pk_bf16_f32 v82, v105, v109
    v_cvt_pk_bf16_f32 v83, v113, v117
    v_and_b32 v81, v101, v81
    v_and_b32 v83, v101, v83
    ds_write_b128 v5, v[80:83] offset:3072
    v_fmamk_f32 v102, v96, 0x3f800000, v97
    v_fmamk_f32 v103, v96, 0x40a00000, v97
    v_sin_f32 v102, v102
    v_sin_f32 v103, v103
    s_nop 0
    v_fma_f32 v104, v118, v103, -v102
    v_fma_f32 v105, v118, v104, -v103
    v_fma_f32 v106, v118, v105, -v104
    v_and_b32 v94, 31, v1
    v_lshlrev_b32 v94, 7, v94
    s_mov_b32 s50, 32768
    s_cmp_lg_u32 s3, 1
    s_cbranch_scc1 S_p0
    buffer_load_dword v20, v94, s[36:39], s50 offen sc1
S_p0:
    v_fma_f32 v107, v118, v106, -v105
    v_fma_f32 v108, v118, v107, -v106
    v_fma_f32 v109, v118, v108, -v107
    v_fma_f32 v110, v118, v109, -v108
    v_fma_f32 v111, v118, v110, -v109
    v_fma_f32 v112, v118, v111, -v110
    v_fma_f32 v113, v118, v112, -v111
    v_fma_f32 v114, v118, v113, -v112
    v_fma_f32 v115, v118, v114, -v113
    v_fma_f32 v116, v118, v115, -v114
    v_fma_f32 v117, v118, v116, -v115
    v_cvt_pk_bf16_f32 v76, v102, v106
    v_cvt_pk_bf16_f32 v77, v110, v114
    v_cvt_pk_bf16_f32 v78, v103, v107
    v_cvt_pk_bf16_f32 v79, v111, v115
    v_and_b32 v77, v101, v77
    v_and_b32 v79, v101, v79
    ds_write_b128 v5, v[76:79] offset:6144
    v_cvt_pk_bf16_f32 v80, v104, v108
    v_cvt_pk_bf16_f32 v81, v112, v116
    v_cvt_pk_bf16_f32 v82, v105, v109
    v_cvt_pk_bf16_f32 v83, v113, v117
    v_and_b32 v81, v101, v81
    v_and_b32 v83, v101, v83
    ds_write_b128 v5, v[80:83] offset:7168
    v_bfe_u32 v88, v60, 4, 2
    v_mov_b32 v5, 0xffff0000
    v_add_u32 v4, s3, v88
    v_cmp_eq_u32 s[42:43], 0, v4
    s_nop 1
    v_cndmask_b32 v90, v5, 0, s[42:43]
    s_and_b32 s61, s3, 1
    s_lshl_b32 s61, s61, 2
    v_add_lshl_u32 v88, v88, s61, 16
    v_lshrrev_b32 v4, 2, v3
    v_lshl_add_u32 v4, v2, 3, v4
    v_lshlrev_b32 v4, 6, v4
    v_and_b32 v5, 3, v1
    v_lshl_add_u32 v4, v5, 3, v4
    v_and_b32 v5, 16, v1
    v_lshl_add_u32 v4, v5, 1, v4
    s_lshl_b32 s61, s3, 12
    s_cmp_lg_u32 s3, 1
    s_cbranch_scc1 P_dB
    s_mov_b32 s9, 0
P_lB:
    buffer_load_dword v21, v94, s[36:39], s50 offen sc1
    s_waitcnt vmcnt(1)
    v_cmp_ne_u32 vcc, s12, v20
    s_nop 0
    s_cbranch_vccz P_dB
    buffer_load_dword v20, v94, s[36:39], s50 offen sc1
    s_waitcnt vmcnt(1)
    v_cmp_ne_u32 vcc, s12, v21
    s_nop 0
    s_cbranch_vccz P_dB
    s_add_u32 s9, s9, 1
    s_cmp_lt_u32 s9, 200000
    s_cbranch_scc1 P_lB
P_dB:
    s_lshl_b32 s40, s3, 12
    s_add_u32 m0, s40, 0
    s_waitcnt lgkmcnt(0)
    s_barrier
    buffer_load_dwordx4 v60, s[36:39], s60 offen offset:0 sc1 lds
    buffer_load_dwordx4 v60, s[36:39], s60 offen offset:1024 sc1 lds
    buffer_load_dwordx4 v60, s[36:39], s60 offen offset:2048 sc1 lds
    buffer_load_dwordx4 v60, s[36:39], s60 offen offset:3072 sc1 lds
    ds_read_b128 v[120:123], v67 offset:0
    ds_read_b128 v[124:127], v67 offset:1024
    ds_read_b128 v[128:131], v67 offset:2048
    ds_read_b128 v[132:135], v67 offset:3072
    ds_read_b128 v[136:139], v67 offset:4096
    ds_read_b128 v[140:143], v67 offset:5120
    ds_read_b128 v[144:147], v67 offset:6144
    ds_read_b128 v[148:151], v67 offset:7168
    ds_read_b128 v[152:155], v67 offset:8192
    ds_read_b128 v[156:159], v67 offset:9216
    ds_read_b128 v[160:163], v67 offset:10240
    ds_read_b128 v[164:167], v67 offset:11264
    ds_read_b128 v[168:171], v67 offset:12288
    ds_read_b128 v[172:175], v67 offset:13312
    ds_read_b128 v[176:179], v67 offset:14336
    ds_read_b128 v[180:183], v67 offset:15360
    v_add_u32 v62, s61, v4
    v_xor_b32 v61, 32, v62
    v_add_u32 v89, s61, v63
    s_lshr_b32 s61, s3, 1
    s_lshl_b32 s61, s61, 13
    s_and_b32 s62, s3, 1
    s_lshl_b32 s62, s62, 10
    s_add_u32 s61, s61, s62
    v_add_u32 v91, s61, v63
    v_mov_b32 v68, 81920
    v_lshl_add_u32 v68, s56, 2, v68
    v_mov_b32 v75, 1
    s_lshl_b32 s61, s56, 11
    v_add_u32 v69, s61, v63
    s_lshl_b32 s61, s56, 4
    v_add_u32 v4, s61, v3
    v_mul_u32_u24 v4, 528, v4
    v_add_u32 v4, 98304, v4
    v_lshl_add_u32 v5, s55, 2, v2
    v_lshl_add_u32 v64, v5, 4, v4
    s_and_b32 s61, s3, 1
    s_lshl_b32 s61, s61, 3
    v_lshrrev_b32 v4, 3, v1
    v_add_u32 v4, s61, v4
    v_and_b32 v5, 7, v1
    v_lshlrev_b32 v5, 4, v5
    s_and_b32 s61, s3, 2
    s_add_u32 s61, s61, s56
    s_mul_i32 s61, s61, 8448
    s_add_u32 s61, s61, 98304
    v_mul_u32_u24 v96, 528, v4
    v_add3_u32 v65, v96, v5, s61
    v_add_u32 v97, s61, v96
    s_bitcmp1_b32 s3, 1
    s_cselect_b32 s62, -1, 1
    s_mul_i32 s62, s62, 16896
    v_add_u32 v71, s62, v97
    s_cmp_eq_u32 s56, 0
    s_cselect_b32 s61, s8, s63
    v_lshl_add_u32 v66, v4, 6, s61
    v_sub_u32 v96, 2048, v66
    v_mov_b32 v4, 1024
    v_cmp_eq_u32 s[42:43], 0, v66
    s_nop 1
    v_cndmask_b32 v96, v96, v4, s[42:43]
    v_cndmask_b32 v71, v71, v97, s[42:43]
    s_bitcmp1_b32 s3, 1
    s_cselect_b64 s[42:43], -1, 0
    v_cndmask_b32 v66, v66, v96, s[42:43]
    v_mov_b32 v96, 1792
    v_mad_u32_u24 v66, v66, v96, v5
    v_sub_u32 v71, v71, v5
    v_and_b32 v4, 4, v1
    v_lshl_add_u32 v70, v4, 5, v65
    v_lshl_add_u32 v73, v4, 5, v66
    v_lshlrev_b32 v4, 4, v4
    v_sub_u32 v72, v71, v4
    v_mov_b32 v74, 0xffff
    v_xor_b32 v88, s51, v88
    s_mov_b32 s9, 0
    s_waitcnt lgkmcnt(0)
S_gc:
    s_waitcnt vmcnt(2)
    ds_read_b64_tr_b16 v[184:185], v62 offset:0
    ds_read_b64_tr_b16 v[186:187], v62 offset:256
    ds_read_b64_tr_b16 v[192:193], v61 offset:0
    ds_read_b64_tr_b16 v[194:195], v61 offset:256
    ds_read_b32 v102, v89 offset:12
    ds_read_b32 v103, v89 offset:1036
    s_waitcnt lgkmcnt(4)
    v_mfma_f32_16x16x32_bf16 v[200:203], v[184:187], v[28:31], 0
    v_mfma_f32_16x16x32_bf16 v[208:211], v[184:187], v[36:39], 0
    v_mfma_f32_16x16x32_bf16 v[216:219], v[184:187], v[44:47], 0
    v_mfma_f32_16x16x32_bf16 v[224:227], v[184:187], v[52:55], 0
    s_waitcnt vmcnt(0)
    ds_read_b64_tr_b16 v[188:189], v62 offset:2048
    ds_read_b64_tr_b16 v[190:191], v62 offset:2304
    ds_read_b64_tr_b16 v[196:197], v61 offset:2048
    ds_read_b64_tr_b16 v[198:199], v61 offset:2304
    ds_read_b32 v104, v89 offset:2060
    ds_read_b32 v105, v89 offset:3084
    s_waitcnt lgkmcnt(8)
    v_mfma_f32_16x16x32_bf16 v[204:207], v[192:195], v[28:31], 0
    v_mfma_f32_16x16x32_bf16 v[212:215], v[192:195], v[36:39], 0
    v_mfma_f32_16x16x32_bf16 v[220:223], v[192:195], v[44:47], 0
    v_mfma_f32_16x16x32_bf16 v[228:231], v[192:195], v[52:55], 0
    s_waitcnt lgkmcnt(4)
    v_mfma_f32_16x16x32_bf16 v[200:203], v[188:191], v[32:35], v[200:203]
    s_waitcnt lgkmcnt(2)
    v_mfma_f32_16x16x32_bf16 v[204:207], v[196:199], v[32:35], v[204:207]
    s_waitcnt lgkmcnt(0)
    v_xor_b32 v102, v88, v102
    v_xor_b32 v103, v88, v103
    v_xor_b32 v104, v88, v104
    v_mfma_f32_16x16x32_bf16 v[208:211], v[188:191], v[40:43], v[208:211]
    v_xor_b32 v105, v88, v105
    v_or_b32 v102, v102, v103
    v_or3_b32 v102, v102, v104, v105
    v_mfma_f32_16x16x32_bf16 v[212:215], v[196:199], v[40:43], v[212:215]
    v_and_b32 v102, v90, v102
    v_cmp_ne_u32 vcc, 0, v102
    v_mfma_f32_16x16x32_bf16 v[216:219], v[188:191], v[48:51], v[216:219]
    v_mfma_f32_16x16x32_bf16 v[220:223], v[196:199], v[48:51], v[220:223]
    v_cvt_pk_bf16_f32 v232, v200, v201
    v_cvt_pk_bf16_f32 v233, v202, v203
    v_cvt_pk_bf16_f32 v234, v204, v205
    v_cvt_pk_bf16_f32 v235, v206, v207
    ds_write_b128 v91, v[232:235] offset:32768
    v_mfma_f32_16x16x32_bf16 v[224:227], v[188:191], v[56:59], v[224:227]
    v_mfma_f32_16x16x32_bf16 v[228:231], v[196:199], v[56:59], v[228:231]
    v_cvt_pk_bf16_f32 v236, v208, v209
    v_cvt_pk_bf16_f32 v237, v210, v211
    v_cvt_pk_bf16_f32 v238, v212, v213
    v_cvt_pk_bf16_f32 v239, v214, v215
    ds_write_b128 v91, v[236:239] offset:36864
    s_cbranch_vccnz S_gr
S_gk:
    v_cvt_pk_bf16_f32 v240, v216, v217
    v_cvt_pk_bf16_f32 v241, v218, v219
    v_cvt_pk_bf16_f32 v242, v220, v221
    v_cvt_pk_bf16_f32 v243, v222, v223
    ds_write_b128 v91, v[240:243] offset:34816
    v_cvt_pk_bf16_f32 v244, v224, v225
    v_cvt_pk_bf16_f32 v245, v226, v227
    v_cvt_pk_bf16_f32 v246, v228, v229
    v_cvt_pk_bf16_f32 v247, v230, v231
    ds_write_b128 v91, v[244:247] offset:38912
    s_waitcnt lgkmcnt(0)
    s_barrier
    s_cmp_lg_u32 s56, 0
    s_cbranch_scc1 S_np
    s_setprio 1
S_np:
    ds_read_b128 v[184:187], v69 offset:32768
    ds_read_b128 v[188:191], v69 offset:33792
    ds_read_b128 v[192:195], v69 offset:40960
    ds_read_b128 v[196:199], v69 offset:41984
    ds_read_b128 v[200:203], v69 offset:49152
    ds_read_b128 v[204:207], v69 offset:50176
    ds_read_b128 v[208:211], v69 offset:57344
    s_waitcnt lgkmcnt(6)
    v_mfma_f32_16x16x32_bf16 v[216:219], v[120:123], v[184:187], 0
    ds_read_b128 v[212:215], v69 offset:58368
    s_waitcnt lgkmcnt(6)
    v_mfma_f32_16x16x32_bf16 v[216:219], v[124:127], v[188:191], v[216:219]
    ds_read_b128 v[184:187], v69 offset:53248
    s_waitcnt lgkmcnt(6)
    v_mfma_f32_16x16x32_bf16 v[220:223], v[128:131], v[192:195], 0
    ds_read_b128 v[188:191], v69 offset:54272
    s_waitcnt lgkmcnt(6)
    v_mfma_f32_16x16x32_bf16 v[220:223], v[132:135], v[196:199], v[220:223]
    ds_read_b128 v[192:195], v69 offset:61440
    s_waitcnt lgkmcnt(6)
    v_mfma_f32_16x16x32_bf16 v[232:235], v[152:155], v[200:203], 0
    ds_read_b128 v[196:199], v69 offset:62464
    s_waitcnt lgkmcnt(6)
    v_mfma_f32_16x16x32_bf16 v[232:235], v[156:159], v[204:207], v[232:235]
    ds_read_b128 v[200:203], v69 offset:36864
    s_waitcnt lgkmcnt(6)
    v_mfma_f32_16x16x32_bf16 v[236:239], v[160:163], v[208:211], 0
    ds_read_b128 v[204:207], v69 offset:37888
    s_waitcnt lgkmcnt(6)
    v_mfma_f32_16x16x32_bf16 v[236:239], v[164:167], v[212:215], v[236:239]
    ds_read_b128 v[208:211], v69 offset:45056
    s_waitcnt lgkmcnt(6)
    v_mfma_f32_16x16x32_bf16 v[224:227], v[136:139], v[184:187], 0
    ds_read_b128 v[212:215], v69 offset:46080
    s_waitcnt lgkmcnt(6)
    v_mfma_f32_16x16x32_bf16 v[224:227], v[140:143], v[188:191], v[224:227]
    s_waitcnt lgkmcnt(5)
    v_mfma_f32_16x16x32_bf16 v[228:231], v[144:147], v[192:195], 0
    v_pk_add_f32 v[102:103], v[216:217], v[220:221]
    v_pk_add_f32 v[104:105], v[218:219], v[222:223]
    s_waitcnt lgkmcnt(4)
    v_mfma_f32_16x16x32_bf16 v[228:231], v[148:151], v[196:199], v[228:231]
    v_pk_add_f32 v[220:221], v[216:217], v[220:221] neg_lo:[0,1] neg_hi:[0,1]
    v_pk_add_f32 v[222:223], v[218:219], v[222:223] neg_lo:[0,1] neg_hi:[0,1]
    s_waitcnt lgkmcnt(3)
    v_mfma_f32_16x16x32_bf16 v[240:243], v[168:171], v[200:203], 0
    v_pk_add_f32 v[106:107], v[232:233], v[236:237]
    s_waitcnt lgkmcnt(2)
    v_mfma_f32_16x16x32_bf16 v[240:243], v[172:175], v[204:207], v[240:243]
    v_pk_add_f32 v[108:109], v[234:235], v[238:239]
    s_waitcnt lgkmcnt(1)
    v_mfma_f32_16x16x32_bf16 v[244:247], v[176:179], v[208:211], 0
    v_pk_add_f32 v[236:237], v[232:233], v[236:237] neg_lo:[0,1] neg_hi:[0,1]
    s_waitcnt lgkmcnt(0)
    v_mfma_f32_16x16x32_bf16 v[244:247], v[180:183], v[212:215], v[244:247]
    v_pk_add_f32 v[238:239], v[234:235], v[238:239] neg_lo:[0,1] neg_hi:[0,1]
    s_add_u32 s40, s8, s56
    s_cmp_eq_u32 s40, 0
    s_cbranch_scc1 S_y0
S_y1:
    v_pk_add_f32 v[216:217], v[224:225], v[228:229]
    v_pk_add_f32 v[218:219], v[226:227], v[230:231]
    v_pk_add_f32 v[228:229], v[224:225], v[228:229] neg_lo:[0,1] neg_hi:[0,1]
    v_pk_add_f32 v[230:231], v[226:227], v[230:231] neg_lo:[0,1] neg_hi:[0,1]
    v_pk_add_f32 v[232:233], v[240:241], v[244:245]
    v_pk_add_f32 v[234:235], v[242:243], v[246:247]
    v_pk_add_f32 v[244:245], v[240:241], v[244:245] neg_lo:[0,1] neg_hi:[0,1]
    v_pk_add_f32 v[246:247], v[242:243], v[246:247] neg_lo:[0,1] neg_hi:[0,1]
    v_pk_add_f32 v[224:225], v[102:103], v[216:217]
    v_pk_add_f32 v[226:227], v[104:105], v[218:219]
    v_pk_add_f32 v[240:241], v[106:107], v[232:233]
    v_pk_add_f32 v[242:243], v[108:109], v[234:235]
    v_cvt_pk_bf16_f32 v184, v224, v240
    v_cvt_pk_bf16_f32 v185, v225, v241
    v_cvt_pk_bf16_f32 v186, v226, v242
    v_cvt_pk_bf16_f32 v187, v227, v243
    ds_write_b128 v64, v[184:187] offset:0
    v_pk_add_f32 v[224:225], v[102:103], v[216:217] neg_lo:[0,1] neg_hi:[0,1]
    v_pk_add_f32 v[226:227], v[104:105], v[218:219] neg_lo:[0,1] neg_hi:[0,1]
    v_pk_add_f32 v[240:241], v[106:107], v[232:233] neg_lo:[0,1] neg_hi:[0,1]
    v_pk_add_f32 v[242:243], v[108:109], v[234:235] neg_lo:[0,1] neg_hi:[0,1]
    v_cvt_pk_bf16_f32 v188, v224, v240
    v_cvt_pk_bf16_f32 v189, v225, v241
    v_cvt_pk_bf16_f32 v190, v226, v242
    v_cvt_pk_bf16_f32 v191, v227, v243
    ds_write_b128 v64, v[188:191] offset:16896
    v_pk_add_f32 v[224:225], v[220:221], v[228:229]
    v_pk_add_f32 v[226:227], v[222:223], v[230:231]
    v_pk_add_f32 v[240:241], v[236:237], v[244:245]
    v_pk_add_f32 v[242:243], v[238:239], v[246:247]
    v_cvt_pk_bf16_f32 v192, v224, v240
    v_cvt_pk_bf16_f32 v193, v225, v241
    v_cvt_pk_bf16_f32 v194, v226, v242
    v_cvt_pk_bf16_f32 v195, v227, v243
    ds_write_b128 v64, v[192:195] offset:256
    v_pk_add_f32 v[224:225], v[220:221], v[228:229] neg_lo:[0,1] neg_hi:[0,1]
    v_pk_add_f32 v[226:227], v[222:223], v[230:231] neg_lo:[0,1] neg_hi:[0,1]
    v_pk_add_f32 v[240:241], v[236:237], v[244:245] neg_lo:[0,1] neg_hi:[0,1]
    v_pk_add_f32 v[242:243], v[238:239], v[246:247] neg_lo:[0,1] neg_hi:[0,1]
    v_cvt_pk_bf16_f32 v196, v224, v240
    v_cvt_pk_bf16_f32 v197, v225, v241
    v_cvt_pk_bf16_f32 v198, v226, v242
    v_cvt_pk_bf16_f32 v199, v227, v243
    ds_write_b128 v64, v[196:199] offset:17152
    s_mov_b64 exec, 1
    ds_add_u32 v68, v75
    s_mov_b64 exec, -1
    s_mov_b32 s9, 0
W_lO:
    ds_read_b32 v4, v68 offset:0
    s_add_u32 s9, s9, 1
    s_cmp_gt_u32 s9, 1600000
    s_cbranch_scc1 W_dO
    s_waitcnt lgkmcnt(0)
    v_cmp_gt_u32 vcc, 4, v4
    s_nop 0
    s_cbranch_vccnz W_lO
W_dO:
    v_and_b32 v4, 4, v1
    v_lshl_add_u32 v5, v4, 6, v66
    ds_read_b128 v[120:123], v65 offset:0
    ds_read_b128 v[124:127], v65 offset:128
    ds_read_b128 v[128:131], v65 offset:320
    ds_read_b128 v[132:135], v70 offset:256
    ds_read_b128 v[136:139], v71 offset:432
    ds_read_b32 v140, v71 offset:448
    ds_read_b128 v[144:147], v71 offset:112
    ds_read_b32 v148, v71 offset:128
    ds_read_b128 v[152:155], v72 offset:304
    ds_read_b32 v156, v72 offset:320
    s_waitcnt lgkmcnt(9)
    buffer_store_dwordx4 v[120:123], v66, s[32:35], 0 offen offset:896 nt
    s_waitcnt lgkmcnt(8)
    buffer_store_dwordx4 v[124:127], v66, s[32:35], 0 offen offset:1024 nt
    s_waitcnt lgkmcnt(7)
    buffer_store_dwordx4 v[128:131], v66, s[32:35], 0 offen offset:1408 nt
    s_waitcnt lgkmcnt(6)
    buffer_store_dwordx4 v[132:135], v73, s[32:35], 0 offen offset:1344 nt
    s_waitcnt lgkmcnt(4)
    v_bfi_b32 v160, v74, v140, v139
    v_bfi_b32 v161, v74, v139, v138
    v_bfi_b32 v162, v74, v138, v137
    v_bfi_b32 v163, v74, v137, v136
    buffer_store_dwordx4 v[160:163], v66, s[32:35], 0 offen offset:1152 nt
    s_waitcnt lgkmcnt(2)
    v_bfi_b32 v164, v74, v148, v147
    v_bfi_b32 v165, v74, v147, v146
    v_bfi_b32 v166, v74, v146, v145
    v_bfi_b32 v167, v74, v145, v144
    buffer_store_dwordx4 v[164:167], v66, s[32:35], 0 offen offset:1664 nt
    s_waitcnt lgkmcnt(0)
    v_bfi_b32 v168, v74, v156, v155
    v_bfi_b32 v169, v74, v155, v154
    v_bfi_b32 v170, v74, v154, v153
    v_bfi_b32 v171, v74, v153, v152
    buffer_store_dwordx4 v[168:171], v5, s[32:35], 0 offen offset:1280 nt
    s_add_u32 s40, s8, s3
    s_cmp_lg_u32 s40, 0
    s_cbranch_scc1 S_end
    s_add_u32 s40, s10, 16
    v_mov_b32 v4, s40
    s_mov_b32 s40, 4096
    s_mov_b64 exec, 1
    buffer_store_dword v4, v12, s[36:39], s40 offen
S_end:
    s_endpgm
    s_endpgm
    s_endpgm
    s_endpgm
    s_endpgm
    s_endpgm
    s_endpgm
    s_endpgm
    s_endpgm
    s_endpgm
    s_endpgm
    s_endpgm
    s_endpgm
    s_endpgm
    s_endpgm
    s_endpgm
    s_endpgm
    s_endpgm
    s_endpgm
    s_endpgm
    s_endpgm
    s_endpgm
    s_endpgm
    s_endpgm
    s_endpgm
    s_endpgm
    s_endpgm
    s_endpgm
    s_endpgm
    s_endpgm
    s_endpgm
    s_endpgm
    s_endpgm
    s_endpgm
    s_endpgm
    s_endpgm
    s_endpgm
    s_endpgm
    s_endpgm
    s_endpgm
    s_endpgm
    s_endpgm
    s_endpgm
    s_endpgm
    s_endpgm
    s_endpgm
    s_endpgm
    s_endpgm
    s_endpgm
    s_endpgm
    s_endpgm
    s_endpgm
    s_endpgm
    s_endpgm
    s_endpgm
    s_endpgm
    s_endpgm
    s_endpgm
    s_endpgm
    s_endpgm
    s_endpgm
    s_endpgm
    s_endpgm
    s_endpgm
    s_endpgm
    s_endpgm
    s_endpgm
    s_endpgm
    s_endpgm
    s_endpgm
    s_endpgm
    s_endpgm
    s_endpgm
    s_endpgm
    s_endpgm
    s_endpgm
    s_endpgm
    s_endpgm
    s_endpgm
    s_endpgm
    s_endpgm
    s_endpgm
    s_endpgm
    s_endpgm
    s_endpgm
    s_endpgm
    s_endpgm
    s_endpgm
    s_endpgm
    s_endpgm
    s_endpgm
    s_endpgm
    s_endpgm
    s_endpgm
    s_endpgm
    s_endpgm
    s_endpgm
    s_endpgm
    s_endpgm
    s_endpgm
    s_endpgm
    s_endpgm
    s_endpgm
    s_endpgm
    s_endpgm
    s_endpgm
    s_endpgm
    s_endpgm
    s_endpgm
    s_endpgm
    s_endpgm
    s_endpgm
    s_endpgm
    s_endpgm
    s_endpgm
    s_endpgm
    s_endpgm
    s_endpgm
    s_endpgm
    s_endpgm
    s_endpgm
    s_endpgm
    s_endpgm
    s_endpgm
    s_endpgm
    s_endpgm
    s_endpgm
    s_endpgm
    s_endpgm
K_c:
    s_lshl_b32 s40, s8, 7
    s_waitcnt lgkmcnt(0)
    s_load_dwordx2 s[10:11], s[36:37], s40
    s_lshl_b32 s14, s8, 10
    s_add_u32 s14, s14, 65536
    s_getreg_b32 s52, hwreg(HW_REG_XCC_ID, 0, 3)
    s_mov_b32 s26, 401408
    s_mov_b32 s27, 0x00020000
    s_mov_b32 s34, 3670016
    s_mov_b32 s35, 0x00020000
    s_sub_u32 s62, s3, 4
    s_lshr_b32 s16, s62, 1
    s_and_b32 s17, s62, 1
    s_lshl_b32 s29, s62, 11
    v_and_b32 v1, 63, v0
    v_lshlrev_b32 v4, 4, v1
    s_lshl_b32 s1, s5, 3
    s_add_u32 s1, s1, s4
    s_mul_i32 s1, s1, 1792
    v_min_u32 v46, 13, v1
    v_lshlrev_b32 v46, 7, v46
    v_lshrrev_b32 v29, 4, v1
    v_and_b32 v30, 15, v1
    v_lshrrev_b32 v31, 3, v1
    v_and_b32 v32, 7, v1
    v_mov_b32 v5, 161792
    v_mov_b32 v6, 0
    v_lshl_add_u32 v2, v1, 2, v5
    ds_write_b32 v2, v6
    v_lshrrev_b32 v3, 1, v30
    v_xor_b32 v3, v3, v29
    v_lshlrev_b32 v3, 4, v3
    v_lshl_add_u32 v3, v30, 7, v3
    s_lshr_b32 s18, s62, 1
    s_lshl_b32 s18, s18, 12
    v_add_u32 v33, s18, v3
    v_xor_b32 v34, 64, v33
    v_add_u32 v35, 40960, v33
    v_add_u32 v36, 40960, v34
    v_lshrrev_b32 v3, 2, v30
    v_lshl_add_u32 v3, v29, 3, v3
    v_lshlrev_b32 v3, 7, v3
    v_and_b32 v7, 3, v1
    v_lshl_add_u32 v3, v7, 3, v3
    v_bfe_u32 v7, v1, 3, 2
    s_and_b32 s18, s62, 1
    s_lshl_b32 s18, s18, 1
    v_xor_b32 v7, s18, v7
    v_lshl_add_u32 v3, v7, 5, v3
    v_add_u32 v37, 71680, v3
    v_xor_b32 v38, 32, v37
    v_add_u32 v39, 49152, v37
    v_add_u32 v40, 49152, v38
    s_and_b32 s18, s62, 1
    s_lshl_b32 s19, s7, 1
    s_add_u32 s18, s18, s19
    s_cmp_ge_u32 s18, 7
    s_cselect_b32 s19, 14, 7
    s_sub_u32 s18, s19, s18
    v_cmp_gt_u32 s[54:55], s18, v29
    v_add_u32 v2, 4, v29
    v_cmp_gt_u32 s[56:57], s18, v2
    s_bitcmp0_b32 s62, 0
    s_cselect_b64 vcc, -1, 0
    s_xor_b64 s[54:55], s[54:55], vcc
    s_xor_b64 s[56:57], s[56:57], vcc
    v_lshrrev_b32 v3, 2, v30
    s_and_b32 s18, s62, 1
    s_lshl_b32 s19, s7, 1
    s_add_u32 s18, s18, s19
    s_cmp_ge_u32 s18, 7
    s_cselect_b32 s19, 14, 7
    s_sub_u32 s18, s19, s18
    v_cmp_gt_u32 s[58:59], s18, v3
    v_add_u32 v2, 4, v3
    v_cmp_gt_u32 s[60:61], s18, v2
    s_bitcmp0_b32 s62, 0
    s_cselect_b64 vcc, -1, 0
    s_xor_b64 s[58:59], s[58:59], vcc
    s_xor_b64 s[60:61], s[60:61], vcc
    s_and_b32 s18, s62, 1
    s_lshl_b32 s19, s7, 1
    s_add_u32 s18, s18, s19
    s_lshl_b32 s100, s18, 10
    s_lshl_b32 s18, s8, 2
    s_and_b32 s19, s62, 2
    s_add_u32 s18, s18, s19
    s_mul_i32 s19, s18, 14336
    s_add_u32 s100, s100, s19
    s_add_u32 s100, s100, 2097152
    s_lshl_b32 s20, s18, 6
    s_add_u32 s20, s20, 16384
    s_lshl_b32 s18, s17, 11
    s_sub_u32 s18, s18, 1024
    s_add_u32 s15, s100, s18
    s_lshl_b32 s19, s7, 1
    s_add_u32 s18, s17, s19
    s_lshl_b32 s18, s18, 3
    s_add_u32 s21, s20, s18
    v_and_b32 v2, 1, v30
    v_cmp_eq_u32 s[44:45], 1, v2
    v_lshl_add_u32 v2, v29, 2, v2
    v_cmp_le_u32 s[46:47], v2, v30
    v_add_u32 v2, 2, v2
    v_cmp_le_u32 s[48:49], v2, v30
    v_mov_b32 v2, 0xffff
    v_mov_b32 v3, 0xffff0000
    v_cndmask_b32 v2, v2, v3, s[44:45]
    v_cndmask_b32 v41, v2, 0, s[46:47]
    v_cndmask_b32 v42, v2, 0, s[48:49]
    v_cndmask_b32 v43, 0, v2, s[46:47]
    v_cndmask_b32 v44, 0, v2, s[48:49]
    s_add_u32 s18, s8, s16
    s_cmp_eq_u32 s18, 0
    s_cselect_b64 s[50:51], -1, 0
    s_mul_i32 s18, s17, 6
    s_cmp_eq_u32 s18, s7
    s_cselect_b32 s101, 1, 0
    v_mov_b32 v49, 1
    v_mov_b32 v50, 0xf149f2ca
    v_mov_b32 v51, 0xffffff00
    s_mov_b32 s0, 0x3e8b97f6
    s_add_u32 s18, s29, 4096
    v_add_u32 v47, s18, v4
    v_add_u32 v48, s29, v4
    v_lshl_add_u32 v52, s62, 2, v5
    v_lshl_add_u32 v222, s17, 10, v4
    v_add_u32 v223, 2048, v222
    v_lshl_add_u32 v224, s17, 2, v5
    v_lshl_add_u32 v225, s17, 3, v5
    s_lshl_b32 s18, s7, 7
    v_min_u32 v8, 11, v1
    s_lshl_b32 s19, s7, 1
    s_add_u32 s19, s19, 2
    v_add_u32 v8, s19, v8
    v_add_u32 v2, -14, v8
    v_min_u32 v8, v8, v2
    v_lshlrev_b32 v8, 3, v8
    v_lshl_add_u32 v18, s16, 12, v222
    v_add_u32 v19, s29, v4
    v_lshl_add_u32 v20, s16, 3, v5
    v_lshrrev_b32 v2, 2, v1
    v_bfe_u32 v3, v1, 3, 2
    v_lshlrev_b32 v3, 5, v3
    v_lshl_add_u32 v2, v2, 7, v3
    v_and_b32 v3, 3, v1
    v_lshl_add_u32 v2, v3, 3, v2
    v_add_u32 v21, 71680, v2
    v_xor_b32 v22, 32, v21
    v_xor_b32 v23, 64, v21
    v_xor_b32 v24, 96, v21
    s_add_u32 s19, s29, 4096
    v_lshrrev_b32 v2, 1, v29
    v_xor_b32 v2, v2, v32
    v_lshlrev_b32 v2, 4, v2
    v_lshl_add_u32 v2, v30, 7, v2
    v_and_b32 v3, 1, v29
    v_lshl_add_u32 v2, v3, 3, v2
    v_add_u32 v25, s19, v2
    v_xor_b32 v26, 32, v25
    v_xor_b32 v27, 64, v25
    v_xor_b32 v28, 96, v25
    v_mul_u32_u24 v10, 1792, v31
    v_lshl_add_u32 v10, v32, 4, v10
    v_xor_b32 v3, v32, v31
    v_lshlrev_b32 v3, 4, v3
    v_lshl_add_u32 v2, v31, 7, v3
    v_add_u32 v9, s19, v2
    s_lshl_b32 s19, s8, 2
    s_add_u32 s19, s19, s62
    s_mul_i32 s22, s19, 14336
    s_add_u32 s22, s22, 2097152
    s_mul_i32 s23, s19, 28672
    s_add_u32 s23, s23, s18
    s_add_u32 s28, s23, 14336
    s_waitcnt lgkmcnt(0)
    s_add_u32 s40, s7, 1
    s_sub_u32 s41, s40, 7
    s_min_u32 s40, s40, s41
    s_lshl_b32 s40, s40, 11
    s_add_u32 s1, s40, s22
    s_add_u32 s40, s7, 2
    s_sub_u32 s41, s40, 7
    s_min_u32 s40, s40, s41
    s_lshl_b32 s40, s40, 11
    s_add_u32 s4, s40, s22
    s_add_u32 s40, s7, 3
    s_sub_u32 s41, s40, 7
    s_min_u32 s40, s40, s41
    s_lshl_b32 s40, s40, 11
    s_add_u32 s6, s40, s22
    s_add_u32 s40, s7, 4
    s_sub_u32 s41, s40, 7
    s_min_u32 s40, s40, s41
    s_lshl_b32 s40, s40, 11
    s_add_u32 s24, s40, s22
    s_add_u32 s40, s7, 5
    s_sub_u32 s41, s40, 7
    s_min_u32 s40, s40, s41
    s_lshl_b32 s40, s40, 11
    s_add_u32 s25, s40, s22
    s_add_u32 s40, s7, 6
    s_sub_u32 s41, s40, 7
    s_min_u32 s40, s40, s41
    s_lshl_b32 s40, s40, 11
    s_add_u32 s26, s40, s22
    s_add_u32 s12, s10, 0x5a3c9671
    s_xor_b32 s13, s11, 0x2b7e1516
    s_add_u32 s52, s52, s12
    s_mov_b32 s53, s13
    v_mov_b32 v14, s12
    v_mov_b32 v15, s13
    s_bfe_u32 s40, s12, 0x80000
    v_mov_b32 v54, s40
    s_bfe_u32 s40, s12, 0x80008
    v_mov_b32 v55, s40
    s_bfe_u32 s40, s12, 0x80010
    v_mov_b32 v56, s40
    s_bfe_u32 s40, s12, 0x80018
    v_mov_b32 v57, s40
    s_setprio 3
    s_cmp_lg_u32 s62, 0
    s_cbranch_scc1 C_nox
    v_mov_b32 v12, s52
    v_mov_b32 v13, s53
    s_lshl_b32 s41, s7, 3
    s_add_u32 s40, s14, s41
    s_mov_b64 exec, 1
    buffer_store_dwordx2 v[12:13], v6, s[36:39], s40 offen sc1
    s_mov_b64 exec, -1
C_nox:
    s_cmp_lg_u32 s16, 0
    s_cbranch_scc1 C_tp1
    s_barrier
    ds_read_b128 v[134:137], v33 offset:2048
    ds_read_b64_tr_b16 v[178:179], v37 offset:8192
    ds_read_b64_tr_b16 v[180:181], v37 offset:8704
    ds_read_b128 v[146:149], v34 offset:2048
    ds_read_b64_tr_b16 v[182:183], v37 offset:12288
    ds_read_b64_tr_b16 v[184:185], v37 offset:12800
    ds_read_b128 v[138:141], v33 offset:4096
    ds_read_b128 v[150:153], v34 offset:4096
    ds_read_b64_tr_b16 v[186:187], v38 offset:8192
    ds_read_b64_tr_b16 v[188:189], v38 offset:8704
    ds_read_b64_tr_b16 v[190:191], v38 offset:12288
    ds_read_b64_tr_b16 v[192:193], v38 offset:12800
    s_waitcnt lgkmcnt(9)
    v_mfma_f32_16x16x32_bf16 v[66:69], v[178:181], v[134:137], 0
    ds_read_b128 v[130:133], v33 offset:0
    s_waitcnt lgkmcnt(7)
    v_mfma_f32_16x16x32_bf16 v[66:69], v[182:185], v[146:149], v[66:69]
    ds_read_b64_tr_b16 v[194:195], v37 offset:16384
    ds_read_b64_tr_b16 v[196:197], v37 offset:16896
    s_waitcnt lgkmcnt(8)
    v_mfma_f32_16x16x32_bf16 v[74:77], v[178:181], v[138:141], 0
    ds_read_b128 v[142:145], v34 offset:0
    ds_read_b64_tr_b16 v[198:199], v37 offset:20480
    s_waitcnt lgkmcnt(9)
    v_mfma_f32_16x16x32_bf16 v[74:77], v[182:185], v[150:153], v[74:77]
    ds_read_b64_tr_b16 v[200:201], v37 offset:20992
    s_waitcnt lgkmcnt(8)
    v_mfma_f32_16x16x32_bf16 v[70:73], v[186:189], v[134:137], 0
    ds_read_b64_tr_b16 v[178:179], v38 offset:16384
    s_waitcnt lgkmcnt(7)
    v_mfma_f32_16x16x32_bf16 v[70:73], v[190:193], v[146:149], v[70:73]
    ds_read_b64_tr_b16 v[180:181], v38 offset:16896
    v_mfma_f32_16x16x32_bf16 v[78:81], v[186:189], v[138:141], 0
    ds_read_b64_tr_b16 v[182:183], v38 offset:20480
    v_mfma_f32_16x16x32_bf16 v[78:81], v[190:193], v[150:153], v[78:81]
    ds_read_b64_tr_b16 v[184:185], v38 offset:20992
    s_waitcnt lgkmcnt(7)
    v_mfma_f32_16x16x32_bf16 v[82:85], v[194:197], v[130:133], 0
    ds_read_b64_tr_b16 v[186:187], v37 offset:24576
    s_waitcnt lgkmcnt(5)
    v_mfma_f32_16x16x32_bf16 v[82:85], v[198:201], v[142:145], v[82:85]
    ds_read_b64_tr_b16 v[188:189], v37 offset:25088
    v_mfma_f32_16x16x32_bf16 v[90:93], v[194:197], v[134:137], 0
    ds_read_b64_tr_b16 v[190:191], v37 offset:28672
    v_mfma_f32_16x16x32_bf16 v[90:93], v[198:201], v[146:149], v[90:93]
    ds_read_b64_tr_b16 v[192:193], v37 offset:29184
    v_mfma_f32_16x16x32_bf16 v[98:101], v[194:197], v[138:141], 0
    ds_read_b64_tr_b16 v[194:195], v38 offset:24576
    v_mfma_f32_16x16x32_bf16 v[98:101], v[198:201], v[150:153], v[98:101]
    ds_read_b64_tr_b16 v[196:197], v38 offset:25088
    s_waitcnt lgkmcnt(8)
    v_mfma_f32_16x16x32_bf16 v[86:89], v[178:181], v[130:133], 0
    ds_read_b64_tr_b16 v[198:199], v38 offset:28672
    s_waitcnt lgkmcnt(7)
    v_mfma_f32_16x16x32_bf16 v[86:89], v[182:185], v[142:145], v[86:89]
    ds_read_b64_tr_b16 v[200:201], v38 offset:29184
    v_mfma_f32_16x16x32_bf16 v[94:97], v[178:181], v[134:137], 0
    v_mfma_f32_16x16x32_bf16 v[94:97], v[182:185], v[146:149], v[94:97]
    v_mfma_f32_16x16x32_bf16 v[102:105], v[178:181], v[138:141], 0
    v_mfma_f32_16x16x32_bf16 v[102:105], v[182:185], v[150:153], v[102:105]
    s_waitcnt lgkmcnt(6)
    v_mfma_f32_16x16x32_bf16 v[106:109], v[130:133], v[186:189], 0
    s_waitcnt lgkmcnt(4)
    v_mfma_f32_16x16x32_bf16 v[106:109], v[142:145], v[190:193], v[106:109]
    v_mfma_f32_16x16x32_bf16 v[114:117], v[134:137], v[186:189], 0
    v_mfma_f32_16x16x32_bf16 v[114:117], v[146:149], v[190:193], v[114:117]
    s_waitcnt lgkmcnt(2)
    v_mfma_f32_16x16x32_bf16 v[110:113], v[130:133], v[194:197], 0
    s_waitcnt lgkmcnt(0)
    s_barrier
    ds_read_b128 v[158:161], v33 offset:12288
    ds_read_b64_tr_b16 v[178:179], v37 offset:32768
    ds_read_b64_tr_b16 v[180:181], v37 offset:33280
    ds_read_b128 v[170:173], v34 offset:12288
    ds_read_b64_tr_b16 v[182:183], v37 offset:36864
    ds_read_b64_tr_b16 v[184:185], v37 offset:37376
    ds_read_b128 v[162:165], v33 offset:14336
    ds_read_b128 v[174:177], v34 offset:14336
    ds_read_b64_tr_b16 v[186:187], v38 offset:32768
    ds_read_b64_tr_b16 v[188:189], v38 offset:33280
    ds_read_b64_tr_b16 v[190:191], v38 offset:36864
    ds_read_b64_tr_b16 v[192:193], v38 offset:37376
    ds_read_b128 v[154:157], v33 offset:10240
    v_mfma_f32_16x16x32_bf16 v[110:113], v[142:145], v[198:201], v[110:113]
    v_mfma_f32_16x16x32_bf16 v[118:121], v[134:137], v[194:197], 0
    ds_read_b64_tr_b16 v[194:195], v37 offset:40960
    v_mfma_f32_16x16x32_bf16 v[118:121], v[146:149], v[198:201], v[118:121]
    ds_read_b64_tr_b16 v[196:197], v37 offset:41472
    s_waitcnt lgkmcnt(12)
    v_mfma_f32_16x16x32_bf16 v[66:69], v[178:181], v[158:161], v[66:69]
    ds_read_b128 v[166:169], v34 offset:10240
    s_waitcnt lgkmcnt(10)
    v_mfma_f32_16x16x32_bf16 v[66:69], v[182:185], v[170:173], v[66:69]
    ds_read_b64_tr_b16 v[198:199], v37 offset:45056
    s_waitcnt lgkmcnt(10)
    v_mfma_f32_16x16x32_bf16 v[74:77], v[178:181], v[162:165], v[74:77]
    ds_read_b64_tr_b16 v[200:201], v37 offset:45568
    s_waitcnt lgkmcnt(10)
    v_mfma_f32_16x16x32_bf16 v[74:77], v[182:185], v[174:177], v[74:77]
    ds_read_b64_tr_b16 v[178:179], v38 offset:40960
    s_waitcnt lgkmcnt(9)
    v_mfma_f32_16x16x32_bf16 v[70:73], v[186:189], v[158:161], v[70:73]
    ds_read_b64_tr_b16 v[180:181], v38 offset:41472
    s_waitcnt lgkmcnt(8)
    v_mfma_f32_16x16x32_bf16 v[70:73], v[190:193], v[170:173], v[70:73]
    ds_read_b64_tr_b16 v[182:183], v38 offset:45056
    v_mfma_f32_16x16x32_bf16 v[78:81], v[186:189], v[162:165], v[78:81]
    ds_read_b64_tr_b16 v[184:185], v38 offset:45568
    v_mfma_f32_16x16x32_bf16 v[78:81], v[190:193], v[174:177], v[78:81]
    ds_read_b64_tr_b16 v[186:187], v39 offset:0
    s_waitcnt lgkmcnt(8)
    v_mfma_f32_16x16x32_bf16 v[82:85], v[194:197], v[154:157], v[82:85]
    ds_read_b64_tr_b16 v[188:189], v39 offset:512
    s_waitcnt lgkmcnt(6)
    v_mfma_f32_16x16x32_bf16 v[82:85], v[198:201], v[166:169], v[82:85]
    ds_read_b64_tr_b16 v[190:191], v39 offset:4096
    v_mfma_f32_16x16x32_bf16 v[90:93], v[194:197], v[158:161], v[90:93]
    ds_read_b64_tr_b16 v[192:193], v39 offset:4608
    v_mfma_f32_16x16x32_bf16 v[90:93], v[198:201], v[170:173], v[90:93]
    v_mfma_f32_16x16x32_bf16 v[98:101], v[194:197], v[162:165], v[98:101]
    ds_read_b64_tr_b16 v[194:195], v40 offset:0
    v_mfma_f32_16x16x32_bf16 v[98:101], v[198:201], v[174:177], v[98:101]
    ds_read_b64_tr_b16 v[196:197], v40 offset:512
    s_waitcnt lgkmcnt(8)
    v_mfma_f32_16x16x32_bf16 v[86:89], v[178:181], v[154:157], v[86:89]
    ds_read_b64_tr_b16 v[198:199], v40 offset:4096
    s_waitcnt lgkmcnt(7)
    v_mfma_f32_16x16x32_bf16 v[86:89], v[182:185], v[166:169], v[86:89]
    ds_read_b64_tr_b16 v[200:201], v40 offset:4608
    v_mfma_f32_16x16x32_bf16 v[94:97], v[178:181], v[158:161], v[94:97]
    v_mfma_f32_16x16x32_bf16 v[94:97], v[182:185], v[170:173], v[94:97]
    v_mfma_f32_16x16x32_bf16 v[102:105], v[178:181], v[162:165], v[102:105]
    v_mfma_f32_16x16x32_bf16 v[102:105], v[182:185], v[174:177], v[102:105]
    s_waitcnt lgkmcnt(6)
    v_mfma_f32_16x16x32_bf16 v[106:109], v[154:157], v[186:189], v[106:109]
    s_waitcnt lgkmcnt(4)
    v_mfma_f32_16x16x32_bf16 v[106:109], v[166:169], v[190:193], v[106:109]
    v_mfma_f32_16x16x32_bf16 v[114:117], v[158:161], v[186:189], v[114:117]
    v_mfma_f32_16x16x32_bf16 v[114:117], v[170:173], v[190:193], v[114:117]
    s_waitcnt lgkmcnt(2)
    v_mfma_f32_16x16x32_bf16 v[110:113], v[154:157], v[194:197], v[110:113]
    s_waitcnt lgkmcnt(0)
    s_barrier
    ds_read_b128 v[134:137], v33 offset:22528
    ds_read_b64_tr_b16 v[178:179], v39 offset:8192
    ds_read_b64_tr_b16 v[180:181], v39 offset:8704
    ds_read_b128 v[146:149], v34 offset:22528
    ds_read_b64_tr_b16 v[182:183], v39 offset:12288
    ds_read_b64_tr_b16 v[184:185], v39 offset:12800
    ds_read_b128 v[138:141], v33 offset:24576
    ds_read_b128 v[150:153], v34 offset:24576
    ds_read_b64_tr_b16 v[186:187], v40 offset:8192
    ds_read_b64_tr_b16 v[188:189], v40 offset:8704
    ds_read_b64_tr_b16 v[190:191], v40 offset:12288
    ds_read_b64_tr_b16 v[192:193], v40 offset:12800
    ds_read_b128 v[130:133], v33 offset:20480
    v_mfma_f32_16x16x32_bf16 v[110:113], v[166:169], v[198:201], v[110:113]
    v_mfma_f32_16x16x32_bf16 v[118:121], v[158:161], v[194:197], v[118:121]
    ds_read_b64_tr_b16 v[194:195], v39 offset:16384
    v_mfma_f32_16x16x32_bf16 v[118:121], v[170:173], v[198:201], v[118:121]
    ds_read_b64_tr_b16 v[196:197], v39 offset:16896
    s_waitcnt lgkmcnt(12)
    v_mfma_f32_16x16x32_bf16 v[66:69], v[178:181], v[134:137], v[66:69]
    ds_read_b128 v[142:145], v34 offset:20480
    s_waitcnt lgkmcnt(10)
    v_mfma_f32_16x16x32_bf16 v[66:69], v[182:185], v[146:149], v[66:69]
    ds_read_b64_tr_b16 v[198:199], v39 offset:20480
    s_waitcnt lgkmcnt(10)
    v_mfma_f32_16x16x32_bf16 v[74:77], v[178:181], v[138:141], v[74:77]
    ds_read_b64_tr_b16 v[200:201], v39 offset:20992
    s_waitcnt lgkmcnt(10)
    v_mfma_f32_16x16x32_bf16 v[74:77], v[182:185], v[150:153], v[74:77]
    ds_read_b64_tr_b16 v[178:179], v40 offset:16384
    s_waitcnt lgkmcnt(9)
    v_mfma_f32_16x16x32_bf16 v[70:73], v[186:189], v[134:137], v[70:73]
    ds_read_b64_tr_b16 v[180:181], v40 offset:16896
    s_waitcnt lgkmcnt(8)
    v_mfma_f32_16x16x32_bf16 v[70:73], v[190:193], v[146:149], v[70:73]
    ds_read_b64_tr_b16 v[182:183], v40 offset:20480
    v_mfma_f32_16x16x32_bf16 v[78:81], v[186:189], v[138:141], v[78:81]
    ds_read_b64_tr_b16 v[184:185], v40 offset:20992
    v_mfma_f32_16x16x32_bf16 v[78:81], v[190:193], v[150:153], v[78:81]
    ds_read_b64_tr_b16 v[186:187], v39 offset:24576
    s_waitcnt lgkmcnt(8)
    v_mfma_f32_16x16x32_bf16 v[82:85], v[194:197], v[130:133], v[82:85]
    ds_read_b64_tr_b16 v[188:189], v39 offset:25088
    s_waitcnt lgkmcnt(6)
    v_mfma_f32_16x16x32_bf16 v[82:85], v[198:201], v[142:145], v[82:85]
    ds_read_b64_tr_b16 v[190:191], v39 offset:28672
    v_mfma_f32_16x16x32_bf16 v[90:93], v[194:197], v[134:137], v[90:93]
    ds_read_b64_tr_b16 v[192:193], v39 offset:29184
    v_mfma_f32_16x16x32_bf16 v[90:93], v[198:201], v[146:149], v[90:93]
    v_mfma_f32_16x16x32_bf16 v[98:101], v[194:197], v[138:141], v[98:101]
    ds_read_b64_tr_b16 v[194:195], v40 offset:24576
    v_mfma_f32_16x16x32_bf16 v[98:101], v[198:201], v[150:153], v[98:101]
    ds_read_b64_tr_b16 v[196:197], v40 offset:25088
    s_waitcnt lgkmcnt(8)
    v_mfma_f32_16x16x32_bf16 v[86:89], v[178:181], v[130:133], v[86:89]
    ds_read_b64_tr_b16 v[198:199], v40 offset:28672
    s_waitcnt lgkmcnt(7)
    v_mfma_f32_16x16x32_bf16 v[86:89], v[182:185], v[142:145], v[86:89]
    ds_read_b64_tr_b16 v[200:201], v40 offset:29184
    v_mfma_f32_16x16x32_bf16 v[94:97], v[178:181], v[134:137], v[94:97]
    v_mfma_f32_16x16x32_bf16 v[94:97], v[182:185], v[146:149], v[94:97]
    v_mfma_f32_16x16x32_bf16 v[102:105], v[178:181], v[138:141], v[102:105]
    v_mfma_f32_16x16x32_bf16 v[102:105], v[182:185], v[150:153], v[102:105]
    s_waitcnt lgkmcnt(6)
    v_mfma_f32_16x16x32_bf16 v[106:109], v[130:133], v[186:189], v[106:109]
    s_waitcnt lgkmcnt(4)
    v_mfma_f32_16x16x32_bf16 v[106:109], v[142:145], v[190:193], v[106:109]
    v_mfma_f32_16x16x32_bf16 v[114:117], v[134:137], v[186:189], v[114:117]
    v_mfma_f32_16x16x32_bf16 v[114:117], v[146:149], v[190:193], v[114:117]
    s_waitcnt lgkmcnt(2)
    v_mfma_f32_16x16x32_bf16 v[110:113], v[130:133], v[194:197], v[110:113]
    s_waitcnt lgkmcnt(0)
    s_barrier
    ds_read_b128 v[158:161], v33 offset:32768
    ds_read_b64_tr_b16 v[178:179], v39 offset:32768
    ds_read_b64_tr_b16 v[180:181], v39 offset:33280
    ds_read_b128 v[170:173], v34 offset:32768
    ds_read_b64_tr_b16 v[182:183], v39 offset:36864
    ds_read_b64_tr_b16 v[184:185], v39 offset:37376
    ds_read_b128 v[162:165], v33 offset:34816
    ds_read_b128 v[174:177], v34 offset:34816
    ds_read_b64_tr_b16 v[186:187], v40 offset:32768
    ds_read_b64_tr_b16 v[188:189], v40 offset:33280
    ds_read_b64_tr_b16 v[190:191], v40 offset:36864
    ds_read_b64_tr_b16 v[192:193], v40 offset:37376
    ds_read_b128 v[154:157], v33 offset:30720
    v_mfma_f32_16x16x32_bf16 v[110:113], v[142:145], v[198:201], v[110:113]
    v_mfma_f32_16x16x32_bf16 v[118:121], v[134:137], v[194:197], v[118:121]
    ds_read_b64_tr_b16 v[194:195], v37 offset:0
    v_mfma_f32_16x16x32_bf16 v[118:121], v[146:149], v[198:201], v[118:121]
    ds_read_b64_tr_b16 v[196:197], v37 offset:512
    s_waitcnt lgkmcnt(12)
    v_mfma_f32_16x16x32_bf16 v[66:69], v[178:181], v[158:161], v[66:69]
    ds_read_b128 v[166:169], v34 offset:30720
    s_waitcnt lgkmcnt(10)
    v_mfma_f32_16x16x32_bf16 v[66:69], v[182:185], v[170:173], v[66:69]
    ds_read_b64_tr_b16 v[198:199], v37 offset:4096
    s_waitcnt lgkmcnt(10)
    v_mfma_f32_16x16x32_bf16 v[74:77], v[178:181], v[162:165], v[74:77]
    ds_read_b64_tr_b16 v[200:201], v37 offset:4608
    s_waitcnt lgkmcnt(10)
    v_mfma_f32_16x16x32_bf16 v[74:77], v[182:185], v[174:177], v[74:77]
    ds_read_b64_tr_b16 v[178:179], v38 offset:0
    s_waitcnt lgkmcnt(9)
    v_mfma_f32_16x16x32_bf16 v[70:73], v[186:189], v[158:161], v[70:73]
    ds_read_b64_tr_b16 v[180:181], v38 offset:512
    s_waitcnt lgkmcnt(8)
    v_mfma_f32_16x16x32_bf16 v[70:73], v[190:193], v[170:173], v[70:73]
    ds_read_b64_tr_b16 v[182:183], v38 offset:4096
    v_mfma_f32_16x16x32_bf16 v[78:81], v[186:189], v[162:165], v[78:81]
    ds_read_b64_tr_b16 v[184:185], v38 offset:4608
    v_mfma_f32_16x16x32_bf16 v[78:81], v[190:193], v[174:177], v[78:81]
    ds_read_b64_tr_b16 v[186:187], v37 offset:8192
    s_waitcnt lgkmcnt(8)
    v_mfma_f32_16x16x32_bf16 v[82:85], v[194:197], v[154:157], v[82:85]
    ds_read_b64_tr_b16 v[188:189], v37 offset:8704
    s_waitcnt lgkmcnt(6)
    v_mfma_f32_16x16x32_bf16 v[82:85], v[198:201], v[166:169], v[82:85]
    ds_read_b64_tr_b16 v[190:191], v37 offset:12288
    v_mfma_f32_16x16x32_bf16 v[90:93], v[194:197], v[158:161], v[90:93]
    ds_read_b64_tr_b16 v[192:193], v37 offset:12800
    v_mfma_f32_16x16x32_bf16 v[90:93], v[198:201], v[170:173], v[90:93]
    v_mfma_f32_16x16x32_bf16 v[98:101], v[194:197], v[162:165], v[98:101]
    ds_read_b64_tr_b16 v[194:195], v38 offset:8192
    v_mfma_f32_16x16x32_bf16 v[98:101], v[198:201], v[174:177], v[98:101]
    ds_read_b64_tr_b16 v[196:197], v38 offset:8704
    s_waitcnt lgkmcnt(8)
    v_mfma_f32_16x16x32_bf16 v[86:89], v[178:181], v[154:157], v[86:89]
    ds_read_b64_tr_b16 v[198:199], v38 offset:12288
    s_waitcnt lgkmcnt(7)
    v_mfma_f32_16x16x32_bf16 v[86:89], v[182:185], v[166:169], v[86:89]
    ds_read_b64_tr_b16 v[200:201], v38 offset:12800
    v_mfma_f32_16x16x32_bf16 v[94:97], v[178:181], v[158:161], v[94:97]
    v_mfma_f32_16x16x32_bf16 v[94:97], v[182:185], v[170:173], v[94:97]
    v_mfma_f32_16x16x32_bf16 v[102:105], v[178:181], v[162:165], v[102:105]
    v_mfma_f32_16x16x32_bf16 v[102:105], v[182:185], v[174:177], v[102:105]
    s_waitcnt lgkmcnt(6)
    v_mfma_f32_16x16x32_bf16 v[106:109], v[154:157], v[186:189], v[106:109]
    s_waitcnt lgkmcnt(4)
    v_mfma_f32_16x16x32_bf16 v[106:109], v[166:169], v[190:193], v[106:109]
    v_mfma_f32_16x16x32_bf16 v[114:117], v[158:161], v[186:189], v[114:117]
    v_mfma_f32_16x16x32_bf16 v[114:117], v[170:173], v[190:193], v[114:117]
    s_waitcnt lgkmcnt(2)
    v_mfma_f32_16x16x32_bf16 v[110:113], v[154:157], v[194:197], v[110:113]
    s_waitcnt lgkmcnt(0)
    s_barrier
    ds_read_b128 v[134:137], v35 offset:2048
    ds_read_b64_tr_b16 v[178:179], v37 offset:16384
    ds_read_b64_tr_b16 v[180:181], v37 offset:16896
    ds_read_b128 v[146:149], v36 offset:2048
    ds_read_b64_tr_b16 v[182:183], v37 offset:20480
    ds_read_b64_tr_b16 v[184:185], v37 offset:20992
    ds_read_b128 v[138:141], v35 offset:4096
    ds_read_b128 v[150:153], v36 offset:4096
    ds_read_b64_tr_b16 v[186:187], v38 offset:16384
    ds_read_b64_tr_b16 v[188:189], v38 offset:16896
    ds_read_b64_tr_b16 v[190:191], v38 offset:20480
    ds_read_b64_tr_b16 v[192:193], v38 offset:20992
    ds_read_b128 v[130:133], v35 offset:0
    v_mfma_f32_16x16x32_bf16 v[110:113], v[166:169], v[198:201], v[110:113]
    v_mfma_f32_16x16x32_bf16 v[118:121], v[158:161], v[194:197], v[118:121]
    ds_read_b64_tr_b16 v[194:195], v37 offset:24576
    v_mfma_f32_16x16x32_bf16 v[118:121], v[170:173], v[198:201], v[118:121]
    ds_read_b64_tr_b16 v[196:197], v37 offset:25088
    s_waitcnt lgkmcnt(12)
    v_mfma_f32_16x16x32_bf16 v[66:69], v[178:181], v[134:137], v[66:69]
    ds_read_b128 v[142:145], v36 offset:0
    s_waitcnt lgkmcnt(10)
    v_mfma_f32_16x16x32_bf16 v[66:69], v[182:185], v[146:149], v[66:69]
    ds_read_b64_tr_b16 v[198:199], v37 offset:28672
    s_waitcnt lgkmcnt(10)
    v_mfma_f32_16x16x32_bf16 v[74:77], v[178:181], v[138:141], v[74:77]
    ds_read_b64_tr_b16 v[200:201], v37 offset:29184
    s_waitcnt lgkmcnt(10)
    v_mfma_f32_16x16x32_bf16 v[74:77], v[182:185], v[150:153], v[74:77]
    ds_read_b64_tr_b16 v[178:179], v38 offset:24576
    s_waitcnt lgkmcnt(9)
    v_mfma_f32_16x16x32_bf16 v[70:73], v[186:189], v[134:137], v[70:73]
    ds_read_b64_tr_b16 v[180:181], v38 offset:25088
    s_waitcnt lgkmcnt(8)
    v_mfma_f32_16x16x32_bf16 v[70:73], v[190:193], v[146:149], v[70:73]
    ds_read_b64_tr_b16 v[182:183], v38 offset:28672
    v_mfma_f32_16x16x32_bf16 v[78:81], v[186:189], v[138:141], v[78:81]
    ds_read_b64_tr_b16 v[184:185], v38 offset:29184
    v_mfma_f32_16x16x32_bf16 v[78:81], v[190:193], v[150:153], v[78:81]
    ds_read_b64_tr_b16 v[186:187], v37 offset:32768
    s_waitcnt lgkmcnt(8)
    v_mfma_f32_16x16x32_bf16 v[82:85], v[194:197], v[130:133], v[82:85]
    ds_read_b64_tr_b16 v[188:189], v37 offset:33280
    s_waitcnt lgkmcnt(6)
    v_mfma_f32_16x16x32_bf16 v[82:85], v[198:201], v[142:145], v[82:85]
    ds_read_b64_tr_b16 v[190:191], v37 offset:36864
    v_mfma_f32_16x16x32_bf16 v[90:93], v[194:197], v[134:137], v[90:93]
    ds_read_b64_tr_b16 v[192:193], v37 offset:37376
    v_mfma_f32_16x16x32_bf16 v[90:93], v[198:201], v[146:149], v[90:93]
    v_mfma_f32_16x16x32_bf16 v[98:101], v[194:197], v[138:141], v[98:101]
    ds_read_b64_tr_b16 v[194:195], v38 offset:32768
    v_mfma_f32_16x16x32_bf16 v[98:101], v[198:201], v[150:153], v[98:101]
    ds_read_b64_tr_b16 v[196:197], v38 offset:33280
    s_waitcnt lgkmcnt(8)
    v_mfma_f32_16x16x32_bf16 v[86:89], v[178:181], v[130:133], v[86:89]
    ds_read_b64_tr_b16 v[198:199], v38 offset:36864
    s_waitcnt lgkmcnt(7)
    v_mfma_f32_16x16x32_bf16 v[86:89], v[182:185], v[142:145], v[86:89]
    ds_read_b64_tr_b16 v[200:201], v38 offset:37376
    v_mfma_f32_16x16x32_bf16 v[94:97], v[178:181], v[134:137], v[94:97]
    v_mfma_f32_16x16x32_bf16 v[94:97], v[182:185], v[146:149], v[94:97]
    v_mfma_f32_16x16x32_bf16 v[102:105], v[178:181], v[138:141], v[102:105]
    v_mfma_f32_16x16x32_bf16 v[102:105], v[182:185], v[150:153], v[102:105]
    s_waitcnt lgkmcnt(6)
    v_mfma_f32_16x16x32_bf16 v[106:109], v[130:133], v[186:189], v[106:109]
    s_waitcnt lgkmcnt(4)
    v_mfma_f32_16x16x32_bf16 v[106:109], v[142:145], v[190:193], v[106:109]
    v_mfma_f32_16x16x32_bf16 v[114:117], v[134:137], v[186:189], v[114:117]
    v_mfma_f32_16x16x32_bf16 v[114:117], v[146:149], v[190:193], v[114:117]
    s_waitcnt lgkmcnt(2)
    v_mfma_f32_16x16x32_bf16 v[110:113], v[130:133], v[194:197], v[110:113]
    s_waitcnt lgkmcnt(0)
    s_barrier
    ds_read_b128 v[158:161], v35 offset:12288
    ds_read_b64_tr_b16 v[178:179], v37 offset:40960
    ds_read_b64_tr_b16 v[180:181], v37 offset:41472
    ds_read_b128 v[170:173], v36 offset:12288
    ds_read_b64_tr_b16 v[182:183], v37 offset:45056
    ds_read_b64_tr_b16 v[184:185], v37 offset:45568
    ds_read_b128 v[162:165], v35 offset:14336
    ds_read_b128 v[174:177], v36 offset:14336
    ds_read_b64_tr_b16 v[186:187], v38 offset:40960
    ds_read_b64_tr_b16 v[188:189], v38 offset:41472
    ds_read_b64_tr_b16 v[190:191], v38 offset:45056
    ds_read_b64_tr_b16 v[192:193], v38 offset:45568
    ds_read_b128 v[154:157], v35 offset:10240
    v_mfma_f32_16x16x32_bf16 v[110:113], v[142:145], v[198:201], v[110:113]
    ds_read_b64_tr_b16 v[202:203], v39 offset:0
    v_mfma_f32_16x16x32_bf16 v[118:121], v[134:137], v[194:197], v[118:121]
    ds_read_b64_tr_b16 v[204:205], v39 offset:512
    v_mfma_f32_16x16x32_bf16 v[118:121], v[146:149], v[198:201], v[118:121]
    ds_read_b128 v[166:169], v36 offset:10240
    s_waitcnt lgkmcnt(13)
    v_mfma_f32_16x16x32_bf16 v[66:69], v[178:181], v[158:161], v[66:69]
    ds_read_b64_tr_b16 v[206:207], v39 offset:4096
    s_waitcnt lgkmcnt(11)
    v_mfma_f32_16x16x32_bf16 v[66:69], v[182:185], v[170:173], v[66:69]
    ds_read_b64_tr_b16 v[208:209], v39 offset:4608
    s_waitcnt lgkmcnt(11)
    v_mfma_f32_16x16x32_bf16 v[74:77], v[178:181], v[162:165], v[74:77]
    ds_read_b64_tr_b16 v[194:195], v40 offset:0
    s_waitcnt lgkmcnt(11)
    v_mfma_f32_16x16x32_bf16 v[74:77], v[182:185], v[174:177], v[74:77]
    ds_read_b64_tr_b16 v[196:197], v40 offset:512
    s_waitcnt lgkmcnt(10)
    v_mfma_f32_16x16x32_bf16 v[70:73], v[186:189], v[158:161], v[70:73]
    ds_read_b64_tr_b16 v[198:199], v40 offset:4096
    s_waitcnt lgkmcnt(9)
    v_mfma_f32_16x16x32_bf16 v[70:73], v[190:193], v[170:173], v[70:73]
    ds_read_b64_tr_b16 v[200:201], v40 offset:4608
    v_mfma_f32_16x16x32_bf16 v[78:81], v[186:189], v[162:165], v[78:81]
    v_mfma_f32_16x16x32_bf16 v[78:81], v[190:193], v[174:177], v[78:81]
    s_waitcnt lgkmcnt(7)
    v_mfma_f32_16x16x32_bf16 v[82:85], v[202:205], v[154:157], v[82:85]
    s_waitcnt lgkmcnt(4)
    v_mfma_f32_16x16x32_bf16 v[82:85], v[206:209], v[166:169], v[82:85]
    v_mfma_f32_16x16x32_bf16 v[90:93], v[202:205], v[158:161], v[90:93]
    v_mfma_f32_16x16x32_bf16 v[90:93], v[206:209], v[170:173], v[90:93]
    v_mfma_f32_16x16x32_bf16 v[98:101], v[202:205], v[162:165], v[98:101]
    v_mfma_f32_16x16x32_bf16 v[98:101], v[206:209], v[174:177], v[98:101]
    s_waitcnt lgkmcnt(2)
    v_mfma_f32_16x16x32_bf16 v[86:89], v[194:197], v[154:157], v[86:89]
    s_waitcnt lgkmcnt(0)
    v_mfma_f32_16x16x32_bf16 v[86:89], v[198:201], v[166:169], v[86:89]
    v_mfma_f32_16x16x32_bf16 v[94:97], v[194:197], v[158:161], v[94:97]
    v_mfma_f32_16x16x32_bf16 v[94:97], v[198:201], v[170:173], v[94:97]
    v_mfma_f32_16x16x32_bf16 v[102:105], v[194:197], v[162:165], v[102:105]
    s_barrier
    ds_read_b128 v[134:137], v35 offset:22528
    ds_read_b64_tr_b16 v[178:179], v39 offset:8192
    ds_read_b64_tr_b16 v[180:181], v39 offset:8704
    ds_read_b128 v[146:149], v36 offset:22528
    ds_read_b64_tr_b16 v[182:183], v39 offset:12288
    ds_read_b64_tr_b16 v[184:185], v39 offset:12800
    ds_read_b128 v[138:141], v35 offset:24576
    ds_read_b128 v[150:153], v36 offset:24576
    ds_read_b64_tr_b16 v[186:187], v40 offset:8192
    ds_read_b64_tr_b16 v[188:189], v40 offset:8704
    ds_read_b64_tr_b16 v[190:191], v40 offset:12288
    ds_read_b64_tr_b16 v[192:193], v40 offset:12800
    ds_read_b128 v[130:133], v35 offset:20480
    v_mfma_f32_16x16x32_bf16 v[102:105], v[198:201], v[174:177], v[102:105]
    ds_read_b128 v[142:145], v36 offset:20480
    s_waitcnt lgkmcnt(11)
    v_mfma_f32_16x16x32_bf16 v[66:69], v[178:181], v[134:137], v[66:69]
    s_barrier
    ds_read_b64_tr_b16 v[202:203], v39 offset:16384
    ds_read_b64_tr_b16 v[204:205], v39 offset:16896
    ds_read_b64_tr_b16 v[206:207], v39 offset:20480
    ds_read_b64_tr_b16 v[208:209], v39 offset:20992
    ds_read_b64_tr_b16 v[194:195], v40 offset:16384
    s_waitcnt lgkmcnt(13)
    v_mfma_f32_16x16x32_bf16 v[66:69], v[182:185], v[146:149], v[66:69]
    ds_read_b64_tr_b16 v[196:197], v40 offset:16896
    s_waitcnt lgkmcnt(13)
    v_mfma_f32_16x16x32_bf16 v[74:77], v[178:181], v[138:141], v[74:77]
    ds_read_b64_tr_b16 v[198:199], v40 offset:20480
    s_waitcnt lgkmcnt(13)
    v_mfma_f32_16x16x32_bf16 v[74:77], v[182:185], v[150:153], v[74:77]
    ds_read_b64_tr_b16 v[200:201], v40 offset:20992
    s_waitcnt lgkmcnt(12)
    v_mfma_f32_16x16x32_bf16 v[70:73], v[186:189], v[134:137], v[70:73]
    v_cvt_pk_bf16_f32 v154, v66, v67
    v_cvt_pk_bf16_f32 v155, v68, v69
    s_waitcnt lgkmcnt(10)
    v_mfma_f32_16x16x32_bf16 v[70:73], v[190:193], v[146:149], v[70:73]
    v_cndmask_b32 v162, 0, v154, s[54:55]
    v_cndmask_b32 v154, v154, 0, s[54:55]
    v_mfma_f32_16x16x32_bf16 v[78:81], v[186:189], v[138:141], v[78:81]
    v_cndmask_b32 v163, 0, v155, s[54:55]
    v_cndmask_b32 v155, v155, 0, s[54:55]
    v_mfma_f32_16x16x32_bf16 v[78:81], v[190:193], v[150:153], v[78:81]
    v_cvt_pk_bf16_f32 v158, v74, v75
    v_cvt_pk_bf16_f32 v159, v76, v77
    s_waitcnt lgkmcnt(6)
    v_mfma_f32_16x16x32_bf16 v[98:101], v[202:205], v[138:141], v[98:101]
    v_cndmask_b32 v166, 0, v158, s[54:55]
    v_cndmask_b32 v158, v158, 0, s[54:55]
    s_waitcnt lgkmcnt(4)
    v_mfma_f32_16x16x32_bf16 v[98:101], v[206:209], v[150:153], v[98:101]
    v_cndmask_b32 v167, 0, v159, s[54:55]
    v_cndmask_b32 v159, v159, 0, s[54:55]
    s_waitcnt lgkmcnt(2)
    v_mfma_f32_16x16x32_bf16 v[102:105], v[194:197], v[138:141], v[102:105]
    v_cvt_pk_bf16_f32 v156, v70, v71
    v_cvt_pk_bf16_f32 v157, v72, v73
    s_waitcnt lgkmcnt(0)
    v_mfma_f32_16x16x32_bf16 v[102:105], v[198:201], v[150:153], v[102:105]
    v_cndmask_b32 v164, 0, v156, s[56:57]
    v_cndmask_b32 v156, v156, 0, s[56:57]
    v_mfma_f32_16x16x32_bf16 v[82:85], v[202:205], v[130:133], v[82:85]
    v_cndmask_b32 v165, 0, v157, s[56:57]
    v_cndmask_b32 v157, v157, 0, s[56:57]
    v_mfma_f32_16x16x32_bf16 v[82:85], v[206:209], v[142:145], v[82:85]
    v_cvt_pk_bf16_f32 v160, v78, v79
    v_cvt_pk_bf16_f32 v161, v80, v81
    v_mfma_f32_16x16x32_bf16 v[86:89], v[194:197], v[130:133], v[86:89]
    v_cndmask_b32 v168, 0, v160, s[56:57]
    v_cndmask_b32 v160, v160, 0, s[56:57]
    v_mfma_f32_16x16x32_bf16 v[86:89], v[198:201], v[142:145], v[86:89]
    v_cndmask_b32 v169, 0, v161, s[56:57]
    v_cndmask_b32 v161, v161, 0, s[56:57]
    v_mfma_f32_16x16x32_bf16 v[90:93], v[202:205], v[134:137], v[90:93]
    v_cvt_pk_bf16_f32 v238, v98, v99
    v_cvt_pk_bf16_f32 v239, v100, v101
    v_mfma_f32_16x16x32_bf16 v[90:93], v[206:209], v[146:149], v[90:93]
    v_cvt_pk_bf16_f32 v240, v102, v103
    v_cvt_pk_bf16_f32 v241, v104, v105
    v_mfma_f32_16x16x32_bf16 v[94:97], v[194:197], v[134:137], v[94:97]
    ds_write_b128 v222, v[238:241]
    ds_write_b32 v224, v5 offset:56
    v_mfma_f32_16x16x32_bf16 v[94:97], v[198:201], v[146:149], v[94:97]
    ds_read_b32 v45, v5 offset:4
    v_cvt_pk_bf16_f32 v230, v82, v83
    v_cvt_pk_bf16_f32 v231, v84, v85
    v_cvt_pk_bf16_f32 v232, v86, v87
    v_cvt_pk_bf16_f32 v233, v88, v89
    s_nop 1
    v_mfma_f32_16x16x32_bf16 v[66:69], v[230:233], v[154:157], 0
    v_mfma_f32_16x16x32_bf16 v[78:81], v[238:241], v[158:161], 0
    v_cvt_pk_bf16_f32 v234, v90, v91
    v_cvt_pk_bf16_f32 v235, v92, v93
    v_cvt_pk_bf16_f32 v236, v94, v95
    v_cvt_pk_bf16_f32 v237, v96, v97
    s_nop 1
    v_mfma_f32_16x16x32_bf16 v[70:73], v[234:237], v[154:157], 0
    v_mfma_f32_16x16x32_bf16 v[74:77], v[234:237], v[158:161], 0
    v_mfma_f32_16x16x32_bf16 v[178:181], v[230:233], v[162:165], 0
    v_mfma_f32_16x16x32_bf16 v[182:185], v[234:237], v[162:165], 0
    s_waitcnt lgkmcnt(0)
    v_readfirstlane_b32 s63, v45
    s_nop 2
    v_cndmask_b32 v70, v70, v71, s[44:45]
    v_cndmask_b32 v72, v72, v73, s[44:45]
    v_cndmask_b32 v66, v66, v67, s[44:45]
    v_cndmask_b32 v68, v68, v69, s[44:45]
    v_cndmask_b32 v66, v66, v50, s[50:51]
    v_cndmask_b32 v68, v68, v50, s[50:51]
    v_cndmask_b32 v214, v66, v70, s[46:47]
    v_cndmask_b32 v215, v68, v72, s[48:49]
    v_cndmask_b32 v78, v78, v79, s[44:45]
    v_cndmask_b32 v80, v80, v81, s[44:45]
    v_cndmask_b32 v74, v74, v75, s[44:45]
    v_cndmask_b32 v76, v76, v77, s[44:45]
    v_cndmask_b32 v216, v74, v78, s[46:47]
    v_cndmask_b32 v217, v76, v80, s[48:49]
    v_and_or_b32 v98, v214, v51, v54
    v_and_or_b32 v99, v215, v51, v55
    v_and_or_b32 v100, v216, v51, v56
    v_and_or_b32 v101, v217, v51, v57
    s_sub_u32 s63, s63, 1
    s_cbranch_scc1 C_mr0
C_md0:
    s_cmp_lg_u32 s101, 0
    s_cbranch_scc1 SM_jS0
    s_cmp_eq_u32 s63, 0
    s_cbranch_scc1 SM_sS0
    buffer_store_dwordx4 v[98:101], v4, s[36:39], s15 offen
SM_jS0:
    v_mfma_f32_16x16x32_bf16 v[186:189], v[234:237], v[166:169], 0
    v_mfma_f32_16x16x32_bf16 v[190:193], v[238:241], v[166:169], 0
    ds_read_b32 v45, v5 offset:32
    ds_read_b64_tr_b16 v[170:171], v39 offset:32768
    ds_read_b64_tr_b16 v[172:173], v39 offset:33280
    ds_read_b64_tr_b16 v[174:175], v40 offset:32768
    ds_read_b64_tr_b16 v[176:177], v40 offset:33280
    ds_read_b64_tr_b16 v[202:203], v39 offset:36864
    ds_read_b64_tr_b16 v[204:205], v39 offset:37376
    ds_read_b64_tr_b16 v[206:207], v40 offset:36864
    ds_read_b64_tr_b16 v[208:209], v40 offset:37376
    v_cndmask_b32 v182, v182, v183, s[44:45]
    v_cndmask_b32 v184, v184, v185, s[44:45]
    v_cndmask_b32 v178, v178, v179, s[44:45]
    v_cndmask_b32 v180, v180, v181, s[44:45]
    v_cndmask_b32 v178, v178, v50, s[50:51]
    v_cndmask_b32 v180, v180, v50, s[50:51]
    v_cndmask_b32 v210, v178, v182, s[46:47]
    v_cndmask_b32 v211, v180, v184, s[48:49]
    v_cndmask_b32 v190, v190, v191, s[44:45]
    v_cndmask_b32 v192, v192, v193, s[44:45]
    v_cndmask_b32 v186, v186, v187, s[44:45]
    v_cndmask_b32 v188, v188, v189, s[44:45]
    v_cndmask_b32 v212, v186, v190, s[46:47]
    v_cndmask_b32 v213, v188, v192, s[48:49]
    ds_write_b128 v47, v[210:213]
    ds_write_b32 v52, v5 offset:16
    s_waitcnt lgkmcnt(10)
    v_cmp_gt_u32 vcc, 4, v45
    s_nop 0
    s_cbranch_vccnz C_vr0
C_vd0:
    s_waitcnt lgkmcnt(8)
    v_mfma_f32_16x16x32_bf16 v[106:109], v[130:133], v[170:173], v[106:109]
    ds_read_b128 v[154:157], v35 offset:10240
    ds_read_b64_tr_b16 v[186:187], v39 offset:24576
    s_waitcnt lgkmcnt(6)
    v_mfma_f32_16x16x32_bf16 v[106:109], v[142:145], v[202:205], v[106:109]
    ds_read_b64_tr_b16 v[188:189], v39 offset:25088
    ds_read_b128 v[166:169], v36 offset:10240
    v_mfma_f32_16x16x32_bf16 v[114:117], v[134:137], v[170:173], v[114:117]
    ds_read_b64_tr_b16 v[194:195], v39 offset:28672
    ds_read_b64_tr_b16 v[196:197], v39 offset:29184
    v_mfma_f32_16x16x32_bf16 v[114:117], v[146:149], v[202:205], v[114:117]
    ds_read_b64_tr_b16 v[190:191], v40 offset:24576
    ds_read_b64_tr_b16 v[192:193], v40 offset:25088
    v_mfma_f32_16x16x32_bf16 v[110:113], v[130:133], v[174:177], v[110:113]
    ds_read_b64_tr_b16 v[198:199], v40 offset:28672
    ds_read_b64_tr_b16 v[200:201], v40 offset:29184
    s_waitcnt lgkmcnt(12)
    v_mfma_f32_16x16x32_bf16 v[110:113], v[142:145], v[206:209], v[110:113]
    ds_read_b128 v[158:161], v35 offset:12288
    ds_read_b128 v[178:181], v36 offset:12288
    v_mfma_f32_16x16x32_bf16 v[118:121], v[134:137], v[174:177], v[118:121]
    v_mfma_f32_16x16x32_bf16 v[118:121], v[146:149], v[206:209], v[118:121]
    s_waitcnt lgkmcnt(9)
    v_mfma_f32_16x16x32_bf16 v[106:109], v[154:157], v[186:189], v[106:109]
    s_waitcnt lgkmcnt(6)
    v_mfma_f32_16x16x32_bf16 v[106:109], v[166:169], v[194:197], v[106:109]
    s_waitcnt lgkmcnt(4)
    v_mfma_f32_16x16x32_bf16 v[110:113], v[154:157], v[190:193], v[110:113]
    s_waitcnt lgkmcnt(2)
    v_mfma_f32_16x16x32_bf16 v[110:113], v[166:169], v[198:201], v[110:113]
    s_waitcnt lgkmcnt(1)
    v_mfma_f32_16x16x32_bf16 v[114:117], v[158:161], v[186:189], v[114:117]
    s_nop 1
    v_cvt_pk_bf16_f32 v230, v106, v107
    v_cvt_pk_bf16_f32 v231, v108, v109
    s_waitcnt lgkmcnt(0)
    v_mfma_f32_16x16x32_bf16 v[114:117], v[178:181], v[194:197], v[114:117]
    v_mfma_f32_16x16x32_bf16 v[118:121], v[158:161], v[190:193], v[118:121]
    v_cvt_pk_bf16_f32 v236, v110, v111
    v_cvt_pk_bf16_f32 v237, v112, v113
    v_mfma_f32_16x16x32_bf16 v[118:121], v[178:181], v[198:201], v[118:121]
    ds_read_b32 v53, v225 offset:68
    ds_read_b64 v[234:235], v223 offset:0
    ds_read_b64 v[240:241], v223 offset:8
    v_cndmask_b32 v130, 0, v230, s[58:59]
    v_cndmask_b32 v230, v230, 0, s[58:59]
    v_cndmask_b32 v131, 0, v231, s[58:59]
    v_cndmask_b32 v231, v231, 0, s[58:59]
    buffer_load_dwordx4 v[218:221], v4, s[36:39], s100 offen sc1
    v_cvt_pk_bf16_f32 v232, v114, v115
    v_cvt_pk_bf16_f32 v233, v116, v117
    v_cvt_pk_bf16_f32 v238, v118, v119
    v_cvt_pk_bf16_f32 v239, v120, v121
    v_cndmask_b32 v136, 0, v236, s[60:61]
    v_cndmask_b32 v236, v236, 0, s[60:61]
    v_cndmask_b32 v137, 0, v237, s[60:61]
    v_cndmask_b32 v237, v237, 0, s[60:61]
    v_cndmask_b32 v132, 0, v232, s[58:59]
    v_cndmask_b32 v232, v232, 0, s[58:59]
    v_cndmask_b32 v133, 0, v233, s[58:59]
    v_cndmask_b32 v233, v233, 0, s[58:59]
    v_cndmask_b32 v138, 0, v238, s[60:61]
    v_cndmask_b32 v238, v238, 0, s[60:61]
    v_cndmask_b32 v139, 0, v239, s[60:61]
    v_cndmask_b32 v239, v239, 0, s[60:61]
    s_waitcnt lgkmcnt(0)
    v_cmp_ne_u32 vcc, 0, v53
    s_nop 0
    s_cbranch_vccnz D_dV0
    s_mov_b32 s9, 0
D_lV0:
    ds_read_b32 v53, v225 offset:68
    ds_read_b64 v[234:235], v223 offset:0
    ds_read_b64 v[240:241], v223 offset:8
    s_add_u32 s9, s9, 1
    s_cmp_gt_u32 s9, 1600000
    s_waitcnt lgkmcnt(0)
    s_cbranch_scc1 D_dV0
    v_cmp_eq_u32 vcc, 0, v53
    s_nop 0
    s_cbranch_vccnz D_lV0
D_dV0:
    v_cndmask_b32 v134, 0, v234, s[58:59]
    v_cndmask_b32 v234, v234, 0, s[58:59]
    v_cndmask_b32 v135, 0, v235, s[58:59]
    v_cndmask_b32 v235, v235, 0, s[58:59]
    v_cndmask_b32 v140, 0, v240, s[60:61]
    v_cndmask_b32 v240, v240, 0, s[60:61]
    v_cndmask_b32 v141, 0, v241, s[60:61]
    v_cndmask_b32 v241, v241, 0, s[60:61]
    s_branch C_join
C_tp1:
    s_barrier
    ds_read_b128 v[134:137], v33 offset:2048
    ds_read_b64_tr_b16 v[178:179], v37 offset:8192
    ds_read_b64_tr_b16 v[180:181], v37 offset:8704
    ds_read_b128 v[146:149], v34 offset:2048
    ds_read_b64_tr_b16 v[182:183], v37 offset:12288
    ds_read_b64_tr_b16 v[184:185], v37 offset:12800
    ds_read_b128 v[138:141], v33 offset:4096
    ds_read_b128 v[150:153], v34 offset:4096
    ds_read_b64_tr_b16 v[186:187], v38 offset:8192
    ds_read_b64_tr_b16 v[188:189], v38 offset:8704
    ds_read_b64_tr_b16 v[190:191], v38 offset:12288
    ds_read_b64_tr_b16 v[192:193], v38 offset:12800
    s_waitcnt lgkmcnt(9)
    v_mfma_f32_16x16x32_bf16 v[66:69], v[178:181], v[134:137], 0
    ds_read_b64_tr_b16 v[194:195], v37 offset:16384
    s_waitcnt lgkmcnt(7)
    v_mfma_f32_16x16x32_bf16 v[66:69], v[182:185], v[146:149], v[66:69]
    ds_read_b64_tr_b16 v[196:197], v37 offset:16896
    s_waitcnt lgkmcnt(7)
    v_mfma_f32_16x16x32_bf16 v[74:77], v[178:181], v[138:141], 0
    ds_read_b64_tr_b16 v[198:199], v37 offset:20480
    ds_read_b64_tr_b16 v[200:201], v37 offset:20992
    s_waitcnt lgkmcnt(8)
    v_mfma_f32_16x16x32_bf16 v[74:77], v[182:185], v[150:153], v[74:77]
    ds_read_b64_tr_b16 v[178:179], v38 offset:16384
    s_waitcnt lgkmcnt(7)
    v_mfma_f32_16x16x32_bf16 v[70:73], v[186:189], v[134:137], 0
    ds_read_b64_tr_b16 v[180:181], v38 offset:16896
    s_waitcnt lgkmcnt(6)
    v_mfma_f32_16x16x32_bf16 v[70:73], v[190:193], v[146:149], v[70:73]
    ds_read_b64_tr_b16 v[182:183], v38 offset:20480
    v_mfma_f32_16x16x32_bf16 v[78:81], v[186:189], v[138:141], 0
    ds_read_b64_tr_b16 v[184:185], v38 offset:20992
    v_mfma_f32_16x16x32_bf16 v[78:81], v[190:193], v[150:153], v[78:81]
    ds_read_b128 v[130:133], v33 offset:0
    s_waitcnt lgkmcnt(7)
    v_mfma_f32_16x16x32_bf16 v[90:93], v[194:197], v[134:137], 0
    ds_read_b64_tr_b16 v[186:187], v37 offset:24576
    s_waitcnt lgkmcnt(6)
    v_mfma_f32_16x16x32_bf16 v[90:93], v[198:201], v[146:149], v[90:93]
    ds_read_b64_tr_b16 v[188:189], v37 offset:25088
    v_mfma_f32_16x16x32_bf16 v[98:101], v[194:197], v[138:141], 0
    ds_read_b128 v[142:145], v34 offset:0
    ds_read_b64_tr_b16 v[190:191], v37 offset:28672
    v_mfma_f32_16x16x32_bf16 v[98:101], v[198:201], v[150:153], v[98:101]
    ds_read_b64_tr_b16 v[192:193], v37 offset:29184
    s_waitcnt lgkmcnt(8)
    v_mfma_f32_16x16x32_bf16 v[94:97], v[178:181], v[134:137], 0
    ds_read_b64_tr_b16 v[194:195], v38 offset:24576
    s_waitcnt lgkmcnt(7)
    v_mfma_f32_16x16x32_bf16 v[94:97], v[182:185], v[146:149], v[94:97]
    ds_read_b64_tr_b16 v[196:197], v38 offset:25088
    v_mfma_f32_16x16x32_bf16 v[102:105], v[178:181], v[138:141], 0
    ds_read_b64_tr_b16 v[198:199], v38 offset:28672
    v_mfma_f32_16x16x32_bf16 v[102:105], v[182:185], v[150:153], v[102:105]
    ds_read_b64_tr_b16 v[200:201], v38 offset:29184
    s_waitcnt lgkmcnt(7)
    v_mfma_f32_16x16x32_bf16 v[106:109], v[130:133], v[186:189], 0
    s_waitcnt lgkmcnt(4)
    v_mfma_f32_16x16x32_bf16 v[106:109], v[142:145], v[190:193], v[106:109]
    v_mfma_f32_16x16x32_bf16 v[114:117], v[134:137], v[186:189], 0
    v_mfma_f32_16x16x32_bf16 v[114:117], v[146:149], v[190:193], v[114:117]
    v_mfma_f32_16x16x32_bf16 v[122:125], v[138:141], v[186:189], 0
    v_mfma_f32_16x16x32_bf16 v[122:125], v[150:153], v[190:193], v[122:125]
    s_waitcnt lgkmcnt(2)
    v_mfma_f32_16x16x32_bf16 v[110:113], v[130:133], v[194:197], 0
    s_waitcnt lgkmcnt(0)
    v_mfma_f32_16x16x32_bf16 v[110:113], v[142:145], v[198:201], v[110:113]
    v_mfma_f32_16x16x32_bf16 v[118:121], v[134:137], v[194:197], 0
    s_barrier
    ds_read_b128 v[158:161], v33 offset:12288
    ds_read_b64_tr_b16 v[178:179], v37 offset:32768
    ds_read_b64_tr_b16 v[180:181], v37 offset:33280
    ds_read_b128 v[170:173], v34 offset:12288
    ds_read_b64_tr_b16 v[182:183], v37 offset:36864
    ds_read_b64_tr_b16 v[184:185], v37 offset:37376
    ds_read_b128 v[162:165], v33 offset:14336
    ds_read_b128 v[174:177], v34 offset:14336
    ds_read_b64_tr_b16 v[186:187], v38 offset:32768
    ds_read_b64_tr_b16 v[188:189], v38 offset:33280
    ds_read_b64_tr_b16 v[190:191], v38 offset:36864
    ds_read_b64_tr_b16 v[192:193], v38 offset:37376
    v_mfma_f32_16x16x32_bf16 v[118:121], v[146:149], v[198:201], v[118:121]
    v_mfma_f32_16x16x32_bf16 v[126:129], v[138:141], v[194:197], 0
    ds_read_b64_tr_b16 v[194:195], v37 offset:40960
    v_mfma_f32_16x16x32_bf16 v[126:129], v[150:153], v[198:201], v[126:129]
    ds_read_b64_tr_b16 v[196:197], v37 offset:41472
    s_waitcnt lgkmcnt(11)
    v_mfma_f32_16x16x32_bf16 v[66:69], v[178:181], v[158:161], v[66:69]
    ds_read_b64_tr_b16 v[198:199], v37 offset:45056
    s_waitcnt lgkmcnt(9)
    v_mfma_f32_16x16x32_bf16 v[66:69], v[182:185], v[170:173], v[66:69]
    ds_read_b64_tr_b16 v[200:201], v37 offset:45568
    s_waitcnt lgkmcnt(9)
    v_mfma_f32_16x16x32_bf16 v[74:77], v[178:181], v[162:165], v[74:77]
    ds_read_b64_tr_b16 v[178:179], v38 offset:40960
    s_waitcnt lgkmcnt(9)
    v_mfma_f32_16x16x32_bf16 v[74:77], v[182:185], v[174:177], v[74:77]
    ds_read_b64_tr_b16 v[180:181], v38 offset:41472
    s_waitcnt lgkmcnt(8)
    v_mfma_f32_16x16x32_bf16 v[70:73], v[186:189], v[158:161], v[70:73]
    ds_read_b64_tr_b16 v[182:183], v38 offset:45056
    s_waitcnt lgkmcnt(7)
    v_mfma_f32_16x16x32_bf16 v[70:73], v[190:193], v[170:173], v[70:73]
    ds_read_b64_tr_b16 v[184:185], v38 offset:45568
    v_mfma_f32_16x16x32_bf16 v[78:81], v[186:189], v[162:165], v[78:81]
    ds_read_b128 v[154:157], v33 offset:10240
    v_mfma_f32_16x16x32_bf16 v[78:81], v[190:193], v[174:177], v[78:81]
    ds_read_b64_tr_b16 v[186:187], v39 offset:0
    s_waitcnt lgkmcnt(8)
    v_mfma_f32_16x16x32_bf16 v[90:93], v[194:197], v[158:161], v[90:93]
    ds_read_b64_tr_b16 v[188:189], v39 offset:512
    s_waitcnt lgkmcnt(7)
    v_mfma_f32_16x16x32_bf16 v[90:93], v[198:201], v[170:173], v[90:93]
    ds_read_b128 v[166:169], v34 offset:10240
    v_mfma_f32_16x16x32_bf16 v[98:101], v[194:197], v[162:165], v[98:101]
    ds_read_b64_tr_b16 v[190:191], v39 offset:4096
    ds_read_b64_tr_b16 v[192:193], v39 offset:4608
    v_mfma_f32_16x16x32_bf16 v[98:101], v[198:201], v[174:177], v[98:101]
    ds_read_b64_tr_b16 v[194:195], v40 offset:0
    s_waitcnt lgkmcnt(9)
    v_mfma_f32_16x16x32_bf16 v[94:97], v[178:181], v[158:161], v[94:97]
    ds_read_b64_tr_b16 v[196:197], v40 offset:512
    s_waitcnt lgkmcnt(8)
    v_mfma_f32_16x16x32_bf16 v[94:97], v[182:185], v[170:173], v[94:97]
    ds_read_b64_tr_b16 v[198:199], v40 offset:4096
    v_mfma_f32_16x16x32_bf16 v[102:105], v[178:181], v[162:165], v[102:105]
    ds_read_b64_tr_b16 v[200:201], v40 offset:4608
    v_mfma_f32_16x16x32_bf16 v[102:105], v[182:185], v[174:177], v[102:105]
    s_waitcnt lgkmcnt(7)
    v_mfma_f32_16x16x32_bf16 v[106:109], v[154:157], v[186:189], v[106:109]
    s_waitcnt lgkmcnt(4)
    v_mfma_f32_16x16x32_bf16 v[106:109], v[166:169], v[190:193], v[106:109]
    v_mfma_f32_16x16x32_bf16 v[114:117], v[158:161], v[186:189], v[114:117]
    v_mfma_f32_16x16x32_bf16 v[114:117], v[170:173], v[190:193], v[114:117]
    v_mfma_f32_16x16x32_bf16 v[122:125], v[162:165], v[186:189], v[122:125]
    v_mfma_f32_16x16x32_bf16 v[122:125], v[174:177], v[190:193], v[122:125]
    s_waitcnt lgkmcnt(2)
    v_mfma_f32_16x16x32_bf16 v[110:113], v[154:157], v[194:197], v[110:113]
    s_waitcnt lgkmcnt(0)
    v_mfma_f32_16x16x32_bf16 v[110:113], v[166:169], v[198:201], v[110:113]
    v_mfma_f32_16x16x32_bf16 v[118:121], v[158:161], v[194:197], v[118:121]
    s_barrier
    ds_read_b128 v[134:137], v33 offset:22528
    ds_read_b64_tr_b16 v[178:179], v39 offset:8192
    ds_read_b64_tr_b16 v[180:181], v39 offset:8704
    ds_read_b128 v[146:149], v34 offset:22528
    ds_read_b64_tr_b16 v[182:183], v39 offset:12288
    ds_read_b64_tr_b16 v[184:185], v39 offset:12800
    ds_read_b128 v[138:141], v33 offset:24576
    ds_read_b128 v[150:153], v34 offset:24576
    ds_read_b64_tr_b16 v[186:187], v40 offset:8192
    ds_read_b64_tr_b16 v[188:189], v40 offset:8704
    ds_read_b64_tr_b16 v[190:191], v40 offset:12288
    ds_read_b64_tr_b16 v[192:193], v40 offset:12800
    v_mfma_f32_16x16x32_bf16 v[118:121], v[170:173], v[198:201], v[118:121]
    v_mfma_f32_16x16x32_bf16 v[126:129], v[162:165], v[194:197], v[126:129]
    ds_read_b64_tr_b16 v[194:195], v39 offset:16384
    v_mfma_f32_16x16x32_bf16 v[126:129], v[174:177], v[198:201], v[126:129]
    ds_read_b64_tr_b16 v[196:197], v39 offset:16896
    s_waitcnt lgkmcnt(11)
    v_mfma_f32_16x16x32_bf16 v[66:69], v[178:181], v[134:137], v[66:69]
    ds_read_b64_tr_b16 v[198:199], v39 offset:20480
    s_waitcnt lgkmcnt(9)
    v_mfma_f32_16x16x32_bf16 v[66:69], v[182:185], v[146:149], v[66:69]
    ds_read_b64_tr_b16 v[200:201], v39 offset:20992
    s_waitcnt lgkmcnt(9)
    v_mfma_f32_16x16x32_bf16 v[74:77], v[178:181], v[138:141], v[74:77]
    ds_read_b64_tr_b16 v[178:179], v40 offset:16384
    s_waitcnt lgkmcnt(9)
    v_mfma_f32_16x16x32_bf16 v[74:77], v[182:185], v[150:153], v[74:77]
    ds_read_b64_tr_b16 v[180:181], v40 offset:16896
    s_waitcnt lgkmcnt(8)
    v_mfma_f32_16x16x32_bf16 v[70:73], v[186:189], v[134:137], v[70:73]
    ds_read_b64_tr_b16 v[182:183], v40 offset:20480
    s_waitcnt lgkmcnt(7)
    v_mfma_f32_16x16x32_bf16 v[70:73], v[190:193], v[146:149], v[70:73]
    ds_read_b64_tr_b16 v[184:185], v40 offset:20992
    v_mfma_f32_16x16x32_bf16 v[78:81], v[186:189], v[138:141], v[78:81]
    ds_read_b128 v[130:133], v33 offset:20480
    v_mfma_f32_16x16x32_bf16 v[78:81], v[190:193], v[150:153], v[78:81]
    ds_read_b64_tr_b16 v[186:187], v39 offset:24576
    s_waitcnt lgkmcnt(8)
    v_mfma_f32_16x16x32_bf16 v[90:93], v[194:197], v[134:137], v[90:93]
    ds_read_b64_tr_b16 v[188:189], v39 offset:25088
    s_waitcnt lgkmcnt(7)
    v_mfma_f32_16x16x32_bf16 v[90:93], v[198:201], v[146:149], v[90:93]
    ds_read_b128 v[142:145], v34 offset:20480
    v_mfma_f32_16x16x32_bf16 v[98:101], v[194:197], v[138:141], v[98:101]
    ds_read_b64_tr_b16 v[190:191], v39 offset:28672
    ds_read_b64_tr_b16 v[192:193], v39 offset:29184
    v_mfma_f32_16x16x32_bf16 v[98:101], v[198:201], v[150:153], v[98:101]
    ds_read_b64_tr_b16 v[194:195], v40 offset:24576
    s_waitcnt lgkmcnt(9)
    v_mfma_f32_16x16x32_bf16 v[94:97], v[178:181], v[134:137], v[94:97]
    ds_read_b64_tr_b16 v[196:197], v40 offset:25088
    s_waitcnt lgkmcnt(8)
    v_mfma_f32_16x16x32_bf16 v[94:97], v[182:185], v[146:149], v[94:97]
    ds_read_b64_tr_b16 v[198:199], v40 offset:28672
    v_mfma_f32_16x16x32_bf16 v[102:105], v[178:181], v[138:141], v[102:105]
    ds_read_b64_tr_b16 v[200:201], v40 offset:29184
    v_mfma_f32_16x16x32_bf16 v[102:105], v[182:185], v[150:153], v[102:105]
    s_waitcnt lgkmcnt(7)
    v_mfma_f32_16x16x32_bf16 v[106:109], v[130:133], v[186:189], v[106:109]
    s_waitcnt lgkmcnt(4)
    v_mfma_f32_16x16x32_bf16 v[106:109], v[142:145], v[190:193], v[106:109]
    v_mfma_f32_16x16x32_bf16 v[114:117], v[134:137], v[186:189], v[114:117]
    v_mfma_f32_16x16x32_bf16 v[114:117], v[146:149], v[190:193], v[114:117]
    v_mfma_f32_16x16x32_bf16 v[122:125], v[138:141], v[186:189], v[122:125]
    v_mfma_f32_16x16x32_bf16 v[122:125], v[150:153], v[190:193], v[122:125]
    s_waitcnt lgkmcnt(2)
    v_mfma_f32_16x16x32_bf16 v[110:113], v[130:133], v[194:197], v[110:113]
    s_waitcnt lgkmcnt(0)
    v_mfma_f32_16x16x32_bf16 v[110:113], v[142:145], v[198:201], v[110:113]
    v_mfma_f32_16x16x32_bf16 v[118:121], v[134:137], v[194:197], v[118:121]
    s_barrier
    ds_read_b128 v[158:161], v33 offset:32768
    ds_read_b64_tr_b16 v[178:179], v39 offset:32768
    ds_read_b64_tr_b16 v[180:181], v39 offset:33280
    ds_read_b128 v[170:173], v34 offset:32768
    ds_read_b64_tr_b16 v[182:183], v39 offset:36864
    ds_read_b64_tr_b16 v[184:185], v39 offset:37376
    ds_read_b128 v[162:165], v33 offset:34816
    ds_read_b128 v[174:177], v34 offset:34816
    ds_read_b64_tr_b16 v[186:187], v40 offset:32768
    ds_read_b64_tr_b16 v[188:189], v40 offset:33280
    ds_read_b64_tr_b16 v[190:191], v40 offset:36864
    ds_read_b64_tr_b16 v[192:193], v40 offset:37376
    v_mfma_f32_16x16x32_bf16 v[118:121], v[146:149], v[198:201], v[118:121]
    v_mfma_f32_16x16x32_bf16 v[126:129], v[138:141], v[194:197], v[126:129]
    ds_read_b64_tr_b16 v[194:195], v37 offset:0
    v_mfma_f32_16x16x32_bf16 v[126:129], v[150:153], v[198:201], v[126:129]
    ds_read_b64_tr_b16 v[196:197], v37 offset:512
    s_waitcnt lgkmcnt(11)
    v_mfma_f32_16x16x32_bf16 v[66:69], v[178:181], v[158:161], v[66:69]
    ds_read_b64_tr_b16 v[198:199], v37 offset:4096
    s_waitcnt lgkmcnt(9)
    v_mfma_f32_16x16x32_bf16 v[66:69], v[182:185], v[170:173], v[66:69]
    ds_read_b64_tr_b16 v[200:201], v37 offset:4608
    s_waitcnt lgkmcnt(9)
    v_mfma_f32_16x16x32_bf16 v[74:77], v[178:181], v[162:165], v[74:77]
    ds_read_b64_tr_b16 v[178:179], v38 offset:0
    s_waitcnt lgkmcnt(9)
    v_mfma_f32_16x16x32_bf16 v[74:77], v[182:185], v[174:177], v[74:77]
    ds_read_b64_tr_b16 v[180:181], v38 offset:512
    s_waitcnt lgkmcnt(8)
    v_mfma_f32_16x16x32_bf16 v[70:73], v[186:189], v[158:161], v[70:73]
    ds_read_b64_tr_b16 v[182:183], v38 offset:4096
    s_waitcnt lgkmcnt(7)
    v_mfma_f32_16x16x32_bf16 v[70:73], v[190:193], v[170:173], v[70:73]
    ds_read_b64_tr_b16 v[184:185], v38 offset:4608
    v_mfma_f32_16x16x32_bf16 v[78:81], v[186:189], v[162:165], v[78:81]
    ds_read_b128 v[154:157], v33 offset:30720
    v_mfma_f32_16x16x32_bf16 v[78:81], v[190:193], v[174:177], v[78:81]
    ds_read_b64_tr_b16 v[186:187], v37 offset:8192
    s_waitcnt lgkmcnt(8)
    v_mfma_f32_16x16x32_bf16 v[90:93], v[194:197], v[158:161], v[90:93]
    ds_read_b64_tr_b16 v[188:189], v37 offset:8704
    s_waitcnt lgkmcnt(7)
    v_mfma_f32_16x16x32_bf16 v[90:93], v[198:201], v[170:173], v[90:93]
    ds_read_b128 v[166:169], v34 offset:30720
    v_mfma_f32_16x16x32_bf16 v[98:101], v[194:197], v[162:165], v[98:101]
    ds_read_b64_tr_b16 v[190:191], v37 offset:12288
    ds_read_b64_tr_b16 v[192:193], v37 offset:12800
    v_mfma_f32_16x16x32_bf16 v[98:101], v[198:201], v[174:177], v[98:101]
    ds_read_b64_tr_b16 v[194:195], v38 offset:8192
    s_waitcnt lgkmcnt(9)
    v_mfma_f32_16x16x32_bf16 v[94:97], v[178:181], v[158:161], v[94:97]
    ds_read_b64_tr_b16 v[196:197], v38 offset:8704
    s_waitcnt lgkmcnt(8)
    v_mfma_f32_16x16x32_bf16 v[94:97], v[182:185], v[170:173], v[94:97]
    ds_read_b64_tr_b16 v[198:199], v38 offset:12288
    v_mfma_f32_16x16x32_bf16 v[102:105], v[178:181], v[162:165], v[102:105]
    ds_read_b64_tr_b16 v[200:201], v38 offset:12800
    v_mfma_f32_16x16x32_bf16 v[102:105], v[182:185], v[174:177], v[102:105]
    s_waitcnt lgkmcnt(7)
    v_mfma_f32_16x16x32_bf16 v[106:109], v[154:157], v[186:189], v[106:109]
    s_waitcnt lgkmcnt(4)
    v_mfma_f32_16x16x32_bf16 v[106:109], v[166:169], v[190:193], v[106:109]
    v_mfma_f32_16x16x32_bf16 v[114:117], v[158:161], v[186:189], v[114:117]
    v_mfma_f32_16x16x32_bf16 v[114:117], v[170:173], v[190:193], v[114:117]
    v_mfma_f32_16x16x32_bf16 v[122:125], v[162:165], v[186:189], v[122:125]
    v_mfma_f32_16x16x32_bf16 v[122:125], v[174:177], v[190:193], v[122:125]
    s_waitcnt lgkmcnt(2)
    v_mfma_f32_16x16x32_bf16 v[110:113], v[154:157], v[194:197], v[110:113]
    s_waitcnt lgkmcnt(0)
    v_mfma_f32_16x16x32_bf16 v[110:113], v[166:169], v[198:201], v[110:113]
    v_mfma_f32_16x16x32_bf16 v[118:121], v[158:161], v[194:197], v[118:121]
    s_barrier
    ds_read_b128 v[134:137], v35 offset:2048
    ds_read_b64_tr_b16 v[178:179], v37 offset:16384
    ds_read_b64_tr_b16 v[180:181], v37 offset:16896
    ds_read_b128 v[146:149], v36 offset:2048
    ds_read_b64_tr_b16 v[182:183], v37 offset:20480
    ds_read_b64_tr_b16 v[184:185], v37 offset:20992
    ds_read_b128 v[138:141], v35 offset:4096
    ds_read_b128 v[150:153], v36 offset:4096
    ds_read_b64_tr_b16 v[186:187], v38 offset:16384
    ds_read_b64_tr_b16 v[188:189], v38 offset:16896
    ds_read_b64_tr_b16 v[190:191], v38 offset:20480
    ds_read_b64_tr_b16 v[192:193], v38 offset:20992
    v_mfma_f32_16x16x32_bf16 v[118:121], v[170:173], v[198:201], v[118:121]
    v_mfma_f32_16x16x32_bf16 v[126:129], v[162:165], v[194:197], v[126:129]
    ds_read_b64_tr_b16 v[194:195], v37 offset:24576
    v_mfma_f32_16x16x32_bf16 v[126:129], v[174:177], v[198:201], v[126:129]
    ds_read_b64_tr_b16 v[196:197], v37 offset:25088
    s_waitcnt lgkmcnt(11)
    v_mfma_f32_16x16x32_bf16 v[66:69], v[178:181], v[134:137], v[66:69]
    ds_read_b64_tr_b16 v[198:199], v37 offset:28672
    s_waitcnt lgkmcnt(9)
    v_mfma_f32_16x16x32_bf16 v[66:69], v[182:185], v[146:149], v[66:69]
    ds_read_b64_tr_b16 v[200:201], v37 offset:29184
    s_waitcnt lgkmcnt(9)
    v_mfma_f32_16x16x32_bf16 v[74:77], v[178:181], v[138:141], v[74:77]
    ds_read_b64_tr_b16 v[178:179], v38 offset:24576
    s_waitcnt lgkmcnt(9)
    v_mfma_f32_16x16x32_bf16 v[74:77], v[182:185], v[150:153], v[74:77]
    ds_read_b64_tr_b16 v[180:181], v38 offset:25088
    s_waitcnt lgkmcnt(8)
    v_mfma_f32_16x16x32_bf16 v[70:73], v[186:189], v[134:137], v[70:73]
    ds_read_b64_tr_b16 v[182:183], v38 offset:28672
    s_waitcnt lgkmcnt(7)
    v_mfma_f32_16x16x32_bf16 v[70:73], v[190:193], v[146:149], v[70:73]
    ds_read_b64_tr_b16 v[184:185], v38 offset:29184
    v_mfma_f32_16x16x32_bf16 v[78:81], v[186:189], v[138:141], v[78:81]
    ds_read_b128 v[130:133], v35 offset:0
    v_mfma_f32_16x16x32_bf16 v[78:81], v[190:193], v[150:153], v[78:81]
    ds_read_b64_tr_b16 v[186:187], v37 offset:32768
    s_waitcnt lgkmcnt(8)
    v_mfma_f32_16x16x32_bf16 v[90:93], v[194:197], v[134:137], v[90:93]
    ds_read_b64_tr_b16 v[188:189], v37 offset:33280
    s_waitcnt lgkmcnt(7)
    v_mfma_f32_16x16x32_bf16 v[90:93], v[198:201], v[146:149], v[90:93]
    ds_read_b128 v[142:145], v36 offset:0
    v_mfma_f32_16x16x32_bf16 v[98:101], v[194:197], v[138:141], v[98:101]
    ds_read_b64_tr_b16 v[190:191], v37 offset:36864
    ds_read_b64_tr_b16 v[192:193], v37 offset:37376
    v_mfma_f32_16x16x32_bf16 v[98:101], v[198:201], v[150:153], v[98:101]
    ds_read_b64_tr_b16 v[194:195], v38 offset:32768
    s_waitcnt lgkmcnt(9)
    v_mfma_f32_16x16x32_bf16 v[94:97], v[178:181], v[134:137], v[94:97]
    ds_read_b64_tr_b16 v[196:197], v38 offset:33280
    s_waitcnt lgkmcnt(8)
    v_mfma_f32_16x16x32_bf16 v[94:97], v[182:185], v[146:149], v[94:97]
    ds_read_b64_tr_b16 v[198:199], v38 offset:36864
    v_mfma_f32_16x16x32_bf16 v[102:105], v[178:181], v[138:141], v[102:105]
    ds_read_b64_tr_b16 v[200:201], v38 offset:37376
    v_mfma_f32_16x16x32_bf16 v[102:105], v[182:185], v[150:153], v[102:105]
    s_waitcnt lgkmcnt(7)
    v_mfma_f32_16x16x32_bf16 v[106:109], v[130:133], v[186:189], v[106:109]
    s_waitcnt lgkmcnt(4)
    v_mfma_f32_16x16x32_bf16 v[106:109], v[142:145], v[190:193], v[106:109]
    v_mfma_f32_16x16x32_bf16 v[114:117], v[134:137], v[186:189], v[114:117]
    v_mfma_f32_16x16x32_bf16 v[114:117], v[146:149], v[190:193], v[114:117]
    v_mfma_f32_16x16x32_bf16 v[122:125], v[138:141], v[186:189], v[122:125]
    v_mfma_f32_16x16x32_bf16 v[122:125], v[150:153], v[190:193], v[122:125]
    s_waitcnt lgkmcnt(2)
    v_mfma_f32_16x16x32_bf16 v[110:113], v[130:133], v[194:197], v[110:113]
    s_waitcnt lgkmcnt(0)
    v_mfma_f32_16x16x32_bf16 v[110:113], v[142:145], v[198:201], v[110:113]
    v_mfma_f32_16x16x32_bf16 v[118:121], v[134:137], v[194:197], v[118:121]
    s_barrier
    ds_read_b128 v[158:161], v35 offset:12288
    ds_read_b64_tr_b16 v[178:179], v37 offset:40960
    ds_read_b64_tr_b16 v[180:181], v37 offset:41472
    ds_read_b128 v[170:173], v36 offset:12288
    ds_read_b64_tr_b16 v[182:183], v37 offset:45056
    ds_read_b64_tr_b16 v[184:185], v37 offset:45568
    ds_read_b128 v[162:165], v35 offset:14336
    ds_read_b128 v[174:177], v36 offset:14336
    ds_read_b64_tr_b16 v[186:187], v38 offset:40960
    ds_read_b64_tr_b16 v[188:189], v38 offset:41472
    ds_read_b64_tr_b16 v[190:191], v38 offset:45056
    ds_read_b64_tr_b16 v[192:193], v38 offset:45568
    ds_read_b64_tr_b16 v[202:203], v39 offset:0
    v_mfma_f32_16x16x32_bf16 v[118:121], v[146:149], v[198:201], v[118:121]
    ds_read_b64_tr_b16 v[204:205], v39 offset:512
    v_mfma_f32_16x16x32_bf16 v[126:129], v[138:141], v[194:197], v[126:129]
    ds_read_b64_tr_b16 v[206:207], v39 offset:4096
    v_mfma_f32_16x16x32_bf16 v[126:129], v[150:153], v[198:201], v[126:129]
    ds_read_b64_tr_b16 v[208:209], v39 offset:4608
    s_waitcnt lgkmcnt(13)
    v_mfma_f32_16x16x32_bf16 v[66:69], v[178:181], v[158:161], v[66:69]
    ds_read_b64_tr_b16 v[194:195], v40 offset:0
    s_waitcnt lgkmcnt(11)
    v_mfma_f32_16x16x32_bf16 v[66:69], v[182:185], v[170:173], v[66:69]
    ds_read_b64_tr_b16 v[196:197], v40 offset:512
    s_waitcnt lgkmcnt(11)
    v_mfma_f32_16x16x32_bf16 v[74:77], v[178:181], v[162:165], v[74:77]
    ds_read_b64_tr_b16 v[198:199], v40 offset:4096
    s_waitcnt lgkmcnt(11)
    v_mfma_f32_16x16x32_bf16 v[74:77], v[182:185], v[174:177], v[74:77]
    ds_read_b64_tr_b16 v[200:201], v40 offset:4608
    s_waitcnt lgkmcnt(10)
    v_mfma_f32_16x16x32_bf16 v[70:73], v[186:189], v[158:161], v[70:73]
    s_waitcnt lgkmcnt(8)
    v_mfma_f32_16x16x32_bf16 v[70:73], v[190:193], v[170:173], v[70:73]
    v_mfma_f32_16x16x32_bf16 v[78:81], v[186:189], v[162:165], v[78:81]
    v_mfma_f32_16x16x32_bf16 v[78:81], v[190:193], v[174:177], v[78:81]
    s_waitcnt lgkmcnt(6)
    v_mfma_f32_16x16x32_bf16 v[90:93], v[202:205], v[158:161], v[90:93]
    s_waitcnt lgkmcnt(4)
    v_mfma_f32_16x16x32_bf16 v[90:93], v[206:209], v[170:173], v[90:93]
    v_mfma_f32_16x16x32_bf16 v[98:101], v[202:205], v[162:165], v[98:101]
    v_mfma_f32_16x16x32_bf16 v[98:101], v[206:209], v[174:177], v[98:101]
    s_waitcnt lgkmcnt(2)
    v_mfma_f32_16x16x32_bf16 v[94:97], v[194:197], v[158:161], v[94:97]
    s_waitcnt lgkmcnt(0)
    v_mfma_f32_16x16x32_bf16 v[94:97], v[198:201], v[170:173], v[94:97]
    v_mfma_f32_16x16x32_bf16 v[102:105], v[194:197], v[162:165], v[102:105]
    s_barrier
    ds_read_b128 v[134:137], v35 offset:22528
    ds_read_b64_tr_b16 v[178:179], v39 offset:8192
    ds_read_b64_tr_b16 v[180:181], v39 offset:8704
    ds_read_b128 v[146:149], v36 offset:22528
    ds_read_b64_tr_b16 v[182:183], v39 offset:12288
    ds_read_b64_tr_b16 v[184:185], v39 offset:12800
    ds_read_b128 v[138:141], v35 offset:24576
    ds_read_b128 v[150:153], v36 offset:24576
    ds_read_b64_tr_b16 v[186:187], v40 offset:8192
    ds_read_b64_tr_b16 v[188:189], v40 offset:8704
    ds_read_b64_tr_b16 v[190:191], v40 offset:12288
    ds_read_b64_tr_b16 v[192:193], v40 offset:12800
    ds_read_b128 v[130:133], v35 offset:20480
    v_mfma_f32_16x16x32_bf16 v[102:105], v[198:201], v[174:177], v[102:105]
    ds_read_b128 v[142:145], v36 offset:20480
    s_waitcnt lgkmcnt(11)
    v_mfma_f32_16x16x32_bf16 v[66:69], v[178:181], v[134:137], v[66:69]
    s_barrier
    ds_read_b64_tr_b16 v[202:203], v39 offset:16384
    ds_read_b64_tr_b16 v[204:205], v39 offset:16896
    ds_read_b64_tr_b16 v[206:207], v39 offset:20480
    ds_read_b64_tr_b16 v[208:209], v39 offset:20992
    ds_read_b64_tr_b16 v[194:195], v40 offset:16384
    s_waitcnt lgkmcnt(13)
    v_mfma_f32_16x16x32_bf16 v[66:69], v[182:185], v[146:149], v[66:69]
    ds_read_b64_tr_b16 v[196:197], v40 offset:16896
    s_waitcnt lgkmcnt(13)
    v_mfma_f32_16x16x32_bf16 v[74:77], v[178:181], v[138:141], v[74:77]
    ds_read_b64_tr_b16 v[198:199], v40 offset:20480
    s_waitcnt lgkmcnt(13)
    v_mfma_f32_16x16x32_bf16 v[74:77], v[182:185], v[150:153], v[74:77]
    ds_read_b64_tr_b16 v[200:201], v40 offset:20992
    s_waitcnt lgkmcnt(12)
    v_mfma_f32_16x16x32_bf16 v[70:73], v[186:189], v[134:137], v[70:73]
    v_cvt_pk_bf16_f32 v154, v66, v67
    v_cvt_pk_bf16_f32 v155, v68, v69
    s_waitcnt lgkmcnt(10)
    v_mfma_f32_16x16x32_bf16 v[70:73], v[190:193], v[146:149], v[70:73]
    v_cndmask_b32 v162, 0, v154, s[54:55]
    v_cndmask_b32 v154, v154, 0, s[54:55]
    v_mfma_f32_16x16x32_bf16 v[78:81], v[186:189], v[138:141], v[78:81]
    v_cndmask_b32 v163, 0, v155, s[54:55]
    v_cndmask_b32 v155, v155, 0, s[54:55]
    v_mfma_f32_16x16x32_bf16 v[78:81], v[190:193], v[150:153], v[78:81]
    v_cvt_pk_bf16_f32 v158, v74, v75
    v_cvt_pk_bf16_f32 v159, v76, v77
    s_waitcnt lgkmcnt(6)
    v_mfma_f32_16x16x32_bf16 v[90:93], v[202:205], v[134:137], v[90:93]
    v_cndmask_b32 v166, 0, v158, s[54:55]
    v_cndmask_b32 v158, v158, 0, s[54:55]
    s_waitcnt lgkmcnt(4)
    v_mfma_f32_16x16x32_bf16 v[90:93], v[206:209], v[146:149], v[90:93]
    v_cndmask_b32 v167, 0, v159, s[54:55]
    v_cndmask_b32 v159, v159, 0, s[54:55]
    s_waitcnt lgkmcnt(2)
    v_mfma_f32_16x16x32_bf16 v[94:97], v[194:197], v[134:137], v[94:97]
    v_cvt_pk_bf16_f32 v156, v70, v71
    v_cvt_pk_bf16_f32 v157, v72, v73
    s_waitcnt lgkmcnt(0)
    v_mfma_f32_16x16x32_bf16 v[94:97], v[198:201], v[146:149], v[94:97]
    v_cndmask_b32 v164, 0, v156, s[56:57]
    v_cndmask_b32 v156, v156, 0, s[56:57]
    v_mfma_f32_16x16x32_bf16 v[98:101], v[202:205], v[138:141], v[98:101]
    v_cndmask_b32 v165, 0, v157, s[56:57]
    v_cndmask_b32 v157, v157, 0, s[56:57]
    v_mfma_f32_16x16x32_bf16 v[98:101], v[206:209], v[150:153], v[98:101]
    v_cvt_pk_bf16_f32 v160, v78, v79
    v_cvt_pk_bf16_f32 v161, v80, v81
    v_mfma_f32_16x16x32_bf16 v[102:105], v[194:197], v[138:141], v[102:105]
    v_cndmask_b32 v168, 0, v160, s[56:57]
    v_cndmask_b32 v160, v160, 0, s[56:57]
    v_mfma_f32_16x16x32_bf16 v[102:105], v[198:201], v[150:153], v[102:105]
    ds_read_b32 v45, v5 offset:4
    v_cndmask_b32 v169, 0, v161, s[56:57]
    v_cndmask_b32 v161, v161, 0, s[56:57]
    ds_read_b32 v53, v224 offset:56
    ds_read_b128 v[230:233], v222
    v_cvt_pk_bf16_f32 v234, v90, v91
    v_cvt_pk_bf16_f32 v235, v92, v93
    v_cvt_pk_bf16_f32 v236, v94, v95
    v_cvt_pk_bf16_f32 v237, v96, v97
    s_nop 1
    v_mfma_f32_16x16x32_bf16 v[70:73], v[234:237], v[154:157], 0
    v_mfma_f32_16x16x32_bf16 v[74:77], v[234:237], v[158:161], 0
    v_cvt_pk_bf16_f32 v238, v98, v99
    v_cvt_pk_bf16_f32 v239, v100, v101
    v_cvt_pk_bf16_f32 v240, v102, v103
    v_cvt_pk_bf16_f32 v241, v104, v105
    s_nop 1
    v_mfma_f32_16x16x32_bf16 v[78:81], v[238:241], v[158:161], 0
    v_mfma_f32_16x16x32_bf16 v[182:185], v[234:237], v[162:165], 0
    v_mfma_f32_16x16x32_bf16 v[186:189], v[234:237], v[166:169], 0
    s_waitcnt lgkmcnt(0)
    v_cmp_ne_u32 vcc, 0, v53
    s_nop 0
    s_cbranch_vccnz D_dK
    s_mov_b32 s9, 0
D_lK:
    ds_read_b32 v53, v224 offset:56
    ds_read_b128 v[230:233], v222
    s_add_u32 s9, s9, 1
    s_cmp_gt_u32 s9, 1600000
    s_waitcnt lgkmcnt(0)
    s_cbranch_scc1 D_dK
    v_cmp_eq_u32 vcc, 0, v53
    s_nop 0
    s_cbranch_vccnz D_lK
D_dK:
    v_mfma_f32_16x16x32_bf16 v[66:69], v[230:233], v[154:157], 0
    v_readfirstlane_b32 s63, v45
    v_cndmask_b32 v78, v78, v79, s[44:45]
    v_cndmask_b32 v80, v80, v81, s[44:45]
    v_cndmask_b32 v74, v74, v75, s[44:45]
    v_cndmask_b32 v76, v76, v77, s[44:45]
    v_cndmask_b32 v216, v74, v78, s[46:47]
    v_cndmask_b32 v217, v76, v80, s[48:49]
    v_cndmask_b32 v70, v70, v71, s[44:45]
    v_cndmask_b32 v72, v72, v73, s[44:45]
    v_cndmask_b32 v66, v66, v67, s[44:45]
    v_cndmask_b32 v68, v68, v69, s[44:45]
    v_cndmask_b32 v214, v66, v70, s[46:47]
    v_cndmask_b32 v215, v68, v72, s[48:49]
    v_and_or_b32 v98, v214, v51, v54
    v_and_or_b32 v99, v215, v51, v55
    v_and_or_b32 v100, v216, v51, v56
    v_and_or_b32 v101, v217, v51, v57
    s_sub_u32 s63, s63, 1
    s_cbranch_scc1 C_mr1
C_md1:
    s_cmp_lg_u32 s101, 0
    s_cbranch_scc1 SM_jS1
    s_cmp_eq_u32 s63, 0
    s_cbranch_scc1 SM_sS1
    buffer_store_dwordx4 v[98:101], v4, s[36:39], s15 offen
SM_jS1:
    v_mfma_f32_16x16x32_bf16 v[178:181], v[230:233], v[162:165], 0
    v_mfma_f32_16x16x32_bf16 v[190:193], v[238:241], v[166:169], 0
    ds_read_b32 v45, v5 offset:32
    ds_read_b64_tr_b16 v[170:171], v39 offset:32768
    ds_read_b64_tr_b16 v[172:173], v39 offset:33280
    ds_read_b64_tr_b16 v[174:175], v40 offset:32768
    ds_read_b64_tr_b16 v[176:177], v40 offset:33280
    ds_read_b64_tr_b16 v[202:203], v39 offset:36864
    ds_read_b64_tr_b16 v[204:205], v39 offset:37376
    ds_read_b64_tr_b16 v[206:207], v40 offset:36864
    ds_read_b64_tr_b16 v[208:209], v40 offset:37376
    v_cndmask_b32 v190, v190, v191, s[44:45]
    v_cndmask_b32 v192, v192, v193, s[44:45]
    v_cndmask_b32 v186, v186, v187, s[44:45]
    v_cndmask_b32 v188, v188, v189, s[44:45]
    v_cndmask_b32 v212, v186, v190, s[46:47]
    v_cndmask_b32 v213, v188, v192, s[48:49]
    v_cndmask_b32 v182, v182, v183, s[44:45]
    v_cndmask_b32 v184, v184, v185, s[44:45]
    v_cndmask_b32 v178, v178, v179, s[44:45]
    v_cndmask_b32 v180, v180, v181, s[44:45]
    v_cndmask_b32 v210, v178, v182, s[46:47]
    v_cndmask_b32 v211, v180, v184, s[48:49]
    ds_write_b128 v47, v[210:213]
    ds_write_b32 v52, v5 offset:16
    s_waitcnt lgkmcnt(10)
    v_cmp_gt_u32 vcc, 4, v45
    s_nop 0
    s_cbranch_vccnz C_vr1
C_vd1:
    s_waitcnt lgkmcnt(8)
    v_mfma_f32_16x16x32_bf16 v[106:109], v[130:133], v[170:173], v[106:109]
    ds_read_b128 v[154:157], v35 offset:10240
    s_waitcnt lgkmcnt(5)
    v_mfma_f32_16x16x32_bf16 v[106:109], v[142:145], v[202:205], v[106:109]
    ds_read_b64_tr_b16 v[186:187], v39 offset:24576
    v_mfma_f32_16x16x32_bf16 v[114:117], v[134:137], v[170:173], v[114:117]
    ds_read_b64_tr_b16 v[188:189], v39 offset:25088
    v_mfma_f32_16x16x32_bf16 v[114:117], v[146:149], v[202:205], v[114:117]
    ds_read_b128 v[166:169], v36 offset:10240
    v_mfma_f32_16x16x32_bf16 v[122:125], v[138:141], v[170:173], v[122:125]
    ds_read_b64_tr_b16 v[194:195], v39 offset:28672
    v_mfma_f32_16x16x32_bf16 v[122:125], v[150:153], v[202:205], v[122:125]
    ds_read_b64_tr_b16 v[196:197], v39 offset:29184
    v_mfma_f32_16x16x32_bf16 v[110:113], v[130:133], v[174:177], v[110:113]
    ds_read_b64_tr_b16 v[190:191], v40 offset:24576
    ds_read_b64_tr_b16 v[192:193], v40 offset:25088
    s_waitcnt lgkmcnt(10)
    v_mfma_f32_16x16x32_bf16 v[110:113], v[142:145], v[206:209], v[110:113]
    ds_read_b64_tr_b16 v[198:199], v40 offset:28672
    ds_read_b64_tr_b16 v[200:201], v40 offset:29184
    v_mfma_f32_16x16x32_bf16 v[118:121], v[134:137], v[174:177], v[118:121]
    ds_read_b128 v[158:161], v35 offset:12288
    v_mfma_f32_16x16x32_bf16 v[118:121], v[146:149], v[206:209], v[118:121]
    ds_read_b128 v[178:181], v36 offset:12288
    v_mfma_f32_16x16x32_bf16 v[126:129], v[138:141], v[174:177], v[126:129]
    ds_read_b128 v[162:165], v35 offset:14336
    v_mfma_f32_16x16x32_bf16 v[126:129], v[150:153], v[206:209], v[126:129]
    ds_read_b128 v[182:185], v36 offset:14336
    s_waitcnt lgkmcnt(11)
    v_mfma_f32_16x16x32_bf16 v[106:109], v[154:157], v[186:189], v[106:109]
    s_waitcnt lgkmcnt(8)
    v_mfma_f32_16x16x32_bf16 v[106:109], v[166:169], v[194:197], v[106:109]
    s_waitcnt lgkmcnt(6)
    v_mfma_f32_16x16x32_bf16 v[110:113], v[154:157], v[190:193], v[110:113]
    s_waitcnt lgkmcnt(4)
    v_mfma_f32_16x16x32_bf16 v[110:113], v[166:169], v[198:201], v[110:113]
    s_waitcnt lgkmcnt(3)
    v_mfma_f32_16x16x32_bf16 v[114:117], v[158:161], v[186:189], v[114:117]
    s_nop 1
    v_cvt_pk_bf16_f32 v230, v106, v107
    v_cvt_pk_bf16_f32 v231, v108, v109
    ds_write_b64 v223, v[230:231] offset:0
    s_waitcnt lgkmcnt(3)
    v_mfma_f32_16x16x32_bf16 v[114:117], v[178:181], v[194:197], v[114:117]
    v_mfma_f32_16x16x32_bf16 v[118:121], v[158:161], v[190:193], v[118:121]
    v_cvt_pk_bf16_f32 v236, v110, v111
    v_cvt_pk_bf16_f32 v237, v112, v113
    ds_write_b64 v223, v[236:237] offset:8
    v_mfma_f32_16x16x32_bf16 v[118:121], v[178:181], v[198:201], v[118:121]
    ds_write_b32 v225, v5 offset:68
    s_waitcnt lgkmcnt(4)
    v_mfma_f32_16x16x32_bf16 v[122:125], v[162:165], v[186:189], v[122:125]
    v_cvt_pk_bf16_f32 v232, v114, v115
    v_cvt_pk_bf16_f32 v233, v116, v117
    s_waitcnt lgkmcnt(3)
    v_mfma_f32_16x16x32_bf16 v[122:125], v[182:185], v[194:197], v[122:125]
    v_mfma_f32_16x16x32_bf16 v[126:129], v[162:165], v[190:193], v[126:129]
    v_cvt_pk_bf16_f32 v238, v118, v119
    v_cvt_pk_bf16_f32 v239, v120, v121
    v_mfma_f32_16x16x32_bf16 v[126:129], v[182:185], v[198:201], v[126:129]
    v_cndmask_b32 v130, 0, v230, s[58:59]
    v_cndmask_b32 v230, v230, 0, s[58:59]
    v_cndmask_b32 v131, 0, v231, s[58:59]
    v_cndmask_b32 v231, v231, 0, s[58:59]
    buffer_load_dwordx4 v[218:221], v4, s[36:39], s100 offen sc1
    v_cvt_pk_bf16_f32 v234, v122, v123
    v_cvt_pk_bf16_f32 v235, v124, v125
    s_nop 0
    v_cvt_pk_bf16_f32 v240, v126, v127
    v_cvt_pk_bf16_f32 v241, v128, v129
    v_cndmask_b32 v136, 0, v236, s[60:61]
    v_cndmask_b32 v236, v236, 0, s[60:61]
    v_cndmask_b32 v137, 0, v237, s[60:61]
    v_cndmask_b32 v237, v237, 0, s[60:61]
    v_cndmask_b32 v132, 0, v232, s[58:59]
    v_cndmask_b32 v232, v232, 0, s[58:59]
    v_cndmask_b32 v133, 0, v233, s[58:59]
    v_cndmask_b32 v233, v233, 0, s[58:59]
    v_cndmask_b32 v138, 0, v238, s[60:61]
    v_cndmask_b32 v238, v238, 0, s[60:61]
    v_cndmask_b32 v139, 0, v239, s[60:61]
    v_cndmask_b32 v239, v239, 0, s[60:61]
    v_cndmask_b32 v134, 0, v234, s[58:59]
    v_cndmask_b32 v234, v234, 0, s[58:59]
    v_cndmask_b32 v135, 0, v235, s[58:59]
    v_cndmask_b32 v235, v235, 0, s[58:59]
    v_cndmask_b32 v140, 0, v240, s[60:61]
    v_cndmask_b32 v240, v240, 0, s[60:61]
    v_cndmask_b32 v141, 0, v241, s[60:61]
    v_cndmask_b32 v241, v241, 0, s[60:61]
    s_waitcnt lgkmcnt(0)
C_join:
    v_mov_b32 v12, s0
    v_mov_b32 v13, s0
    v_pk_mul_f32 v[214:215], v[214:215], v[12:13]
    v_pk_mul_f32 v[216:217], v[216:217], v[12:13]
    s_mov_b32 s9, 0
    s_add_u32 s19, s100, 14336
    s_cmp_lg_u32 s101, 0
    s_cbranch_scc1 C_sv
    s_mov_b32 s40, 0x0c0c0400
    s_mov_b32 s41, 0x05040100
    s_waitcnt vmcnt(0)
C_sl:
    v_perm_b32 v2, v219, v218, s40
    v_perm_b32 v3, v221, v220, s40
    v_and_b32 v218, v51, v218
    v_perm_b32 v2, v3, v2, s41
    v_and_b32 v219, v51, v219
    v_cmp_ne_u32 vcc, s12, v2
    v_and_b32 v220, v51, v220
    v_and_b32 v221, v51, v221
    s_cbranch_vccz C_sk
    buffer_load_dwordx4 v[218:221], v4, s[36:39], s100 offen sc1
    s_waitcnt vmcnt(0)
    s_add_u32 s9, s9, 1
    s_cmp_lt_u32 s9, 200000
    s_cbranch_scc1 C_sl
C_sk:
    v_pk_fma_f32 v[214:215], v[218:219], v[12:13], v[214:215]
    v_pk_fma_f32 v[216:217], v[220:221], v[12:13], v[216:217]
C_sv:
    v_max_f32 v226, v214, v215
    v_max_f32 v227, v216, v217
    v_mov_b32 v228, v226
    v_mov_b32 v229, v227
    s_mov_b64 exec, 1
    ds_add_u32 v5, v49 offset:80
    s_mov_b64 exec, -1
    v_permlane16_swap_b32 v226, v228
    v_permlane16_swap_b32 v227, v229
    v_max_f32 v226, v226, v228
    v_max_f32 v227, v227, v229
    v_mov_b32 v228, v226
    v_mov_b32 v229, v227
    s_nop 0
    v_permlane32_swap_b32 v226, v228
    v_permlane32_swap_b32 v227, v229
    v_max_f32 v226, v226, v228
    v_max_f32 v227, v227, v229
    v_sub_f32 v214, v214, v226
    v_sub_f32 v215, v215, v226
    v_sub_f32 v216, v216, v227
    v_sub_f32 v217, v217, v227
    v_exp_f32 v214, v214
    v_exp_f32 v215, v215
    v_exp_f32 v216, v216
    v_exp_f32 v217, v217
    v_add_f32 v226, v214, v215
    v_add_f32 v227, v216, v217
    v_mov_b32 v228, v226
    v_mov_b32 v229, v227
    ds_read_b32 v53, v52 offset:40
    ds_read_b128 v[82:85], v48 offset:12288
    ds_read_b128 v[86:89], v48 offset:13312
    ds_read_b32 v7, v5 offset:12
    v_permlane16_swap_b32 v226, v228
    v_permlane16_swap_b32 v227, v229
    v_add_f32 v226, v226, v228
    v_add_f32 v227, v227, v229
    v_mov_b32 v228, v226
    v_mov_b32 v229, v227
    s_nop 0
    v_permlane32_swap_b32 v226, v228
    v_permlane32_swap_b32 v227, v229
    v_add_f32 v226, v226, v228
    v_add_f32 v227, v227, v229
    v_rcp_f32 v226, v226
    v_rcp_f32 v227, v227
    s_waitcnt lgkmcnt(0)
    v_cmp_eq_u32 vcc, 0, v53
    v_mul_f32 v214, v214, v226
    v_mul_f32 v215, v215, v226
    v_mul_f32 v216, v216, v227
    v_mul_f32 v217, v217, v227
    v_cvt_pk_bf16_f32 v214, v214, v214
    v_cvt_pk_bf16_f32 v215, v215, v215
    v_cvt_pk_bf16_f32 v216, v216, v216
    v_cvt_pk_bf16_f32 v217, v217, v217
    s_cbranch_vccnz C_pr
C_pd:
    v_mfma_f32_16x16x32_bf16 v[66:69], v[130:133], v[82:85], 0
    v_and_b32 v90, v41, v214
    v_and_b32 v91, v42, v215
    v_mfma_f32_16x16x32_bf16 v[70:73], v[136:139], v[82:85], 0
    v_and_b32 v92, v43, v214
    v_and_b32 v93, v44, v215
    v_mfma_f32_16x16x32_bf16 v[74:77], v[132:135], v[86:89], 0
    v_and_b32 v94, v41, v216
    v_and_b32 v95, v42, v217
    v_mfma_f32_16x16x32_bf16 v[78:81], v[138:141], v[86:89], 0
    v_and_b32 v96, v43, v216
    v_and_b32 v97, v44, v217
    v_mfma_f32_16x16x32_bf16 v[66:69], v[230:233], v[90:93], v[66:69]
    v_mfma_f32_16x16x32_bf16 v[70:73], v[236:239], v[90:93], v[70:73]
    v_mfma_f32_16x16x32_bf16 v[74:77], v[232:235], v[94:97], v[74:77]
    v_mfma_f32_16x16x32_bf16 v[78:81], v[238:241], v[94:97], v[78:81]
    s_cmp_eq_u32 s63, 0
    s_cbranch_scc1 SM_sO
    s_nop 2
    v_cvt_pk_bf16_f32 v58, v66, v67
    v_cvt_pk_bf16_f32 v59, v68, v69
    v_cvt_pk_bf16_f32 v60, v70, v71
    v_cvt_pk_bf16_f32 v61, v72, v73
    buffer_store_dwordx4 v[58:61], v4, s[36:39], s100 offen nt
    v_cvt_pk_bf16_f32 v62, v74, v75
    v_cvt_pk_bf16_f32 v63, v76, v77
    v_cvt_pk_bf16_f32 v64, v78, v79
    v_cvt_pk_bf16_f32 v65, v80, v81
    buffer_store_dwordx4 v[62:65], v4, s[36:39], s19 offen nt
SM_jO:
    ds_write_b128 v18, v[58:61] offset:20480
    ds_write_b128 v18, v[62:65] offset:22528
    ds_write_b32 v52, v5 offset:96
    v_cmp_gt_u32 vcc, 4, v7
    s_nop 0
    s_cbranch_vccz W_dW
    s_mov_b32 s9, 0
W_lW:
    ds_read_b32 v2, v5 offset:12
    s_add_u32 s9, s9, 1
    s_cmp_gt_u32 s9, 1600000
    s_cbranch_scc1 W_dW
    s_waitcnt lgkmcnt(0)
    v_cmp_gt_u32 vcc, 4, v2
    s_nop 0
    s_cbranch_vccnz W_lW
W_dW:
    ds_read_b64_tr_b16 v[82:83], v21 offset:0
    ds_read_b64_tr_b16 v[84:85], v21 offset:2048
    ds_read_b64_tr_b16 v[86:87], v22 offset:0
    ds_read_b64_tr_b16 v[88:89], v22 offset:2048
    ds_read_b64_tr_b16 v[90:91], v23 offset:0
    ds_read_b64_tr_b16 v[92:93], v23 offset:2048
    ds_read_b64_tr_b16 v[94:95], v24 offset:0
    ds_read_b64_tr_b16 v[96:97], v24 offset:2048
    ds_read_b64_tr_b16 v[98:99], v21 offset:4096
    ds_read_b64_tr_b16 v[100:101], v21 offset:6144
    ds_read_b64_tr_b16 v[102:103], v22 offset:4096
    ds_read_b64_tr_b16 v[104:105], v22 offset:6144
    ds_read_b64_tr_b16 v[106:107], v23 offset:4096
    ds_read_b64_tr_b16 v[108:109], v23 offset:6144
    ds_read_b64_tr_b16 v[110:111], v24 offset:4096
    ds_read_b64_tr_b16 v[112:113], v24 offset:6144
    s_waitcnt vmcnt(0)
    s_mov_b64 exec, 1
    s_cmp_eq_u32 s63, 0
    s_cbranch_scc1 SM_sF
    buffer_store_dwordx2 v[14:15], v6, s[36:39], s21 offen
SM_jF:
    s_mov_b64 exec, -1
    ds_read_b64_tr_b16 v[114:115], v21 offset:8192
    ds_read_b64_tr_b16 v[116:117], v21 offset:10240
    ds_read_b64_tr_b16 v[118:119], v22 offset:8192
    ds_read_b64_tr_b16 v[120:121], v22 offset:10240
    ds_read_b64_tr_b16 v[122:123], v23 offset:8192
    ds_read_b64_tr_b16 v[124:125], v23 offset:10240
    ds_read_b64_tr_b16 v[126:127], v24 offset:8192
    ds_read_b64_tr_b16 v[128:129], v24 offset:10240
    ds_read_b64_tr_b16 v[130:131], v21 offset:12288
    ds_read_b64_tr_b16 v[132:133], v21 offset:14336
    ds_read_b64_tr_b16 v[134:135], v22 offset:12288
    ds_read_b64_tr_b16 v[136:137], v22 offset:14336
    ds_read_b64_tr_b16 v[138:139], v23 offset:12288
    ds_read_b64_tr_b16 v[140:141], v23 offset:14336
    ds_read_b64_tr_b16 v[142:143], v24 offset:12288
    ds_read_b64_tr_b16 v[144:145], v24 offset:14336
    ds_read_b64_tr_b16 v[146:147], v21 offset:16384
    ds_read_b64_tr_b16 v[148:149], v21 offset:18432
    ds_read_b64_tr_b16 v[150:151], v22 offset:16384
    ds_read_b64_tr_b16 v[152:153], v22 offset:18432
    ds_read_b64_tr_b16 v[154:155], v23 offset:16384
    ds_read_b64_tr_b16 v[156:157], v23 offset:18432
    ds_read_b64_tr_b16 v[158:159], v24 offset:16384
    ds_read_b64_tr_b16 v[160:161], v24 offset:18432
    buffer_load_dwordx2 v[12:13], v8, s[36:39], s20 offen sc1
    s_waitcnt lgkmcnt(0)
    s_mov_b32 s9, 0
C_wl:
    ds_read_b64 v[16:17], v20 offset:96
    ds_read_b128 v[46:49], v19 offset:20480
    ds_read_b128 v[50:53], v19 offset:21504
    s_add_u32 s9, s9, 1
    s_cmp_gt_u32 s9, 1600000
    s_cbranch_scc1 C_wd
    s_waitcnt lgkmcnt(2)
    v_and_b32 v16, v16, v17
    v_cmp_eq_u32 vcc, 0, v16
    s_waitcnt lgkmcnt(0)
    s_cbranch_vccnz C_wl
C_wd:
    s_waitcnt lgkmcnt(0)
    v_mfma_f32_16x16x32_bf16 v[30:33], v[82:85], v[46:49], 0
    ds_read_b64_tr_b16 v[162:163], v21 offset:20480
    v_mfma_f32_16x16x32_bf16 v[30:33], v[98:101], v[50:53], v[30:33]
    ds_read_b64_tr_b16 v[164:165], v21 offset:22528
    v_mfma_f32_16x16x32_bf16 v[34:37], v[86:89], v[46:49], 0
    ds_read_b64_tr_b16 v[166:167], v22 offset:20480
    v_mfma_f32_16x16x32_bf16 v[34:37], v[102:105], v[50:53], v[34:37]
    ds_read_b64_tr_b16 v[168:169], v22 offset:22528
    v_mfma_f32_16x16x32_bf16 v[38:41], v[90:93], v[46:49], 0
    ds_read_b64_tr_b16 v[170:171], v23 offset:20480
    v_mfma_f32_16x16x32_bf16 v[38:41], v[106:109], v[50:53], v[38:41]
    ds_read_b64_tr_b16 v[172:173], v23 offset:22528
    v_mfma_f32_16x16x32_bf16 v[42:45], v[94:97], v[46:49], 0
    ds_read_b64_tr_b16 v[174:175], v24 offset:20480
    v_mfma_f32_16x16x32_bf16 v[42:45], v[110:113], v[50:53], v[42:45]
    ds_read_b64_tr_b16 v[176:177], v24 offset:22528
    ds_read_b64_tr_b16 v[178:179], v21 offset:24576
    ds_read_b64_tr_b16 v[180:181], v21 offset:26624
    ds_read_b64_tr_b16 v[182:183], v22 offset:24576
    ds_read_b64_tr_b16 v[184:185], v22 offset:26624
    ds_read_b64_tr_b16 v[186:187], v23 offset:24576
    ds_read_b64_tr_b16 v[188:189], v23 offset:26624
    ds_read_b64_tr_b16 v[190:191], v24 offset:24576
    ds_read_b64_tr_b16 v[192:193], v24 offset:26624
    s_mov_b32 s9, 0
P_lO:
    s_waitcnt vmcnt(0)
    v_cmp_ne_u64 vcc, s[12:13], v[12:13]
    s_nop 0
    s_cbranch_vccz P_dO
    buffer_load_dwordx2 v[12:13], v8, s[36:39], s20 offen sc1
    s_add_u32 s9, s9, 1
    s_cmp_lt_u32 s9, 200000
    s_cbranch_scc1 P_lO
    s_waitcnt vmcnt(0)
P_dO:
    buffer_load_dwordx4 v[54:57], v4, s[36:39], s1 offen offset:0 sc1
    buffer_load_dwordx4 v[58:61], v4, s[36:39], s1 offen offset:1024 sc1
    buffer_load_dwordx4 v[62:65], v4, s[36:39], s4 offen offset:0 sc1
    buffer_load_dwordx4 v[66:69], v4, s[36:39], s4 offen offset:1024 sc1
    buffer_load_dwordx4 v[70:73], v4, s[36:39], s6 offen offset:0 sc1
C_go:
    ds_read_b32 v7, v5 offset:36
    ds_read_b64_tr_b16 v[194:195], v21 offset:28672
    ds_read_b64_tr_b16 v[196:197], v21 offset:30720
    ds_read_b64_tr_b16 v[198:199], v22 offset:28672
    ds_read_b64_tr_b16 v[200:201], v22 offset:30720
    ds_read_b64_tr_b16 v[202:203], v23 offset:28672
    ds_read_b64_tr_b16 v[204:205], v23 offset:30720
    ds_read_b64_tr_b16 v[206:207], v24 offset:28672
    ds_read_b64_tr_b16 v[208:209], v24 offset:30720
    ds_read_b64_tr_b16 v[210:211], v21 offset:32768
    ds_read_b64_tr_b16 v[212:213], v21 offset:34816
    ds_read_b64_tr_b16 v[214:215], v22 offset:32768
    ds_read_b64_tr_b16 v[216:217], v22 offset:34816
    ds_read_b64_tr_b16 v[218:219], v23 offset:32768
    ds_read_b64_tr_b16 v[220:221], v23 offset:34816
    ds_read_b64_tr_b16 v[222:223], v24 offset:32768
    ds_read_b64_tr_b16 v[224:225], v24 offset:34816
    ds_read_b64_tr_b16 v[226:227], v21 offset:36864
    ds_read_b64_tr_b16 v[228:229], v21 offset:38912
    ds_read_b64_tr_b16 v[230:231], v22 offset:36864
    ds_read_b64_tr_b16 v[232:233], v22 offset:38912
    ds_read_b64_tr_b16 v[234:235], v23 offset:36864
    ds_read_b64_tr_b16 v[236:237], v23 offset:38912
    ds_read_b64_tr_b16 v[238:239], v24 offset:36864
    ds_read_b64_tr_b16 v[240:241], v24 offset:38912
    s_waitcnt vmcnt(4)
    v_mfma_f32_16x16x32_bf16 v[30:33], v[114:117], v[54:57], v[30:33]
    buffer_load_dwordx4 v[74:77], v4, s[36:39], s6 offen offset:1024 sc1
    v_mfma_f32_16x16x32_bf16 v[34:37], v[118:121], v[54:57], v[34:37]
    s_waitcnt lgkmcnt(15)
    v_cmp_gt_u32 vcc, 4, v7
    s_nop 0
    s_cbranch_vccnz C_w2
W_dW2:
    ds_read_b64_tr_b16 v[82:83], v21 offset:40960
    v_mfma_f32_16x16x32_bf16 v[38:41], v[122:125], v[54:57], v[38:41]
    ds_read_b64_tr_b16 v[84:85], v21 offset:43008
    v_mfma_f32_16x16x32_bf16 v[42:45], v[126:129], v[54:57], v[42:45]
    ds_read_b64_tr_b16 v[86:87], v22 offset:40960
    s_waitcnt vmcnt(4)
    v_mfma_f32_16x16x32_bf16 v[30:33], v[130:133], v[58:61], v[30:33]
    buffer_load_dwordx4 v[78:81], v4, s[36:39], s24 offen offset:0 sc1
    v_mfma_f32_16x16x32_bf16 v[34:37], v[134:137], v[58:61], v[34:37]
    ds_read_b64_tr_b16 v[88:89], v22 offset:43008
    v_mfma_f32_16x16x32_bf16 v[38:41], v[138:141], v[58:61], v[38:41]
    ds_read_b64_tr_b16 v[90:91], v23 offset:40960
    v_mfma_f32_16x16x32_bf16 v[42:45], v[142:145], v[58:61], v[42:45]
    ds_read_b64_tr_b16 v[92:93], v23 offset:43008
    s_waitcnt vmcnt(4)
    v_mfma_f32_16x16x32_bf16 v[30:33], v[146:149], v[62:65], v[30:33]
    buffer_load_dwordx4 v[46:49], v4, s[36:39], s24 offen offset:1024 sc1
    v_mfma_f32_16x16x32_bf16 v[34:37], v[150:153], v[62:65], v[34:37]
    ds_read_b64_tr_b16 v[94:95], v24 offset:40960
    v_mfma_f32_16x16x32_bf16 v[38:41], v[154:157], v[62:65], v[38:41]
    ds_read_b64_tr_b16 v[96:97], v24 offset:43008
    v_mfma_f32_16x16x32_bf16 v[42:45], v[158:161], v[62:65], v[42:45]
    ds_read_b64_tr_b16 v[98:99], v21 offset:45056
    s_waitcnt vmcnt(4)
    v_mfma_f32_16x16x32_bf16 v[30:33], v[162:165], v[66:69], v[30:33]
    buffer_load_dwordx4 v[50:53], v4, s[36:39], s25 offen offset:0 sc1
    v_mfma_f32_16x16x32_bf16 v[34:37], v[166:169], v[66:69], v[34:37]
    ds_read_b64_tr_b16 v[100:101], v21 offset:47104
    v_mfma_f32_16x16x32_bf16 v[38:41], v[170:173], v[66:69], v[38:41]
    ds_read_b64_tr_b16 v[102:103], v22 offset:45056
    v_mfma_f32_16x16x32_bf16 v[42:45], v[174:177], v[66:69], v[42:45]
    ds_read_b64_tr_b16 v[104:105], v22 offset:47104
    s_waitcnt vmcnt(4)
    v_mfma_f32_16x16x32_bf16 v[30:33], v[178:181], v[70:73], v[30:33]
    buffer_load_dwordx4 v[54:57], v4, s[36:39], s25 offen offset:1024 sc1
    v_mfma_f32_16x16x32_bf16 v[34:37], v[182:185], v[70:73], v[34:37]
    ds_read_b64_tr_b16 v[106:107], v23 offset:45056
    v_mfma_f32_16x16x32_bf16 v[38:41], v[186:189], v[70:73], v[38:41]
    ds_read_b64_tr_b16 v[108:109], v23 offset:47104
    v_mfma_f32_16x16x32_bf16 v[42:45], v[190:193], v[70:73], v[42:45]
    ds_read_b64_tr_b16 v[110:111], v24 offset:45056
    s_waitcnt vmcnt(4)
    v_mfma_f32_16x16x32_bf16 v[30:33], v[194:197], v[74:77], v[30:33]
    buffer_load_dwordx4 v[58:61], v4, s[36:39], s26 offen offset:0 sc1
    v_mfma_f32_16x16x32_bf16 v[34:37], v[198:201], v[74:77], v[34:37]
    ds_read_b64_tr_b16 v[112:113], v24 offset:47104
    v_mfma_f32_16x16x32_bf16 v[38:41], v[202:205], v[74:77], v[38:41]
    ds_read_b64_tr_b16 v[114:115], v21 offset:49152
    v_mfma_f32_16x16x32_bf16 v[42:45], v[206:209], v[74:77], v[42:45]
    ds_read_b64_tr_b16 v[116:117], v21 offset:51200
    s_waitcnt vmcnt(4)
    s_waitcnt lgkmcnt(15)
    v_mfma_f32_16x16x32_bf16 v[30:33], v[210:213], v[78:81], v[30:33]
    buffer_load_dwordx4 v[62:65], v4, s[36:39], s26 offen offset:1024 sc1
    v_mfma_f32_16x16x32_bf16 v[34:37], v[214:217], v[78:81], v[34:37]
    ds_read_b64_tr_b16 v[118:119], v22 offset:49152
    v_mfma_f32_16x16x32_bf16 v[38:41], v[218:221], v[78:81], v[38:41]
    ds_read_b64_tr_b16 v[120:121], v22 offset:51200
    v_mfma_f32_16x16x32_bf16 v[42:45], v[222:225], v[78:81], v[42:45]
    ds_read_b64_tr_b16 v[122:123], v23 offset:49152
    s_waitcnt vmcnt(4)
    v_mfma_f32_16x16x32_bf16 v[30:33], v[226:229], v[46:49], v[30:33]
    ds_read_b64_tr_b16 v[124:125], v23 offset:51200
    ds_read_b64_tr_b16 v[126:127], v24 offset:49152
    v_mfma_f32_16x16x32_bf16 v[34:37], v[230:233], v[46:49], v[34:37]
    ds_read_b64_tr_b16 v[128:129], v24 offset:51200
    v_mfma_f32_16x16x32_bf16 v[38:41], v[234:237], v[46:49], v[38:41]
    ds_read_b64_tr_b16 v[130:131], v21 offset:53248
    v_mfma_f32_16x16x32_bf16 v[42:45], v[238:241], v[46:49], v[42:45]
    ds_read_b64_tr_b16 v[132:133], v21 offset:55296
    s_waitcnt vmcnt(3)
    v_mfma_f32_16x16x32_bf16 v[30:33], v[82:85], v[50:53], v[30:33]
    ds_read_b64_tr_b16 v[134:135], v22 offset:53248
    ds_read_b64_tr_b16 v[136:137], v22 offset:55296
    s_waitcnt lgkmcnt(15)
    v_mfma_f32_16x16x32_bf16 v[34:37], v[86:89], v[50:53], v[34:37]
    ds_read_b64_tr_b16 v[138:139], v23 offset:53248
    ds_read_b64_tr_b16 v[140:141], v23 offset:55296
    v_mfma_f32_16x16x32_bf16 v[38:41], v[90:93], v[50:53], v[38:41]
    ds_read_b64_tr_b16 v[142:143], v24 offset:53248
    ds_read_b64_tr_b16 v[144:145], v24 offset:55296
    v_mfma_f32_16x16x32_bf16 v[42:45], v[94:97], v[50:53], v[42:45]
    s_waitcnt vmcnt(2)
    v_mfma_f32_16x16x32_bf16 v[30:33], v[98:101], v[54:57], v[30:33]
    v_mfma_f32_16x16x32_bf16 v[34:37], v[102:105], v[54:57], v[34:37]
    s_waitcnt lgkmcnt(15)
    v_mfma_f32_16x16x32_bf16 v[38:41], v[106:109], v[54:57], v[38:41]
    v_mfma_f32_16x16x32_bf16 v[42:45], v[110:113], v[54:57], v[42:45]
    s_waitcnt vmcnt(1)
    s_waitcnt lgkmcnt(14)
    v_mfma_f32_16x16x32_bf16 v[30:33], v[114:117], v[58:61], v[30:33]
    s_waitcnt lgkmcnt(12)
    v_mfma_f32_16x16x32_bf16 v[34:37], v[118:121], v[58:61], v[34:37]
    s_waitcnt lgkmcnt(10)
    v_mfma_f32_16x16x32_bf16 v[38:41], v[122:125], v[58:61], v[38:41]
    s_waitcnt lgkmcnt(8)
    v_mfma_f32_16x16x32_bf16 v[42:45], v[126:129], v[58:61], v[42:45]
    s_waitcnt vmcnt(0)
    s_waitcnt lgkmcnt(6)
    v_mfma_f32_16x16x32_bf16 v[30:33], v[130:133], v[62:65], v[30:33]
    s_waitcnt lgkmcnt(4)
    v_mfma_f32_16x16x32_bf16 v[34:37], v[134:137], v[62:65], v[34:37]
    s_waitcnt lgkmcnt(2)
    v_mfma_f32_16x16x32_bf16 v[38:41], v[138:141], v[62:65], v[38:41]
    s_waitcnt lgkmcnt(0)
    v_mfma_f32_16x16x32_bf16 v[42:45], v[142:145], v[62:65], v[42:45]
    s_nop 1
    v_cvt_pk_bf16_f32 v162, v30, v31
    v_cvt_pk_bf16_f32 v163, v32, v33
    ds_write_b64 v25, v[162:163]
    v_cvt_pk_bf16_f32 v164, v34, v35
    v_cvt_pk_bf16_f32 v165, v36, v37
    ds_write_b64 v26, v[164:165]
    v_cvt_pk_bf16_f32 v166, v38, v39
    v_cvt_pk_bf16_f32 v167, v40, v41
    ds_write_b64 v27, v[166:167]
    v_cvt_pk_bf16_f32 v168, v42, v43
    v_cvt_pk_bf16_f32 v169, v44, v45
    ds_write_b64 v28, v[168:169]
    ds_read_b128 v[178:181], v9
    ds_read_b128 v[182:185], v9 offset:1024
    s_waitcnt lgkmcnt(1)
    buffer_store_dwordx4 v[178:181], v10, s[32:35], s23 offen nt
    s_waitcnt lgkmcnt(0)
    buffer_store_dwordx4 v[182:185], v10, s[32:35], s28 offen nt
    s_add_u32 s40, s7, s62
    s_cmp_lg_u32 s40, 0
    s_cbranch_scc1 C_end
    s_add_u32 s40, s10, 16
    v_mov_b32 v2, s40
    s_lshl_b32 s40, s8, 7
    s_mov_b64 exec, 1
    buffer_store_dword v2, v6, s[36:39], s40 offen
C_end:
    s_endpgm
K_cold:
X_cH:
    s_mov_b32 s9, 0
X_lH:
    v_cmp_ne_u64 vcc, s[28:29], v[18:19]
    s_nop 0
    s_cbranch_vccz X_okH
    v_subrev_u32 v18, s12, v18
    v_cmp_ne_u32 s[42:43], s13, v19
    v_cmp_le_u32 vcc, 8, v18
    s_nop 0
    s_or_b64 vcc, vcc, s[42:43]
    s_cbranch_vccz X_nH
    buffer_load_dwordx2 v[18:19], v20, s[36:39], s30 offen sc1
    s_add_u32 s9, s9, 1
    s_cmp_lt_u32 s9, 200000
    s_waitcnt vmcnt(0)
    s_cbranch_scc1 X_lH
X_nH:
    s_mov_b32 s101, 0
    s_branch X_okH
S_cls0:
    v_cmp_eq_u32 s[42:43], 0, v3
    v_cvt_pk_bf16_f32 v28, v102, 0
    v_cvt_pk_bf16_f32 v36, -v106, 0
    v_cndmask_b32 v103, v103, 0, s[42:43]
    v_cndmask_b32 v107, v107, -1.0, s[42:43]
    v_cvt_pk_bf16_f32 v29, v103, 0
    v_cvt_pk_bf16_f32 v37, -v107, 0
    v_cvt_pk_bf16_f32 v30, v104, 0
    v_cvt_pk_bf16_f32 v38, -v108, 0
    v_cndmask_b32 v105, v105, 0, s[42:43]
    v_cndmask_b32 v109, v109, -1.0, s[42:43]
    v_cvt_pk_bf16_f32 v31, v105, 0
    v_cvt_pk_bf16_f32 v39, -v109, 0
    v_cvt_pk_bf16_f32 v32, v110, 0
    v_cvt_pk_bf16_f32 v40, -v114, 0
    v_cndmask_b32 v111, v111, 0, s[42:43]
    v_cndmask_b32 v115, v115, -1.0, s[42:43]
    v_cvt_pk_bf16_f32 v33, v111, 0
    v_cvt_pk_bf16_f32 v41, -v115, 0
    v_cvt_pk_bf16_f32 v34, v112, 0
    v_cvt_pk_bf16_f32 v42, -v116, 0
    v_cndmask_b32 v113, v113, 0, s[42:43]
    v_cndmask_b32 v117, v117, -1.0, s[42:43]
    v_cvt_pk_bf16_f32 v35, v113, 0
    v_cvt_pk_bf16_f32 v43, -v117, 0
    v_lshl_add_u32 v4, v3, 6, 32
    v_cvt_f32_u32 v96, v4
    v_mul_f32 v96, 0x3a000000, v96
    v_lshlrev_b32 v4, 2, v2
    v_cvt_f32_u32 v4, v4
    v_mul_f32 v97, v96, v4
    v_cos_f32 v118, v96
    s_nop 0
    v_add_f32 v118, v118, v118
    v_fmamk_f32 v102, v96, 0x0, v97
    v_fmamk_f32 v103, v96, 0x3f800000, v97
    v_fmamk_f32 v106, v96, 0x0, v97
    v_fmamk_f32 v107, v96, 0x3f800000, v97
    v_fmamk_f32 v110, v96, 0x41800000, v97
    v_fmamk_f32 v111, v96, 0x41880000, v97
    v_fmamk_f32 v114, v96, 0x41800000, v97
    v_fmamk_f32 v115, v96, 0x41880000, v97
    v_cos_f32 v102, v102
    v_cos_f32 v103, v103
    v_sin_f32 v106, v106
    v_sin_f32 v107, v107
    v_cos_f32 v110, v110
    v_cos_f32 v111, v111
    v_sin_f32 v114, v114
    v_sin_f32 v115, v115
    v_fma_f32 v104, v118, v103, -v102
    v_fma_f32 v108, v118, v107, -v106
    v_fma_f32 v112, v118, v111, -v110
    v_fma_f32 v116, v118, v115, -v114
    v_fma_f32 v105, v118, v104, -v103
    v_fma_f32 v109, v118, v108, -v107
    v_fma_f32 v113, v118, v112, -v111
    v_fma_f32 v117, v118, v116, -v115
    v_cvt_pk_bf16_f32 v44, 0, v102
    v_cvt_pk_bf16_f32 v52, 0, -v106
    v_cvt_pk_bf16_f32 v45, 0, v103
    v_cvt_pk_bf16_f32 v53, 0, -v107
    v_cvt_pk_bf16_f32 v46, 0, v104
    v_cvt_pk_bf16_f32 v54, 0, -v108
    v_cvt_pk_bf16_f32 v47, 0, v105
    v_cvt_pk_bf16_f32 v55, 0, -v109
    v_cvt_pk_bf16_f32 v48, 0, v110
    v_cvt_pk_bf16_f32 v56, 0, -v114
    v_cvt_pk_bf16_f32 v49, 0, v111
    v_cvt_pk_bf16_f32 v57, 0, -v115
    v_cvt_pk_bf16_f32 v50, 0, v112
    v_cvt_pk_bf16_f32 v58, 0, -v116
    v_cvt_pk_bf16_f32 v51, 0, v113
    v_cvt_pk_bf16_f32 v59, 0, -v117
    s_branch S_reg
S_gr:
    s_add_u32 s9, s9, 1
    s_cmp_gt_u32 s9, 200000
    s_cbranch_scc1 S_gk
    buffer_load_dwordx4 v60, s[36:39], s60 offen offset:0 sc1 lds
    buffer_load_dwordx4 v60, s[36:39], s60 offen offset:1024 sc1 lds
    buffer_load_dwordx4 v60, s[36:39], s60 offen offset:2048 sc1 lds
    buffer_load_dwordx4 v60, s[36:39], s60 offen offset:3072 sc1 lds
    s_waitcnt lgkmcnt(0)
    s_branch S_gc
S_y0:
    v_cmp_eq_u32 s[42:43], 0, v3
    v_mfma_f32_16x16x32_bf16 v[28:31], v[120:123], v[200:203], 0
    v_mfma_f32_16x16x32_bf16 v[28:31], v[124:127], v[204:207], v[28:31]
    v_mfma_f32_16x16x32_bf16 v[32:35], v[128:131], v[208:211], 0
    v_mfma_f32_16x16x32_bf16 v[32:35], v[132:135], v[212:215], v[32:35]
    v_mfma_f32_16x16x32_bf16 v[36:39], v[152:155], v[184:187], 0
    v_mfma_f32_16x16x32_bf16 v[36:39], v[156:159], v[188:191], v[36:39]
    v_mfma_f32_16x16x32_bf16 v[40:43], v[160:163], v[192:195], 0
    v_mfma_f32_16x16x32_bf16 v[40:43], v[164:167], v[196:199], v[40:43]
    s_nop 1
    v_cndmask_b32 v224, v224, v28, s[42:43]
    v_cndmask_b32 v225, v225, v29, s[42:43]
    v_cndmask_b32 v226, v226, v30, s[42:43]
    v_cndmask_b32 v227, v227, v31, s[42:43]
    v_cndmask_b32 v228, v228, v32, s[42:43]
    v_cndmask_b32 v229, v229, v33, s[42:43]
    v_cndmask_b32 v230, v230, v34, s[42:43]
    v_cndmask_b32 v231, v231, v35, s[42:43]
    v_cndmask_b32 v240, v240, v36, s[42:43]
    v_cndmask_b32 v241, v241, v37, s[42:43]
    v_cndmask_b32 v242, v242, v38, s[42:43]
    v_cndmask_b32 v243, v243, v39, s[42:43]
    v_cndmask_b32 v244, v244, v40, s[42:43]
    v_cndmask_b32 v245, v245, v41, s[42:43]
    v_cndmask_b32 v246, v246, v42, s[42:43]
    v_cndmask_b32 v247, v247, v43, s[42:43]
    s_branch S_y1
C_mr0:
    s_mov_b32 s9, 0
W_lM0:
    ds_read_b32 v2, v5 offset:4
    s_add_u32 s9, s9, 1
    s_cmp_gt_u32 s9, 1600000
    s_cbranch_scc1 W_dM0
    s_waitcnt lgkmcnt(0)
    v_cmp_gt_u32 vcc, 1, v2
    s_nop 0
    s_cbranch_vccnz W_lM0
W_dM0:
    s_waitcnt lgkmcnt(0)
    v_readfirstlane_b32 s63, v2
    s_nop 0
    s_lshr_b32 s63, s63, 1
    s_branch C_md0
SM_sS0:
    buffer_store_dwordx4 v[98:101], v4, s[36:39], s15 offen sc1
    s_branch SM_jS0
C_vr0:
    s_mov_b32 s9, 0
W_lV0:
    ds_read_b32 v2, v5 offset:32
    s_add_u32 s9, s9, 1
    s_cmp_gt_u32 s9, 1600000
    s_cbranch_scc1 W_dV0
    s_waitcnt lgkmcnt(0)
    v_cmp_gt_u32 vcc, 4, v2
    s_nop 0
    s_cbranch_vccnz W_lV0
W_dV0:
    ds_read_b64_tr_b16 v[170:171], v39 offset:32768
    ds_read_b64_tr_b16 v[172:173], v39 offset:33280
    ds_read_b64_tr_b16 v[174:175], v40 offset:32768
    ds_read_b64_tr_b16 v[176:177], v40 offset:33280
    ds_read_b64_tr_b16 v[202:203], v39 offset:36864
    ds_read_b64_tr_b16 v[204:205], v39 offset:37376
    ds_read_b64_tr_b16 v[206:207], v40 offset:36864
    ds_read_b64_tr_b16 v[208:209], v40 offset:37376
    s_waitcnt lgkmcnt(0)
    s_branch C_vd0
C_mr1:
    s_mov_b32 s9, 0
W_lM1:
    ds_read_b32 v2, v5 offset:4
    s_add_u32 s9, s9, 1
    s_cmp_gt_u32 s9, 1600000
    s_cbranch_scc1 W_dM1
    s_waitcnt lgkmcnt(0)
    v_cmp_gt_u32 vcc, 1, v2
    s_nop 0
    s_cbranch_vccnz W_lM1
W_dM1:
    s_waitcnt lgkmcnt(0)
    v_readfirstlane_b32 s63, v2
    s_nop 0
    s_lshr_b32 s63, s63, 1
    s_branch C_md1
SM_sS1:
    buffer_store_dwordx4 v[98:101], v4, s[36:39], s15 offen sc1
    s_branch SM_jS1
C_vr1:
    s_mov_b32 s9, 0
W_lV1:
    ds_read_b32 v2, v5 offset:32
    s_add_u32 s9, s9, 1
    s_cmp_gt_u32 s9, 1600000
    s_cbranch_scc1 W_dV1
    s_waitcnt lgkmcnt(0)
    v_cmp_gt_u32 vcc, 4, v2
    s_nop 0
    s_cbranch_vccnz W_lV1
W_dV1:
    ds_read_b64_tr_b16 v[170:171], v39 offset:32768
    ds_read_b64_tr_b16 v[172:173], v39 offset:33280
    ds_read_b64_tr_b16 v[174:175], v40 offset:32768
    ds_read_b64_tr_b16 v[176:177], v40 offset:33280
    ds_read_b64_tr_b16 v[202:203], v39 offset:36864
    ds_read_b64_tr_b16 v[204:205], v39 offset:37376
    ds_read_b64_tr_b16 v[206:207], v40 offset:36864
    ds_read_b64_tr_b16 v[208:209], v40 offset:37376
    s_waitcnt lgkmcnt(0)
    s_branch C_vd1
C_pr:
    s_mov_b32 s9, 0
C_pl:
    ds_read_b32 v53, v52 offset:40
    ds_read_b128 v[82:85], v48 offset:12288
    ds_read_b128 v[86:89], v48 offset:13312
    s_add_u32 s9, s9, 1
    s_cmp_gt_u32 s9, 1600000
    s_waitcnt lgkmcnt(0)
    s_cbranch_scc1 C_pd
    v_cmp_eq_u32 vcc, 0, v53
    s_nop 0
    s_cbranch_vccnz C_pl
    s_branch C_pd
SM_sO:
    s_nop 7
    v_cvt_pk_bf16_f32 v58, v66, v67
    v_cvt_pk_bf16_f32 v59, v68, v69
    v_cvt_pk_bf16_f32 v60, v70, v71
    v_cvt_pk_bf16_f32 v61, v72, v73
    buffer_store_dwordx4 v[58:61], v4, s[36:39], s100 offen sc1
    v_cvt_pk_bf16_f32 v62, v74, v75
    v_cvt_pk_bf16_f32 v63, v76, v77
    v_cvt_pk_bf16_f32 v64, v78, v79
    v_cvt_pk_bf16_f32 v65, v80, v81
    buffer_store_dwordx4 v[62:65], v4, s[36:39], s19 offen sc1
    s_branch SM_jO
SM_sF:
    buffer_store_dwordx2 v[14:15], v6, s[36:39], s21 offen sc1
    s_branch SM_jF
C_w2:
    s_mov_b32 s9, 0
W_lW3:
    ds_read_b32 v2, v5 offset:36
    s_add_u32 s9, s9, 1
    s_cmp_gt_u32 s9, 1600000
    s_cbranch_scc1 W_dW3
    s_waitcnt lgkmcnt(0)
    v_cmp_gt_u32 vcc, 4, v2
    s_nop 0
    s_cbranch_vccnz W_lW3
W_dW3:
    s_waitcnt lgkmcnt(0)
    s_branch W_dW2
K_exit:
    s_endpgm
.fill 7168, 4, 0xbf810000
.section .rodata,"a"
.p2align 6
.amdhsa_kernel concat_heads__sliding_local_dilated__spectral_fnet__prompt_kernel
  .amdhsa_next_free_vgpr 256
  .amdhsa_next_free_sgpr 102
  .amdhsa_accum_offset 256
  .amdhsa_group_segment_fixed_size 0
  .amdhsa_kernarg_size 88
  .amdhsa_user_sgpr_count 2
  .amdhsa_user_sgpr_kernarg_segment_ptr 1
  .amdhsa_system_sgpr_workgroup_id_x 1
.end_amdhsa_kernel
```

```asm
; @launch grid=(256,1,1) block=(512,1,1) lds=163840
.amdgcn_target "amdgcn-amd-amdhsa--gfx950"
.text
.p2align 12
.fill 832, 4, 0xbf810000
.globl concat_heads__sliding_local_dilated__spectral_fnet__prompt_kernel
.p2align 8
.type concat_heads__sliding_local_dilated__spectral_fnet__prompt_kernel,@function
concat_heads__sliding_local_dilated__spectral_fnet__prompt_kernel:
    s_load_dwordx2 s[16:17], s[0:1], 0
    s_load_dwordx2 s[20:21], s[0:1], 8
    s_load_dwordx2 s[28:29], s[0:1], 24
    s_load_dwordx2 s[36:37], s[0:1], 80
    s_load_dwordx2 s[24:25], s[0:1], 16
    s_load_dwordx2 s[32:33], s[0:1], 64
    v_lshrrev_b32 v1, 6, v0
    s_cmp_ge_u32 s2, 256
    s_cbranch_scc1 K_exit
    v_readfirstlane_b32 s3, v1
    s_and_b32 s4, s2, 7
    s_lshr_b32 s5, s2, 3
    s_sub_u32 s5, s5, 4
    s_and_b32 s5, s5, 31
    s_cmp_lg_u32 s3, 7
    s_cbranch_scc1 K_nopf
    s_getpc_b64 s[44:45]
    s_mov_b32 s46, 28672
    s_mov_b32 s47, 0x00020000
    s_mul_i32 s40, s5, 896
    v_and_b32 v1, 63, v0
    v_min_u32 v1, 6, v1
    v_lshlrev_b32 v1, 7, v1
    buffer_load_dword v255, v1, s[44:47], s40 offen
K_nopf:
    s_mul_i32 s6, s5, 37
    s_lshr_b32 s6, s6, 8
    s_mul_i32 s40, s6, 7
    s_sub_u32 s7, s5, s40
    s_mov_b32 s38, 0x10000000
    s_mov_b32 s39, 0x00020000
    s_lshl_b32 s8, s4, 2
    s_cmp_lt_u32 s5, 28
    s_cbranch_scc1 K_a
    s_add_u32 s8, s8, s7
    s_mov_b32 s30, 1835008
    s_mov_b32 s31, 0x00020000
    s_lshl_b32 s40, s3, 7
    s_add_u32 s40, s40, s8
    v_and_b32 v4, 32, v0
    v_add_u32 v4, s40, v4
    v_and_b32 v5, 31, v0
    v_lshlrev_b32 v5, 4, v5
    v_mov_b32 v6, 896
    v_mad_u32_u24 v7, v4, v6, v5
    v_add_u32 v5, 384, v5
    v_sub_u32 v8, 960, v4
    v_mad_u32_u24 v8, v8, v6, v5
    v_sub_u32 v9, 2048, v4
    v_and_b32 v9, 2047, v9
    v_mad_u32_u24 v9, v9, v6, v5
    s_lshl_b32 s42, s3, 13
    s_mov_b32 m0, s42
    s_mov_b32 s52, 57344
    s_mov_b32 s53, 917504
    s_mov_b32 s54, 974848
    s_waitcnt lgkmcnt(0)
    s_load_dwordx2 s[10:11], s[36:37], 4096
    s_branch K_spare2
K_a:
    s_add_u32 s8, s8, s6
    s_cmp_ge_u32 s3, 4
    s_cbranch_scc1 K_c
    s_setprio 2
    s_mov_b32 s44, s4
    s_add_u32 s44, s44, s7
    s_mul_i32 s40, s44, 65
    s_lshr_b32 s40, s40, 8
    s_mul_i32 s40, s40, 4
    s_sub_u32 s44, s44, s40
    s_lshl_b32 s44, s44, 2
    s_lshr_b32 s44, 0x6420, s44
    s_and_b32 s44, s44, 7
    s_mov_b32 s18, 1835008
    s_mov_b32 s19, 0x00020000
    s_mov_b32 s22, 1204224
    s_mov_b32 s23, 0x00020000
    v_and_b32 v1, 63, v0
    v_lshrrev_b32 v6, 3, v1
    v_and_b32 v7, 7, v1
    v_lshrrev_b32 v8, 4, v1
    v_xor_b32 v3, v7, v8
    v_mul_u32_u24 v23, 896, v6
    v_lshl_add_u32 v21, v3, 4, v23
    v_xor_b32 v22, 64, v21
    v_add_u32 v22, 6144, v22
    s_and_b32 s43, s3, 1
    s_lshl_b32 s40, s43, 6
    v_xor_b32 v23, s40, v21
    s_lshl_b32 s40, s43, 1
    s_sub_u32 s40, 2, s40
    v_sub_u32 v2, s40, v6
    v_max_i32 v2, 0, v2
    v_mul_u32_u24 v2, 896, v2
    v_add_u32 v23, v23, v2
    v_and_b32 v2, 2, v6
    v_xor_b32 v2, v7, v2
    v_mul_u32_u24 v3, 2688, v6
    v_lshl_add_u32 v24, v2, 4, v3
    v_xor_b32 v25, 64, v24
    v_add_u32 v25, 20480, v25
    v_add_u32 v26, 896, v24
    v_add_u32 v27, 896, v25
    v_add_u32 v28, 1792, v24
    v_add_u32 v29, 1792, v25
    s_mov_b32 s45, s44
    s_lshl_b32 s40, s8, 6
    s_lshl_b32 s41, s3, 4
    s_add_u32 s42, s40, s41
    s_mul_i32 s46, s42, 896
    s_mul_i32 s48, s41, 2688
    s_lshl_b32 s42, s7, 7
    s_add_u32 s48, s48, s42
    s_sub_u32 s40, s40, 16
    s_max_i32 s40, s40, 0
    s_lshl_b32 s41, s43, 3
    s_add_u32 s40, s40, s41
    s_mul_i32 s47, s40, 896
    s_lshl_b32 s50, s3, 11
    s_lshr_b32 s41, s3, 1
    s_mul_i32 s41, s41, 10240
    s_lshl_b32 s49, s43, 10
    s_add_u32 s49, s49, s41
    s_lshl_b32 s40, s44, 7
    s_add_u32 s51, s40, s46
    s_mul_i32 s53, s44, 172032
    s_add_u32 s53, s53, s48
    s_add_u32 m0, s50, 2048
    s_add_u32 s44, s44, 1
    s_cmp_eq_u32 s44, 7
    s_cselect_b32 s44, 0, s44
    s_waitcnt lgkmcnt(0)
    buffer_load_dwordx4 v21, s[16:19], s51 offen lds
    buffer_load_dwordx4 v22, s[16:19], s51 offen offset:1024 lds
    s_lshl_b32 s41, s44, 7
    s_cmp_lt_u32 s3, 2
    s_cselect_b32 s52, s40, s41
    s_add_u32 m0, s49, 0
    s_add_u32 s52, s52, s47
    buffer_load_dwordx4 v23, s[16:19], s52 offen lds
    s_add_u32 m0, s50, 79872
    s_nop 0
    buffer_load_dwordx4 v24, s[20:23], s53 offen lds
    buffer_load_dwordx4 v25, s[20:23], s53 offen offset:1024 lds
    s_add_u32 m0, s50, 88064
    s_nop 0
    buffer_load_dwordx4 v26, s[20:23], s53 offen lds
    buffer_load_dwordx4 v27, s[20:23], s53 offen offset:1024 lds
    s_add_u32 m0, s50, 96256
    s_mul_i32 s53, s45, 172032
    s_add_u32 s53, s53, s48
    s_add_u32 s45, s45, 1
    s_cmp_eq_u32 s45, 7
    s_cselect_b32 s45, 0, s45
    buffer_load_dwordx4 v28, s[20:23], s53 offen lds
    buffer_load_dwordx4 v29, s[20:23], s53 offen offset:1024 lds
    s_lshl_b32 s40, s44, 7
    s_add_u32 s51, s40, s46
    s_mul_i32 s53, s44, 172032
    s_add_u32 s53, s53, s48
    s_add_u32 m0, s50, 12288
    s_add_u32 s44, s44, 1
    s_cmp_eq_u32 s44, 7
    s_cselect_b32 s44, 0, s44
    buffer_load_dwordx4 v21, s[16:19], s51 offen lds
    buffer_load_dwordx4 v22, s[16:19], s51 offen offset:1024 lds
    s_lshl_b32 s56, s8, 7
    s_load_dwordx2 s[10:11], s[36:37], s56
    s_lshl_b32 s30, s8, 10
    s_add_u32 s30, s30, 65536
    s_getreg_b32 s28, hwreg(HW_REG_XCC_ID, 0, 3)
    v_min_u32 v20, 6, v1
    v_lshlrev_b32 v20, 3, v20
    s_mov_b32 s26, 401408
    s_mov_b32 s27, 0x00020000
    s_mov_b32 s34, 3670016
    s_mov_b32 s35, 0x00020000
    s_lshr_b32 s58, s3, 1
    s_and_b32 s59, s3, 1
    v_and_b32 v9, 15, v1
    v_mov_b32 v4, 0
    v_mov_b32 v14, 1
    v_mov_b32 v5, 161792
    v_and_b32 v50, 6, v6
    v_xor_b32 v50, v7, v50
    v_mul_u32_u24 v51, 896, v6
    v_lshl_add_u32 v10, v50, 4, v51
    v_add_u32 v11, 6144, v10
    s_mov_b32 s54, s6
    s_mul_i32 s55, s3, 14336
    s_lshl_b32 s56, s7, 7
    s_add_u32 s55, s55, s56
    s_and_b32 s56, s3, 1
    s_lshl_b32 s57, s7, 1
    s_add_u32 s56, s56, s57
    s_lshl_b32 s15, s56, 10
    s_lshl_b32 s56, s8, 2
    s_and_b32 s57, s3, 2
    s_add_u32 s56, s56, s57
    s_mul_i32 s57, s56, 14336
    s_add_u32 s15, s15, s57
    s_add_u32 s15, s15, 2097152
    s_lshl_b32 s100, s56, 6
    s_add_u32 s100, s100, 16384
    v_lshlrev_b32 v50, 7, v7
    v_and_b32 v51, 1, v6
    v_mul_u32_u24 v51, 14336, v51
    v_add3_u32 v12, v50, v51, s15
    v_mov_b32 v50, s100
    v_cmp_le_u32 vcc, 16, v1
    s_nop 1
    v_cndmask_b32 v12, v12, v50, vcc
    v_and_b32 v50, 1, v9
    v_cmp_eq_u32 s[42:43], 1, v50
    v_lshl_add_u32 v50, v8, 2, v50
    v_cmp_le_u32 s[0:1], v50, v9
    v_add_u32 v50, 2, v50
    v_cmp_le_u32 s[12:13], v50, v9
    v_mov_b32 v50, 0xffff
    v_mov_b32 v51, 0xffff0000
    v_cndmask_b32 v50, v50, v51, s[42:43]
    v_cndmask_b32 v52, v50, 0, s[0:1]
    v_cndmask_b32 v53, v50, 0, s[12:13]
    v_cndmask_b32 v54, 0, v50, s[0:1]
    v_cndmask_b32 v55, 0, v50, s[12:13]
    v_lshlrev_b32 v50, 4, v1
    s_add_u32 s56, s50, 4096
    v_add_u32 v56, s56, v50
    s_xor_b32 s56, s50, 2048
    s_add_u32 s56, s56, 4096
    v_add_u32 v57, s56, v50
    v_add_u32 v59, s50, v50
    v_lshl_add_u32 v58, s58, 3, v5
    v_lshl_add_u32 v60, s3, 2, v5
    s_cmp_eq_u32 s7, 3
    s_cselect_b32 s56, 0, 1.0
    v_mov_b32 v61, s56
    s_mov_b32 s31, 0x3e8b97f6
K_h2:
    s_add_u32 m0, s50, 104448
    s_nop 0
    buffer_load_dwordx4 v24, s[20:23], s53 offen lds
    buffer_load_dwordx4 v25, s[20:23], s53 offen offset:1024 lds
    s_add_u32 m0, s50, 112640
    s_nop 0
    buffer_load_dwordx4 v26, s[20:23], s53 offen lds
    buffer_load_dwordx4 v27, s[20:23], s53 offen offset:1024 lds
    s_add_u32 m0, s50, 120832
    s_mul_i32 s53, s45, 172032
    s_add_u32 s53, s53, s48
    s_add_u32 s45, s45, 1
    s_cmp_eq_u32 s45, 7
    s_cselect_b32 s45, 0, s45
    buffer_load_dwordx4 v28, s[20:23], s53 offen lds
    buffer_load_dwordx4 v29, s[20:23], s53 offen offset:1024 lds
    s_lshl_b32 s40, s44, 7
    s_add_u32 s51, s40, s46
    s_mul_i32 s53, s44, 172032
    s_add_u32 s53, s53, s48
    s_add_u32 m0, s50, 22528
    s_add_u32 s44, s44, 1
    s_cmp_eq_u32 s44, 7
    s_cselect_b32 s44, 0, s44
    buffer_load_dwordx4 v21, s[16:19], s51 offen lds
    buffer_load_dwordx4 v22, s[16:19], s51 offen offset:1024 lds
    s_waitcnt lgkmcnt(0)
    s_add_u32 s12, s10, 0x5a3c9671
    s_xor_b32 s13, s11, 0x2b7e1516
    s_add_u32 s28, s28, s12
    s_mov_b32 s29, s13
    s_waitcnt vmcnt(10)
    s_barrier
    s_lshl_b32 s41, s44, 7
    s_cmp_lt_u32 s3, 2
    s_cselect_b32 s52, s40, s41
    s_add_u32 m0, s49, 20480
    s_add_u32 s52, s52, s47
    buffer_load_dwordx4 v23, s[16:19], s52 offen lds
    s_add_u32 m0, s50, 129024
    s_nop 0
    buffer_load_dwordx4 v24, s[20:23], s53 offen lds
    buffer_load_dwordx4 v25, s[20:23], s53 offen offset:1024 lds
    s_add_u32 m0, s50, 137216
    s_nop 0
    buffer_load_dwordx4 v26, s[20:23], s53 offen lds
    buffer_load_dwordx4 v27, s[20:23], s53 offen offset:1024 lds
    s_add_u32 m0, s50, 145408
    s_mul_i32 s53, s45, 172032
    s_add_u32 s53, s53, s48
    s_add_u32 s45, s45, 1
    s_cmp_eq_u32 s45, 7
    s_cselect_b32 s45, 0, s45
    buffer_load_dwordx4 v28, s[20:23], s53 offen lds
    buffer_load_dwordx4 v29, s[20:23], s53 offen offset:1024 lds
    s_lshl_b32 s40, s44, 7
    s_add_u32 s51, s40, s46
    s_mul_i32 s53, s44, 172032
    s_add_u32 s53, s53, s48
    s_add_u32 m0, s50, 32768
    s_add_u32 s44, s44, 1
    s_cmp_eq_u32 s44, 7
    s_cselect_b32 s44, 0, s44
    buffer_load_dwordx4 v21, s[16:19], s51 offen lds
    buffer_load_dwordx4 v22, s[16:19], s51 offen offset:1024 lds
    s_add_u32 m0, s50, 153600
    s_nop 0
    buffer_load_dwordx4 v24, s[20:23], s53 offen lds
    s_waitcnt vmcnt(12)
    s_barrier
    buffer_load_dwordx4 v25, s[20:23], s53 offen offset:1024 lds
    s_add_u32 m0, s50, 71680
    s_nop 0
    buffer_load_dwordx4 v26, s[20:23], s53 offen lds
    buffer_load_dwordx4 v27, s[20:23], s53 offen offset:1024 lds
    s_add_u32 m0, s50, 79872
    s_mul_i32 s53, s45, 172032
    s_add_u32 s53, s53, s48
    s_add_u32 s45, s45, 1
    s_cmp_eq_u32 s45, 7
    s_cselect_b32 s45, 0, s45
    buffer_load_dwordx4 v28, s[20:23], s53 offen lds
    buffer_load_dwordx4 v29, s[20:23], s53 offen offset:1024 lds
    s_lshl_b32 s40, s44, 7
    s_add_u32 s51, s40, s46
    s_mul_i32 s53, s44, 172032
    s_add_u32 s53, s53, s48
    s_add_u32 m0, s50, 43008
    s_add_u32 s44, s44, 1
    s_cmp_eq_u32 s44, 7
    s_cselect_b32 s44, 0, s44
    buffer_load_dwordx4 v21, s[16:19], s51 offen lds
    buffer_load_dwordx4 v22, s[16:19], s51 offen offset:1024 lds
    s_lshl_b32 s41, s44, 7
    s_cmp_lt_u32 s3, 2
    s_cselect_b32 s52, s40, s41
    s_add_u32 m0, s49, 40960
    s_add_u32 s52, s52, s47
    buffer_load_dwordx4 v23, s[16:19], s52 offen lds
    s_add_u32 m0, s50, 88064
    s_nop 0
    buffer_load_dwordx4 v24, s[20:23], s53 offen lds
    s_waitcnt vmcnt(12)
    s_barrier
    buffer_load_dwordx4 v25, s[20:23], s53 offen offset:1024 lds
    s_add_u32 m0, s50, 96256
    s_nop 0
    buffer_load_dwordx4 v26, s[20:23], s53 offen lds
    buffer_load_dwordx4 v27, s[20:23], s53 offen offset:1024 lds
    s_add_u32 m0, s50, 104448
    s_mul_i32 s53, s45, 172032
    s_add_u32 s53, s53, s48
    s_add_u32 s45, s45, 1
    s_cmp_eq_u32 s45, 7
    s_cselect_b32 s45, 0, s45
    buffer_load_dwordx4 v28, s[20:23], s53 offen lds
    buffer_load_dwordx4 v29, s[20:23], s53 offen offset:1024 lds
    s_lshl_b32 s40, s44, 7
    s_add_u32 s51, s40, s46
    s_mul_i32 s53, s44, 172032
    s_add_u32 s53, s53, s48
    s_add_u32 m0, s50, 53248
    s_add_u32 s44, s44, 1
    s_cmp_eq_u32 s44, 7
    s_cselect_b32 s44, 0, s44
    buffer_load_dwordx4 v21, s[16:19], s51 offen lds
    buffer_load_dwordx4 v22, s[16:19], s51 offen offset:1024 lds
    s_add_u32 m0, s50, 112640
    s_nop 0
    buffer_load_dwordx4 v24, s[20:23], s53 offen lds
    s_waitcnt vmcnt(12)
    s_barrier
    buffer_load_dwordx4 v25, s[20:23], s53 offen offset:1024 lds
    s_add_u32 m0, s50, 120832
    s_nop 0
    buffer_load_dwordx4 v26, s[20:23], s53 offen lds
    buffer_load_dwordx4 v27, s[20:23], s53 offen offset:1024 lds
    s_cmp_lg_u32 s3, 3
    s_cbranch_scc1 H_nx
    buffer_load_dwordx2 v[18:19], v20, s[36:39], s30 offen sc1
H_nx:
    s_lshl_b32 s40, s44, 7
    s_add_u32 s51, s40, s46
    s_mul_i32 s53, s44, 172032
    s_add_u32 s53, s53, s48
    s_add_u32 m0, s50, 63488
    s_add_u32 s44, s44, 1
    s_cmp_eq_u32 s44, 7
    s_cselect_b32 s44, 0, s44
    buffer_load_dwordx4 v21, s[16:19], s51 offen lds
    buffer_load_dwordx4 v22, s[16:19], s51 offen offset:1024 lds
    s_lshl_b32 s41, s44, 7
    s_cmp_lt_u32 s3, 2
    s_cselect_b32 s52, s40, s41
    s_cbranch_scc0 H_nh
    s_add_u32 m0, s49, 61440
    s_add_u32 s52, s52, s47
    buffer_load_dwordx4 v23, s[16:19], s52 offen lds
H_nh:
    s_add_u32 m0, s50, 129024
    s_nop 0
    buffer_load_dwordx4 v24, s[20:23], s53 offen lds
    buffer_load_dwordx4 v25, s[20:23], s53 offen offset:1024 lds
    s_waitcnt vmcnt(10)
    s_barrier
    s_add_u32 m0, s50, 137216
    s_nop 0
    buffer_load_dwordx4 v26, s[20:23], s53 offen lds
    buffer_load_dwordx4 v27, s[20:23], s53 offen offset:1024 lds
    s_add_u32 m0, s50, 145408
    s_mul_i32 s53, s45, 172032
    s_add_u32 s53, s53, s48
    s_add_u32 s45, s45, 1
    s_cmp_eq_u32 s45, 7
    s_cselect_b32 s45, 0, s45
    buffer_load_dwordx4 v28, s[20:23], s53 offen lds
    buffer_load_dwordx4 v29, s[20:23], s53 offen offset:1024 lds
    s_add_u32 m0, s50, 153600
    s_mul_i32 s53, s45, 172032
    s_add_u32 s53, s53, s48
    s_add_u32 s45, s45, 1
    s_cmp_eq_u32 s45, 7
    s_cselect_b32 s45, 0, s45
    buffer_load_dwordx4 v28, s[20:23], s53 offen lds
    s_waitcnt vmcnt(9)
    s_barrier
    buffer_load_dwordx4 v29, s[20:23], s53 offen offset:1024 lds
    s_lshl_b32 s40, s54, 13
    s_add_u32 s40, s40, s50
    s_add_u32 m0, s40, 71680
    s_add_u32 s40, s54, s7
    s_sub_u32 s41, s40, 7
    s_min_u32 s40, s40, s41
    s_mul_i32 s40, s40, 57344
    s_add_u32 s40, s40, s55
    s_add_u32 s54, s54, 1
    s_cmp_eq_u32 s54, 5
    s_cselect_b32 s54, 0, s54
    buffer_load_dwordx4 v10, s[24:27], s40 offen lds
    buffer_load_dwordx4 v11, s[24:27], s40 offen offset:1024 lds
    s_waitcnt vmcnt(8)
    s_barrier
    s_lshl_b32 s40, s54, 13
    s_add_u32 s40, s40, s50
    s_add_u32 m0, s40, 71680
    s_add_u32 s40, s54, s7
    s_sub_u32 s41, s40, 7
    s_min_u32 s40, s40, s41
    s_mul_i32 s40, s40, 57344
    s_add_u32 s40, s40, s55
    s_add_u32 s54, s54, 1
    s_cmp_eq_u32 s54, 5
    s_cselect_b32 s54, 0, s54
    buffer_load_dwordx4 v10, s[24:27], s40 offen lds
    buffer_load_dwordx4 v11, s[24:27], s40 offen offset:1024 lds
    s_waitcnt vmcnt(8)
    s_barrier
    s_cmp_lg_u32 s3, 3
    s_cbranch_scc1 H_nc
    s_mov_b32 s101, 1
    v_cmp_ne_u32 vcc, s28, v18
    v_cmp_ne_u32 s[42:43], s29, v19
    s_nop 0
    s_or_b64 vcc, vcc, s[42:43]
    s_cbranch_vccnz X_cH
X_okH:
    v_add_u32 v2, s101, v14
    ds_write_b32 v5, v2 offset:4
H_nc:
    s_setprio 0
    s_lshl_b32 s40, s54, 13
    s_add_u32 s40, s40, s50
    s_add_u32 m0, s40, 71680
    s_add_u32 s40, s54, s7
    s_sub_u32 s41, s40, 7
    s_min_u32 s40, s40, s41
    s_mul_i32 s40, s40, 57344
    s_add_u32 s40, s40, s55
    s_add_u32 s54, s54, 1
    s_cmp_eq_u32 s54, 5
    s_cselect_b32 s54, 0, s54
    buffer_load_dwordx4 v10, s[24:27], s40 offen lds
    buffer_load_dwordx4 v11, s[24:27], s40 offen offset:1024 lds
    buffer_load_dword v13, v12, s[36:39], 0 offen sc1
    s_lshl_b32 s40, s54, 13
    s_add_u32 s40, s40, s50
    s_add_u32 m0, s40, 71680
    s_add_u32 s40, s54, s7
    s_sub_u32 s41, s40, 7
    s_min_u32 s40, s40, s41
    s_mul_i32 s40, s40, 57344
    s_add_u32 s40, s40, s55
    s_add_u32 s54, s54, 1
    s_cmp_eq_u32 s54, 5
    s_cselect_b32 s54, 0, s54
    buffer_load_dwordx4 v10, s[24:27], s40 offen lds
    buffer_load_dwordx4 v11, s[24:27], s40 offen offset:1024 lds
    s_lshl_b32 s40, s54, 13
    s_add_u32 s40, s40, s50
    s_add_u32 m0, s40, 71680
    s_add_u32 s40, s54, s7
    s_sub_u32 s41, s40, 7
    s_min_u32 s40, s40, s41
    s_mul_i32 s40, s40, 57344
    s_add_u32 s40, s40, s55
    s_add_u32 s54, s54, 1
    s_cmp_eq_u32 s54, 5
    s_cselect_b32 s54, 0, s54
    buffer_load_dwordx4 v10, s[24:27], s40 offen lds
    buffer_load_dwordx4 v11, s[24:27], s40 offen offset:1024 lds
    s_waitcnt vmcnt(11)
    s_mov_b64 exec, 1
    ds_add_u32 v5, v14 offset:32
    s_mov_b64 exec, -1
    s_mov_b32 s9, 0
    s_setprio 0
H_il:
    ds_read_b64 v[62:63], v58 offset:16
    ds_read_b128 v[30:33], v56
    ds_read_b128 v[34:37], v57
    s_add_u32 s9, s9, 1
    s_cmp_gt_u32 s9, 1600000
    s_cbranch_scc1 H_id
    s_waitcnt lgkmcnt(2)
    v_and_b32 v62, v62, v63
    v_cmp_eq_u32 vcc, 0, v62
    s_waitcnt lgkmcnt(0)
    s_cbranch_vccnz H_il
H_id:
    s_waitcnt lgkmcnt(0)
    v_fma_f32 v30, v34, v61, v30
    v_fma_f32 v31, v35, v61, v31
    v_fma_f32 v32, v36, v61, v32
    v_fma_f32 v33, v37, v61, v33
    v_mul_f32 v30, s31, v30
    v_mul_f32 v31, s31, v31
    v_mul_f32 v32, s31, v32
    v_mul_f32 v33, s31, v33
    v_max_f32 v62, v30, v31
    v_max_f32 v63, v32, v33
    v_mov_b32 v64, v62
    v_mov_b32 v65, v63
    s_nop 0
    v_permlane16_swap_b32 v62, v64
    v_permlane16_swap_b32 v63, v65
    v_max_f32 v62, v62, v64
    v_max_f32 v63, v63, v65
    v_mov_b32 v64, v62
    v_mov_b32 v65, v63
    s_nop 0
    v_permlane32_swap_b32 v62, v64
    v_permlane32_swap_b32 v63, v65
    v_max_f32 v62, v62, v64
    v_max_f32 v63, v63, v65
    v_sub_f32 v30, v30, v62
    v_sub_f32 v31, v31, v62
    v_sub_f32 v32, v32, v63
    v_sub_f32 v33, v33, v63
    v_exp_f32 v30, v30
    v_exp_f32 v31, v31
    v_exp_f32 v32, v32
    v_exp_f32 v33, v33
    v_add_f32 v62, v30, v31
    v_add_f32 v63, v32, v33
    v_mov_b32 v64, v62
    v_mov_b32 v65, v63
    s_nop 0
    v_permlane16_swap_b32 v62, v64
    v_permlane16_swap_b32 v63, v65
    v_add_f32 v62, v62, v64
    v_add_f32 v63, v63, v65
    v_mov_b32 v64, v62
    v_mov_b32 v65, v63
    s_nop 0
    v_permlane32_swap_b32 v62, v64
    v_permlane32_swap_b32 v63, v65
    v_add_f32 v62, v62, v64
    v_add_f32 v63, v63, v65
    v_rcp_f32 v62, v62
    v_rcp_f32 v63, v63
    v_mul_f32 v30, v30, v62
    v_mul_f32 v31, v31, v62
    v_mul_f32 v32, v32, v63
    v_mul_f32 v33, v33, v63
    v_cvt_pk_bf16_f32 v30, v30, v30
    v_cvt_pk_bf16_f32 v31, v31, v31
    v_cvt_pk_bf16_f32 v32, v32, v32
    v_cvt_pk_bf16_f32 v33, v33, v33
    v_and_b32 v38, v52, v30
    v_and_b32 v39, v53, v31
    v_and_b32 v40, v54, v30
    v_and_b32 v41, v55, v31
    ds_write_b128 v59, v[38:41] offset:12288
    v_and_b32 v42, v52, v32
    v_and_b32 v43, v53, v33
    v_and_b32 v44, v54, v32
    v_and_b32 v45, v55, v33
    ds_write_b128 v59, v[42:45] offset:13312
    ds_write_b32 v60, v5 offset:40
    s_setprio 0
    s_waitcnt vmcnt(0)
    s_mov_b64 exec, 1
    ds_add_u32 v5, v14 offset:12
    s_mov_b64 exec, -1
    s_mov_b32 s9, 0
W_lR:
    ds_read_b32 v2, v5 offset:80
    s_add_u32 s9, s9, 1
    s_cmp_gt_u32 s9, 1600000
    s_cbranch_scc1 W_dR
    s_waitcnt lgkmcnt(0)
    v_cmp_gt_u32 vcc, 4, v2
    s_nop 0
    s_cbranch_vccnz W_lR
W_dR:
    s_add_u32 m0, s50, 112640
    s_add_u32 s40, s7, 5
    s_sub_u32 s41, s40, 7
    s_min_u32 s40, s40, s41
    s_mul_i32 s40, s40, 57344
    s_add_u32 s40, s40, s55
    buffer_load_dwordx4 v10, s[24:27], s40 offen lds
    buffer_load_dwordx4 v11, s[24:27], s40 offen offset:1024 lds
    s_add_u32 m0, s50, 120832
    s_add_u32 s40, s7, 6
    s_sub_u32 s41, s40, 7
    s_min_u32 s40, s40, s41
    s_mul_i32 s40, s40, 57344
    s_add_u32 s40, s40, s55
    buffer_load_dwordx4 v10, s[24:27], s40 offen lds
    buffer_load_dwordx4 v11, s[24:27], s40 offen offset:1024 lds
    s_waitcnt vmcnt(0)
    s_mov_b64 exec, 1
    ds_add_u32 v5, v14 offset:36
    s_endpgm
K_spare2:
    s_mov_b32 s26, 401408
    s_mov_b32 s27, 0x00020000
    s_mov_b32 s34, 3670016
    s_mov_b32 s35, 0x00020000
    v_and_b32 v6, 15, v0
    v_lshlrev_b32 v6, 4, v6
    v_bfe_u32 v4, v0, 4, 2
    v_lshl_add_u32 v4, v4, 9, s42
    v_add_u32 v10, v4, v6
    v_sub_u32 v11, v4, v6
    v_add_u32 v11, 432, v11
    v_mov_b32 v12, 0
    s_and_b32 s55, s3, 3
    s_lshr_b32 s56, s3, 2
    v_and_b32 v1, 63, v0
    v_lshrrev_b32 v2, 4, v1
    v_and_b32 v3, 15, v1
    s_lshl_b32 s61, s55, 3
    v_lshrrev_b32 v4, 1, v3
    v_and_b32 v4, 4, v4
    v_and_or_b32 v4, v3, 3, v4
    v_add_u32 v4, s61, v4
    v_bfe_u32 v5, v3, 2, 1
    v_cvt_f32_u32 v97, v5
    v_mul_f32 v97, 0x3e800000, v97
    v_lshl_add_u32 v5, v4, 1, v5
    v_cmp_eq_u32 vcc, 1, v5
    s_nop 1
    v_cndmask_b32 v4, v4, 32, vcc
    v_cndmask_b32 v97, v97, 0, vcc
    v_cvt_f32_u32 v96, v4
    v_mul_f32 v96, 0x3c800000, v96
    v_lshlrev_b32 v4, 3, v2
    buffer_load_dwordx4 v7, s[28:31], 0 offen nt lds
    s_add_u32 m0, m0, 1024
    s_nop 0
    buffer_load_dwordx4 v7, s[28:31], s52 offen nt lds
    s_add_u32 m0, m0, 1024
    s_nop 0
    buffer_load_dwordx4 v9, s[28:31], 0 offen nt lds
    s_add_u32 m0, m0, 1024
    s_nop 0
    buffer_load_dwordx4 v8, s[28:31], s53 offen nt lds
    s_add_u32 m0, m0, 1024
    v_cvt_f32_u32 v4, v4
    v_fma_f32 v97, v96, v4, v97
    v_cos_f32 v118, v96
    s_nop 0
    v_add_f32 v118, v118, v118
    v_fmamk_f32 v102, v96, 0x0, v97
    v_fmamk_f32 v103, v96, 0x3f800000, v97
    v_fmamk_f32 v110, v96, 0x42000000, v97
    v_fmamk_f32 v111, v96, 0x42040000, v97
    v_cos_f32 v102, v102
    v_cos_f32 v103, v103
    v_cos_f32 v110, v110
    v_cos_f32 v111, v111
    v_fma_f32 v104, v118, v103, -v102
    v_fma_f32 v112, v118, v111, -v110
    v_fma_f32 v105, v118, v104, -v103
    v_fma_f32 v113, v118, v112, -v111
    v_fma_f32 v106, v118, v105, -v104
    v_fma_f32 v114, v118, v113, -v112
    v_fma_f32 v107, v118, v106, -v105
    v_fma_f32 v115, v118, v114, -v113
    v_fma_f32 v108, v118, v107, -v106
    v_fma_f32 v116, v118, v115, -v114
    v_fma_f32 v109, v118, v108, -v107
    v_fma_f32 v117, v118, v116, -v115
    v_cvt_pk_bf16_f32 v20, v102, v103
    v_cvt_pk_bf16_f32 v21, v104, v105
    v_cvt_pk_bf16_f32 v22, v106, v107
    v_cvt_pk_bf16_f32 v23, v108, v109
    v_cvt_pk_bf16_f32 v24, v110, v111
    v_cvt_pk_bf16_f32 v25, v112, v113
    v_cvt_pk_bf16_f32 v26, v114, v115
    v_cvt_pk_bf16_f32 v27, v116, v117
    v_lshrrev_b32 v4, 4, v0
    v_and_b32 v5, 3, v4
    v_lshlrev_b32 v5, 6, v5
    v_lshlrev_b32 v13, 1, v6
    v_xor_b32 v13, v13, v5
    v_bfe_u32 v5, v4, 3, 1
    v_lshl_add_u32 v13, v5, 4, v13
    v_lshl_add_u32 v13, v4, 9, v13
    v_add_u32 v13, 65536, v13
    v_xor_b32 v14, 16, v13
    v_lshrrev_b32 v4, 2, v3
    v_lshl_add_u32 v5, v2, 3, v4
    v_lshlrev_b32 v5, 9, v5
    v_lshl_add_u32 v5, v4, 6, v5
    v_and_b32 v4, 1, v1
    v_lshl_add_u32 v5, v4, 5, v5
    v_bfe_u32 v4, v1, 1, 1
    v_lshl_add_u32 v5, v4, 3, v5
    v_and_b32 v4, 1, v2
    v_xor_b32 v4, s56, v4
    v_lshl_add_u32 v16, v4, 4, v5
    v_add_u32 v16, 65536, v16
    v_xor_b32 v17, 64, v16
    v_xor_b32 v18, 128, v16
    v_xor_b32 v19, 192, v16
    v_and_b32 v15, 32, v1
    v_lshrrev_b32 v4, 2, v3
    v_add_lshl_u32 v15, v15, v4, 12
    v_and_b32 v4, 16, v1
    v_lshl_add_u32 v15, v4, 2, v15
    v_and_b32 v4, 3, v3
    v_lshl_add_u32 v15, v4, 4, v15
    v_and_b32 v4, 7, v3
    v_lshlrev_b32 v86, 16, v4
    v_mov_b32 v5, 0xffff0000
    v_add_u32 v87, s56, v3
    v_cmp_eq_u32 vcc, 0, v87
    s_nop 1
    v_cndmask_b32 v87, v5, 0, vcc
    v_add_u32 v4, 256, v11
    v_cmp_eq_u32 vcc, 15, v3
    s_nop 1
    v_cndmask_b32 v11, v11, v4, vcc
    s_lshl_b32 s50, s8, 3
    s_add_u32 s50, s50, s3
    s_mul_i32 s50, s50, 1568
    s_and_b32 s50, s50, 0xffffff80
    v_min_u32 v95, 12, v1
    v_lshlrev_b32 v95, 7, v95
    s_lshl_b32 s59, s55, 18
    s_lshl_b32 s61, s56, 14
    s_add_u32 s59, s59, s61
    s_lshl_b32 s61, s8, 7
    s_add_u32 s59, s59, s61
    s_add_u32 s59, s59, 1048576
    v_lshlrev_b32 v63, 4, v1
    v_and_b32 v4, 32, v1
    v_xor_b32 v60, v63, v4
    s_lshl_b32 s60, s8, 3
    s_add_u32 s60, s60, s3
    s_lshl_b32 s60, s60, 12
    s_add_u32 s60, s60, 1048576
    s_add_u32 s63, s8, 1024
    s_cmp_eq_u32 s8, 0
    s_cselect_b32 s63, 32, s63
    v_lshl_add_u32 v4, v3, 6, s8
    v_cvt_f32_u32 v96, v4
    v_mul_f32 v96, 0x3a000000, v96
    v_lshlrev_b32 v4, 2, v2
    v_cvt_f32_u32 v4, v4
    v_mul_f32 v97, v96, v4
    v_cos_f32 v118, v96
    s_nop 0
    v_add_f32 v118, v118, v118
    v_fmamk_f32 v102, v96, 0x0, v97
    v_fmamk_f32 v103, v96, 0x3f800000, v97
    v_fmamk_f32 v106, v96, 0x0, v97
    v_fmamk_f32 v107, v96, 0x3f800000, v97
    v_fmamk_f32 v110, v96, 0x41800000, v97
    v_fmamk_f32 v111, v96, 0x41880000, v97
    v_fmamk_f32 v114, v96, 0x41800000, v97
    v_fmamk_f32 v115, v96, 0x41880000, v97
    v_cos_f32 v102, v102
    v_cos_f32 v103, v103
    v_sin_f32 v106, v106
    v_sin_f32 v107, v107
    v_cos_f32 v110, v110
    v_cos_f32 v111, v111
    v_sin_f32 v114, v114
    v_sin_f32 v115, v115
    v_fma_f32 v104, v118, v103, -v102
    v_fma_f32 v108, v118, v107, -v106
    v_fma_f32 v112, v118, v111, -v110
    v_fma_f32 v116, v118, v115, -v114
    v_fma_f32 v105, v118, v104, -v103
    v_fma_f32 v109, v118, v108, -v107
    v_fma_f32 v113, v118, v112, -v111
    v_fma_f32 v117, v118, v116, -v115
    s_cmp_eq_u32 s8, 0
    s_cbranch_scc1 S_cls0
    v_cvt_pk_bf16_f32 v28, v102, v106
    v_cvt_pk_bf16_f32 v36, -v106, v102
    v_mov_b32 v44, v28
    v_mov_b32 v52, v36
    v_cvt_pk_bf16_f32 v29, v103, v107
    v_cvt_pk_bf16_f32 v37, -v107, v103
    v_xor_b32 v45, 0x80008000, v29
    v_xor_b32 v53, 0x80008000, v37
    v_cvt_pk_bf16_f32 v30, v104, v108
    v_cvt_pk_bf16_f32 v38, -v108, v104
    v_mov_b32 v46, v30
    v_mov_b32 v54, v38
    v_cvt_pk_bf16_f32 v31, v105, v109
    v_cvt_pk_bf16_f32 v39, -v109, v105
    v_xor_b32 v47, 0x80008000, v31
    v_xor_b32 v55, 0x80008000, v39
    v_cvt_pk_bf16_f32 v32, v110, v114
    v_cvt_pk_bf16_f32 v40, -v114, v110
    v_mov_b32 v48, v32
    v_mov_b32 v56, v40
    v_cvt_pk_bf16_f32 v33, v111, v115
    v_cvt_pk_bf16_f32 v41, -v115, v111
    v_xor_b32 v49, 0x80008000, v33
    v_xor_b32 v57, 0x80008000, v41
    v_cvt_pk_bf16_f32 v34, v112, v116
    v_cvt_pk_bf16_f32 v42, -v116, v112
    v_mov_b32 v50, v34
    v_mov_b32 v58, v42
    v_cvt_pk_bf16_f32 v35, v113, v117
    v_cvt_pk_bf16_f32 v43, -v117, v113
    v_xor_b32 v51, 0x80008000, v35
    v_xor_b32 v59, 0x80008000, v43
S_reg:
    s_lshl_b32 s61, s55, 14
    s_add_u32 s61, s61, 98304
    v_add_u32 v67, s61, v63
    v_cmp_eq_u32 s[42:43], 0, v2
    s_nop 1
    v_cndmask_b32 v98, 1.0, 0.5, s[42:43]
    v_and_b32 v4, 1, v2
    v_mov_b32 v5, 0xffff
    v_cmp_eq_u32 s[42:43], 1, v4
    s_nop 1
    v_cndmask_b32 v101, -1, v5, s[42:43]
    v_cndmask_b32 v96, 1.0, 0, s[42:43]
    v_cmp_eq_u32 s[42:43], 1, v2
    s_nop 1
    v_cndmask_b32 v97, v96, 0.5, s[42:43]
    s_cmp_eq_u32 s56, 0
    s_cselect_b64 s[42:43], -1, 0
    v_cndmask_b32 v99, v96, v97, s[42:43]
    v_cndmask_b32 v100, v97, v96, s[42:43]
    v_lshlrev_b32 v4, 6, v4
    v_and_b32 v5, 2, v2
    v_add_u32 v4, v4, v5
    v_cvt_f32_u32 v97, v4
    s_lshl_b32 s61, s55, 5
    s_add_u32 s61, s61, s56
    v_lshl_add_u32 v4, v3, 1, s61
    buffer_load_dwordx4 v7, s[28:31], s53 offen nt lds
    s_add_u32 m0, m0, 1024
    s_nop 0
    buffer_load_dwordx4 v7, s[28:31], s54 offen nt lds
    s_add_u32 m0, m0, 1024
    s_nop 0
    buffer_load_dwordx4 v8, s[28:31], s52 offen nt lds
    s_add_u32 m0, m0, 1024
    s_nop 0
    buffer_load_dwordx4 v8, s[28:31], 0 offen nt lds
    s_add_u32 m0, m0, 1024
    v_cvt_f32_u32 v96, v4
    v_mul_f32 v96, 0x3b124925, v96
    v_mul_f32 v97, v96, v97
    s_lshl_b32 s61, s56, 13
    v_add_u32 v5, s61, v67
    v_mul_f32 v118, 0x40800000, v96
    v_cos_f32 v118, v118
    s_nop 0
    v_add_f32 v118, v118, v118
    v_fmamk_f32 v102, v96, 0x0, v97
    v_fmamk_f32 v103, v96, 0x40800000, v97
    v_cos_f32 v102, v102
    v_cos_f32 v103, v103
    s_nop 0
    v_fma_f32 v104, v118, v103, -v102
    v_fma_f32 v105, v118, v104, -v103
    v_fma_f32 v106, v118, v105, -v104
    v_fma_f32 v107, v118, v106, -v105
    v_fma_f32 v108, v118, v107, -v106
    v_fma_f32 v109, v118, v108, -v107
    v_fma_f32 v110, v118, v109, -v108
    v_fma_f32 v111, v118, v110, -v109
    s_waitcnt lgkmcnt(0)
    s_add_u32 s12, s10, 0x5a3c9671
    s_xor_b32 s13, s11, 0x2b7e1516
    s_lshl_b32 s51, s12, 12
    s_xor_b32 s51, s51, s13
    s_and_b32 s51, s51, 0xbfff0000
    v_xor_b32 v86, s51, v86
    v_mov_b32 v92, s12
    v_mov_b32 v93, s13
    s_waitcnt vmcnt(4)
    ds_read_b128 v[120:123], v10 offset:0
    ds_read_b128 v[124:127], v11 offset:2112
    ds_read_b128 v[132:135], v10 offset:2112
    ds_read_b128 v[128:131], v11 offset:0
    s_waitcnt lgkmcnt(2)
    v_mov_b32 v136, v120
    v_lshlrev_b32 v140, 16, v121
    v_lshlrev_b32 v154, 16, v127
    v_and_b32 v141, 0xffff0000, v121
    v_and_b32 v155, 0xffff0000, v126
    v_pk_add_f32 v[140:141], v[140:141], v[154:155]
    v_mov_b32_dpp v136, v124 row_shr:1 row_mask:0xf bank_mask:0xf
    v_lshlrev_b32 v142, 16, v122
    v_lshlrev_b32 v154, 16, v126
    v_and_b32 v143, 0xffff0000, v122
    v_and_b32 v155, 0xffff0000, v125
    v_pk_add_f32 v[142:143], v[142:143], v[154:155]
    v_lshlrev_b32 v144, 16, v123
    v_lshlrev_b32 v154, 16, v125
    v_and_b32 v145, 0xffff0000, v123
    v_and_b32 v155, 0xffff0000, v124
    v_pk_add_f32 v[144:145], v[144:145], v[154:155]
    v_lshlrev_b32 v138, 16, v120
    v_lshlrev_b32 v154, 16, v136
    v_and_b32 v139, 0xffff0000, v120
    v_and_b32 v155, 0xffff0000, v127
    v_pk_add_f32 v[138:139], v[138:139], v[154:155]
    s_waitcnt lgkmcnt(0)
    v_lshlrev_b32 v148, 16, v133
    v_lshlrev_b32 v154, 16, v131
    v_and_b32 v149, 0xffff0000, v133
    v_and_b32 v155, 0xffff0000, v130
    v_pk_add_f32 v[148:149], v[148:149], v[154:155]
    v_mov_b32_dpp v137, v128 row_ror:1 row_mask:0xf bank_mask:0xf
    v_lshlrev_b32 v150, 16, v134
    v_lshlrev_b32 v154, 16, v130
    v_and_b32 v151, 0xffff0000, v134
    v_and_b32 v155, 0xffff0000, v129
    v_pk_add_f32 v[150:151], v[150:151], v[154:155]
    v_lshlrev_b32 v152, 16, v135
    v_lshlrev_b32 v154, 16, v129
    v_and_b32 v153, 0xffff0000, v135
    v_and_b32 v155, 0xffff0000, v128
    v_pk_add_f32 v[152:153], v[152:153], v[154:155]
    v_lshlrev_b32 v146, 16, v132
    v_lshlrev_b32 v154, 16, v137
    v_and_b32 v147, 0xffff0000, v132
    v_and_b32 v155, 0xffff0000, v131
    v_pk_add_f32 v[146:147], v[146:147], v[154:155]
    v_pk_add_f32 v[164:165], v[138:139], v[146:147]
    v_pk_add_f32 v[166:167], v[140:141], v[148:149]
    v_pk_add_f32 v[168:169], v[142:143], v[150:151]
    v_pk_add_f32 v[170:171], v[144:145], v[152:153]
    v_cvt_pk_bf16_f32 v156, v164, v166
    v_cvt_pk_bf16_f32 v157, v168, v170
    v_cvt_pk_bf16_f32 v158, v165, v167
    v_cvt_pk_bf16_f32 v159, v169, v171
    ds_write_b128 v13, v[156:159] offset:0
    v_pk_add_f32 v[164:165], v[138:139], v[146:147] neg_lo:[0,1] neg_hi:[0,1]
    v_pk_add_f32 v[166:167], v[140:141], v[148:149] neg_lo:[0,1] neg_hi:[0,1]
    v_pk_add_f32 v[168:169], v[142:143], v[150:151] neg_lo:[0,1] neg_hi:[0,1]
    v_pk_add_f32 v[170:171], v[144:145], v[152:153] neg_lo:[0,1] neg_hi:[0,1]
    v_cvt_pk_bf16_f32 v160, v164, v166
    v_cvt_pk_bf16_f32 v161, v168, v170
    v_cvt_pk_bf16_f32 v162, v165, v167
    v_cvt_pk_bf16_f32 v163, v169, v171
    ds_write_b128 v14, v[160:163] offset:0
    s_waitcnt lgkmcnt(0)
    s_barrier
    ds_read_b64_tr_b16 v[172:173], v16 offset:0
    ds_read_b64_tr_b16 v[174:175], v16 offset:2048
    ds_read_b64_tr_b16 v[176:177], v17 offset:0
    ds_read_b64_tr_b16 v[178:179], v17 offset:2048
    ds_read_b64_tr_b16 v[180:181], v18 offset:0
    ds_read_b64_tr_b16 v[182:183], v18 offset:2048
    ds_read_b64_tr_b16 v[184:185], v19 offset:0
    ds_read_b64_tr_b16 v[186:187], v19 offset:2048
    s_waitcnt lgkmcnt(6)
    v_mfma_f32_16x16x32_bf16 v[188:191], v[20:23], v[172:175], 0
    ds_read_b64_tr_b16 v[172:173], v16 offset:256
    ds_read_b64_tr_b16 v[174:175], v16 offset:2304
    s_waitcnt lgkmcnt(6)
    v_mfma_f32_16x16x32_bf16 v[192:195], v[20:23], v[176:179], 0
    ds_read_b64_tr_b16 v[176:177], v17 offset:256
    ds_read_b64_tr_b16 v[178:179], v17 offset:2304
    s_waitcnt lgkmcnt(6)
    v_mfma_f32_16x16x32_bf16 v[196:199], v[20:23], v[180:183], 0
    ds_read_b64_tr_b16 v[180:181], v18 offset:256
    ds_read_b64_tr_b16 v[182:183], v18 offset:2304
    s_waitcnt lgkmcnt(6)
    v_mfma_f32_16x16x32_bf16 v[200:203], v[20:23], v[184:187], 0
    ds_read_b64_tr_b16 v[184:185], v19 offset:256
    ds_read_b64_tr_b16 v[186:187], v19 offset:2304
    s_waitcnt lgkmcnt(6)
    v_mfma_f32_16x16x32_bf16 v[204:207], v[20:23], v[172:175], 0
    s_waitcnt lgkmcnt(4)
    v_mfma_f32_16x16x32_bf16 v[208:211], v[20:23], v[176:179], 0
    s_waitcnt lgkmcnt(2)
    v_mfma_f32_16x16x32_bf16 v[212:215], v[20:23], v[180:183], 0
    s_waitcnt lgkmcnt(0)
    v_mfma_f32_16x16x32_bf16 v[216:219], v[20:23], v[184:187], 0
    s_waitcnt vmcnt(0)
    buffer_load_dword v255, v95, s[24:27], s50 offen
    ds_read_b128 v[120:123], v10 offset:4096
    ds_read_b128 v[124:127], v11 offset:6208
    ds_read_b128 v[132:135], v10 offset:6208
    ds_read_b128 v[128:131], v11 offset:4096
    s_waitcnt lgkmcnt(2)
    v_mov_b32 v136, v120
    v_lshlrev_b32 v140, 16, v121
    v_lshlrev_b32 v154, 16, v127
    v_and_b32 v141, 0xffff0000, v121
    v_and_b32 v155, 0xffff0000, v126
    v_pk_add_f32 v[140:141], v[140:141], v[154:155]
    v_mov_b32_dpp v136, v124 row_shr:1 row_mask:0xf bank_mask:0xf
    v_lshlrev_b32 v142, 16, v122
    v_lshlrev_b32 v154, 16, v126
    v_and_b32 v143, 0xffff0000, v122
    v_and_b32 v155, 0xffff0000, v125
    v_pk_add_f32 v[142:143], v[142:143], v[154:155]
    v_lshlrev_b32 v144, 16, v123
    v_lshlrev_b32 v154, 16, v125
    v_and_b32 v145, 0xffff0000, v123
    v_and_b32 v155, 0xffff0000, v124
    v_pk_add_f32 v[144:145], v[144:145], v[154:155]
    v_lshlrev_b32 v138, 16, v120
    v_lshlrev_b32 v154, 16, v136
    v_and_b32 v139, 0xffff0000, v120
    v_and_b32 v155, 0xffff0000, v127
    v_pk_add_f32 v[138:139], v[138:139], v[154:155]
    s_waitcnt lgkmcnt(0)
    v_lshlrev_b32 v148, 16, v133
    v_lshlrev_b32 v154, 16, v131
    v_and_b32 v149, 0xffff0000, v133
    v_and_b32 v155, 0xffff0000, v130
    v_pk_add_f32 v[148:149], v[148:149], v[154:155]
    v_mov_b32_dpp v137, v128 row_ror:1 row_mask:0xf bank_mask:0xf
    v_lshlrev_b32 v150, 16, v134
    v_lshlrev_b32 v154, 16, v130
    v_and_b32 v151, 0xffff0000, v134
    v_and_b32 v155, 0xffff0000, v129
    v_pk_add_f32 v[150:151], v[150:151], v[154:155]
    v_lshlrev_b32 v152, 16, v135
    v_lshlrev_b32 v154, 16, v129
    v_and_b32 v153, 0xffff0000, v135
    v_and_b32 v155, 0xffff0000, v128
    v_pk_add_f32 v[152:153], v[152:153], v[154:155]
    v_lshlrev_b32 v146, 16, v132
    v_lshlrev_b32 v154, 16, v137
    v_and_b32 v147, 0xffff0000, v132
    v_and_b32 v155, 0xffff0000, v131
    v_pk_add_f32 v[146:147], v[146:147], v[154:155]
    v_pk_add_f32 v[164:165], v[138:139], v[146:147]
    v_pk_add_f32 v[166:167], v[140:141], v[148:149]
    v_pk_add_f32 v[168:169], v[142:143], v[150:151]
    v_pk_add_f32 v[170:171], v[144:145], v[152:153]
    v_cvt_pk_bf16_f32 v156, v164, v166
    v_cvt_pk_bf16_f32 v157, v168, v170
    v_cvt_pk_bf16_f32 v158, v165, v167
    v_cvt_pk_bf16_f32 v159, v169, v171
    ds_write_b128 v13, v[156:159] offset:16384
    v_pk_add_f32 v[164:165], v[138:139], v[146:147] neg_lo:[0,1] neg_hi:[0,1]
    v_pk_add_f32 v[166:167], v[140:141], v[148:149] neg_lo:[0,1] neg_hi:[0,1]
    v_pk_add_f32 v[168:169], v[142:143], v[150:151] neg_lo:[0,1] neg_hi:[0,1]
    v_pk_add_f32 v[170:171], v[144:145], v[152:153] neg_lo:[0,1] neg_hi:[0,1]
    v_cvt_pk_bf16_f32 v160, v164, v166
    v_cvt_pk_bf16_f32 v161, v168, v170
    v_cvt_pk_bf16_f32 v162, v165, v167
    v_cvt_pk_bf16_f32 v163, v169, v171
    ds_write_b128 v14, v[160:163] offset:16384
    s_cmp_lg_u32 s3, 0
    s_cbranch_scc1 S_nw
    s_lshl_b32 s40, s8, 7
    s_add_u32 s40, s40, 32768
    buffer_load_dword v255, v12, s[36:39], s40 offen
S_nw:
    s_waitcnt lgkmcnt(0)
    s_barrier
    ds_read_b64_tr_b16 v[172:173], v16 offset:16384
    ds_read_b64_tr_b16 v[174:175], v16 offset:18432
    ds_read_b64_tr_b16 v[176:177], v17 offset:16384
    ds_read_b64_tr_b16 v[178:179], v17 offset:18432
    ds_read_b64_tr_b16 v[180:181], v18 offset:16384
    ds_read_b64_tr_b16 v[182:183], v18 offset:18432
    ds_read_b64_tr_b16 v[184:185], v19 offset:16384
    ds_read_b64_tr_b16 v[186:187], v19 offset:18432
    s_waitcnt lgkmcnt(6)
    v_mfma_f32_16x16x32_bf16 v[188:191], v[24:27], v[172:175], v[188:191]
    ds_read_b64_tr_b16 v[172:173], v16 offset:16640
    ds_read_b64_tr_b16 v[174:175], v16 offset:18688
    s_waitcnt lgkmcnt(6)
    v_mfma_f32_16x16x32_bf16 v[192:195], v[24:27], v[176:179], v[192:195]
    ds_read_b64_tr_b16 v[176:177], v17 offset:16640
    ds_read_b64_tr_b16 v[178:179], v17 offset:18688
    s_waitcnt lgkmcnt(6)
    v_mfma_f32_16x16x32_bf16 v[196:199], v[24:27], v[180:183], v[196:199]
    ds_read_b64_tr_b16 v[180:181], v18 offset:16640
    ds_read_b64_tr_b16 v[182:183], v18 offset:18688
    s_waitcnt lgkmcnt(6)
    v_mfma_f32_16x16x32_bf16 v[200:203], v[24:27], v[184:187], v[200:203]
    ds_read_b64_tr_b16 v[184:185], v19 offset:16640
    ds_read_b64_tr_b16 v[186:187], v19 offset:18688
    s_waitcnt lgkmcnt(6)
    v_mfma_f32_16x16x32_bf16 v[204:207], v[24:27], v[172:175], v[204:207]
    s_waitcnt lgkmcnt(4)
    v_mfma_f32_16x16x32_bf16 v[208:211], v[24:27], v[176:179], v[208:211]
    s_waitcnt lgkmcnt(2)
    v_mfma_f32_16x16x32_bf16 v[212:215], v[24:27], v[180:183], v[212:215]
    s_waitcnt lgkmcnt(0)
    v_mfma_f32_16x16x32_bf16 v[216:219], v[24:27], v[184:187], v[216:219]
    v_cvt_pk_bf16_f32 v120, v188, v192
    v_cvt_pk_bf16_f32 v121, v196, v200
    s_nop 1
    v_cvt_pk_bf16_f32 v122, v204, v208
    s_nop 2
    v_cvt_pk_bf16_f32 v123, v212, v216
    v_bfi_b32 v123, v87, v86, v123
    s_add_u32 s41, s59, 0
    buffer_store_dwordx4 v[120:123], v15, s[36:39], s41 offen sc1
    v_cvt_pk_bf16_f32 v124, v189, v193
    v_cvt_pk_bf16_f32 v125, v197, v201
    v_cvt_pk_bf16_f32 v126, v205, v209
    v_cvt_pk_bf16_f32 v127, v213, v217
    v_bfi_b32 v127, v87, v86, v127
    s_add_u32 s41, s59, 32768
    buffer_store_dwordx4 v[124:127], v15, s[36:39], s41 offen sc1
    v_cvt_pk_bf16_f32 v128, v190, v194
    v_cvt_pk_bf16_f32 v129, v198, v202
    v_cvt_pk_bf16_f32 v130, v206, v210
    v_cvt_pk_bf16_f32 v131, v214, v218
    v_bfi_b32 v131, v87, v86, v131
    s_add_u32 s41, s59, 65536
    buffer_store_dwordx4 v[128:131], v15, s[36:39], s41 offen sc1
    v_cvt_pk_bf16_f32 v132, v191, v195
    v_cvt_pk_bf16_f32 v133, v199, v203
    v_cvt_pk_bf16_f32 v134, v207, v211
    v_cvt_pk_bf16_f32 v135, v215, v219
    v_bfi_b32 v135, v87, v86, v135
    s_add_u32 s41, s59, 98304
    buffer_store_dwordx4 v[132:135], v15, s[36:39], s41 offen sc1
    s_cmp_lg_u32 s3, 0
    s_cbranch_scc1 S_nh
    s_lshl_b32 s40, s8, 7
    s_add_u32 s40, s40, 32768
    s_mov_b64 exec, 1
    buffer_store_dwordx2 v[92:93], v12, s[36:39], s40 offen sc1
    s_mov_b64 exec, -1
S_nh:
    s_barrier
    s_cmp_lg_u32 s3, 0
    s_cbranch_scc1 S_nf
    v_lshlrev_b32 v94, 2, v3
    v_add_u32 v94, 81920, v94
    ds_write_b32 v94, v12
S_nf:
    s_lshl_b32 s40, s7, 3
    s_add_u32 s40, s40, s3
    s_mul_i32 s40, s40, 28
    v_min_u32 v24, 27, v1
    v_add_u32 v24, s40, v24
    v_and_b32 v25, 0xffffff80, v24
    v_lshrrev_b32 v26, 1, v25
    v_sub_u32 v24, v24, v26
    v_add_u32 v26, -128, v24
    v_add_u32 v24, 320, v24
    v_min_u32 v24, v24, v26
    v_mul_u32_u24 v24, 896, v24
    v_add_u32 v24, v24, v25
    buffer_load_dword v255, v24, s[24:27], 0 offen
    v_fma_f32 v112, v118, v111, -v110
    v_fma_f32 v113, v118, v112, -v111
    v_fma_f32 v114, v118, v113, -v112
    v_fma_f32 v115, v118, v114, -v113
    v_fma_f32 v116, v118, v115, -v114
    v_fma_f32 v117, v118, v116, -v115
    v_mul_f32 v102, v102, v98
    v_mul_f32 v114, v114, v99
    v_cvt_pk_bf16_f32 v76, v102, v106
    v_cvt_pk_bf16_f32 v77, v110, v114
    v_cvt_pk_bf16_f32 v78, v103, v107
    v_cvt_pk_bf16_f32 v79, v111, v115
    v_and_b32 v79, v101, v79
    ds_write_b128 v5, v[76:79] offset:0
    v_cvt_pk_bf16_f32 v80, v104, v108
    v_cvt_pk_bf16_f32 v81, v112, v116
    v_cvt_pk_bf16_f32 v82, v105, v109
    v_cvt_pk_bf16_f32 v83, v113, v117
    v_and_b32 v81, v101, v81
    v_and_b32 v83, v101, v83
    ds_write_b128 v5, v[80:83] offset:1024
    v_fmamk_f32 v102, v96, 0x0, v97
    v_fmamk_f32 v103, v96, 0x40800000, v97
    v_sin_f32 v102, v102
    v_sin_f32 v103, v103
    s_nop 0
    v_fma_f32 v104, v118, v103, -v102
    v_fma_f32 v105, v118, v104, -v103
    v_fma_f32 v106, v118, v105, -v104
    v_fma_f32 v107, v118, v106, -v105
    v_fma_f32 v108, v118, v107, -v106
    v_fma_f32 v109, v118, v108, -v107
    v_fma_f32 v110, v118, v109, -v108
    v_fma_f32 v111, v118, v110, -v109
    v_fma_f32 v112, v118, v111, -v110
    v_fma_f32 v113, v118, v112, -v111
    v_fma_f32 v114, v118, v113, -v112
    v_fma_f32 v115, v118, v114, -v113
    v_fma_f32 v116, v118, v115, -v114
    v_fma_f32 v117, v118, v116, -v115
    v_mul_f32 v114, v114, v100
    v_cvt_pk_bf16_f32 v76, v102, v106
    v_cvt_pk_bf16_f32 v77, v110, v114
    v_cvt_pk_bf16_f32 v78, v103, v107
    v_cvt_pk_bf16_f32 v79, v111, v115
    v_and_b32 v79, v101, v79
    ds_write_b128 v5, v[76:79] offset:4096
    v_cvt_pk_bf16_f32 v80, v104, v108
    v_cvt_pk_bf16_f32 v81, v112, v116
    v_cvt_pk_bf16_f32 v82, v105, v109
    v_cvt_pk_bf16_f32 v83, v113, v117
    v_and_b32 v81, v101, v81
    v_and_b32 v83, v101, v83
    ds_write_b128 v5, v[80:83] offset:5120
    v_fmamk_f32 v102, v96, 0x3f800000, v97
    v_fmamk_f32 v103, v96, 0x40a00000, v97
    v_cos_f32 v102, v102
    v_cos_f32 v103, v103
    s_nop 0
    v_fma_f32 v104, v118, v103, -v102
    v_fma_f32 v105, v118, v104, -v103
    v_fma_f32 v106, v118, v105, -v104
    v_fma_f32 v107, v118, v106, -v105
    v_fma_f32 v108, v118, v107, -v106
    v_fma_f32 v109, v118, v108, -v107
    v_fma_f32 v110, v118, v109, -v108
    v_fma_f32 v111, v118, v110, -v109
    v_fma_f32 v112, v118, v111, -v110
    v_fma_f32 v113, v118, v112, -v111
    v_fma_f32 v114, v118, v113, -v112
    v_fma_f32 v115, v118, v114, -v113
    v_fma_f32 v116, v118, v115, -v114
    v_fma_f32 v117, v118, v116, -v115
    v_cvt_pk_bf16_f32 v76, v102, v106
    v_cvt_pk_bf16_f32 v77, v110, v114
    v_cvt_pk_bf16_f32 v78, v103, v107
    v_cvt_pk_bf16_f32 v79, v111, v115
    v_and_b32 v77, v101, v77
    v_and_b32 v79, v101, v79
    ds_write_b128 v5, v[76:79] offset:2048
    v_cvt_pk_bf16_f32 v80, v104, v108
    v_cvt_pk_bf16_f32 v81, v112, v116
    v_cvt_pk_bf16_f32 v82, v105, v109
    v_cvt_pk_bf16_f32 v83, v113, v117
    v_and_b32 v81, v101, v81
    v_and_b32 v83, v101, v83
    ds_write_b128 v5, v[80:83] offset:3072
    v_fmamk_f32 v102, v96, 0x3f800000, v97
    v_fmamk_f32 v103, v96, 0x40a00000, v97
    v_sin_f32 v102, v102
    v_sin_f32 v103, v103
    s_nop 0
    v_fma_f32 v104, v118, v103, -v102
    v_fma_f32 v105, v118, v104, -v103
    v_fma_f32 v106, v118, v105, -v104
    v_and_b32 v94, 31, v1
    v_lshlrev_b32 v94, 7, v94
    s_mov_b32 s50, 32768
    s_cmp_lg_u32 s3, 1
    s_cbranch_scc1 S_p0
    buffer_load_dword v20, v94, s[36:39], s50 offen sc1
S_p0:
    v_fma_f32 v107, v118, v106, -v105
    v_fma_f32 v108, v118, v107, -v106
    v_fma_f32 v109, v118, v108, -v107
    v_fma_f32 v110, v118, v109, -v108
    v_fma_f32 v111, v118, v110, -v109
    v_fma_f32 v112, v118, v111, -v110
    v_fma_f32 v113, v118, v112, -v111
    v_fma_f32 v114, v118, v113, -v112
    v_fma_f32 v115, v118, v114, -v113
    v_fma_f32 v116, v118, v115, -v114
    v_fma_f32 v117, v118, v116, -v115
    v_cvt_pk_bf16_f32 v76, v102, v106
    v_cvt_pk_bf16_f32 v77, v110, v114
    v_cvt_pk_bf16_f32 v78, v103, v107
    v_cvt_pk_bf16_f32 v79, v111, v115
    v_and_b32 v77, v101, v77
    v_and_b32 v79, v101, v79
    ds_write_b128 v5, v[76:79] offset:6144
    v_cvt_pk_bf16_f32 v80, v104, v108
    v_cvt_pk_bf16_f32 v81, v112, v116
    v_cvt_pk_bf16_f32 v82, v105, v109
    v_cvt_pk_bf16_f32 v83, v113, v117
    v_and_b32 v81, v101, v81
    v_and_b32 v83, v101, v83
    ds_write_b128 v5, v[80:83] offset:7168
    v_bfe_u32 v88, v60, 4, 2
    v_mov_b32 v5, 0xffff0000
    v_add_u32 v4, s3, v88
    v_cmp_eq_u32 s[42:43], 0, v4
    s_nop 1
    v_cndmask_b32 v90, v5, 0, s[42:43]
    s_and_b32 s61, s3, 1
    s_lshl_b32 s61, s61, 2
    v_add_lshl_u32 v88, v88, s61, 16
    v_lshrrev_b32 v4, 2, v3
    v_lshl_add_u32 v4, v2, 3, v4
    v_lshlrev_b32 v4, 6, v4
    v_and_b32 v5, 3, v1
    v_lshl_add_u32 v4, v5, 3, v4
    v_and_b32 v5, 16, v1
    v_lshl_add_u32 v4, v5, 1, v4
    s_lshl_b32 s61, s3, 12
    s_cmp_lg_u32 s3, 1
    s_cbranch_scc1 P_dB
    s_mov_b32 s9, 0
P_lB:
    buffer_load_dword v21, v94, s[36:39], s50 offen sc1
    s_waitcnt vmcnt(1)
    v_cmp_ne_u32 vcc, s12, v20
    s_nop 0
    s_cbranch_vccz P_dB
    buffer_load_dword v20, v94, s[36:39], s50 offen sc1
    s_waitcnt vmcnt(1)
    v_cmp_ne_u32 vcc, s12, v21
    s_nop 0
    s_cbranch_vccz P_dB
    s_add_u32 s9, s9, 1
    s_cmp_lt_u32 s9, 200000
    s_cbranch_scc1 P_lB
P_dB:
    s_lshl_b32 s40, s3, 12
    s_add_u32 m0, s40, 0
    s_waitcnt lgkmcnt(0)
    s_barrier
    buffer_load_dwordx4 v60, s[36:39], s60 offen offset:0 sc1 lds
    buffer_load_dwordx4 v60, s[36:39], s60 offen offset:1024 sc1 lds
    buffer_load_dwordx4 v60, s[36:39], s60 offen offset:2048 sc1 lds
    buffer_load_dwordx4 v60, s[36:39], s60 offen offset:3072 sc1 lds
    ds_read_b128 v[120:123], v67 offset:0
    ds_read_b128 v[124:127], v67 offset:1024
    ds_read_b128 v[128:131], v67 offset:2048
    ds_read_b128 v[132:135], v67 offset:3072
    ds_read_b128 v[136:139], v67 offset:4096
    ds_read_b128 v[140:143], v67 offset:5120
    ds_read_b128 v[144:147], v67 offset:6144
    ds_read_b128 v[148:151], v67 offset:7168
    ds_read_b128 v[152:155], v67 offset:8192
    ds_read_b128 v[156:159], v67 offset:9216
    ds_read_b128 v[160:163], v67 offset:10240
    ds_read_b128 v[164:167], v67 offset:11264
    ds_read_b128 v[168:171], v67 offset:12288
    ds_read_b128 v[172:175], v67 offset:13312
    ds_read_b128 v[176:179], v67 offset:14336
    ds_read_b128 v[180:183], v67 offset:15360
    v_add_u32 v62, s61, v4
    v_xor_b32 v61, 32, v62
    v_add_u32 v89, s61, v63
    s_lshr_b32 s61, s3, 1
    s_lshl_b32 s61, s61, 13
    s_and_b32 s62, s3, 1
    s_lshl_b32 s62, s62, 10
    s_add_u32 s61, s61, s62
    v_add_u32 v91, s61, v63
    v_mov_b32 v68, 81920
    v_lshl_add_u32 v68, s56, 2, v68
    v_mov_b32 v75, 1
    s_lshl_b32 s61, s56, 11
    v_add_u32 v69, s61, v63
    s_lshl_b32 s61, s56, 4
    v_add_u32 v4, s61, v3
    v_mul_u32_u24 v4, 528, v4
    v_add_u32 v4, 98304, v4
    v_lshl_add_u32 v5, s55, 2, v2
    v_lshl_add_u32 v64, v5, 4, v4
    s_and_b32 s61, s3, 1
    s_lshl_b32 s61, s61, 3
    v_lshrrev_b32 v4, 3, v1
    v_add_u32 v4, s61, v4
    v_and_b32 v5, 7, v1
    v_lshlrev_b32 v5, 4, v5
    s_and_b32 s61, s3, 2
    s_add_u32 s61, s61, s56
    s_mul_i32 s61, s61, 8448
    s_add_u32 s61, s61, 98304
    v_mul_u32_u24 v96, 528, v4
    v_add3_u32 v65, v96, v5, s61
    v_add_u32 v97, s61, v96
    s_bitcmp1_b32 s3, 1
    s_cselect_b32 s62, -1, 1
    s_mul_i32 s62, s62, 16896
    v_add_u32 v71, s62, v97
    s_cmp_eq_u32 s56, 0
    s_cselect_b32 s61, s8, s63
    v_lshl_add_u32 v66, v4, 6, s61
    v_sub_u32 v96, 2048, v66
    v_mov_b32 v4, 1024
    v_cmp_eq_u32 s[42:43], 0, v66
    s_nop 1
    v_cndmask_b32 v96, v96, v4, s[42:43]
    v_cndmask_b32 v71, v71, v97, s[42:43]
    s_bitcmp1_b32 s3, 1
    s_cselect_b64 s[42:43], -1, 0
    v_cndmask_b32 v66, v66, v96, s[42:43]
    v_mov_b32 v96, 1792
    v_mad_u32_u24 v66, v66, v96, v5
    v_sub_u32 v71, v71, v5
    v_and_b32 v4, 4, v1
    v_lshl_add_u32 v70, v4, 5, v65
    v_lshl_add_u32 v73, v4, 5, v66
    v_lshlrev_b32 v4, 4, v4
    v_sub_u32 v72, v71, v4
    v_mov_b32 v74, 0xffff
    v_xor_b32 v88, s51, v88
    s_mov_b32 s9, 0
    s_waitcnt lgkmcnt(0)
S_gc:
    s_waitcnt vmcnt(2)
    ds_read_b64_tr_b16 v[184:185], v62 offset:0
    ds_read_b64_tr_b16 v[186:187], v62 offset:256
    ds_read_b64_tr_b16 v[192:193], v61 offset:0
    ds_read_b64_tr_b16 v[194:195], v61 offset:256
    ds_read_b32 v102, v89 offset:12
    ds_read_b32 v103, v89 offset:1036
    s_waitcnt lgkmcnt(4)
    v_mfma_f32_16x16x32_bf16 v[200:203], v[184:187], v[28:31], 0
    v_mfma_f32_16x16x32_bf16 v[208:211], v[184:187], v[36:39], 0
    v_mfma_f32_16x16x32_bf16 v[216:219], v[184:187], v[44:47], 0
    v_mfma_f32_16x16x32_bf16 v[224:227], v[184:187], v[52:55], 0
    s_waitcnt vmcnt(0)
    ds_read_b64_tr_b16 v[188:189], v62 offset:2048
    ds_read_b64_tr_b16 v[190:191], v62 offset:2304
    ds_read_b64_tr_b16 v[196:197], v61 offset:2048
    ds_read_b64_tr_b16 v[198:199], v61 offset:2304
    ds_read_b32 v104, v89 offset:2060
    ds_read_b32 v105, v89 offset:3084
    s_waitcnt lgkmcnt(8)
    v_mfma_f32_16x16x32_bf16 v[204:207], v[192:195], v[28:31], 0
    v_mfma_f32_16x16x32_bf16 v[212:215], v[192:195], v[36:39], 0
    v_mfma_f32_16x16x32_bf16 v[220:223], v[192:195], v[44:47], 0
    v_mfma_f32_16x16x32_bf16 v[228:231], v[192:195], v[52:55], 0
    s_waitcnt lgkmcnt(4)
    v_mfma_f32_16x16x32_bf16 v[200:203], v[188:191], v[32:35], v[200:203]
    s_waitcnt lgkmcnt(2)
    v_mfma_f32_16x16x32_bf16 v[204:207], v[196:199], v[32:35], v[204:207]
    s_waitcnt lgkmcnt(0)
    v_xor_b32 v102, v88, v102
    v_xor_b32 v103, v88, v103
    v_xor_b32 v104, v88, v104
    v_mfma_f32_16x16x32_bf16 v[208:211], v[188:191], v[40:43], v[208:211]
    v_xor_b32 v105, v88, v105
    v_or_b32 v102, v102, v103
    v_or3_b32 v102, v102, v104, v105
    v_mfma_f32_16x16x32_bf16 v[212:215], v[196:199], v[40:43], v[212:215]
    v_and_b32 v102, v90, v102
    v_cmp_ne_u32 vcc, 0, v102
    v_mfma_f32_16x16x32_bf16 v[216:219], v[188:191], v[48:51], v[216:219]
    v_mfma_f32_16x16x32_bf16 v[220:223], v[196:199], v[48:51], v[220:223]
    v_cvt_pk_bf16_f32 v232, v200, v201
    v_cvt_pk_bf16_f32 v233, v202, v203
    v_cvt_pk_bf16_f32 v234, v204, v205
    v_cvt_pk_bf16_f32 v235, v206, v207
    ds_write_b128 v91, v[232:235] offset:32768
    v_mfma_f32_16x16x32_bf16 v[224:227], v[188:191], v[56:59], v[224:227]
    v_mfma_f32_16x16x32_bf16 v[228:231], v[196:199], v[56:59], v[228:231]
    v_cvt_pk_bf16_f32 v236, v208, v209
    v_cvt_pk_bf16_f32 v237, v210, v211
    v_cvt_pk_bf16_f32 v238, v212, v213
    v_cvt_pk_bf16_f32 v239, v214, v215
    ds_write_b128 v91, v[236:239] offset:36864
    s_cbranch_vccnz S_gr
S_gk:
    v_cvt_pk_bf16_f32 v240, v216, v217
    v_cvt_pk_bf16_f32 v241, v218, v219
    v_cvt_pk_bf16_f32 v242, v220, v221
    v_cvt_pk_bf16_f32 v243, v222, v223
    ds_write_b128 v91, v[240:243] offset:34816
    v_cvt_pk_bf16_f32 v244, v224, v225
    v_cvt_pk_bf16_f32 v245, v226, v227
    v_cvt_pk_bf16_f32 v246, v228, v229
    v_cvt_pk_bf16_f32 v247, v230, v231
    ds_write_b128 v91, v[244:247] offset:38912
    s_waitcnt lgkmcnt(0)
    s_barrier
    s_cmp_lg_u32 s56, 0
    s_cbranch_scc1 S_np
    s_setprio 1
S_np:
    ds_read_b128 v[184:187], v69 offset:32768
    ds_read_b128 v[188:191], v69 offset:33792
    ds_read_b128 v[192:195], v69 offset:40960
    ds_read_b128 v[196:199], v69 offset:41984
    ds_read_b128 v[200:203], v69 offset:49152
    ds_read_b128 v[204:207], v69 offset:50176
    ds_read_b128 v[208:211], v69 offset:57344
    s_waitcnt lgkmcnt(6)
    v_mfma_f32_16x16x32_bf16 v[216:219], v[120:123], v[184:187], 0
    ds_read_b128 v[212:215], v69 offset:58368
    s_waitcnt lgkmcnt(6)
    v_mfma_f32_16x16x32_bf16 v[216:219], v[124:127], v[188:191], v[216:219]
    ds_read_b128 v[184:187], v69 offset:53248
    s_waitcnt lgkmcnt(6)
    v_mfma_f32_16x16x32_bf16 v[220:223], v[128:131], v[192:195], 0
    ds_read_b128 v[188:191], v69 offset:54272
    s_waitcnt lgkmcnt(6)
    v_mfma_f32_16x16x32_bf16 v[220:223], v[132:135], v[196:199], v[220:223]
    ds_read_b128 v[192:195], v69 offset:61440
    s_waitcnt lgkmcnt(6)
    v_mfma_f32_16x16x32_bf16 v[232:235], v[152:155], v[200:203], 0
    ds_read_b128 v[196:199], v69 offset:62464
    s_waitcnt lgkmcnt(6)
    v_mfma_f32_16x16x32_bf16 v[232:235], v[156:159], v[204:207], v[232:235]
    ds_read_b128 v[200:203], v69 offset:36864
    s_waitcnt lgkmcnt(6)
    v_mfma_f32_16x16x32_bf16 v[236:239], v[160:163], v[208:211], 0
    ds_read_b128 v[204:207], v69 offset:37888
    s_waitcnt lgkmcnt(6)
    v_mfma_f32_16x16x32_bf16 v[236:239], v[164:167], v[212:215], v[236:239]
    ds_read_b128 v[208:211], v69 offset:45056
    s_waitcnt lgkmcnt(6)
    v_mfma_f32_16x16x32_bf16 v[224:227], v[136:139], v[184:187], 0
    ds_read_b128 v[212:215], v69 offset:46080
    s_waitcnt lgkmcnt(6)
    v_mfma_f32_16x16x32_bf16 v[224:227], v[140:143], v[188:191], v[224:227]
    s_waitcnt lgkmcnt(5)
    v_mfma_f32_16x16x32_bf16 v[228:231], v[144:147], v[192:195], 0
    v_pk_add_f32 v[102:103], v[216:217], v[220:221]
    v_pk_add_f32 v[104:105], v[218:219], v[222:223]
    s_waitcnt lgkmcnt(4)
    v_mfma_f32_16x16x32_bf16 v[228:231], v[148:151], v[196:199], v[228:231]
    v_pk_add_f32 v[220:221], v[216:217], v[220:221] neg_lo:[0,1] neg_hi:[0,1]
    v_pk_add_f32 v[222:223], v[218:219], v[222:223] neg_lo:[0,1] neg_hi:[0,1]
    s_waitcnt lgkmcnt(3)
    v_mfma_f32_16x16x32_bf16 v[240:243], v[168:171], v[200:203], 0
    v_pk_add_f32 v[106:107], v[232:233], v[236:237]
    s_waitcnt lgkmcnt(2)
    v_mfma_f32_16x16x32_bf16 v[240:243], v[172:175], v[204:207], v[240:243]
    v_pk_add_f32 v[108:109], v[234:235], v[238:239]
    s_waitcnt lgkmcnt(1)
    v_mfma_f32_16x16x32_bf16 v[244:247], v[176:179], v[208:211], 0
    v_pk_add_f32 v[236:237], v[232:233], v[236:237] neg_lo:[0,1] neg_hi:[0,1]
    s_waitcnt lgkmcnt(0)
    v_mfma_f32_16x16x32_bf16 v[244:247], v[180:183], v[212:215], v[244:247]
    v_pk_add_f32 v[238:239], v[234:235], v[238:239] neg_lo:[0,1] neg_hi:[0,1]
    s_add_u32 s40, s8, s56
    s_cmp_eq_u32 s40, 0
    s_cbranch_scc1 S_y0
S_y1:
    v_pk_add_f32 v[216:217], v[224:225], v[228:229]
    v_pk_add_f32 v[218:219], v[226:227], v[230:231]
    v_pk_add_f32 v[228:229], v[224:225], v[228:229] neg_lo:[0,1] neg_hi:[0,1]
    v_pk_add_f32 v[230:231], v[226:227], v[230:231] neg_lo:[0,1] neg_hi:[0,1]
    v_pk_add_f32 v[232:233], v[240:241], v[244:245]
    v_pk_add_f32 v[234:235], v[242:243], v[246:247]
    v_pk_add_f32 v[244:245], v[240:241], v[244:245] neg_lo:[0,1] neg_hi:[0,1]
    v_pk_add_f32 v[246:247], v[242:243], v[246:247] neg_lo:[0,1] neg_hi:[0,1]
    v_pk_add_f32 v[224:225], v[102:103], v[216:217]
    v_pk_add_f32 v[226:227], v[104:105], v[218:219]
    v_pk_add_f32 v[240:241], v[106:107], v[232:233]
    v_pk_add_f32 v[242:243], v[108:109], v[234:235]
    v_cvt_pk_bf16_f32 v184, v224, v240
    v_cvt_pk_bf16_f32 v185, v225, v241
    v_cvt_pk_bf16_f32 v186, v226, v242
    v_cvt_pk_bf16_f32 v187, v227, v243
    ds_write_b128 v64, v[184:187] offset:0
    v_pk_add_f32 v[224:225], v[102:103], v[216:217] neg_lo:[0,1] neg_hi:[0,1]
    v_pk_add_f32 v[226:227], v[104:105], v[218:219] neg_lo:[0,1] neg_hi:[0,1]
    v_pk_add_f32 v[240:241], v[106:107], v[232:233] neg_lo:[0,1] neg_hi:[0,1]
    v_pk_add_f32 v[242:243], v[108:109], v[234:235] neg_lo:[0,1] neg_hi:[0,1]
    v_cvt_pk_bf16_f32 v188, v224, v240
    v_cvt_pk_bf16_f32 v189, v225, v241
    v_cvt_pk_bf16_f32 v190, v226, v242
    v_cvt_pk_bf16_f32 v191, v227, v243
    ds_write_b128 v64, v[188:191] offset:16896
    v_pk_add_f32 v[224:225], v[220:221], v[228:229]
    v_pk_add_f32 v[226:227], v[222:223], v[230:231]
    v_pk_add_f32 v[240:241], v[236:237], v[244:245]
    v_pk_add_f32 v[242:243], v[238:239], v[246:247]
    v_cvt_pk_bf16_f32 v192, v224, v240
    v_cvt_pk_bf16_f32 v193, v225, v241
    v_cvt_pk_bf16_f32 v194, v226, v242
    v_cvt_pk_bf16_f32 v195, v227, v243
    ds_write_b128 v64, v[192:195] offset:256
    v_pk_add_f32 v[224:225], v[220:221], v[228:229] neg_lo:[0,1] neg_hi:[0,1]
    v_pk_add_f32 v[226:227], v[222:223], v[230:231] neg_lo:[0,1] neg_hi:[0,1]
    v_pk_add_f32 v[240:241], v[236:237], v[244:245] neg_lo:[0,1] neg_hi:[0,1]
    v_pk_add_f32 v[242:243], v[238:239], v[246:247] neg_lo:[0,1] neg_hi:[0,1]
    v_cvt_pk_bf16_f32 v196, v224, v240
    v_cvt_pk_bf16_f32 v197, v225, v241
    v_cvt_pk_bf16_f32 v198, v226, v242
    v_cvt_pk_bf16_f32 v199, v227, v243
    ds_write_b128 v64, v[196:199] offset:17152
    s_mov_b64 exec, 1
    ds_add_u32 v68, v75
    s_mov_b64 exec, -1
    s_mov_b32 s9, 0
W_lO:
    ds_read_b32 v4, v68 offset:0
    s_add_u32 s9, s9, 1
    s_cmp_gt_u32 s9, 1600000
    s_cbranch_scc1 W_dO
    s_waitcnt lgkmcnt(0)
    v_cmp_gt_u32 vcc, 4, v4
    s_nop 0
    s_cbranch_vccnz W_lO
W_dO:
    v_and_b32 v4, 4, v1
    v_lshl_add_u32 v5, v4, 6, v66
    ds_read_b128 v[120:123], v65 offset:0
    ds_read_b128 v[124:127], v65 offset:128
    ds_read_b128 v[128:131], v65 offset:320
    ds_read_b128 v[132:135], v70 offset:256
    ds_read_b128 v[136:139], v71 offset:432
    ds_read_b32 v140, v71 offset:448
    ds_read_b128 v[144:147], v71 offset:112
    ds_read_b32 v148, v71 offset:128
    ds_read_b128 v[152:155], v72 offset:304
    ds_read_b32 v156, v72 offset:320
    s_waitcnt lgkmcnt(9)
    buffer_store_dwordx4 v[120:123], v66, s[32:35], 0 offen offset:896 nt
    s_waitcnt lgkmcnt(8)
    buffer_store_dwordx4 v[124:127], v66, s[32:35], 0 offen offset:1024 nt
    s_waitcnt lgkmcnt(7)
    buffer_store_dwordx4 v[128:131], v66, s[32:35], 0 offen offset:1408 nt
    s_waitcnt lgkmcnt(6)
    buffer_store_dwordx4 v[132:135], v73, s[32:35], 0 offen offset:1344 nt
    s_waitcnt lgkmcnt(4)
    v_bfi_b32 v160, v74, v140, v139
    v_bfi_b32 v161, v74, v139, v138
    v_bfi_b32 v162, v74, v138, v137
    v_bfi_b32 v163, v74, v137, v136
    buffer_store_dwordx4 v[160:163], v66, s[32:35], 0 offen offset:1152 nt
    s_waitcnt lgkmcnt(2)
    v_bfi_b32 v164, v74, v148, v147
    v_bfi_b32 v165, v74, v147, v146
    v_bfi_b32 v166, v74, v146, v145
    v_bfi_b32 v167, v74, v145, v144
    buffer_store_dwordx4 v[164:167], v66, s[32:35], 0 offen offset:1664 nt
    s_waitcnt lgkmcnt(0)
    v_bfi_b32 v168, v74, v156, v155
    v_bfi_b32 v169, v74, v155, v154
    v_bfi_b32 v170, v74, v154, v153
    v_bfi_b32 v171, v74, v153, v152
    buffer_store_dwordx4 v[168:171], v5, s[32:35], 0 offen offset:1280 nt
    s_add_u32 s40, s8, s3
    s_cmp_lg_u32 s40, 0
    s_cbranch_scc1 S_end
    s_add_u32 s40, s10, 16
    v_mov_b32 v4, s40
    s_mov_b32 s40, 4096
    s_mov_b64 exec, 1
    buffer_store_dword v4, v12, s[36:39], s40 offen
S_end:
    s_endpgm
    s_endpgm
    s_endpgm
    s_endpgm
    s_endpgm
    s_endpgm
    s_endpgm
    s_endpgm
    s_endpgm
    s_endpgm
    s_endpgm
    s_endpgm
    s_endpgm
    s_endpgm
    s_endpgm
    s_endpgm
    s_endpgm
    s_endpgm
    s_endpgm
    s_endpgm
    s_endpgm
    s_endpgm
    s_endpgm
    s_endpgm
    s_endpgm
    s_endpgm
    s_endpgm
    s_endpgm
    s_endpgm
    s_endpgm
    s_endpgm
    s_endpgm
    s_endpgm
    s_endpgm
    s_endpgm
    s_endpgm
    s_endpgm
    s_endpgm
    s_endpgm
    s_endpgm
    s_endpgm
    s_endpgm
    s_endpgm
    s_endpgm
    s_endpgm
    s_endpgm
    s_endpgm
    s_endpgm
    s_endpgm
    s_endpgm
    s_endpgm
    s_endpgm
    s_endpgm
    s_endpgm
    s_endpgm
    s_endpgm
    s_endpgm
    s_endpgm
    s_endpgm
    s_endpgm
    s_endpgm
    s_endpgm
    s_endpgm
    s_endpgm
    s_endpgm
    s_endpgm
    s_endpgm
    s_endpgm
    s_endpgm
    s_endpgm
    s_endpgm
    s_endpgm
    s_endpgm
    s_endpgm
    s_endpgm
    s_endpgm
    s_endpgm
    s_endpgm
    s_endpgm
    s_endpgm
    s_endpgm
    s_endpgm
    s_endpgm
    s_endpgm
    s_endpgm
    s_endpgm
    s_endpgm
    s_endpgm
    s_endpgm
    s_endpgm
    s_endpgm
    s_endpgm
    s_endpgm
    s_endpgm
    s_endpgm
    s_endpgm
    s_endpgm
    s_endpgm
    s_endpgm
    s_endpgm
    s_endpgm
    s_endpgm
    s_endpgm
    s_endpgm
    s_endpgm
    s_endpgm
    s_endpgm
    s_endpgm
    s_endpgm
    s_endpgm
    s_endpgm
    s_endpgm
    s_endpgm
    s_endpgm
    s_endpgm
    s_endpgm
    s_endpgm
    s_endpgm
    s_endpgm
    s_endpgm
    s_endpgm
    s_endpgm
    s_endpgm
    s_endpgm
    s_endpgm
    s_endpgm
    s_endpgm
    s_endpgm
    s_endpgm
K_c:
    s_lshl_b32 s40, s8, 7
    s_waitcnt lgkmcnt(0)
    s_load_dwordx2 s[10:11], s[36:37], s40
    s_lshl_b32 s14, s8, 10
    s_add_u32 s14, s14, 65536
    s_getreg_b32 s52, hwreg(HW_REG_XCC_ID, 0, 3)
    s_mov_b32 s26, 401408
    s_mov_b32 s27, 0x00020000
    s_mov_b32 s34, 3670016
    s_mov_b32 s35, 0x00020000
    s_sub_u32 s62, s3, 4
    s_lshr_b32 s16, s62, 1
    s_and_b32 s17, s62, 1
    s_lshl_b32 s29, s62, 11
    v_and_b32 v1, 63, v0
    v_lshlrev_b32 v4, 4, v1
    s_lshl_b32 s1, s5, 3
    s_add_u32 s1, s1, s4
    s_mul_i32 s1, s1, 1792
    v_min_u32 v46, 13, v1
    v_lshlrev_b32 v46, 7, v46
    v_lshrrev_b32 v29, 4, v1
    v_and_b32 v30, 15, v1
    v_lshrrev_b32 v31, 3, v1
    v_and_b32 v32, 7, v1
    v_mov_b32 v5, 161792
    v_mov_b32 v6, 0
    v_lshl_add_u32 v2, v1, 2, v5
    ds_write_b32 v2, v6
    v_lshrrev_b32 v3, 1, v30
    v_xor_b32 v3, v3, v29
    v_lshlrev_b32 v3, 4, v3
    v_lshl_add_u32 v3, v30, 7, v3
    s_lshr_b32 s18, s62, 1
    s_lshl_b32 s18, s18, 12
    v_add_u32 v33, s18, v3
    v_xor_b32 v34, 64, v33
    v_add_u32 v35, 40960, v33
    v_add_u32 v36, 40960, v34
    v_lshrrev_b32 v3, 2, v30
    v_lshl_add_u32 v3, v29, 3, v3
    v_lshlrev_b32 v3, 7, v3
    v_and_b32 v7, 3, v1
    v_lshl_add_u32 v3, v7, 3, v3
    v_bfe_u32 v7, v1, 3, 2
    s_and_b32 s18, s62, 1
    s_lshl_b32 s18, s18, 1
    v_xor_b32 v7, s18, v7
    v_lshl_add_u32 v3, v7, 5, v3
    v_add_u32 v37, 71680, v3
    v_xor_b32 v38, 32, v37
    v_add_u32 v39, 49152, v37
    v_add_u32 v40, 49152, v38
    s_and_b32 s18, s62, 1
    s_lshl_b32 s19, s7, 1
    s_add_u32 s18, s18, s19
    s_cmp_ge_u32 s18, 7
    s_cselect_b32 s19, 14, 7
    s_sub_u32 s18, s19, s18
    v_cmp_gt_u32 s[54:55], s18, v29
    v_add_u32 v2, 4, v29
    v_cmp_gt_u32 s[56:57], s18, v2
    s_bitcmp0_b32 s62, 0
    s_cselect_b64 vcc, -1, 0
    s_xor_b64 s[54:55], s[54:55], vcc
    s_xor_b64 s[56:57], s[56:57], vcc
    v_lshrrev_b32 v3, 2, v30
    s_and_b32 s18, s62, 1
    s_lshl_b32 s19, s7, 1
    s_add_u32 s18, s18, s19
    s_cmp_ge_u32 s18, 7
    s_cselect_b32 s19, 14, 7
    s_sub_u32 s18, s19, s18
    v_cmp_gt_u32 s[58:59], s18, v3
    v_add_u32 v2, 4, v3
    v_cmp_gt_u32 s[60:61], s18, v2
    s_bitcmp0_b32 s62, 0
    s_cselect_b64 vcc, -1, 0
    s_xor_b64 s[58:59], s[58:59], vcc
    s_xor_b64 s[60:61], s[60:61], vcc
    s_and_b32 s18, s62, 1
    s_lshl_b32 s19, s7, 1
    s_add_u32 s18, s18, s19
    s_lshl_b32 s100, s18, 10
    s_lshl_b32 s18, s8, 2
    s_and_b32 s19, s62, 2
    s_add_u32 s18, s18, s19
    s_mul_i32 s19, s18, 14336
    s_add_u32 s100, s100, s19
    s_add_u32 s100, s100, 2097152
    s_lshl_b32 s20, s18, 6
    s_add_u32 s20, s20, 16384
    s_lshl_b32 s18, s17, 11
    s_sub_u32 s18, s18, 1024
    s_add_u32 s15, s100, s18
    s_lshl_b32 s19, s7, 1
    s_add_u32 s18, s17, s19
    s_lshl_b32 s18, s18, 3
    s_add_u32 s21, s20, s18
    v_and_b32 v2, 1, v30
    v_cmp_eq_u32 s[44:45], 1, v2
    v_lshl_add_u32 v2, v29, 2, v2
    v_cmp_le_u32 s[46:47], v2, v30
    v_add_u32 v2, 2, v2
    v_cmp_le_u32 s[48:49], v2, v30
    v_mov_b32 v2, 0xffff
    v_mov_b32 v3, 0xffff0000
    v_cndmask_b32 v2, v2, v3, s[44:45]
    v_cndmask_b32 v41, v2, 0, s[46:47]
    v_cndmask_b32 v42, v2, 0, s[48:49]
    v_cndmask_b32 v43, 0, v2, s[46:47]
    v_cndmask_b32 v44, 0, v2, s[48:49]
    s_add_u32 s18, s8, s16
    s_cmp_eq_u32 s18, 0
    s_cselect_b64 s[50:51], -1, 0
    s_mul_i32 s18, s17, 6
    s_cmp_eq_u32 s18, s7
    s_cselect_b32 s101, 1, 0
    v_mov_b32 v49, 1
    v_mov_b32 v50, 0xf149f2ca
    v_mov_b32 v51, 0xffffff00
    s_mov_b32 s0, 0x3e8b97f6
    s_add_u32 s18, s29, 4096
    v_add_u32 v47, s18, v4
    v_add_u32 v48, s29, v4
    v_lshl_add_u32 v52, s62, 2, v5
    v_lshl_add_u32 v222, s17, 10, v4
    v_add_u32 v223, 2048, v222
    v_lshl_add_u32 v224, s17, 2, v5
    v_lshl_add_u32 v225, s17, 3, v5
    s_lshl_b32 s18, s7, 7
    v_min_u32 v8, 11, v1
    s_lshl_b32 s19, s7, 1
    s_add_u32 s19, s19, 2
    v_add_u32 v8, s19, v8
    v_add_u32 v2, -14, v8
    v_min_u32 v8, v8, v2
    v_lshlrev_b32 v8, 3, v8
    v_lshl_add_u32 v18, s16, 12, v222
    v_add_u32 v19, s29, v4
    v_lshl_add_u32 v20, s16, 3, v5
    v_lshrrev_b32 v2, 2, v1
    v_bfe_u32 v3, v1, 3, 2
    v_lshlrev_b32 v3, 5, v3
    v_lshl_add_u32 v2, v2, 7, v3
    v_and_b32 v3, 3, v1
    v_lshl_add_u32 v2, v3, 3, v2
    v_add_u32 v21, 71680, v2
    v_xor_b32 v22, 32, v21
    v_xor_b32 v23, 64, v21
    v_xor_b32 v24, 96, v21
    s_add_u32 s19, s29, 4096
    v_lshrrev_b32 v2, 1, v29
    v_xor_b32 v2, v2, v32
    v_lshlrev_b32 v2, 4, v2
    v_lshl_add_u32 v2, v30, 7, v2
    v_and_b32 v3, 1, v29
    v_lshl_add_u32 v2, v3, 3, v2
    v_add_u32 v25, s19, v2
    v_xor_b32 v26, 32, v25
    v_xor_b32 v27, 64, v25
    v_xor_b32 v28, 96, v25
    v_mul_u32_u24 v10, 1792, v31
    v_lshl_add_u32 v10, v32, 4, v10
    v_xor_b32 v3, v32, v31
    v_lshlrev_b32 v3, 4, v3
    v_lshl_add_u32 v2, v31, 7, v3
    v_add_u32 v9, s19, v2
    s_lshl_b32 s19, s8, 2
    s_add_u32 s19, s19, s62
    s_mul_i32 s22, s19, 14336
    s_add_u32 s22, s22, 2097152
    s_mul_i32 s23, s19, 28672
    s_add_u32 s23, s23, s18
    s_add_u32 s28, s23, 14336
    s_waitcnt lgkmcnt(0)
    s_add_u32 s40, s7, 1
    s_sub_u32 s41, s40, 7
    s_min_u32 s40, s40, s41
    s_lshl_b32 s40, s40, 11
    s_add_u32 s1, s40, s22
    s_add_u32 s40, s7, 2
    s_sub_u32 s41, s40, 7
    s_min_u32 s40, s40, s41
    s_lshl_b32 s40, s40, 11
    s_add_u32 s4, s40, s22
    s_add_u32 s40, s7, 3
    s_sub_u32 s41, s40, 7
    s_min_u32 s40, s40, s41
    s_lshl_b32 s40, s40, 11
    s_add_u32 s6, s40, s22
    s_add_u32 s40, s7, 4
    s_sub_u32 s41, s40, 7
    s_min_u32 s40, s40, s41
    s_lshl_b32 s40, s40, 11
    s_add_u32 s24, s40, s22
    s_add_u32 s40, s7, 5
    s_sub_u32 s41, s40, 7
    s_min_u32 s40, s40, s41
    s_lshl_b32 s40, s40, 11
    s_add_u32 s25, s40, s22
    s_add_u32 s40, s7, 6
    s_sub_u32 s41, s40, 7
    s_min_u32 s40, s40, s41
    s_lshl_b32 s40, s40, 11
    s_add_u32 s26, s40, s22
    s_add_u32 s12, s10, 0x5a3c9671
    s_xor_b32 s13, s11, 0x2b7e1516
    s_add_u32 s52, s52, s12
    s_mov_b32 s53, s13
    v_mov_b32 v14, s12
    v_mov_b32 v15, s13
    s_bfe_u32 s40, s12, 0x80000
    v_mov_b32 v54, s40
    s_bfe_u32 s40, s12, 0x80008
    v_mov_b32 v55, s40
    s_bfe_u32 s40, s12, 0x80010
    v_mov_b32 v56, s40
    s_bfe_u32 s40, s12, 0x80018
    v_mov_b32 v57, s40
    s_setprio 3
    s_cmp_lg_u32 s62, 0
    s_cbranch_scc1 C_nox
    v_mov_b32 v12, s52
    v_mov_b32 v13, s53
    s_lshl_b32 s41, s7, 3
    s_add_u32 s40, s14, s41
    s_mov_b64 exec, 1
    buffer_store_dwordx2 v[12:13], v6, s[36:39], s40 offen sc1
    s_mov_b64 exec, -1
C_nox:
    s_cmp_lg_u32 s16, 0
    s_cbranch_scc1 C_tp1
    s_barrier
    ds_read_b128 v[134:137], v33 offset:2048
    ds_read_b64_tr_b16 v[178:179], v37 offset:8192
    ds_read_b64_tr_b16 v[180:181], v37 offset:8704
    ds_read_b128 v[146:149], v34 offset:2048
    ds_read_b64_tr_b16 v[182:183], v37 offset:12288
    ds_read_b64_tr_b16 v[184:185], v37 offset:12800
    ds_read_b128 v[138:141], v33 offset:4096
    ds_read_b128 v[150:153], v34 offset:4096
    ds_read_b64_tr_b16 v[186:187], v38 offset:8192
    ds_read_b64_tr_b16 v[188:189], v38 offset:8704
    ds_read_b64_tr_b16 v[190:191], v38 offset:12288
    ds_read_b64_tr_b16 v[192:193], v38 offset:12800
    s_waitcnt lgkmcnt(9)
    v_mfma_f32_16x16x32_bf16 v[66:69], v[178:181], v[134:137], 0
    ds_read_b128 v[130:133], v33 offset:0
    s_waitcnt lgkmcnt(7)
    v_mfma_f32_16x16x32_bf16 v[66:69], v[182:185], v[146:149], v[66:69]
    ds_read_b64_tr_b16 v[194:195], v37 offset:16384
    ds_read_b64_tr_b16 v[196:197], v37 offset:16896
    s_waitcnt lgkmcnt(8)
    v_mfma_f32_16x16x32_bf16 v[74:77], v[178:181], v[138:141], 0
    ds_read_b128 v[142:145], v34 offset:0
    ds_read_b64_tr_b16 v[198:199], v37 offset:20480
    s_waitcnt lgkmcnt(9)
    v_mfma_f32_16x16x32_bf16 v[74:77], v[182:185], v[150:153], v[74:77]
    ds_read_b64_tr_b16 v[200:201], v37 offset:20992
    s_waitcnt lgkmcnt(8)
    v_mfma_f32_16x16x32_bf16 v[70:73], v[186:189], v[134:137], 0
    ds_read_b64_tr_b16 v[178:179], v38 offset:16384
    s_waitcnt lgkmcnt(7)
    v_mfma_f32_16x16x32_bf16 v[70:73], v[190:193], v[146:149], v[70:73]
    ds_read_b64_tr_b16 v[180:181], v38 offset:16896
    v_mfma_f32_16x16x32_bf16 v[78:81], v[186:189], v[138:141], 0
    ds_read_b64_tr_b16 v[182:183], v38 offset:20480
    v_mfma_f32_16x16x32_bf16 v[78:81], v[190:193], v[150:153], v[78:81]
    ds_read_b64_tr_b16 v[184:185], v38 offset:20992
    s_waitcnt lgkmcnt(7)
    v_mfma_f32_16x16x32_bf16 v[82:85], v[194:197], v[130:133], 0
    ds_read_b64_tr_b16 v[186:187], v37 offset:24576
    s_waitcnt lgkmcnt(5)
    v_mfma_f32_16x16x32_bf16 v[82:85], v[198:201], v[142:145], v[82:85]
    ds_read_b64_tr_b16 v[188:189], v37 offset:25088
    v_mfma_f32_16x16x32_bf16 v[90:93], v[194:197], v[134:137], 0
    ds_read_b64_tr_b16 v[190:191], v37 offset:28672
    v_mfma_f32_16x16x32_bf16 v[90:93], v[198:201], v[146:149], v[90:93]
    ds_read_b64_tr_b16 v[192:193], v37 offset:29184
    v_mfma_f32_16x16x32_bf16 v[98:101], v[194:197], v[138:141], 0
    ds_read_b64_tr_b16 v[194:195], v38 offset:24576
    v_mfma_f32_16x16x32_bf16 v[98:101], v[198:201], v[150:153], v[98:101]
    ds_read_b64_tr_b16 v[196:197], v38 offset:25088
    s_waitcnt lgkmcnt(8)
    v_mfma_f32_16x16x32_bf16 v[86:89], v[178:181], v[130:133], 0
    ds_read_b64_tr_b16 v[198:199], v38 offset:28672
    s_waitcnt lgkmcnt(7)
    v_mfma_f32_16x16x32_bf16 v[86:89], v[182:185], v[142:145], v[86:89]
    ds_read_b64_tr_b16 v[200:201], v38 offset:29184
    v_mfma_f32_16x16x32_bf16 v[94:97], v[178:181], v[134:137], 0
    v_mfma_f32_16x16x32_bf16 v[94:97], v[182:185], v[146:149], v[94:97]
    v_mfma_f32_16x16x32_bf16 v[102:105], v[178:181], v[138:141], 0
    v_mfma_f32_16x16x32_bf16 v[102:105], v[182:185], v[150:153], v[102:105]
    s_waitcnt lgkmcnt(6)
    v_mfma_f32_16x16x32_bf16 v[106:109], v[130:133], v[186:189], 0
    s_waitcnt lgkmcnt(4)
    v_mfma_f32_16x16x32_bf16 v[106:109], v[142:145], v[190:193], v[106:109]
    v_mfma_f32_16x16x32_bf16 v[114:117], v[134:137], v[186:189], 0
    v_mfma_f32_16x16x32_bf16 v[114:117], v[146:149], v[190:193], v[114:117]
    s_waitcnt lgkmcnt(2)
    v_mfma_f32_16x16x32_bf16 v[110:113], v[130:133], v[194:197], 0
    s_waitcnt lgkmcnt(0)
    s_barrier
    ds_read_b128 v[158:161], v33 offset:12288
    ds_read_b64_tr_b16 v[178:179], v37 offset:32768
    ds_read_b64_tr_b16 v[180:181], v37 offset:33280
    ds_read_b128 v[170:173], v34 offset:12288
    ds_read_b64_tr_b16 v[182:183], v37 offset:36864
    ds_read_b64_tr_b16 v[184:185], v37 offset:37376
    ds_read_b128 v[162:165], v33 offset:14336
    ds_read_b128 v[174:177], v34 offset:14336
    ds_read_b64_tr_b16 v[186:187], v38 offset:32768
    ds_read_b64_tr_b16 v[188:189], v38 offset:33280
    ds_read_b64_tr_b16 v[190:191], v38 offset:36864
    ds_read_b64_tr_b16 v[192:193], v38 offset:37376
    ds_read_b128 v[154:157], v33 offset:10240
    v_mfma_f32_16x16x32_bf16 v[110:113], v[142:145], v[198:201], v[110:113]
    v_mfma_f32_16x16x32_bf16 v[118:121], v[134:137], v[194:197], 0
    ds_read_b64_tr_b16 v[194:195], v37 offset:40960
    v_mfma_f32_16x16x32_bf16 v[118:121], v[146:149], v[198:201], v[118:121]
    ds_read_b64_tr_b16 v[196:197], v37 offset:41472
    s_waitcnt lgkmcnt(12)
    v_mfma_f32_16x16x32_bf16 v[66:69], v[178:181], v[158:161], v[66:69]
    ds_read_b128 v[166:169], v34 offset:10240
    s_waitcnt lgkmcnt(10)
    v_mfma_f32_16x16x32_bf16 v[66:69], v[182:185], v[170:173], v[66:69]
    ds_read_b64_tr_b16 v[198:199], v37 offset:45056
    s_waitcnt lgkmcnt(10)
    v_mfma_f32_16x16x32_bf16 v[74:77], v[178:181], v[162:165], v[74:77]
    ds_read_b64_tr_b16 v[200:201], v37 offset:45568
    s_waitcnt lgkmcnt(10)
    v_mfma_f32_16x16x32_bf16 v[74:77], v[182:185], v[174:177], v[74:77]
    ds_read_b64_tr_b16 v[178:179], v38 offset:40960
    s_waitcnt lgkmcnt(9)
    v_mfma_f32_16x16x32_bf16 v[70:73], v[186:189], v[158:161], v[70:73]
    ds_read_b64_tr_b16 v[180:181], v38 offset:41472
    s_waitcnt lgkmcnt(8)
    v_mfma_f32_16x16x32_bf16 v[70:73], v[190:193], v[170:173], v[70:73]
    ds_read_b64_tr_b16 v[182:183], v38 offset:45056
    v_mfma_f32_16x16x32_bf16 v[78:81], v[186:189], v[162:165], v[78:81]
    ds_read_b64_tr_b16 v[184:185], v38 offset:45568
    v_mfma_f32_16x16x32_bf16 v[78:81], v[190:193], v[174:177], v[78:81]
    ds_read_b64_tr_b16 v[186:187], v39 offset:0
    s_waitcnt lgkmcnt(8)
    v_mfma_f32_16x16x32_bf16 v[82:85], v[194:197], v[154:157], v[82:85]
    ds_read_b64_tr_b16 v[188:189], v39 offset:512
    s_waitcnt lgkmcnt(6)
    v_mfma_f32_16x16x32_bf16 v[82:85], v[198:201], v[166:169], v[82:85]
    ds_read_b64_tr_b16 v[190:191], v39 offset:4096
    v_mfma_f32_16x16x32_bf16 v[90:93], v[194:197], v[158:161], v[90:93]
    ds_read_b64_tr_b16 v[192:193], v39 offset:4608
    v_mfma_f32_16x16x32_bf16 v[90:93], v[198:201], v[170:173], v[90:93]
    v_mfma_f32_16x16x32_bf16 v[98:101], v[194:197], v[162:165], v[98:101]
    ds_read_b64_tr_b16 v[194:195], v40 offset:0
    v_mfma_f32_16x16x32_bf16 v[98:101], v[198:201], v[174:177], v[98:101]
    ds_read_b64_tr_b16 v[196:197], v40 offset:512
    s_waitcnt lgkmcnt(8)
    v_mfma_f32_16x16x32_bf16 v[86:89], v[178:181], v[154:157], v[86:89]
    ds_read_b64_tr_b16 v[198:199], v40 offset:4096
    s_waitcnt lgkmcnt(7)
    v_mfma_f32_16x16x32_bf16 v[86:89], v[182:185], v[166:169], v[86:89]
    ds_read_b64_tr_b16 v[200:201], v40 offset:4608
    v_mfma_f32_16x16x32_bf16 v[94:97], v[178:181], v[158:161], v[94:97]
    v_mfma_f32_16x16x32_bf16 v[94:97], v[182:185], v[170:173], v[94:97]
    v_mfma_f32_16x16x32_bf16 v[102:105], v[178:181], v[162:165], v[102:105]
    v_mfma_f32_16x16x32_bf16 v[102:105], v[182:185], v[174:177], v[102:105]
    s_waitcnt lgkmcnt(6)
    v_mfma_f32_16x16x32_bf16 v[106:109], v[154:157], v[186:189], v[106:109]
    s_waitcnt lgkmcnt(4)
    v_mfma_f32_16x16x32_bf16 v[106:109], v[166:169], v[190:193], v[106:109]
    v_mfma_f32_16x16x32_bf16 v[114:117], v[158:161], v[186:189], v[114:117]
    v_mfma_f32_16x16x32_bf16 v[114:117], v[170:173], v[190:193], v[114:117]
    s_waitcnt lgkmcnt(2)
    v_mfma_f32_16x16x32_bf16 v[110:113], v[154:157], v[194:197], v[110:113]
    s_waitcnt lgkmcnt(0)
    s_barrier
    ds_read_b128 v[134:137], v33 offset:22528
    ds_read_b64_tr_b16 v[178:179], v39 offset:8192
    ds_read_b64_tr_b16 v[180:181], v39 offset:8704
    ds_read_b128 v[146:149], v34 offset:22528
    ds_read_b64_tr_b16 v[182:183], v39 offset:12288
    ds_read_b64_tr_b16 v[184:185], v39 offset:12800
    ds_read_b128 v[138:141], v33 offset:24576
    ds_read_b128 v[150:153], v34 offset:24576
    ds_read_b64_tr_b16 v[186:187], v40 offset:8192
    ds_read_b64_tr_b16 v[188:189], v40 offset:8704
    ds_read_b64_tr_b16 v[190:191], v40 offset:12288
    ds_read_b64_tr_b16 v[192:193], v40 offset:12800
    ds_read_b128 v[130:133], v33 offset:20480
    v_mfma_f32_16x16x32_bf16 v[110:113], v[166:169], v[198:201], v[110:113]
    v_mfma_f32_16x16x32_bf16 v[118:121], v[158:161], v[194:197], v[118:121]
    ds_read_b64_tr_b16 v[194:195], v39 offset:16384
    v_mfma_f32_16x16x32_bf16 v[118:121], v[170:173], v[198:201], v[118:121]
    ds_read_b64_tr_b16 v[196:197], v39 offset:16896
    s_waitcnt lgkmcnt(12)
    v_mfma_f32_16x16x32_bf16 v[66:69], v[178:181], v[134:137], v[66:69]
    ds_read_b128 v[142:145], v34 offset:20480
    s_waitcnt lgkmcnt(10)
    v_mfma_f32_16x16x32_bf16 v[66:69], v[182:185], v[146:149], v[66:69]
    ds_read_b64_tr_b16 v[198:199], v39 offset:20480
    s_waitcnt lgkmcnt(10)
    v_mfma_f32_16x16x32_bf16 v[74:77], v[178:181], v[138:141], v[74:77]
    ds_read_b64_tr_b16 v[200:201], v39 offset:20992
    s_waitcnt lgkmcnt(10)
    v_mfma_f32_16x16x32_bf16 v[74:77], v[182:185], v[150:153], v[74:77]
    ds_read_b64_tr_b16 v[178:179], v40 offset:16384
    s_waitcnt lgkmcnt(9)
    v_mfma_f32_16x16x32_bf16 v[70:73], v[186:189], v[134:137], v[70:73]
    ds_read_b64_tr_b16 v[180:181], v40 offset:16896
    s_waitcnt lgkmcnt(8)
    v_mfma_f32_16x16x32_bf16 v[70:73], v[190:193], v[146:149], v[70:73]
    ds_read_b64_tr_b16 v[182:183], v40 offset:20480
    v_mfma_f32_16x16x32_bf16 v[78:81], v[186:189], v[138:141], v[78:81]
    ds_read_b64_tr_b16 v[184:185], v40 offset:20992
    v_mfma_f32_16x16x32_bf16 v[78:81], v[190:193], v[150:153], v[78:81]
    ds_read_b64_tr_b16 v[186:187], v39 offset:24576
    s_waitcnt lgkmcnt(8)
    v_mfma_f32_16x16x32_bf16 v[82:85], v[194:197], v[130:133], v[82:85]
    ds_read_b64_tr_b16 v[188:189], v39 offset:25088
    s_waitcnt lgkmcnt(6)
    v_mfma_f32_16x16x32_bf16 v[82:85], v[198:201], v[142:145], v[82:85]
    ds_read_b64_tr_b16 v[190:191], v39 offset:28672
    v_mfma_f32_16x16x32_bf16 v[90:93], v[194:197], v[134:137], v[90:93]
    ds_read_b64_tr_b16 v[192:193], v39 offset:29184
    v_mfma_f32_16x16x32_bf16 v[90:93], v[198:201], v[146:149], v[90:93]
    v_mfma_f32_16x16x32_bf16 v[98:101], v[194:197], v[138:141], v[98:101]
    ds_read_b64_tr_b16 v[194:195], v40 offset:24576
    v_mfma_f32_16x16x32_bf16 v[98:101], v[198:201], v[150:153], v[98:101]
    ds_read_b64_tr_b16 v[196:197], v40 offset:25088
    s_waitcnt lgkmcnt(8)
    v_mfma_f32_16x16x32_bf16 v[86:89], v[178:181], v[130:133], v[86:89]
    ds_read_b64_tr_b16 v[198:199], v40 offset:28672
    s_waitcnt lgkmcnt(7)
    v_mfma_f32_16x16x32_bf16 v[86:89], v[182:185], v[142:145], v[86:89]
    ds_read_b64_tr_b16 v[200:201], v40 offset:29184
    v_mfma_f32_16x16x32_bf16 v[94:97], v[178:181], v[134:137], v[94:97]
    v_mfma_f32_16x16x32_bf16 v[94:97], v[182:185], v[146:149], v[94:97]
    v_mfma_f32_16x16x32_bf16 v[102:105], v[178:181], v[138:141], v[102:105]
    v_mfma_f32_16x16x32_bf16 v[102:105], v[182:185], v[150:153], v[102:105]
    s_waitcnt lgkmcnt(6)
    v_mfma_f32_16x16x32_bf16 v[106:109], v[130:133], v[186:189], v[106:109]
    s_waitcnt lgkmcnt(4)
    v_mfma_f32_16x16x32_bf16 v[106:109], v[142:145], v[190:193], v[106:109]
    v_mfma_f32_16x16x32_bf16 v[114:117], v[134:137], v[186:189], v[114:117]
    v_mfma_f32_16x16x32_bf16 v[114:117], v[146:149], v[190:193], v[114:117]
    s_waitcnt lgkmcnt(2)
    v_mfma_f32_16x16x32_bf16 v[110:113], v[130:133], v[194:197], v[110:113]
    s_waitcnt lgkmcnt(0)
    s_barrier
    ds_read_b128 v[158:161], v33 offset:32768
    ds_read_b64_tr_b16 v[178:179], v39 offset:32768
    ds_read_b64_tr_b16 v[180:181], v39 offset:33280
    ds_read_b128 v[170:173], v34 offset:32768
    ds_read_b64_tr_b16 v[182:183], v39 offset:36864
    ds_read_b64_tr_b16 v[184:185], v39 offset:37376
    ds_read_b128 v[162:165], v33 offset:34816
    ds_read_b128 v[174:177], v34 offset:34816
    ds_read_b64_tr_b16 v[186:187], v40 offset:32768
    ds_read_b64_tr_b16 v[188:189], v40 offset:33280
    ds_read_b64_tr_b16 v[190:191], v40 offset:36864
    ds_read_b64_tr_b16 v[192:193], v40 offset:37376
    ds_read_b128 v[154:157], v33 offset:30720
    v_mfma_f32_16x16x32_bf16 v[110:113], v[142:145], v[198:201], v[110:113]
    v_mfma_f32_16x16x32_bf16 v[118:121], v[134:137], v[194:197], v[118:121]
    ds_read_b64_tr_b16 v[194:195], v37 offset:0
    v_mfma_f32_16x16x32_bf16 v[118:121], v[146:149], v[198:201], v[118:121]
    ds_read_b64_tr_b16 v[196:197], v37 offset:512
    s_waitcnt lgkmcnt(12)
    v_mfma_f32_16x16x32_bf16 v[66:69], v[178:181], v[158:161], v[66:69]
    ds_read_b128 v[166:169], v34 offset:30720
    s_waitcnt lgkmcnt(10)
    v_mfma_f32_16x16x32_bf16 v[66:69], v[182:185], v[170:173], v[66:69]
    ds_read_b64_tr_b16 v[198:199], v37 offset:4096
    s_waitcnt lgkmcnt(10)
    v_mfma_f32_16x16x32_bf16 v[74:77], v[178:181], v[162:165], v[74:77]
    ds_read_b64_tr_b16 v[200:201], v37 offset:4608
    s_waitcnt lgkmcnt(10)
    v_mfma_f32_16x16x32_bf16 v[74:77], v[182:185], v[174:177], v[74:77]
    ds_read_b64_tr_b16 v[178:179], v38 offset:0
    s_waitcnt lgkmcnt(9)
    v_mfma_f32_16x16x32_bf16 v[70:73], v[186:189], v[158:161], v[70:73]
    ds_read_b64_tr_b16 v[180:181], v38 offset:512
    s_waitcnt lgkmcnt(8)
    v_mfma_f32_16x16x32_bf16 v[70:73], v[190:193], v[170:173], v[70:73]
    ds_read_b64_tr_b16 v[182:183], v38 offset:4096
    v_mfma_f32_16x16x32_bf16 v[78:81], v[186:189], v[162:165], v[78:81]
    ds_read_b64_tr_b16 v[184:185], v38 offset:4608
    v_mfma_f32_16x16x32_bf16 v[78:81], v[190:193], v[174:177], v[78:81]
    ds_read_b64_tr_b16 v[186:187], v37 offset:8192
    s_waitcnt lgkmcnt(8)
    v_mfma_f32_16x16x32_bf16 v[82:85], v[194:197], v[154:157], v[82:85]
    ds_read_b64_tr_b16 v[188:189], v37 offset:8704
    s_waitcnt lgkmcnt(6)
    v_mfma_f32_16x16x32_bf16 v[82:85], v[198:201], v[166:169], v[82:85]
    ds_read_b64_tr_b16 v[190:191], v37 offset:12288
    v_mfma_f32_16x16x32_bf16 v[90:93], v[194:197], v[158:161], v[90:93]
    ds_read_b64_tr_b16 v[192:193], v37 offset:12800
    v_mfma_f32_16x16x32_bf16 v[90:93], v[198:201], v[170:173], v[90:93]
    v_mfma_f32_16x16x32_bf16 v[98:101], v[194:197], v[162:165], v[98:101]
    ds_read_b64_tr_b16 v[194:195], v38 offset:8192
    v_mfma_f32_16x16x32_bf16 v[98:101], v[198:201], v[174:177], v[98:101]
    ds_read_b64_tr_b16 v[196:197], v38 offset:8704
    s_waitcnt lgkmcnt(8)
    v_mfma_f32_16x16x32_bf16 v[86:89], v[178:181], v[154:157], v[86:89]
    ds_read_b64_tr_b16 v[198:199], v38 offset:12288
    s_waitcnt lgkmcnt(7)
    v_mfma_f32_16x16x32_bf16 v[86:89], v[182:185], v[166:169], v[86:89]
    ds_read_b64_tr_b16 v[200:201], v38 offset:12800
    v_mfma_f32_16x16x32_bf16 v[94:97], v[178:181], v[158:161], v[94:97]
    v_mfma_f32_16x16x32_bf16 v[94:97], v[182:185], v[170:173], v[94:97]
    v_mfma_f32_16x16x32_bf16 v[102:105], v[178:181], v[162:165], v[102:105]
    v_mfma_f32_16x16x32_bf16 v[102:105], v[182:185], v[174:177], v[102:105]
    s_waitcnt lgkmcnt(6)
    v_mfma_f32_16x16x32_bf16 v[106:109], v[154:157], v[186:189], v[106:109]
    s_waitcnt lgkmcnt(4)
    v_mfma_f32_16x16x32_bf16 v[106:109], v[166:169], v[190:193], v[106:109]
    v_mfma_f32_16x16x32_bf16 v[114:117], v[158:161], v[186:189], v[114:117]
    v_mfma_f32_16x16x32_bf16 v[114:117], v[170:173], v[190:193], v[114:117]
    s_waitcnt lgkmcnt(2)
    v_mfma_f32_16x16x32_bf16 v[110:113], v[154:157], v[194:197], v[110:113]
    s_waitcnt lgkmcnt(0)
    s_barrier
    ds_read_b128 v[134:137], v35 offset:2048
    ds_read_b64_tr_b16 v[178:179], v37 offset:16384
    ds_read_b64_tr_b16 v[180:181], v37 offset:16896
    ds_read_b128 v[146:149], v36 offset:2048
    ds_read_b64_tr_b16 v[182:183], v37 offset:20480
    ds_read_b64_tr_b16 v[184:185], v37 offset:20992
    ds_read_b128 v[138:141], v35 offset:4096
    ds_read_b128 v[150:153], v36 offset:4096
    ds_read_b64_tr_b16 v[186:187], v38 offset:16384
    ds_read_b64_tr_b16 v[188:189], v38 offset:16896
    ds_read_b64_tr_b16 v[190:191], v38 offset:20480
    ds_read_b64_tr_b16 v[192:193], v38 offset:20992
    ds_read_b128 v[130:133], v35 offset:0
    v_mfma_f32_16x16x32_bf16 v[110:113], v[166:169], v[198:201], v[110:113]
    v_mfma_f32_16x16x32_bf16 v[118:121], v[158:161], v[194:197], v[118:121]
    ds_read_b64_tr_b16 v[194:195], v37 offset:24576
    v_mfma_f32_16x16x32_bf16 v[118:121], v[170:173], v[198:201], v[118:121]
    ds_read_b64_tr_b16 v[196:197], v37 offset:25088
    s_waitcnt lgkmcnt(12)
    v_mfma_f32_16x16x32_bf16 v[66:69], v[178:181], v[134:137], v[66:69]
    ds_read_b128 v[142:145], v36 offset:0
    s_waitcnt lgkmcnt(10)
    v_mfma_f32_16x16x32_bf16 v[66:69], v[182:185], v[146:149], v[66:69]
    ds_read_b64_tr_b16 v[198:199], v37 offset:28672
    s_waitcnt lgkmcnt(10)
    v_mfma_f32_16x16x32_bf16 v[74:77], v[178:181], v[138:141], v[74:77]
    ds_read_b64_tr_b16 v[200:201], v37 offset:29184
    s_waitcnt lgkmcnt(10)
    v_mfma_f32_16x16x32_bf16 v[74:77], v[182:185], v[150:153], v[74:77]
    ds_read_b64_tr_b16 v[178:179], v38 offset:24576
    s_waitcnt lgkmcnt(9)
    v_mfma_f32_16x16x32_bf16 v[70:73], v[186:189], v[134:137], v[70:73]
    ds_read_b64_tr_b16 v[180:181], v38 offset:25088
    s_waitcnt lgkmcnt(8)
    v_mfma_f32_16x16x32_bf16 v[70:73], v[190:193], v[146:149], v[70:73]
    ds_read_b64_tr_b16 v[182:183], v38 offset:28672
    v_mfma_f32_16x16x32_bf16 v[78:81], v[186:189], v[138:141], v[78:81]
    ds_read_b64_tr_b16 v[184:185], v38 offset:29184
    v_mfma_f32_16x16x32_bf16 v[78:81], v[190:193], v[150:153], v[78:81]
    ds_read_b64_tr_b16 v[186:187], v37 offset:32768
    s_waitcnt lgkmcnt(8)
    v_mfma_f32_16x16x32_bf16 v[82:85], v[194:197], v[130:133], v[82:85]
    ds_read_b64_tr_b16 v[188:189], v37 offset:33280
    s_waitcnt lgkmcnt(6)
    v_mfma_f32_16x16x32_bf16 v[82:85], v[198:201], v[142:145], v[82:85]
    ds_read_b64_tr_b16 v[190:191], v37 offset:36864
    v_mfma_f32_16x16x32_bf16 v[90:93], v[194:197], v[134:137], v[90:93]
    ds_read_b64_tr_b16 v[192:193], v37 offset:37376
    v_mfma_f32_16x16x32_bf16 v[90:93], v[198:201], v[146:149], v[90:93]
    v_mfma_f32_16x16x32_bf16 v[98:101], v[194:197], v[138:141], v[98:101]
    ds_read_b64_tr_b16 v[194:195], v38 offset:32768
    v_mfma_f32_16x16x32_bf16 v[98:101], v[198:201], v[150:153], v[98:101]
    ds_read_b64_tr_b16 v[196:197], v38 offset:33280
    s_waitcnt lgkmcnt(8)
    v_mfma_f32_16x16x32_bf16 v[86:89], v[178:181], v[130:133], v[86:89]
    ds_read_b64_tr_b16 v[198:199], v38 offset:36864
    s_waitcnt lgkmcnt(7)
    v_mfma_f32_16x16x32_bf16 v[86:89], v[182:185], v[142:145], v[86:89]
    ds_read_b64_tr_b16 v[200:201], v38 offset:37376
    v_mfma_f32_16x16x32_bf16 v[94:97], v[178:181], v[134:137], v[94:97]
    v_mfma_f32_16x16x32_bf16 v[94:97], v[182:185], v[146:149], v[94:97]
    v_mfma_f32_16x16x32_bf16 v[102:105], v[178:181], v[138:141], v[102:105]
    v_mfma_f32_16x16x32_bf16 v[102:105], v[182:185], v[150:153], v[102:105]
    s_waitcnt lgkmcnt(6)
    v_mfma_f32_16x16x32_bf16 v[106:109], v[130:133], v[186:189], v[106:109]
    s_waitcnt lgkmcnt(4)
    v_mfma_f32_16x16x32_bf16 v[106:109], v[142:145], v[190:193], v[106:109]
    v_mfma_f32_16x16x32_bf16 v[114:117], v[134:137], v[186:189], v[114:117]
    v_mfma_f32_16x16x32_bf16 v[114:117], v[146:149], v[190:193], v[114:117]
    s_waitcnt lgkmcnt(2)
    v_mfma_f32_16x16x32_bf16 v[110:113], v[130:133], v[194:197], v[110:113]
    s_waitcnt lgkmcnt(0)
    s_barrier
    ds_read_b128 v[158:161], v35 offset:12288
    ds_read_b64_tr_b16 v[178:179], v37 offset:40960
    ds_read_b64_tr_b16 v[180:181], v37 offset:41472
    ds_read_b128 v[170:173], v36 offset:12288
    ds_read_b64_tr_b16 v[182:183], v37 offset:45056
    ds_read_b64_tr_b16 v[184:185], v37 offset:45568
    ds_read_b128 v[162:165], v35 offset:14336
    ds_read_b128 v[174:177], v36 offset:14336
    ds_read_b64_tr_b16 v[186:187], v38 offset:40960
    ds_read_b64_tr_b16 v[188:189], v38 offset:41472
    ds_read_b64_tr_b16 v[190:191], v38 offset:45056
    ds_read_b64_tr_b16 v[192:193], v38 offset:45568
    ds_read_b128 v[154:157], v35 offset:10240
    v_mfma_f32_16x16x32_bf16 v[110:113], v[142:145], v[198:201], v[110:113]
    ds_read_b64_tr_b16 v[202:203], v39 offset:0
    v_mfma_f32_16x16x32_bf16 v[118:121], v[134:137], v[194:197], v[118:121]
    ds_read_b64_tr_b16 v[204:205], v39 offset:512
    v_mfma_f32_16x16x32_bf16 v[118:121], v[146:149], v[198:201], v[118:121]
    ds_read_b128 v[166:169], v36 offset:10240
    s_waitcnt lgkmcnt(13)
    v_mfma_f32_16x16x32_bf16 v[66:69], v[178:181], v[158:161], v[66:69]
    ds_read_b64_tr_b16 v[206:207], v39 offset:4096
    s_waitcnt lgkmcnt(11)
    v_mfma_f32_16x16x32_bf16 v[66:69], v[182:185], v[170:173], v[66:69]
    ds_read_b64_tr_b16 v[208:209], v39 offset:4608
    s_waitcnt lgkmcnt(11)
    v_mfma_f32_16x16x32_bf16 v[74:77], v[178:181], v[162:165], v[74:77]
    ds_read_b64_tr_b16 v[194:195], v40 offset:0
    s_waitcnt lgkmcnt(11)
    v_mfma_f32_16x16x32_bf16 v[74:77], v[182:185], v[174:177], v[74:77]
    ds_read_b64_tr_b16 v[196:197], v40 offset:512
    s_waitcnt lgkmcnt(10)
    v_mfma_f32_16x16x32_bf16 v[70:73], v[186:189], v[158:161], v[70:73]
    ds_read_b64_tr_b16 v[198:199], v40 offset:4096
    s_waitcnt lgkmcnt(9)
    v_mfma_f32_16x16x32_bf16 v[70:73], v[190:193], v[170:173], v[70:73]
    ds_read_b64_tr_b16 v[200:201], v40 offset:4608
    v_mfma_f32_16x16x32_bf16 v[78:81], v[186:189], v[162:165], v[78:81]
    v_mfma_f32_16x16x32_bf16 v[78:81], v[190:193], v[174:177], v[78:81]
    s_waitcnt lgkmcnt(7)
    v_mfma_f32_16x16x32_bf16 v[82:85], v[202:205], v[154:157], v[82:85]
    s_waitcnt lgkmcnt(4)
    v_mfma_f32_16x16x32_bf16 v[82:85], v[206:209], v[166:169], v[82:85]
    v_mfma_f32_16x16x32_bf16 v[90:93], v[202:205], v[158:161], v[90:93]
    v_mfma_f32_16x16x32_bf16 v[90:93], v[206:209], v[170:173], v[90:93]
    v_mfma_f32_16x16x32_bf16 v[98:101], v[202:205], v[162:165], v[98:101]
    v_mfma_f32_16x16x32_bf16 v[98:101], v[206:209], v[174:177], v[98:101]
    s_waitcnt lgkmcnt(2)
    v_mfma_f32_16x16x32_bf16 v[86:89], v[194:197], v[154:157], v[86:89]
    s_waitcnt lgkmcnt(0)
    v_mfma_f32_16x16x32_bf16 v[86:89], v[198:201], v[166:169], v[86:89]
    v_mfma_f32_16x16x32_bf16 v[94:97], v[194:197], v[158:161], v[94:97]
    v_mfma_f32_16x16x32_bf16 v[94:97], v[198:201], v[170:173], v[94:97]
    v_mfma_f32_16x16x32_bf16 v[102:105], v[194:197], v[162:165], v[102:105]
    s_barrier
    ds_read_b128 v[134:137], v35 offset:22528
    ds_read_b64_tr_b16 v[178:179], v39 offset:8192
    ds_read_b64_tr_b16 v[180:181], v39 offset:8704
    ds_read_b128 v[146:149], v36 offset:22528
    ds_read_b64_tr_b16 v[182:183], v39 offset:12288
    ds_read_b64_tr_b16 v[184:185], v39 offset:12800
    ds_read_b128 v[138:141], v35 offset:24576
    ds_read_b128 v[150:153], v36 offset:24576
    ds_read_b64_tr_b16 v[186:187], v40 offset:8192
    ds_read_b64_tr_b16 v[188:189], v40 offset:8704
    ds_read_b64_tr_b16 v[190:191], v40 offset:12288
    ds_read_b64_tr_b16 v[192:193], v40 offset:12800
    ds_read_b128 v[130:133], v35 offset:20480
    v_mfma_f32_16x16x32_bf16 v[102:105], v[198:201], v[174:177], v[102:105]
    ds_read_b128 v[142:145], v36 offset:20480
    s_waitcnt lgkmcnt(11)
    v_mfma_f32_16x16x32_bf16 v[66:69], v[178:181], v[134:137], v[66:69]
    s_barrier
    ds_read_b64_tr_b16 v[202:203], v39 offset:16384
    ds_read_b64_tr_b16 v[204:205], v39 offset:16896
    ds_read_b64_tr_b16 v[206:207], v39 offset:20480
    ds_read_b64_tr_b16 v[208:209], v39 offset:20992
    ds_read_b64_tr_b16 v[194:195], v40 offset:16384
    s_waitcnt lgkmcnt(13)
    v_mfma_f32_16x16x32_bf16 v[66:69], v[182:185], v[146:149], v[66:69]
    ds_read_b64_tr_b16 v[196:197], v40 offset:16896
    s_waitcnt lgkmcnt(13)
    v_mfma_f32_16x16x32_bf16 v[74:77], v[178:181], v[138:141], v[74:77]
    ds_read_b64_tr_b16 v[198:199], v40 offset:20480
    s_waitcnt lgkmcnt(13)
    v_mfma_f32_16x16x32_bf16 v[74:77], v[182:185], v[150:153], v[74:77]
    ds_read_b64_tr_b16 v[200:201], v40 offset:20992
    s_waitcnt lgkmcnt(12)
    v_mfma_f32_16x16x32_bf16 v[70:73], v[186:189], v[134:137], v[70:73]
    v_cvt_pk_bf16_f32 v154, v66, v67
    v_cvt_pk_bf16_f32 v155, v68, v69
    s_waitcnt lgkmcnt(10)
    v_mfma_f32_16x16x32_bf16 v[70:73], v[190:193], v[146:149], v[70:73]
    v_cndmask_b32 v162, 0, v154, s[54:55]
    v_cndmask_b32 v154, v154, 0, s[54:55]
    v_mfma_f32_16x16x32_bf16 v[78:81], v[186:189], v[138:141], v[78:81]
    v_cndmask_b32 v163, 0, v155, s[54:55]
    v_cndmask_b32 v155, v155, 0, s[54:55]
    v_mfma_f32_16x16x32_bf16 v[78:81], v[190:193], v[150:153], v[78:81]
    v_cvt_pk_bf16_f32 v158, v74, v75
    v_cvt_pk_bf16_f32 v159, v76, v77
    s_waitcnt lgkmcnt(6)
    v_mfma_f32_16x16x32_bf16 v[98:101], v[202:205], v[138:141], v[98:101]
    v_cndmask_b32 v166, 0, v158, s[54:55]
    v_cndmask_b32 v158, v158, 0, s[54:55]
    s_waitcnt lgkmcnt(4)
    v_mfma_f32_16x16x32_bf16 v[98:101], v[206:209], v[150:153], v[98:101]
    v_cndmask_b32 v167, 0, v159, s[54:55]
    v_cndmask_b32 v159, v159, 0, s[54:55]
    s_waitcnt lgkmcnt(2)
    v_mfma_f32_16x16x32_bf16 v[102:105], v[194:197], v[138:141], v[102:105]
    v_cvt_pk_bf16_f32 v156, v70, v71
    v_cvt_pk_bf16_f32 v157, v72, v73
    s_waitcnt lgkmcnt(0)
    v_mfma_f32_16x16x32_bf16 v[102:105], v[198:201], v[150:153], v[102:105]
    v_cndmask_b32 v164, 0, v156, s[56:57]
    v_cndmask_b32 v156, v156, 0, s[56:57]
    v_mfma_f32_16x16x32_bf16 v[82:85], v[202:205], v[130:133], v[82:85]
    v_cndmask_b32 v165, 0, v157, s[56:57]
    v_cndmask_b32 v157, v157, 0, s[56:57]
    v_mfma_f32_16x16x32_bf16 v[82:85], v[206:209], v[142:145], v[82:85]
    v_cvt_pk_bf16_f32 v160, v78, v79
    v_cvt_pk_bf16_f32 v161, v80, v81
    v_mfma_f32_16x16x32_bf16 v[86:89], v[194:197], v[130:133], v[86:89]
    v_cndmask_b32 v168, 0, v160, s[56:57]
    v_cndmask_b32 v160, v160, 0, s[56:57]
    v_mfma_f32_16x16x32_bf16 v[86:89], v[198:201], v[142:145], v[86:89]
    v_cndmask_b32 v169, 0, v161, s[56:57]
    v_cndmask_b32 v161, v161, 0, s[56:57]
    v_mfma_f32_16x16x32_bf16 v[90:93], v[202:205], v[134:137], v[90:93]
    v_cvt_pk_bf16_f32 v238, v98, v99
    v_cvt_pk_bf16_f32 v239, v100, v101
    v_mfma_f32_16x16x32_bf16 v[90:93], v[206:209], v[146:149], v[90:93]
    v_cvt_pk_bf16_f32 v240, v102, v103
    v_cvt_pk_bf16_f32 v241, v104, v105
    v_mfma_f32_16x16x32_bf16 v[94:97], v[194:197], v[134:137], v[94:97]
    ds_write_b128 v222, v[238:241]
    ds_write_b32 v224, v5 offset:56
    v_mfma_f32_16x16x32_bf16 v[94:97], v[198:201], v[146:149], v[94:97]
    ds_read_b32 v45, v5 offset:4
    v_cvt_pk_bf16_f32 v230, v82, v83
    v_cvt_pk_bf16_f32 v231, v84, v85
    v_cvt_pk_bf16_f32 v232, v86, v87
    v_cvt_pk_bf16_f32 v233, v88, v89
    s_nop 1
    v_mfma_f32_16x16x32_bf16 v[66:69], v[230:233], v[154:157], 0
    v_mfma_f32_16x16x32_bf16 v[78:81], v[238:241], v[158:161], 0
    v_cvt_pk_bf16_f32 v234, v90, v91
    v_cvt_pk_bf16_f32 v235, v92, v93
    v_cvt_pk_bf16_f32 v236, v94, v95
    v_cvt_pk_bf16_f32 v237, v96, v97
    s_nop 1
    v_mfma_f32_16x16x32_bf16 v[70:73], v[234:237], v[154:157], 0
    v_mfma_f32_16x16x32_bf16 v[74:77], v[234:237], v[158:161], 0
    v_mfma_f32_16x16x32_bf16 v[178:181], v[230:233], v[162:165], 0
    v_mfma_f32_16x16x32_bf16 v[182:185], v[234:237], v[162:165], 0
    s_waitcnt lgkmcnt(0)
    v_readfirstlane_b32 s63, v45
    s_nop 2
    v_cndmask_b32 v70, v70, v71, s[44:45]
    v_cndmask_b32 v72, v72, v73, s[44:45]
    v_cndmask_b32 v66, v66, v67, s[44:45]
    v_cndmask_b32 v68, v68, v69, s[44:45]
    v_cndmask_b32 v66, v66, v50, s[50:51]
    v_cndmask_b32 v68, v68, v50, s[50:51]
    v_cndmask_b32 v214, v66, v70, s[46:47]
    v_cndmask_b32 v215, v68, v72, s[48:49]
    v_cndmask_b32 v78, v78, v79, s[44:45]
    v_cndmask_b32 v80, v80, v81, s[44:45]
    v_cndmask_b32 v74, v74, v75, s[44:45]
    v_cndmask_b32 v76, v76, v77, s[44:45]
    v_cndmask_b32 v216, v74, v78, s[46:47]
    v_cndmask_b32 v217, v76, v80, s[48:49]
    v_and_or_b32 v98, v214, v51, v54
    v_and_or_b32 v99, v215, v51, v55
    v_and_or_b32 v100, v216, v51, v56
    v_and_or_b32 v101, v217, v51, v57
    s_sub_u32 s63, s63, 1
    s_cbranch_scc1 C_mr0
C_md0:
    s_cmp_lg_u32 s101, 0
    s_cbranch_scc1 SM_jS0
    s_cmp_eq_u32 s63, 0
    s_cbranch_scc1 SM_sS0
    buffer_store_dwordx4 v[98:101], v4, s[36:39], s15 offen
SM_jS0:
    v_mfma_f32_16x16x32_bf16 v[186:189], v[234:237], v[166:169], 0
    v_mfma_f32_16x16x32_bf16 v[190:193], v[238:241], v[166:169], 0
    ds_read_b32 v45, v5 offset:32
    ds_read_b64_tr_b16 v[170:171], v39 offset:32768
    ds_read_b64_tr_b16 v[172:173], v39 offset:33280
    ds_read_b64_tr_b16 v[174:175], v40 offset:32768
    ds_read_b64_tr_b16 v[176:177], v40 offset:33280
    ds_read_b64_tr_b16 v[202:203], v39 offset:36864
    ds_read_b64_tr_b16 v[204:205], v39 offset:37376
    ds_read_b64_tr_b16 v[206:207], v40 offset:36864
    ds_read_b64_tr_b16 v[208:209], v40 offset:37376
    v_cndmask_b32 v182, v182, v183, s[44:45]
    v_cndmask_b32 v184, v184, v185, s[44:45]
    v_cndmask_b32 v178, v178, v179, s[44:45]
    v_cndmask_b32 v180, v180, v181, s[44:45]
    v_cndmask_b32 v178, v178, v50, s[50:51]
    v_cndmask_b32 v180, v180, v50, s[50:51]
    v_cndmask_b32 v210, v178, v182, s[46:47]
    v_cndmask_b32 v211, v180, v184, s[48:49]
    v_cndmask_b32 v190, v190, v191, s[44:45]
    v_cndmask_b32 v192, v192, v193, s[44:45]
    v_cndmask_b32 v186, v186, v187, s[44:45]
    v_cndmask_b32 v188, v188, v189, s[44:45]
    v_cndmask_b32 v212, v186, v190, s[46:47]
    v_cndmask_b32 v213, v188, v192, s[48:49]
    ds_write_b128 v47, v[210:213]
    ds_write_b32 v52, v5 offset:16
    s_waitcnt lgkmcnt(10)
    v_cmp_gt_u32 vcc, 4, v45
    s_nop 0
    s_cbranch_vccnz C_vr0
C_vd0:
    s_waitcnt lgkmcnt(8)
    v_mfma_f32_16x16x32_bf16 v[106:109], v[130:133], v[170:173], v[106:109]
    ds_read_b128 v[154:157], v35 offset:10240
    ds_read_b64_tr_b16 v[186:187], v39 offset:24576
    s_waitcnt lgkmcnt(6)
    v_mfma_f32_16x16x32_bf16 v[106:109], v[142:145], v[202:205], v[106:109]
    ds_read_b64_tr_b16 v[188:189], v39 offset:25088
    ds_read_b128 v[166:169], v36 offset:10240
    v_mfma_f32_16x16x32_bf16 v[114:117], v[134:137], v[170:173], v[114:117]
    ds_read_b64_tr_b16 v[194:195], v39 offset:28672
    ds_read_b64_tr_b16 v[196:197], v39 offset:29184
    v_mfma_f32_16x16x32_bf16 v[114:117], v[146:149], v[202:205], v[114:117]
    ds_read_b64_tr_b16 v[190:191], v40 offset:24576
    ds_read_b64_tr_b16 v[192:193], v40 offset:25088
    v_mfma_f32_16x16x32_bf16 v[110:113], v[130:133], v[174:177], v[110:113]
    ds_read_b64_tr_b16 v[198:199], v40 offset:28672
    ds_read_b64_tr_b16 v[200:201], v40 offset:29184
    s_waitcnt lgkmcnt(12)
    v_mfma_f32_16x16x32_bf16 v[110:113], v[142:145], v[206:209], v[110:113]
    ds_read_b128 v[158:161], v35 offset:12288
    ds_read_b128 v[178:181], v36 offset:12288
    v_mfma_f32_16x16x32_bf16 v[118:121], v[134:137], v[174:177], v[118:121]
    v_mfma_f32_16x16x32_bf16 v[118:121], v[146:149], v[206:209], v[118:121]
    s_waitcnt lgkmcnt(9)
    v_mfma_f32_16x16x32_bf16 v[106:109], v[154:157], v[186:189], v[106:109]
    s_waitcnt lgkmcnt(6)
    v_mfma_f32_16x16x32_bf16 v[106:109], v[166:169], v[194:197], v[106:109]
    s_waitcnt lgkmcnt(4)
    v_mfma_f32_16x16x32_bf16 v[110:113], v[154:157], v[190:193], v[110:113]
    s_waitcnt lgkmcnt(2)
    v_mfma_f32_16x16x32_bf16 v[110:113], v[166:169], v[198:201], v[110:113]
    s_waitcnt lgkmcnt(1)
    v_mfma_f32_16x16x32_bf16 v[114:117], v[158:161], v[186:189], v[114:117]
    s_nop 1
    v_cvt_pk_bf16_f32 v230, v106, v107
    v_cvt_pk_bf16_f32 v231, v108, v109
    s_waitcnt lgkmcnt(0)
    v_mfma_f32_16x16x32_bf16 v[114:117], v[178:181], v[194:197], v[114:117]
    v_mfma_f32_16x16x32_bf16 v[118:121], v[158:161], v[190:193], v[118:121]
    v_cvt_pk_bf16_f32 v236, v110, v111
    v_cvt_pk_bf16_f32 v237, v112, v113
    v_mfma_f32_16x16x32_bf16 v[118:121], v[178:181], v[198:201], v[118:121]
    ds_read_b32 v53, v225 offset:68
    ds_read_b64 v[234:235], v223 offset:0
    ds_read_b64 v[240:241], v223 offset:8
    v_cndmask_b32 v130, 0, v230, s[58:59]
    v_cndmask_b32 v230, v230, 0, s[58:59]
    v_cndmask_b32 v131, 0, v231, s[58:59]
    v_cndmask_b32 v231, v231, 0, s[58:59]
    buffer_load_dwordx4 v[218:221], v4, s[36:39], s100 offen sc1
    v_cvt_pk_bf16_f32 v232, v114, v115
    v_cvt_pk_bf16_f32 v233, v116, v117
    v_cvt_pk_bf16_f32 v238, v118, v119
    v_cvt_pk_bf16_f32 v239, v120, v121
    v_cndmask_b32 v136, 0, v236, s[60:61]
    v_cndmask_b32 v236, v236, 0, s[60:61]
    v_cndmask_b32 v137, 0, v237, s[60:61]
    v_cndmask_b32 v237, v237, 0, s[60:61]
    v_cndmask_b32 v132, 0, v232, s[58:59]
    v_cndmask_b32 v232, v232, 0, s[58:59]
    v_cndmask_b32 v133, 0, v233, s[58:59]
    v_cndmask_b32 v233, v233, 0, s[58:59]
    v_cndmask_b32 v138, 0, v238, s[60:61]
    v_cndmask_b32 v238, v238, 0, s[60:61]
    v_cndmask_b32 v139, 0, v239, s[60:61]
    v_cndmask_b32 v239, v239, 0, s[60:61]
    s_waitcnt lgkmcnt(0)
    v_cmp_ne_u32 vcc, 0, v53
    s_nop 0
    s_cbranch_vccnz D_dV0
    s_mov_b32 s9, 0
D_lV0:
    ds_read_b32 v53, v225 offset:68
    ds_read_b64 v[234:235], v223 offset:0
    ds_read_b64 v[240:241], v223 offset:8
    s_add_u32 s9, s9, 1
    s_cmp_gt_u32 s9, 1600000
    s_waitcnt lgkmcnt(0)
    s_cbranch_scc1 D_dV0
    v_cmp_eq_u32 vcc, 0, v53
    s_nop 0
    s_cbranch_vccnz D_lV0
D_dV0:
    v_cndmask_b32 v134, 0, v234, s[58:59]
    v_cndmask_b32 v234, v234, 0, s[58:59]
    v_cndmask_b32 v135, 0, v235, s[58:59]
    v_cndmask_b32 v235, v235, 0, s[58:59]
    v_cndmask_b32 v140, 0, v240, s[60:61]
    v_cndmask_b32 v240, v240, 0, s[60:61]
    v_cndmask_b32 v141, 0, v241, s[60:61]
    v_cndmask_b32 v241, v241, 0, s[60:61]
    s_branch C_join
C_tp1:
    s_barrier
    ds_read_b128 v[134:137], v33 offset:2048
    ds_read_b64_tr_b16 v[178:179], v37 offset:8192
    ds_read_b64_tr_b16 v[180:181], v37 offset:8704
    ds_read_b128 v[146:149], v34 offset:2048
    ds_read_b64_tr_b16 v[182:183], v37 offset:12288
    ds_read_b64_tr_b16 v[184:185], v37 offset:12800
    ds_read_b128 v[138:141], v33 offset:4096
    ds_read_b128 v[150:153], v34 offset:4096
    ds_read_b64_tr_b16 v[186:187], v38 offset:8192
    ds_read_b64_tr_b16 v[188:189], v38 offset:8704
    ds_read_b64_tr_b16 v[190:191], v38 offset:12288
    ds_read_b64_tr_b16 v[192:193], v38 offset:12800
    s_waitcnt lgkmcnt(9)
    v_mfma_f32_16x16x32_bf16 v[66:69], v[178:181], v[134:137], 0
    ds_read_b64_tr_b16 v[194:195], v37 offset:16384
    s_waitcnt lgkmcnt(7)
    v_mfma_f32_16x16x32_bf16 v[66:69], v[182:185], v[146:149], v[66:69]
    ds_read_b64_tr_b16 v[196:197], v37 offset:16896
    s_waitcnt lgkmcnt(7)
    v_mfma_f32_16x16x32_bf16 v[74:77], v[178:181], v[138:141], 0
    ds_read_b64_tr_b16 v[198:199], v37 offset:20480
    ds_read_b64_tr_b16 v[200:201], v37 offset:20992
    s_waitcnt lgkmcnt(8)
    v_mfma_f32_16x16x32_bf16 v[74:77], v[182:185], v[150:153], v[74:77]
    ds_read_b64_tr_b16 v[178:179], v38 offset:16384
    s_waitcnt lgkmcnt(7)
    v_mfma_f32_16x16x32_bf16 v[70:73], v[186:189], v[134:137], 0
    ds_read_b64_tr_b16 v[180:181], v38 offset:16896
    s_waitcnt lgkmcnt(6)
    v_mfma_f32_16x16x32_bf16 v[70:73], v[190:193], v[146:149], v[70:73]
    ds_read_b64_tr_b16 v[182:183], v38 offset:20480
    v_mfma_f32_16x16x32_bf16 v[78:81], v[186:189], v[138:141], 0
    ds_read_b64_tr_b16 v[184:185], v38 offset:20992
    v_mfma_f32_16x16x32_bf16 v[78:81], v[190:193], v[150:153], v[78:81]
    ds_read_b128 v[130:133], v33 offset:0
    s_waitcnt lgkmcnt(7)
    v_mfma_f32_16x16x32_bf16 v[90:93], v[194:197], v[134:137], 0
    ds_read_b64_tr_b16 v[186:187], v37 offset:24576
    s_waitcnt lgkmcnt(6)
    v_mfma_f32_16x16x32_bf16 v[90:93], v[198:201], v[146:149], v[90:93]
    ds_read_b64_tr_b16 v[188:189], v37 offset:25088
    v_mfma_f32_16x16x32_bf16 v[98:101], v[194:197], v[138:141], 0
    ds_read_b128 v[142:145], v34 offset:0
    ds_read_b64_tr_b16 v[190:191], v37 offset:28672
    v_mfma_f32_16x16x32_bf16 v[98:101], v[198:201], v[150:153], v[98:101]
    ds_read_b64_tr_b16 v[192:193], v37 offset:29184
    s_waitcnt lgkmcnt(8)
    v_mfma_f32_16x16x32_bf16 v[94:97], v[178:181], v[134:137], 0
    ds_read_b64_tr_b16 v[194:195], v38 offset:24576
    s_waitcnt lgkmcnt(7)
    v_mfma_f32_16x16x32_bf16 v[94:97], v[182:185], v[146:149], v[94:97]
    ds_read_b64_tr_b16 v[196:197], v38 offset:25088
    v_mfma_f32_16x16x32_bf16 v[102:105], v[178:181], v[138:141], 0
    ds_read_b64_tr_b16 v[198:199], v38 offset:28672
    v_mfma_f32_16x16x32_bf16 v[102:105], v[182:185], v[150:153], v[102:105]
    ds_read_b64_tr_b16 v[200:201], v38 offset:29184
    s_waitcnt lgkmcnt(7)
    v_mfma_f32_16x16x32_bf16 v[106:109], v[130:133], v[186:189], 0
    s_waitcnt lgkmcnt(4)
    v_mfma_f32_16x16x32_bf16 v[106:109], v[142:145], v[190:193], v[106:109]
    v_mfma_f32_16x16x32_bf16 v[114:117], v[134:137], v[186:189], 0
    v_mfma_f32_16x16x32_bf16 v[114:117], v[146:149], v[190:193], v[114:117]
    v_mfma_f32_16x16x32_bf16 v[122:125], v[138:141], v[186:189], 0
    v_mfma_f32_16x16x32_bf16 v[122:125], v[150:153], v[190:193], v[122:125]
    s_waitcnt lgkmcnt(2)
    v_mfma_f32_16x16x32_bf16 v[110:113], v[130:133], v[194:197], 0
    s_waitcnt lgkmcnt(0)
    v_mfma_f32_16x16x32_bf16 v[110:113], v[142:145], v[198:201], v[110:113]
    v_mfma_f32_16x16x32_bf16 v[118:121], v[134:137], v[194:197], 0
    s_barrier
    ds_read_b128 v[158:161], v33 offset:12288
    ds_read_b64_tr_b16 v[178:179], v37 offset:32768
    ds_read_b64_tr_b16 v[180:181], v37 offset:33280
    ds_read_b128 v[170:173], v34 offset:12288
    ds_read_b64_tr_b16 v[182:183], v37 offset:36864
    ds_read_b64_tr_b16 v[184:185], v37 offset:37376
    ds_read_b128 v[162:165], v33 offset:14336
    ds_read_b128 v[174:177], v34 offset:14336
    ds_read_b64_tr_b16 v[186:187], v38 offset:32768
    ds_read_b64_tr_b16 v[188:189], v38 offset:33280
    ds_read_b64_tr_b16 v[190:191], v38 offset:36864
    ds_read_b64_tr_b16 v[192:193], v38 offset:37376
    v_mfma_f32_16x16x32_bf16 v[118:121], v[146:149], v[198:201], v[118:121]
    v_mfma_f32_16x16x32_bf16 v[126:129], v[138:141], v[194:197], 0
    ds_read_b64_tr_b16 v[194:195], v37 offset:40960
    v_mfma_f32_16x16x32_bf16 v[126:129], v[150:153], v[198:201], v[126:129]
    ds_read_b64_tr_b16 v[196:197], v37 offset:41472
    s_waitcnt lgkmcnt(11)
    v_mfma_f32_16x16x32_bf16 v[66:69], v[178:181], v[158:161], v[66:69]
    ds_read_b64_tr_b16 v[198:199], v37 offset:45056
    s_waitcnt lgkmcnt(9)
    v_mfma_f32_16x16x32_bf16 v[66:69], v[182:185], v[170:173], v[66:69]
    ds_read_b64_tr_b16 v[200:201], v37 offset:45568
    s_waitcnt lgkmcnt(9)
    v_mfma_f32_16x16x32_bf16 v[74:77], v[178:181], v[162:165], v[74:77]
    ds_read_b64_tr_b16 v[178:179], v38 offset:40960
    s_waitcnt lgkmcnt(9)
    v_mfma_f32_16x16x32_bf16 v[74:77], v[182:185], v[174:177], v[74:77]
    ds_read_b64_tr_b16 v[180:181], v38 offset:41472
    s_waitcnt lgkmcnt(8)
    v_mfma_f32_16x16x32_bf16 v[70:73], v[186:189], v[158:161], v[70:73]
    ds_read_b64_tr_b16 v[182:183], v38 offset:45056
    s_waitcnt lgkmcnt(7)
    v_mfma_f32_16x16x32_bf16 v[70:73], v[190:193], v[170:173], v[70:73]
    ds_read_b64_tr_b16 v[184:185], v38 offset:45568
    v_mfma_f32_16x16x32_bf16 v[78:81], v[186:189], v[162:165], v[78:81]
    ds_read_b128 v[154:157], v33 offset:10240
    v_mfma_f32_16x16x32_bf16 v[78:81], v[190:193], v[174:177], v[78:81]
    ds_read_b64_tr_b16 v[186:187], v39 offset:0
    s_waitcnt lgkmcnt(8)
    v_mfma_f32_16x16x32_bf16 v[90:93], v[194:197], v[158:161], v[90:93]
    ds_read_b64_tr_b16 v[188:189], v39 offset:512
    s_waitcnt lgkmcnt(7)
    v_mfma_f32_16x16x32_bf16 v[90:93], v[198:201], v[170:173], v[90:93]
    ds_read_b128 v[166:169], v34 offset:10240
    v_mfma_f32_16x16x32_bf16 v[98:101], v[194:197], v[162:165], v[98:101]
    ds_read_b64_tr_b16 v[190:191], v39 offset:4096
    ds_read_b64_tr_b16 v[192:193], v39 offset:4608
    v_mfma_f32_16x16x32_bf16 v[98:101], v[198:201], v[174:177], v[98:101]
    ds_read_b64_tr_b16 v[194:195], v40 offset:0
    s_waitcnt lgkmcnt(9)
    v_mfma_f32_16x16x32_bf16 v[94:97], v[178:181], v[158:161], v[94:97]
    ds_read_b64_tr_b16 v[196:197], v40 offset:512
    s_waitcnt lgkmcnt(8)
    v_mfma_f32_16x16x32_bf16 v[94:97], v[182:185], v[170:173], v[94:97]
    ds_read_b64_tr_b16 v[198:199], v40 offset:4096
    v_mfma_f32_16x16x32_bf16 v[102:105], v[178:181], v[162:165], v[102:105]
    ds_read_b64_tr_b16 v[200:201], v40 offset:4608
    v_mfma_f32_16x16x32_bf16 v[102:105], v[182:185], v[174:177], v[102:105]
    s_waitcnt lgkmcnt(7)
    v_mfma_f32_16x16x32_bf16 v[106:109], v[154:157], v[186:189], v[106:109]
    s_waitcnt lgkmcnt(4)
    v_mfma_f32_16x16x32_bf16 v[106:109], v[166:169], v[190:193], v[106:109]
    v_mfma_f32_16x16x32_bf16 v[114:117], v[158:161], v[186:189], v[114:117]
    v_mfma_f32_16x16x32_bf16 v[114:117], v[170:173], v[190:193], v[114:117]
    v_mfma_f32_16x16x32_bf16 v[122:125], v[162:165], v[186:189], v[122:125]
    v_mfma_f32_16x16x32_bf16 v[122:125], v[174:177], v[190:193], v[122:125]
    s_waitcnt lgkmcnt(2)
    v_mfma_f32_16x16x32_bf16 v[110:113], v[154:157], v[194:197], v[110:113]
    s_waitcnt lgkmcnt(0)
    v_mfma_f32_16x16x32_bf16 v[110:113], v[166:169], v[198:201], v[110:113]
    v_mfma_f32_16x16x32_bf16 v[118:121], v[158:161], v[194:197], v[118:121]
    s_barrier
    ds_read_b128 v[134:137], v33 offset:22528
    ds_read_b64_tr_b16 v[178:179], v39 offset:8192
    ds_read_b64_tr_b16 v[180:181], v39 offset:8704
    ds_read_b128 v[146:149], v34 offset:22528
    ds_read_b64_tr_b16 v[182:183], v39 offset:12288
    ds_read_b64_tr_b16 v[184:185], v39 offset:12800
    ds_read_b128 v[138:141], v33 offset:24576
    ds_read_b128 v[150:153], v34 offset:24576
    ds_read_b64_tr_b16 v[186:187], v40 offset:8192
    ds_read_b64_tr_b16 v[188:189], v40 offset:8704
    ds_read_b64_tr_b16 v[190:191], v40 offset:12288
    ds_read_b64_tr_b16 v[192:193], v40 offset:12800
    v_mfma_f32_16x16x32_bf16 v[118:121], v[170:173], v[198:201], v[118:121]
    v_mfma_f32_16x16x32_bf16 v[126:129], v[162:165], v[194:197], v[126:129]
    ds_read_b64_tr_b16 v[194:195], v39 offset:16384
    v_mfma_f32_16x16x32_bf16 v[126:129], v[174:177], v[198:201], v[126:129]
    ds_read_b64_tr_b16 v[196:197], v39 offset:16896
    s_waitcnt lgkmcnt(11)
    v_mfma_f32_16x16x32_bf16 v[66:69], v[178:181], v[134:137], v[66:69]
    ds_read_b64_tr_b16 v[198:199], v39 offset:20480
    s_waitcnt lgkmcnt(9)
    v_mfma_f32_16x16x32_bf16 v[66:69], v[182:185], v[146:149], v[66:69]
    ds_read_b64_tr_b16 v[200:201], v39 offset:20992
    s_waitcnt lgkmcnt(9)
    v_mfma_f32_16x16x32_bf16 v[74:77], v[178:181], v[138:141], v[74:77]
    ds_read_b64_tr_b16 v[178:179], v40 offset:16384
    s_waitcnt lgkmcnt(9)
    v_mfma_f32_16x16x32_bf16 v[74:77], v[182:185], v[150:153], v[74:77]
    ds_read_b64_tr_b16 v[180:181], v40 offset:16896
    s_waitcnt lgkmcnt(8)
    v_mfma_f32_16x16x32_bf16 v[70:73], v[186:189], v[134:137], v[70:73]
    ds_read_b64_tr_b16 v[182:183], v40 offset:20480
    s_waitcnt lgkmcnt(7)
    v_mfma_f32_16x16x32_bf16 v[70:73], v[190:193], v[146:149], v[70:73]
    ds_read_b64_tr_b16 v[184:185], v40 offset:20992
    v_mfma_f32_16x16x32_bf16 v[78:81], v[186:189], v[138:141], v[78:81]
    ds_read_b128 v[130:133], v33 offset:20480
    v_mfma_f32_16x16x32_bf16 v[78:81], v[190:193], v[150:153], v[78:81]
    ds_read_b64_tr_b16 v[186:187], v39 offset:24576
    s_waitcnt lgkmcnt(8)
    v_mfma_f32_16x16x32_bf16 v[90:93], v[194:197], v[134:137], v[90:93]
    ds_read_b64_tr_b16 v[188:189], v39 offset:25088
    s_waitcnt lgkmcnt(7)
    v_mfma_f32_16x16x32_bf16 v[90:93], v[198:201], v[146:149], v[90:93]
    ds_read_b128 v[142:145], v34 offset:20480
    v_mfma_f32_16x16x32_bf16 v[98:101], v[194:197], v[138:141], v[98:101]
    ds_read_b64_tr_b16 v[190:191], v39 offset:28672
    ds_read_b64_tr_b16 v[192:193], v39 offset:29184
    v_mfma_f32_16x16x32_bf16 v[98:101], v[198:201], v[150:153], v[98:101]
    ds_read_b64_tr_b16 v[194:195], v40 offset:24576
    s_waitcnt lgkmcnt(9)
    v_mfma_f32_16x16x32_bf16 v[94:97], v[178:181], v[134:137], v[94:97]
    ds_read_b64_tr_b16 v[196:197], v40 offset:25088
    s_waitcnt lgkmcnt(8)
    v_mfma_f32_16x16x32_bf16 v[94:97], v[182:185], v[146:149], v[94:97]
    ds_read_b64_tr_b16 v[198:199], v40 offset:28672
    v_mfma_f32_16x16x32_bf16 v[102:105], v[178:181], v[138:141], v[102:105]
    ds_read_b64_tr_b16 v[200:201], v40 offset:29184
    v_mfma_f32_16x16x32_bf16 v[102:105], v[182:185], v[150:153], v[102:105]
    s_waitcnt lgkmcnt(7)
    v_mfma_f32_16x16x32_bf16 v[106:109], v[130:133], v[186:189], v[106:109]
    s_waitcnt lgkmcnt(4)
    v_mfma_f32_16x16x32_bf16 v[106:109], v[142:145], v[190:193], v[106:109]
    v_mfma_f32_16x16x32_bf16 v[114:117], v[134:137], v[186:189], v[114:117]
    v_mfma_f32_16x16x32_bf16 v[114:117], v[146:149], v[190:193], v[114:117]
    v_mfma_f32_16x16x32_bf16 v[122:125], v[138:141], v[186:189], v[122:125]
    v_mfma_f32_16x16x32_bf16 v[122:125], v[150:153], v[190:193], v[122:125]
    s_waitcnt lgkmcnt(2)
    v_mfma_f32_16x16x32_bf16 v[110:113], v[130:133], v[194:197], v[110:113]
    s_waitcnt lgkmcnt(0)
    v_mfma_f32_16x16x32_bf16 v[110:113], v[142:145], v[198:201], v[110:113]
    v_mfma_f32_16x16x32_bf16 v[118:121], v[134:137], v[194:197], v[118:121]
    s_barrier
    ds_read_b128 v[158:161], v33 offset:32768
    ds_read_b64_tr_b16 v[178:179], v39 offset:32768
    ds_read_b64_tr_b16 v[180:181], v39 offset:33280
    ds_read_b128 v[170:173], v34 offset:32768
    ds_read_b64_tr_b16 v[182:183], v39 offset:36864
    ds_read_b64_tr_b16 v[184:185], v39 offset:37376
    ds_read_b128 v[162:165], v33 offset:34816
    ds_read_b128 v[174:177], v34 offset:34816
    ds_read_b64_tr_b16 v[186:187], v40 offset:32768
    ds_read_b64_tr_b16 v[188:189], v40 offset:33280
    ds_read_b64_tr_b16 v[190:191], v40 offset:36864
    ds_read_b64_tr_b16 v[192:193], v40 offset:37376
    v_mfma_f32_16x16x32_bf16 v[118:121], v[146:149], v[198:201], v[118:121]
    v_mfma_f32_16x16x32_bf16 v[126:129], v[138:141], v[194:197], v[126:129]
    ds_read_b64_tr_b16 v[194:195], v37 offset:0
    v_mfma_f32_16x16x32_bf16 v[126:129], v[150:153], v[198:201], v[126:129]
    ds_read_b64_tr_b16 v[196:197], v37 offset:512
    s_waitcnt lgkmcnt(11)
    v_mfma_f32_16x16x32_bf16 v[66:69], v[178:181], v[158:161], v[66:69]
    ds_read_b64_tr_b16 v[198:199], v37 offset:4096
    s_waitcnt lgkmcnt(9)
    v_mfma_f32_16x16x32_bf16 v[66:69], v[182:185], v[170:173], v[66:69]
    ds_read_b64_tr_b16 v[200:201], v37 offset:4608
    s_waitcnt lgkmcnt(9)
    v_mfma_f32_16x16x32_bf16 v[74:77], v[178:181], v[162:165], v[74:77]
    ds_read_b64_tr_b16 v[178:179], v38 offset:0
    s_waitcnt lgkmcnt(9)
    v_mfma_f32_16x16x32_bf16 v[74:77], v[182:185], v[174:177], v[74:77]
    ds_read_b64_tr_b16 v[180:181], v38 offset:512
    s_waitcnt lgkmcnt(8)
    v_mfma_f32_16x16x32_bf16 v[70:73], v[186:189], v[158:161], v[70:73]
    ds_read_b64_tr_b16 v[182:183], v38 offset:4096
    s_waitcnt lgkmcnt(7)
    v_mfma_f32_16x16x32_bf16 v[70:73], v[190:193], v[170:173], v[70:73]
    ds_read_b64_tr_b16 v[184:185], v38 offset:4608
    v_mfma_f32_16x16x32_bf16 v[78:81], v[186:189], v[162:165], v[78:81]
    ds_read_b128 v[154:157], v33 offset:30720
    v_mfma_f32_16x16x32_bf16 v[78:81], v[190:193], v[174:177], v[78:81]
    ds_read_b64_tr_b16 v[186:187], v37 offset:8192
    s_waitcnt lgkmcnt(8)
    v_mfma_f32_16x16x32_bf16 v[90:93], v[194:197], v[158:161], v[90:93]
    ds_read_b64_tr_b16 v[188:189], v37 offset:8704
    s_waitcnt lgkmcnt(7)
    v_mfma_f32_16x16x32_bf16 v[90:93], v[198:201], v[170:173], v[90:93]
    ds_read_b128 v[166:169], v34 offset:30720
    v_mfma_f32_16x16x32_bf16 v[98:101], v[194:197], v[162:165], v[98:101]
    ds_read_b64_tr_b16 v[190:191], v37 offset:12288
    ds_read_b64_tr_b16 v[192:193], v37 offset:12800
    v_mfma_f32_16x16x32_bf16 v[98:101], v[198:201], v[174:177], v[98:101]
    ds_read_b64_tr_b16 v[194:195], v38 offset:8192
    s_waitcnt lgkmcnt(9)
    v_mfma_f32_16x16x32_bf16 v[94:97], v[178:181], v[158:161], v[94:97]
    ds_read_b64_tr_b16 v[196:197], v38 offset:8704
    s_waitcnt lgkmcnt(8)
    v_mfma_f32_16x16x32_bf16 v[94:97], v[182:185], v[170:173], v[94:97]
    ds_read_b64_tr_b16 v[198:199], v38 offset:12288
    v_mfma_f32_16x16x32_bf16 v[102:105], v[178:181], v[162:165], v[102:105]
    ds_read_b64_tr_b16 v[200:201], v38 offset:12800
    v_mfma_f32_16x16x32_bf16 v[102:105], v[182:185], v[174:177], v[102:105]
    s_waitcnt lgkmcnt(7)
    v_mfma_f32_16x16x32_bf16 v[106:109], v[154:157], v[186:189], v[106:109]
    s_waitcnt lgkmcnt(4)
    v_mfma_f32_16x16x32_bf16 v[106:109], v[166:169], v[190:193], v[106:109]
    v_mfma_f32_16x16x32_bf16 v[114:117], v[158:161], v[186:189], v[114:117]
    v_mfma_f32_16x16x32_bf16 v[114:117], v[170:173], v[190:193], v[114:117]
    v_mfma_f32_16x16x32_bf16 v[122:125], v[162:165], v[186:189], v[122:125]
    v_mfma_f32_16x16x32_bf16 v[122:125], v[174:177], v[190:193], v[122:125]
    s_waitcnt lgkmcnt(2)
    v_mfma_f32_16x16x32_bf16 v[110:113], v[154:157], v[194:197], v[110:113]
    s_waitcnt lgkmcnt(0)
    v_mfma_f32_16x16x32_bf16 v[110:113], v[166:169], v[198:201], v[110:113]
    v_mfma_f32_16x16x32_bf16 v[118:121], v[158:161], v[194:197], v[118:121]
    s_barrier
    ds_read_b128 v[134:137], v35 offset:2048
    ds_read_b64_tr_b16 v[178:179], v37 offset:16384
    ds_read_b64_tr_b16 v[180:181], v37 offset:16896
    ds_read_b128 v[146:149], v36 offset:2048
    ds_read_b64_tr_b16 v[182:183], v37 offset:20480
    ds_read_b64_tr_b16 v[184:185], v37 offset:20992
    ds_read_b128 v[138:141], v35 offset:4096
    ds_read_b128 v[150:153], v36 offset:4096
    ds_read_b64_tr_b16 v[186:187], v38 offset:16384
    ds_read_b64_tr_b16 v[188:189], v38 offset:16896
    ds_read_b64_tr_b16 v[190:191], v38 offset:20480
    ds_read_b64_tr_b16 v[192:193], v38 offset:20992
    v_mfma_f32_16x16x32_bf16 v[118:121], v[170:173], v[198:201], v[118:121]
    v_mfma_f32_16x16x32_bf16 v[126:129], v[162:165], v[194:197], v[126:129]
    ds_read_b64_tr_b16 v[194:195], v37 offset:24576
    v_mfma_f32_16x16x32_bf16 v[126:129], v[174:177], v[198:201], v[126:129]
    ds_read_b64_tr_b16 v[196:197], v37 offset:25088
    s_waitcnt lgkmcnt(11)
    v_mfma_f32_16x16x32_bf16 v[66:69], v[178:181], v[134:137], v[66:69]
    ds_read_b64_tr_b16 v[198:199], v37 offset:28672
    s_waitcnt lgkmcnt(9)
    v_mfma_f32_16x16x32_bf16 v[66:69], v[182:185], v[146:149], v[66:69]
    ds_read_b64_tr_b16 v[200:201], v37 offset:29184
    s_waitcnt lgkmcnt(9)
    v_mfma_f32_16x16x32_bf16 v[74:77], v[178:181], v[138:141], v[74:77]
    ds_read_b64_tr_b16 v[178:179], v38 offset:24576
    s_waitcnt lgkmcnt(9)
    v_mfma_f32_16x16x32_bf16 v[74:77], v[182:185], v[150:153], v[74:77]
    ds_read_b64_tr_b16 v[180:181], v38 offset:25088
    s_waitcnt lgkmcnt(8)
    v_mfma_f32_16x16x32_bf16 v[70:73], v[186:189], v[134:137], v[70:73]
    ds_read_b64_tr_b16 v[182:183], v38 offset:28672
    s_waitcnt lgkmcnt(7)
    v_mfma_f32_16x16x32_bf16 v[70:73], v[190:193], v[146:149], v[70:73]
    ds_read_b64_tr_b16 v[184:185], v38 offset:29184
    v_mfma_f32_16x16x32_bf16 v[78:81], v[186:189], v[138:141], v[78:81]
    ds_read_b128 v[130:133], v35 offset:0
    v_mfma_f32_16x16x32_bf16 v[78:81], v[190:193], v[150:153], v[78:81]
    ds_read_b64_tr_b16 v[186:187], v37 offset:32768
    s_waitcnt lgkmcnt(8)
    v_mfma_f32_16x16x32_bf16 v[90:93], v[194:197], v[134:137], v[90:93]
    ds_read_b64_tr_b16 v[188:189], v37 offset:33280
    s_waitcnt lgkmcnt(7)
    v_mfma_f32_16x16x32_bf16 v[90:93], v[198:201], v[146:149], v[90:93]
    ds_read_b128 v[142:145], v36 offset:0
    v_mfma_f32_16x16x32_bf16 v[98:101], v[194:197], v[138:141], v[98:101]
    ds_read_b64_tr_b16 v[190:191], v37 offset:36864
    ds_read_b64_tr_b16 v[192:193], v37 offset:37376
    v_mfma_f32_16x16x32_bf16 v[98:101], v[198:201], v[150:153], v[98:101]
    ds_read_b64_tr_b16 v[194:195], v38 offset:32768
    s_waitcnt lgkmcnt(9)
    v_mfma_f32_16x16x32_bf16 v[94:97], v[178:181], v[134:137], v[94:97]
    ds_read_b64_tr_b16 v[196:197], v38 offset:33280
    s_waitcnt lgkmcnt(8)
    v_mfma_f32_16x16x32_bf16 v[94:97], v[182:185], v[146:149], v[94:97]
    ds_read_b64_tr_b16 v[198:199], v38 offset:36864
    v_mfma_f32_16x16x32_bf16 v[102:105], v[178:181], v[138:141], v[102:105]
    ds_read_b64_tr_b16 v[200:201], v38 offset:37376
    v_mfma_f32_16x16x32_bf16 v[102:105], v[182:185], v[150:153], v[102:105]
    s_waitcnt lgkmcnt(7)
    v_mfma_f32_16x16x32_bf16 v[106:109], v[130:133], v[186:189], v[106:109]
    s_waitcnt lgkmcnt(4)
    v_mfma_f32_16x16x32_bf16 v[106:109], v[142:145], v[190:193], v[106:109]
    v_mfma_f32_16x16x32_bf16 v[114:117], v[134:137], v[186:189], v[114:117]
    v_mfma_f32_16x16x32_bf16 v[114:117], v[146:149], v[190:193], v[114:117]
    v_mfma_f32_16x16x32_bf16 v[122:125], v[138:141], v[186:189], v[122:125]
    v_mfma_f32_16x16x32_bf16 v[122:125], v[150:153], v[190:193], v[122:125]
    s_waitcnt lgkmcnt(2)
    v_mfma_f32_16x16x32_bf16 v[110:113], v[130:133], v[194:197], v[110:113]
    s_waitcnt lgkmcnt(0)
    v_mfma_f32_16x16x32_bf16 v[110:113], v[142:145], v[198:201], v[110:113]
    v_mfma_f32_16x16x32_bf16 v[118:121], v[134:137], v[194:197], v[118:121]
    s_barrier
    ds_read_b128 v[158:161], v35 offset:12288
    ds_read_b64_tr_b16 v[178:179], v37 offset:40960
    ds_read_b64_tr_b16 v[180:181], v37 offset:41472
    ds_read_b128 v[170:173], v36 offset:12288
    ds_read_b64_tr_b16 v[182:183], v37 offset:45056
    ds_read_b64_tr_b16 v[184:185], v37 offset:45568
    ds_read_b128 v[162:165], v35 offset:14336
    ds_read_b128 v[174:177], v36 offset:14336
    ds_read_b64_tr_b16 v[186:187], v38 offset:40960
    ds_read_b64_tr_b16 v[188:189], v38 offset:41472
    ds_read_b64_tr_b16 v[190:191], v38 offset:45056
    ds_read_b64_tr_b16 v[192:193], v38 offset:45568
    ds_read_b64_tr_b16 v[202:203], v39 offset:0
    v_mfma_f32_16x16x32_bf16 v[118:121], v[146:149], v[198:201], v[118:121]
    ds_read_b64_tr_b16 v[204:205], v39 offset:512
    v_mfma_f32_16x16x32_bf16 v[126:129], v[138:141], v[194:197], v[126:129]
    ds_read_b64_tr_b16 v[206:207], v39 offset:4096
    v_mfma_f32_16x16x32_bf16 v[126:129], v[150:153], v[198:201], v[126:129]
    ds_read_b64_tr_b16 v[208:209], v39 offset:4608
    s_waitcnt lgkmcnt(13)
    v_mfma_f32_16x16x32_bf16 v[66:69], v[178:181], v[158:161], v[66:69]
    ds_read_b64_tr_b16 v[194:195], v40 offset:0
    s_waitcnt lgkmcnt(11)
    v_mfma_f32_16x16x32_bf16 v[66:69], v[182:185], v[170:173], v[66:69]
    ds_read_b64_tr_b16 v[196:197], v40 offset:512
    s_waitcnt lgkmcnt(11)
    v_mfma_f32_16x16x32_bf16 v[74:77], v[178:181], v[162:165], v[74:77]
    ds_read_b64_tr_b16 v[198:199], v40 offset:4096
    s_waitcnt lgkmcnt(11)
    v_mfma_f32_16x16x32_bf16 v[74:77], v[182:185], v[174:177], v[74:77]
    ds_read_b64_tr_b16 v[200:201], v40 offset:4608
    s_waitcnt lgkmcnt(10)
    v_mfma_f32_16x16x32_bf16 v[70:73], v[186:189], v[158:161], v[70:73]
    s_waitcnt lgkmcnt(8)
    v_mfma_f32_16x16x32_bf16 v[70:73], v[190:193], v[170:173], v[70:73]
    v_mfma_f32_16x16x32_bf16 v[78:81], v[186:189], v[162:165], v[78:81]
    v_mfma_f32_16x16x32_bf16 v[78:81], v[190:193], v[174:177], v[78:81]
    s_waitcnt lgkmcnt(6)
    v_mfma_f32_16x16x32_bf16 v[90:93], v[202:205], v[158:161], v[90:93]
    s_waitcnt lgkmcnt(4)
    v_mfma_f32_16x16x32_bf16 v[90:93], v[206:209], v[170:173], v[90:93]
    v_mfma_f32_16x16x32_bf16 v[98:101], v[202:205], v[162:165], v[98:101]
    v_mfma_f32_16x16x32_bf16 v[98:101], v[206:209], v[174:177], v[98:101]
    s_waitcnt lgkmcnt(2)
    v_mfma_f32_16x16x32_bf16 v[94:97], v[194:197], v[158:161], v[94:97]
    s_waitcnt lgkmcnt(0)
    v_mfma_f32_16x16x32_bf16 v[94:97], v[198:201], v[170:173], v[94:97]
    v_mfma_f32_16x16x32_bf16 v[102:105], v[194:197], v[162:165], v[102:105]
    s_barrier
    ds_read_b128 v[134:137], v35 offset:22528
    ds_read_b64_tr_b16 v[178:179], v39 offset:8192
    ds_read_b64_tr_b16 v[180:181], v39 offset:8704
    ds_read_b128 v[146:149], v36 offset:22528
    ds_read_b64_tr_b16 v[182:183], v39 offset:12288
    ds_read_b64_tr_b16 v[184:185], v39 offset:12800
    ds_read_b128 v[138:141], v35 offset:24576
    ds_read_b128 v[150:153], v36 offset:24576
    ds_read_b64_tr_b16 v[186:187], v40 offset:8192
    ds_read_b64_tr_b16 v[188:189], v40 offset:8704
    ds_read_b64_tr_b16 v[190:191], v40 offset:12288
    ds_read_b64_tr_b16 v[192:193], v40 offset:12800
    ds_read_b128 v[130:133], v35 offset:20480
    v_mfma_f32_16x16x32_bf16 v[102:105], v[198:201], v[174:177], v[102:105]
    ds_read_b128 v[142:145], v36 offset:20480
    s_waitcnt lgkmcnt(11)
    v_mfma_f32_16x16x32_bf16 v[66:69], v[178:181], v[134:137], v[66:69]
    s_barrier
    ds_read_b64_tr_b16 v[202:203], v39 offset:16384
    ds_read_b64_tr_b16 v[204:205], v39 offset:16896
    ds_read_b64_tr_b16 v[206:207], v39 offset:20480
    ds_read_b64_tr_b16 v[208:209], v39 offset:20992
    ds_read_b64_tr_b16 v[194:195], v40 offset:16384
    s_waitcnt lgkmcnt(13)
    v_mfma_f32_16x16x32_bf16 v[66:69], v[182:185], v[146:149], v[66:69]
    ds_read_b64_tr_b16 v[196:197], v40 offset:16896
    s_waitcnt lgkmcnt(13)
    v_mfma_f32_16x16x32_bf16 v[74:77], v[178:181], v[138:141], v[74:77]
    ds_read_b64_tr_b16 v[198:199], v40 offset:20480
    s_waitcnt lgkmcnt(13)
    v_mfma_f32_16x16x32_bf16 v[74:77], v[182:185], v[150:153], v[74:77]
    ds_read_b64_tr_b16 v[200:201], v40 offset:20992
    s_waitcnt lgkmcnt(12)
    v_mfma_f32_16x16x32_bf16 v[70:73], v[186:189], v[134:137], v[70:73]
    v_cvt_pk_bf16_f32 v154, v66, v67
    v_cvt_pk_bf16_f32 v155, v68, v69
    s_waitcnt lgkmcnt(10)
    v_mfma_f32_16x16x32_bf16 v[70:73], v[190:193], v[146:149], v[70:73]
    v_cndmask_b32 v162, 0, v154, s[54:55]
    v_cndmask_b32 v154, v154, 0, s[54:55]
    v_mfma_f32_16x16x32_bf16 v[78:81], v[186:189], v[138:141], v[78:81]
    v_cndmask_b32 v163, 0, v155, s[54:55]
    v_cndmask_b32 v155, v155, 0, s[54:55]
    v_mfma_f32_16x16x32_bf16 v[78:81], v[190:193], v[150:153], v[78:81]
    v_cvt_pk_bf16_f32 v158, v74, v75
    v_cvt_pk_bf16_f32 v159, v76, v77
    s_waitcnt lgkmcnt(6)
    v_mfma_f32_16x16x32_bf16 v[90:93], v[202:205], v[134:137], v[90:93]
    v_cndmask_b32 v166, 0, v158, s[54:55]
    v_cndmask_b32 v158, v158, 0, s[54:55]
    s_waitcnt lgkmcnt(4)
    v_mfma_f32_16x16x32_bf16 v[90:93], v[206:209], v[146:149], v[90:93]
    v_cndmask_b32 v167, 0, v159, s[54:55]
    v_cndmask_b32 v159, v159, 0, s[54:55]
    s_waitcnt lgkmcnt(2)
    v_mfma_f32_16x16x32_bf16 v[94:97], v[194:197], v[134:137], v[94:97]
    v_cvt_pk_bf16_f32 v156, v70, v71
    v_cvt_pk_bf16_f32 v157, v72, v73
    s_waitcnt lgkmcnt(0)
    v_mfma_f32_16x16x32_bf16 v[94:97], v[198:201], v[146:149], v[94:97]
    v_cndmask_b32 v164, 0, v156, s[56:57]
    v_cndmask_b32 v156, v156, 0, s[56:57]
    v_mfma_f32_16x16x32_bf16 v[98:101], v[202:205], v[138:141], v[98:101]
    v_cndmask_b32 v165, 0, v157, s[56:57]
    v_cndmask_b32 v157, v157, 0, s[56:57]
    v_mfma_f32_16x16x32_bf16 v[98:101], v[206:209], v[150:153], v[98:101]
    v_cvt_pk_bf16_f32 v160, v78, v79
    v_cvt_pk_bf16_f32 v161, v80, v81
    v_mfma_f32_16x16x32_bf16 v[102:105], v[194:197], v[138:141], v[102:105]
    v_cndmask_b32 v168, 0, v160, s[56:57]
    v_cndmask_b32 v160, v160, 0, s[56:57]
    v_mfma_f32_16x16x32_bf16 v[102:105], v[198:201], v[150:153], v[102:105]
    ds_read_b32 v45, v5 offset:4
    v_cndmask_b32 v169, 0, v161, s[56:57]
    v_cndmask_b32 v161, v161, 0, s[56:57]
    ds_read_b32 v53, v224 offset:56
    ds_read_b128 v[230:233], v222
    v_cvt_pk_bf16_f32 v234, v90, v91
    v_cvt_pk_bf16_f32 v235, v92, v93
    v_cvt_pk_bf16_f32 v236, v94, v95
    v_cvt_pk_bf16_f32 v237, v96, v97
    s_nop 1
    v_mfma_f32_16x16x32_bf16 v[70:73], v[234:237], v[154:157], 0
    v_mfma_f32_16x16x32_bf16 v[74:77], v[234:237], v[158:161], 0
    v_cvt_pk_bf16_f32 v238, v98, v99
    v_cvt_pk_bf16_f32 v239, v100, v101
    v_cvt_pk_bf16_f32 v240, v102, v103
    v_cvt_pk_bf16_f32 v241, v104, v105
    s_nop 1
    v_mfma_f32_16x16x32_bf16 v[78:81], v[238:241], v[158:161], 0
    v_mfma_f32_16x16x32_bf16 v[182:185], v[234:237], v[162:165], 0
    v_mfma_f32_16x16x32_bf16 v[186:189], v[234:237], v[166:169], 0
    s_waitcnt lgkmcnt(0)
    v_cmp_ne_u32 vcc, 0, v53
    s_nop 0
    s_cbranch_vccnz D_dK
    s_mov_b32 s9, 0
D_lK:
    ds_read_b32 v53, v224 offset:56
    ds_read_b128 v[230:233], v222
    s_add_u32 s9, s9, 1
    s_cmp_gt_u32 s9, 1600000
    s_waitcnt lgkmcnt(0)
    s_cbranch_scc1 D_dK
    v_cmp_eq_u32 vcc, 0, v53
    s_nop 0
    s_cbranch_vccnz D_lK
D_dK:
    v_mfma_f32_16x16x32_bf16 v[66:69], v[230:233], v[154:157], 0
    v_readfirstlane_b32 s63, v45
    v_cndmask_b32 v78, v78, v79, s[44:45]
    v_cndmask_b32 v80, v80, v81, s[44:45]
    v_cndmask_b32 v74, v74, v75, s[44:45]
    v_cndmask_b32 v76, v76, v77, s[44:45]
    v_cndmask_b32 v216, v74, v78, s[46:47]
    v_cndmask_b32 v217, v76, v80, s[48:49]
    v_cndmask_b32 v70, v70, v71, s[44:45]
    v_cndmask_b32 v72, v72, v73, s[44:45]
    v_cndmask_b32 v66, v66, v67, s[44:45]
    v_cndmask_b32 v68, v68, v69, s[44:45]
    v_cndmask_b32 v214, v66, v70, s[46:47]
    v_cndmask_b32 v215, v68, v72, s[48:49]
    v_and_or_b32 v98, v214, v51, v54
    v_and_or_b32 v99, v215, v51, v55
    v_and_or_b32 v100, v216, v51, v56
    v_and_or_b32 v101, v217, v51, v57
    s_sub_u32 s63, s63, 1
    s_cbranch_scc1 C_mr1
C_md1:
    s_cmp_lg_u32 s101, 0
    s_cbranch_scc1 SM_jS1
    s_cmp_eq_u32 s63, 0
    s_cbranch_scc1 SM_sS1
    buffer_store_dwordx4 v[98:101], v4, s[36:39], s15 offen
SM_jS1:
    v_mfma_f32_16x16x32_bf16 v[178:181], v[230:233], v[162:165], 0
    v_mfma_f32_16x16x32_bf16 v[190:193], v[238:241], v[166:169], 0
    ds_read_b32 v45, v5 offset:32
    ds_read_b64_tr_b16 v[170:171], v39 offset:32768
    ds_read_b64_tr_b16 v[172:173], v39 offset:33280
    ds_read_b64_tr_b16 v[174:175], v40 offset:32768
    ds_read_b64_tr_b16 v[176:177], v40 offset:33280
    ds_read_b64_tr_b16 v[202:203], v39 offset:36864
    ds_read_b64_tr_b16 v[204:205], v39 offset:37376
    ds_read_b64_tr_b16 v[206:207], v40 offset:36864
    ds_read_b64_tr_b16 v[208:209], v40 offset:37376
    v_cndmask_b32 v190, v190, v191, s[44:45]
    v_cndmask_b32 v192, v192, v193, s[44:45]
    v_cndmask_b32 v186, v186, v187, s[44:45]
    v_cndmask_b32 v188, v188, v189, s[44:45]
    v_cndmask_b32 v212, v186, v190, s[46:47]
    v_cndmask_b32 v213, v188, v192, s[48:49]
    v_cndmask_b32 v182, v182, v183, s[44:45]
    v_cndmask_b32 v184, v184, v185, s[44:45]
    v_cndmask_b32 v178, v178, v179, s[44:45]
    v_cndmask_b32 v180, v180, v181, s[44:45]
    v_cndmask_b32 v210, v178, v182, s[46:47]
    v_cndmask_b32 v211, v180, v184, s[48:49]
    ds_write_b128 v47, v[210:213]
    ds_write_b32 v52, v5 offset:16
    s_waitcnt lgkmcnt(10)
    v_cmp_gt_u32 vcc, 4, v45
    s_nop 0
    s_cbranch_vccnz C_vr1
C_vd1:
    s_waitcnt lgkmcnt(8)
    v_mfma_f32_16x16x32_bf16 v[106:109], v[130:133], v[170:173], v[106:109]
    ds_read_b128 v[154:157], v35 offset:10240
    s_waitcnt lgkmcnt(5)
    v_mfma_f32_16x16x32_bf16 v[106:109], v[142:145], v[202:205], v[106:109]
    ds_read_b64_tr_b16 v[186:187], v39 offset:24576
    v_mfma_f32_16x16x32_bf16 v[114:117], v[134:137], v[170:173], v[114:117]
    ds_read_b64_tr_b16 v[188:189], v39 offset:25088
    v_mfma_f32_16x16x32_bf16 v[114:117], v[146:149], v[202:205], v[114:117]
    ds_read_b128 v[166:169], v36 offset:10240
    v_mfma_f32_16x16x32_bf16 v[122:125], v[138:141], v[170:173], v[122:125]
    ds_read_b64_tr_b16 v[194:195], v39 offset:28672
    v_mfma_f32_16x16x32_bf16 v[122:125], v[150:153], v[202:205], v[122:125]
    ds_read_b64_tr_b16 v[196:197], v39 offset:29184
    v_mfma_f32_16x16x32_bf16 v[110:113], v[130:133], v[174:177], v[110:113]
    ds_read_b64_tr_b16 v[190:191], v40 offset:24576
    ds_read_b64_tr_b16 v[192:193], v40 offset:25088
    s_waitcnt lgkmcnt(10)
    v_mfma_f32_16x16x32_bf16 v[110:113], v[142:145], v[206:209], v[110:113]
    ds_read_b64_tr_b16 v[198:199], v40 offset:28672
    ds_read_b64_tr_b16 v[200:201], v40 offset:29184
    v_mfma_f32_16x16x32_bf16 v[118:121], v[134:137], v[174:177], v[118:121]
    ds_read_b128 v[158:161], v35 offset:12288
    v_mfma_f32_16x16x32_bf16 v[118:121], v[146:149], v[206:209], v[118:121]
    ds_read_b128 v[178:181], v36 offset:12288
    v_mfma_f32_16x16x32_bf16 v[126:129], v[138:141], v[174:177], v[126:129]
    ds_read_b128 v[162:165], v35 offset:14336
    v_mfma_f32_16x16x32_bf16 v[126:129], v[150:153], v[206:209], v[126:129]
    ds_read_b128 v[182:185], v36 offset:14336
    s_waitcnt lgkmcnt(11)
    v_mfma_f32_16x16x32_bf16 v[106:109], v[154:157], v[186:189], v[106:109]
    s_waitcnt lgkmcnt(8)
    v_mfma_f32_16x16x32_bf16 v[106:109], v[166:169], v[194:197], v[106:109]
    s_waitcnt lgkmcnt(6)
    v_mfma_f32_16x16x32_bf16 v[110:113], v[154:157], v[190:193], v[110:113]
    s_waitcnt lgkmcnt(4)
    v_mfma_f32_16x16x32_bf16 v[110:113], v[166:169], v[198:201], v[110:113]
    s_waitcnt lgkmcnt(3)
    v_mfma_f32_16x16x32_bf16 v[114:117], v[158:161], v[186:189], v[114:117]
    s_nop 1
    v_cvt_pk_bf16_f32 v230, v106, v107
    v_cvt_pk_bf16_f32 v231, v108, v109
    ds_write_b64 v223, v[230:231] offset:0
    s_waitcnt lgkmcnt(3)
    v_mfma_f32_16x16x32_bf16 v[114:117], v[178:181], v[194:197], v[114:117]
    v_mfma_f32_16x16x32_bf16 v[118:121], v[158:161], v[190:193], v[118:121]
    v_cvt_pk_bf16_f32 v236, v110, v111
    v_cvt_pk_bf16_f32 v237, v112, v113
    ds_write_b64 v223, v[236:237] offset:8
    v_mfma_f32_16x16x32_bf16 v[118:121], v[178:181], v[198:201], v[118:121]
    ds_write_b32 v225, v5 offset:68
    s_waitcnt lgkmcnt(4)
    v_mfma_f32_16x16x32_bf16 v[122:125], v[162:165], v[186:189], v[122:125]
    v_cvt_pk_bf16_f32 v232, v114, v115
    v_cvt_pk_bf16_f32 v233, v116, v117
    s_waitcnt lgkmcnt(3)
    v_mfma_f32_16x16x32_bf16 v[122:125], v[182:185], v[194:197], v[122:125]
    v_mfma_f32_16x16x32_bf16 v[126:129], v[162:165], v[190:193], v[126:129]
    v_cvt_pk_bf16_f32 v238, v118, v119
    v_cvt_pk_bf16_f32 v239, v120, v121
    v_mfma_f32_16x16x32_bf16 v[126:129], v[182:185], v[198:201], v[126:129]
    v_cndmask_b32 v130, 0, v230, s[58:59]
    v_cndmask_b32 v230, v230, 0, s[58:59]
    v_cndmask_b32 v131, 0, v231, s[58:59]
    v_cndmask_b32 v231, v231, 0, s[58:59]
    buffer_load_dwordx4 v[218:221], v4, s[36:39], s100 offen sc1
    v_cvt_pk_bf16_f32 v234, v122, v123
    v_cvt_pk_bf16_f32 v235, v124, v125
    s_nop 0
    v_cvt_pk_bf16_f32 v240, v126, v127
    v_cvt_pk_bf16_f32 v241, v128, v129
    v_cndmask_b32 v136, 0, v236, s[60:61]
    v_cndmask_b32 v236, v236, 0, s[60:61]
    v_cndmask_b32 v137, 0, v237, s[60:61]
    v_cndmask_b32 v237, v237, 0, s[60:61]
    v_cndmask_b32 v132, 0, v232, s[58:59]
    v_cndmask_b32 v232, v232, 0, s[58:59]
    v_cndmask_b32 v133, 0, v233, s[58:59]
    v_cndmask_b32 v233, v233, 0, s[58:59]
    v_cndmask_b32 v138, 0, v238, s[60:61]
    v_cndmask_b32 v238, v238, 0, s[60:61]
    v_cndmask_b32 v139, 0, v239, s[60:61]
    v_cndmask_b32 v239, v239, 0, s[60:61]
    v_cndmask_b32 v134, 0, v234, s[58:59]
    v_cndmask_b32 v234, v234, 0, s[58:59]
    v_cndmask_b32 v135, 0, v235, s[58:59]
    v_cndmask_b32 v235, v235, 0, s[58:59]
    v_cndmask_b32 v140, 0, v240, s[60:61]
    v_cndmask_b32 v240, v240, 0, s[60:61]
    v_cndmask_b32 v141, 0, v241, s[60:61]
    v_cndmask_b32 v241, v241, 0, s[60:61]
    s_waitcnt lgkmcnt(0)
C_join:
    v_mov_b32 v12, s0
    v_mov_b32 v13, s0
    v_pk_mul_f32 v[214:215], v[214:215], v[12:13]
    v_pk_mul_f32 v[216:217], v[216:217], v[12:13]
    s_mov_b32 s9, 0
    s_add_u32 s19, s100, 14336
    s_cmp_lg_u32 s101, 0
    s_cbranch_scc1 C_sv
    s_mov_b32 s40, 0x0c0c0400
    s_mov_b32 s41, 0x05040100
    s_waitcnt vmcnt(0)
C_sl:
    v_perm_b32 v2, v219, v218, s40
    v_perm_b32 v3, v221, v220, s40
    v_and_b32 v218, v51, v218
    v_perm_b32 v2, v3, v2, s41
    v_and_b32 v219, v51, v219
    v_cmp_ne_u32 vcc, s12, v2
    v_and_b32 v220, v51, v220
    v_and_b32 v221, v51, v221
    s_cbranch_vccz C_sk
    buffer_load_dwordx4 v[218:221], v4, s[36:39], s100 offen sc1
    s_waitcnt vmcnt(0)
    s_add_u32 s9, s9, 1
    s_cmp_lt_u32 s9, 200000
    s_cbranch_scc1 C_sl
C_sk:
    v_pk_fma_f32 v[214:215], v[218:219], v[12:13], v[214:215]
    v_pk_fma_f32 v[216:217], v[220:221], v[12:13], v[216:217]
C_sv:
    v_max_f32 v226, v214, v215
    v_max_f32 v227, v216, v217
    v_mov_b32 v228, v226
    v_mov_b32 v229, v227
    s_mov_b64 exec, 1
    ds_add_u32 v5, v49 offset:80
    s_mov_b64 exec, -1
    v_permlane16_swap_b32 v226, v228
    v_permlane16_swap_b32 v227, v229
    v_max_f32 v226, v226, v228
    v_max_f32 v227, v227, v229
    v_mov_b32 v228, v226
    v_mov_b32 v229, v227
    s_nop 0
    v_permlane32_swap_b32 v226, v228
    v_permlane32_swap_b32 v227, v229
    v_max_f32 v226, v226, v228
    v_max_f32 v227, v227, v229
    v_sub_f32 v214, v214, v226
    v_sub_f32 v215, v215, v226
    v_sub_f32 v216, v216, v227
    v_sub_f32 v217, v217, v227
    v_exp_f32 v214, v214
    v_exp_f32 v215, v215
    v_exp_f32 v216, v216
    v_exp_f32 v217, v217
    v_add_f32 v226, v214, v215
    v_add_f32 v227, v216, v217
    v_mov_b32 v228, v226
    v_mov_b32 v229, v227
    ds_read_b32 v53, v52 offset:40
    ds_read_b128 v[82:85], v48 offset:12288
    ds_read_b128 v[86:89], v48 offset:13312
    ds_read_b32 v7, v5 offset:12
    v_permlane16_swap_b32 v226, v228
    v_permlane16_swap_b32 v227, v229
    v_add_f32 v226, v226, v228
    v_add_f32 v227, v227, v229
    v_mov_b32 v228, v226
    v_mov_b32 v229, v227
    s_nop 0
    v_permlane32_swap_b32 v226, v228
    v_permlane32_swap_b32 v227, v229
    v_add_f32 v226, v226, v228
    v_add_f32 v227, v227, v229
    v_rcp_f32 v226, v226
    v_rcp_f32 v227, v227
    s_waitcnt lgkmcnt(0)
    v_cmp_eq_u32 vcc, 0, v53
    v_mul_f32 v214, v214, v226
    v_mul_f32 v215, v215, v226
    v_mul_f32 v216, v216, v227
    v_mul_f32 v217, v217, v227
    v_cvt_pk_bf16_f32 v214, v214, v214
    v_cvt_pk_bf16_f32 v215, v215, v215
    v_cvt_pk_bf16_f32 v216, v216, v216
    v_cvt_pk_bf16_f32 v217, v217, v217
    s_cbranch_vccnz C_pr
C_pd:
    v_mfma_f32_16x16x32_bf16 v[66:69], v[130:133], v[82:85], 0
    v_and_b32 v90, v41, v214
    v_and_b32 v91, v42, v215
    v_mfma_f32_16x16x32_bf16 v[70:73], v[136:139], v[82:85], 0
    v_and_b32 v92, v43, v214
    v_and_b32 v93, v44, v215
    v_mfma_f32_16x16x32_bf16 v[74:77], v[132:135], v[86:89], 0
    v_and_b32 v94, v41, v216
    v_and_b32 v95, v42, v217
    v_mfma_f32_16x16x32_bf16 v[78:81], v[138:141], v[86:89], 0
    v_and_b32 v96, v43, v216
    v_and_b32 v97, v44, v217
    v_mfma_f32_16x16x32_bf16 v[66:69], v[230:233], v[90:93], v[66:69]
    v_mfma_f32_16x16x32_bf16 v[70:73], v[236:239], v[90:93], v[70:73]
    v_mfma_f32_16x16x32_bf16 v[74:77], v[232:235], v[94:97], v[74:77]
    v_mfma_f32_16x16x32_bf16 v[78:81], v[238:241], v[94:97], v[78:81]
    s_cmp_eq_u32 s63, 0
    s_cbranch_scc1 SM_sO
    s_nop 2
    v_cvt_pk_bf16_f32 v58, v66, v67
    v_cvt_pk_bf16_f32 v59, v68, v69
    v_cvt_pk_bf16_f32 v60, v70, v71
    v_cvt_pk_bf16_f32 v61, v72, v73
    buffer_store_dwordx4 v[58:61], v4, s[36:39], s100 offen nt
    v_cvt_pk_bf16_f32 v62, v74, v75
    v_cvt_pk_bf16_f32 v63, v76, v77
    v_cvt_pk_bf16_f32 v64, v78, v79
    v_cvt_pk_bf16_f32 v65, v80, v81
    buffer_store_dwordx4 v[62:65], v4, s[36:39], s19 offen nt
SM_jO:
    ds_write_b128 v18, v[58:61] offset:20480
    ds_write_b128 v18, v[62:65] offset:22528
    ds_write_b32 v52, v5 offset:96
    v_cmp_gt_u32 vcc, 4, v7
    s_nop 0
    s_cbranch_vccz W_dW
    s_mov_b32 s9, 0
W_lW:
    ds_read_b32 v2, v5 offset:12
    s_add_u32 s9, s9, 1
    s_cmp_gt_u32 s9, 1600000
    s_cbranch_scc1 W_dW
    s_waitcnt lgkmcnt(0)
    v_cmp_gt_u32 vcc, 4, v2
    s_nop 0
    s_cbranch_vccnz W_lW
W_dW:
    ds_read_b64_tr_b16 v[82:83], v21 offset:0
    ds_read_b64_tr_b16 v[84:85], v21 offset:2048
    ds_read_b64_tr_b16 v[86:87], v22 offset:0
    ds_read_b64_tr_b16 v[88:89], v22 offset:2048
    ds_read_b64_tr_b16 v[90:91], v23 offset:0
    ds_read_b64_tr_b16 v[92:93], v23 offset:2048
    ds_read_b64_tr_b16 v[94:95], v24 offset:0
    ds_read_b64_tr_b16 v[96:97], v24 offset:2048
    ds_read_b64_tr_b16 v[98:99], v21 offset:4096
    ds_read_b64_tr_b16 v[100:101], v21 offset:6144
    ds_read_b64_tr_b16 v[102:103], v22 offset:4096
    ds_read_b64_tr_b16 v[104:105], v22 offset:6144
    ds_read_b64_tr_b16 v[106:107], v23 offset:4096
    ds_read_b64_tr_b16 v[108:109], v23 offset:6144
    ds_read_b64_tr_b16 v[110:111], v24 offset:4096
    ds_read_b64_tr_b16 v[112:113], v24 offset:6144
    s_waitcnt vmcnt(0)
    s_mov_b64 exec, 1
    s_cmp_eq_u32 s63, 0
    s_cbranch_scc1 SM_sF
    buffer_store_dwordx2 v[14:15], v6, s[36:39], s21 offen
SM_jF:
    s_mov_b64 exec, -1
    ds_read_b64_tr_b16 v[114:115], v21 offset:8192
    ds_read_b64_tr_b16 v[116:117], v21 offset:10240
    ds_read_b64_tr_b16 v[118:119], v22 offset:8192
    ds_read_b64_tr_b16 v[120:121], v22 offset:10240
    ds_read_b64_tr_b16 v[122:123], v23 offset:8192
    ds_read_b64_tr_b16 v[124:125], v23 offset:10240
    ds_read_b64_tr_b16 v[126:127], v24 offset:8192
    ds_read_b64_tr_b16 v[128:129], v24 offset:10240
    ds_read_b64_tr_b16 v[130:131], v21 offset:12288
    ds_read_b64_tr_b16 v[132:133], v21 offset:14336
    ds_read_b64_tr_b16 v[134:135], v22 offset:12288
    ds_read_b64_tr_b16 v[136:137], v22 offset:14336
    ds_read_b64_tr_b16 v[138:139], v23 offset:12288
    ds_read_b64_tr_b16 v[140:141], v23 offset:14336
    ds_read_b64_tr_b16 v[142:143], v24 offset:12288
    ds_read_b64_tr_b16 v[144:145], v24 offset:14336
    ds_read_b64_tr_b16 v[146:147], v21 offset:16384
    ds_read_b64_tr_b16 v[148:149], v21 offset:18432
    ds_read_b64_tr_b16 v[150:151], v22 offset:16384
    ds_read_b64_tr_b16 v[152:153], v22 offset:18432
    ds_read_b64_tr_b16 v[154:155], v23 offset:16384
    ds_read_b64_tr_b16 v[156:157], v23 offset:18432
    ds_read_b64_tr_b16 v[158:159], v24 offset:16384
    ds_read_b64_tr_b16 v[160:161], v24 offset:18432
    buffer_load_dwordx2 v[12:13], v8, s[36:39], s20 offen sc1
    s_waitcnt lgkmcnt(0)
    s_mov_b32 s9, 0
C_wl:
    ds_read_b64 v[16:17], v20 offset:96
    ds_read_b128 v[46:49], v19 offset:20480
    ds_read_b128 v[50:53], v19 offset:21504
    s_add_u32 s9, s9, 1
    s_cmp_gt_u32 s9, 1600000
    s_cbranch_scc1 C_wd
    s_waitcnt lgkmcnt(2)
    v_and_b32 v16, v16, v17
    v_cmp_eq_u32 vcc, 0, v16
    s_waitcnt lgkmcnt(0)
    s_cbranch_vccnz C_wl
C_wd:
    s_waitcnt lgkmcnt(0)
    v_mfma_f32_16x16x32_bf16 v[30:33], v[82:85], v[46:49], 0
    ds_read_b64_tr_b16 v[162:163], v21 offset:20480
    v_mfma_f32_16x16x32_bf16 v[30:33], v[98:101], v[50:53], v[30:33]
    ds_read_b64_tr_b16 v[164:165], v21 offset:22528
    v_mfma_f32_16x16x32_bf16 v[34:37], v[86:89], v[46:49], 0
    ds_read_b64_tr_b16 v[166:167], v22 offset:20480
    v_mfma_f32_16x16x32_bf16 v[34:37], v[102:105], v[50:53], v[34:37]
    ds_read_b64_tr_b16 v[168:169], v22 offset:22528
    v_mfma_f32_16x16x32_bf16 v[38:41], v[90:93], v[46:49], 0
    ds_read_b64_tr_b16 v[170:171], v23 offset:20480
    v_mfma_f32_16x16x32_bf16 v[38:41], v[106:109], v[50:53], v[38:41]
    ds_read_b64_tr_b16 v[172:173], v23 offset:22528
    v_mfma_f32_16x16x32_bf16 v[42:45], v[94:97], v[46:49], 0
    ds_read_b64_tr_b16 v[174:175], v24 offset:20480
    v_mfma_f32_16x16x32_bf16 v[42:45], v[110:113], v[50:53], v[42:45]
    ds_read_b64_tr_b16 v[176:177], v24 offset:22528
    ds_read_b64_tr_b16 v[178:179], v21 offset:24576
    ds_read_b64_tr_b16 v[180:181], v21 offset:26624
    ds_read_b64_tr_b16 v[182:183], v22 offset:24576
    ds_read_b64_tr_b16 v[184:185], v22 offset:26624
    ds_read_b64_tr_b16 v[186:187], v23 offset:24576
    ds_read_b64_tr_b16 v[188:189], v23 offset:26624
    ds_read_b64_tr_b16 v[190:191], v24 offset:24576
    ds_read_b64_tr_b16 v[192:193], v24 offset:26624
    s_mov_b32 s9, 0
P_lO:
    s_waitcnt vmcnt(0)
    v_cmp_ne_u64 vcc, s[12:13], v[12:13]
    s_nop 0
    s_cbranch_vccz P_dO
    buffer_load_dwordx2 v[12:13], v8, s[36:39], s20 offen sc1
    s_add_u32 s9, s9, 1
    s_cmp_lt_u32 s9, 200000
    s_cbranch_scc1 P_lO
    s_waitcnt vmcnt(0)
P_dO:
    buffer_load_dwordx4 v[54:57], v4, s[36:39], s1 offen offset:0 sc1
    buffer_load_dwordx4 v[58:61], v4, s[36:39], s1 offen offset:1024 sc1
    buffer_load_dwordx4 v[62:65], v4, s[36:39], s4 offen offset:0 sc1
    buffer_load_dwordx4 v[66:69], v4, s[36:39], s4 offen offset:1024 sc1
    buffer_load_dwordx4 v[70:73], v4, s[36:39], s6 offen offset:0 sc1
C_go:
    ds_read_b32 v7, v5 offset:36
    ds_read_b64_tr_b16 v[194:195], v21 offset:28672
    ds_read_b64_tr_b16 v[196:197], v21 offset:30720
    ds_read_b64_tr_b16 v[198:199], v22 offset:28672
    ds_read_b64_tr_b16 v[200:201], v22 offset:30720
    ds_read_b64_tr_b16 v[202:203], v23 offset:28672
    ds_read_b64_tr_b16 v[204:205], v23 offset:30720
    ds_read_b64_tr_b16 v[206:207], v24 offset:28672
    ds_read_b64_tr_b16 v[208:209], v24 offset:30720
    ds_read_b64_tr_b16 v[210:211], v21 offset:32768
    ds_read_b64_tr_b16 v[212:213], v21 offset:34816
    ds_read_b64_tr_b16 v[214:215], v22 offset:32768
    ds_read_b64_tr_b16 v[216:217], v22 offset:34816
    ds_read_b64_tr_b16 v[218:219], v23 offset:32768
    ds_read_b64_tr_b16 v[220:221], v23 offset:34816
    ds_read_b64_tr_b16 v[222:223], v24 offset:32768
    ds_read_b64_tr_b16 v[224:225], v24 offset:34816
    ds_read_b64_tr_b16 v[226:227], v21 offset:36864
    ds_read_b64_tr_b16 v[228:229], v21 offset:38912
    ds_read_b64_tr_b16 v[230:231], v22 offset:36864
    ds_read_b64_tr_b16 v[232:233], v22 offset:38912
    ds_read_b64_tr_b16 v[234:235], v23 offset:36864
    ds_read_b64_tr_b16 v[236:237], v23 offset:38912
    ds_read_b64_tr_b16 v[238:239], v24 offset:36864
    ds_read_b64_tr_b16 v[240:241], v24 offset:38912
    s_waitcnt vmcnt(4)
    v_mfma_f32_16x16x32_bf16 v[30:33], v[114:117], v[54:57], v[30:33]
    buffer_load_dwordx4 v[74:77], v4, s[36:39], s6 offen offset:1024 sc1
    v_mfma_f32_16x16x32_bf16 v[34:37], v[118:121], v[54:57], v[34:37]
    s_waitcnt lgkmcnt(15)
    v_cmp_gt_u32 vcc, 4, v7
    s_nop 0
    s_cbranch_vccnz C_w2
W_dW2:
    ds_read_b64_tr_b16 v[82:83], v21 offset:40960
    v_mfma_f32_16x16x32_bf16 v[38:41], v[122:125], v[54:57], v[38:41]
    ds_read_b64_tr_b16 v[84:85], v21 offset:43008
    v_mfma_f32_16x16x32_bf16 v[42:45], v[126:129], v[54:57], v[42:45]
    ds_read_b64_tr_b16 v[86:87], v22 offset:40960
    s_waitcnt vmcnt(4)
    v_mfma_f32_16x16x32_bf16 v[30:33], v[130:133], v[58:61], v[30:33]
    buffer_load_dwordx4 v[78:81], v4, s[36:39], s24 offen offset:0 sc1
    v_mfma_f32_16x16x32_bf16 v[34:37], v[134:137], v[58:61], v[34:37]
    ds_read_b64_tr_b16 v[88:89], v22 offset:43008
    v_mfma_f32_16x16x32_bf16 v[38:41], v[138:141], v[58:61], v[38:41]
    ds_read_b64_tr_b16 v[90:91], v23 offset:40960
    v_mfma_f32_16x16x32_bf16 v[42:45], v[142:145], v[58:61], v[42:45]
    ds_read_b64_tr_b16 v[92:93], v23 offset:43008
    s_waitcnt vmcnt(4)
    v_mfma_f32_16x16x32_bf16 v[30:33], v[146:149], v[62:65], v[30:33]
    buffer_load_dwordx4 v[46:49], v4, s[36:39], s24 offen offset:1024 sc1
    v_mfma_f32_16x16x32_bf16 v[34:37], v[150:153], v[62:65], v[34:37]
    ds_read_b64_tr_b16 v[94:95], v24 offset:40960
    v_mfma_f32_16x16x32_bf16 v[38:41], v[154:157], v[62:65], v[38:41]
    ds_read_b64_tr_b16 v[96:97], v24 offset:43008
    v_mfma_f32_16x16x32_bf16 v[42:45], v[158:161], v[62:65], v[42:45]
    ds_read_b64_tr_b16 v[98:99], v21 offset:45056
    s_waitcnt vmcnt(4)
    v_mfma_f32_16x16x32_bf16 v[30:33], v[162:165], v[66:69], v[30:33]
    buffer_load_dwordx4 v[50:53], v4, s[36:39], s25 offen offset:0 sc1
    v_mfma_f32_16x16x32_bf16 v[34:37], v[166:169], v[66:69], v[34:37]
    ds_read_b64_tr_b16 v[100:101], v21 offset:47104
    v_mfma_f32_16x16x32_bf16 v[38:41], v[170:173], v[66:69], v[38:41]
    ds_read_b64_tr_b16 v[102:103], v22 offset:45056
    v_mfma_f32_16x16x32_bf16 v[42:45], v[174:177], v[66:69], v[42:45]
    ds_read_b64_tr_b16 v[104:105], v22 offset:47104
    s_waitcnt vmcnt(4)
    v_mfma_f32_16x16x32_bf16 v[30:33], v[178:181], v[70:73], v[30:33]
    buffer_load_dwordx4 v[54:57], v4, s[36:39], s25 offen offset:1024 sc1
    v_mfma_f32_16x16x32_bf16 v[34:37], v[182:185], v[70:73], v[34:37]
    ds_read_b64_tr_b16 v[106:107], v23 offset:45056
    v_mfma_f32_16x16x32_bf16 v[38:41], v[186:189], v[70:73], v[38:41]
    ds_read_b64_tr_b16 v[108:109], v23 offset:47104
    v_mfma_f32_16x16x32_bf16 v[42:45], v[190:193], v[70:73], v[42:45]
    ds_read_b64_tr_b16 v[110:111], v24 offset:45056
    s_waitcnt vmcnt(4)
    v_mfma_f32_16x16x32_bf16 v[30:33], v[194:197], v[74:77], v[30:33]
    buffer_load_dwordx4 v[58:61], v4, s[36:39], s26 offen offset:0 sc1
    v_mfma_f32_16x16x32_bf16 v[34:37], v[198:201], v[74:77], v[34:37]
    ds_read_b64_tr_b16 v[112:113], v24 offset:47104
    v_mfma_f32_16x16x32_bf16 v[38:41], v[202:205], v[74:77], v[38:41]
    ds_read_b64_tr_b16 v[114:115], v21 offset:49152
    v_mfma_f32_16x16x32_bf16 v[42:45], v[206:209], v[74:77], v[42:45]
    ds_read_b64_tr_b16 v[116:117], v21 offset:51200
    s_waitcnt vmcnt(4)
    s_waitcnt lgkmcnt(15)
    v_mfma_f32_16x16x32_bf16 v[30:33], v[210:213], v[78:81], v[30:33]
    buffer_load_dwordx4 v[62:65], v4, s[36:39], s26 offen offset:1024 sc1
    v_mfma_f32_16x16x32_bf16 v[34:37], v[214:217], v[78:81], v[34:37]
    ds_read_b64_tr_b16 v[118:119], v22 offset:49152
    v_mfma_f32_16x16x32_bf16 v[38:41], v[218:221], v[78:81], v[38:41]
    ds_read_b64_tr_b16 v[120:121], v22 offset:51200
    v_mfma_f32_16x16x32_bf16 v[42:45], v[222:225], v[78:81], v[42:45]
    ds_read_b64_tr_b16 v[122:123], v23 offset:49152
    s_waitcnt vmcnt(4)
    v_mfma_f32_16x16x32_bf16 v[30:33], v[226:229], v[46:49], v[30:33]
    ds_read_b64_tr_b16 v[124:125], v23 offset:51200
    ds_read_b64_tr_b16 v[126:127], v24 offset:49152
    v_mfma_f32_16x16x32_bf16 v[34:37], v[230:233], v[46:49], v[34:37]
    ds_read_b64_tr_b16 v[128:129], v24 offset:51200
    v_mfma_f32_16x16x32_bf16 v[38:41], v[234:237], v[46:49], v[38:41]
    ds_read_b64_tr_b16 v[130:131], v21 offset:53248
    v_mfma_f32_16x16x32_bf16 v[42:45], v[238:241], v[46:49], v[42:45]
    ds_read_b64_tr_b16 v[132:133], v21 offset:55296
    s_waitcnt vmcnt(3)
    v_mfma_f32_16x16x32_bf16 v[30:33], v[82:85], v[50:53], v[30:33]
    ds_read_b64_tr_b16 v[134:135], v22 offset:53248
    ds_read_b64_tr_b16 v[136:137], v22 offset:55296
    s_waitcnt lgkmcnt(15)
    v_mfma_f32_16x16x32_bf16 v[34:37], v[86:89], v[50:53], v[34:37]
    ds_read_b64_tr_b16 v[138:139], v23 offset:53248
    ds_read_b64_tr_b16 v[140:141], v23 offset:55296
    v_mfma_f32_16x16x32_bf16 v[38:41], v[90:93], v[50:53], v[38:41]
    ds_read_b64_tr_b16 v[142:143], v24 offset:53248
    ds_read_b64_tr_b16 v[144:145], v24 offset:55296
    v_mfma_f32_16x16x32_bf16 v[42:45], v[94:97], v[50:53], v[42:45]
    s_waitcnt vmcnt(2)
    v_mfma_f32_16x16x32_bf16 v[30:33], v[98:101], v[54:57], v[30:33]
    v_mfma_f32_16x16x32_bf16 v[34:37], v[102:105], v[54:57], v[34:37]
    s_waitcnt lgkmcnt(15)
    v_mfma_f32_16x16x32_bf16 v[38:41], v[106:109], v[54:57], v[38:41]
    v_mfma_f32_16x16x32_bf16 v[42:45], v[110:113], v[54:57], v[42:45]
    s_waitcnt vmcnt(1)
    s_waitcnt lgkmcnt(14)
    v_mfma_f32_16x16x32_bf16 v[30:33], v[114:117], v[58:61], v[30:33]
    s_waitcnt lgkmcnt(12)
    v_mfma_f32_16x16x32_bf16 v[34:37], v[118:121], v[58:61], v[34:37]
    s_waitcnt lgkmcnt(10)
    v_mfma_f32_16x16x32_bf16 v[38:41], v[122:125], v[58:61], v[38:41]
    s_waitcnt lgkmcnt(8)
    v_mfma_f32_16x16x32_bf16 v[42:45], v[126:129], v[58:61], v[42:45]
    s_waitcnt vmcnt(0)
    s_waitcnt lgkmcnt(6)
    v_mfma_f32_16x16x32_bf16 v[30:33], v[130:133], v[62:65], v[30:33]
    s_waitcnt lgkmcnt(4)
    v_mfma_f32_16x16x32_bf16 v[34:37], v[134:137], v[62:65], v[34:37]
    s_waitcnt lgkmcnt(2)
    v_mfma_f32_16x16x32_bf16 v[38:41], v[138:141], v[62:65], v[38:41]
    s_waitcnt lgkmcnt(0)
    v_mfma_f32_16x16x32_bf16 v[42:45], v[142:145], v[62:65], v[42:45]
    s_nop 1
    v_cvt_pk_bf16_f32 v162, v30, v31
    v_cvt_pk_bf16_f32 v163, v32, v33
    ds_write_b64 v25, v[162:163]
    v_cvt_pk_bf16_f32 v164, v34, v35
    v_cvt_pk_bf16_f32 v165, v36, v37
    ds_write_b64 v26, v[164:165]
    v_cvt_pk_bf16_f32 v166, v38, v39
    v_cvt_pk_bf16_f32 v167, v40, v41
    ds_write_b64 v27, v[166:167]
    v_cvt_pk_bf16_f32 v168, v42, v43
    v_cvt_pk_bf16_f32 v169, v44, v45
    ds_write_b64 v28, v[168:169]
    ds_read_b128 v[178:181], v9
    ds_read_b128 v[182:185], v9 offset:1024
    s_waitcnt lgkmcnt(1)
    buffer_store_dwordx4 v[178:181], v10, s[32:35], s23 offen nt
    s_waitcnt lgkmcnt(0)
    buffer_store_dwordx4 v[182:185], v10, s[32:35], s28 offen nt
    s_add_u32 s40, s7, s62
    s_cmp_lg_u32 s40, 0
    s_cbranch_scc1 C_end
    s_add_u32 s40, s10, 16
    v_mov_b32 v2, s40
    s_lshl_b32 s40, s8, 7
    s_mov_b64 exec, 1
    buffer_store_dword v2, v6, s[36:39], s40 offen
C_end:
    s_endpgm
K_cold:
X_cH:
    s_mov_b32 s9, 0
X_lH:
    v_cmp_ne_u64 vcc, s[28:29], v[18:19]
    s_nop 0
    s_cbranch_vccz X_okH
    v_subrev_u32 v18, s12, v18
    v_cmp_ne_u32 s[42:43], s13, v19
    v_cmp_le_u32 vcc, 8, v18
    s_nop 0
    s_or_b64 vcc, vcc, s[42:43]
    s_cbranch_vccz X_nH
    buffer_load_dwordx2 v[18:19], v20, s[36:39], s30 offen sc1
    s_add_u32 s9, s9, 1
    s_cmp_lt_u32 s9, 200000
    s_waitcnt vmcnt(0)
    s_cbranch_scc1 X_lH
X_nH:
    s_mov_b32 s101, 0
    s_branch X_okH
S_cls0:
    v_cmp_eq_u32 s[42:43], 0, v3
    v_cvt_pk_bf16_f32 v28, v102, 0
    v_cvt_pk_bf16_f32 v36, -v106, 0
    v_cndmask_b32 v103, v103, 0, s[42:43]
    v_cndmask_b32 v107, v107, -1.0, s[42:43]
    v_cvt_pk_bf16_f32 v29, v103, 0
    v_cvt_pk_bf16_f32 v37, -v107, 0
    v_cvt_pk_bf16_f32 v30, v104, 0
    v_cvt_pk_bf16_f32 v38, -v108, 0
    v_cndmask_b32 v105, v105, 0, s[42:43]
    v_cndmask_b32 v109, v109, -1.0, s[42:43]
    v_cvt_pk_bf16_f32 v31, v105, 0
    v_cvt_pk_bf16_f32 v39, -v109, 0
    v_cvt_pk_bf16_f32 v32, v110, 0
    v_cvt_pk_bf16_f32 v40, -v114, 0
    v_cndmask_b32 v111, v111, 0, s[42:43]
    v_cndmask_b32 v115, v115, -1.0, s[42:43]
    v_cvt_pk_bf16_f32 v33, v111, 0
    v_cvt_pk_bf16_f32 v41, -v115, 0
    v_cvt_pk_bf16_f32 v34, v112, 0
    v_cvt_pk_bf16_f32 v42, -v116, 0
    v_cndmask_b32 v113, v113, 0, s[42:43]
    v_cndmask_b32 v117, v117, -1.0, s[42:43]
    v_cvt_pk_bf16_f32 v35, v113, 0
    v_cvt_pk_bf16_f32 v43, -v117, 0
    v_lshl_add_u32 v4, v3, 6, 32
    v_cvt_f32_u32 v96, v4
    v_mul_f32 v96, 0x3a000000, v96
    v_lshlrev_b32 v4, 2, v2
    v_cvt_f32_u32 v4, v4
    v_mul_f32 v97, v96, v4
    v_cos_f32 v118, v96
    s_nop 0
    v_add_f32 v118, v118, v118
    v_fmamk_f32 v102, v96, 0x0, v97
    v_fmamk_f32 v103, v96, 0x3f800000, v97
    v_fmamk_f32 v106, v96, 0x0, v97
    v_fmamk_f32 v107, v96, 0x3f800000, v97
    v_fmamk_f32 v110, v96, 0x41800000, v97
    v_fmamk_f32 v111, v96, 0x41880000, v97
    v_fmamk_f32 v114, v96, 0x41800000, v97
    v_fmamk_f32 v115, v96, 0x41880000, v97
    v_cos_f32 v102, v102
    v_cos_f32 v103, v103
    v_sin_f32 v106, v106
    v_sin_f32 v107, v107
    v_cos_f32 v110, v110
    v_cos_f32 v111, v111
    v_sin_f32 v114, v114
    v_sin_f32 v115, v115
    v_fma_f32 v104, v118, v103, -v102
    v_fma_f32 v108, v118, v107, -v106
    v_fma_f32 v112, v118, v111, -v110
    v_fma_f32 v116, v118, v115, -v114
    v_fma_f32 v105, v118, v104, -v103
    v_fma_f32 v109, v118, v108, -v107
    v_fma_f32 v113, v118, v112, -v111
    v_fma_f32 v117, v118, v116, -v115
    v_cvt_pk_bf16_f32 v44, 0, v102
    v_cvt_pk_bf16_f32 v52, 0, -v106
    v_cvt_pk_bf16_f32 v45, 0, v103
    v_cvt_pk_bf16_f32 v53, 0, -v107
    v_cvt_pk_bf16_f32 v46, 0, v104
    v_cvt_pk_bf16_f32 v54, 0, -v108
    v_cvt_pk_bf16_f32 v47, 0, v105
    v_cvt_pk_bf16_f32 v55, 0, -v109
    v_cvt_pk_bf16_f32 v48, 0, v110
    v_cvt_pk_bf16_f32 v56, 0, -v114
    v_cvt_pk_bf16_f32 v49, 0, v111
    v_cvt_pk_bf16_f32 v57, 0, -v115
    v_cvt_pk_bf16_f32 v50, 0, v112
    v_cvt_pk_bf16_f32 v58, 0, -v116
    v_cvt_pk_bf16_f32 v51, 0, v113
    v_cvt_pk_bf16_f32 v59, 0, -v117
    s_branch S_reg
S_gr:
    s_add_u32 s9, s9, 1
    s_cmp_gt_u32 s9, 200000
    s_cbranch_scc1 S_gk
    buffer_load_dwordx4 v60, s[36:39], s60 offen offset:0 sc1 lds
    buffer_load_dwordx4 v60, s[36:39], s60 offen offset:1024 sc1 lds
    buffer_load_dwordx4 v60, s[36:39], s60 offen offset:2048 sc1 lds
    buffer_load_dwordx4 v60, s[36:39], s60 offen offset:3072 sc1 lds
    s_waitcnt lgkmcnt(0)
    s_branch S_gc
S_y0:
    v_cmp_eq_u32 s[42:43], 0, v3
    v_mfma_f32_16x16x32_bf16 v[28:31], v[120:123], v[200:203], 0
    v_mfma_f32_16x16x32_bf16 v[28:31], v[124:127], v[204:207], v[28:31]
    v_mfma_f32_16x16x32_bf16 v[32:35], v[128:131], v[208:211], 0
    v_mfma_f32_16x16x32_bf16 v[32:35], v[132:135], v[212:215], v[32:35]
    v_mfma_f32_16x16x32_bf16 v[36:39], v[152:155], v[184:187], 0
    v_mfma_f32_16x16x32_bf16 v[36:39], v[156:159], v[188:191], v[36:39]
    v_mfma_f32_16x16x32_bf16 v[40:43], v[160:163], v[192:195], 0
    v_mfma_f32_16x16x32_bf16 v[40:43], v[164:167], v[196:199], v[40:43]
    s_nop 1
    v_cndmask_b32 v224, v224, v28, s[42:43]
    v_cndmask_b32 v225, v225, v29, s[42:43]
    v_cndmask_b32 v226, v226, v30, s[42:43]
    v_cndmask_b32 v227, v227, v31, s[42:43]
    v_cndmask_b32 v228, v228, v32, s[42:43]
    v_cndmask_b32 v229, v229, v33, s[42:43]
    v_cndmask_b32 v230, v230, v34, s[42:43]
    v_cndmask_b32 v231, v231, v35, s[42:43]
    v_cndmask_b32 v240, v240, v36, s[42:43]
    v_cndmask_b32 v241, v241, v37, s[42:43]
    v_cndmask_b32 v242, v242, v38, s[42:43]
    v_cndmask_b32 v243, v243, v39, s[42:43]
    v_cndmask_b32 v244, v244, v40, s[42:43]
    v_cndmask_b32 v245, v245, v41, s[42:43]
    v_cndmask_b32 v246, v246, v42, s[42:43]
    v_cndmask_b32 v247, v247, v43, s[42:43]
    s_branch S_y1
C_mr0:
    s_mov_b32 s9, 0
W_lM0:
    ds_read_b32 v2, v5 offset:4
    s_add_u32 s9, s9, 1
    s_cmp_gt_u32 s9, 1600000
    s_cbranch_scc1 W_dM0
    s_waitcnt lgkmcnt(0)
    v_cmp_gt_u32 vcc, 1, v2
    s_nop 0
    s_cbranch_vccnz W_lM0
W_dM0:
    s_waitcnt lgkmcnt(0)
    v_readfirstlane_b32 s63, v2
    s_nop 0
    s_lshr_b32 s63, s63, 1
    s_branch C_md0
SM_sS0:
    buffer_store_dwordx4 v[98:101], v4, s[36:39], s15 offen sc1
    s_branch SM_jS0
C_vr0:
    s_mov_b32 s9, 0
W_lV0:
    ds_read_b32 v2, v5 offset:32
    s_add_u32 s9, s9, 1
    s_cmp_gt_u32 s9, 1600000
    s_cbranch_scc1 W_dV0
    s_waitcnt lgkmcnt(0)
    v_cmp_gt_u32 vcc, 4, v2
    s_nop 0
    s_cbranch_vccnz W_lV0
W_dV0:
    ds_read_b64_tr_b16 v[170:171], v39 offset:32768
    ds_read_b64_tr_b16 v[172:173], v39 offset:33280
    ds_read_b64_tr_b16 v[174:175], v40 offset:32768
    ds_read_b64_tr_b16 v[176:177], v40 offset:33280
    ds_read_b64_tr_b16 v[202:203], v39 offset:36864
    ds_read_b64_tr_b16 v[204:205], v39 offset:37376
    ds_read_b64_tr_b16 v[206:207], v40 offset:36864
    ds_read_b64_tr_b16 v[208:209], v40 offset:37376
    s_waitcnt lgkmcnt(0)
    s_branch C_vd0
C_mr1:
    s_mov_b32 s9, 0
W_lM1:
    ds_read_b32 v2, v5 offset:4
    s_add_u32 s9, s9, 1
    s_cmp_gt_u32 s9, 1600000
    s_cbranch_scc1 W_dM1
    s_waitcnt lgkmcnt(0)
    v_cmp_gt_u32 vcc, 1, v2
    s_nop 0
    s_cbranch_vccnz W_lM1
W_dM1:
    s_waitcnt lgkmcnt(0)
    v_readfirstlane_b32 s63, v2
    s_nop 0
    s_lshr_b32 s63, s63, 1
    s_branch C_md1
SM_sS1:
    buffer_store_dwordx4 v[98:101], v4, s[36:39], s15 offen sc1
    s_branch SM_jS1
C_vr1:
    s_mov_b32 s9, 0
W_lV1:
    ds_read_b32 v2, v5 offset:32
    s_add_u32 s9, s9, 1
    s_cmp_gt_u32 s9, 1600000
    s_cbranch_scc1 W_dV1
    s_waitcnt lgkmcnt(0)
    v_cmp_gt_u32 vcc, 4, v2
    s_nop 0
    s_cbranch_vccnz W_lV1
W_dV1:
    ds_read_b64_tr_b16 v[170:171], v39 offset:32768
    ds_read_b64_tr_b16 v[172:173], v39 offset:33280
    ds_read_b64_tr_b16 v[174:175], v40 offset:32768
    ds_read_b64_tr_b16 v[176:177], v40 offset:33280
    ds_read_b64_tr_b16 v[202:203], v39 offset:36864
    ds_read_b64_tr_b16 v[204:205], v39 offset:37376
    ds_read_b64_tr_b16 v[206:207], v40 offset:36864
    ds_read_b64_tr_b16 v[208:209], v40 offset:37376
    s_waitcnt lgkmcnt(0)
    s_branch C_vd1
C_pr:
    s_mov_b32 s9, 0
C_pl:
    ds_read_b32 v53, v52 offset:40
    ds_read_b128 v[82:85], v48 offset:12288
    ds_read_b128 v[86:89], v48 offset:13312
    s_add_u32 s9, s9, 1
    s_cmp_gt_u32 s9, 1600000
    s_waitcnt lgkmcnt(0)
    s_cbranch_scc1 C_pd
    v_cmp_eq_u32 vcc, 0, v53
    s_nop 0
    s_cbranch_vccnz C_pl
    s_branch C_pd
SM_sO:
    s_nop 7
    v_cvt_pk_bf16_f32 v58, v66, v67
    v_cvt_pk_bf16_f32 v59, v68, v69
    v_cvt_pk_bf16_f32 v60, v70, v71
    v_cvt_pk_bf16_f32 v61, v72, v73
    buffer_store_dwordx4 v[58:61], v4, s[36:39], s100 offen sc1
    v_cvt_pk_bf16_f32 v62, v74, v75
    v_cvt_pk_bf16_f32 v63, v76, v77
    v_cvt_pk_bf16_f32 v64, v78, v79
    v_cvt_pk_bf16_f32 v65, v80, v81
    buffer_store_dwordx4 v[62:65], v4, s[36:39], s19 offen sc1
    s_branch SM_jO
SM_sF:
    buffer_store_dwordx2 v[14:15], v6, s[36:39], s21 offen sc1
    s_branch SM_jF
C_w2:
    s_mov_b32 s9, 0
W_lW3:
    ds_read_b32 v2, v5 offset:36
    s_add_u32 s9, s9, 1
    s_cmp_gt_u32 s9, 1600000
    s_cbranch_scc1 W_dW3
    s_waitcnt lgkmcnt(0)
    v_cmp_gt_u32 vcc, 4, v2
    s_nop 0
    s_cbranch_vccnz W_lW3
W_dW3:
    s_waitcnt lgkmcnt(0)
    s_branch W_dW2
K_exit:
    s_endpgm
.fill 7168, 4, 0xbf810000
.section .rodata,"a"
.p2align 6
.amdhsa_kernel concat_heads__sliding_local_dilated__spectral_fnet__prompt_kernel
  .amdhsa_next_free_vgpr 256
  .amdhsa_next_free_sgpr 102
  .amdhsa_accum_offset 256
  .amdhsa_group_segment_fixed_size 0
  .amdhsa_kernarg_size 88
  .amdhsa_user_sgpr_count 2
  .amdhsa_user_sgpr_kernarg_segment_ptr 1
  .amdhsa_system_sgpr_workgroup_id_x 1
.end_amdhsa_kernel
```

```asm
; @launch grid=(256,1,1) block=(512,1,1) lds=163840
.amdgcn_target "amdgcn-amd-amdhsa--gfx950"
.text
.p2align 12
.fill 832, 4, 0xbf810000
.globl concat_heads__sliding_local_dilated__spectral_fnet__prompt_kernel
.p2align 8
.type concat_heads__sliding_local_dilated__spectral_fnet__prompt_kernel,@function
concat_heads__sliding_local_dilated__spectral_fnet__prompt_kernel:
    s_load_dwordx2 s[16:17], s[0:1], 0
    s_load_dwordx2 s[20:21], s[0:1], 8
    s_load_dwordx2 s[28:29], s[0:1], 24
    s_load_dwordx2 s[36:37], s[0:1], 80
    s_load_dwordx2 s[24:25], s[0:1], 16
    s_load_dwordx2 s[32:33], s[0:1], 64
    v_lshrrev_b32 v1, 6, v0
    s_cmp_ge_u32 s2, 256
    s_cbranch_scc1 K_exit
    v_readfirstlane_b32 s3, v1
    s_and_b32 s4, s2, 7
    s_lshr_b32 s5, s2, 3
    s_sub_u32 s5, s5, 4
    s_and_b32 s5, s5, 31
    s_cmp_lg_u32 s3, 7
    s_cbranch_scc1 K_nopf
    s_getpc_b64 s[44:45]
    s_mov_b32 s46, 28672
    s_mov_b32 s47, 0x00020000
    s_mul_i32 s40, s5, 896
    v_and_b32 v1, 63, v0
    v_min_u32 v1, 6, v1
    v_lshlrev_b32 v1, 7, v1
    buffer_load_dword v255, v1, s[44:47], s40 offen
K_nopf:
    s_mul_i32 s6, s5, 37
    s_lshr_b32 s6, s6, 8
    s_mul_i32 s40, s6, 7
    s_sub_u32 s7, s5, s40
    s_mov_b32 s38, 0x10000000
    s_mov_b32 s39, 0x00020000
    s_lshl_b32 s8, s4, 2
    s_cmp_lt_u32 s5, 28
    s_cbranch_scc1 K_a
    s_add_u32 s8, s8, s7
    s_mov_b32 s30, 1835008
    s_mov_b32 s31, 0x00020000
    s_lshl_b32 s40, s3, 7
    s_add_u32 s40, s40, s8
    v_and_b32 v4, 32, v0
    v_add_u32 v4, s40, v4
    v_and_b32 v5, 31, v0
    v_lshlrev_b32 v5, 4, v5
    v_mov_b32 v6, 896
    v_mad_u32_u24 v7, v4, v6, v5
    v_add_u32 v5, 384, v5
    v_sub_u32 v8, 960, v4
    v_mad_u32_u24 v8, v8, v6, v5
    v_sub_u32 v9, 2048, v4
    v_and_b32 v9, 2047, v9
    v_mad_u32_u24 v9, v9, v6, v5
    s_lshl_b32 s42, s3, 13
    s_mov_b32 m0, s42
    s_mov_b32 s52, 57344
    s_mov_b32 s53, 917504
    s_mov_b32 s54, 974848
    s_waitcnt lgkmcnt(0)
    s_load_dwordx2 s[10:11], s[36:37], 4096
    s_branch K_spare2
K_a:
    s_add_u32 s8, s8, s6
    s_cmp_ge_u32 s3, 4
    s_cbranch_scc1 K_c
    s_setprio 2
    s_mov_b32 s44, s4
    s_add_u32 s44, s44, s7
    s_mul_i32 s40, s44, 65
    s_lshr_b32 s40, s40, 8
    s_mul_i32 s40, s40, 4
    s_sub_u32 s44, s44, s40
    s_lshl_b32 s44, s44, 2
    s_lshr_b32 s44, 0x6420, s44
    s_and_b32 s44, s44, 7
    s_mov_b32 s18, 1835008
    s_mov_b32 s19, 0x00020000
    s_mov_b32 s22, 1204224
    s_mov_b32 s23, 0x00020000
    v_and_b32 v1, 63, v0
    v_lshrrev_b32 v6, 3, v1
    v_and_b32 v7, 7, v1
    v_lshrrev_b32 v8, 4, v1
    v_xor_b32 v3, v7, v8
    v_mul_u32_u24 v23, 896, v6
    v_lshl_add_u32 v21, v3, 4, v23
    v_xor_b32 v22, 64, v21
    v_add_u32 v22, 6144, v22
    s_and_b32 s43, s3, 1
    s_lshl_b32 s40, s43, 6
    v_xor_b32 v23, s40, v21
    s_lshl_b32 s40, s43, 1
    s_sub_u32 s40, 2, s40
    v_sub_u32 v2, s40, v6
    v_max_i32 v2, 0, v2
    v_mul_u32_u24 v2, 896, v2
    v_add_u32 v23, v23, v2
    v_and_b32 v2, 2, v6
    v_xor_b32 v2, v7, v2
    v_mul_u32_u24 v3, 2688, v6
    v_lshl_add_u32 v24, v2, 4, v3
    v_xor_b32 v25, 64, v24
    v_add_u32 v25, 20480, v25
    v_add_u32 v26, 896, v24
    v_add_u32 v27, 896, v25
    v_add_u32 v28, 1792, v24
    v_add_u32 v29, 1792, v25
    s_mov_b32 s45, s44
    s_lshl_b32 s40, s8, 6
    s_lshl_b32 s41, s3, 4
    s_add_u32 s42, s40, s41
    s_mul_i32 s46, s42, 896
    s_mul_i32 s48, s41, 2688
    s_lshl_b32 s42, s7, 7
    s_add_u32 s48, s48, s42
    s_sub_u32 s40, s40, 16
    s_max_i32 s40, s40, 0
    s_lshl_b32 s41, s43, 3
    s_add_u32 s40, s40, s41
    s_mul_i32 s47, s40, 896
    s_lshl_b32 s50, s3, 11
    s_lshr_b32 s41, s3, 1
    s_mul_i32 s41, s41, 10240
    s_lshl_b32 s49, s43, 10
    s_add_u32 s49, s49, s41
    s_lshl_b32 s40, s44, 7
    s_add_u32 s51, s40, s46
    s_mul_i32 s53, s44, 172032
    s_add_u32 s53, s53, s48
    s_add_u32 m0, s50, 2048
    s_add_u32 s44, s44, 1
    s_cmp_eq_u32 s44, 7
    s_cselect_b32 s44, 0, s44
    s_waitcnt lgkmcnt(0)
    buffer_load_dwordx4 v21, s[16:19], s51 offen lds
    buffer_load_dwordx4 v22, s[16:19], s51 offen offset:1024 lds
    s_lshl_b32 s41, s44, 7
    s_cmp_lt_u32 s3, 2
    s_cselect_b32 s52, s40, s41
    s_add_u32 m0, s49, 0
    s_add_u32 s52, s52, s47
    buffer_load_dwordx4 v23, s[16:19], s52 offen lds
    s_add_u32 m0, s50, 79872
    s_nop 0
    buffer_load_dwordx4 v24, s[20:23], s53 offen lds
    buffer_load_dwordx4 v25, s[20:23], s53 offen offset:1024 lds
    s_add_u32 m0, s50, 88064
    s_nop 0
    buffer_load_dwordx4 v26, s[20:23], s53 offen lds
    buffer_load_dwordx4 v27, s[20:23], s53 offen offset:1024 lds
    s_add_u32 m0, s50, 96256
    s_mul_i32 s53, s45, 172032
    s_add_u32 s53, s53, s48
    s_add_u32 s45, s45, 1
    s_cmp_eq_u32 s45, 7
    s_cselect_b32 s45, 0, s45
    buffer_load_dwordx4 v28, s[20:23], s53 offen lds
    buffer_load_dwordx4 v29, s[20:23], s53 offen offset:1024 lds
    s_lshl_b32 s40, s44, 7
    s_add_u32 s51, s40, s46
    s_mul_i32 s53, s44, 172032
    s_add_u32 s53, s53, s48
    s_add_u32 m0, s50, 12288
    s_add_u32 s44, s44, 1
    s_cmp_eq_u32 s44, 7
    s_cselect_b32 s44, 0, s44
    buffer_load_dwordx4 v21, s[16:19], s51 offen lds
    buffer_load_dwordx4 v22, s[16:19], s51 offen offset:1024 lds
    s_lshl_b32 s56, s8, 7
    s_load_dwordx2 s[10:11], s[36:37], s56
    s_lshl_b32 s30, s8, 10
    s_add_u32 s30, s30, 65536
    s_getreg_b32 s28, hwreg(HW_REG_XCC_ID, 0, 3)
    v_min_u32 v20, 6, v1
    v_lshlrev_b32 v20, 3, v20
    s_mov_b32 s26, 401408
    s_mov_b32 s27, 0x00020000
    s_mov_b32 s34, 3670016
    s_mov_b32 s35, 0x00020000
    s_lshr_b32 s58, s3, 1
    s_and_b32 s59, s3, 1
    v_and_b32 v9, 15, v1
    v_mov_b32 v4, 0
    v_mov_b32 v14, 1
    v_mov_b32 v5, 161792
    v_and_b32 v50, 6, v6
    v_xor_b32 v50, v7, v50
    v_mul_u32_u24 v51, 896, v6
    v_lshl_add_u32 v10, v50, 4, v51
    v_add_u32 v11, 6144, v10
    s_mov_b32 s54, s6
    s_mul_i32 s55, s3, 14336
    s_lshl_b32 s56, s7, 7
    s_add_u32 s55, s55, s56
    s_and_b32 s56, s3, 1
    s_lshl_b32 s57, s7, 1
    s_add_u32 s56, s56, s57
    s_lshl_b32 s15, s56, 10
    s_lshl_b32 s56, s8, 2
    s_and_b32 s57, s3, 2
    s_add_u32 s56, s56, s57
    s_mul_i32 s57, s56, 14336
    s_add_u32 s15, s15, s57
    s_add_u32 s15, s15, 2097152
    s_lshl_b32 s100, s56, 6
    s_add_u32 s100, s100, 16384
    v_lshlrev_b32 v50, 7, v7
    v_and_b32 v51, 1, v6
    v_mul_u32_u24 v51, 14336, v51
    v_add3_u32 v12, v50, v51, s15
    v_mov_b32 v50, s100
    v_cmp_le_u32 vcc, 16, v1
    s_nop 1
    v_cndmask_b32 v12, v12, v50, vcc
    v_and_b32 v50, 1, v9
    v_cmp_eq_u32 s[42:43], 1, v50
    v_lshl_add_u32 v50, v8, 2, v50
    v_cmp_le_u32 s[0:1], v50, v9
    v_add_u32 v50, 2, v50
    v_cmp_le_u32 s[12:13], v50, v9
    v_mov_b32 v50, 0xffff
    v_mov_b32 v51, 0xffff0000
    v_cndmask_b32 v50, v50, v51, s[42:43]
    v_cndmask_b32 v52, v50, 0, s[0:1]
    v_cndmask_b32 v53, v50, 0, s[12:13]
    v_cndmask_b32 v54, 0, v50, s[0:1]
    v_cndmask_b32 v55, 0, v50, s[12:13]
    v_lshlrev_b32 v50, 4, v1
    s_add_u32 s56, s50, 4096
    v_add_u32 v56, s56, v50
    s_xor_b32 s56, s50, 2048
    s_add_u32 s56, s56, 4096
    v_add_u32 v57, s56, v50
    v_add_u32 v59, s50, v50
    v_lshl_add_u32 v58, s58, 3, v5
    v_lshl_add_u32 v60, s3, 2, v5
    s_cmp_eq_u32 s7, 3
    s_cselect_b32 s56, 0, 1.0
    v_mov_b32 v61, s56
    s_mov_b32 s31, 0x3e8b97f6
K_h2:
    s_add_u32 m0, s50, 104448
    s_nop 0
    buffer_load_dwordx4 v24, s[20:23], s53 offen lds
    buffer_load_dwordx4 v25, s[20:23], s53 offen offset:1024 lds
    s_add_u32 m0, s50, 112640
    s_nop 0
    buffer_load_dwordx4 v26, s[20:23], s53 offen lds
    buffer_load_dwordx4 v27, s[20:23], s53 offen offset:1024 lds
    s_add_u32 m0, s50, 120832
    s_mul_i32 s53, s45, 172032
    s_add_u32 s53, s53, s48
    s_add_u32 s45, s45, 1
    s_cmp_eq_u32 s45, 7
    s_cselect_b32 s45, 0, s45
    buffer_load_dwordx4 v28, s[20:23], s53 offen lds
    buffer_load_dwordx4 v29, s[20:23], s53 offen offset:1024 lds
    s_lshl_b32 s40, s44, 7
    s_add_u32 s51, s40, s46
    s_mul_i32 s53, s44, 172032
    s_add_u32 s53, s53, s48
    s_add_u32 m0, s50, 22528
    s_add_u32 s44, s44, 1
    s_cmp_eq_u32 s44, 7
    s_cselect_b32 s44, 0, s44
    buffer_load_dwordx4 v21, s[16:19], s51 offen lds
    buffer_load_dwordx4 v22, s[16:19], s51 offen offset:1024 lds
    s_waitcnt lgkmcnt(0)
    s_add_u32 s12, s10, 0x5a3c9671
    s_xor_b32 s13, s11, 0x2b7e1516
    s_add_u32 s28, s28, s12
    s_mov_b32 s29, s13
    s_waitcnt vmcnt(10)
    s_barrier
    s_lshl_b32 s41, s44, 7
    s_cmp_lt_u32 s3, 2
    s_cselect_b32 s52, s40, s41
    s_add_u32 m0, s49, 20480
    s_add_u32 s52, s52, s47
    buffer_load_dwordx4 v23, s[16:19], s52 offen lds
    s_add_u32 m0, s50, 129024
    s_nop 0
    buffer_load_dwordx4 v24, s[20:23], s53 offen lds
    buffer_load_dwordx4 v25, s[20:23], s53 offen offset:1024 lds
    s_add_u32 m0, s50, 137216
    s_nop 0
    buffer_load_dwordx4 v26, s[20:23], s53 offen lds
    buffer_load_dwordx4 v27, s[20:23], s53 offen offset:1024 lds
    s_add_u32 m0, s50, 145408
    s_mul_i32 s53, s45, 172032
    s_add_u32 s53, s53, s48
    s_add_u32 s45, s45, 1
    s_cmp_eq_u32 s45, 7
    s_cselect_b32 s45, 0, s45
    buffer_load_dwordx4 v28, s[20:23], s53 offen lds
    buffer_load_dwordx4 v29, s[20:23], s53 offen offset:1024 lds
    s_lshl_b32 s40, s44, 7
    s_add_u32 s51, s40, s46
    s_mul_i32 s53, s44, 172032
    s_add_u32 s53, s53, s48
    s_add_u32 m0, s50, 32768
    s_add_u32 s44, s44, 1
    s_cmp_eq_u32 s44, 7
    s_cselect_b32 s44, 0, s44
    buffer_load_dwordx4 v21, s[16:19], s51 offen lds
    buffer_load_dwordx4 v22, s[16:19], s51 offen offset:1024 lds
    s_add_u32 m0, s50, 153600
    s_nop 0
    buffer_load_dwordx4 v24, s[20:23], s53 offen lds
    s_waitcnt vmcnt(12)
    s_barrier
    buffer_load_dwordx4 v25, s[20:23], s53 offen offset:1024 lds
    s_add_u32 m0, s50, 71680
    s_nop 0
    buffer_load_dwordx4 v26, s[20:23], s53 offen lds
    buffer_load_dwordx4 v27, s[20:23], s53 offen offset:1024 lds
    s_add_u32 m0, s50, 79872
    s_mul_i32 s53, s45, 172032
    s_add_u32 s53, s53, s48
    s_add_u32 s45, s45, 1
    s_cmp_eq_u32 s45, 7
    s_cselect_b32 s45, 0, s45
    buffer_load_dwordx4 v28, s[20:23], s53 offen lds
    buffer_load_dwordx4 v29, s[20:23], s53 offen offset:1024 lds
    s_lshl_b32 s40, s44, 7
    s_add_u32 s51, s40, s46
    s_mul_i32 s53, s44, 172032
    s_add_u32 s53, s53, s48
    s_add_u32 m0, s50, 43008
    s_add_u32 s44, s44, 1
    s_cmp_eq_u32 s44, 7
    s_cselect_b32 s44, 0, s44
    buffer_load_dwordx4 v21, s[16:19], s51 offen lds
    buffer_load_dwordx4 v22, s[16:19], s51 offen offset:1024 lds
    s_lshl_b32 s41, s44, 7
    s_cmp_lt_u32 s3, 2
    s_cselect_b32 s52, s40, s41
    s_add_u32 m0, s49, 40960
    s_add_u32 s52, s52, s47
    buffer_load_dwordx4 v23, s[16:19], s52 offen lds
    s_add_u32 m0, s50, 88064
    s_nop 0
    buffer_load_dwordx4 v24, s[20:23], s53 offen lds
    s_waitcnt vmcnt(12)
    s_barrier
    buffer_load_dwordx4 v25, s[20:23], s53 offen offset:1024 lds
    s_add_u32 m0, s50, 96256
    s_nop 0
    buffer_load_dwordx4 v26, s[20:23], s53 offen lds
    buffer_load_dwordx4 v27, s[20:23], s53 offen offset:1024 lds
    s_add_u32 m0, s50, 104448
    s_mul_i32 s53, s45, 172032
    s_add_u32 s53, s53, s48
    s_add_u32 s45, s45, 1
    s_cmp_eq_u32 s45, 7
    s_cselect_b32 s45, 0, s45
    buffer_load_dwordx4 v28, s[20:23], s53 offen lds
    buffer_load_dwordx4 v29, s[20:23], s53 offen offset:1024 lds
    s_lshl_b32 s40, s44, 7
    s_add_u32 s51, s40, s46
    s_mul_i32 s53, s44, 172032
    s_add_u32 s53, s53, s48
    s_add_u32 m0, s50, 53248
    s_add_u32 s44, s44, 1
    s_cmp_eq_u32 s44, 7
    s_cselect_b32 s44, 0, s44
    buffer_load_dwordx4 v21, s[16:19], s51 offen lds
    buffer_load_dwordx4 v22, s[16:19], s51 offen offset:1024 lds
    s_add_u32 m0, s50, 112640
    s_nop 0
    buffer_load_dwordx4 v24, s[20:23], s53 offen lds
    s_waitcnt vmcnt(12)
    s_barrier
    buffer_load_dwordx4 v25, s[20:23], s53 offen offset:1024 lds
    s_add_u32 m0, s50, 120832
    s_nop 0
    buffer_load_dwordx4 v26, s[20:23], s53 offen lds
    buffer_load_dwordx4 v27, s[20:23], s53 offen offset:1024 lds
    s_cmp_lg_u32 s3, 3
    s_cbranch_scc1 H_nx
    buffer_load_dwordx2 v[18:19], v20, s[36:39], s30 offen sc1
H_nx:
    s_lshl_b32 s40, s44, 7
    s_add_u32 s51, s40, s46
    s_mul_i32 s53, s44, 172032
    s_add_u32 s53, s53, s48
    s_add_u32 m0, s50, 63488
    s_add_u32 s44, s44, 1
    s_cmp_eq_u32 s44, 7
    s_cselect_b32 s44, 0, s44
    buffer_load_dwordx4 v21, s[16:19], s51 offen lds
    buffer_load_dwordx4 v22, s[16:19], s51 offen offset:1024 lds
    s_lshl_b32 s41, s44, 7
    s_cmp_lt_u32 s3, 2
    s_cselect_b32 s52, s40, s41
    s_cbranch_scc0 H_nh
    s_add_u32 m0, s49, 61440
    s_add_u32 s52, s52, s47
    buffer_load_dwordx4 v23, s[16:19], s52 offen lds
H_nh:
    s_add_u32 m0, s50, 129024
    s_nop 0
    buffer_load_dwordx4 v24, s[20:23], s53 offen lds
    buffer_load_dwordx4 v25, s[20:23], s53 offen offset:1024 lds
    s_waitcnt vmcnt(10)
    s_barrier
    s_add_u32 m0, s50, 137216
    s_nop 0
    buffer_load_dwordx4 v26, s[20:23], s53 offen lds
    buffer_load_dwordx4 v27, s[20:23], s53 offen offset:1024 lds
    s_add_u32 m0, s50, 145408
    s_mul_i32 s53, s45, 172032
    s_add_u32 s53, s53, s48
    s_add_u32 s45, s45, 1
    s_cmp_eq_u32 s45, 7
    s_cselect_b32 s45, 0, s45
    buffer_load_dwordx4 v28, s[20:23], s53 offen lds
    buffer_load_dwordx4 v29, s[20:23], s53 offen offset:1024 lds
    s_add_u32 m0, s50, 153600
    s_mul_i32 s53, s45, 172032
    s_add_u32 s53, s53, s48
    s_add_u32 s45, s45, 1
    s_cmp_eq_u32 s45, 7
    s_cselect_b32 s45, 0, s45
    buffer_load_dwordx4 v28, s[20:23], s53 offen lds
    s_waitcnt vmcnt(9)
    s_barrier
    buffer_load_dwordx4 v29, s[20:23], s53 offen offset:1024 lds
    s_lshl_b32 s40, s54, 13
    s_add_u32 s40, s40, s50
    s_add_u32 m0, s40, 71680
    s_add_u32 s40, s54, s7
    s_sub_u32 s41, s40, 7
    s_min_u32 s40, s40, s41
    s_mul_i32 s40, s40, 57344
    s_add_u32 s40, s40, s55
    s_add_u32 s54, s54, 1
    s_cmp_eq_u32 s54, 5
    s_cselect_b32 s54, 0, s54
    buffer_load_dwordx4 v10, s[24:27], s40 offen lds
    buffer_load_dwordx4 v11, s[24:27], s40 offen offset:1024 lds
    s_waitcnt vmcnt(8)
    s_barrier
    s_lshl_b32 s40, s54, 13
    s_add_u32 s40, s40, s50
    s_add_u32 m0, s40, 71680
    s_add_u32 s40, s54, s7
    s_sub_u32 s41, s40, 7
    s_min_u32 s40, s40, s41
    s_mul_i32 s40, s40, 57344
    s_add_u32 s40, s40, s55
    s_add_u32 s54, s54, 1
    s_cmp_eq_u32 s54, 5
    s_cselect_b32 s54, 0, s54
    buffer_load_dwordx4 v10, s[24:27], s40 offen lds
    buffer_load_dwordx4 v11, s[24:27], s40 offen offset:1024 lds
    s_waitcnt vmcnt(8)
    s_barrier
    s_cmp_lg_u32 s3, 3
    s_cbranch_scc1 H_nc
    s_mov_b32 s101, 1
    v_cmp_ne_u32 vcc, s28, v18
    v_cmp_ne_u32 s[42:43], s29, v19
    s_nop 0
    s_or_b64 vcc, vcc, s[42:43]
    s_cbranch_vccnz X_cH
X_okH:
    v_add_u32 v2, s101, v14
    ds_write_b32 v5, v2 offset:4
H_nc:
    s_setprio 0
    s_lshl_b32 s40, s54, 13
    s_add_u32 s40, s40, s50
    s_add_u32 m0, s40, 71680
    s_add_u32 s40, s54, s7
    s_sub_u32 s41, s40, 7
    s_min_u32 s40, s40, s41
    s_mul_i32 s40, s40, 57344
    s_add_u32 s40, s40, s55
    s_add_u32 s54, s54, 1
    s_cmp_eq_u32 s54, 5
    s_cselect_b32 s54, 0, s54
    buffer_load_dwordx4 v10, s[24:27], s40 offen lds
    buffer_load_dwordx4 v11, s[24:27], s40 offen offset:1024 lds
    buffer_load_dword v13, v12, s[36:39], 0 offen sc1
    s_lshl_b32 s40, s54, 13
    s_add_u32 s40, s40, s50
    s_add_u32 m0, s40, 71680
    s_add_u32 s40, s54, s7
    s_sub_u32 s41, s40, 7
    s_min_u32 s40, s40, s41
    s_mul_i32 s40, s40, 57344
    s_add_u32 s40, s40, s55
    s_add_u32 s54, s54, 1
    s_cmp_eq_u32 s54, 5
    s_cselect_b32 s54, 0, s54
    buffer_load_dwordx4 v10, s[24:27], s40 offen lds
    buffer_load_dwordx4 v11, s[24:27], s40 offen offset:1024 lds
    s_lshl_b32 s40, s54, 13
    s_add_u32 s40, s40, s50
    s_add_u32 m0, s40, 71680
    s_add_u32 s40, s54, s7
    s_sub_u32 s41, s40, 7
    s_min_u32 s40, s40, s41
    s_mul_i32 s40, s40, 57344
    s_add_u32 s40, s40, s55
    s_add_u32 s54, s54, 1
    s_cmp_eq_u32 s54, 5
    s_cselect_b32 s54, 0, s54
    buffer_load_dwordx4 v10, s[24:27], s40 offen lds
    buffer_load_dwordx4 v11, s[24:27], s40 offen offset:1024 lds
    s_waitcnt vmcnt(11)
    s_mov_b64 exec, 1
    ds_add_u32 v5, v14 offset:32
    s_mov_b64 exec, -1
    s_mov_b32 s9, 0
    s_setprio 0
H_il:
    ds_read_b64 v[62:63], v58 offset:16
    ds_read_b128 v[30:33], v56
    ds_read_b128 v[34:37], v57
    s_add_u32 s9, s9, 1
    s_cmp_gt_u32 s9, 1600000
    s_cbranch_scc1 H_id
    s_waitcnt lgkmcnt(2)
    v_and_b32 v62, v62, v63
    v_cmp_eq_u32 vcc, 0, v62
    s_waitcnt lgkmcnt(0)
    s_cbranch_vccnz H_il
H_id:
    s_waitcnt lgkmcnt(0)
    v_fma_f32 v30, v34, v61, v30
    v_fma_f32 v31, v35, v61, v31
    v_fma_f32 v32, v36, v61, v32
    v_fma_f32 v33, v37, v61, v33
    v_mul_f32 v30, s31, v30
    v_mul_f32 v31, s31, v31
    v_mul_f32 v32, s31, v32
    v_mul_f32 v33, s31, v33
    v_max_f32 v62, v30, v31
    v_max_f32 v63, v32, v33
    v_mov_b32 v64, v62
    v_mov_b32 v65, v63
    s_nop 0
    v_permlane16_swap_b32 v62, v64
    v_permlane16_swap_b32 v63, v65
    v_max_f32 v62, v62, v64
    v_max_f32 v63, v63, v65
    v_mov_b32 v64, v62
    v_mov_b32 v65, v63
    s_nop 0
    v_permlane32_swap_b32 v62, v64
    v_permlane32_swap_b32 v63, v65
    v_max_f32 v62, v62, v64
    v_max_f32 v63, v63, v65
    v_sub_f32 v30, v30, v62
    v_sub_f32 v31, v31, v62
    v_sub_f32 v32, v32, v63
    v_sub_f32 v33, v33, v63
    v_exp_f32 v30, v30
    v_exp_f32 v31, v31
    v_exp_f32 v32, v32
    v_exp_f32 v33, v33
    v_add_f32 v62, v30, v31
    v_add_f32 v63, v32, v33
    v_mov_b32 v64, v62
    v_mov_b32 v65, v63
    s_nop 0
    v_permlane16_swap_b32 v62, v64
    v_permlane16_swap_b32 v63, v65
    v_add_f32 v62, v62, v64
    v_add_f32 v63, v63, v65
    v_mov_b32 v64, v62
    v_mov_b32 v65, v63
    s_nop 0
    v_permlane32_swap_b32 v62, v64
    v_permlane32_swap_b32 v63, v65
    v_add_f32 v62, v62, v64
    v_add_f32 v63, v63, v65
    v_rcp_f32 v62, v62
    v_rcp_f32 v63, v63
    v_mul_f32 v30, v30, v62
    v_mul_f32 v31, v31, v62
    v_mul_f32 v32, v32, v63
    v_mul_f32 v33, v33, v63
    v_cvt_pk_bf16_f32 v30, v30, v30
    v_cvt_pk_bf16_f32 v31, v31, v31
    v_cvt_pk_bf16_f32 v32, v32, v32
    v_cvt_pk_bf16_f32 v33, v33, v33
    v_and_b32 v38, v52, v30
    v_and_b32 v39, v53, v31
    v_and_b32 v40, v54, v30
    v_and_b32 v41, v55, v31
    ds_write_b128 v59, v[38:41] offset:12288
    v_and_b32 v42, v52, v32
    v_and_b32 v43, v53, v33
    v_and_b32 v44, v54, v32
    v_and_b32 v45, v55, v33
    ds_write_b128 v59, v[42:45] offset:13312
    ds_write_b32 v60, v5 offset:40
    s_setprio 0
    s_waitcnt vmcnt(0)
    s_mov_b64 exec, 1
    ds_add_u32 v5, v14 offset:12
    s_mov_b64 exec, -1
    s_mov_b32 s9, 0
W_lR:
    ds_read_b32 v2, v5 offset:80
    s_add_u32 s9, s9, 1
    s_cmp_gt_u32 s9, 1600000
    s_cbranch_scc1 W_dR
    s_waitcnt lgkmcnt(0)
    v_cmp_gt_u32 vcc, 4, v2
    s_nop 0
    s_cbranch_vccnz W_lR
W_dR:
    s_add_u32 m0, s50, 112640
    s_add_u32 s40, s7, 5
    s_sub_u32 s41, s40, 7
    s_min_u32 s40, s40, s41
    s_mul_i32 s40, s40, 57344
    s_add_u32 s40, s40, s55
    buffer_load_dwordx4 v10, s[24:27], s40 offen lds
    buffer_load_dwordx4 v11, s[24:27], s40 offen offset:1024 lds
    s_add_u32 m0, s50, 120832
    s_add_u32 s40, s7, 6
    s_sub_u32 s41, s40, 7
    s_min_u32 s40, s40, s41
    s_mul_i32 s40, s40, 57344
    s_add_u32 s40, s40, s55
    buffer_load_dwordx4 v10, s[24:27], s40 offen lds
    buffer_load_dwordx4 v11, s[24:27], s40 offen offset:1024 lds
    s_waitcnt vmcnt(0)
    s_mov_b64 exec, 1
    ds_add_u32 v5, v14 offset:36
    s_endpgm
K_spare2:
    buffer_load_dwordx4 v7, s[28:31], 0 offen nt lds
    s_add_u32 m0, m0, 1024
    s_nop 0
    buffer_load_dwordx4 v7, s[28:31], s52 offen nt lds
    s_add_u32 m0, m0, 1024
    s_nop 0
    buffer_load_dwordx4 v9, s[28:31], 0 offen nt lds
    s_add_u32 m0, m0, 1024
    s_nop 0
    buffer_load_dwordx4 v8, s[28:31], s53 offen nt lds
    s_add_u32 m0, m0, 1024
    s_mov_b32 s26, 401408
    s_mov_b32 s27, 0x00020000
    s_mov_b32 s34, 3670016
    s_mov_b32 s35, 0x00020000
    v_and_b32 v6, 15, v0
    v_lshlrev_b32 v6, 4, v6
    v_bfe_u32 v4, v0, 4, 2
    v_lshl_add_u32 v4, v4, 9, s42
    v_add_u32 v10, v4, v6
    v_sub_u32 v11, v4, v6
    v_add_u32 v11, 432, v11
    v_mov_b32 v12, 0
    s_and_b32 s55, s3, 3
    s_lshr_b32 s56, s3, 2
    v_and_b32 v1, 63, v0
    v_lshrrev_b32 v2, 4, v1
    v_and_b32 v3, 15, v1
    s_lshl_b32 s61, s55, 3
    v_lshrrev_b32 v4, 1, v3
    v_and_b32 v4, 4, v4
    v_and_or_b32 v4, v3, 3, v4
    v_add_u32 v4, s61, v4
    v_bfe_u32 v5, v3, 2, 1
    v_cvt_f32_u32 v97, v5
    v_mul_f32 v97, 0x3e800000, v97
    v_lshl_add_u32 v5, v4, 1, v5
    v_cmp_eq_u32 s[42:43], 1, v5
    v_and_b32 v110, 1, v4
    s_nop 0
    v_cndmask_b32 v4, v4, 32, s[42:43]
    v_cndmask_b32 v97, v97, 0, s[42:43]
    v_sub_u32 v110, 0, v110
    v_and_b32 v110, 0x80008000, v110
    v_cvt_f32_u32 v96, v4
    v_mul_f32 v96, 0x3c800000, v96
    v_lshlrev_b32 v4, 3, v2
    v_cvt_f32_u32 v4, v4
    v_fma_f32 v97, v96, v4, v97
    v_cos_f32 v118, v96
    s_nop 0
    v_add_f32 v118, v118, v118
    v_fmamk_f32 v102, v96, 0x0, v97
    v_fmamk_f32 v103, v96, 0x3f800000, v97
    v_cos_f32 v102, v102
    v_cos_f32 v103, v103
    s_nop 0
    v_fma_f32 v104, v118, v103, -v102
    v_fma_f32 v105, v118, v104, -v103
    v_fma_f32 v106, v118, v105, -v104
    v_fma_f32 v107, v118, v106, -v105
    v_fma_f32 v108, v118, v107, -v106
    v_fma_f32 v109, v118, v108, -v107
    v_cvt_pk_bf16_f32 v20, v102, v103
    v_xor_b32 v24, v110, v20
    v_cvt_pk_bf16_f32 v21, v104, v105
    v_xor_b32 v25, v110, v21
    v_cvt_pk_bf16_f32 v22, v106, v107
    v_xor_b32 v26, v110, v22
    v_cvt_pk_bf16_f32 v23, v108, v109
    v_xor_b32 v27, v110, v23
    v_lshrrev_b32 v4, 4, v0
    v_and_b32 v5, 3, v4
    v_lshlrev_b32 v5, 6, v5
    v_lshlrev_b32 v13, 1, v6
    v_xor_b32 v13, v13, v5
    v_bfe_u32 v5, v4, 3, 1
    v_lshl_add_u32 v13, v5, 4, v13
    v_lshl_add_u32 v13, v4, 9, v13
    v_add_u32 v13, 65536, v13
    v_xor_b32 v14, 16, v13
    v_lshrrev_b32 v4, 2, v3
    v_lshl_add_u32 v5, v2, 3, v4
    v_lshlrev_b32 v5, 9, v5
    v_lshl_add_u32 v5, v4, 6, v5
    v_and_b32 v4, 1, v1
    v_lshl_add_u32 v5, v4, 5, v5
    v_bfe_u32 v4, v1, 1, 1
    v_lshl_add_u32 v5, v4, 3, v5
    v_and_b32 v4, 1, v2
    v_xor_b32 v4, s56, v4
    v_lshl_add_u32 v16, v4, 4, v5
    v_add_u32 v16, 65536, v16
    v_xor_b32 v17, 64, v16
    v_xor_b32 v18, 128, v16
    v_xor_b32 v19, 192, v16
    v_and_b32 v15, 32, v1
    v_lshrrev_b32 v4, 2, v3
    v_add_lshl_u32 v15, v15, v4, 12
    v_and_b32 v4, 16, v1
    v_lshl_add_u32 v15, v4, 2, v15
    v_and_b32 v4, 3, v3
    v_lshl_add_u32 v15, v4, 4, v15
    v_and_b32 v4, 7, v3
    v_lshlrev_b32 v86, 16, v4
    v_mov_b32 v5, 0xffff0000
    v_add_u32 v87, s56, v3
    v_cmp_eq_u32 s[42:43], 0, v87
    s_nop 1
    v_cndmask_b32 v87, v5, 0, s[42:43]
    v_add_u32 v4, 256, v11
    v_cmp_eq_u32 s[42:43], 15, v3
    s_nop 1
    v_cndmask_b32 v11, v11, v4, s[42:43]
    s_lshl_b32 s50, s8, 3
    s_add_u32 s50, s50, s3
    s_mul_i32 s50, s50, 1568
    s_and_b32 s50, s50, 0xffffff80
    v_min_u32 v95, 12, v1
    v_lshlrev_b32 v95, 7, v95
    s_lshl_b32 s59, s55, 18
    s_lshl_b32 s61, s56, 14
    s_add_u32 s59, s59, s61
    s_lshl_b32 s61, s8, 7
    s_add_u32 s59, s59, s61
    s_add_u32 s59, s59, 1048576
    v_lshlrev_b32 v63, 4, v1
    v_and_b32 v4, 32, v1
    v_xor_b32 v60, v63, v4
    s_lshl_b32 s60, s8, 3
    s_add_u32 s60, s60, s3
    s_lshl_b32 s60, s60, 12
    s_add_u32 s60, s60, 1048576
    s_add_u32 s63, s8, 1024
    s_cmp_eq_u32 s8, 0
    s_cselect_b32 s63, 32, s63
    s_cmp_eq_u32 s56, 0
    s_cselect_b32 s61, s8, s63
    v_lshl_add_u32 v4, v3, 6, s61
    v_cvt_f32_u32 v96, v4
    v_mul_f32 v96, 0x3a000000, v96
    s_and_b32 s61, s3, 1
    s_lshl_b32 s61, s61, 4
    v_lshl_add_u32 v4, v2, 2, s61
    v_cvt_f32_u32 v4, v4
    s_bitcmp1_b32 s3, 1
    s_cselect_b32 s61, 0x3e800000, 0
    v_fma_f32 v102, v96, v4, s61
    v_add_f32 v103, v96, v102
    v_add_f32 v104, v96, v103
    v_add_f32 v105, v96, v104
    v_sin_f32 v106, v102
    v_cos_f32 v102, v102
    v_sin_f32 v107, v103
    v_cos_f32 v103, v103
    v_sin_f32 v108, v104
    v_cos_f32 v104, v104
    v_sin_f32 v109, v105
    v_cos_f32 v105, v105
    s_cmp_eq_u32 s8, 0
    s_cbranch_scc1 S_cls0
S_reg:
    v_cvt_pk_bf16_f32 v28, v102, v106
    v_cvt_pk_bf16_f32 v29, v103, v107
    v_cvt_pk_bf16_f32 v30, v104, v108
    v_cvt_pk_bf16_f32 v31, v105, v109
    s_lshl_b32 s61, s55, 14
    s_add_u32 s61, s61, 98304
    v_add_u32 v67, s61, v63
    v_cmp_eq_u32 s[42:43], 0, v2
    s_nop 1
    v_cndmask_b32 v98, 1.0, 0.5, s[42:43]
    v_and_b32 v4, 1, v2
    v_mov_b32 v5, 0xffff
    v_cmp_eq_u32 s[42:43], 1, v4
    s_nop 1
    v_cndmask_b32 v101, -1, v5, s[42:43]
    v_cndmask_b32 v96, 1.0, 0, s[42:43]
    v_cmp_eq_u32 s[42:43], 1, v2
    s_nop 1
    v_cndmask_b32 v97, v96, 0.5, s[42:43]
    s_cmp_eq_u32 s56, 0
    s_cselect_b64 s[42:43], -1, 0
    v_cndmask_b32 v99, v96, v97, s[42:43]
    v_cndmask_b32 v100, v97, v96, s[42:43]
    v_lshlrev_b32 v4, 6, v4
    v_and_b32 v5, 2, v2
    buffer_load_dwordx4 v7, s[28:31], s53 offen nt lds
    s_add_u32 m0, m0, 1024
    s_nop 0
    buffer_load_dwordx4 v7, s[28:31], s54 offen nt lds
    s_add_u32 m0, m0, 1024
    s_nop 0
    buffer_load_dwordx4 v8, s[28:31], s52 offen nt lds
    s_add_u32 m0, m0, 1024
    s_nop 0
    buffer_load_dwordx4 v8, s[28:31], 0 offen nt lds
    s_add_u32 m0, m0, 1024
    v_add_u32 v4, v4, v5
    v_cvt_f32_u32 v97, v4
    s_lshl_b32 s61, s55, 5
    s_add_u32 s61, s61, s56
    v_lshl_add_u32 v4, v3, 1, s61
    v_cvt_f32_u32 v96, v4
    v_mul_f32 v96, 0x3b124925, v96
    v_mul_f32 v97, v96, v97
    s_lshl_b32 s61, s56, 13
    v_add_u32 v5, s61, v67
    v_mul_f32 v118, 0x40800000, v96
    v_cos_f32 v118, v118
    s_nop 0
    v_add_f32 v118, v118, v118
    v_fmamk_f32 v102, v96, 0x0, v97
    v_fmamk_f32 v103, v96, 0x40800000, v97
    v_cos_f32 v102, v102
    v_cos_f32 v103, v103
    s_nop 0
    v_fma_f32 v104, v118, v103, -v102
    v_fma_f32 v105, v118, v104, -v103
    v_fma_f32 v106, v118, v105, -v104
    v_fma_f32 v107, v118, v106, -v105
    v_fma_f32 v108, v118, v107, -v106
    v_fma_f32 v109, v118, v108, -v107
    v_fma_f32 v110, v118, v109, -v108
    v_fma_f32 v111, v118, v110, -v109
    v_fma_f32 v112, v118, v111, -v110
    v_fma_f32 v113, v118, v112, -v111
    v_fma_f32 v114, v118, v113, -v112
    v_fma_f32 v115, v118, v114, -v113
    v_fma_f32 v116, v118, v115, -v114
    v_fma_f32 v117, v118, v116, -v115
    v_mul_f32 v102, v102, v98
    v_mul_f32 v114, v114, v99
    v_cvt_pk_bf16_f32 v76, v102, v106
    v_cvt_pk_bf16_f32 v77, v110, v114
    v_cvt_pk_bf16_f32 v78, v103, v107
    v_cvt_pk_bf16_f32 v79, v111, v115
    v_and_b32 v79, v101, v79
    ds_write_b128 v5, v[76:79] offset:0
    v_cvt_pk_bf16_f32 v80, v104, v108
    s_waitcnt lgkmcnt(0)
    s_add_u32 s12, s10, 0x5a3c9671
    s_xor_b32 s13, s11, 0x2b7e1516
    s_lshl_b32 s51, s12, 12
    s_xor_b32 s51, s51, s13
    s_and_b32 s51, s51, 0xbfff0000
    v_xor_b32 v86, s51, v86
    v_mov_b32 v92, s12
    v_mov_b32 v93, s13
    s_waitcnt vmcnt(4)
    ds_read_b128 v[120:123], v10 offset:0
    ds_read_b128 v[124:127], v11 offset:2112
    ds_read_b128 v[132:135], v10 offset:2112
    ds_read_b128 v[128:131], v11 offset:0
    s_waitcnt lgkmcnt(2)
    v_mov_b32 v136, v120
    v_lshlrev_b32 v140, 16, v121
    v_lshlrev_b32 v154, 16, v127
    v_and_b32 v141, 0xffff0000, v121
    v_and_b32 v155, 0xffff0000, v126
    v_pk_add_f32 v[140:141], v[140:141], v[154:155]
    v_mov_b32_dpp v136, v124 row_shr:1 row_mask:0xf bank_mask:0xf
    v_lshlrev_b32 v142, 16, v122
    v_lshlrev_b32 v154, 16, v126
    v_and_b32 v143, 0xffff0000, v122
    v_and_b32 v155, 0xffff0000, v125
    v_pk_add_f32 v[142:143], v[142:143], v[154:155]
    v_lshlrev_b32 v144, 16, v123
    v_lshlrev_b32 v154, 16, v125
    v_and_b32 v145, 0xffff0000, v123
    v_and_b32 v155, 0xffff0000, v124
    v_pk_add_f32 v[144:145], v[144:145], v[154:155]
    v_lshlrev_b32 v138, 16, v120
    v_lshlrev_b32 v154, 16, v136
    v_and_b32 v139, 0xffff0000, v120
    v_and_b32 v155, 0xffff0000, v127
    v_pk_add_f32 v[138:139], v[138:139], v[154:155]
    s_waitcnt lgkmcnt(0)
    v_lshlrev_b32 v148, 16, v133
    v_lshlrev_b32 v154, 16, v131
    v_and_b32 v149, 0xffff0000, v133
    v_and_b32 v155, 0xffff0000, v130
    v_pk_add_f32 v[148:149], v[148:149], v[154:155]
    v_mov_b32_dpp v137, v128 row_ror:1 row_mask:0xf bank_mask:0xf
    v_lshlrev_b32 v150, 16, v134
    v_lshlrev_b32 v154, 16, v130
    v_and_b32 v151, 0xffff0000, v134
    v_and_b32 v155, 0xffff0000, v129
    v_pk_add_f32 v[150:151], v[150:151], v[154:155]
    v_lshlrev_b32 v152, 16, v135
    v_lshlrev_b32 v154, 16, v129
    v_and_b32 v153, 0xffff0000, v135
    v_and_b32 v155, 0xffff0000, v128
    v_pk_add_f32 v[152:153], v[152:153], v[154:155]
    v_lshlrev_b32 v146, 16, v132
    v_lshlrev_b32 v154, 16, v137
    v_and_b32 v147, 0xffff0000, v132
    v_and_b32 v155, 0xffff0000, v131
    v_pk_add_f32 v[146:147], v[146:147], v[154:155]
    v_pk_add_f32 v[164:165], v[138:139], v[146:147]
    v_pk_add_f32 v[166:167], v[140:141], v[148:149]
    v_pk_add_f32 v[168:169], v[142:143], v[150:151]
    v_pk_add_f32 v[170:171], v[144:145], v[152:153]
    v_cvt_pk_bf16_f32 v156, v164, v166
    v_cvt_pk_bf16_f32 v157, v168, v170
    v_cvt_pk_bf16_f32 v158, v165, v167
    v_cvt_pk_bf16_f32 v159, v169, v171
    ds_write_b128 v13, v[156:159] offset:0
    v_pk_add_f32 v[164:165], v[138:139], v[146:147] neg_lo:[0,1] neg_hi:[0,1]
    v_pk_add_f32 v[166:167], v[140:141], v[148:149] neg_lo:[0,1] neg_hi:[0,1]
    v_pk_add_f32 v[168:169], v[142:143], v[150:151] neg_lo:[0,1] neg_hi:[0,1]
    v_pk_add_f32 v[170:171], v[144:145], v[152:153] neg_lo:[0,1] neg_hi:[0,1]
    v_cvt_pk_bf16_f32 v160, v164, v166
    v_cvt_pk_bf16_f32 v161, v168, v170
    v_cvt_pk_bf16_f32 v162, v165, v167
    v_cvt_pk_bf16_f32 v163, v169, v171
    ds_write_b128 v14, v[160:163] offset:0
    s_waitcnt lgkmcnt(0)
    s_barrier
    ds_read_b64_tr_b16 v[172:173], v16 offset:0
    ds_read_b64_tr_b16 v[174:175], v16 offset:2048
    ds_read_b64_tr_b16 v[176:177], v17 offset:0
    ds_read_b64_tr_b16 v[178:179], v17 offset:2048
    ds_read_b64_tr_b16 v[180:181], v18 offset:0
    ds_read_b64_tr_b16 v[182:183], v18 offset:2048
    ds_read_b64_tr_b16 v[184:185], v19 offset:0
    ds_read_b64_tr_b16 v[186:187], v19 offset:2048
    s_waitcnt lgkmcnt(6)
    v_mfma_f32_16x16x32_bf16 v[188:191], v[20:23], v[172:175], 0
    ds_read_b64_tr_b16 v[172:173], v16 offset:256
    ds_read_b64_tr_b16 v[174:175], v16 offset:2304
    s_waitcnt lgkmcnt(6)
    v_mfma_f32_16x16x32_bf16 v[192:195], v[20:23], v[176:179], 0
    ds_read_b64_tr_b16 v[176:177], v17 offset:256
    ds_read_b64_tr_b16 v[178:179], v17 offset:2304
    s_waitcnt lgkmcnt(6)
    v_mfma_f32_16x16x32_bf16 v[196:199], v[20:23], v[180:183], 0
    ds_read_b64_tr_b16 v[180:181], v18 offset:256
    ds_read_b64_tr_b16 v[182:183], v18 offset:2304
    s_waitcnt lgkmcnt(6)
    v_mfma_f32_16x16x32_bf16 v[200:203], v[20:23], v[184:187], 0
    ds_read_b64_tr_b16 v[184:185], v19 offset:256
    ds_read_b64_tr_b16 v[186:187], v19 offset:2304
    s_waitcnt lgkmcnt(6)
    v_mfma_f32_16x16x32_bf16 v[204:207], v[20:23], v[172:175], 0
    s_waitcnt lgkmcnt(4)
    v_mfma_f32_16x16x32_bf16 v[208:211], v[20:23], v[176:179], 0
    s_waitcnt lgkmcnt(2)
    v_mfma_f32_16x16x32_bf16 v[212:215], v[20:23], v[180:183], 0
    s_waitcnt lgkmcnt(0)
    v_mfma_f32_16x16x32_bf16 v[216:219], v[20:23], v[184:187], 0
    s_waitcnt vmcnt(0)
    buffer_load_dword v255, v95, s[24:27], s50 offen
    ds_read_b128 v[120:123], v10 offset:4096
    ds_read_b128 v[124:127], v11 offset:6208
    ds_read_b128 v[132:135], v10 offset:6208
    ds_read_b128 v[128:131], v11 offset:4096
    s_waitcnt lgkmcnt(2)
    v_mov_b32 v136, v120
    v_lshlrev_b32 v140, 16, v121
    v_lshlrev_b32 v154, 16, v127
    v_and_b32 v141, 0xffff0000, v121
    v_and_b32 v155, 0xffff0000, v126
    v_pk_add_f32 v[140:141], v[140:141], v[154:155]
    v_mov_b32_dpp v136, v124 row_shr:1 row_mask:0xf bank_mask:0xf
    v_lshlrev_b32 v142, 16, v122
    v_lshlrev_b32 v154, 16, v126
    v_and_b32 v143, 0xffff0000, v122
    v_and_b32 v155, 0xffff0000, v125
    v_pk_add_f32 v[142:143], v[142:143], v[154:155]
    v_lshlrev_b32 v144, 16, v123
    v_lshlrev_b32 v154, 16, v125
    v_and_b32 v145, 0xffff0000, v123
    v_and_b32 v155, 0xffff0000, v124
    v_pk_add_f32 v[144:145], v[144:145], v[154:155]
    v_lshlrev_b32 v138, 16, v120
    v_lshlrev_b32 v154, 16, v136
    v_and_b32 v139, 0xffff0000, v120
    v_and_b32 v155, 0xffff0000, v127
    v_pk_add_f32 v[138:139], v[138:139], v[154:155]
    s_waitcnt lgkmcnt(0)
    v_lshlrev_b32 v148, 16, v133
    v_lshlrev_b32 v154, 16, v131
    v_and_b32 v149, 0xffff0000, v133
    v_and_b32 v155, 0xffff0000, v130
    v_pk_add_f32 v[148:149], v[148:149], v[154:155]
    v_mov_b32_dpp v137, v128 row_ror:1 row_mask:0xf bank_mask:0xf
    v_lshlrev_b32 v150, 16, v134
    v_lshlrev_b32 v154, 16, v130
    v_and_b32 v151, 0xffff0000, v134
    v_and_b32 v155, 0xffff0000, v129
    v_pk_add_f32 v[150:151], v[150:151], v[154:155]
    v_lshlrev_b32 v152, 16, v135
    v_lshlrev_b32 v154, 16, v129
    v_and_b32 v153, 0xffff0000, v135
    v_and_b32 v155, 0xffff0000, v128
    v_pk_add_f32 v[152:153], v[152:153], v[154:155]
    v_lshlrev_b32 v146, 16, v132
    v_lshlrev_b32 v154, 16, v137
    v_and_b32 v147, 0xffff0000, v132
    v_and_b32 v155, 0xffff0000, v131
    v_pk_add_f32 v[146:147], v[146:147], v[154:155]
    v_pk_add_f32 v[164:165], v[138:139], v[146:147]
    v_pk_add_f32 v[166:167], v[140:141], v[148:149]
    v_pk_add_f32 v[168:169], v[142:143], v[150:151]
    v_pk_add_f32 v[170:171], v[144:145], v[152:153]
    v_cvt_pk_bf16_f32 v156, v164, v166
    v_cvt_pk_bf16_f32 v157, v168, v170
    v_cvt_pk_bf16_f32 v158, v165, v167
    v_cvt_pk_bf16_f32 v159, v169, v171
    ds_write_b128 v13, v[156:159] offset:16384
    v_pk_add_f32 v[164:165], v[138:139], v[146:147] neg_lo:[0,1] neg_hi:[0,1]
    v_pk_add_f32 v[166:167], v[140:141], v[148:149] neg_lo:[0,1] neg_hi:[0,1]
    v_pk_add_f32 v[168:169], v[142:143], v[150:151] neg_lo:[0,1] neg_hi:[0,1]
    v_pk_add_f32 v[170:171], v[144:145], v[152:153] neg_lo:[0,1] neg_hi:[0,1]
    v_cvt_pk_bf16_f32 v160, v164, v166
    v_cvt_pk_bf16_f32 v161, v168, v170
    v_cvt_pk_bf16_f32 v162, v165, v167
    v_cvt_pk_bf16_f32 v163, v169, v171
    ds_write_b128 v14, v[160:163] offset:16384
    s_cmp_lg_u32 s3, 0
    s_cbranch_scc1 S_nw
    s_lshl_b32 s40, s8, 7
    s_add_u32 s40, s40, 32768
    buffer_load_dword v255, v12, s[36:39], s40 offen
S_nw:
    s_waitcnt lgkmcnt(0)
    s_barrier
    ds_read_b64_tr_b16 v[172:173], v16 offset:16384
    ds_read_b64_tr_b16 v[174:175], v16 offset:18432
    ds_read_b64_tr_b16 v[176:177], v17 offset:16384
    ds_read_b64_tr_b16 v[178:179], v17 offset:18432
    ds_read_b64_tr_b16 v[180:181], v18 offset:16384
    ds_read_b64_tr_b16 v[182:183], v18 offset:18432
    ds_read_b64_tr_b16 v[184:185], v19 offset:16384
    ds_read_b64_tr_b16 v[186:187], v19 offset:18432
    s_waitcnt lgkmcnt(6)
    v_mfma_f32_16x16x32_bf16 v[188:191], v[24:27], v[172:175], v[188:191]
    ds_read_b64_tr_b16 v[172:173], v16 offset:16640
    ds_read_b64_tr_b16 v[174:175], v16 offset:18688
    s_waitcnt lgkmcnt(6)
    v_mfma_f32_16x16x32_bf16 v[192:195], v[24:27], v[176:179], v[192:195]
    ds_read_b64_tr_b16 v[176:177], v17 offset:16640
    ds_read_b64_tr_b16 v[178:179], v17 offset:18688
    s_waitcnt lgkmcnt(6)
    v_mfma_f32_16x16x32_bf16 v[196:199], v[24:27], v[180:183], v[196:199]
    ds_read_b64_tr_b16 v[180:181], v18 offset:16640
    ds_read_b64_tr_b16 v[182:183], v18 offset:18688
    s_waitcnt lgkmcnt(6)
    v_mfma_f32_16x16x32_bf16 v[200:203], v[24:27], v[184:187], v[200:203]
    ds_read_b64_tr_b16 v[184:185], v19 offset:16640
    ds_read_b64_tr_b16 v[186:187], v19 offset:18688
    s_waitcnt lgkmcnt(6)
    v_mfma_f32_16x16x32_bf16 v[204:207], v[24:27], v[172:175], v[204:207]
    s_waitcnt lgkmcnt(4)
    v_mfma_f32_16x16x32_bf16 v[208:211], v[24:27], v[176:179], v[208:211]
    s_waitcnt lgkmcnt(2)
    v_mfma_f32_16x16x32_bf16 v[212:215], v[24:27], v[180:183], v[212:215]
    s_waitcnt lgkmcnt(0)
    v_mfma_f32_16x16x32_bf16 v[216:219], v[24:27], v[184:187], v[216:219]
    v_cvt_pk_bf16_f32 v120, v188, v192
    v_cvt_pk_bf16_f32 v121, v196, v200
    s_nop 1
    v_cvt_pk_bf16_f32 v122, v204, v208
    s_nop 2
    v_cvt_pk_bf16_f32 v123, v212, v216
    v_bfi_b32 v123, v87, v86, v123
    s_add_u32 s41, s59, 0
    buffer_store_dwordx4 v[120:123], v15, s[36:39], s41 offen sc1
    v_cvt_pk_bf16_f32 v124, v189, v193
    v_cvt_pk_bf16_f32 v125, v197, v201
    v_cvt_pk_bf16_f32 v126, v205, v209
    v_cvt_pk_bf16_f32 v127, v213, v217
    v_bfi_b32 v127, v87, v86, v127
    s_add_u32 s41, s59, 32768
    buffer_store_dwordx4 v[124:127], v15, s[36:39], s41 offen sc1
    v_cvt_pk_bf16_f32 v128, v190, v194
    v_cvt_pk_bf16_f32 v129, v198, v202
    v_cvt_pk_bf16_f32 v130, v206, v210
    v_cvt_pk_bf16_f32 v131, v214, v218
    v_bfi_b32 v131, v87, v86, v131
    s_add_u32 s41, s59, 65536
    buffer_store_dwordx4 v[128:131], v15, s[36:39], s41 offen sc1
    v_cvt_pk_bf16_f32 v132, v191, v195
    v_cvt_pk_bf16_f32 v133, v199, v203
    v_cvt_pk_bf16_f32 v134, v207, v211
    v_cvt_pk_bf16_f32 v135, v215, v219
    v_bfi_b32 v135, v87, v86, v135
    s_add_u32 s41, s59, 98304
    buffer_store_dwordx4 v[132:135], v15, s[36:39], s41 offen sc1
    s_cmp_lg_u32 s3, 0
    s_cbranch_scc1 S_nh
    s_lshl_b32 s40, s8, 7
    s_add_u32 s40, s40, 32768
    s_mov_b64 exec, 1
    buffer_store_dwordx2 v[92:93], v12, s[36:39], s40 offen sc1
    s_mov_b64 exec, -1
S_nh:
    s_barrier
    s_cmp_lg_u32 s3, 0
    s_cbranch_scc1 S_nf
    v_lshlrev_b32 v94, 2, v3
    v_add_u32 v94, 81920, v94
    ds_write_b32 v94, v12
S_nf:
    s_lshl_b32 s40, s7, 3
    s_add_u32 s40, s40, s3
    s_mul_i32 s40, s40, 28
    v_min_u32 v24, 27, v1
    v_add_u32 v24, s40, v24
    v_and_b32 v25, 0xffffff80, v24
    v_lshrrev_b32 v26, 1, v25
    v_sub_u32 v24, v24, v26
    v_add_u32 v26, -128, v24
    v_add_u32 v24, 320, v24
    v_min_u32 v24, v24, v26
    v_mul_u32_u24 v24, 896, v24
    v_add_u32 v24, v24, v25
    buffer_load_dword v255, v24, s[24:27], 0 offen
    v_cvt_pk_bf16_f32 v81, v112, v116
    v_cvt_pk_bf16_f32 v82, v105, v109
    v_cvt_pk_bf16_f32 v83, v113, v117
    v_and_b32 v81, v101, v81
    v_and_b32 v83, v101, v83
    ds_write_b128 v5, v[80:83] offset:1024
    v_fmamk_f32 v102, v96, 0x0, v97
    v_fmamk_f32 v103, v96, 0x40800000, v97
    v_sin_f32 v102, v102
    v_sin_f32 v103, v103
    s_nop 0
    v_fma_f32 v104, v118, v103, -v102
    v_fma_f32 v105, v118, v104, -v103
    v_fma_f32 v106, v118, v105, -v104
    v_fma_f32 v107, v118, v106, -v105
    v_fma_f32 v108, v118, v107, -v106
    v_fma_f32 v109, v118, v108, -v107
    v_fma_f32 v110, v118, v109, -v108
    v_fma_f32 v111, v118, v110, -v109
    v_fma_f32 v112, v118, v111, -v110
    v_fma_f32 v113, v118, v112, -v111
    v_fma_f32 v114, v118, v113, -v112
    v_fma_f32 v115, v118, v114, -v113
    v_fma_f32 v116, v118, v115, -v114
    v_fma_f32 v117, v118, v116, -v115
    v_mul_f32 v114, v114, v100
    v_cvt_pk_bf16_f32 v76, v102, v106
    v_cvt_pk_bf16_f32 v77, v110, v114
    v_cvt_pk_bf16_f32 v78, v103, v107
    v_cvt_pk_bf16_f32 v79, v111, v115
    v_and_b32 v79, v101, v79
    ds_write_b128 v5, v[76:79] offset:4096
    v_cvt_pk_bf16_f32 v80, v104, v108
    v_cvt_pk_bf16_f32 v81, v112, v116
    v_cvt_pk_bf16_f32 v82, v105, v109
    v_cvt_pk_bf16_f32 v83, v113, v117
    v_and_b32 v81, v101, v81
    v_and_b32 v83, v101, v83
    ds_write_b128 v5, v[80:83] offset:5120
    v_fmamk_f32 v102, v96, 0x3f800000, v97
    v_fmamk_f32 v103, v96, 0x40a00000, v97
    v_cos_f32 v102, v102
    v_cos_f32 v103, v103
    s_nop 0
    v_fma_f32 v104, v118, v103, -v102
    v_fma_f32 v105, v118, v104, -v103
    v_fma_f32 v106, v118, v105, -v104
    v_fma_f32 v107, v118, v106, -v105
    v_fma_f32 v108, v118, v107, -v106
    v_fma_f32 v109, v118, v108, -v107
    v_fma_f32 v110, v118, v109, -v108
    v_fma_f32 v111, v118, v110, -v109
    v_fma_f32 v112, v118, v111, -v110
    v_fma_f32 v113, v118, v112, -v111
    v_fma_f32 v114, v118, v113, -v112
    v_fma_f32 v115, v118, v114, -v113
    v_fma_f32 v116, v118, v115, -v114
    v_fma_f32 v117, v118, v116, -v115
    v_cvt_pk_bf16_f32 v76, v102, v106
    v_cvt_pk_bf16_f32 v77, v110, v114
    v_cvt_pk_bf16_f32 v78, v103, v107
    v_cvt_pk_bf16_f32 v79, v111, v115
    v_and_b32 v77, v101, v77
    v_and_b32 v79, v101, v79
    ds_write_b128 v5, v[76:79] offset:2048
    v_cvt_pk_bf16_f32 v80, v104, v108
    v_cvt_pk_bf16_f32 v81, v112, v116
    v_cvt_pk_bf16_f32 v82, v105, v109
    v_cvt_pk_bf16_f32 v83, v113, v117
    v_and_b32 v81, v101, v81
    v_and_b32 v83, v101, v83
    ds_write_b128 v5, v[80:83] offset:3072
    v_fmamk_f32 v102, v96, 0x3f800000, v97
    v_fmamk_f32 v103, v96, 0x40a00000, v97
    v_sin_f32 v102, v102
    v_sin_f32 v103, v103
    s_nop 0
    v_fma_f32 v104, v118, v103, -v102
    v_fma_f32 v105, v118, v104, -v103
    v_fma_f32 v106, v118, v105, -v104
    v_fma_f32 v107, v118, v106, -v105
    v_fma_f32 v108, v118, v107, -v106
    v_fma_f32 v109, v118, v108, -v107
    v_fma_f32 v110, v118, v109, -v108
    v_fma_f32 v111, v118, v110, -v109
    v_fma_f32 v112, v118, v111, -v110
    v_fma_f32 v113, v118, v112, -v111
    v_fma_f32 v114, v118, v113, -v112
    v_fma_f32 v115, v118, v114, -v113
    v_fma_f32 v116, v118, v115, -v114
    v_fma_f32 v117, v118, v116, -v115
    v_cvt_pk_bf16_f32 v76, v102, v106
    v_cvt_pk_bf16_f32 v77, v110, v114
    v_cvt_pk_bf16_f32 v78, v103, v107
    v_cvt_pk_bf16_f32 v79, v111, v115
    v_and_b32 v77, v101, v77
    v_and_b32 v79, v101, v79
    ds_write_b128 v5, v[76:79] offset:6144
    v_cvt_pk_bf16_f32 v80, v104, v108
    v_cvt_pk_bf16_f32 v81, v112, v116
    v_and_b32 v94, 31, v1
    v_lshlrev_b32 v94, 7, v94
    s_mov_b32 s50, 32768
    s_cmp_lg_u32 s3, 1
    s_cbranch_scc1 S_p0
    buffer_load_dword v20, v94, s[36:39], s50 offen sc1
S_p0:
    v_cvt_pk_bf16_f32 v82, v105, v109
    v_cvt_pk_bf16_f32 v83, v113, v117
    v_and_b32 v81, v101, v81
    v_and_b32 v83, v101, v83
    ds_write_b128 v5, v[80:83] offset:7168
    v_bfe_u32 v88, v60, 4, 2
    v_mov_b32 v5, 0xffff0000
    v_add_u32 v4, s3, v88
    v_cmp_eq_u32 s[42:43], 0, v4
    s_nop 1
    v_cndmask_b32 v90, v5, 0, s[42:43]
    s_and_b32 s61, s3, 1
    s_lshl_b32 s61, s61, 2
    v_add_lshl_u32 v88, v88, s61, 16
    v_lshrrev_b32 v4, 2, v3
    v_lshl_add_u32 v4, v2, 3, v4
    v_lshlrev_b32 v4, 6, v4
    v_and_b32 v5, 3, v1
    v_lshl_add_u32 v4, v5, 3, v4
    v_and_b32 v5, 16, v1
    v_lshl_add_u32 v4, v5, 1, v4
    s_lshl_b32 s61, s3, 12
    v_add_u32 v62, s61, v4
    v_xor_b32 v61, 32, v62
    v_add_u32 v89, s61, v63
    s_lshr_b32 s61, s3, 1
    s_lshl_b32 s61, s61, 13
    s_and_b32 s62, s3, 1
    s_lshl_b32 s62, s62, 10
    s_add_u32 s61, s61, s62
    v_add_u32 v91, s61, v63
    v_mov_b32 v68, 81920
    v_lshl_add_u32 v68, s56, 2, v68
    v_mov_b32 v75, 1
    s_lshl_b32 s61, s56, 11
    v_add_u32 v69, s61, v63
    s_lshl_b32 s61, s56, 4
    v_add_u32 v4, s61, v3
    v_mul_u32_u24 v4, 528, v4
    v_add_u32 v4, 98304, v4
    v_lshl_add_u32 v5, s55, 2, v2
    v_lshl_add_u32 v64, v5, 4, v4
    s_lshl_b32 s40, s3, 10
    s_add_u32 s40, s40, 69632
    v_add_u32 v27, s40, v63
    ds_write_b128 v27, v[28:31]
    s_cmp_lg_u32 s3, 1
    s_cbranch_scc1 P_dB
    s_mov_b32 s9, 0
P_lB:
    buffer_load_dword v21, v94, s[36:39], s50 offen sc1
    s_waitcnt vmcnt(1)
    v_cmp_ne_u32 vcc, s12, v20
    s_nop 0
    s_cbranch_vccz P_dB
    buffer_load_dword v20, v94, s[36:39], s50 offen sc1
    s_waitcnt vmcnt(1)
    v_cmp_ne_u32 vcc, s12, v21
    s_nop 0
    s_cbranch_vccz P_dB
    s_add_u32 s9, s9, 1
    s_cmp_lt_u32 s9, 200000
    s_cbranch_scc1 P_lB
P_dB:
    s_lshl_b32 s40, s3, 12
    s_add_u32 m0, s40, 0
    s_waitcnt lgkmcnt(0)
    s_barrier
    buffer_load_dwordx4 v60, s[36:39], s60 offen offset:0 sc1 lds
    buffer_load_dwordx4 v60, s[36:39], s60 offen offset:1024 sc1 lds
    buffer_load_dwordx4 v60, s[36:39], s60 offen offset:2048 sc1 lds
    buffer_load_dwordx4 v60, s[36:39], s60 offen offset:3072 sc1 lds
    v_add_u32 v27, 69632, v63
    ds_read_b128 v[28:31], v27 offset:0
    ds_read_b128 v[32:35], v27 offset:1024
    ds_read_b128 v[36:39], v27 offset:2048
    ds_read_b128 v[40:43], v27 offset:3072
    ds_read_b128 v[44:47], v27 offset:4096
    ds_read_b128 v[48:51], v27 offset:5120
    ds_read_b128 v[52:55], v27 offset:6144
    ds_read_b128 v[56:59], v27 offset:7168
    ds_read_b128 v[120:123], v67 offset:0
    ds_read_b128 v[124:127], v67 offset:1024
    ds_read_b128 v[128:131], v67 offset:2048
    ds_read_b128 v[132:135], v67 offset:3072
    ds_read_b128 v[136:139], v67 offset:4096
    ds_read_b128 v[140:143], v67 offset:5120
    ds_read_b128 v[144:147], v67 offset:6144
    ds_read_b128 v[148:151], v67 offset:7168
    ds_read_b128 v[152:155], v67 offset:8192
    ds_read_b128 v[156:159], v67 offset:9216
    ds_read_b128 v[160:163], v67 offset:10240
    ds_read_b128 v[164:167], v67 offset:11264
    ds_read_b128 v[168:171], v67 offset:12288
    ds_read_b128 v[172:175], v67 offset:13312
    ds_read_b128 v[176:179], v67 offset:14336
    ds_read_b128 v[180:183], v67 offset:15360
    s_and_b32 s61, s3, 1
    s_lshl_b32 s61, s61, 3
    v_lshrrev_b32 v4, 3, v1
    v_add_u32 v4, s61, v4
    v_and_b32 v5, 7, v1
    v_lshlrev_b32 v5, 4, v5
    s_and_b32 s61, s3, 2
    s_add_u32 s61, s61, s56
    s_mul_i32 s61, s61, 8448
    s_add_u32 s61, s61, 98304
    v_mul_u32_u24 v96, 528, v4
    v_add3_u32 v65, v96, v5, s61
    v_add_u32 v97, s61, v96
    s_bitcmp1_b32 s3, 1
    s_cselect_b32 s62, -1, 1
    s_mul_i32 s62, s62, 16896
    v_add_u32 v71, s62, v97
    s_cmp_eq_u32 s56, 0
    s_cselect_b32 s61, s8, s63
    v_lshl_add_u32 v66, v4, 6, s61
    v_sub_u32 v96, 2048, v66
    v_mov_b32 v4, 1024
    v_cmp_eq_u32 s[42:43], 0, v66
    s_nop 1
    v_cndmask_b32 v96, v96, v4, s[42:43]
    v_cndmask_b32 v71, v71, v97, s[42:43]
    s_bitcmp1_b32 s3, 1
    s_cselect_b64 s[42:43], -1, 0
    v_cndmask_b32 v66, v66, v96, s[42:43]
    v_mov_b32 v96, 1792
    v_mad_u32_u24 v66, v66, v96, v5
    v_sub_u32 v71, v71, v5
    v_and_b32 v4, 4, v1
    v_lshl_add_u32 v70, v4, 5, v65
    v_lshl_add_u32 v73, v4, 5, v66
    v_lshlrev_b32 v4, 4, v4
    v_sub_u32 v72, v71, v4
    v_mov_b32 v74, 0xffff
    v_xor_b32 v88, s51, v88
    s_mov_b32 s9, 0
    s_waitcnt lgkmcnt(0)
S_gc:
    s_waitcnt vmcnt(2)
    ds_read_b64_tr_b16 v[184:185], v62 offset:0
    ds_read_b64_tr_b16 v[186:187], v62 offset:256
    ds_read_b64_tr_b16 v[192:193], v61 offset:0
    ds_read_b64_tr_b16 v[194:195], v61 offset:256
    ds_read_b32 v102, v89 offset:12
    ds_read_b32 v103, v89 offset:1036
    s_waitcnt lgkmcnt(4)
    v_mfma_f32_16x16x32_bf16 v[200:203], v[184:187], v[28:31], 0
    v_mfma_f32_16x16x32_bf16 v[208:211], v[184:187], v[36:39], 0
    v_mfma_f32_16x16x32_bf16 v[216:219], v[184:187], v[44:47], 0
    v_mfma_f32_16x16x32_bf16 v[224:227], v[184:187], v[52:55], 0
    s_waitcnt vmcnt(0)
    ds_read_b64_tr_b16 v[188:189], v62 offset:2048
    ds_read_b64_tr_b16 v[190:191], v62 offset:2304
    ds_read_b64_tr_b16 v[196:197], v61 offset:2048
    ds_read_b64_tr_b16 v[198:199], v61 offset:2304
    ds_read_b32 v104, v89 offset:2060
    ds_read_b32 v105, v89 offset:3084
    s_waitcnt lgkmcnt(8)
    v_mfma_f32_16x16x32_bf16 v[204:207], v[192:195], v[28:31], 0
    v_mfma_f32_16x16x32_bf16 v[212:215], v[192:195], v[36:39], 0
    v_mfma_f32_16x16x32_bf16 v[220:223], v[192:195], v[44:47], 0
    v_mfma_f32_16x16x32_bf16 v[228:231], v[192:195], v[52:55], 0
    s_waitcnt lgkmcnt(4)
    v_mfma_f32_16x16x32_bf16 v[200:203], v[188:191], v[32:35], v[200:203]
    s_waitcnt lgkmcnt(2)
    v_mfma_f32_16x16x32_bf16 v[204:207], v[196:199], v[32:35], v[204:207]
    s_waitcnt lgkmcnt(0)
    v_xor_b32 v102, v88, v102
    v_xor_b32 v103, v88, v103
    v_xor_b32 v104, v88, v104
    v_mfma_f32_16x16x32_bf16 v[208:211], v[188:191], v[40:43], v[208:211]
    v_xor_b32 v105, v88, v105
    v_or_b32 v102, v102, v103
    v_or3_b32 v102, v102, v104, v105
    v_mfma_f32_16x16x32_bf16 v[212:215], v[196:199], v[40:43], v[212:215]
    v_and_b32 v102, v90, v102
    v_cmp_ne_u32 vcc, 0, v102
    v_mfma_f32_16x16x32_bf16 v[216:219], v[188:191], v[48:51], v[216:219]
    v_mfma_f32_16x16x32_bf16 v[220:223], v[196:199], v[48:51], v[220:223]
    v_cvt_pk_bf16_f32 v232, v200, v201
    v_cvt_pk_bf16_f32 v233, v202, v203
    v_cvt_pk_bf16_f32 v234, v204, v205
    v_cvt_pk_bf16_f32 v235, v206, v207
    ds_write_b128 v91, v[232:235] offset:32768
    v_mfma_f32_16x16x32_bf16 v[224:227], v[188:191], v[56:59], v[224:227]
    v_mfma_f32_16x16x32_bf16 v[228:231], v[196:199], v[56:59], v[228:231]
    v_cvt_pk_bf16_f32 v236, v208, v209
    v_cvt_pk_bf16_f32 v237, v210, v211
    v_cvt_pk_bf16_f32 v238, v212, v213
    v_cvt_pk_bf16_f32 v239, v214, v215
    ds_write_b128 v91, v[236:239] offset:36864
    s_cbranch_vccnz S_gr
S_gk:
    v_cvt_pk_bf16_f32 v240, v216, v217
    v_cvt_pk_bf16_f32 v241, v218, v219
    v_cvt_pk_bf16_f32 v242, v220, v221
    v_cvt_pk_bf16_f32 v243, v222, v223
    ds_write_b128 v91, v[240:243] offset:34816
    v_cvt_pk_bf16_f32 v244, v224, v225
    v_cvt_pk_bf16_f32 v245, v226, v227
    v_cvt_pk_bf16_f32 v246, v228, v229
    v_cvt_pk_bf16_f32 v247, v230, v231
    ds_write_b128 v91, v[244:247] offset:38912
    s_waitcnt lgkmcnt(0)
    s_barrier
    s_cmp_lg_u32 s56, 0
    s_cbranch_scc1 S_np
    s_setprio 1
S_np:
    ds_read_b128 v[184:187], v69 offset:32768
    ds_read_b128 v[188:191], v69 offset:33792
    ds_read_b128 v[192:195], v69 offset:40960
    ds_read_b128 v[196:199], v69 offset:41984
    ds_read_b128 v[200:203], v69 offset:49152
    ds_read_b128 v[204:207], v69 offset:50176
    ds_read_b128 v[208:211], v69 offset:57344
    s_waitcnt lgkmcnt(6)
    v_mfma_f32_16x16x32_bf16 v[216:219], v[120:123], v[184:187], 0
    ds_read_b128 v[212:215], v69 offset:58368
    s_waitcnt lgkmcnt(6)
    v_mfma_f32_16x16x32_bf16 v[216:219], v[124:127], v[188:191], v[216:219]
    ds_read_b128 v[184:187], v69 offset:53248
    s_waitcnt lgkmcnt(6)
    v_mfma_f32_16x16x32_bf16 v[220:223], v[128:131], v[192:195], 0
    ds_read_b128 v[188:191], v69 offset:54272
    s_waitcnt lgkmcnt(6)
    v_mfma_f32_16x16x32_bf16 v[220:223], v[132:135], v[196:199], v[220:223]
    ds_read_b128 v[192:195], v69 offset:61440
    s_waitcnt lgkmcnt(6)
    v_mfma_f32_16x16x32_bf16 v[232:235], v[152:155], v[200:203], 0
    ds_read_b128 v[196:199], v69 offset:62464
    s_waitcnt lgkmcnt(6)
    v_mfma_f32_16x16x32_bf16 v[232:235], v[156:159], v[204:207], v[232:235]
    ds_read_b128 v[200:203], v69 offset:36864
    s_waitcnt lgkmcnt(6)
    v_mfma_f32_16x16x32_bf16 v[236:239], v[160:163], v[208:211], 0
    ds_read_b128 v[204:207], v69 offset:37888
    s_waitcnt lgkmcnt(6)
    v_mfma_f32_16x16x32_bf16 v[236:239], v[164:167], v[212:215], v[236:239]
    ds_read_b128 v[208:211], v69 offset:45056
    s_waitcnt lgkmcnt(6)
    v_mfma_f32_16x16x32_bf16 v[224:227], v[136:139], v[184:187], 0
    ds_read_b128 v[212:215], v69 offset:46080
    s_waitcnt lgkmcnt(6)
    v_mfma_f32_16x16x32_bf16 v[224:227], v[140:143], v[188:191], v[224:227]
    s_waitcnt lgkmcnt(5)
    v_mfma_f32_16x16x32_bf16 v[228:231], v[144:147], v[192:195], 0
    v_pk_add_f32 v[102:103], v[216:217], v[220:221]
    v_pk_add_f32 v[104:105], v[218:219], v[222:223]
    s_waitcnt lgkmcnt(4)
    v_mfma_f32_16x16x32_bf16 v[228:231], v[148:151], v[196:199], v[228:231]
    v_pk_add_f32 v[220:221], v[216:217], v[220:221] neg_lo:[0,1] neg_hi:[0,1]
    v_pk_add_f32 v[222:223], v[218:219], v[222:223] neg_lo:[0,1] neg_hi:[0,1]
    s_waitcnt lgkmcnt(3)
    v_mfma_f32_16x16x32_bf16 v[240:243], v[168:171], v[200:203], 0
    v_pk_add_f32 v[106:107], v[232:233], v[236:237]
    s_waitcnt lgkmcnt(2)
    v_mfma_f32_16x16x32_bf16 v[240:243], v[172:175], v[204:207], v[240:243]
    v_pk_add_f32 v[108:109], v[234:235], v[238:239]
    s_waitcnt lgkmcnt(1)
    v_mfma_f32_16x16x32_bf16 v[244:247], v[176:179], v[208:211], 0
    v_pk_add_f32 v[236:237], v[232:233], v[236:237] neg_lo:[0,1] neg_hi:[0,1]
    s_waitcnt lgkmcnt(0)
    v_mfma_f32_16x16x32_bf16 v[244:247], v[180:183], v[212:215], v[244:247]
    v_pk_add_f32 v[238:239], v[234:235], v[238:239] neg_lo:[0,1] neg_hi:[0,1]
    s_add_u32 s40, s8, s56
    s_cmp_eq_u32 s40, 0
    s_cbranch_scc1 S_y0
S_y1:
    v_pk_add_f32 v[216:217], v[224:225], v[228:229]
    v_pk_add_f32 v[218:219], v[226:227], v[230:231]
    v_pk_add_f32 v[228:229], v[224:225], v[228:229] neg_lo:[0,1] neg_hi:[0,1]
    v_pk_add_f32 v[230:231], v[226:227], v[230:231] neg_lo:[0,1] neg_hi:[0,1]
    v_pk_add_f32 v[232:233], v[240:241], v[244:245]
    v_pk_add_f32 v[234:235], v[242:243], v[246:247]
    v_pk_add_f32 v[244:245], v[240:241], v[244:245] neg_lo:[0,1] neg_hi:[0,1]
    v_pk_add_f32 v[246:247], v[242:243], v[246:247] neg_lo:[0,1] neg_hi:[0,1]
    v_pk_add_f32 v[224:225], v[102:103], v[216:217]
    v_pk_add_f32 v[226:227], v[104:105], v[218:219]
    v_pk_add_f32 v[240:241], v[106:107], v[232:233]
    v_pk_add_f32 v[242:243], v[108:109], v[234:235]
    v_cvt_pk_bf16_f32 v184, v224, v240
    v_cvt_pk_bf16_f32 v185, v225, v241
    v_cvt_pk_bf16_f32 v186, v226, v242
    v_cvt_pk_bf16_f32 v187, v227, v243
    ds_write_b128 v64, v[184:187] offset:0
    v_pk_add_f32 v[224:225], v[102:103], v[216:217] neg_lo:[0,1] neg_hi:[0,1]
    v_pk_add_f32 v[226:227], v[104:105], v[218:219] neg_lo:[0,1] neg_hi:[0,1]
    v_pk_add_f32 v[240:241], v[106:107], v[232:233] neg_lo:[0,1] neg_hi:[0,1]
    v_pk_add_f32 v[242:243], v[108:109], v[234:235] neg_lo:[0,1] neg_hi:[0,1]
    v_cvt_pk_bf16_f32 v188, v224, v240
    v_cvt_pk_bf16_f32 v189, v225, v241
    v_cvt_pk_bf16_f32 v190, v226, v242
    v_cvt_pk_bf16_f32 v191, v227, v243
    ds_write_b128 v64, v[188:191] offset:16896
    v_pk_add_f32 v[224:225], v[220:221], v[228:229]
    v_pk_add_f32 v[226:227], v[222:223], v[230:231]
    v_pk_add_f32 v[240:241], v[236:237], v[244:245]
    v_pk_add_f32 v[242:243], v[238:239], v[246:247]
    v_cvt_pk_bf16_f32 v192, v224, v240
    v_cvt_pk_bf16_f32 v193, v225, v241
    v_cvt_pk_bf16_f32 v194, v226, v242
    v_cvt_pk_bf16_f32 v195, v227, v243
    ds_write_b128 v64, v[192:195] offset:256
    v_pk_add_f32 v[224:225], v[220:221], v[228:229] neg_lo:[0,1] neg_hi:[0,1]
    v_pk_add_f32 v[226:227], v[222:223], v[230:231] neg_lo:[0,1] neg_hi:[0,1]
    v_pk_add_f32 v[240:241], v[236:237], v[244:245] neg_lo:[0,1] neg_hi:[0,1]
    v_pk_add_f32 v[242:243], v[238:239], v[246:247] neg_lo:[0,1] neg_hi:[0,1]
    v_cvt_pk_bf16_f32 v196, v224, v240
    v_cvt_pk_bf16_f32 v197, v225, v241
    v_cvt_pk_bf16_f32 v198, v226, v242
    v_cvt_pk_bf16_f32 v199, v227, v243
    ds_write_b128 v64, v[196:199] offset:17152
    s_mov_b64 exec, 1
    ds_add_u32 v68, v75
    s_mov_b64 exec, -1
    s_mov_b32 s9, 0
W_lO:
    ds_read_b32 v4, v68 offset:0
    s_add_u32 s9, s9, 1
    s_cmp_gt_u32 s9, 1600000
    s_cbranch_scc1 W_dO
    s_waitcnt lgkmcnt(0)
    v_cmp_gt_u32 vcc, 4, v4
    s_nop 0
    s_cbranch_vccnz W_lO
W_dO:
    v_and_b32 v4, 4, v1
    v_lshl_add_u32 v5, v4, 6, v66
    ds_read_b128 v[120:123], v65 offset:0
    ds_read_b128 v[124:127], v65 offset:128
    ds_read_b128 v[128:131], v65 offset:320
    ds_read_b128 v[132:135], v70 offset:256
    ds_read_b128 v[136:139], v71 offset:432
    ds_read_b32 v140, v71 offset:448
    ds_read_b128 v[144:147], v71 offset:112
    ds_read_b32 v148, v71 offset:128
    ds_read_b128 v[152:155], v72 offset:304
    ds_read_b32 v156, v72 offset:320
    s_waitcnt lgkmcnt(9)
    buffer_store_dwordx4 v[120:123], v66, s[32:35], 0 offen offset:896 nt
    s_waitcnt lgkmcnt(8)
    buffer_store_dwordx4 v[124:127], v66, s[32:35], 0 offen offset:1024 nt
    s_waitcnt lgkmcnt(7)
    buffer_store_dwordx4 v[128:131], v66, s[32:35], 0 offen offset:1408 nt
    s_waitcnt lgkmcnt(6)
    buffer_store_dwordx4 v[132:135], v73, s[32:35], 0 offen offset:1344 nt
    s_waitcnt lgkmcnt(4)
    v_bfi_b32 v160, v74, v140, v139
    v_bfi_b32 v161, v74, v139, v138
    v_bfi_b32 v162, v74, v138, v137
    v_bfi_b32 v163, v74, v137, v136
    buffer_store_dwordx4 v[160:163], v66, s[32:35], 0 offen offset:1152 nt
    s_waitcnt lgkmcnt(2)
    v_bfi_b32 v164, v74, v148, v147
    v_bfi_b32 v165, v74, v147, v146
    v_bfi_b32 v166, v74, v146, v145
    v_bfi_b32 v167, v74, v145, v144
    buffer_store_dwordx4 v[164:167], v66, s[32:35], 0 offen offset:1664 nt
    s_waitcnt lgkmcnt(0)
    v_bfi_b32 v168, v74, v156, v155
    v_bfi_b32 v169, v74, v155, v154
    v_bfi_b32 v170, v74, v154, v153
    v_bfi_b32 v171, v74, v153, v152
    buffer_store_dwordx4 v[168:171], v5, s[32:35], 0 offen offset:1280 nt
    s_add_u32 s40, s8, s3
    s_cmp_lg_u32 s40, 0
    s_cbranch_scc1 S_end
    s_add_u32 s40, s10, 16
    v_mov_b32 v4, s40
    s_mov_b32 s40, 4096
    s_mov_b64 exec, 1
    buffer_store_dword v4, v12, s[36:39], s40 offen
S_end:
    s_endpgm
    s_endpgm
    s_endpgm
    s_endpgm
    s_endpgm
    s_endpgm
    s_endpgm
    s_endpgm
    s_endpgm
    s_endpgm
    s_endpgm
    s_endpgm
    s_endpgm
    s_endpgm
    s_endpgm
    s_endpgm
    s_endpgm
    s_endpgm
    s_endpgm
    s_endpgm
    s_endpgm
    s_endpgm
    s_endpgm
    s_endpgm
    s_endpgm
    s_endpgm
    s_endpgm
    s_endpgm
    s_endpgm
    s_endpgm
    s_endpgm
    s_endpgm
    s_endpgm
    s_endpgm
    s_endpgm
    s_endpgm
    s_endpgm
    s_endpgm
    s_endpgm
    s_endpgm
    s_endpgm
    s_endpgm
    s_endpgm
    s_endpgm
    s_endpgm
    s_endpgm
    s_endpgm
    s_endpgm
    s_endpgm
    s_endpgm
    s_endpgm
    s_endpgm
    s_endpgm
    s_endpgm
    s_endpgm
    s_endpgm
    s_endpgm
    s_endpgm
    s_endpgm
    s_endpgm
    s_endpgm
    s_endpgm
    s_endpgm
    s_endpgm
    s_endpgm
    s_endpgm
    s_endpgm
    s_endpgm
    s_endpgm
    s_endpgm
    s_endpgm
    s_endpgm
    s_endpgm
    s_endpgm
    s_endpgm
    s_endpgm
    s_endpgm
    s_endpgm
    s_endpgm
    s_endpgm
    s_endpgm
    s_endpgm
    s_endpgm
    s_endpgm
    s_endpgm
    s_endpgm
    s_endpgm
    s_endpgm
    s_endpgm
    s_endpgm
    s_endpgm
    s_endpgm
    s_endpgm
    s_endpgm
    s_endpgm
    s_endpgm
    s_endpgm
    s_endpgm
    s_endpgm
    s_endpgm
    s_endpgm
    s_endpgm
    s_endpgm
    s_endpgm
    s_endpgm
    s_endpgm
    s_endpgm
    s_endpgm
    s_endpgm
    s_endpgm
    s_endpgm
    s_endpgm
    s_endpgm
    s_endpgm
    s_endpgm
    s_endpgm
    s_endpgm
    s_endpgm
    s_endpgm
    s_endpgm
    s_endpgm
    s_endpgm
    s_endpgm
    s_endpgm
    s_endpgm
    s_endpgm
    s_endpgm
    s_endpgm
    s_endpgm
    s_endpgm
    s_endpgm
    s_endpgm
    s_endpgm
    s_endpgm
    s_endpgm
    s_endpgm
    s_endpgm
    s_endpgm
    s_endpgm
    s_endpgm
    s_endpgm
    s_endpgm
    s_endpgm
    s_endpgm
    s_endpgm
    s_endpgm
    s_endpgm
    s_endpgm
    s_endpgm
    s_endpgm
    s_endpgm
    s_endpgm
    s_endpgm
    s_endpgm
    s_endpgm
    s_endpgm
    s_endpgm
    s_endpgm
    s_endpgm
    s_endpgm
    s_endpgm
    s_endpgm
    s_endpgm
    s_endpgm
    s_endpgm
    s_endpgm
    s_endpgm
    s_endpgm
    s_endpgm
    s_endpgm
    s_endpgm
    s_endpgm
    s_endpgm
    s_endpgm
    s_endpgm
    s_endpgm
    s_endpgm
    s_endpgm
    s_endpgm
    s_endpgm
    s_endpgm
    s_endpgm
    s_endpgm
    s_endpgm
    s_endpgm
    s_endpgm
    s_endpgm
    s_endpgm
    s_endpgm
    s_endpgm
    s_endpgm
    s_endpgm
    s_endpgm
    s_endpgm
    s_endpgm
    s_endpgm
    s_endpgm
    s_endpgm
    s_endpgm
    s_endpgm
    s_endpgm
    s_endpgm
    s_endpgm
    s_endpgm
    s_endpgm
    s_endpgm
    s_endpgm
    s_endpgm
    s_endpgm
    s_endpgm
    s_endpgm
    s_endpgm
    s_endpgm
    s_endpgm
    s_endpgm
    s_endpgm
    s_endpgm
    s_endpgm
    s_endpgm
    s_endpgm
    s_endpgm
    s_endpgm
    s_endpgm
    s_endpgm
    s_endpgm
    s_endpgm
    s_endpgm
    s_endpgm
    s_endpgm
    s_endpgm
    s_endpgm
    s_endpgm
    s_endpgm
    s_endpgm
    s_endpgm
    s_endpgm
    s_endpgm
    s_endpgm
    s_endpgm
    s_endpgm
    s_endpgm
    s_endpgm
    s_endpgm
    s_endpgm
    s_endpgm
    s_endpgm
    s_endpgm
    s_endpgm
    s_endpgm
    s_endpgm
    s_endpgm
    s_endpgm
    s_endpgm
    s_endpgm
    s_endpgm
    s_endpgm
    s_endpgm
    s_endpgm
    s_endpgm
    s_endpgm
    s_endpgm
    s_endpgm
    s_endpgm
    s_endpgm
    s_endpgm
    s_endpgm
    s_endpgm
    s_endpgm
    s_endpgm
    s_endpgm
    s_endpgm
    s_endpgm
    s_endpgm
    s_endpgm
    s_endpgm
    s_endpgm
    s_endpgm
    s_endpgm
    s_endpgm
    s_endpgm
    s_endpgm
    s_endpgm
    s_endpgm
    s_endpgm
    s_endpgm
    s_endpgm
    s_endpgm
    s_endpgm
    s_endpgm
    s_endpgm
    s_endpgm
    s_endpgm
    s_endpgm
    s_endpgm
    s_endpgm
    s_endpgm
    s_endpgm
    s_endpgm
    s_endpgm
    s_endpgm
    s_endpgm
K_c:
    s_lshl_b32 s40, s8, 7
    s_waitcnt lgkmcnt(0)
    s_load_dwordx2 s[10:11], s[36:37], s40
    s_lshl_b32 s14, s8, 10
    s_add_u32 s14, s14, 65536
    s_getreg_b32 s52, hwreg(HW_REG_XCC_ID, 0, 3)
    s_mov_b32 s26, 401408
    s_mov_b32 s27, 0x00020000
    s_mov_b32 s34, 3670016
    s_mov_b32 s35, 0x00020000
    s_sub_u32 s62, s3, 4
    s_lshr_b32 s16, s62, 1
    s_and_b32 s17, s62, 1
    s_lshl_b32 s29, s62, 11
    v_and_b32 v1, 63, v0
    v_lshlrev_b32 v4, 4, v1
    s_lshl_b32 s1, s5, 3
    s_add_u32 s1, s1, s4
    s_mul_i32 s1, s1, 1792
    v_min_u32 v46, 13, v1
    v_lshlrev_b32 v46, 7, v46
    v_lshrrev_b32 v29, 4, v1
    v_and_b32 v30, 15, v1
    v_lshrrev_b32 v31, 3, v1
    v_and_b32 v32, 7, v1
    v_mov_b32 v5, 161792
    v_mov_b32 v6, 0
    v_lshl_add_u32 v2, v1, 2, v5
    ds_write_b32 v2, v6
    v_lshrrev_b32 v3, 1, v30
    v_xor_b32 v3, v3, v29
    v_lshlrev_b32 v3, 4, v3
    v_lshl_add_u32 v3, v30, 7, v3
    s_lshr_b32 s18, s62, 1
    s_lshl_b32 s18, s18, 12
    v_add_u32 v33, s18, v3
    v_xor_b32 v34, 64, v33
    v_add_u32 v35, 40960, v33
    v_add_u32 v36, 40960, v34
    v_lshrrev_b32 v3, 2, v30
    v_lshl_add_u32 v3, v29, 3, v3
    v_lshlrev_b32 v3, 7, v3
    v_and_b32 v7, 3, v1
    v_lshl_add_u32 v3, v7, 3, v3
    v_bfe_u32 v7, v1, 3, 2
    s_and_b32 s18, s62, 1
    s_lshl_b32 s18, s18, 1
    v_xor_b32 v7, s18, v7
    v_lshl_add_u32 v3, v7, 5, v3
    v_add_u32 v37, 71680, v3
    v_xor_b32 v38, 32, v37
    v_add_u32 v39, 49152, v37
    v_add_u32 v40, 49152, v38
    s_and_b32 s18, s62, 1
    s_lshl_b32 s19, s7, 1
    s_add_u32 s18, s18, s19
    s_cmp_ge_u32 s18, 7
    s_cselect_b32 s19, 14, 7
    s_sub_u32 s18, s19, s18
    v_cmp_gt_u32 s[54:55], s18, v29
    v_add_u32 v2, 4, v29
    v_cmp_gt_u32 s[56:57], s18, v2
    s_bitcmp0_b32 s62, 0
    s_cselect_b64 vcc, -1, 0
    s_xor_b64 s[54:55], s[54:55], vcc
    s_xor_b64 s[56:57], s[56:57], vcc
    v_lshrrev_b32 v3, 2, v30
    s_and_b32 s18, s62, 1
    s_lshl_b32 s19, s7, 1
    s_add_u32 s18, s18, s19
    s_cmp_ge_u32 s18, 7
    s_cselect_b32 s19, 14, 7
    s_sub_u32 s18, s19, s18
    v_cmp_gt_u32 s[58:59], s18, v3
    v_add_u32 v2, 4, v3
    v_cmp_gt_u32 s[60:61], s18, v2
    s_bitcmp0_b32 s62, 0
    s_cselect_b64 vcc, -1, 0
    s_xor_b64 s[58:59], s[58:59], vcc
    s_xor_b64 s[60:61], s[60:61], vcc
    s_and_b32 s18, s62, 1
    s_lshl_b32 s19, s7, 1
    s_add_u32 s18, s18, s19
    s_lshl_b32 s100, s18, 10
    s_lshl_b32 s18, s8, 2
    s_and_b32 s19, s62, 2
    s_add_u32 s18, s18, s19
    s_mul_i32 s19, s18, 14336
    s_add_u32 s100, s100, s19
    s_add_u32 s100, s100, 2097152
    s_lshl_b32 s20, s18, 6
    s_add_u32 s20, s20, 16384
    s_lshl_b32 s18, s17, 11
    s_sub_u32 s18, s18, 1024
    s_add_u32 s15, s100, s18
    s_lshl_b32 s19, s7, 1
    s_add_u32 s18, s17, s19
    s_lshl_b32 s18, s18, 3
    s_add_u32 s21, s20, s18
    v_and_b32 v2, 1, v30
    v_cmp_eq_u32 s[44:45], 1, v2
    v_lshl_add_u32 v2, v29, 2, v2
    v_cmp_le_u32 s[46:47], v2, v30
    v_add_u32 v2, 2, v2
    v_cmp_le_u32 s[48:49], v2, v30
    v_mov_b32 v2, 0xffff
    v_mov_b32 v3, 0xffff0000
    v_cndmask_b32 v2, v2, v3, s[44:45]
    v_cndmask_b32 v41, v2, 0, s[46:47]
    v_cndmask_b32 v42, v2, 0, s[48:49]
    v_cndmask_b32 v43, 0, v2, s[46:47]
    v_cndmask_b32 v44, 0, v2, s[48:49]
    s_add_u32 s18, s8, s16
    s_cmp_eq_u32 s18, 0
    s_cselect_b64 s[50:51], -1, 0
    s_mul_i32 s18, s17, 6
    s_cmp_eq_u32 s18, s7
    s_cselect_b32 s101, 1, 0
    v_mov_b32 v49, 1
    v_mov_b32 v50, 0xf149f2ca
    v_mov_b32 v51, 0xffffff00
    s_mov_b32 s0, 0x3e8b97f6
    s_add_u32 s18, s29, 4096
    v_add_u32 v47, s18, v4
    v_add_u32 v48, s29, v4
    v_lshl_add_u32 v52, s62, 2, v5
    v_lshl_add_u32 v222, s17, 10, v4
    v_add_u32 v223, 2048, v222
    v_lshl_add_u32 v224, s17, 2, v5
    v_lshl_add_u32 v225, s17, 3, v5
    s_lshl_b32 s18, s7, 7
    v_min_u32 v8, 11, v1
    s_lshl_b32 s19, s7, 1
    s_add_u32 s19, s19, 2
    v_add_u32 v8, s19, v8
    v_add_u32 v2, -14, v8
    v_min_u32 v8, v8, v2
    v_lshlrev_b32 v8, 3, v8
    v_lshl_add_u32 v18, s16, 12, v222
    v_add_u32 v19, s29, v4
    v_lshl_add_u32 v20, s16, 3, v5
    v_lshrrev_b32 v2, 2, v1
    v_bfe_u32 v3, v1, 3, 2
    v_lshlrev_b32 v3, 5, v3
    v_lshl_add_u32 v2, v2, 7, v3
    v_and_b32 v3, 3, v1
    v_lshl_add_u32 v2, v3, 3, v2
    v_add_u32 v21, 71680, v2
    v_xor_b32 v22, 32, v21
    v_xor_b32 v23, 64, v21
    v_xor_b32 v24, 96, v21
    s_add_u32 s19, s29, 4096
    v_lshrrev_b32 v2, 1, v29
    v_xor_b32 v2, v2, v32
    v_lshlrev_b32 v2, 4, v2
    v_lshl_add_u32 v2, v30, 7, v2
    v_and_b32 v3, 1, v29
    v_lshl_add_u32 v2, v3, 3, v2
    v_add_u32 v25, s19, v2
    v_xor_b32 v26, 32, v25
    v_xor_b32 v27, 64, v25
    v_xor_b32 v28, 96, v25
    v_mul_u32_u24 v10, 1792, v31
    v_lshl_add_u32 v10, v32, 4, v10
    v_xor_b32 v3, v32, v31
    v_lshlrev_b32 v3, 4, v3
    v_lshl_add_u32 v2, v31, 7, v3
    v_add_u32 v9, s19, v2
    s_lshl_b32 s19, s8, 2
    s_add_u32 s19, s19, s62
    s_mul_i32 s22, s19, 14336
    s_add_u32 s22, s22, 2097152
    s_mul_i32 s23, s19, 28672
    s_add_u32 s23, s23, s18
    s_add_u32 s28, s23, 14336
    s_waitcnt lgkmcnt(0)
    s_add_u32 s40, s7, 1
    s_sub_u32 s41, s40, 7
    s_min_u32 s40, s40, s41
    s_lshl_b32 s40, s40, 11
    s_add_u32 s1, s40, s22
    s_add_u32 s40, s7, 2
    s_sub_u32 s41, s40, 7
    s_min_u32 s40, s40, s41
    s_lshl_b32 s40, s40, 11
    s_add_u32 s4, s40, s22
    s_add_u32 s40, s7, 3
    s_sub_u32 s41, s40, 7
    s_min_u32 s40, s40, s41
    s_lshl_b32 s40, s40, 11
    s_add_u32 s6, s40, s22
    s_add_u32 s40, s7, 4
    s_sub_u32 s41, s40, 7
    s_min_u32 s40, s40, s41
    s_lshl_b32 s40, s40, 11
    s_add_u32 s24, s40, s22
    s_add_u32 s40, s7, 5
    s_sub_u32 s41, s40, 7
    s_min_u32 s40, s40, s41
    s_lshl_b32 s40, s40, 11
    s_add_u32 s25, s40, s22
    s_add_u32 s40, s7, 6
    s_sub_u32 s41, s40, 7
    s_min_u32 s40, s40, s41
    s_lshl_b32 s40, s40, 11
    s_add_u32 s26, s40, s22
    s_add_u32 s12, s10, 0x5a3c9671
    s_xor_b32 s13, s11, 0x2b7e1516
    s_add_u32 s52, s52, s12
    s_mov_b32 s53, s13
    v_mov_b32 v14, s12
    v_mov_b32 v15, s13
    s_bfe_u32 s40, s12, 0x80000
    v_mov_b32 v54, s40
    s_bfe_u32 s40, s12, 0x80008
    v_mov_b32 v55, s40
    s_bfe_u32 s40, s12, 0x80010
    v_mov_b32 v56, s40
    s_bfe_u32 s40, s12, 0x80018
    v_mov_b32 v57, s40
    s_setprio 3
    s_cmp_lg_u32 s62, 0
    s_cbranch_scc1 C_nox
    v_mov_b32 v12, s52
    v_mov_b32 v13, s53
    s_lshl_b32 s41, s7, 3
    s_add_u32 s40, s14, s41
    s_mov_b64 exec, 1
    buffer_store_dwordx2 v[12:13], v6, s[36:39], s40 offen sc1
    s_mov_b64 exec, -1
C_nox:
    s_cmp_lg_u32 s16, 0
    s_cbranch_scc1 C_tp1
    s_barrier
    ds_read_b128 v[134:137], v33 offset:2048
    ds_read_b64_tr_b16 v[178:179], v37 offset:8192
    ds_read_b64_tr_b16 v[180:181], v37 offset:8704
    ds_read_b128 v[146:149], v34 offset:2048
    ds_read_b64_tr_b16 v[182:183], v37 offset:12288
    ds_read_b64_tr_b16 v[184:185], v37 offset:12800
    ds_read_b128 v[138:141], v33 offset:4096
    ds_read_b128 v[150:153], v34 offset:4096
    ds_read_b64_tr_b16 v[186:187], v38 offset:8192
    ds_read_b64_tr_b16 v[188:189], v38 offset:8704
    ds_read_b64_tr_b16 v[190:191], v38 offset:12288
    ds_read_b64_tr_b16 v[192:193], v38 offset:12800
    s_waitcnt lgkmcnt(9)
    v_mfma_f32_16x16x32_bf16 v[66:69], v[178:181], v[134:137], 0
    ds_read_b128 v[130:133], v33 offset:0
    s_waitcnt lgkmcnt(7)
    v_mfma_f32_16x16x32_bf16 v[66:69], v[182:185], v[146:149], v[66:69]
    ds_read_b64_tr_b16 v[194:195], v37 offset:16384
    ds_read_b64_tr_b16 v[196:197], v37 offset:16896
    s_waitcnt lgkmcnt(8)
    v_mfma_f32_16x16x32_bf16 v[74:77], v[178:181], v[138:141], 0
    ds_read_b128 v[142:145], v34 offset:0
    ds_read_b64_tr_b16 v[198:199], v37 offset:20480
    s_waitcnt lgkmcnt(9)
    v_mfma_f32_16x16x32_bf16 v[74:77], v[182:185], v[150:153], v[74:77]
    ds_read_b64_tr_b16 v[200:201], v37 offset:20992
    s_waitcnt lgkmcnt(8)
    v_mfma_f32_16x16x32_bf16 v[70:73], v[186:189], v[134:137], 0
    ds_read_b64_tr_b16 v[178:179], v38 offset:16384
    s_waitcnt lgkmcnt(7)
    v_mfma_f32_16x16x32_bf16 v[70:73], v[190:193], v[146:149], v[70:73]
    ds_read_b64_tr_b16 v[180:181], v38 offset:16896
    v_mfma_f32_16x16x32_bf16 v[78:81], v[186:189], v[138:141], 0
    ds_read_b64_tr_b16 v[182:183], v38 offset:20480
    v_mfma_f32_16x16x32_bf16 v[78:81], v[190:193], v[150:153], v[78:81]
    ds_read_b64_tr_b16 v[184:185], v38 offset:20992
    s_waitcnt lgkmcnt(7)
    v_mfma_f32_16x16x32_bf16 v[82:85], v[194:197], v[130:133], 0
    ds_read_b64_tr_b16 v[186:187], v37 offset:24576
    s_waitcnt lgkmcnt(5)
    v_mfma_f32_16x16x32_bf16 v[82:85], v[198:201], v[142:145], v[82:85]
    ds_read_b64_tr_b16 v[188:189], v37 offset:25088
    v_mfma_f32_16x16x32_bf16 v[90:93], v[194:197], v[134:137], 0
    ds_read_b64_tr_b16 v[190:191], v37 offset:28672
    v_mfma_f32_16x16x32_bf16 v[90:93], v[198:201], v[146:149], v[90:93]
    ds_read_b64_tr_b16 v[192:193], v37 offset:29184
    v_mfma_f32_16x16x32_bf16 v[98:101], v[194:197], v[138:141], 0
    ds_read_b64_tr_b16 v[194:195], v38 offset:24576
    v_mfma_f32_16x16x32_bf16 v[98:101], v[198:201], v[150:153], v[98:101]
    ds_read_b64_tr_b16 v[196:197], v38 offset:25088
    s_waitcnt lgkmcnt(8)
    v_mfma_f32_16x16x32_bf16 v[86:89], v[178:181], v[130:133], 0
    ds_read_b64_tr_b16 v[198:199], v38 offset:28672
    s_waitcnt lgkmcnt(7)
    v_mfma_f32_16x16x32_bf16 v[86:89], v[182:185], v[142:145], v[86:89]
    ds_read_b64_tr_b16 v[200:201], v38 offset:29184
    v_mfma_f32_16x16x32_bf16 v[94:97], v[178:181], v[134:137], 0
    v_mfma_f32_16x16x32_bf16 v[94:97], v[182:185], v[146:149], v[94:97]
    v_mfma_f32_16x16x32_bf16 v[102:105], v[178:181], v[138:141], 0
    v_mfma_f32_16x16x32_bf16 v[102:105], v[182:185], v[150:153], v[102:105]
    s_waitcnt lgkmcnt(6)
    v_mfma_f32_16x16x32_bf16 v[106:109], v[130:133], v[186:189], 0
    s_waitcnt lgkmcnt(4)
    v_mfma_f32_16x16x32_bf16 v[106:109], v[142:145], v[190:193], v[106:109]
    v_mfma_f32_16x16x32_bf16 v[114:117], v[134:137], v[186:189], 0
    v_mfma_f32_16x16x32_bf16 v[114:117], v[146:149], v[190:193], v[114:117]
    s_waitcnt lgkmcnt(2)
    v_mfma_f32_16x16x32_bf16 v[110:113], v[130:133], v[194:197], 0
    s_waitcnt lgkmcnt(0)
    s_barrier
    ds_read_b128 v[158:161], v33 offset:12288
    ds_read_b64_tr_b16 v[178:179], v37 offset:32768
    ds_read_b64_tr_b16 v[180:181], v37 offset:33280
    ds_read_b128 v[170:173], v34 offset:12288
    ds_read_b64_tr_b16 v[182:183], v37 offset:36864
    ds_read_b64_tr_b16 v[184:185], v37 offset:37376
    ds_read_b128 v[162:165], v33 offset:14336
    ds_read_b128 v[174:177], v34 offset:14336
    ds_read_b64_tr_b16 v[186:187], v38 offset:32768
    ds_read_b64_tr_b16 v[188:189], v38 offset:33280
    ds_read_b64_tr_b16 v[190:191], v38 offset:36864
    ds_read_b64_tr_b16 v[192:193], v38 offset:37376
    ds_read_b128 v[154:157], v33 offset:10240
    v_mfma_f32_16x16x32_bf16 v[110:113], v[142:145], v[198:201], v[110:113]
    v_mfma_f32_16x16x32_bf16 v[118:121], v[134:137], v[194:197], 0
    ds_read_b64_tr_b16 v[194:195], v37 offset:40960
    v_mfma_f32_16x16x32_bf16 v[118:121], v[146:149], v[198:201], v[118:121]
    ds_read_b64_tr_b16 v[196:197], v37 offset:41472
    s_waitcnt lgkmcnt(12)
    v_mfma_f32_16x16x32_bf16 v[66:69], v[178:181], v[158:161], v[66:69]
    ds_read_b128 v[166:169], v34 offset:10240
    s_waitcnt lgkmcnt(10)
    v_mfma_f32_16x16x32_bf16 v[66:69], v[182:185], v[170:173], v[66:69]
    ds_read_b64_tr_b16 v[198:199], v37 offset:45056
    s_waitcnt lgkmcnt(10)
    v_mfma_f32_16x16x32_bf16 v[74:77], v[178:181], v[162:165], v[74:77]
    ds_read_b64_tr_b16 v[200:201], v37 offset:45568
    s_waitcnt lgkmcnt(10)
    v_mfma_f32_16x16x32_bf16 v[74:77], v[182:185], v[174:177], v[74:77]
    ds_read_b64_tr_b16 v[178:179], v38 offset:40960
    s_waitcnt lgkmcnt(9)
    v_mfma_f32_16x16x32_bf16 v[70:73], v[186:189], v[158:161], v[70:73]
    ds_read_b64_tr_b16 v[180:181], v38 offset:41472
    s_waitcnt lgkmcnt(8)
    v_mfma_f32_16x16x32_bf16 v[70:73], v[190:193], v[170:173], v[70:73]
    ds_read_b64_tr_b16 v[182:183], v38 offset:45056
    v_mfma_f32_16x16x32_bf16 v[78:81], v[186:189], v[162:165], v[78:81]
    ds_read_b64_tr_b16 v[184:185], v38 offset:45568
    v_mfma_f32_16x16x32_bf16 v[78:81], v[190:193], v[174:177], v[78:81]
    ds_read_b64_tr_b16 v[186:187], v39 offset:0
    s_waitcnt lgkmcnt(8)
    v_mfma_f32_16x16x32_bf16 v[82:85], v[194:197], v[154:157], v[82:85]
    ds_read_b64_tr_b16 v[188:189], v39 offset:512
    s_waitcnt lgkmcnt(6)
    v_mfma_f32_16x16x32_bf16 v[82:85], v[198:201], v[166:169], v[82:85]
    ds_read_b64_tr_b16 v[190:191], v39 offset:4096
    v_mfma_f32_16x16x32_bf16 v[90:93], v[194:197], v[158:161], v[90:93]
    ds_read_b64_tr_b16 v[192:193], v39 offset:4608
    v_mfma_f32_16x16x32_bf16 v[90:93], v[198:201], v[170:173], v[90:93]
    v_mfma_f32_16x16x32_bf16 v[98:101], v[194:197], v[162:165], v[98:101]
    ds_read_b64_tr_b16 v[194:195], v40 offset:0
    v_mfma_f32_16x16x32_bf16 v[98:101], v[198:201], v[174:177], v[98:101]
    ds_read_b64_tr_b16 v[196:197], v40 offset:512
    s_waitcnt lgkmcnt(8)
    v_mfma_f32_16x16x32_bf16 v[86:89], v[178:181], v[154:157], v[86:89]
    ds_read_b64_tr_b16 v[198:199], v40 offset:4096
    s_waitcnt lgkmcnt(7)
    v_mfma_f32_16x16x32_bf16 v[86:89], v[182:185], v[166:169], v[86:89]
    ds_read_b64_tr_b16 v[200:201], v40 offset:4608
    v_mfma_f32_16x16x32_bf16 v[94:97], v[178:181], v[158:161], v[94:97]
    v_mfma_f32_16x16x32_bf16 v[94:97], v[182:185], v[170:173], v[94:97]
    v_mfma_f32_16x16x32_bf16 v[102:105], v[178:181], v[162:165], v[102:105]
    v_mfma_f32_16x16x32_bf16 v[102:105], v[182:185], v[174:177], v[102:105]
    s_waitcnt lgkmcnt(6)
    v_mfma_f32_16x16x32_bf16 v[106:109], v[154:157], v[186:189], v[106:109]
    s_waitcnt lgkmcnt(4)
    v_mfma_f32_16x16x32_bf16 v[106:109], v[166:169], v[190:193], v[106:109]
    v_mfma_f32_16x16x32_bf16 v[114:117], v[158:161], v[186:189], v[114:117]
    v_mfma_f32_16x16x32_bf16 v[114:117], v[170:173], v[190:193], v[114:117]
    s_waitcnt lgkmcnt(2)
    v_mfma_f32_16x16x32_bf16 v[110:113], v[154:157], v[194:197], v[110:113]
    s_waitcnt lgkmcnt(0)
    s_barrier
    ds_read_b128 v[134:137], v33 offset:22528
    ds_read_b64_tr_b16 v[178:179], v39 offset:8192
    ds_read_b64_tr_b16 v[180:181], v39 offset:8704
    ds_read_b128 v[146:149], v34 offset:22528
    ds_read_b64_tr_b16 v[182:183], v39 offset:12288
    ds_read_b64_tr_b16 v[184:185], v39 offset:12800
    ds_read_b128 v[138:141], v33 offset:24576
    ds_read_b128 v[150:153], v34 offset:24576
    ds_read_b64_tr_b16 v[186:187], v40 offset:8192
    ds_read_b64_tr_b16 v[188:189], v40 offset:8704
    ds_read_b64_tr_b16 v[190:191], v40 offset:12288
    ds_read_b64_tr_b16 v[192:193], v40 offset:12800
    ds_read_b128 v[130:133], v33 offset:20480
    v_mfma_f32_16x16x32_bf16 v[110:113], v[166:169], v[198:201], v[110:113]
    v_mfma_f32_16x16x32_bf16 v[118:121], v[158:161], v[194:197], v[118:121]
    ds_read_b64_tr_b16 v[194:195], v39 offset:16384
    v_mfma_f32_16x16x32_bf16 v[118:121], v[170:173], v[198:201], v[118:121]
    ds_read_b64_tr_b16 v[196:197], v39 offset:16896
    s_waitcnt lgkmcnt(12)
    v_mfma_f32_16x16x32_bf16 v[66:69], v[178:181], v[134:137], v[66:69]
    ds_read_b128 v[142:145], v34 offset:20480
    s_waitcnt lgkmcnt(10)
    v_mfma_f32_16x16x32_bf16 v[66:69], v[182:185], v[146:149], v[66:69]
    ds_read_b64_tr_b16 v[198:199], v39 offset:20480
    s_waitcnt lgkmcnt(10)
    v_mfma_f32_16x16x32_bf16 v[74:77], v[178:181], v[138:141], v[74:77]
    ds_read_b64_tr_b16 v[200:201], v39 offset:20992
    s_waitcnt lgkmcnt(10)
    v_mfma_f32_16x16x32_bf16 v[74:77], v[182:185], v[150:153], v[74:77]
    ds_read_b64_tr_b16 v[178:179], v40 offset:16384
    s_waitcnt lgkmcnt(9)
    v_mfma_f32_16x16x32_bf16 v[70:73], v[186:189], v[134:137], v[70:73]
    ds_read_b64_tr_b16 v[180:181], v40 offset:16896
    s_waitcnt lgkmcnt(8)
    v_mfma_f32_16x16x32_bf16 v[70:73], v[190:193], v[146:149], v[70:73]
    ds_read_b64_tr_b16 v[182:183], v40 offset:20480
    v_mfma_f32_16x16x32_bf16 v[78:81], v[186:189], v[138:141], v[78:81]
    ds_read_b64_tr_b16 v[184:185], v40 offset:20992
    v_mfma_f32_16x16x32_bf16 v[78:81], v[190:193], v[150:153], v[78:81]
    ds_read_b64_tr_b16 v[186:187], v39 offset:24576
    s_waitcnt lgkmcnt(8)
    v_mfma_f32_16x16x32_bf16 v[82:85], v[194:197], v[130:133], v[82:85]
    ds_read_b64_tr_b16 v[188:189], v39 offset:25088
    s_waitcnt lgkmcnt(6)
    v_mfma_f32_16x16x32_bf16 v[82:85], v[198:201], v[142:145], v[82:85]
    ds_read_b64_tr_b16 v[190:191], v39 offset:28672
    v_mfma_f32_16x16x32_bf16 v[90:93], v[194:197], v[134:137], v[90:93]
    ds_read_b64_tr_b16 v[192:193], v39 offset:29184
    v_mfma_f32_16x16x32_bf16 v[90:93], v[198:201], v[146:149], v[90:93]
    v_mfma_f32_16x16x32_bf16 v[98:101], v[194:197], v[138:141], v[98:101]
    ds_read_b64_tr_b16 v[194:195], v40 offset:24576
    v_mfma_f32_16x16x32_bf16 v[98:101], v[198:201], v[150:153], v[98:101]
    ds_read_b64_tr_b16 v[196:197], v40 offset:25088
    s_waitcnt lgkmcnt(8)
    v_mfma_f32_16x16x32_bf16 v[86:89], v[178:181], v[130:133], v[86:89]
    ds_read_b64_tr_b16 v[198:199], v40 offset:28672
    s_waitcnt lgkmcnt(7)
    v_mfma_f32_16x16x32_bf16 v[86:89], v[182:185], v[142:145], v[86:89]
    ds_read_b64_tr_b16 v[200:201], v40 offset:29184
    v_mfma_f32_16x16x32_bf16 v[94:97], v[178:181], v[134:137], v[94:97]
    v_mfma_f32_16x16x32_bf16 v[94:97], v[182:185], v[146:149], v[94:97]
    v_mfma_f32_16x16x32_bf16 v[102:105], v[178:181], v[138:141], v[102:105]
    v_mfma_f32_16x16x32_bf16 v[102:105], v[182:185], v[150:153], v[102:105]
    s_waitcnt lgkmcnt(6)
    v_mfma_f32_16x16x32_bf16 v[106:109], v[130:133], v[186:189], v[106:109]
    s_waitcnt lgkmcnt(4)
    v_mfma_f32_16x16x32_bf16 v[106:109], v[142:145], v[190:193], v[106:109]
    v_mfma_f32_16x16x32_bf16 v[114:117], v[134:137], v[186:189], v[114:117]
    v_mfma_f32_16x16x32_bf16 v[114:117], v[146:149], v[190:193], v[114:117]
    s_waitcnt lgkmcnt(2)
    v_mfma_f32_16x16x32_bf16 v[110:113], v[130:133], v[194:197], v[110:113]
    s_waitcnt lgkmcnt(0)
    s_barrier
    ds_read_b128 v[158:161], v33 offset:32768
    ds_read_b64_tr_b16 v[178:179], v39 offset:32768
    ds_read_b64_tr_b16 v[180:181], v39 offset:33280
    ds_read_b128 v[170:173], v34 offset:32768
    ds_read_b64_tr_b16 v[182:183], v39 offset:36864
    ds_read_b64_tr_b16 v[184:185], v39 offset:37376
    ds_read_b128 v[162:165], v33 offset:34816
    ds_read_b128 v[174:177], v34 offset:34816
    ds_read_b64_tr_b16 v[186:187], v40 offset:32768
    ds_read_b64_tr_b16 v[188:189], v40 offset:33280
    ds_read_b64_tr_b16 v[190:191], v40 offset:36864
    ds_read_b64_tr_b16 v[192:193], v40 offset:37376
    ds_read_b128 v[154:157], v33 offset:30720
    v_mfma_f32_16x16x32_bf16 v[110:113], v[142:145], v[198:201], v[110:113]
    v_mfma_f32_16x16x32_bf16 v[118:121], v[134:137], v[194:197], v[118:121]
    ds_read_b64_tr_b16 v[194:195], v37 offset:0
    v_mfma_f32_16x16x32_bf16 v[118:121], v[146:149], v[198:201], v[118:121]
    ds_read_b64_tr_b16 v[196:197], v37 offset:512
    s_waitcnt lgkmcnt(12)
    v_mfma_f32_16x16x32_bf16 v[66:69], v[178:181], v[158:161], v[66:69]
    ds_read_b128 v[166:169], v34 offset:30720
    s_waitcnt lgkmcnt(10)
    v_mfma_f32_16x16x32_bf16 v[66:69], v[182:185], v[170:173], v[66:69]
    ds_read_b64_tr_b16 v[198:199], v37 offset:4096
    s_waitcnt lgkmcnt(10)
    v_mfma_f32_16x16x32_bf16 v[74:77], v[178:181], v[162:165], v[74:77]
    ds_read_b64_tr_b16 v[200:201], v37 offset:4608
    s_waitcnt lgkmcnt(10)
    v_mfma_f32_16x16x32_bf16 v[74:77], v[182:185], v[174:177], v[74:77]
    ds_read_b64_tr_b16 v[178:179], v38 offset:0
    s_waitcnt lgkmcnt(9)
    v_mfma_f32_16x16x32_bf16 v[70:73], v[186:189], v[158:161], v[70:73]
    ds_read_b64_tr_b16 v[180:181], v38 offset:512
    s_waitcnt lgkmcnt(8)
    v_mfma_f32_16x16x32_bf16 v[70:73], v[190:193], v[170:173], v[70:73]
    ds_read_b64_tr_b16 v[182:183], v38 offset:4096
    v_mfma_f32_16x16x32_bf16 v[78:81], v[186:189], v[162:165], v[78:81]
    ds_read_b64_tr_b16 v[184:185], v38 offset:4608
    v_mfma_f32_16x16x32_bf16 v[78:81], v[190:193], v[174:177], v[78:81]
    ds_read_b64_tr_b16 v[186:187], v37 offset:8192
    s_waitcnt lgkmcnt(8)
    v_mfma_f32_16x16x32_bf16 v[82:85], v[194:197], v[154:157], v[82:85]
    ds_read_b64_tr_b16 v[188:189], v37 offset:8704
    s_waitcnt lgkmcnt(6)
    v_mfma_f32_16x16x32_bf16 v[82:85], v[198:201], v[166:169], v[82:85]
    ds_read_b64_tr_b16 v[190:191], v37 offset:12288
    v_mfma_f32_16x16x32_bf16 v[90:93], v[194:197], v[158:161], v[90:93]
    ds_read_b64_tr_b16 v[192:193], v37 offset:12800
    v_mfma_f32_16x16x32_bf16 v[90:93], v[198:201], v[170:173], v[90:93]
    v_mfma_f32_16x16x32_bf16 v[98:101], v[194:197], v[162:165], v[98:101]
    ds_read_b64_tr_b16 v[194:195], v38 offset:8192
    v_mfma_f32_16x16x32_bf16 v[98:101], v[198:201], v[174:177], v[98:101]
    ds_read_b64_tr_b16 v[196:197], v38 offset:8704
    s_waitcnt lgkmcnt(8)
    v_mfma_f32_16x16x32_bf16 v[86:89], v[178:181], v[154:157], v[86:89]
    ds_read_b64_tr_b16 v[198:199], v38 offset:12288
    s_waitcnt lgkmcnt(7)
    v_mfma_f32_16x16x32_bf16 v[86:89], v[182:185], v[166:169], v[86:89]
    ds_read_b64_tr_b16 v[200:201], v38 offset:12800
    v_mfma_f32_16x16x32_bf16 v[94:97], v[178:181], v[158:161], v[94:97]
    v_mfma_f32_16x16x32_bf16 v[94:97], v[182:185], v[170:173], v[94:97]
    v_mfma_f32_16x16x32_bf16 v[102:105], v[178:181], v[162:165], v[102:105]
    v_mfma_f32_16x16x32_bf16 v[102:105], v[182:185], v[174:177], v[102:105]
    s_waitcnt lgkmcnt(6)
    v_mfma_f32_16x16x32_bf16 v[106:109], v[154:157], v[186:189], v[106:109]
    s_waitcnt lgkmcnt(4)
    v_mfma_f32_16x16x32_bf16 v[106:109], v[166:169], v[190:193], v[106:109]
    v_mfma_f32_16x16x32_bf16 v[114:117], v[158:161], v[186:189], v[114:117]
    v_mfma_f32_16x16x32_bf16 v[114:117], v[170:173], v[190:193], v[114:117]
    s_waitcnt lgkmcnt(2)
    v_mfma_f32_16x16x32_bf16 v[110:113], v[154:157], v[194:197], v[110:113]
    s_waitcnt lgkmcnt(0)
    s_barrier
    ds_read_b128 v[134:137], v35 offset:2048
    ds_read_b64_tr_b16 v[178:179], v37 offset:16384
    ds_read_b64_tr_b16 v[180:181], v37 offset:16896
    ds_read_b128 v[146:149], v36 offset:2048
    ds_read_b64_tr_b16 v[182:183], v37 offset:20480
    ds_read_b64_tr_b16 v[184:185], v37 offset:20992
    ds_read_b128 v[138:141], v35 offset:4096
    ds_read_b128 v[150:153], v36 offset:4096
    ds_read_b64_tr_b16 v[186:187], v38 offset:16384
    ds_read_b64_tr_b16 v[188:189], v38 offset:16896
    ds_read_b64_tr_b16 v[190:191], v38 offset:20480
    ds_read_b64_tr_b16 v[192:193], v38 offset:20992
    ds_read_b128 v[130:133], v35 offset:0
    v_mfma_f32_16x16x32_bf16 v[110:113], v[166:169], v[198:201], v[110:113]
    v_mfma_f32_16x16x32_bf16 v[118:121], v[158:161], v[194:197], v[118:121]
    ds_read_b64_tr_b16 v[194:195], v37 offset:24576
    v_mfma_f32_16x16x32_bf16 v[118:121], v[170:173], v[198:201], v[118:121]
    ds_read_b64_tr_b16 v[196:197], v37 offset:25088
    s_waitcnt lgkmcnt(12)
    v_mfma_f32_16x16x32_bf16 v[66:69], v[178:181], v[134:137], v[66:69]
    ds_read_b128 v[142:145], v36 offset:0
    s_waitcnt lgkmcnt(10)
    v_mfma_f32_16x16x32_bf16 v[66:69], v[182:185], v[146:149], v[66:69]
    ds_read_b64_tr_b16 v[198:199], v37 offset:28672
    s_waitcnt lgkmcnt(10)
    v_mfma_f32_16x16x32_bf16 v[74:77], v[178:181], v[138:141], v[74:77]
    ds_read_b64_tr_b16 v[200:201], v37 offset:29184
    s_waitcnt lgkmcnt(10)
    v_mfma_f32_16x16x32_bf16 v[74:77], v[182:185], v[150:153], v[74:77]
    ds_read_b64_tr_b16 v[178:179], v38 offset:24576
    s_waitcnt lgkmcnt(9)
    v_mfma_f32_16x16x32_bf16 v[70:73], v[186:189], v[134:137], v[70:73]
    ds_read_b64_tr_b16 v[180:181], v38 offset:25088
    s_waitcnt lgkmcnt(8)
    v_mfma_f32_16x16x32_bf16 v[70:73], v[190:193], v[146:149], v[70:73]
    ds_read_b64_tr_b16 v[182:183], v38 offset:28672
    v_mfma_f32_16x16x32_bf16 v[78:81], v[186:189], v[138:141], v[78:81]
    ds_read_b64_tr_b16 v[184:185], v38 offset:29184
    v_mfma_f32_16x16x32_bf16 v[78:81], v[190:193], v[150:153], v[78:81]
    ds_read_b64_tr_b16 v[186:187], v37 offset:32768
    s_waitcnt lgkmcnt(8)
    v_mfma_f32_16x16x32_bf16 v[82:85], v[194:197], v[130:133], v[82:85]
    ds_read_b64_tr_b16 v[188:189], v37 offset:33280
    s_waitcnt lgkmcnt(6)
    v_mfma_f32_16x16x32_bf16 v[82:85], v[198:201], v[142:145], v[82:85]
    ds_read_b64_tr_b16 v[190:191], v37 offset:36864
    v_mfma_f32_16x16x32_bf16 v[90:93], v[194:197], v[134:137], v[90:93]
    ds_read_b64_tr_b16 v[192:193], v37 offset:37376
    v_mfma_f32_16x16x32_bf16 v[90:93], v[198:201], v[146:149], v[90:93]
    v_mfma_f32_16x16x32_bf16 v[98:101], v[194:197], v[138:141], v[98:101]
    ds_read_b64_tr_b16 v[194:195], v38 offset:32768
    v_mfma_f32_16x16x32_bf16 v[98:101], v[198:201], v[150:153], v[98:101]
    ds_read_b64_tr_b16 v[196:197], v38 offset:33280
    s_waitcnt lgkmcnt(8)
    v_mfma_f32_16x16x32_bf16 v[86:89], v[178:181], v[130:133], v[86:89]
    ds_read_b64_tr_b16 v[198:199], v38 offset:36864
    s_waitcnt lgkmcnt(7)
    v_mfma_f32_16x16x32_bf16 v[86:89], v[182:185], v[142:145], v[86:89]
    ds_read_b64_tr_b16 v[200:201], v38 offset:37376
    v_mfma_f32_16x16x32_bf16 v[94:97], v[178:181], v[134:137], v[94:97]
    v_mfma_f32_16x16x32_bf16 v[94:97], v[182:185], v[146:149], v[94:97]
    v_mfma_f32_16x16x32_bf16 v[102:105], v[178:181], v[138:141], v[102:105]
    v_mfma_f32_16x16x32_bf16 v[102:105], v[182:185], v[150:153], v[102:105]
    s_waitcnt lgkmcnt(6)
    v_mfma_f32_16x16x32_bf16 v[106:109], v[130:133], v[186:189], v[106:109]
    s_waitcnt lgkmcnt(4)
    v_mfma_f32_16x16x32_bf16 v[106:109], v[142:145], v[190:193], v[106:109]
    v_mfma_f32_16x16x32_bf16 v[114:117], v[134:137], v[186:189], v[114:117]
    v_mfma_f32_16x16x32_bf16 v[114:117], v[146:149], v[190:193], v[114:117]
    s_waitcnt lgkmcnt(2)
    v_mfma_f32_16x16x32_bf16 v[110:113], v[130:133], v[194:197], v[110:113]
    s_waitcnt lgkmcnt(0)
    s_barrier
    ds_read_b128 v[158:161], v35 offset:12288
    ds_read_b64_tr_b16 v[178:179], v37 offset:40960
    ds_read_b64_tr_b16 v[180:181], v37 offset:41472
    ds_read_b128 v[170:173], v36 offset:12288
    ds_read_b64_tr_b16 v[182:183], v37 offset:45056
    ds_read_b64_tr_b16 v[184:185], v37 offset:45568
    ds_read_b128 v[162:165], v35 offset:14336
    ds_read_b128 v[174:177], v36 offset:14336
    ds_read_b64_tr_b16 v[186:187], v38 offset:40960
    ds_read_b64_tr_b16 v[188:189], v38 offset:41472
    ds_read_b64_tr_b16 v[190:191], v38 offset:45056
    ds_read_b64_tr_b16 v[192:193], v38 offset:45568
    ds_read_b128 v[154:157], v35 offset:10240
    v_mfma_f32_16x16x32_bf16 v[110:113], v[142:145], v[198:201], v[110:113]
    ds_read_b64_tr_b16 v[202:203], v39 offset:0
    v_mfma_f32_16x16x32_bf16 v[118:121], v[134:137], v[194:197], v[118:121]
    ds_read_b64_tr_b16 v[204:205], v39 offset:512
    v_mfma_f32_16x16x32_bf16 v[118:121], v[146:149], v[198:201], v[118:121]
    ds_read_b128 v[166:169], v36 offset:10240
    s_waitcnt lgkmcnt(13)
    v_mfma_f32_16x16x32_bf16 v[66:69], v[178:181], v[158:161], v[66:69]
    ds_read_b64_tr_b16 v[206:207], v39 offset:4096
    s_waitcnt lgkmcnt(11)
    v_mfma_f32_16x16x32_bf16 v[66:69], v[182:185], v[170:173], v[66:69]
    ds_read_b64_tr_b16 v[208:209], v39 offset:4608
    s_waitcnt lgkmcnt(11)
    v_mfma_f32_16x16x32_bf16 v[74:77], v[178:181], v[162:165], v[74:77]
    ds_read_b64_tr_b16 v[194:195], v40 offset:0
    s_waitcnt lgkmcnt(11)
    v_mfma_f32_16x16x32_bf16 v[74:77], v[182:185], v[174:177], v[74:77]
    ds_read_b64_tr_b16 v[196:197], v40 offset:512
    s_waitcnt lgkmcnt(10)
    v_mfma_f32_16x16x32_bf16 v[70:73], v[186:189], v[158:161], v[70:73]
    ds_read_b64_tr_b16 v[198:199], v40 offset:4096
    s_waitcnt lgkmcnt(9)
    v_mfma_f32_16x16x32_bf16 v[70:73], v[190:193], v[170:173], v[70:73]
    ds_read_b64_tr_b16 v[200:201], v40 offset:4608
    v_mfma_f32_16x16x32_bf16 v[78:81], v[186:189], v[162:165], v[78:81]
    v_mfma_f32_16x16x32_bf16 v[78:81], v[190:193], v[174:177], v[78:81]
    s_waitcnt lgkmcnt(7)
    v_mfma_f32_16x16x32_bf16 v[82:85], v[202:205], v[154:157], v[82:85]
    s_waitcnt lgkmcnt(4)
    v_mfma_f32_16x16x32_bf16 v[82:85], v[206:209], v[166:169], v[82:85]
    v_mfma_f32_16x16x32_bf16 v[90:93], v[202:205], v[158:161], v[90:93]
    v_mfma_f32_16x16x32_bf16 v[90:93], v[206:209], v[170:173], v[90:93]
    v_mfma_f32_16x16x32_bf16 v[98:101], v[202:205], v[162:165], v[98:101]
    v_mfma_f32_16x16x32_bf16 v[98:101], v[206:209], v[174:177], v[98:101]
    s_waitcnt lgkmcnt(2)
    v_mfma_f32_16x16x32_bf16 v[86:89], v[194:197], v[154:157], v[86:89]
    s_waitcnt lgkmcnt(0)
    v_mfma_f32_16x16x32_bf16 v[86:89], v[198:201], v[166:169], v[86:89]
    v_mfma_f32_16x16x32_bf16 v[94:97], v[194:197], v[158:161], v[94:97]
    v_mfma_f32_16x16x32_bf16 v[94:97], v[198:201], v[170:173], v[94:97]
    v_mfma_f32_16x16x32_bf16 v[102:105], v[194:197], v[162:165], v[102:105]
    s_barrier
    ds_read_b128 v[134:137], v35 offset:22528
    ds_read_b64_tr_b16 v[178:179], v39 offset:8192
    ds_read_b64_tr_b16 v[180:181], v39 offset:8704
    ds_read_b128 v[146:149], v36 offset:22528
    ds_read_b64_tr_b16 v[182:183], v39 offset:12288
    ds_read_b64_tr_b16 v[184:185], v39 offset:12800
    ds_read_b128 v[138:141], v35 offset:24576
    ds_read_b128 v[150:153], v36 offset:24576
    ds_read_b64_tr_b16 v[186:187], v40 offset:8192
    ds_read_b64_tr_b16 v[188:189], v40 offset:8704
    ds_read_b64_tr_b16 v[190:191], v40 offset:12288
    ds_read_b64_tr_b16 v[192:193], v40 offset:12800
    ds_read_b128 v[130:133], v35 offset:20480
    v_mfma_f32_16x16x32_bf16 v[102:105], v[198:201], v[174:177], v[102:105]
    ds_read_b128 v[142:145], v36 offset:20480
    s_waitcnt lgkmcnt(11)
    v_mfma_f32_16x16x32_bf16 v[66:69], v[178:181], v[134:137], v[66:69]
    s_barrier
    ds_read_b64_tr_b16 v[202:203], v39 offset:16384
    ds_read_b64_tr_b16 v[204:205], v39 offset:16896
    ds_read_b64_tr_b16 v[206:207], v39 offset:20480
    ds_read_b64_tr_b16 v[208:209], v39 offset:20992
    ds_read_b64_tr_b16 v[194:195], v40 offset:16384
    s_waitcnt lgkmcnt(13)
    v_mfma_f32_16x16x32_bf16 v[66:69], v[182:185], v[146:149], v[66:69]
    ds_read_b64_tr_b16 v[196:197], v40 offset:16896
    s_waitcnt lgkmcnt(13)
    v_mfma_f32_16x16x32_bf16 v[74:77], v[178:181], v[138:141], v[74:77]
    ds_read_b64_tr_b16 v[198:199], v40 offset:20480
    s_waitcnt lgkmcnt(13)
    v_mfma_f32_16x16x32_bf16 v[74:77], v[182:185], v[150:153], v[74:77]
    ds_read_b64_tr_b16 v[200:201], v40 offset:20992
    s_waitcnt lgkmcnt(12)
    v_mfma_f32_16x16x32_bf16 v[70:73], v[186:189], v[134:137], v[70:73]
    v_cvt_pk_bf16_f32 v154, v66, v67
    v_cvt_pk_bf16_f32 v155, v68, v69
    s_waitcnt lgkmcnt(10)
    v_mfma_f32_16x16x32_bf16 v[70:73], v[190:193], v[146:149], v[70:73]
    v_cndmask_b32 v162, 0, v154, s[54:55]
    v_cndmask_b32 v154, v154, 0, s[54:55]
    v_mfma_f32_16x16x32_bf16 v[78:81], v[186:189], v[138:141], v[78:81]
    v_cndmask_b32 v163, 0, v155, s[54:55]
    v_cndmask_b32 v155, v155, 0, s[54:55]
    v_mfma_f32_16x16x32_bf16 v[78:81], v[190:193], v[150:153], v[78:81]
    v_cvt_pk_bf16_f32 v158, v74, v75
    v_cvt_pk_bf16_f32 v159, v76, v77
    s_waitcnt lgkmcnt(6)
    v_mfma_f32_16x16x32_bf16 v[98:101], v[202:205], v[138:141], v[98:101]
    v_cndmask_b32 v166, 0, v158, s[54:55]
    v_cndmask_b32 v158, v158, 0, s[54:55]
    s_waitcnt lgkmcnt(4)
    v_mfma_f32_16x16x32_bf16 v[98:101], v[206:209], v[150:153], v[98:101]
    v_cndmask_b32 v167, 0, v159, s[54:55]
    v_cndmask_b32 v159, v159, 0, s[54:55]
    s_waitcnt lgkmcnt(2)
    v_mfma_f32_16x16x32_bf16 v[102:105], v[194:197], v[138:141], v[102:105]
    v_cvt_pk_bf16_f32 v156, v70, v71
    v_cvt_pk_bf16_f32 v157, v72, v73
    s_waitcnt lgkmcnt(0)
    v_mfma_f32_16x16x32_bf16 v[102:105], v[198:201], v[150:153], v[102:105]
    v_cndmask_b32 v164, 0, v156, s[56:57]
    v_cndmask_b32 v156, v156, 0, s[56:57]
    v_mfma_f32_16x16x32_bf16 v[82:85], v[202:205], v[130:133], v[82:85]
    v_cndmask_b32 v165, 0, v157, s[56:57]
    v_cndmask_b32 v157, v157, 0, s[56:57]
    v_mfma_f32_16x16x32_bf16 v[82:85], v[206:209], v[142:145], v[82:85]
    v_cvt_pk_bf16_f32 v160, v78, v79
    v_cvt_pk_bf16_f32 v161, v80, v81
    v_mfma_f32_16x16x32_bf16 v[86:89], v[194:197], v[130:133], v[86:89]
    v_cndmask_b32 v168, 0, v160, s[56:57]
    v_cndmask_b32 v160, v160, 0, s[56:57]
    v_mfma_f32_16x16x32_bf16 v[86:89], v[198:201], v[142:145], v[86:89]
    v_cndmask_b32 v169, 0, v161, s[56:57]
    v_cndmask_b32 v161, v161, 0, s[56:57]
    v_mfma_f32_16x16x32_bf16 v[90:93], v[202:205], v[134:137], v[90:93]
    v_cvt_pk_bf16_f32 v238, v98, v99
    v_cvt_pk_bf16_f32 v239, v100, v101
    v_mfma_f32_16x16x32_bf16 v[90:93], v[206:209], v[146:149], v[90:93]
    v_cvt_pk_bf16_f32 v240, v102, v103
    v_cvt_pk_bf16_f32 v241, v104, v105
    v_mfma_f32_16x16x32_bf16 v[94:97], v[194:197], v[134:137], v[94:97]
    ds_write_b128 v222, v[238:241]
    ds_write_b32 v224, v5 offset:56
    v_mfma_f32_16x16x32_bf16 v[94:97], v[198:201], v[146:149], v[94:97]
    ds_read_b32 v45, v5 offset:4
    v_cvt_pk_bf16_f32 v230, v82, v83
    v_cvt_pk_bf16_f32 v231, v84, v85
    v_cvt_pk_bf16_f32 v232, v86, v87
    v_cvt_pk_bf16_f32 v233, v88, v89
    s_nop 1
    v_mfma_f32_16x16x32_bf16 v[66:69], v[230:233], v[154:157], 0
    v_mfma_f32_16x16x32_bf16 v[78:81], v[238:241], v[158:161], 0
    v_cvt_pk_bf16_f32 v234, v90, v91
    v_cvt_pk_bf16_f32 v235, v92, v93
    v_cvt_pk_bf16_f32 v236, v94, v95
    v_cvt_pk_bf16_f32 v237, v96, v97
    s_nop 1
    v_mfma_f32_16x16x32_bf16 v[70:73], v[234:237], v[154:157], 0
    v_mfma_f32_16x16x32_bf16 v[74:77], v[234:237], v[158:161], 0
    v_mfma_f32_16x16x32_bf16 v[178:181], v[230:233], v[162:165], 0
    v_mfma_f32_16x16x32_bf16 v[182:185], v[234:237], v[162:165], 0
    s_waitcnt lgkmcnt(0)
    v_readfirstlane_b32 s63, v45
    s_nop 2
    v_cndmask_b32 v70, v70, v71, s[44:45]
    v_cndmask_b32 v72, v72, v73, s[44:45]
    v_cndmask_b32 v66, v66, v67, s[44:45]
    v_cndmask_b32 v68, v68, v69, s[44:45]
    v_cndmask_b32 v66, v66, v50, s[50:51]
    v_cndmask_b32 v68, v68, v50, s[50:51]
    v_cndmask_b32 v214, v66, v70, s[46:47]
    v_cndmask_b32 v215, v68, v72, s[48:49]
    v_cndmask_b32 v78, v78, v79, s[44:45]
    v_cndmask_b32 v80, v80, v81, s[44:45]
    v_cndmask_b32 v74, v74, v75, s[44:45]
    v_cndmask_b32 v76, v76, v77, s[44:45]
    v_cndmask_b32 v216, v74, v78, s[46:47]
    v_cndmask_b32 v217, v76, v80, s[48:49]
    v_and_or_b32 v98, v214, v51, v54
    v_and_or_b32 v99, v215, v51, v55
    v_and_or_b32 v100, v216, v51, v56
    v_and_or_b32 v101, v217, v51, v57
    s_sub_u32 s63, s63, 1
    s_cbranch_scc1 C_mr0
C_md0:
    s_cmp_lg_u32 s101, 0
    s_cbranch_scc1 SM_jS0
    s_cmp_eq_u32 s63, 0
    s_cbranch_scc1 SM_sS0
    buffer_store_dwordx4 v[98:101], v4, s[36:39], s15 offen
SM_jS0:
    v_mfma_f32_16x16x32_bf16 v[186:189], v[234:237], v[166:169], 0
    v_mfma_f32_16x16x32_bf16 v[190:193], v[238:241], v[166:169], 0
    ds_read_b32 v45, v5 offset:32
    ds_read_b64_tr_b16 v[170:171], v39 offset:32768
    ds_read_b64_tr_b16 v[172:173], v39 offset:33280
    ds_read_b64_tr_b16 v[174:175], v40 offset:32768
    ds_read_b64_tr_b16 v[176:177], v40 offset:33280
    ds_read_b64_tr_b16 v[202:203], v39 offset:36864
    ds_read_b64_tr_b16 v[204:205], v39 offset:37376
    ds_read_b64_tr_b16 v[206:207], v40 offset:36864
    ds_read_b64_tr_b16 v[208:209], v40 offset:37376
    v_cndmask_b32 v182, v182, v183, s[44:45]
    v_cndmask_b32 v184, v184, v185, s[44:45]
    v_cndmask_b32 v178, v178, v179, s[44:45]
    v_cndmask_b32 v180, v180, v181, s[44:45]
    v_cndmask_b32 v178, v178, v50, s[50:51]
    v_cndmask_b32 v180, v180, v50, s[50:51]
    v_cndmask_b32 v210, v178, v182, s[46:47]
    v_cndmask_b32 v211, v180, v184, s[48:49]
    v_cndmask_b32 v190, v190, v191, s[44:45]
    v_cndmask_b32 v192, v192, v193, s[44:45]
    v_cndmask_b32 v186, v186, v187, s[44:45]
    v_cndmask_b32 v188, v188, v189, s[44:45]
    v_cndmask_b32 v212, v186, v190, s[46:47]
    v_cndmask_b32 v213, v188, v192, s[48:49]
    ds_write_b128 v47, v[210:213]
    ds_write_b32 v52, v5 offset:16
    s_waitcnt lgkmcnt(10)
    v_cmp_gt_u32 vcc, 4, v45
    s_nop 0
    s_cbranch_vccnz C_vr0
C_vd0:
    s_waitcnt lgkmcnt(8)
    v_mfma_f32_16x16x32_bf16 v[106:109], v[130:133], v[170:173], v[106:109]
    ds_read_b128 v[154:157], v35 offset:10240
    ds_read_b64_tr_b16 v[186:187], v39 offset:24576
    s_waitcnt lgkmcnt(6)
    v_mfma_f32_16x16x32_bf16 v[106:109], v[142:145], v[202:205], v[106:109]
    ds_read_b64_tr_b16 v[188:189], v39 offset:25088
    ds_read_b128 v[166:169], v36 offset:10240
    v_mfma_f32_16x16x32_bf16 v[114:117], v[134:137], v[170:173], v[114:117]
    ds_read_b64_tr_b16 v[194:195], v39 offset:28672
    ds_read_b64_tr_b16 v[196:197], v39 offset:29184
    v_mfma_f32_16x16x32_bf16 v[114:117], v[146:149], v[202:205], v[114:117]
    ds_read_b64_tr_b16 v[190:191], v40 offset:24576
    ds_read_b64_tr_b16 v[192:193], v40 offset:25088
    v_mfma_f32_16x16x32_bf16 v[110:113], v[130:133], v[174:177], v[110:113]
    ds_read_b64_tr_b16 v[198:199], v40 offset:28672
    ds_read_b64_tr_b16 v[200:201], v40 offset:29184
    s_waitcnt lgkmcnt(12)
    v_mfma_f32_16x16x32_bf16 v[110:113], v[142:145], v[206:209], v[110:113]
    ds_read_b128 v[158:161], v35 offset:12288
    ds_read_b128 v[178:181], v36 offset:12288
    v_mfma_f32_16x16x32_bf16 v[118:121], v[134:137], v[174:177], v[118:121]
    v_mfma_f32_16x16x32_bf16 v[118:121], v[146:149], v[206:209], v[118:121]
    s_waitcnt lgkmcnt(9)
    v_mfma_f32_16x16x32_bf16 v[106:109], v[154:157], v[186:189], v[106:109]
    s_waitcnt lgkmcnt(6)
    v_mfma_f32_16x16x32_bf16 v[106:109], v[166:169], v[194:197], v[106:109]
    s_waitcnt lgkmcnt(4)
    v_mfma_f32_16x16x32_bf16 v[110:113], v[154:157], v[190:193], v[110:113]
    s_waitcnt lgkmcnt(2)
    v_mfma_f32_16x16x32_bf16 v[110:113], v[166:169], v[198:201], v[110:113]
    s_waitcnt lgkmcnt(1)
    v_mfma_f32_16x16x32_bf16 v[114:117], v[158:161], v[186:189], v[114:117]
    s_nop 1
    v_cvt_pk_bf16_f32 v230, v106, v107
    v_cvt_pk_bf16_f32 v231, v108, v109
    s_waitcnt lgkmcnt(0)
    v_mfma_f32_16x16x32_bf16 v[114:117], v[178:181], v[194:197], v[114:117]
    v_mfma_f32_16x16x32_bf16 v[118:121], v[158:161], v[190:193], v[118:121]
    v_cvt_pk_bf16_f32 v236, v110, v111
    v_cvt_pk_bf16_f32 v237, v112, v113
    v_mfma_f32_16x16x32_bf16 v[118:121], v[178:181], v[198:201], v[118:121]
    ds_read_b32 v53, v225 offset:68
    ds_read_b64 v[234:235], v223 offset:0
    ds_read_b64 v[240:241], v223 offset:8
    v_cndmask_b32 v130, 0, v230, s[58:59]
    v_cndmask_b32 v230, v230, 0, s[58:59]
    v_cndmask_b32 v131, 0, v231, s[58:59]
    v_cndmask_b32 v231, v231, 0, s[58:59]
    buffer_load_dwordx4 v[218:221], v4, s[36:39], s100 offen sc1
    v_cvt_pk_bf16_f32 v232, v114, v115
    v_cvt_pk_bf16_f32 v233, v116, v117
    v_cvt_pk_bf16_f32 v238, v118, v119
    v_cvt_pk_bf16_f32 v239, v120, v121
    v_cndmask_b32 v136, 0, v236, s[60:61]
    v_cndmask_b32 v236, v236, 0, s[60:61]
    v_cndmask_b32 v137, 0, v237, s[60:61]
    v_cndmask_b32 v237, v237, 0, s[60:61]
    v_cndmask_b32 v132, 0, v232, s[58:59]
    v_cndmask_b32 v232, v232, 0, s[58:59]
    v_cndmask_b32 v133, 0, v233, s[58:59]
    v_cndmask_b32 v233, v233, 0, s[58:59]
    v_cndmask_b32 v138, 0, v238, s[60:61]
    v_cndmask_b32 v238, v238, 0, s[60:61]
    v_cndmask_b32 v139, 0, v239, s[60:61]
    v_cndmask_b32 v239, v239, 0, s[60:61]
    s_waitcnt lgkmcnt(0)
    v_cmp_ne_u32 vcc, 0, v53
    s_nop 0
    s_cbranch_vccnz D_dV0
    s_mov_b32 s9, 0
D_lV0:
    ds_read_b32 v53, v225 offset:68
    ds_read_b64 v[234:235], v223 offset:0
    ds_read_b64 v[240:241], v223 offset:8
    s_add_u32 s9, s9, 1
    s_cmp_gt_u32 s9, 1600000
    s_waitcnt lgkmcnt(0)
    s_cbranch_scc1 D_dV0
    v_cmp_eq_u32 vcc, 0, v53
    s_nop 0
    s_cbranch_vccnz D_lV0
D_dV0:
    v_cndmask_b32 v134, 0, v234, s[58:59]
    v_cndmask_b32 v234, v234, 0, s[58:59]
    v_cndmask_b32 v135, 0, v235, s[58:59]
    v_cndmask_b32 v235, v235, 0, s[58:59]
    v_cndmask_b32 v140, 0, v240, s[60:61]
    v_cndmask_b32 v240, v240, 0, s[60:61]
    v_cndmask_b32 v141, 0, v241, s[60:61]
    v_cndmask_b32 v241, v241, 0, s[60:61]
    s_branch C_join
C_tp1:
    s_barrier
    ds_read_b128 v[134:137], v33 offset:2048
    ds_read_b64_tr_b16 v[178:179], v37 offset:8192
    ds_read_b64_tr_b16 v[180:181], v37 offset:8704
    ds_read_b128 v[146:149], v34 offset:2048
    ds_read_b64_tr_b16 v[182:183], v37 offset:12288
    ds_read_b64_tr_b16 v[184:185], v37 offset:12800
    ds_read_b128 v[138:141], v33 offset:4096
    ds_read_b128 v[150:153], v34 offset:4096
    ds_read_b64_tr_b16 v[186:187], v38 offset:8192
    ds_read_b64_tr_b16 v[188:189], v38 offset:8704
    ds_read_b64_tr_b16 v[190:191], v38 offset:12288
    ds_read_b64_tr_b16 v[192:193], v38 offset:12800
    s_waitcnt lgkmcnt(9)
    v_mfma_f32_16x16x32_bf16 v[66:69], v[178:181], v[134:137], 0
    ds_read_b64_tr_b16 v[194:195], v37 offset:16384
    s_waitcnt lgkmcnt(7)
    v_mfma_f32_16x16x32_bf16 v[66:69], v[182:185], v[146:149], v[66:69]
    ds_read_b64_tr_b16 v[196:197], v37 offset:16896
    s_waitcnt lgkmcnt(7)
    v_mfma_f32_16x16x32_bf16 v[74:77], v[178:181], v[138:141], 0
    ds_read_b64_tr_b16 v[198:199], v37 offset:20480
    ds_read_b64_tr_b16 v[200:201], v37 offset:20992
    s_waitcnt lgkmcnt(8)
    v_mfma_f32_16x16x32_bf16 v[74:77], v[182:185], v[150:153], v[74:77]
    ds_read_b64_tr_b16 v[178:179], v38 offset:16384
    s_waitcnt lgkmcnt(7)
    v_mfma_f32_16x16x32_bf16 v[70:73], v[186:189], v[134:137], 0
    ds_read_b64_tr_b16 v[180:181], v38 offset:16896
    s_waitcnt lgkmcnt(6)
    v_mfma_f32_16x16x32_bf16 v[70:73], v[190:193], v[146:149], v[70:73]
    ds_read_b64_tr_b16 v[182:183], v38 offset:20480
    v_mfma_f32_16x16x32_bf16 v[78:81], v[186:189], v[138:141], 0
    ds_read_b64_tr_b16 v[184:185], v38 offset:20992
    v_mfma_f32_16x16x32_bf16 v[78:81], v[190:193], v[150:153], v[78:81]
    ds_read_b128 v[130:133], v33 offset:0
    s_waitcnt lgkmcnt(7)
    v_mfma_f32_16x16x32_bf16 v[90:93], v[194:197], v[134:137], 0
    ds_read_b64_tr_b16 v[186:187], v37 offset:24576
    s_waitcnt lgkmcnt(6)
    v_mfma_f32_16x16x32_bf16 v[90:93], v[198:201], v[146:149], v[90:93]
    ds_read_b64_tr_b16 v[188:189], v37 offset:25088
    v_mfma_f32_16x16x32_bf16 v[98:101], v[194:197], v[138:141], 0
    ds_read_b128 v[142:145], v34 offset:0
    ds_read_b64_tr_b16 v[190:191], v37 offset:28672
    v_mfma_f32_16x16x32_bf16 v[98:101], v[198:201], v[150:153], v[98:101]
    ds_read_b64_tr_b16 v[192:193], v37 offset:29184
    s_waitcnt lgkmcnt(8)
    v_mfma_f32_16x16x32_bf16 v[94:97], v[178:181], v[134:137], 0
    ds_read_b64_tr_b16 v[194:195], v38 offset:24576
    s_waitcnt lgkmcnt(7)
    v_mfma_f32_16x16x32_bf16 v[94:97], v[182:185], v[146:149], v[94:97]
    ds_read_b64_tr_b16 v[196:197], v38 offset:25088
    v_mfma_f32_16x16x32_bf16 v[102:105], v[178:181], v[138:141], 0
    ds_read_b64_tr_b16 v[198:199], v38 offset:28672
    v_mfma_f32_16x16x32_bf16 v[102:105], v[182:185], v[150:153], v[102:105]
    ds_read_b64_tr_b16 v[200:201], v38 offset:29184
    s_waitcnt lgkmcnt(7)
    v_mfma_f32_16x16x32_bf16 v[106:109], v[130:133], v[186:189], 0
    s_waitcnt lgkmcnt(4)
    v_mfma_f32_16x16x32_bf16 v[106:109], v[142:145], v[190:193], v[106:109]
    v_mfma_f32_16x16x32_bf16 v[114:117], v[134:137], v[186:189], 0
    v_mfma_f32_16x16x32_bf16 v[114:117], v[146:149], v[190:193], v[114:117]
    v_mfma_f32_16x16x32_bf16 v[122:125], v[138:141], v[186:189], 0
    v_mfma_f32_16x16x32_bf16 v[122:125], v[150:153], v[190:193], v[122:125]
    s_waitcnt lgkmcnt(2)
    v_mfma_f32_16x16x32_bf16 v[110:113], v[130:133], v[194:197], 0
    s_waitcnt lgkmcnt(0)
    v_mfma_f32_16x16x32_bf16 v[110:113], v[142:145], v[198:201], v[110:113]
    v_mfma_f32_16x16x32_bf16 v[118:121], v[134:137], v[194:197], 0
    s_barrier
    ds_read_b128 v[158:161], v33 offset:12288
    ds_read_b64_tr_b16 v[178:179], v37 offset:32768
    ds_read_b64_tr_b16 v[180:181], v37 offset:33280
    ds_read_b128 v[170:173], v34 offset:12288
    ds_read_b64_tr_b16 v[182:183], v37 offset:36864
    ds_read_b64_tr_b16 v[184:185], v37 offset:37376
    ds_read_b128 v[162:165], v33 offset:14336
    ds_read_b128 v[174:177], v34 offset:14336
    ds_read_b64_tr_b16 v[186:187], v38 offset:32768
    ds_read_b64_tr_b16 v[188:189], v38 offset:33280
    ds_read_b64_tr_b16 v[190:191], v38 offset:36864
    ds_read_b64_tr_b16 v[192:193], v38 offset:37376
    v_mfma_f32_16x16x32_bf16 v[118:121], v[146:149], v[198:201], v[118:121]
    v_mfma_f32_16x16x32_bf16 v[126:129], v[138:141], v[194:197], 0
    ds_read_b64_tr_b16 v[194:195], v37 offset:40960
    v_mfma_f32_16x16x32_bf16 v[126:129], v[150:153], v[198:201], v[126:129]
    ds_read_b64_tr_b16 v[196:197], v37 offset:41472
    s_waitcnt lgkmcnt(11)
    v_mfma_f32_16x16x32_bf16 v[66:69], v[178:181], v[158:161], v[66:69]
    ds_read_b64_tr_b16 v[198:199], v37 offset:45056
    s_waitcnt lgkmcnt(9)
    v_mfma_f32_16x16x32_bf16 v[66:69], v[182:185], v[170:173], v[66:69]
    ds_read_b64_tr_b16 v[200:201], v37 offset:45568
    s_waitcnt lgkmcnt(9)
    v_mfma_f32_16x16x32_bf16 v[74:77], v[178:181], v[162:165], v[74:77]
    ds_read_b64_tr_b16 v[178:179], v38 offset:40960
    s_waitcnt lgkmcnt(9)
    v_mfma_f32_16x16x32_bf16 v[74:77], v[182:185], v[174:177], v[74:77]
    ds_read_b64_tr_b16 v[180:181], v38 offset:41472
    s_waitcnt lgkmcnt(8)
    v_mfma_f32_16x16x32_bf16 v[70:73], v[186:189], v[158:161], v[70:73]
    ds_read_b64_tr_b16 v[182:183], v38 offset:45056
    s_waitcnt lgkmcnt(7)
    v_mfma_f32_16x16x32_bf16 v[70:73], v[190:193], v[170:173], v[70:73]
    ds_read_b64_tr_b16 v[184:185], v38 offset:45568
    v_mfma_f32_16x16x32_bf16 v[78:81], v[186:189], v[162:165], v[78:81]
    ds_read_b128 v[154:157], v33 offset:10240
    v_mfma_f32_16x16x32_bf16 v[78:81], v[190:193], v[174:177], v[78:81]
    ds_read_b64_tr_b16 v[186:187], v39 offset:0
    s_waitcnt lgkmcnt(8)
    v_mfma_f32_16x16x32_bf16 v[90:93], v[194:197], v[158:161], v[90:93]
    ds_read_b64_tr_b16 v[188:189], v39 offset:512
    s_waitcnt lgkmcnt(7)
    v_mfma_f32_16x16x32_bf16 v[90:93], v[198:201], v[170:173], v[90:93]
    ds_read_b128 v[166:169], v34 offset:10240
    v_mfma_f32_16x16x32_bf16 v[98:101], v[194:197], v[162:165], v[98:101]
    ds_read_b64_tr_b16 v[190:191], v39 offset:4096
    ds_read_b64_tr_b16 v[192:193], v39 offset:4608
    v_mfma_f32_16x16x32_bf16 v[98:101], v[198:201], v[174:177], v[98:101]
    ds_read_b64_tr_b16 v[194:195], v40 offset:0
    s_waitcnt lgkmcnt(9)
    v_mfma_f32_16x16x32_bf16 v[94:97], v[178:181], v[158:161], v[94:97]
    ds_read_b64_tr_b16 v[196:197], v40 offset:512
    s_waitcnt lgkmcnt(8)
    v_mfma_f32_16x16x32_bf16 v[94:97], v[182:185], v[170:173], v[94:97]
    ds_read_b64_tr_b16 v[198:199], v40 offset:4096
    v_mfma_f32_16x16x32_bf16 v[102:105], v[178:181], v[162:165], v[102:105]
    ds_read_b64_tr_b16 v[200:201], v40 offset:4608
    v_mfma_f32_16x16x32_bf16 v[102:105], v[182:185], v[174:177], v[102:105]
    s_waitcnt lgkmcnt(7)
    v_mfma_f32_16x16x32_bf16 v[106:109], v[154:157], v[186:189], v[106:109]
    s_waitcnt lgkmcnt(4)
    v_mfma_f32_16x16x32_bf16 v[106:109], v[166:169], v[190:193], v[106:109]
    v_mfma_f32_16x16x32_bf16 v[114:117], v[158:161], v[186:189], v[114:117]
    v_mfma_f32_16x16x32_bf16 v[114:117], v[170:173], v[190:193], v[114:117]
    v_mfma_f32_16x16x32_bf16 v[122:125], v[162:165], v[186:189], v[122:125]
    v_mfma_f32_16x16x32_bf16 v[122:125], v[174:177], v[190:193], v[122:125]
    s_waitcnt lgkmcnt(2)
    v_mfma_f32_16x16x32_bf16 v[110:113], v[154:157], v[194:197], v[110:113]
    s_waitcnt lgkmcnt(0)
    v_mfma_f32_16x16x32_bf16 v[110:113], v[166:169], v[198:201], v[110:113]
    v_mfma_f32_16x16x32_bf16 v[118:121], v[158:161], v[194:197], v[118:121]
    s_barrier
    ds_read_b128 v[134:137], v33 offset:22528
    ds_read_b64_tr_b16 v[178:179], v39 offset:8192
    ds_read_b64_tr_b16 v[180:181], v39 offset:8704
    ds_read_b128 v[146:149], v34 offset:22528
    ds_read_b64_tr_b16 v[182:183], v39 offset:12288
    ds_read_b64_tr_b16 v[184:185], v39 offset:12800
    ds_read_b128 v[138:141], v33 offset:24576
    ds_read_b128 v[150:153], v34 offset:24576
    ds_read_b64_tr_b16 v[186:187], v40 offset:8192
    ds_read_b64_tr_b16 v[188:189], v40 offset:8704
    ds_read_b64_tr_b16 v[190:191], v40 offset:12288
    ds_read_b64_tr_b16 v[192:193], v40 offset:12800
    v_mfma_f32_16x16x32_bf16 v[118:121], v[170:173], v[198:201], v[118:121]
    v_mfma_f32_16x16x32_bf16 v[126:129], v[162:165], v[194:197], v[126:129]
    ds_read_b64_tr_b16 v[194:195], v39 offset:16384
    v_mfma_f32_16x16x32_bf16 v[126:129], v[174:177], v[198:201], v[126:129]
    ds_read_b64_tr_b16 v[196:197], v39 offset:16896
    s_waitcnt lgkmcnt(11)
    v_mfma_f32_16x16x32_bf16 v[66:69], v[178:181], v[134:137], v[66:69]
    ds_read_b64_tr_b16 v[198:199], v39 offset:20480
    s_waitcnt lgkmcnt(9)
    v_mfma_f32_16x16x32_bf16 v[66:69], v[182:185], v[146:149], v[66:69]
    ds_read_b64_tr_b16 v[200:201], v39 offset:20992
    s_waitcnt lgkmcnt(9)
    v_mfma_f32_16x16x32_bf16 v[74:77], v[178:181], v[138:141], v[74:77]
    ds_read_b64_tr_b16 v[178:179], v40 offset:16384
    s_waitcnt lgkmcnt(9)
    v_mfma_f32_16x16x32_bf16 v[74:77], v[182:185], v[150:153], v[74:77]
    ds_read_b64_tr_b16 v[180:181], v40 offset:16896
    s_waitcnt lgkmcnt(8)
    v_mfma_f32_16x16x32_bf16 v[70:73], v[186:189], v[134:137], v[70:73]
    ds_read_b64_tr_b16 v[182:183], v40 offset:20480
    s_waitcnt lgkmcnt(7)
    v_mfma_f32_16x16x32_bf16 v[70:73], v[190:193], v[146:149], v[70:73]
    ds_read_b64_tr_b16 v[184:185], v40 offset:20992
    v_mfma_f32_16x16x32_bf16 v[78:81], v[186:189], v[138:141], v[78:81]
    ds_read_b128 v[130:133], v33 offset:20480
    v_mfma_f32_16x16x32_bf16 v[78:81], v[190:193], v[150:153], v[78:81]
    ds_read_b64_tr_b16 v[186:187], v39 offset:24576
    s_waitcnt lgkmcnt(8)
    v_mfma_f32_16x16x32_bf16 v[90:93], v[194:197], v[134:137], v[90:93]
    ds_read_b64_tr_b16 v[188:189], v39 offset:25088
    s_waitcnt lgkmcnt(7)
    v_mfma_f32_16x16x32_bf16 v[90:93], v[198:201], v[146:149], v[90:93]
    ds_read_b128 v[142:145], v34 offset:20480
    v_mfma_f32_16x16x32_bf16 v[98:101], v[194:197], v[138:141], v[98:101]
    ds_read_b64_tr_b16 v[190:191], v39 offset:28672
    ds_read_b64_tr_b16 v[192:193], v39 offset:29184
    v_mfma_f32_16x16x32_bf16 v[98:101], v[198:201], v[150:153], v[98:101]
    ds_read_b64_tr_b16 v[194:195], v40 offset:24576
    s_waitcnt lgkmcnt(9)
    v_mfma_f32_16x16x32_bf16 v[94:97], v[178:181], v[134:137], v[94:97]
    ds_read_b64_tr_b16 v[196:197], v40 offset:25088
    s_waitcnt lgkmcnt(8)
    v_mfma_f32_16x16x32_bf16 v[94:97], v[182:185], v[146:149], v[94:97]
    ds_read_b64_tr_b16 v[198:199], v40 offset:28672
    v_mfma_f32_16x16x32_bf16 v[102:105], v[178:181], v[138:141], v[102:105]
    ds_read_b64_tr_b16 v[200:201], v40 offset:29184
    v_mfma_f32_16x16x32_bf16 v[102:105], v[182:185], v[150:153], v[102:105]
    s_waitcnt lgkmcnt(7)
    v_mfma_f32_16x16x32_bf16 v[106:109], v[130:133], v[186:189], v[106:109]
    s_waitcnt lgkmcnt(4)
    v_mfma_f32_16x16x32_bf16 v[106:109], v[142:145], v[190:193], v[106:109]
    v_mfma_f32_16x16x32_bf16 v[114:117], v[134:137], v[186:189], v[114:117]
    v_mfma_f32_16x16x32_bf16 v[114:117], v[146:149], v[190:193], v[114:117]
    v_mfma_f32_16x16x32_bf16 v[122:125], v[138:141], v[186:189], v[122:125]
    v_mfma_f32_16x16x32_bf16 v[122:125], v[150:153], v[190:193], v[122:125]
    s_waitcnt lgkmcnt(2)
    v_mfma_f32_16x16x32_bf16 v[110:113], v[130:133], v[194:197], v[110:113]
    s_waitcnt lgkmcnt(0)
    v_mfma_f32_16x16x32_bf16 v[110:113], v[142:145], v[198:201], v[110:113]
    v_mfma_f32_16x16x32_bf16 v[118:121], v[134:137], v[194:197], v[118:121]
    s_barrier
    ds_read_b128 v[158:161], v33 offset:32768
    ds_read_b64_tr_b16 v[178:179], v39 offset:32768
    ds_read_b64_tr_b16 v[180:181], v39 offset:33280
    ds_read_b128 v[170:173], v34 offset:32768
    ds_read_b64_tr_b16 v[182:183], v39 offset:36864
    ds_read_b64_tr_b16 v[184:185], v39 offset:37376
    ds_read_b128 v[162:165], v33 offset:34816
    ds_read_b128 v[174:177], v34 offset:34816
    ds_read_b64_tr_b16 v[186:187], v40 offset:32768
    ds_read_b64_tr_b16 v[188:189], v40 offset:33280
    ds_read_b64_tr_b16 v[190:191], v40 offset:36864
    ds_read_b64_tr_b16 v[192:193], v40 offset:37376
    v_mfma_f32_16x16x32_bf16 v[118:121], v[146:149], v[198:201], v[118:121]
    v_mfma_f32_16x16x32_bf16 v[126:129], v[138:141], v[194:197], v[126:129]
    ds_read_b64_tr_b16 v[194:195], v37 offset:0
    v_mfma_f32_16x16x32_bf16 v[126:129], v[150:153], v[198:201], v[126:129]
    ds_read_b64_tr_b16 v[196:197], v37 offset:512
    s_waitcnt lgkmcnt(11)
    v_mfma_f32_16x16x32_bf16 v[66:69], v[178:181], v[158:161], v[66:69]
    ds_read_b64_tr_b16 v[198:199], v37 offset:4096
    s_waitcnt lgkmcnt(9)
    v_mfma_f32_16x16x32_bf16 v[66:69], v[182:185], v[170:173], v[66:69]
    ds_read_b64_tr_b16 v[200:201], v37 offset:4608
    s_waitcnt lgkmcnt(9)
    v_mfma_f32_16x16x32_bf16 v[74:77], v[178:181], v[162:165], v[74:77]
    ds_read_b64_tr_b16 v[178:179], v38 offset:0
    s_waitcnt lgkmcnt(9)
    v_mfma_f32_16x16x32_bf16 v[74:77], v[182:185], v[174:177], v[74:77]
    ds_read_b64_tr_b16 v[180:181], v38 offset:512
    s_waitcnt lgkmcnt(8)
    v_mfma_f32_16x16x32_bf16 v[70:73], v[186:189], v[158:161], v[70:73]
    ds_read_b64_tr_b16 v[182:183], v38 offset:4096
    s_waitcnt lgkmcnt(7)
    v_mfma_f32_16x16x32_bf16 v[70:73], v[190:193], v[170:173], v[70:73]
    ds_read_b64_tr_b16 v[184:185], v38 offset:4608
    v_mfma_f32_16x16x32_bf16 v[78:81], v[186:189], v[162:165], v[78:81]
    ds_read_b128 v[154:157], v33 offset:30720
    v_mfma_f32_16x16x32_bf16 v[78:81], v[190:193], v[174:177], v[78:81]
    ds_read_b64_tr_b16 v[186:187], v37 offset:8192
    s_waitcnt lgkmcnt(8)
    v_mfma_f32_16x16x32_bf16 v[90:93], v[194:197], v[158:161], v[90:93]
    ds_read_b64_tr_b16 v[188:189], v37 offset:8704
    s_waitcnt lgkmcnt(7)
    v_mfma_f32_16x16x32_bf16 v[90:93], v[198:201], v[170:173], v[90:93]
    ds_read_b128 v[166:169], v34 offset:30720
    v_mfma_f32_16x16x32_bf16 v[98:101], v[194:197], v[162:165], v[98:101]
    ds_read_b64_tr_b16 v[190:191], v37 offset:12288
    ds_read_b64_tr_b16 v[192:193], v37 offset:12800
    v_mfma_f32_16x16x32_bf16 v[98:101], v[198:201], v[174:177], v[98:101]
    ds_read_b64_tr_b16 v[194:195], v38 offset:8192
    s_waitcnt lgkmcnt(9)
    v_mfma_f32_16x16x32_bf16 v[94:97], v[178:181], v[158:161], v[94:97]
    ds_read_b64_tr_b16 v[196:197], v38 offset:8704
    s_waitcnt lgkmcnt(8)
    v_mfma_f32_16x16x32_bf16 v[94:97], v[182:185], v[170:173], v[94:97]
    ds_read_b64_tr_b16 v[198:199], v38 offset:12288
    v_mfma_f32_16x16x32_bf16 v[102:105], v[178:181], v[162:165], v[102:105]
    ds_read_b64_tr_b16 v[200:201], v38 offset:12800
    v_mfma_f32_16x16x32_bf16 v[102:105], v[182:185], v[174:177], v[102:105]
    s_waitcnt lgkmcnt(7)
    v_mfma_f32_16x16x32_bf16 v[106:109], v[154:157], v[186:189], v[106:109]
    s_waitcnt lgkmcnt(4)
    v_mfma_f32_16x16x32_bf16 v[106:109], v[166:169], v[190:193], v[106:109]
    v_mfma_f32_16x16x32_bf16 v[114:117], v[158:161], v[186:189], v[114:117]
    v_mfma_f32_16x16x32_bf16 v[114:117], v[170:173], v[190:193], v[114:117]
    v_mfma_f32_16x16x32_bf16 v[122:125], v[162:165], v[186:189], v[122:125]
    v_mfma_f32_16x16x32_bf16 v[122:125], v[174:177], v[190:193], v[122:125]
    s_waitcnt lgkmcnt(2)
    v_mfma_f32_16x16x32_bf16 v[110:113], v[154:157], v[194:197], v[110:113]
    s_waitcnt lgkmcnt(0)
    v_mfma_f32_16x16x32_bf16 v[110:113], v[166:169], v[198:201], v[110:113]
    v_mfma_f32_16x16x32_bf16 v[118:121], v[158:161], v[194:197], v[118:121]
    s_barrier
    ds_read_b128 v[134:137], v35 offset:2048
    ds_read_b64_tr_b16 v[178:179], v37 offset:16384
    ds_read_b64_tr_b16 v[180:181], v37 offset:16896
    ds_read_b128 v[146:149], v36 offset:2048
    ds_read_b64_tr_b16 v[182:183], v37 offset:20480
    ds_read_b64_tr_b16 v[184:185], v37 offset:20992
    ds_read_b128 v[138:141], v35 offset:4096
    ds_read_b128 v[150:153], v36 offset:4096
    ds_read_b64_tr_b16 v[186:187], v38 offset:16384
    ds_read_b64_tr_b16 v[188:189], v38 offset:16896
    ds_read_b64_tr_b16 v[190:191], v38 offset:20480
    ds_read_b64_tr_b16 v[192:193], v38 offset:20992
    v_mfma_f32_16x16x32_bf16 v[118:121], v[170:173], v[198:201], v[118:121]
    v_mfma_f32_16x16x32_bf16 v[126:129], v[162:165], v[194:197], v[126:129]
    ds_read_b64_tr_b16 v[194:195], v37 offset:24576
    v_mfma_f32_16x16x32_bf16 v[126:129], v[174:177], v[198:201], v[126:129]
    ds_read_b64_tr_b16 v[196:197], v37 offset:25088
    s_waitcnt lgkmcnt(11)
    v_mfma_f32_16x16x32_bf16 v[66:69], v[178:181], v[134:137], v[66:69]
    ds_read_b64_tr_b16 v[198:199], v37 offset:28672
    s_waitcnt lgkmcnt(9)
    v_mfma_f32_16x16x32_bf16 v[66:69], v[182:185], v[146:149], v[66:69]
    ds_read_b64_tr_b16 v[200:201], v37 offset:29184
    s_waitcnt lgkmcnt(9)
    v_mfma_f32_16x16x32_bf16 v[74:77], v[178:181], v[138:141], v[74:77]
    ds_read_b64_tr_b16 v[178:179], v38 offset:24576
    s_waitcnt lgkmcnt(9)
    v_mfma_f32_16x16x32_bf16 v[74:77], v[182:185], v[150:153], v[74:77]
    ds_read_b64_tr_b16 v[180:181], v38 offset:25088
    s_waitcnt lgkmcnt(8)
    v_mfma_f32_16x16x32_bf16 v[70:73], v[186:189], v[134:137], v[70:73]
    ds_read_b64_tr_b16 v[182:183], v38 offset:28672
    s_waitcnt lgkmcnt(7)
    v_mfma_f32_16x16x32_bf16 v[70:73], v[190:193], v[146:149], v[70:73]
    ds_read_b64_tr_b16 v[184:185], v38 offset:29184
    v_mfma_f32_16x16x32_bf16 v[78:81], v[186:189], v[138:141], v[78:81]
    ds_read_b128 v[130:133], v35 offset:0
    v_mfma_f32_16x16x32_bf16 v[78:81], v[190:193], v[150:153], v[78:81]
    ds_read_b64_tr_b16 v[186:187], v37 offset:32768
    s_waitcnt lgkmcnt(8)
    v_mfma_f32_16x16x32_bf16 v[90:93], v[194:197], v[134:137], v[90:93]
    ds_read_b64_tr_b16 v[188:189], v37 offset:33280
    s_waitcnt lgkmcnt(7)
    v_mfma_f32_16x16x32_bf16 v[90:93], v[198:201], v[146:149], v[90:93]
    ds_read_b128 v[142:145], v36 offset:0
    v_mfma_f32_16x16x32_bf16 v[98:101], v[194:197], v[138:141], v[98:101]
    ds_read_b64_tr_b16 v[190:191], v37 offset:36864
    ds_read_b64_tr_b16 v[192:193], v37 offset:37376
    v_mfma_f32_16x16x32_bf16 v[98:101], v[198:201], v[150:153], v[98:101]
    ds_read_b64_tr_b16 v[194:195], v38 offset:32768
    s_waitcnt lgkmcnt(9)
    v_mfma_f32_16x16x32_bf16 v[94:97], v[178:181], v[134:137], v[94:97]
    ds_read_b64_tr_b16 v[196:197], v38 offset:33280
    s_waitcnt lgkmcnt(8)
    v_mfma_f32_16x16x32_bf16 v[94:97], v[182:185], v[146:149], v[94:97]
    ds_read_b64_tr_b16 v[198:199], v38 offset:36864
    v_mfma_f32_16x16x32_bf16 v[102:105], v[178:181], v[138:141], v[102:105]
    ds_read_b64_tr_b16 v[200:201], v38 offset:37376
    v_mfma_f32_16x16x32_bf16 v[102:105], v[182:185], v[150:153], v[102:105]
    s_waitcnt lgkmcnt(7)
    v_mfma_f32_16x16x32_bf16 v[106:109], v[130:133], v[186:189], v[106:109]
    s_waitcnt lgkmcnt(4)
    v_mfma_f32_16x16x32_bf16 v[106:109], v[142:145], v[190:193], v[106:109]
    v_mfma_f32_16x16x32_bf16 v[114:117], v[134:137], v[186:189], v[114:117]
    v_mfma_f32_16x16x32_bf16 v[114:117], v[146:149], v[190:193], v[114:117]
    v_mfma_f32_16x16x32_bf16 v[122:125], v[138:141], v[186:189], v[122:125]
    v_mfma_f32_16x16x32_bf16 v[122:125], v[150:153], v[190:193], v[122:125]
    s_waitcnt lgkmcnt(2)
    v_mfma_f32_16x16x32_bf16 v[110:113], v[130:133], v[194:197], v[110:113]
    s_waitcnt lgkmcnt(0)
    v_mfma_f32_16x16x32_bf16 v[110:113], v[142:145], v[198:201], v[110:113]
    v_mfma_f32_16x16x32_bf16 v[118:121], v[134:137], v[194:197], v[118:121]
    s_barrier
    ds_read_b128 v[158:161], v35 offset:12288
    ds_read_b64_tr_b16 v[178:179], v37 offset:40960
    ds_read_b64_tr_b16 v[180:181], v37 offset:41472
    ds_read_b128 v[170:173], v36 offset:12288
    ds_read_b64_tr_b16 v[182:183], v37 offset:45056
    ds_read_b64_tr_b16 v[184:185], v37 offset:45568
    ds_read_b128 v[162:165], v35 offset:14336
    ds_read_b128 v[174:177], v36 offset:14336
    ds_read_b64_tr_b16 v[186:187], v38 offset:40960
    ds_read_b64_tr_b16 v[188:189], v38 offset:41472
    ds_read_b64_tr_b16 v[190:191], v38 offset:45056
    ds_read_b64_tr_b16 v[192:193], v38 offset:45568
    ds_read_b64_tr_b16 v[202:203], v39 offset:0
    v_mfma_f32_16x16x32_bf16 v[118:121], v[146:149], v[198:201], v[118:121]
    ds_read_b64_tr_b16 v[204:205], v39 offset:512
    v_mfma_f32_16x16x32_bf16 v[126:129], v[138:141], v[194:197], v[126:129]
    ds_read_b64_tr_b16 v[206:207], v39 offset:4096
    v_mfma_f32_16x16x32_bf16 v[126:129], v[150:153], v[198:201], v[126:129]
    ds_read_b64_tr_b16 v[208:209], v39 offset:4608
    s_waitcnt lgkmcnt(13)
    v_mfma_f32_16x16x32_bf16 v[66:69], v[178:181], v[158:161], v[66:69]
    ds_read_b64_tr_b16 v[194:195], v40 offset:0
    s_waitcnt lgkmcnt(11)
    v_mfma_f32_16x16x32_bf16 v[66:69], v[182:185], v[170:173], v[66:69]
    ds_read_b64_tr_b16 v[196:197], v40 offset:512
    s_waitcnt lgkmcnt(11)
    v_mfma_f32_16x16x32_bf16 v[74:77], v[178:181], v[162:165], v[74:77]
    ds_read_b64_tr_b16 v[198:199], v40 offset:4096
    s_waitcnt lgkmcnt(11)
    v_mfma_f32_16x16x32_bf16 v[74:77], v[182:185], v[174:177], v[74:77]
    ds_read_b64_tr_b16 v[200:201], v40 offset:4608
    s_waitcnt lgkmcnt(10)
    v_mfma_f32_16x16x32_bf16 v[70:73], v[186:189], v[158:161], v[70:73]
    s_waitcnt lgkmcnt(8)
    v_mfma_f32_16x16x32_bf16 v[70:73], v[190:193], v[170:173], v[70:73]
    v_mfma_f32_16x16x32_bf16 v[78:81], v[186:189], v[162:165], v[78:81]
    v_mfma_f32_16x16x32_bf16 v[78:81], v[190:193], v[174:177], v[78:81]
    s_waitcnt lgkmcnt(6)
    v_mfma_f32_16x16x32_bf16 v[90:93], v[202:205], v[158:161], v[90:93]
    s_waitcnt lgkmcnt(4)
    v_mfma_f32_16x16x32_bf16 v[90:93], v[206:209], v[170:173], v[90:93]
    v_mfma_f32_16x16x32_bf16 v[98:101], v[202:205], v[162:165], v[98:101]
    v_mfma_f32_16x16x32_bf16 v[98:101], v[206:209], v[174:177], v[98:101]
    s_waitcnt lgkmcnt(2)
    v_mfma_f32_16x16x32_bf16 v[94:97], v[194:197], v[158:161], v[94:97]
    s_waitcnt lgkmcnt(0)
    v_mfma_f32_16x16x32_bf16 v[94:97], v[198:201], v[170:173], v[94:97]
    v_mfma_f32_16x16x32_bf16 v[102:105], v[194:197], v[162:165], v[102:105]
    s_barrier
    ds_read_b128 v[134:137], v35 offset:22528
    ds_read_b64_tr_b16 v[178:179], v39 offset:8192
    ds_read_b64_tr_b16 v[180:181], v39 offset:8704
    ds_read_b128 v[146:149], v36 offset:22528
    ds_read_b64_tr_b16 v[182:183], v39 offset:12288
    ds_read_b64_tr_b16 v[184:185], v39 offset:12800
    ds_read_b128 v[138:141], v35 offset:24576
    ds_read_b128 v[150:153], v36 offset:24576
    ds_read_b64_tr_b16 v[186:187], v40 offset:8192
    ds_read_b64_tr_b16 v[188:189], v40 offset:8704
    ds_read_b64_tr_b16 v[190:191], v40 offset:12288
    ds_read_b64_tr_b16 v[192:193], v40 offset:12800
    ds_read_b128 v[130:133], v35 offset:20480
    v_mfma_f32_16x16x32_bf16 v[102:105], v[198:201], v[174:177], v[102:105]
    ds_read_b128 v[142:145], v36 offset:20480
    s_waitcnt lgkmcnt(11)
    v_mfma_f32_16x16x32_bf16 v[66:69], v[178:181], v[134:137], v[66:69]
    s_barrier
    ds_read_b64_tr_b16 v[202:203], v39 offset:16384
    ds_read_b64_tr_b16 v[204:205], v39 offset:16896
    ds_read_b64_tr_b16 v[206:207], v39 offset:20480
    ds_read_b64_tr_b16 v[208:209], v39 offset:20992
    ds_read_b64_tr_b16 v[194:195], v40 offset:16384
    s_waitcnt lgkmcnt(13)
    v_mfma_f32_16x16x32_bf16 v[66:69], v[182:185], v[146:149], v[66:69]
    ds_read_b64_tr_b16 v[196:197], v40 offset:16896
    s_waitcnt lgkmcnt(13)
    v_mfma_f32_16x16x32_bf16 v[74:77], v[178:181], v[138:141], v[74:77]
    ds_read_b64_tr_b16 v[198:199], v40 offset:20480
    s_waitcnt lgkmcnt(13)
    v_mfma_f32_16x16x32_bf16 v[74:77], v[182:185], v[150:153], v[74:77]
    ds_read_b64_tr_b16 v[200:201], v40 offset:20992
    s_waitcnt lgkmcnt(12)
    v_mfma_f32_16x16x32_bf16 v[70:73], v[186:189], v[134:137], v[70:73]
    v_cvt_pk_bf16_f32 v154, v66, v67
    v_cvt_pk_bf16_f32 v155, v68, v69
    s_waitcnt lgkmcnt(10)
    v_mfma_f32_16x16x32_bf16 v[70:73], v[190:193], v[146:149], v[70:73]
    v_cndmask_b32 v162, 0, v154, s[54:55]
    v_cndmask_b32 v154, v154, 0, s[54:55]
    v_mfma_f32_16x16x32_bf16 v[78:81], v[186:189], v[138:141], v[78:81]
    v_cndmask_b32 v163, 0, v155, s[54:55]
    v_cndmask_b32 v155, v155, 0, s[54:55]
    v_mfma_f32_16x16x32_bf16 v[78:81], v[190:193], v[150:153], v[78:81]
    v_cvt_pk_bf16_f32 v158, v74, v75
    v_cvt_pk_bf16_f32 v159, v76, v77
    s_waitcnt lgkmcnt(6)
    v_mfma_f32_16x16x32_bf16 v[90:93], v[202:205], v[134:137], v[90:93]
    v_cndmask_b32 v166, 0, v158, s[54:55]
    v_cndmask_b32 v158, v158, 0, s[54:55]
    s_waitcnt lgkmcnt(4)
    v_mfma_f32_16x16x32_bf16 v[90:93], v[206:209], v[146:149], v[90:93]
    v_cndmask_b32 v167, 0, v159, s[54:55]
    v_cndmask_b32 v159, v159, 0, s[54:55]
    s_waitcnt lgkmcnt(2)
    v_mfma_f32_16x16x32_bf16 v[94:97], v[194:197], v[134:137], v[94:97]
    v_cvt_pk_bf16_f32 v156, v70, v71
    v_cvt_pk_bf16_f32 v157, v72, v73
    s_waitcnt lgkmcnt(0)
    v_mfma_f32_16x16x32_bf16 v[94:97], v[198:201], v[146:149], v[94:97]
    v_cndmask_b32 v164, 0, v156, s[56:57]
    v_cndmask_b32 v156, v156, 0, s[56:57]
    v_mfma_f32_16x16x32_bf16 v[98:101], v[202:205], v[138:141], v[98:101]
    v_cndmask_b32 v165, 0, v157, s[56:57]
    v_cndmask_b32 v157, v157, 0, s[56:57]
    v_mfma_f32_16x16x32_bf16 v[98:101], v[206:209], v[150:153], v[98:101]
    v_cvt_pk_bf16_f32 v160, v78, v79
    v_cvt_pk_bf16_f32 v161, v80, v81
    v_mfma_f32_16x16x32_bf16 v[102:105], v[194:197], v[138:141], v[102:105]
    v_cndmask_b32 v168, 0, v160, s[56:57]
    v_cndmask_b32 v160, v160, 0, s[56:57]
    v_mfma_f32_16x16x32_bf16 v[102:105], v[198:201], v[150:153], v[102:105]
    ds_read_b32 v45, v5 offset:4
    v_cndmask_b32 v169, 0, v161, s[56:57]
    v_cndmask_b32 v161, v161, 0, s[56:57]
    ds_read_b32 v53, v224 offset:56
    ds_read_b128 v[230:233], v222
    v_cvt_pk_bf16_f32 v234, v90, v91
    v_cvt_pk_bf16_f32 v235, v92, v93
    v_cvt_pk_bf16_f32 v236, v94, v95
    v_cvt_pk_bf16_f32 v237, v96, v97
    s_nop 1
    v_mfma_f32_16x16x32_bf16 v[70:73], v[234:237], v[154:157], 0
    v_mfma_f32_16x16x32_bf16 v[74:77], v[234:237], v[158:161], 0
    v_cvt_pk_bf16_f32 v238, v98, v99
    v_cvt_pk_bf16_f32 v239, v100, v101
    v_cvt_pk_bf16_f32 v240, v102, v103
    v_cvt_pk_bf16_f32 v241, v104, v105
    s_nop 1
    v_mfma_f32_16x16x32_bf16 v[78:81], v[238:241], v[158:161], 0
    v_mfma_f32_16x16x32_bf16 v[182:185], v[234:237], v[162:165], 0
    v_mfma_f32_16x16x32_bf16 v[186:189], v[234:237], v[166:169], 0
    s_waitcnt lgkmcnt(0)
    v_cmp_ne_u32 vcc, 0, v53
    s_nop 0
    s_cbranch_vccnz D_dK
    s_mov_b32 s9, 0
D_lK:
    ds_read_b32 v53, v224 offset:56
    ds_read_b128 v[230:233], v222
    s_add_u32 s9, s9, 1
    s_cmp_gt_u32 s9, 1600000
    s_waitcnt lgkmcnt(0)
    s_cbranch_scc1 D_dK
    v_cmp_eq_u32 vcc, 0, v53
    s_nop 0
    s_cbranch_vccnz D_lK
D_dK:
    v_mfma_f32_16x16x32_bf16 v[66:69], v[230:233], v[154:157], 0
    v_readfirstlane_b32 s63, v45
    v_cndmask_b32 v78, v78, v79, s[44:45]
    v_cndmask_b32 v80, v80, v81, s[44:45]
    v_cndmask_b32 v74, v74, v75, s[44:45]
    v_cndmask_b32 v76, v76, v77, s[44:45]
    v_cndmask_b32 v216, v74, v78, s[46:47]
    v_cndmask_b32 v217, v76, v80, s[48:49]
    v_cndmask_b32 v70, v70, v71, s[44:45]
    v_cndmask_b32 v72, v72, v73, s[44:45]
    v_cndmask_b32 v66, v66, v67, s[44:45]
    v_cndmask_b32 v68, v68, v69, s[44:45]
    v_cndmask_b32 v214, v66, v70, s[46:47]
    v_cndmask_b32 v215, v68, v72, s[48:49]
    v_and_or_b32 v98, v214, v51, v54
    v_and_or_b32 v99, v215, v51, v55
    v_and_or_b32 v100, v216, v51, v56
    v_and_or_b32 v101, v217, v51, v57
    s_sub_u32 s63, s63, 1
    s_cbranch_scc1 C_mr1
C_md1:
    s_cmp_lg_u32 s101, 0
    s_cbranch_scc1 SM_jS1
    s_cmp_eq_u32 s63, 0
    s_cbranch_scc1 SM_sS1
    buffer_store_dwordx4 v[98:101], v4, s[36:39], s15 offen
SM_jS1:
    v_mfma_f32_16x16x32_bf16 v[178:181], v[230:233], v[162:165], 0
    v_mfma_f32_16x16x32_bf16 v[190:193], v[238:241], v[166:169], 0
    ds_read_b32 v45, v5 offset:32
    ds_read_b64_tr_b16 v[170:171], v39 offset:32768
    ds_read_b64_tr_b16 v[172:173], v39 offset:33280
    ds_read_b64_tr_b16 v[174:175], v40 offset:32768
    ds_read_b64_tr_b16 v[176:177], v40 offset:33280
    ds_read_b64_tr_b16 v[202:203], v39 offset:36864
    ds_read_b64_tr_b16 v[204:205], v39 offset:37376
    ds_read_b64_tr_b16 v[206:207], v40 offset:36864
    ds_read_b64_tr_b16 v[208:209], v40 offset:37376
    v_cndmask_b32 v190, v190, v191, s[44:45]
    v_cndmask_b32 v192, v192, v193, s[44:45]
    v_cndmask_b32 v186, v186, v187, s[44:45]
    v_cndmask_b32 v188, v188, v189, s[44:45]
    v_cndmask_b32 v212, v186, v190, s[46:47]
    v_cndmask_b32 v213, v188, v192, s[48:49]
    v_cndmask_b32 v182, v182, v183, s[44:45]
    v_cndmask_b32 v184, v184, v185, s[44:45]
    v_cndmask_b32 v178, v178, v179, s[44:45]
    v_cndmask_b32 v180, v180, v181, s[44:45]
    v_cndmask_b32 v210, v178, v182, s[46:47]
    v_cndmask_b32 v211, v180, v184, s[48:49]
    ds_write_b128 v47, v[210:213]
    ds_write_b32 v52, v5 offset:16
    s_waitcnt lgkmcnt(10)
    v_cmp_gt_u32 vcc, 4, v45
    s_nop 0
    s_cbranch_vccnz C_vr1
C_vd1:
    s_waitcnt lgkmcnt(8)
    v_mfma_f32_16x16x32_bf16 v[106:109], v[130:133], v[170:173], v[106:109]
    ds_read_b128 v[154:157], v35 offset:10240
    s_waitcnt lgkmcnt(5)
    v_mfma_f32_16x16x32_bf16 v[106:109], v[142:145], v[202:205], v[106:109]
    ds_read_b64_tr_b16 v[186:187], v39 offset:24576
    v_mfma_f32_16x16x32_bf16 v[114:117], v[134:137], v[170:173], v[114:117]
    ds_read_b64_tr_b16 v[188:189], v39 offset:25088
    v_mfma_f32_16x16x32_bf16 v[114:117], v[146:149], v[202:205], v[114:117]
    ds_read_b128 v[166:169], v36 offset:10240
    v_mfma_f32_16x16x32_bf16 v[122:125], v[138:141], v[170:173], v[122:125]
    ds_read_b64_tr_b16 v[194:195], v39 offset:28672
    v_mfma_f32_16x16x32_bf16 v[122:125], v[150:153], v[202:205], v[122:125]
    ds_read_b64_tr_b16 v[196:197], v39 offset:29184
    v_mfma_f32_16x16x32_bf16 v[110:113], v[130:133], v[174:177], v[110:113]
    ds_read_b64_tr_b16 v[190:191], v40 offset:24576
    ds_read_b64_tr_b16 v[192:193], v40 offset:25088
    s_waitcnt lgkmcnt(10)
    v_mfma_f32_16x16x32_bf16 v[110:113], v[142:145], v[206:209], v[110:113]
    ds_read_b64_tr_b16 v[198:199], v40 offset:28672
    ds_read_b64_tr_b16 v[200:201], v40 offset:29184
    v_mfma_f32_16x16x32_bf16 v[118:121], v[134:137], v[174:177], v[118:121]
    ds_read_b128 v[158:161], v35 offset:12288
    v_mfma_f32_16x16x32_bf16 v[118:121], v[146:149], v[206:209], v[118:121]
    ds_read_b128 v[178:181], v36 offset:12288
    v_mfma_f32_16x16x32_bf16 v[126:129], v[138:141], v[174:177], v[126:129]
    ds_read_b128 v[162:165], v35 offset:14336
    v_mfma_f32_16x16x32_bf16 v[126:129], v[150:153], v[206:209], v[126:129]
    ds_read_b128 v[182:185], v36 offset:14336
    s_waitcnt lgkmcnt(11)
    v_mfma_f32_16x16x32_bf16 v[106:109], v[154:157], v[186:189], v[106:109]
    s_waitcnt lgkmcnt(8)
    v_mfma_f32_16x16x32_bf16 v[106:109], v[166:169], v[194:197], v[106:109]
    s_waitcnt lgkmcnt(6)
    v_mfma_f32_16x16x32_bf16 v[110:113], v[154:157], v[190:193], v[110:113]
    s_waitcnt lgkmcnt(4)
    v_mfma_f32_16x16x32_bf16 v[110:113], v[166:169], v[198:201], v[110:113]
    s_waitcnt lgkmcnt(3)
    v_mfma_f32_16x16x32_bf16 v[114:117], v[158:161], v[186:189], v[114:117]
    s_nop 1
    v_cvt_pk_bf16_f32 v230, v106, v107
    v_cvt_pk_bf16_f32 v231, v108, v109
    ds_write_b64 v223, v[230:231] offset:0
    s_waitcnt lgkmcnt(3)
    v_mfma_f32_16x16x32_bf16 v[114:117], v[178:181], v[194:197], v[114:117]
    v_mfma_f32_16x16x32_bf16 v[118:121], v[158:161], v[190:193], v[118:121]
    v_cvt_pk_bf16_f32 v236, v110, v111
    v_cvt_pk_bf16_f32 v237, v112, v113
    ds_write_b64 v223, v[236:237] offset:8
    v_mfma_f32_16x16x32_bf16 v[118:121], v[178:181], v[198:201], v[118:121]
    ds_write_b32 v225, v5 offset:68
    s_waitcnt lgkmcnt(4)
    v_mfma_f32_16x16x32_bf16 v[122:125], v[162:165], v[186:189], v[122:125]
    v_cvt_pk_bf16_f32 v232, v114, v115
    v_cvt_pk_bf16_f32 v233, v116, v117
    s_waitcnt lgkmcnt(3)
    v_mfma_f32_16x16x32_bf16 v[122:125], v[182:185], v[194:197], v[122:125]
    v_mfma_f32_16x16x32_bf16 v[126:129], v[162:165], v[190:193], v[126:129]
    v_cvt_pk_bf16_f32 v238, v118, v119
    v_cvt_pk_bf16_f32 v239, v120, v121
    v_mfma_f32_16x16x32_bf16 v[126:129], v[182:185], v[198:201], v[126:129]
    v_cndmask_b32 v130, 0, v230, s[58:59]
    v_cndmask_b32 v230, v230, 0, s[58:59]
    v_cndmask_b32 v131, 0, v231, s[58:59]
    v_cndmask_b32 v231, v231, 0, s[58:59]
    buffer_load_dwordx4 v[218:221], v4, s[36:39], s100 offen sc1
    v_cvt_pk_bf16_f32 v234, v122, v123
    v_cvt_pk_bf16_f32 v235, v124, v125
    s_nop 0
    v_cvt_pk_bf16_f32 v240, v126, v127
    v_cvt_pk_bf16_f32 v241, v128, v129
    v_cndmask_b32 v136, 0, v236, s[60:61]
    v_cndmask_b32 v236, v236, 0, s[60:61]
    v_cndmask_b32 v137, 0, v237, s[60:61]
    v_cndmask_b32 v237, v237, 0, s[60:61]
    v_cndmask_b32 v132, 0, v232, s[58:59]
    v_cndmask_b32 v232, v232, 0, s[58:59]
    v_cndmask_b32 v133, 0, v233, s[58:59]
    v_cndmask_b32 v233, v233, 0, s[58:59]
    v_cndmask_b32 v138, 0, v238, s[60:61]
    v_cndmask_b32 v238, v238, 0, s[60:61]
    v_cndmask_b32 v139, 0, v239, s[60:61]
    v_cndmask_b32 v239, v239, 0, s[60:61]
    v_cndmask_b32 v134, 0, v234, s[58:59]
    v_cndmask_b32 v234, v234, 0, s[58:59]
    v_cndmask_b32 v135, 0, v235, s[58:59]
    v_cndmask_b32 v235, v235, 0, s[58:59]
    v_cndmask_b32 v140, 0, v240, s[60:61]
    v_cndmask_b32 v240, v240, 0, s[60:61]
    v_cndmask_b32 v141, 0, v241, s[60:61]
    v_cndmask_b32 v241, v241, 0, s[60:61]
    s_waitcnt lgkmcnt(0)
C_join:
    v_mov_b32 v12, s0
    v_mov_b32 v13, s0
    v_pk_mul_f32 v[214:215], v[214:215], v[12:13]
    v_pk_mul_f32 v[216:217], v[216:217], v[12:13]
    s_mov_b32 s9, 0
    s_add_u32 s19, s100, 14336
    s_cmp_lg_u32 s101, 0
    s_cbranch_scc1 C_sv
    s_mov_b32 s40, 0x0c0c0400
    s_mov_b32 s41, 0x05040100
    s_waitcnt vmcnt(0)
C_sl:
    v_perm_b32 v2, v219, v218, s40
    v_perm_b32 v3, v221, v220, s40
    v_and_b32 v218, v51, v218
    v_perm_b32 v2, v3, v2, s41
    v_and_b32 v219, v51, v219
    v_cmp_ne_u32 vcc, s12, v2
    v_and_b32 v220, v51, v220
    v_and_b32 v221, v51, v221
    s_cbranch_vccz C_sk
    buffer_load_dwordx4 v[218:221], v4, s[36:39], s100 offen sc1
    s_waitcnt vmcnt(0)
    s_add_u32 s9, s9, 1
    s_cmp_lt_u32 s9, 200000
    s_cbranch_scc1 C_sl
C_sk:
    v_pk_fma_f32 v[214:215], v[218:219], v[12:13], v[214:215]
    v_pk_fma_f32 v[216:217], v[220:221], v[12:13], v[216:217]
C_sv:
    v_max_f32 v226, v214, v215
    v_max_f32 v227, v216, v217
    v_mov_b32 v228, v226
    v_mov_b32 v229, v227
    s_mov_b64 exec, 1
    ds_add_u32 v5, v49 offset:80
    s_mov_b64 exec, -1
    v_permlane16_swap_b32 v226, v228
    v_permlane16_swap_b32 v227, v229
    v_max_f32 v226, v226, v228
    v_max_f32 v227, v227, v229
    v_mov_b32 v228, v226
    v_mov_b32 v229, v227
    s_nop 0
    v_permlane32_swap_b32 v226, v228
    v_permlane32_swap_b32 v227, v229
    v_max_f32 v226, v226, v228
    v_max_f32 v227, v227, v229
    v_sub_f32 v214, v214, v226
    v_sub_f32 v215, v215, v226
    v_sub_f32 v216, v216, v227
    v_sub_f32 v217, v217, v227
    v_exp_f32 v214, v214
    v_exp_f32 v215, v215
    v_exp_f32 v216, v216
    v_exp_f32 v217, v217
    v_add_f32 v226, v214, v215
    v_add_f32 v227, v216, v217
    v_mov_b32 v228, v226
    v_mov_b32 v229, v227
    ds_read_b32 v53, v52 offset:40
    ds_read_b128 v[82:85], v48 offset:12288
    ds_read_b128 v[86:89], v48 offset:13312
    ds_read_b32 v7, v5 offset:12
    v_permlane16_swap_b32 v226, v228
    v_permlane16_swap_b32 v227, v229
    v_add_f32 v226, v226, v228
    v_add_f32 v227, v227, v229
    v_mov_b32 v228, v226
    v_mov_b32 v229, v227
    s_nop 0
    v_permlane32_swap_b32 v226, v228
    v_permlane32_swap_b32 v227, v229
    v_add_f32 v226, v226, v228
    v_add_f32 v227, v227, v229
    v_rcp_f32 v226, v226
    v_rcp_f32 v227, v227
    s_waitcnt lgkmcnt(0)
    v_cmp_eq_u32 vcc, 0, v53
    v_mul_f32 v214, v214, v226
    v_mul_f32 v215, v215, v226
    v_mul_f32 v216, v216, v227
    v_mul_f32 v217, v217, v227
    v_cvt_pk_bf16_f32 v214, v214, v214
    v_cvt_pk_bf16_f32 v215, v215, v215
    v_cvt_pk_bf16_f32 v216, v216, v216
    v_cvt_pk_bf16_f32 v217, v217, v217
    s_cbranch_vccnz C_pr
C_pd:
    v_mfma_f32_16x16x32_bf16 v[66:69], v[130:133], v[82:85], 0
    v_and_b32 v90, v41, v214
    v_and_b32 v91, v42, v215
    v_mfma_f32_16x16x32_bf16 v[70:73], v[136:139], v[82:85], 0
    v_and_b32 v92, v43, v214
    v_and_b32 v93, v44, v215
    v_mfma_f32_16x16x32_bf16 v[74:77], v[132:135], v[86:89], 0
    v_and_b32 v94, v41, v216
    v_and_b32 v95, v42, v217
    v_mfma_f32_16x16x32_bf16 v[78:81], v[138:141], v[86:89], 0
    v_and_b32 v96, v43, v216
    v_and_b32 v97, v44, v217
    v_mfma_f32_16x16x32_bf16 v[66:69], v[230:233], v[90:93], v[66:69]
    v_mfma_f32_16x16x32_bf16 v[70:73], v[236:239], v[90:93], v[70:73]
    v_mfma_f32_16x16x32_bf16 v[74:77], v[232:235], v[94:97], v[74:77]
    v_mfma_f32_16x16x32_bf16 v[78:81], v[238:241], v[94:97], v[78:81]
    s_cmp_eq_u32 s63, 0
    s_cbranch_scc1 SM_sO
    s_nop 2
    v_cvt_pk_bf16_f32 v58, v66, v67
    v_cvt_pk_bf16_f32 v59, v68, v69
    v_cvt_pk_bf16_f32 v60, v70, v71
    v_cvt_pk_bf16_f32 v61, v72, v73
    buffer_store_dwordx4 v[58:61], v4, s[36:39], s100 offen nt
    v_cvt_pk_bf16_f32 v62, v74, v75
    v_cvt_pk_bf16_f32 v63, v76, v77
    v_cvt_pk_bf16_f32 v64, v78, v79
    v_cvt_pk_bf16_f32 v65, v80, v81
    buffer_store_dwordx4 v[62:65], v4, s[36:39], s19 offen nt
SM_jO:
    ds_write_b128 v18, v[58:61] offset:20480
    ds_write_b128 v18, v[62:65] offset:22528
    ds_write_b32 v52, v5 offset:96
    v_cmp_gt_u32 vcc, 4, v7
    s_nop 0
    s_cbranch_vccz W_dW
    s_mov_b32 s9, 0
W_lW:
    ds_read_b32 v2, v5 offset:12
    s_add_u32 s9, s9, 1
    s_cmp_gt_u32 s9, 1600000
    s_cbranch_scc1 W_dW
    s_waitcnt lgkmcnt(0)
    v_cmp_gt_u32 vcc, 4, v2
    s_nop 0
    s_cbranch_vccnz W_lW
W_dW:
    ds_read_b64_tr_b16 v[82:83], v21 offset:0
    ds_read_b64_tr_b16 v[84:85], v21 offset:2048
    ds_read_b64_tr_b16 v[86:87], v22 offset:0
    ds_read_b64_tr_b16 v[88:89], v22 offset:2048
    ds_read_b64_tr_b16 v[90:91], v23 offset:0
    ds_read_b64_tr_b16 v[92:93], v23 offset:2048
    ds_read_b64_tr_b16 v[94:95], v24 offset:0
    ds_read_b64_tr_b16 v[96:97], v24 offset:2048
    ds_read_b64_tr_b16 v[98:99], v21 offset:4096
    ds_read_b64_tr_b16 v[100:101], v21 offset:6144
    ds_read_b64_tr_b16 v[102:103], v22 offset:4096
    ds_read_b64_tr_b16 v[104:105], v22 offset:6144
    ds_read_b64_tr_b16 v[106:107], v23 offset:4096
    ds_read_b64_tr_b16 v[108:109], v23 offset:6144
    ds_read_b64_tr_b16 v[110:111], v24 offset:4096
    ds_read_b64_tr_b16 v[112:113], v24 offset:6144
    s_waitcnt vmcnt(0)
    s_mov_b64 exec, 1
    s_cmp_eq_u32 s63, 0
    s_cbranch_scc1 SM_sF
    buffer_store_dwordx2 v[14:15], v6, s[36:39], s21 offen
SM_jF:
    s_mov_b64 exec, -1
    ds_read_b64_tr_b16 v[114:115], v21 offset:8192
    ds_read_b64_tr_b16 v[116:117], v21 offset:10240
    ds_read_b64_tr_b16 v[118:119], v22 offset:8192
    ds_read_b64_tr_b16 v[120:121], v22 offset:10240
    ds_read_b64_tr_b16 v[122:123], v23 offset:8192
    ds_read_b64_tr_b16 v[124:125], v23 offset:10240
    ds_read_b64_tr_b16 v[126:127], v24 offset:8192
    ds_read_b64_tr_b16 v[128:129], v24 offset:10240
    ds_read_b64_tr_b16 v[130:131], v21 offset:12288
    ds_read_b64_tr_b16 v[132:133], v21 offset:14336
    ds_read_b64_tr_b16 v[134:135], v22 offset:12288
    ds_read_b64_tr_b16 v[136:137], v22 offset:14336
    ds_read_b64_tr_b16 v[138:139], v23 offset:12288
    ds_read_b64_tr_b16 v[140:141], v23 offset:14336
    ds_read_b64_tr_b16 v[142:143], v24 offset:12288
    ds_read_b64_tr_b16 v[144:145], v24 offset:14336
    ds_read_b64_tr_b16 v[146:147], v21 offset:16384
    ds_read_b64_tr_b16 v[148:149], v21 offset:18432
    ds_read_b64_tr_b16 v[150:151], v22 offset:16384
    ds_read_b64_tr_b16 v[152:153], v22 offset:18432
    ds_read_b64_tr_b16 v[154:155], v23 offset:16384
    ds_read_b64_tr_b16 v[156:157], v23 offset:18432
    ds_read_b64_tr_b16 v[158:159], v24 offset:16384
    ds_read_b64_tr_b16 v[160:161], v24 offset:18432
    buffer_load_dwordx2 v[12:13], v8, s[36:39], s20 offen sc1
    s_waitcnt lgkmcnt(0)
    s_mov_b32 s9, 0
C_wl:
    ds_read_b64 v[16:17], v20 offset:96
    ds_read_b128 v[46:49], v19 offset:20480
    ds_read_b128 v[50:53], v19 offset:21504
    s_add_u32 s9, s9, 1
    s_cmp_gt_u32 s9, 1600000
    s_cbranch_scc1 C_wd
    s_waitcnt lgkmcnt(2)
    v_and_b32 v16, v16, v17
    v_cmp_eq_u32 vcc, 0, v16
    s_waitcnt lgkmcnt(0)
    s_cbranch_vccnz C_wl
C_wd:
    s_waitcnt lgkmcnt(0)
    v_mfma_f32_16x16x32_bf16 v[30:33], v[82:85], v[46:49], 0
    ds_read_b64_tr_b16 v[162:163], v21 offset:20480
    v_mfma_f32_16x16x32_bf16 v[30:33], v[98:101], v[50:53], v[30:33]
    ds_read_b64_tr_b16 v[164:165], v21 offset:22528
    v_mfma_f32_16x16x32_bf16 v[34:37], v[86:89], v[46:49], 0
    ds_read_b64_tr_b16 v[166:167], v22 offset:20480
    v_mfma_f32_16x16x32_bf16 v[34:37], v[102:105], v[50:53], v[34:37]
    ds_read_b64_tr_b16 v[168:169], v22 offset:22528
    v_mfma_f32_16x16x32_bf16 v[38:41], v[90:93], v[46:49], 0
    ds_read_b64_tr_b16 v[170:171], v23 offset:20480
    v_mfma_f32_16x16x32_bf16 v[38:41], v[106:109], v[50:53], v[38:41]
    ds_read_b64_tr_b16 v[172:173], v23 offset:22528
    v_mfma_f32_16x16x32_bf16 v[42:45], v[94:97], v[46:49], 0
    ds_read_b64_tr_b16 v[174:175], v24 offset:20480
    v_mfma_f32_16x16x32_bf16 v[42:45], v[110:113], v[50:53], v[42:45]
    ds_read_b64_tr_b16 v[176:177], v24 offset:22528
    ds_read_b64_tr_b16 v[178:179], v21 offset:24576
    ds_read_b64_tr_b16 v[180:181], v21 offset:26624
    ds_read_b64_tr_b16 v[182:183], v22 offset:24576
    ds_read_b64_tr_b16 v[184:185], v22 offset:26624
    ds_read_b64_tr_b16 v[186:187], v23 offset:24576
    ds_read_b64_tr_b16 v[188:189], v23 offset:26624
    ds_read_b64_tr_b16 v[190:191], v24 offset:24576
    ds_read_b64_tr_b16 v[192:193], v24 offset:26624
    s_mov_b32 s9, 0
P_lO:
    s_waitcnt vmcnt(0)
    v_cmp_ne_u64 vcc, s[12:13], v[12:13]
    s_nop 0
    s_cbranch_vccz P_dO
    buffer_load_dwordx2 v[12:13], v8, s[36:39], s20 offen sc1
    s_add_u32 s9, s9, 1
    s_cmp_lt_u32 s9, 200000
    s_cbranch_scc1 P_lO
    s_waitcnt vmcnt(0)
P_dO:
    buffer_load_dwordx4 v[54:57], v4, s[36:39], s1 offen offset:0 sc1
    buffer_load_dwordx4 v[58:61], v4, s[36:39], s1 offen offset:1024 sc1
    buffer_load_dwordx4 v[62:65], v4, s[36:39], s4 offen offset:0 sc1
    buffer_load_dwordx4 v[66:69], v4, s[36:39], s4 offen offset:1024 sc1
    buffer_load_dwordx4 v[70:73], v4, s[36:39], s6 offen offset:0 sc1
C_go:
    ds_read_b32 v7, v5 offset:36
    ds_read_b64_tr_b16 v[194:195], v21 offset:28672
    ds_read_b64_tr_b16 v[196:197], v21 offset:30720
    ds_read_b64_tr_b16 v[198:199], v22 offset:28672
    ds_read_b64_tr_b16 v[200:201], v22 offset:30720
    ds_read_b64_tr_b16 v[202:203], v23 offset:28672
    ds_read_b64_tr_b16 v[204:205], v23 offset:30720
    ds_read_b64_tr_b16 v[206:207], v24 offset:28672
    ds_read_b64_tr_b16 v[208:209], v24 offset:30720
    ds_read_b64_tr_b16 v[210:211], v21 offset:32768
    ds_read_b64_tr_b16 v[212:213], v21 offset:34816
    ds_read_b64_tr_b16 v[214:215], v22 offset:32768
    ds_read_b64_tr_b16 v[216:217], v22 offset:34816
    ds_read_b64_tr_b16 v[218:219], v23 offset:32768
    ds_read_b64_tr_b16 v[220:221], v23 offset:34816
    ds_read_b64_tr_b16 v[222:223], v24 offset:32768
    ds_read_b64_tr_b16 v[224:225], v24 offset:34816
    ds_read_b64_tr_b16 v[226:227], v21 offset:36864
    ds_read_b64_tr_b16 v[228:229], v21 offset:38912
    ds_read_b64_tr_b16 v[230:231], v22 offset:36864
    ds_read_b64_tr_b16 v[232:233], v22 offset:38912
    ds_read_b64_tr_b16 v[234:235], v23 offset:36864
    ds_read_b64_tr_b16 v[236:237], v23 offset:38912
    ds_read_b64_tr_b16 v[238:239], v24 offset:36864
    ds_read_b64_tr_b16 v[240:241], v24 offset:38912
    s_waitcnt vmcnt(4)
    v_mfma_f32_16x16x32_bf16 v[30:33], v[114:117], v[54:57], v[30:33]
    buffer_load_dwordx4 v[74:77], v4, s[36:39], s6 offen offset:1024 sc1
    v_mfma_f32_16x16x32_bf16 v[34:37], v[118:121], v[54:57], v[34:37]
    s_waitcnt lgkmcnt(15)
    v_cmp_gt_u32 vcc, 4, v7
    s_nop 0
    s_cbranch_vccnz C_w2
W_dW2:
    ds_read_b64_tr_b16 v[82:83], v21 offset:40960
    v_mfma_f32_16x16x32_bf16 v[38:41], v[122:125], v[54:57], v[38:41]
    ds_read_b64_tr_b16 v[84:85], v21 offset:43008
    v_mfma_f32_16x16x32_bf16 v[42:45], v[126:129], v[54:57], v[42:45]
    ds_read_b64_tr_b16 v[86:87], v22 offset:40960
    s_waitcnt vmcnt(4)
    v_mfma_f32_16x16x32_bf16 v[30:33], v[130:133], v[58:61], v[30:33]
    buffer_load_dwordx4 v[78:81], v4, s[36:39], s24 offen offset:0 sc1
    v_mfma_f32_16x16x32_bf16 v[34:37], v[134:137], v[58:61], v[34:37]
    ds_read_b64_tr_b16 v[88:89], v22 offset:43008
    v_mfma_f32_16x16x32_bf16 v[38:41], v[138:141], v[58:61], v[38:41]
    ds_read_b64_tr_b16 v[90:91], v23 offset:40960
    v_mfma_f32_16x16x32_bf16 v[42:45], v[142:145], v[58:61], v[42:45]
    ds_read_b64_tr_b16 v[92:93], v23 offset:43008
    s_waitcnt vmcnt(4)
    v_mfma_f32_16x16x32_bf16 v[30:33], v[146:149], v[62:65], v[30:33]
    buffer_load_dwordx4 v[46:49], v4, s[36:39], s24 offen offset:1024 sc1
    v_mfma_f32_16x16x32_bf16 v[34:37], v[150:153], v[62:65], v[34:37]
    ds_read_b64_tr_b16 v[94:95], v24 offset:40960
    v_mfma_f32_16x16x32_bf16 v[38:41], v[154:157], v[62:65], v[38:41]
    ds_read_b64_tr_b16 v[96:97], v24 offset:43008
    v_mfma_f32_16x16x32_bf16 v[42:45], v[158:161], v[62:65], v[42:45]
    ds_read_b64_tr_b16 v[98:99], v21 offset:45056
    s_waitcnt vmcnt(4)
    v_mfma_f32_16x16x32_bf16 v[30:33], v[162:165], v[66:69], v[30:33]
    buffer_load_dwordx4 v[50:53], v4, s[36:39], s25 offen offset:0 sc1
    v_mfma_f32_16x16x32_bf16 v[34:37], v[166:169], v[66:69], v[34:37]
    ds_read_b64_tr_b16 v[100:101], v21 offset:47104
    v_mfma_f32_16x16x32_bf16 v[38:41], v[170:173], v[66:69], v[38:41]
    ds_read_b64_tr_b16 v[102:103], v22 offset:45056
    v_mfma_f32_16x16x32_bf16 v[42:45], v[174:177], v[66:69], v[42:45]
    ds_read_b64_tr_b16 v[104:105], v22 offset:47104
    s_waitcnt vmcnt(4)
    v_mfma_f32_16x16x32_bf16 v[30:33], v[178:181], v[70:73], v[30:33]
    buffer_load_dwordx4 v[54:57], v4, s[36:39], s25 offen offset:1024 sc1
    v_mfma_f32_16x16x32_bf16 v[34:37], v[182:185], v[70:73], v[34:37]
    ds_read_b64_tr_b16 v[106:107], v23 offset:45056
    v_mfma_f32_16x16x32_bf16 v[38:41], v[186:189], v[70:73], v[38:41]
    ds_read_b64_tr_b16 v[108:109], v23 offset:47104
    v_mfma_f32_16x16x32_bf16 v[42:45], v[190:193], v[70:73], v[42:45]
    ds_read_b64_tr_b16 v[110:111], v24 offset:45056
    s_waitcnt vmcnt(4)
    v_mfma_f32_16x16x32_bf16 v[30:33], v[194:197], v[74:77], v[30:33]
    buffer_load_dwordx4 v[58:61], v4, s[36:39], s26 offen offset:0 sc1
    v_mfma_f32_16x16x32_bf16 v[34:37], v[198:201], v[74:77], v[34:37]
    ds_read_b64_tr_b16 v[112:113], v24 offset:47104
    v_mfma_f32_16x16x32_bf16 v[38:41], v[202:205], v[74:77], v[38:41]
    ds_read_b64_tr_b16 v[114:115], v21 offset:49152
    v_mfma_f32_16x16x32_bf16 v[42:45], v[206:209], v[74:77], v[42:45]
    ds_read_b64_tr_b16 v[116:117], v21 offset:51200
    s_waitcnt vmcnt(4)
    s_waitcnt lgkmcnt(15)
    v_mfma_f32_16x16x32_bf16 v[30:33], v[210:213], v[78:81], v[30:33]
    buffer_load_dwordx4 v[62:65], v4, s[36:39], s26 offen offset:1024 sc1
    v_mfma_f32_16x16x32_bf16 v[34:37], v[214:217], v[78:81], v[34:37]
    ds_read_b64_tr_b16 v[118:119], v22 offset:49152
    v_mfma_f32_16x16x32_bf16 v[38:41], v[218:221], v[78:81], v[38:41]
    ds_read_b64_tr_b16 v[120:121], v22 offset:51200
    v_mfma_f32_16x16x32_bf16 v[42:45], v[222:225], v[78:81], v[42:45]
    ds_read_b64_tr_b16 v[122:123], v23 offset:49152
    s_waitcnt vmcnt(4)
    v_mfma_f32_16x16x32_bf16 v[30:33], v[226:229], v[46:49], v[30:33]
    ds_read_b64_tr_b16 v[124:125], v23 offset:51200
    ds_read_b64_tr_b16 v[126:127], v24 offset:49152
    v_mfma_f32_16x16x32_bf16 v[34:37], v[230:233], v[46:49], v[34:37]
    ds_read_b64_tr_b16 v[128:129], v24 offset:51200
    v_mfma_f32_16x16x32_bf16 v[38:41], v[234:237], v[46:49], v[38:41]
    ds_read_b64_tr_b16 v[130:131], v21 offset:53248
    v_mfma_f32_16x16x32_bf16 v[42:45], v[238:241], v[46:49], v[42:45]
    ds_read_b64_tr_b16 v[132:133], v21 offset:55296
    s_waitcnt vmcnt(3)
    v_mfma_f32_16x16x32_bf16 v[30:33], v[82:85], v[50:53], v[30:33]
    ds_read_b64_tr_b16 v[134:135], v22 offset:53248
    ds_read_b64_tr_b16 v[136:137], v22 offset:55296
    s_waitcnt lgkmcnt(15)
    v_mfma_f32_16x16x32_bf16 v[34:37], v[86:89], v[50:53], v[34:37]
    ds_read_b64_tr_b16 v[138:139], v23 offset:53248
    ds_read_b64_tr_b16 v[140:141], v23 offset:55296
    v_mfma_f32_16x16x32_bf16 v[38:41], v[90:93], v[50:53], v[38:41]
    ds_read_b64_tr_b16 v[142:143], v24 offset:53248
    ds_read_b64_tr_b16 v[144:145], v24 offset:55296
    v_mfma_f32_16x16x32_bf16 v[42:45], v[94:97], v[50:53], v[42:45]
    s_waitcnt vmcnt(2)
    v_mfma_f32_16x16x32_bf16 v[30:33], v[98:101], v[54:57], v[30:33]
    v_mfma_f32_16x16x32_bf16 v[34:37], v[102:105], v[54:57], v[34:37]
    s_waitcnt lgkmcnt(15)
    v_mfma_f32_16x16x32_bf16 v[38:41], v[106:109], v[54:57], v[38:41]
    v_mfma_f32_16x16x32_bf16 v[42:45], v[110:113], v[54:57], v[42:45]
    s_waitcnt vmcnt(1)
    s_waitcnt lgkmcnt(14)
    v_mfma_f32_16x16x32_bf16 v[30:33], v[114:117], v[58:61], v[30:33]
    s_waitcnt lgkmcnt(12)
    v_mfma_f32_16x16x32_bf16 v[34:37], v[118:121], v[58:61], v[34:37]
    s_waitcnt lgkmcnt(10)
    v_mfma_f32_16x16x32_bf16 v[38:41], v[122:125], v[58:61], v[38:41]
    s_waitcnt lgkmcnt(8)
    v_mfma_f32_16x16x32_bf16 v[42:45], v[126:129], v[58:61], v[42:45]
    s_waitcnt vmcnt(0)
    s_waitcnt lgkmcnt(6)
    v_mfma_f32_16x16x32_bf16 v[30:33], v[130:133], v[62:65], v[30:33]
    s_waitcnt lgkmcnt(4)
    v_mfma_f32_16x16x32_bf16 v[34:37], v[134:137], v[62:65], v[34:37]
    s_waitcnt lgkmcnt(2)
    v_mfma_f32_16x16x32_bf16 v[38:41], v[138:141], v[62:65], v[38:41]
    s_waitcnt lgkmcnt(0)
    v_mfma_f32_16x16x32_bf16 v[42:45], v[142:145], v[62:65], v[42:45]
    s_nop 1
    v_cvt_pk_bf16_f32 v162, v30, v31
    v_cvt_pk_bf16_f32 v163, v32, v33
    ds_write_b64 v25, v[162:163]
    v_cvt_pk_bf16_f32 v164, v34, v35
    v_cvt_pk_bf16_f32 v165, v36, v37
    ds_write_b64 v26, v[164:165]
    v_cvt_pk_bf16_f32 v166, v38, v39
    v_cvt_pk_bf16_f32 v167, v40, v41
    ds_write_b64 v27, v[166:167]
    v_cvt_pk_bf16_f32 v168, v42, v43
    v_cvt_pk_bf16_f32 v169, v44, v45
    ds_write_b64 v28, v[168:169]
    ds_read_b128 v[178:181], v9
    ds_read_b128 v[182:185], v9 offset:1024
    s_waitcnt lgkmcnt(1)
    buffer_store_dwordx4 v[178:181], v10, s[32:35], s23 offen nt
    s_waitcnt lgkmcnt(0)
    buffer_store_dwordx4 v[182:185], v10, s[32:35], s28 offen nt
    s_add_u32 s40, s7, s62
    s_cmp_lg_u32 s40, 0
    s_cbranch_scc1 C_end
    s_add_u32 s40, s10, 16
    v_mov_b32 v2, s40
    s_lshl_b32 s40, s8, 7
    s_mov_b64 exec, 1
    buffer_store_dword v2, v6, s[36:39], s40 offen
C_end:
    s_endpgm
K_cold:
X_cH:
    s_mov_b32 s9, 0
X_lH:
    v_cmp_ne_u64 vcc, s[28:29], v[18:19]
    s_nop 0
    s_cbranch_vccz X_okH
    v_subrev_u32 v18, s12, v18
    v_cmp_ne_u32 s[42:43], s13, v19
    v_cmp_le_u32 vcc, 8, v18
    s_nop 0
    s_or_b64 vcc, vcc, s[42:43]
    s_cbranch_vccz X_nH
    buffer_load_dwordx2 v[18:19], v20, s[36:39], s30 offen sc1
    s_add_u32 s9, s9, 1
    s_cmp_lt_u32 s9, 200000
    s_waitcnt vmcnt(0)
    s_cbranch_scc1 X_lH
X_nH:
    s_mov_b32 s101, 0
    s_branch X_okH
S_cls0:
    s_cmp_eq_u32 s56, 0
    s_cbranch_scc0 S_cls1
    v_cmp_eq_u32 s[42:43], 0, v3
    s_bitcmp1_b32 s3, 1
    s_cselect_b32 s61, 1.0, 0
    s_cselect_b32 s62, 0, 1.0
    v_mov_b32 v106, s62
    v_mov_b32 v107, s61
    v_cndmask_b32 v102, v102, v106, s[42:43]
    v_cndmask_b32 v103, v103, v107, s[42:43]
    v_cndmask_b32 v104, v104, v106, s[42:43]
    v_cndmask_b32 v105, v105, v107, s[42:43]
    v_mov_b32 v106, 0
    v_mov_b32 v107, 0
    v_mov_b32 v108, 0
    v_mov_b32 v109, 0
    s_branch S_reg
S_cls1:
    v_mov_b32 v106, v102
    v_mov_b32 v102, 0
    v_mov_b32 v107, v103
    v_mov_b32 v103, 0
    v_mov_b32 v108, v104
    v_mov_b32 v104, 0
    v_mov_b32 v109, v105
    v_mov_b32 v105, 0
    s_branch S_reg
S_gr:
    s_add_u32 s9, s9, 1
    s_cmp_gt_u32 s9, 200000
    s_cbranch_scc1 S_gk
    buffer_load_dwordx4 v60, s[36:39], s60 offen offset:0 sc1 lds
    buffer_load_dwordx4 v60, s[36:39], s60 offen offset:1024 sc1 lds
    buffer_load_dwordx4 v60, s[36:39], s60 offen offset:2048 sc1 lds
    buffer_load_dwordx4 v60, s[36:39], s60 offen offset:3072 sc1 lds
    s_waitcnt lgkmcnt(0)
    s_branch S_gc
S_y0:
    v_cmp_eq_u32 s[42:43], 0, v3
    v_mfma_f32_16x16x32_bf16 v[28:31], v[120:123], v[200:203], 0
    v_mfma_f32_16x16x32_bf16 v[28:31], v[124:127], v[204:207], v[28:31]
    v_mfma_f32_16x16x32_bf16 v[32:35], v[128:131], v[208:211], 0
    v_mfma_f32_16x16x32_bf16 v[32:35], v[132:135], v[212:215], v[32:35]
    v_mfma_f32_16x16x32_bf16 v[36:39], v[152:155], v[184:187], 0
    v_mfma_f32_16x16x32_bf16 v[36:39], v[156:159], v[188:191], v[36:39]
    v_mfma_f32_16x16x32_bf16 v[40:43], v[160:163], v[192:195], 0
    v_mfma_f32_16x16x32_bf16 v[40:43], v[164:167], v[196:199], v[40:43]
    s_nop 1
    v_cndmask_b32 v224, v224, v28, s[42:43]
    v_cndmask_b32 v225, v225, v29, s[42:43]
    v_cndmask_b32 v226, v226, v30, s[42:43]
    v_cndmask_b32 v227, v227, v31, s[42:43]
    v_cndmask_b32 v228, v228, v32, s[42:43]
    v_cndmask_b32 v229, v229, v33, s[42:43]
    v_cndmask_b32 v230, v230, v34, s[42:43]
    v_cndmask_b32 v231, v231, v35, s[42:43]
    v_cndmask_b32 v240, v240, v36, s[42:43]
    v_cndmask_b32 v241, v241, v37, s[42:43]
    v_cndmask_b32 v242, v242, v38, s[42:43]
    v_cndmask_b32 v243, v243, v39, s[42:43]
    v_cndmask_b32 v244, v244, v40, s[42:43]
    v_cndmask_b32 v245, v245, v41, s[42:43]
    v_cndmask_b32 v246, v246, v42, s[42:43]
    v_cndmask_b32 v247, v247, v43, s[42:43]
    s_branch S_y1
C_mr0:
    s_mov_b32 s9, 0
W_lM0:
    ds_read_b32 v2, v5 offset:4
    s_add_u32 s9, s9, 1
    s_cmp_gt_u32 s9, 1600000
    s_cbranch_scc1 W_dM0
    s_waitcnt lgkmcnt(0)
    v_cmp_gt_u32 vcc, 1, v2
    s_nop 0
    s_cbranch_vccnz W_lM0
W_dM0:
    s_waitcnt lgkmcnt(0)
    v_readfirstlane_b32 s63, v2
    s_nop 0
    s_lshr_b32 s63, s63, 1
    s_branch C_md0
SM_sS0:
    buffer_store_dwordx4 v[98:101], v4, s[36:39], s15 offen sc1
    s_branch SM_jS0
C_vr0:
    s_mov_b32 s9, 0
W_lV0:
    ds_read_b32 v2, v5 offset:32
    s_add_u32 s9, s9, 1
    s_cmp_gt_u32 s9, 1600000
    s_cbranch_scc1 W_dV0
    s_waitcnt lgkmcnt(0)
    v_cmp_gt_u32 vcc, 4, v2
    s_nop 0
    s_cbranch_vccnz W_lV0
W_dV0:
    ds_read_b64_tr_b16 v[170:171], v39 offset:32768
    ds_read_b64_tr_b16 v[172:173], v39 offset:33280
    ds_read_b64_tr_b16 v[174:175], v40 offset:32768
    ds_read_b64_tr_b16 v[176:177], v40 offset:33280
    ds_read_b64_tr_b16 v[202:203], v39 offset:36864
    ds_read_b64_tr_b16 v[204:205], v39 offset:37376
    ds_read_b64_tr_b16 v[206:207], v40 offset:36864
    ds_read_b64_tr_b16 v[208:209], v40 offset:37376
    s_waitcnt lgkmcnt(0)
    s_branch C_vd0
C_mr1:
    s_mov_b32 s9, 0
W_lM1:
    ds_read_b32 v2, v5 offset:4
    s_add_u32 s9, s9, 1
    s_cmp_gt_u32 s9, 1600000
    s_cbranch_scc1 W_dM1
    s_waitcnt lgkmcnt(0)
    v_cmp_gt_u32 vcc, 1, v2
    s_nop 0
    s_cbranch_vccnz W_lM1
W_dM1:
    s_waitcnt lgkmcnt(0)
    v_readfirstlane_b32 s63, v2
    s_nop 0
    s_lshr_b32 s63, s63, 1
    s_branch C_md1
SM_sS1:
    buffer_store_dwordx4 v[98:101], v4, s[36:39], s15 offen sc1
    s_branch SM_jS1
C_vr1:
    s_mov_b32 s9, 0
W_lV1:
    ds_read_b32 v2, v5 offset:32
    s_add_u32 s9, s9, 1
    s_cmp_gt_u32 s9, 1600000
    s_cbranch_scc1 W_dV1
    s_waitcnt lgkmcnt(0)
    v_cmp_gt_u32 vcc, 4, v2
    s_nop 0
    s_cbranch_vccnz W_lV1
W_dV1:
    ds_read_b64_tr_b16 v[170:171], v39 offset:32768
    ds_read_b64_tr_b16 v[172:173], v39 offset:33280
    ds_read_b64_tr_b16 v[174:175], v40 offset:32768
    ds_read_b64_tr_b16 v[176:177], v40 offset:33280
    ds_read_b64_tr_b16 v[202:203], v39 offset:36864
    ds_read_b64_tr_b16 v[204:205], v39 offset:37376
    ds_read_b64_tr_b16 v[206:207], v40 offset:36864
    ds_read_b64_tr_b16 v[208:209], v40 offset:37376
    s_waitcnt lgkmcnt(0)
    s_branch C_vd1
C_pr:
    s_mov_b32 s9, 0
C_pl:
    ds_read_b32 v53, v52 offset:40
    ds_read_b128 v[82:85], v48 offset:12288
    ds_read_b128 v[86:89], v48 offset:13312
    s_add_u32 s9, s9, 1
    s_cmp_gt_u32 s9, 1600000
    s_waitcnt lgkmcnt(0)
    s_cbranch_scc1 C_pd
    v_cmp_eq_u32 vcc, 0, v53
    s_nop 0
    s_cbranch_vccnz C_pl
    s_branch C_pd
SM_sO:
    s_nop 7
    v_cvt_pk_bf16_f32 v58, v66, v67
    v_cvt_pk_bf16_f32 v59, v68, v69
    v_cvt_pk_bf16_f32 v60, v70, v71
    v_cvt_pk_bf16_f32 v61, v72, v73
    buffer_store_dwordx4 v[58:61], v4, s[36:39], s100 offen sc1
    v_cvt_pk_bf16_f32 v62, v74, v75
    v_cvt_pk_bf16_f32 v63, v76, v77
    v_cvt_pk_bf16_f32 v64, v78, v79
    v_cvt_pk_bf16_f32 v65, v80, v81
    buffer_store_dwordx4 v[62:65], v4, s[36:39], s19 offen sc1
    s_branch SM_jO
SM_sF:
    buffer_store_dwordx2 v[14:15], v6, s[36:39], s21 offen sc1
    s_branch SM_jF
C_w2:
    s_mov_b32 s9, 0
W_lW3:
    ds_read_b32 v2, v5 offset:36
    s_add_u32 s9, s9, 1
    s_cmp_gt_u32 s9, 1600000
    s_cbranch_scc1 W_dW3
    s_waitcnt lgkmcnt(0)
    v_cmp_gt_u32 vcc, 4, v2
    s_nop 0
    s_cbranch_vccnz W_lW3
W_dW3:
    s_waitcnt lgkmcnt(0)
    s_branch W_dW2
K_exit:
    s_endpgm
.fill 7168, 4, 0xbf810000
.section .rodata,"a"
.p2align 6
.amdhsa_kernel concat_heads__sliding_local_dilated__spectral_fnet__prompt_kernel
  .amdhsa_next_free_vgpr 256
  .amdhsa_next_free_sgpr 102
  .amdhsa_accum_offset 256
  .amdhsa_group_segment_fixed_size 0
  .amdhsa_kernarg_size 88
  .amdhsa_user_sgpr_count 2
  .amdhsa_user_sgpr_kernarg_segment_ptr 1
  .amdhsa_system_sgpr_workgroup_id_x 1
.end_amdhsa_kernel
```
